```python
import torch

def _softmax(x, axis=-1):
    return torch.softmax(x, dim=axis)

def _gelu(x):
    return torch.nn.functional.gelu(x, approximate='tanh')

def _silu(x):
    return torch.nn.functional.silu(x)

def _sigmoid(x):
    return torch.sigmoid(x)

def _layernorm(x, axis=-1, eps=1e-05):
    m = x.mean(dim=axis, keepdim=True)
    v = x.var(dim=axis, keepdim=True, unbiased=False)
    return (x - m) / torch.sqrt(v + eps)

def _scatter_add(tgt, idx, src, axis=0):
    return tgt.clone().index_add_(axis, idx, src)

def _segment_sum(src, seg, n):
    out = torch.zeros((n,) + src.shape[1:], dtype=src.dtype)
    return out.index_add_(0, seg, src)

def _pad(x, pw):
    flat = tuple((v for pair in reversed(pw) for v in pair))
    return torch.nn.functional.pad(x, flat)
kernel_name = 'concat_heads__memory_aug_recurrent_mem_tr__ssm_conv_s4__prompt'

def setup_inputs():

    _w = lambda a: (lambda t: t.to(torch.bfloat16) if t.is_floating_point() else t)(torch.as_tensor(a))

    def _A_setup():
        B, S, Dm = (1, 2048, 1024)
        H, Dh = (32, 128)
        M, seg = (8, 32)
        seg = min(seg, S)
        S = S // seg * seg
        return {'x': _w((lambda *s: torch.randn(*s, dtype=torch.bfloat16) * 0.05)(B, S, Dm)), 'mem0': _w((lambda *s: torch.randn(*s, dtype=torch.bfloat16) * 0.4)(B, M, Dm)), 'Wq': _w((lambda *s: torch.randn(*s, dtype=torch.bfloat16) * 6.4)(Dm, H, Dh) * Dm ** (-0.5)), 'Wk': _w((lambda *s: torch.randn(*s, dtype=torch.bfloat16) * 6.4)(Dm, H, Dh) * Dm ** (-0.5)), 'Wv': _w((lambda *s: torch.randn(*s, dtype=torch.bfloat16) * 0.4)(Dm, H, Dh) * Dm ** (-0.5)), 'Wo': _w((lambda *s: torch.randn(*s, dtype=torch.bfloat16) * 0.4)(H, Dh, Dm) * (H * Dh) ** (-0.5)), 'seg_len': seg}
    _A_in = _A_setup()

    def _B_setup():
        B, L, D, N = (1, 2048, 1024, 128)
        A_re = -(lambda _x: torch.exp(torch.as_tensor(_x)))((lambda *s: torch.randn(*s, dtype=torch.bfloat16) * 6.4)(D, N))
        A_im = torch.pi * (lambda *s: torch.randn(*s, dtype=torch.bfloat16) * 0.05)(D, N)
        B_re = (lambda *s: torch.randn(*s, dtype=torch.bfloat16) * 0.1)(D, N)
        B_im = (lambda *s: torch.randn(*s, dtype=torch.bfloat16) * 0.1)(D, N)
        C_re = (lambda *s: torch.randn(*s, dtype=torch.bfloat16) * 0.1)(D, N)
        C_im = (lambda *s: torch.randn(*s, dtype=torch.bfloat16) * 0.1)(D, N)
        log_dt = (lambda *s: torch.randn(*s, dtype=torch.bfloat16) * 0.05)(D) * 0.5 - 4.0
        Dskip = (lambda *s: torch.randn(*s, dtype=torch.bfloat16) * 0.05)(D)
        return {'u': _w((lambda *s: torch.randn(*s, dtype=torch.bfloat16) * 0.05)(B, L, D)), 'A_re': _w(A_re), 'A_im': _w(A_im), 'B_re': _w(B_re), 'B_im': _w(B_im), 'C_re': _w(C_re), 'C_im': _w(C_im), 'log_dt': _w(log_dt), 'Dskip': _w(Dskip)}
    _B_in = _B_setup()
    return {'A_x': _A_in['x'], 'A_mem0': _A_in['mem0'], 'A_Wq': _A_in['Wq'], 'A_Wk': _A_in['Wk'], 'A_Wv': _A_in['Wv'], 'A_Wo': _A_in['Wo'], 'A_seg_len': _A_in['seg_len'], 'B_u': _B_in['u'], 'B_A_re': _B_in['A_re'], 'B_A_im': _B_in['A_im'], 'B_B_re': _B_in['B_re'], 'B_B_im': _B_in['B_im'], 'B_C_re': _B_in['C_re'], 'B_C_im': _B_in['C_im'], 'B_log_dt': _B_in['log_dt'], 'B_Dskip': _B_in['Dskip']}

def reference(A_x, A_mem0, A_Wq, A_Wk, A_Wv, A_Wo, A_seg_len, B_u, B_A_re, B_A_im, B_B_re, B_B_im, B_C_re, B_C_im, B_log_dt, B_Dskip):

    def _A_ref(x, mem0, Wq, Wk, Wv, Wo, seg_len):
        B, S, Dm = x.shape
        H, Dh = (Wq.shape[1], Wq.shape[2])
        M = mem0.shape[1]
        scale = Dh ** (-0.5)
        n_seg = S // seg_len
        L = M + seg_len
        idx = torch.arange(L)
        mask = (idx[:, None] < M) | (idx[:, None] >= idx[None, :])
        mem = mem0
        outs = []
        for s in range(n_seg):
            xs = x[:, s * seg_len:(s + 1) * seg_len, :].clone()
            h = torch.concatenate([mem, xs], axis=1)
            q = torch.einsum('btd,dhe->bhte', h, Wq)
            k = torch.einsum('btd,dhe->bhte', h, Wk)
            v = torch.einsum('btd,dhe->bhte', h, Wv)
            scores = torch.einsum('bhqe,bhke->bhqk', q, k) * scale
            scores = torch.where(mask[None, None], scores, -1000000000.0)
            p = _softmax(scores, axis=-1)
            o = torch.einsum('bhqk,bhke->bhqe', p, v)
            o = torch.einsum('bhte,hed->btd', o, Wo)
            mem = o[:, :M, :].clone()
            outs.append(o[:, M:, :])
        return torch.concatenate(outs, axis=1)

    def _B_ref(u, A_re, A_im, B_re, B_im, C_re, C_im, log_dt, Dskip):
        Bsz, L, D = u.shape
        dt = torch.exp(log_dt)[:, None]
        A = A_re + 1j * A_im
        Bc = B_re + 1j * B_im
        Cc = C_re + 1j * C_im
        logdA = dt * A
        dB = dt * Bc
        l = (lambda x, dt: x.to(dt))(torch.arange(L), A_re.dtype)
        P = torch.exp(logdA[:, :, None] * l[None, None, :])
        K = torch.einsum('dn,dnl,dn->dl', Cc, P, dB).real
        L2 = 2 * L
        Kp = _pad(K, ((0, 0), (0, L)))
        up = (lambda x, *d: x.permute(*d))(u, 0, 2, 1)
        up = _pad(up, ((0, 0), (0, 0), (0, L)))
        Kf = (lambda x, axes=(-2, -1): torch.fft.rfft2(x.float(), dim=axes))(Kp[:, None, :], axes=(-2, -1))
        Uf = (lambda x, axes=(-2, -1): torch.fft.rfft2(x.float(), dim=axes))(up[:, :, None, :], axes=(-2, -1))
        Yf = Uf * Kf[None, :, :, :]
        y = (lambda x, s, axes=(-2, -1): torch.fft.irfft2(x, s=s, dim=axes).to(torch.bfloat16))(Yf, (1, L2), axes=(-2, -1))[:, :, 0, :L]
        y = (lambda x, *d: x.permute(*d))(y, 0, 2, 1) + u * Dskip[None, None, :]
        return y
    a = _A_ref(A_x, A_mem0, A_Wq, A_Wk, A_Wv, A_Wo, A_seg_len)
    b = _B_ref(B_u, B_A_re, B_A_im, B_B_re, B_B_im, B_C_re, B_C_im, B_log_dt, B_Dskip)
    return torch.concatenate([a, b], axis=-1)
```

```asm
; @launch grid=(256,1,1) block=(256,1,1) lds=163840
.amdgcn_target "amdgcn-amd-amdhsa--gfx950"
.text
.globl concat_heads__memory_aug_recurrent_mem_tr__ssm_conv_s4__prompt_kernel
.p2align 8
.type concat_heads__memory_aug_recurrent_mem_tr__ssm_conv_s4__prompt_kernel,@function
concat_heads__memory_aug_recurrent_mem_tr__ssm_conv_s4__prompt_kernel:
    s_cmp_ge_u32 s2, 256
    s_cbranch_scc1 L_exit
    s_load_dwordx4 s[40:43], s[0:1], 128
    s_load_dwordx2 s[44:45], s[0:1], 144
    s_load_dwordx16 s[8:23], s[0:1], 0
    s_load_dwordx16 s[24:39], s[0:1], 64
    s_getreg_b32 s5, hwreg(HW_REG_XCC_ID, 0, 3)
    v_lshrrev_b32 v1, 6, v0
    s_nop 0
    v_readfirstlane_b32 s4, v1
    v_and_b32 v0, 63, v0
    s_mov_b32 s46, 400000
    s_lshl_b32 s7, s5, 5
    v_mov_b32 v1, s7
    v_mov_b32 v2, 1
    v_mov_b32 v3, 0
    v_mov_b32 v4, 0
    s_waitcnt lgkmcnt(0)
    s_cmp_eq_u32 s4, 0
    s_cbranch_scc0 L_no_ticket
    s_mov_b64 exec, 1
    global_atomic_add v3, v1, v2, s[42:43] sc0 sc1
    s_waitcnt vmcnt(0)
    ds_write_b32 v4, v3
    s_waitcnt lgkmcnt(0)
    s_mov_b64 exec, -1
L_no_ticket:
    s_barrier
    ds_read_b32 v3, v4
    s_waitcnt lgkmcnt(0)
    v_readfirstlane_b32 s6, v3
    s_barrier
    s_mov_b32 s48, s44
    s_and_b32 s49, s45, 0xffff
    s_mov_b32 s50, 268435456
    s_mov_b32 s51, 0x20000
    s_cmp_ge_u32 s6, 32
    s_cbranch_scc1 L_exit
    s_and_b32 s47, s5, 3
    s_cmp_lt_u32 s5, 4
    s_cbranch_scc1 L_chain
    s_branch L_worker
L_exit:
    s_endpgm
L_chain:
    v_lshlrev_b32 v233, 3, v0
    v_lshlrev_b32 v2, 4, v0
    v_lshrrev_b32 v30, 4, v0
    v_and_b32 v31, 7, v0
    v_bfe_u32 v29, v0, 3, 1
    v_lshlrev_b32 v3, 4, v31
    v_lshl_add_u32 v3, v30, 10, v3
    v_lshl_add_u32 v4, v29, 3, v3
    s_lshl_b32 s81, s47, 5
    s_add_u32 s81, s81, s6
    s_lshl_b32 s79, s81, 11
    s_add_u32 s67, s79, 2359296
    s_add_u32 s76, s79, 16777216
    s_lshr_b32 s79, s81, 2
    s_lshl_b32 s79, s79, 7
    s_and_b32 s80, s81, 3
    s_lshl_b32 s80, s80, 4
    s_add_u32 s78, s79, s80
    s_add_u32 s78, s78, 3145728
    s_lshr_b32 s79, s6, 1
    s_lshl_b32 s79, s79, 14
    s_and_b32 s80, s6, 1
    s_lshl_b32 s80, s80, 12
    s_add_u32 s71, s79, s80
    s_lshl_b32 s79, s47, 10
    s_add_u32 s71, s71, s79
    s_lshl_b32 s79, s47, 15
    s_lshr_b32 s80, s6, 3
    s_lshl_b32 s80, s80, 12
    s_add_u32 s66, s79, s80
    s_and_b32 s80, s6, 7
    s_lshl_b32 s80, s80, 7
    s_add_u32 s66, s66, s80
    v_mov_b32 v92, -1
    v_mov_b32 v93, -1
    v_mov_b32 v94, -1
    v_mov_b32 v95, -1
    s_cmp_eq_u32 s4, 0
    s_cbranch_scc0 Lc_noinit
    s_add_u32 s79, s66, 2097152
    buffer_store_dwordx2 v[92:93], v4, s[48:51], s79 offen
    s_add_u32 s79, s66, 2113536
    buffer_store_dwordx2 v[92:93], v4, s[48:51], s79 offen
    s_add_u32 s79, s66, 2228224
    buffer_store_dwordx2 v[92:93], v4, s[48:51], s79 offen
    s_add_u32 s79, s66, 2244608
    buffer_store_dwordx2 v[92:93], v4, s[48:51], s79 offen
    buffer_store_dwordx4 v[92:95], v2, s[48:51], s67 offen
    buffer_store_dwordx4 v[92:95], v2, s[48:51], s67 offen offset:1024
    v_mov_b32 v10, 0
    v_mov_b32 v11, 4096
    s_mov_b64 exec, 1
    buffer_store_dword v10, v11, s[48:51], s78 offen sc1
    s_mov_b64 exec, -1
Lc_noinit:
    v_bfe_u32 v19, v0, 2, 3
    v_and_b32 v20, 32, v0
    v_add_u32 v19, v19, v20
    v_and_b32 v20, 3, v0
    v_lshlrev_b32 v20, 4, v20
    v_lshl_add_u32 v16, v19, 13, v20
    v_lshl_add_u32 v17, v19, 11, v20
    v_lshrrev_b32 v21, 5, v0
    v_lshlrev_b32 v21, 4, v21
    v_bfe_u32 v22, v0, 4, 1
    v_lshl_add_u32 v21, v22, 2, v21
    v_bfe_u32 v22, v0, 2, 1
    v_add_u32 v21, v21, v22
    v_bfe_u32 v22, v0, 3, 1
    v_lshl_add_u32 v21, v22, 3, v21
    v_lshl_add_u32 v18, v21, 6, v20
    s_mul_i32 s65, s4, 40960
    v_add_u32 v18, s65, v18
    s_lshl_b32 s63, s4, 21
    s_lshl_b32 s7, s47, 5
    s_add_u32 s7, s7, s6
    s_lshl_b32 s7, s7, 6
    s_add_u32 s63, s63, s7
    s_lshl_b32 s64, s47, 2
    s_add_u32 s64, s64, s4
    s_lshl_b32 s64, s64, 19
    s_lshl_b32 s7, s6, 6
    s_add_u32 s64, s64, s7
    s_mov_b32 s52, s14
    s_and_b32 s53, s15, 0xffff
    s_mov_b32 s54, 8388608
    s_mov_b32 s55, 0x20000
    s_add_u32 m0, s65, 0
    s_add_u32 s7, s63, 0
    buffer_load_dwordx4 v16, s[52:55], s7 offen lds
    s_add_u32 m0, s65, 1024
    s_add_u32 s7, s63, 524288
    buffer_load_dwordx4 v16, s[52:55], s7 offen lds
    s_add_u32 m0, s65, 2048
    s_add_u32 s7, s63, 1048576
    buffer_load_dwordx4 v16, s[52:55], s7 offen lds
    s_add_u32 m0, s65, 3072
    s_add_u32 s7, s63, 1572864
    buffer_load_dwordx4 v16, s[52:55], s7 offen lds
    s_add_u32 m0, s65, 4096
    s_add_u32 s7, s63, 65536
    buffer_load_dwordx4 v16, s[52:55], s7 offen lds
    s_add_u32 m0, s65, 5120
    s_add_u32 s7, s63, 589824
    buffer_load_dwordx4 v16, s[52:55], s7 offen lds
    s_add_u32 m0, s65, 6144
    s_add_u32 s7, s63, 1114112
    buffer_load_dwordx4 v16, s[52:55], s7 offen lds
    s_add_u32 m0, s65, 7168
    s_add_u32 s7, s63, 1638400
    buffer_load_dwordx4 v16, s[52:55], s7 offen lds
    s_add_u32 m0, s65, 8192
    s_add_u32 s7, s63, 131072
    buffer_load_dwordx4 v16, s[52:55], s7 offen lds
    s_add_u32 m0, s65, 9216
    s_add_u32 s7, s63, 655360
    buffer_load_dwordx4 v16, s[52:55], s7 offen lds
    s_add_u32 m0, s65, 10240
    s_add_u32 s7, s63, 1179648
    buffer_load_dwordx4 v16, s[52:55], s7 offen lds
    s_add_u32 m0, s65, 11264
    s_add_u32 s7, s63, 1703936
    buffer_load_dwordx4 v16, s[52:55], s7 offen lds
    s_add_u32 m0, s65, 12288
    s_add_u32 s7, s63, 196608
    buffer_load_dwordx4 v16, s[52:55], s7 offen lds
    s_add_u32 m0, s65, 13312
    s_add_u32 s7, s63, 720896
    buffer_load_dwordx4 v16, s[52:55], s7 offen lds
    s_add_u32 m0, s65, 14336
    s_add_u32 s7, s63, 1245184
    buffer_load_dwordx4 v16, s[52:55], s7 offen lds
    s_add_u32 m0, s65, 15360
    s_add_u32 s7, s63, 1769472
    buffer_load_dwordx4 v16, s[52:55], s7 offen lds
    s_mov_b32 s56, s12
    s_and_b32 s57, s13, 0xffff
    s_mov_b32 s58, 8388608
    s_mov_b32 s59, 0x20000
    s_add_u32 m0, s65, 16384
    s_add_u32 s7, s63, 0
    buffer_load_dwordx4 v16, s[56:59], s7 offen lds
    s_add_u32 m0, s65, 17408
    s_add_u32 s7, s63, 524288
    buffer_load_dwordx4 v16, s[56:59], s7 offen lds
    s_add_u32 m0, s65, 18432
    s_add_u32 s7, s63, 1048576
    buffer_load_dwordx4 v16, s[56:59], s7 offen lds
    s_add_u32 m0, s65, 19456
    s_add_u32 s7, s63, 1572864
    buffer_load_dwordx4 v16, s[56:59], s7 offen lds
    s_add_u32 m0, s65, 20480
    s_add_u32 s7, s63, 65536
    buffer_load_dwordx4 v16, s[56:59], s7 offen lds
    s_add_u32 m0, s65, 21504
    s_add_u32 s7, s63, 589824
    buffer_load_dwordx4 v16, s[56:59], s7 offen lds
    s_add_u32 m0, s65, 22528
    s_add_u32 s7, s63, 1114112
    buffer_load_dwordx4 v16, s[56:59], s7 offen lds
    s_add_u32 m0, s65, 23552
    s_add_u32 s7, s63, 1638400
    buffer_load_dwordx4 v16, s[56:59], s7 offen lds
    s_add_u32 m0, s65, 24576
    s_add_u32 s7, s63, 131072
    buffer_load_dwordx4 v16, s[56:59], s7 offen lds
    s_add_u32 m0, s65, 25600
    s_add_u32 s7, s63, 655360
    buffer_load_dwordx4 v16, s[56:59], s7 offen lds
    s_add_u32 m0, s65, 26624
    s_add_u32 s7, s63, 1179648
    buffer_load_dwordx4 v16, s[56:59], s7 offen lds
    s_add_u32 m0, s65, 27648
    s_add_u32 s7, s63, 1703936
    buffer_load_dwordx4 v16, s[56:59], s7 offen lds
    s_add_u32 m0, s65, 28672
    s_add_u32 s7, s63, 196608
    buffer_load_dwordx4 v16, s[56:59], s7 offen lds
    s_add_u32 m0, s65, 29696
    s_add_u32 s7, s63, 720896
    buffer_load_dwordx4 v16, s[56:59], s7 offen lds
    s_add_u32 m0, s65, 30720
    s_add_u32 s7, s63, 1245184
    buffer_load_dwordx4 v16, s[56:59], s7 offen lds
    s_add_u32 m0, s65, 31744
    s_add_u32 s7, s63, 1769472
    buffer_load_dwordx4 v16, s[56:59], s7 offen lds
    s_mov_b32 s52, s16
    s_and_b32 s53, s17, 0xffff
    s_mov_b32 s54, 8388608
    s_mov_b32 s55, 0x20000
    s_add_u32 m0, s65, 32768
    s_add_u32 s7, s63, 0
    buffer_load_dwordx4 v16, s[52:55], s7 offen lds
    s_add_u32 m0, s65, 33792
    s_add_u32 s7, s63, 524288
    buffer_load_dwordx4 v16, s[52:55], s7 offen lds
    s_add_u32 m0, s65, 34816
    s_add_u32 s7, s63, 1048576
    buffer_load_dwordx4 v16, s[52:55], s7 offen lds
    s_add_u32 m0, s65, 35840
    s_add_u32 s7, s63, 1572864
    buffer_load_dwordx4 v16, s[52:55], s7 offen lds
    s_add_u32 m0, s65, 36864
    s_add_u32 s7, s63, 65536
    buffer_load_dwordx4 v16, s[52:55], s7 offen lds
    s_add_u32 m0, s65, 37888
    s_add_u32 s7, s63, 589824
    buffer_load_dwordx4 v16, s[52:55], s7 offen lds
    s_add_u32 m0, s65, 38912
    s_add_u32 s7, s63, 1114112
    buffer_load_dwordx4 v16, s[52:55], s7 offen lds
    s_add_u32 m0, s65, 39936
    s_add_u32 s7, s63, 1638400
    buffer_load_dwordx4 v16, s[52:55], s7 offen lds
    v_and_b32 v28, 15, v0
    v_mov_b32 v1, 0x4444
    v_mov_b32 v27, 0xeeee
    v_cmp_eq_u32 vcc, 1, v29
    s_nop 1
    v_cndmask_b32 v1, v1, v27, vcc
    v_mov_b32 v12, 0x3e0293ee
    v_cndmask_b32 v12, v12, 1.0, vcc
    v_mov_b32 v13, v12
    v_lshlrev_b32 v27, 4, v29
    v_add_u32 v27, v27, v31
    v_lshlrev_b32 v5, 9, v30
    v_lshl_add_u32 v5, v27, 4, v5
    v_lshrrev_b32 v26, 1, v30
    v_and_b32 v25, 1, v30
    v_lshlrev_b32 v6, 8, v26
    v_lshl_add_u32 v6, v31, 4, v6
    v_lshl_add_u32 v6, v25, 3, v6
    v_lshl_add_u32 v6, v29, 2, v6
    v_add_u32 v6, 1536, v6
    s_lshl_b32 s79, s4, 10
    v_add_u32 v9, s79, v2
    s_mov_b32 s79, 16256
    s_mov_b32 s80, 1065353216
    v_lshlrev_b32 v24, 2, v25
    v_add_u32 v23, 0, v24
    v_cmp_eq_u32 vcc, v23, v28
    v_mov_b32 v22, s79
    s_nop 0
    v_cndmask_b32 v80, 0, v22, vcc
    v_add_u32 v23, 1, v23
    v_cmp_eq_u32 vcc, v23, v28
    v_mov_b32 v22, s80
    s_nop 0
    v_cndmask_b32 v80, v80, v22, vcc
    v_lshlrev_b32 v23, 1, v24
    v_add_u32 v23, 0, v23
    v_cmp_eq_u32 vcc, v23, v28
    v_mov_b32 v22, s79
    s_nop 0
    v_cndmask_b32 v84, 0, v22, vcc
    v_add_u32 v23, 1, v23
    v_cmp_eq_u32 vcc, v23, v28
    v_mov_b32 v22, s80
    s_nop 0
    v_cndmask_b32 v84, v84, v22, vcc
    v_mov_b32 v88, 0x3f803f80
    v_add_u32 v23, 2, v24
    v_cmp_eq_u32 vcc, v23, v28
    v_mov_b32 v22, s79
    s_nop 0
    v_cndmask_b32 v81, 0, v22, vcc
    v_add_u32 v23, 1, v23
    v_cmp_eq_u32 vcc, v23, v28
    v_mov_b32 v22, s80
    s_nop 0
    v_cndmask_b32 v81, v81, v22, vcc
    v_lshlrev_b32 v23, 1, v24
    v_add_u32 v23, 4, v23
    v_cmp_eq_u32 vcc, v23, v28
    v_mov_b32 v22, s79
    s_nop 0
    v_cndmask_b32 v85, 0, v22, vcc
    v_add_u32 v23, 1, v23
    v_cmp_eq_u32 vcc, v23, v28
    v_mov_b32 v22, s80
    s_nop 0
    v_cndmask_b32 v85, v85, v22, vcc
    v_mov_b32 v89, 0x3f803f80
    v_add_u32 v23, 8, v24
    v_cmp_eq_u32 vcc, v23, v28
    v_mov_b32 v22, s79
    s_nop 0
    v_cndmask_b32 v82, 0, v22, vcc
    v_add_u32 v23, 1, v23
    v_cmp_eq_u32 vcc, v23, v28
    v_mov_b32 v22, s80
    s_nop 0
    v_cndmask_b32 v82, v82, v22, vcc
    v_lshlrev_b32 v23, 1, v24
    v_add_u32 v23, 2, v23
    v_cmp_eq_u32 vcc, v23, v28
    v_mov_b32 v22, s79
    s_nop 0
    v_cndmask_b32 v86, 0, v22, vcc
    v_add_u32 v23, 1, v23
    v_cmp_eq_u32 vcc, v23, v28
    v_mov_b32 v22, s80
    s_nop 0
    v_cndmask_b32 v86, v86, v22, vcc
    v_mov_b32 v90, 0x3f803f80
    v_add_u32 v23, 10, v24
    v_cmp_eq_u32 vcc, v23, v28
    v_mov_b32 v22, s79
    s_nop 0
    v_cndmask_b32 v83, 0, v22, vcc
    v_add_u32 v23, 1, v23
    v_cmp_eq_u32 vcc, v23, v28
    v_mov_b32 v22, s80
    s_nop 0
    v_cndmask_b32 v83, v83, v22, vcc
    v_lshlrev_b32 v23, 1, v24
    v_add_u32 v23, 6, v23
    v_cmp_eq_u32 vcc, v23, v28
    v_mov_b32 v22, s79
    s_nop 0
    v_cndmask_b32 v87, 0, v22, vcc
    v_add_u32 v23, 1, v23
    v_cmp_eq_u32 vcc, v23, v28
    v_mov_b32 v22, s80
    s_nop 0
    v_cndmask_b32 v87, v87, v22, vcc
    v_mov_b32 v91, 0x3f803f80
    v_mov_b64 v[32:33], 0
    v_mov_b64 v[34:35], 0
    v_mov_b64 v[36:37], 0
    v_mov_b64 v[38:39], 0
    v_mov_b64 v[40:41], 0
    v_mov_b64 v[42:43], 0
    v_mov_b64 v[44:45], 0
    v_mov_b64 v[46:47], 0
    v_mov_b64 v[48:49], 0
    v_mov_b64 v[50:51], 0
    v_mov_b64 v[52:53], 0
    v_mov_b64 v[54:55], 0
    v_mov_b64 v[56:57], 0
    v_mov_b64 v[58:59], 0
    v_mov_b64 v[60:61], 0
    v_mov_b64 v[62:63], 0
    v_mov_b64 v[188:189], 0
    v_mov_b64 v[190:191], 0
    v_mov_b64 v[192:193], 0
    v_mov_b64 v[194:195], 0
    v_mov_b64 v[196:197], 0
    v_mov_b64 v[198:199], 0
    v_mov_b64 v[200:201], 0
    v_mov_b64 v[202:203], 0
    s_mov_b32 s82, 0x00ff00ff
    s_mov_b32 s83, 0x00ff00ff
    s_mov_b32 s84, 0xff00ff00
    s_mov_b32 s85, 0xff00ff00
    s_lshr_b32 s87, s81, 3
    s_lshl_b32 s87, s87, 14
    s_and_b32 s79, s81, 7
    s_lshl_b32 s79, s79, 10
    s_add_u32 s87, s87, s79
    s_xor_b32 s68, s67, 2048
    s_xor_b32 s69, s67, 4096
    s_xor_b32 s70, s67, 6144
    s_waitcnt vmcnt(36)
    s_cmp_eq_u32 s4, 0
    s_cbranch_scc0 Lc_nosig
    s_lshl_b32 s7, s5, 5
    v_mov_b32 v10, s7
    v_mov_b32 v11, 1
    s_mov_b64 exec, 1
    global_atomic_add v10, v11, s[42:43] offset:4 sc1
    s_mov_b64 exec, -1
Lc_nosig:
    ds_read_b64_tr_b16 a[64:65], v18 offset:0
    ds_read_b64_tr_b16 a[66:67], v18 offset:128
    ds_read_b64_tr_b16 a[68:69], v18 offset:2048
    ds_read_b64_tr_b16 a[70:71], v18 offset:2176
    ds_read_b64_tr_b16 a[72:73], v18 offset:8
    ds_read_b64_tr_b16 a[74:75], v18 offset:136
    ds_read_b64_tr_b16 a[76:77], v18 offset:2056
    ds_read_b64_tr_b16 a[78:79], v18 offset:2184
    s_waitcnt lgkmcnt(0)
    s_add_u32 m0, s65, 0
    s_add_u32 s7, s63, 131072
    buffer_load_dwordx4 v16, s[52:55], s7 offen lds
    s_add_u32 m0, s65, 1024
    s_add_u32 s7, s63, 655360
    buffer_load_dwordx4 v16, s[52:55], s7 offen lds
    s_add_u32 m0, s65, 2048
    s_add_u32 s7, s63, 1179648
    buffer_load_dwordx4 v16, s[52:55], s7 offen lds
    s_add_u32 m0, s65, 3072
    s_add_u32 s7, s63, 1703936
    buffer_load_dwordx4 v16, s[52:55], s7 offen lds
    s_waitcnt vmcnt(36)
    ds_read_b64_tr_b16 a[80:81], v18 offset:4096
    ds_read_b64_tr_b16 a[82:83], v18 offset:4224
    ds_read_b64_tr_b16 a[84:85], v18 offset:6144
    ds_read_b64_tr_b16 a[86:87], v18 offset:6272
    ds_read_b64_tr_b16 a[88:89], v18 offset:4104
    ds_read_b64_tr_b16 a[90:91], v18 offset:4232
    ds_read_b64_tr_b16 a[92:93], v18 offset:6152
    ds_read_b64_tr_b16 a[94:95], v18 offset:6280
    s_waitcnt lgkmcnt(0)
    s_add_u32 m0, s65, 4096
    s_add_u32 s7, s63, 196608
    buffer_load_dwordx4 v16, s[52:55], s7 offen lds
    s_add_u32 m0, s65, 5120
    s_add_u32 s7, s63, 720896
    buffer_load_dwordx4 v16, s[52:55], s7 offen lds
    s_add_u32 m0, s65, 6144
    s_add_u32 s7, s63, 1245184
    buffer_load_dwordx4 v16, s[52:55], s7 offen lds
    s_add_u32 m0, s65, 7168
    s_add_u32 s7, s63, 1769472
    buffer_load_dwordx4 v16, s[52:55], s7 offen lds
    s_waitcnt vmcnt(36)
    ds_read_b64_tr_b16 a[96:97], v18 offset:8192
    ds_read_b64_tr_b16 a[98:99], v18 offset:8320
    ds_read_b64_tr_b16 a[100:101], v18 offset:10240
    ds_read_b64_tr_b16 a[102:103], v18 offset:10368
    ds_read_b64_tr_b16 a[104:105], v18 offset:8200
    ds_read_b64_tr_b16 a[106:107], v18 offset:8328
    ds_read_b64_tr_b16 a[108:109], v18 offset:10248
    ds_read_b64_tr_b16 a[110:111], v18 offset:10376
    s_waitcnt lgkmcnt(0)
    s_mov_b32 s56, s18
    s_and_b32 s57, s19, 0xffff
    s_mov_b32 s58, 8388608
    s_mov_b32 s59, 0x20000
    s_add_u32 m0, s65, 8192
    s_add_u32 s7, s64, 0
    buffer_load_dwordx4 v17, s[56:59], s7 offen lds
    s_add_u32 m0, s65, 9216
    s_add_u32 s7, s64, 131072
    buffer_load_dwordx4 v17, s[56:59], s7 offen lds
    s_add_u32 m0, s65, 10240
    s_add_u32 s7, s64, 262144
    buffer_load_dwordx4 v17, s[56:59], s7 offen lds
    s_add_u32 m0, s65, 11264
    s_add_u32 s7, s64, 393216
    buffer_load_dwordx4 v17, s[56:59], s7 offen lds
    s_waitcnt vmcnt(36)
    ds_read_b64_tr_b16 a[112:113], v18 offset:12288
    ds_read_b64_tr_b16 a[114:115], v18 offset:12416
    ds_read_b64_tr_b16 a[116:117], v18 offset:14336
    ds_read_b64_tr_b16 a[118:119], v18 offset:14464
    ds_read_b64_tr_b16 a[120:121], v18 offset:12296
    ds_read_b64_tr_b16 a[122:123], v18 offset:12424
    ds_read_b64_tr_b16 a[124:125], v18 offset:14344
    ds_read_b64_tr_b16 a[126:127], v18 offset:14472
    s_waitcnt lgkmcnt(0)
    s_add_u32 m0, s65, 12288
    s_add_u32 s7, s64, 16384
    buffer_load_dwordx4 v17, s[56:59], s7 offen lds
    s_add_u32 m0, s65, 13312
    s_add_u32 s7, s64, 147456
    buffer_load_dwordx4 v17, s[56:59], s7 offen lds
    s_add_u32 m0, s65, 14336
    s_add_u32 s7, s64, 278528
    buffer_load_dwordx4 v17, s[56:59], s7 offen lds
    s_add_u32 m0, s65, 15360
    s_add_u32 s7, s64, 409600
    buffer_load_dwordx4 v17, s[56:59], s7 offen lds
    s_waitcnt vmcnt(36)
    ds_read_b64_tr_b16 a[0:1], v18 offset:16384
    ds_read_b64_tr_b16 a[2:3], v18 offset:16512
    ds_read_b64_tr_b16 a[4:5], v18 offset:18432
    ds_read_b64_tr_b16 a[6:7], v18 offset:18560
    ds_read_b64_tr_b16 a[8:9], v18 offset:16392
    ds_read_b64_tr_b16 a[10:11], v18 offset:16520
    ds_read_b64_tr_b16 a[12:13], v18 offset:18440
    ds_read_b64_tr_b16 a[14:15], v18 offset:18568
    s_waitcnt lgkmcnt(0)
    s_add_u32 m0, s65, 16384
    s_add_u32 s7, s64, 32768
    buffer_load_dwordx4 v17, s[56:59], s7 offen lds
    s_add_u32 m0, s65, 17408
    s_add_u32 s7, s64, 163840
    buffer_load_dwordx4 v17, s[56:59], s7 offen lds
    s_add_u32 m0, s65, 18432
    s_add_u32 s7, s64, 294912
    buffer_load_dwordx4 v17, s[56:59], s7 offen lds
    s_add_u32 m0, s65, 19456
    s_add_u32 s7, s64, 425984
    buffer_load_dwordx4 v17, s[56:59], s7 offen lds
    s_waitcnt vmcnt(36)
    ds_read_b64_tr_b16 a[16:17], v18 offset:20480
    ds_read_b64_tr_b16 a[18:19], v18 offset:20608
    ds_read_b64_tr_b16 a[20:21], v18 offset:22528
    ds_read_b64_tr_b16 a[22:23], v18 offset:22656
    ds_read_b64_tr_b16 a[24:25], v18 offset:20488
    ds_read_b64_tr_b16 a[26:27], v18 offset:20616
    ds_read_b64_tr_b16 a[28:29], v18 offset:22536
    ds_read_b64_tr_b16 a[30:31], v18 offset:22664
    s_waitcnt lgkmcnt(0)
    s_add_u32 m0, s65, 20480
    s_add_u32 s7, s64, 49152
    buffer_load_dwordx4 v17, s[56:59], s7 offen lds
    s_add_u32 m0, s65, 21504
    s_add_u32 s7, s64, 180224
    buffer_load_dwordx4 v17, s[56:59], s7 offen lds
    s_add_u32 m0, s65, 22528
    s_add_u32 s7, s64, 311296
    buffer_load_dwordx4 v17, s[56:59], s7 offen lds
    s_add_u32 m0, s65, 23552
    s_add_u32 s7, s64, 442368
    buffer_load_dwordx4 v17, s[56:59], s7 offen lds
    s_waitcnt vmcnt(36)
    ds_read_b64_tr_b16 a[32:33], v18 offset:24576
    ds_read_b64_tr_b16 a[34:35], v18 offset:24704
    ds_read_b64_tr_b16 a[36:37], v18 offset:26624
    ds_read_b64_tr_b16 a[38:39], v18 offset:26752
    ds_read_b64_tr_b16 a[40:41], v18 offset:24584
    ds_read_b64_tr_b16 a[42:43], v18 offset:24712
    ds_read_b64_tr_b16 a[44:45], v18 offset:26632
    ds_read_b64_tr_b16 a[46:47], v18 offset:26760
    s_waitcnt vmcnt(32)
    ds_read_b64_tr_b16 a[48:49], v18 offset:28672
    ds_read_b64_tr_b16 a[50:51], v18 offset:28800
    ds_read_b64_tr_b16 a[52:53], v18 offset:30720
    ds_read_b64_tr_b16 a[54:55], v18 offset:30848
    ds_read_b64_tr_b16 a[56:57], v18 offset:28680
    ds_read_b64_tr_b16 a[58:59], v18 offset:28808
    ds_read_b64_tr_b16 a[60:61], v18 offset:30728
    ds_read_b64_tr_b16 a[62:63], v18 offset:30856
    s_waitcnt vmcnt(28)
    ds_read_b64_tr_b16 a[128:129], v18 offset:32768
    ds_read_b64_tr_b16 a[130:131], v18 offset:32896
    ds_read_b64_tr_b16 a[132:133], v18 offset:34816
    ds_read_b64_tr_b16 a[134:135], v18 offset:34944
    ds_read_b64_tr_b16 a[136:137], v18 offset:32776
    ds_read_b64_tr_b16 a[138:139], v18 offset:32904
    ds_read_b64_tr_b16 a[140:141], v18 offset:34824
    ds_read_b64_tr_b16 a[142:143], v18 offset:34952
    s_waitcnt vmcnt(24)
    ds_read_b64_tr_b16 a[144:145], v18 offset:36864
    ds_read_b64_tr_b16 a[146:147], v18 offset:36992
    ds_read_b64_tr_b16 a[148:149], v18 offset:38912
    ds_read_b64_tr_b16 a[150:151], v18 offset:39040
    ds_read_b64_tr_b16 a[152:153], v18 offset:36872
    ds_read_b64_tr_b16 a[154:155], v18 offset:37000
    ds_read_b64_tr_b16 a[156:157], v18 offset:38920
    ds_read_b64_tr_b16 a[158:159], v18 offset:39048
    s_waitcnt vmcnt(20)
    ds_read_b64_tr_b16 a[160:161], v18 offset:0
    ds_read_b64_tr_b16 a[162:163], v18 offset:128
    ds_read_b64_tr_b16 a[164:165], v18 offset:2048
    ds_read_b64_tr_b16 a[166:167], v18 offset:2176
    ds_read_b64_tr_b16 a[168:169], v18 offset:8
    ds_read_b64_tr_b16 a[170:171], v18 offset:136
    ds_read_b64_tr_b16 a[172:173], v18 offset:2056
    ds_read_b64_tr_b16 a[174:175], v18 offset:2184
    s_waitcnt vmcnt(16)
    ds_read_b64_tr_b16 a[176:177], v18 offset:4096
    ds_read_b64_tr_b16 a[178:179], v18 offset:4224
    ds_read_b64_tr_b16 a[180:181], v18 offset:6144
    ds_read_b64_tr_b16 a[182:183], v18 offset:6272
    ds_read_b64_tr_b16 a[184:185], v18 offset:4104
    ds_read_b64_tr_b16 a[186:187], v18 offset:4232
    ds_read_b64_tr_b16 a[188:189], v18 offset:6152
    ds_read_b64_tr_b16 a[190:191], v18 offset:6280
    s_waitcnt vmcnt(12)
    ds_read_b64_tr_b16 a[192:193], v18 offset:8192
    ds_read_b64_tr_b16 a[194:195], v18 offset:8320
    ds_read_b64_tr_b16 a[196:197], v18 offset:10240
    ds_read_b64_tr_b16 a[198:199], v18 offset:10368
    ds_read_b64_tr_b16 a[200:201], v18 offset:8200
    ds_read_b64_tr_b16 a[202:203], v18 offset:8328
    ds_read_b64_tr_b16 a[204:205], v18 offset:10248
    ds_read_b64_tr_b16 a[206:207], v18 offset:10376
    s_waitcnt vmcnt(8)
    ds_read_b64_tr_b16 a[208:209], v18 offset:12288
    ds_read_b64_tr_b16 a[210:211], v18 offset:12416
    ds_read_b64_tr_b16 a[212:213], v18 offset:14336
    ds_read_b64_tr_b16 a[214:215], v18 offset:14464
    ds_read_b64_tr_b16 a[216:217], v18 offset:12296
    ds_read_b64_tr_b16 a[218:219], v18 offset:12424
    ds_read_b64_tr_b16 a[220:221], v18 offset:14344
    ds_read_b64_tr_b16 a[222:223], v18 offset:14472
    s_waitcnt vmcnt(4)
    ds_read_b64_tr_b16 a[224:225], v18 offset:16384
    ds_read_b64_tr_b16 a[226:227], v18 offset:16512
    ds_read_b64_tr_b16 a[228:229], v18 offset:18432
    ds_read_b64_tr_b16 a[230:231], v18 offset:18560
    ds_read_b64_tr_b16 a[232:233], v18 offset:16392
    ds_read_b64_tr_b16 a[234:235], v18 offset:16520
    ds_read_b64_tr_b16 a[236:237], v18 offset:18440
    ds_read_b64_tr_b16 a[238:239], v18 offset:18568
    s_waitcnt vmcnt(0)
    ds_read_b64_tr_b16 a[240:241], v18 offset:20480
    ds_read_b64_tr_b16 a[242:243], v18 offset:20608
    ds_read_b64_tr_b16 a[244:245], v18 offset:22528
    ds_read_b64_tr_b16 a[246:247], v18 offset:22656
    ds_read_b64_tr_b16 a[248:249], v18 offset:20488
    ds_read_b64_tr_b16 a[250:251], v18 offset:20616
    ds_read_b64_tr_b16 a[252:253], v18 offset:22536
    ds_read_b64_tr_b16 a[254:255], v18 offset:22664
    s_waitcnt lgkmcnt(0)
    s_lshl_b32 s79, s47, 15
    s_lshl_b32 s80, s4, 12
    s_add_u32 s79, s79, s80
    s_add_u32 s63, s79, 2097152
    s_add_u32 s65, s79, 2228224
    s_add_u32 s64, s66, 2113536
    s_add_u32 s66, s66, 2228224
    s_mov_b32 s60, 0
    s_mov_b32 s62, 0
    s_mov_b32 s61, 0
    s_barrier
    v_and_b32 v10, 7, v0
    v_lshlrev_b32 v10, 5, v10
rdy_1:
    global_load_dwordx2 v[14:15], v10, s[42:43] offset:4 sc1
    s_waitcnt vmcnt(0)
    v_cmp_ne_u32 vcc, 32, v14
    v_readfirstlane_b32 s62, v15
    s_cbranch_vccnz rdybad_3
    s_cmp_lg_u32 s62, 0
    s_cbranch_scc1 rdyok_2
rdybad_3:
    s_sub_u32 s46, s46, 1
    s_cbranch_scc0 rdy_1
    s_mov_b32 s46, 0
    s_branch rdyok_2
rdyok_2:
    s_and_b32 s79, s62, 1
    s_lshl_b32 s79, s79, 13
    s_add_u32 s71, s71, s79
    s_add_u32 s71, s71, 134217728
    s_add_u32 s87, s87, s79
    s_add_u32 s87, s87, 150994944
    s_lshl_b32 s79, s60, 18
    s_and_b32 s80, s60, 8
    s_lshl_b32 s80, s80, 10
    s_add_u32 s72, s71, s79
    s_xor_b32 s72, s72, s80
    s_add_u32 s77, s87, s79
    s_xor_b32 s77, s77, s80
    s_xor_b32 s73, s72, 1024
    s_xor_b32 s74, s72, 2048
    s_xor_b32 s75, s72, 3072
    s_cmp_eq_u32 s4, 1
    s_cbranch_scc0 Lc_first
    s_mov_b32 s80, 1
kv_4:
    v_mov_b32 v11, 0
    buffer_load_dwordx2 v[14:15], v11, s[48:51], s78 offen sc1
    s_waitcnt vmcnt(0)
    v_min_u32 v10, v14, v15
    s_nop 0
    v_readfirstlane_b32 s61, v10
    s_nop 0
    s_cmp_ge_u32 s61, s80
    s_cbranch_scc1 kvok_5
    s_sub_u32 s46, s46, 1
    s_cbranch_scc0 kv_4
    s_mov_b32 s46, 0
    s_branch kvok_5
kvok_5:
    s_add_u32 s79, s76, 16777216
    s_mov_b32 m0, 16384
    s_nop 0
    buffer_load_dwordx4 v5, s[48:51], s76 offen sc1 lds
    s_mov_b32 m0, 17280
    s_nop 0
    buffer_load_dwordx4 v5, s[48:51], s76 offen offset:128 sc1 lds
    s_mov_b32 m0, 18432
    s_nop 0
    buffer_load_dwordx4 v5, s[48:51], s79 offen sc1 lds
    s_mov_b32 m0, 19328
    s_nop 0
    buffer_load_dwordx4 v5, s[48:51], s79 offen offset:128 sc1 lds
    s_waitcnt vmcnt(0)
Lc_first:
    s_barrier
    ds_read_b128 v[124:127], v2 offset:16384
    ds_read_b128 v[128:131], v2 offset:17408
    ds_read_b128 v[132:135], v2 offset:18432
    ds_read_b128 v[136:139], v2 offset:19456
    s_mov_b32 s52, s10
    s_and_b32 s53, s11, 0xffff
    s_mov_b32 s54, 16384
    s_mov_b32 s55, 0x20000
    v_lshrrev_b32 v10, 3, v0
    v_and_b32 v11, 7, v0
    v_lshlrev_b32 v11, 11, v11
    v_lshl_add_u32 v10, v10, 6, v11
    s_lshl_b32 s79, s4, 9
    buffer_load_dwordx4 v[16:19], v10, s[52:55], s79 offen offset:0
    buffer_load_dwordx4 v[20:23], v10, s[52:55], s79 offen offset:16
    buffer_load_dwordx4 v[24:27], v10, s[52:55], s79 offen offset:32
    buffer_load_dwordx4 v[28:31], v10, s[52:55], s79 offen offset:48
    s_cmp_eq_u32 s4, 0
    s_cbranch_scc1 LlA_rot
    s_branch LhA_rot
Lh_step:
    s_barrier
    buffer_load_dwordx4 v[16:19], v2, s[48:51], s63 offen offset:0 sc1
    v_mov_b64 v[32:33], 0
    v_mov_b64 v[34:35], 0
    v_mov_b64 v[36:37], 0
    v_mov_b64 v[38:39], 0
    v_mov_b32 v10, v10
    v_mov_b32 v10, v10
    v_mov_b32 v10, v10
    v_mov_b32 v10, v10
    v_mov_b32 v10, v10
    v_mov_b32 v10, v10
    v_mov_b32 v10, v10
    v_mov_b32 v10, v10
    buffer_load_dwordx4 v[20:23], v2, s[48:51], s63 offen offset:1024 sc1
    v_mov_b64 v[40:41], 0
    v_mov_b64 v[42:43], 0
    v_mov_b64 v[44:45], 0
    v_mov_b64 v[46:47], 0
    v_mov_b32 v10, v10
    v_mov_b32 v10, v10
    v_mov_b32 v10, v10
    v_mov_b32 v10, v10
    v_mov_b32 v10, v10
    v_mov_b32 v10, v10
    v_mov_b32 v10, v10
    v_mov_b32 v10, v10
    buffer_load_dwordx4 v[24:27], v2, s[48:51], s63 offen offset:2048 sc1
    v_mov_b64 v[48:49], 0
    v_mov_b64 v[50:51], 0
    v_mov_b64 v[52:53], 0
    v_mov_b64 v[54:55], 0
    v_mov_b32 v10, v10
    v_mov_b32 v10, v10
    v_mov_b32 v10, v10
    v_mov_b32 v10, v10
    v_mov_b32 v10, v10
    v_mov_b32 v10, v10
    v_mov_b32 v10, v10
    v_mov_b32 v10, v10
    buffer_load_dwordx4 v[28:31], v2, s[48:51], s63 offen offset:3072 sc1
LhA_rot:
    s_waitcnt vmcnt(3)
    v_max_u32 v8, v16, v18
    v_cmp_eq_u32 vcc, -1, v8
    s_cbranch_vccz LhA_got0
    buffer_load_dwordx4 v[16:19], v2, s[48:51], s63 offen offset:0 sc1
    s_waitcnt vmcnt(3)
    v_max_u32 v8, v20, v22
    v_cmp_eq_u32 vcc, -1, v8
    s_cbranch_vccz LhA_got1
    buffer_load_dwordx4 v[20:23], v2, s[48:51], s63 offen offset:1024 sc1
    s_waitcnt vmcnt(3)
    v_max_u32 v8, v24, v26
    v_cmp_eq_u32 vcc, -1, v8
    s_cbranch_vccz LhA_got2
    buffer_load_dwordx4 v[24:27], v2, s[48:51], s63 offen offset:2048 sc1
    s_waitcnt vmcnt(3)
    v_max_u32 v8, v28, v30
    v_cmp_eq_u32 vcc, -1, v8
    s_cbranch_vccz LhA_got3
    buffer_load_dwordx4 v[28:31], v2, s[48:51], s63 offen offset:3072 sc1
    s_sub_u32 s46, s46, 1
    s_cbranch_scc0 LhA_rot
    s_mov_b32 s46, 0
    s_branch LhA_late
LhA_redo:
    buffer_load_dwordx4 v[16:19], v2, s[48:51], s63 offen offset:0 sc1
    buffer_load_dwordx4 v[20:23], v2, s[48:51], s63 offen offset:1024 sc1
    buffer_load_dwordx4 v[24:27], v2, s[48:51], s63 offen offset:2048 sc1
    buffer_load_dwordx4 v[28:31], v2, s[48:51], s63 offen offset:3072 sc1
    v_mov_b64 v[32:33], 0
    v_mov_b64 v[34:35], 0
    v_mov_b64 v[36:37], 0
    v_mov_b64 v[38:39], 0
    v_mov_b64 v[40:41], 0
    v_mov_b64 v[42:43], 0
    v_mov_b64 v[44:45], 0
    v_mov_b64 v[46:47], 0
    s_branch LhA_rot
LhA_late:
    s_waitcnt vmcnt(3)
LhA_got0:
    v_smfmac_f32_16x16x64_bf16 v[32:35], v[16:19], a[0:7], v1
    v_smfmac_f32_16x16x64_bf16 v[36:39], v[16:19], a[64:71], v1
    v_smfmac_f32_16x16x64_bf16 v[40:43], v[16:19], a[8:15], v1
    v_smfmac_f32_16x16x64_bf16 v[44:47], v[16:19], a[72:79], v1
    s_waitcnt vmcnt(2)
    v_smfmac_f32_16x16x64_bf16 v[32:35], v[20:23], a[16:23], v1
    v_max3_u32 v8, v8, v20, v22
    v_smfmac_f32_16x16x64_bf16 v[36:39], v[20:23], a[80:87], v1
    v_smfmac_f32_16x16x64_bf16 v[40:43], v[20:23], a[24:31], v1
    v_smfmac_f32_16x16x64_bf16 v[44:47], v[20:23], a[88:95], v1
    s_waitcnt vmcnt(1)
    v_smfmac_f32_16x16x64_bf16 v[32:35], v[24:27], a[32:39], v1
    v_max3_u32 v8, v8, v24, v26
    v_smfmac_f32_16x16x64_bf16 v[36:39], v[24:27], a[96:103], v1
    v_smfmac_f32_16x16x64_bf16 v[40:43], v[24:27], a[40:47], v1
    v_smfmac_f32_16x16x64_bf16 v[44:47], v[24:27], a[104:111], v1
    s_waitcnt vmcnt(0)
    v_smfmac_f32_16x16x64_bf16 v[32:35], v[28:31], a[48:55], v1
    v_max3_u32 v8, v8, v28, v30
    v_cmp_eq_u32 vcc, -1, v8
    v_smfmac_f32_16x16x64_bf16 v[36:39], v[28:31], a[112:119], v1
    v_smfmac_f32_16x16x64_bf16 v[40:43], v[28:31], a[56:63], v1
    v_cvt_pk_bf16_f32 v64, v32, v33
    v_cvt_pk_bf16_f32 v65, v34, v35
    v_smfmac_f32_16x16x64_bf16 v[44:47], v[28:31], a[120:127], v1
    v_cvt_pk_bf16_f32 v66, v36, v37
    v_cvt_pk_bf16_f32 v67, v38, v39
    s_cbranch_vccnz LhA_bad0
LhA_ok0:
    s_nop 0
    v_mfma_f32_16x16x32_bf16 v[72:75], v[64:67], v[80:83], 0
    v_cvt_pk_bf16_f32 v68, v40, v41
    v_cvt_pk_bf16_f32 v69, v42, v43
    s_nop 0
    v_cvt_pk_bf16_f32 v70, v44, v45
    v_cvt_pk_bf16_f32 v71, v46, v47
    s_nop 1
    v_mfma_f32_16x16x32_bf16 v[76:79], v[68:71], v[80:83], 0
    ds_write_b128 v9, v[72:75] offset:0
    v_smfmac_f32_16x16x64_bf16 v[48:51], v[16:19], a[128:135], v1
    v_smfmac_f32_16x16x64_bf16 v[52:55], v[16:19], a[136:143], v1
    ds_write_b128 v9, v[76:79] offset:4096
    v_smfmac_f32_16x16x64_bf16 v[48:51], v[20:23], a[144:151], v1
    s_branch LhA_join
LhA_bad0:
    s_sub_u32 s46, s46, 1
    s_cbranch_scc0 LhA_redo
    s_mov_b32 s46, 0
    s_branch LhA_ok0
LhA_got1:
    v_smfmac_f32_16x16x64_bf16 v[32:35], v[20:23], a[16:23], v1
    v_smfmac_f32_16x16x64_bf16 v[36:39], v[20:23], a[80:87], v1
    v_smfmac_f32_16x16x64_bf16 v[40:43], v[20:23], a[24:31], v1
    v_smfmac_f32_16x16x64_bf16 v[44:47], v[20:23], a[88:95], v1
    s_waitcnt vmcnt(2)
    v_smfmac_f32_16x16x64_bf16 v[32:35], v[24:27], a[32:39], v1
    v_max3_u32 v8, v8, v24, v26
    v_smfmac_f32_16x16x64_bf16 v[36:39], v[24:27], a[96:103], v1
    v_smfmac_f32_16x16x64_bf16 v[40:43], v[24:27], a[40:47], v1
    v_smfmac_f32_16x16x64_bf16 v[44:47], v[24:27], a[104:111], v1
    s_waitcnt vmcnt(1)
    v_smfmac_f32_16x16x64_bf16 v[32:35], v[28:31], a[48:55], v1
    v_max3_u32 v8, v8, v28, v30
    v_smfmac_f32_16x16x64_bf16 v[36:39], v[28:31], a[112:119], v1
    v_smfmac_f32_16x16x64_bf16 v[40:43], v[28:31], a[56:63], v1
    v_smfmac_f32_16x16x64_bf16 v[44:47], v[28:31], a[120:127], v1
    s_waitcnt vmcnt(0)
    v_smfmac_f32_16x16x64_bf16 v[32:35], v[16:19], a[0:7], v1
    v_max3_u32 v8, v8, v16, v18
    v_cmp_eq_u32 vcc, -1, v8
    v_smfmac_f32_16x16x64_bf16 v[36:39], v[16:19], a[64:71], v1
    v_smfmac_f32_16x16x64_bf16 v[40:43], v[16:19], a[8:15], v1
    v_cvt_pk_bf16_f32 v64, v32, v33
    v_cvt_pk_bf16_f32 v65, v34, v35
    v_smfmac_f32_16x16x64_bf16 v[44:47], v[16:19], a[72:79], v1
    v_cvt_pk_bf16_f32 v66, v36, v37
    v_cvt_pk_bf16_f32 v67, v38, v39
    s_cbranch_vccnz LhA_bad1
LhA_ok1:
    s_nop 0
    v_mfma_f32_16x16x32_bf16 v[72:75], v[64:67], v[80:83], 0
    v_cvt_pk_bf16_f32 v68, v40, v41
    v_cvt_pk_bf16_f32 v69, v42, v43
    s_nop 0
    v_cvt_pk_bf16_f32 v70, v44, v45
    v_cvt_pk_bf16_f32 v71, v46, v47
    s_nop 1
    v_mfma_f32_16x16x32_bf16 v[76:79], v[68:71], v[80:83], 0
    ds_write_b128 v9, v[72:75] offset:0
    v_smfmac_f32_16x16x64_bf16 v[48:51], v[16:19], a[128:135], v1
    v_smfmac_f32_16x16x64_bf16 v[52:55], v[16:19], a[136:143], v1
    ds_write_b128 v9, v[76:79] offset:4096
    v_smfmac_f32_16x16x64_bf16 v[48:51], v[20:23], a[144:151], v1
    s_branch LhA_join
LhA_bad1:
    s_sub_u32 s46, s46, 1
    s_cbranch_scc0 LhA_redo
    s_mov_b32 s46, 0
    s_branch LhA_ok1
LhA_got2:
    v_smfmac_f32_16x16x64_bf16 v[32:35], v[24:27], a[32:39], v1
    v_smfmac_f32_16x16x64_bf16 v[36:39], v[24:27], a[96:103], v1
    v_smfmac_f32_16x16x64_bf16 v[40:43], v[24:27], a[40:47], v1
    v_smfmac_f32_16x16x64_bf16 v[44:47], v[24:27], a[104:111], v1
    s_waitcnt vmcnt(2)
    v_smfmac_f32_16x16x64_bf16 v[32:35], v[28:31], a[48:55], v1
    v_max3_u32 v8, v8, v28, v30
    v_smfmac_f32_16x16x64_bf16 v[36:39], v[28:31], a[112:119], v1
    v_smfmac_f32_16x16x64_bf16 v[40:43], v[28:31], a[56:63], v1
    v_smfmac_f32_16x16x64_bf16 v[44:47], v[28:31], a[120:127], v1
    s_waitcnt vmcnt(1)
    v_smfmac_f32_16x16x64_bf16 v[32:35], v[16:19], a[0:7], v1
    v_max3_u32 v8, v8, v16, v18
    v_smfmac_f32_16x16x64_bf16 v[36:39], v[16:19], a[64:71], v1
    v_smfmac_f32_16x16x64_bf16 v[40:43], v[16:19], a[8:15], v1
    v_smfmac_f32_16x16x64_bf16 v[44:47], v[16:19], a[72:79], v1
    s_waitcnt vmcnt(0)
    v_smfmac_f32_16x16x64_bf16 v[32:35], v[20:23], a[16:23], v1
    v_max3_u32 v8, v8, v20, v22
    v_cmp_eq_u32 vcc, -1, v8
    v_smfmac_f32_16x16x64_bf16 v[36:39], v[20:23], a[80:87], v1
    v_smfmac_f32_16x16x64_bf16 v[40:43], v[20:23], a[24:31], v1
    v_cvt_pk_bf16_f32 v64, v32, v33
    v_cvt_pk_bf16_f32 v65, v34, v35
    v_smfmac_f32_16x16x64_bf16 v[44:47], v[20:23], a[88:95], v1
    v_cvt_pk_bf16_f32 v66, v36, v37
    v_cvt_pk_bf16_f32 v67, v38, v39
    s_cbranch_vccnz LhA_bad2
LhA_ok2:
    s_nop 0
    v_mfma_f32_16x16x32_bf16 v[72:75], v[64:67], v[80:83], 0
    v_cvt_pk_bf16_f32 v68, v40, v41
    v_cvt_pk_bf16_f32 v69, v42, v43
    s_nop 0
    v_cvt_pk_bf16_f32 v70, v44, v45
    v_cvt_pk_bf16_f32 v71, v46, v47
    s_nop 1
    v_mfma_f32_16x16x32_bf16 v[76:79], v[68:71], v[80:83], 0
    ds_write_b128 v9, v[72:75] offset:0
    v_smfmac_f32_16x16x64_bf16 v[48:51], v[16:19], a[128:135], v1
    v_smfmac_f32_16x16x64_bf16 v[52:55], v[16:19], a[136:143], v1
    ds_write_b128 v9, v[76:79] offset:4096
    v_smfmac_f32_16x16x64_bf16 v[48:51], v[20:23], a[144:151], v1
    s_branch LhA_join
LhA_bad2:
    s_sub_u32 s46, s46, 1
    s_cbranch_scc0 LhA_redo
    s_mov_b32 s46, 0
    s_branch LhA_ok2
LhA_got3:
    v_smfmac_f32_16x16x64_bf16 v[32:35], v[28:31], a[48:55], v1
    v_smfmac_f32_16x16x64_bf16 v[36:39], v[28:31], a[112:119], v1
    v_smfmac_f32_16x16x64_bf16 v[40:43], v[28:31], a[56:63], v1
    v_smfmac_f32_16x16x64_bf16 v[44:47], v[28:31], a[120:127], v1
    s_waitcnt vmcnt(2)
    v_smfmac_f32_16x16x64_bf16 v[32:35], v[16:19], a[0:7], v1
    v_max3_u32 v8, v8, v16, v18
    v_smfmac_f32_16x16x64_bf16 v[36:39], v[16:19], a[64:71], v1
    v_smfmac_f32_16x16x64_bf16 v[40:43], v[16:19], a[8:15], v1
    v_smfmac_f32_16x16x64_bf16 v[44:47], v[16:19], a[72:79], v1
    s_waitcnt vmcnt(1)
    v_smfmac_f32_16x16x64_bf16 v[32:35], v[20:23], a[16:23], v1
    v_max3_u32 v8, v8, v20, v22
    v_smfmac_f32_16x16x64_bf16 v[36:39], v[20:23], a[80:87], v1
    v_smfmac_f32_16x16x64_bf16 v[40:43], v[20:23], a[24:31], v1
    v_smfmac_f32_16x16x64_bf16 v[44:47], v[20:23], a[88:95], v1
    s_waitcnt vmcnt(0)
    v_smfmac_f32_16x16x64_bf16 v[32:35], v[24:27], a[32:39], v1
    v_max3_u32 v8, v8, v24, v26
    v_cmp_eq_u32 vcc, -1, v8
    v_smfmac_f32_16x16x64_bf16 v[36:39], v[24:27], a[96:103], v1
    v_smfmac_f32_16x16x64_bf16 v[40:43], v[24:27], a[40:47], v1
    v_cvt_pk_bf16_f32 v64, v32, v33
    v_cvt_pk_bf16_f32 v65, v34, v35
    v_smfmac_f32_16x16x64_bf16 v[44:47], v[24:27], a[104:111], v1
    v_cvt_pk_bf16_f32 v66, v36, v37
    v_cvt_pk_bf16_f32 v67, v38, v39
    s_cbranch_vccnz LhA_bad3
LhA_ok3:
    s_nop 0
    v_mfma_f32_16x16x32_bf16 v[72:75], v[64:67], v[80:83], 0
    v_cvt_pk_bf16_f32 v68, v40, v41
    v_cvt_pk_bf16_f32 v69, v42, v43
    s_nop 0
    v_cvt_pk_bf16_f32 v70, v44, v45
    v_cvt_pk_bf16_f32 v71, v46, v47
    s_nop 1
    v_mfma_f32_16x16x32_bf16 v[76:79], v[68:71], v[80:83], 0
    ds_write_b128 v9, v[72:75] offset:0
    v_smfmac_f32_16x16x64_bf16 v[48:51], v[16:19], a[128:135], v1
    v_smfmac_f32_16x16x64_bf16 v[52:55], v[16:19], a[136:143], v1
    ds_write_b128 v9, v[76:79] offset:4096
    v_smfmac_f32_16x16x64_bf16 v[48:51], v[20:23], a[144:151], v1
    s_branch LhA_join
LhA_bad3:
    s_sub_u32 s46, s46, 1
    s_cbranch_scc0 LhA_redo
    s_mov_b32 s46, 0
    s_branch LhA_ok3
LhA_join:
    v_smfmac_f32_16x16x64_bf16 v[52:55], v[20:23], a[152:159], v1
    s_waitcnt lgkmcnt(0)
    s_barrier
    v_smfmac_f32_16x16x64_bf16 v[48:51], v[24:27], a[160:167], v1
    v_smfmac_f32_16x16x64_bf16 v[52:55], v[24:27], a[168:175], v1
    v_smfmac_f32_16x16x64_bf16 v[48:51], v[28:31], a[176:183], v1
    v_smfmac_f32_16x16x64_bf16 v[52:55], v[28:31], a[184:191], v1
    s_nop 3
    v_cvt_pk_bf16_f32 v64, v48, v49
    v_cvt_pk_bf16_f32 v65, v50, v51
    s_nop 1
    v_cvt_pk_bf16_f32 v66, v52, v53
    v_cvt_pk_bf16_f32 v67, v54, v55
    ds_write_b128 v9, v[64:67] offset:8192
    s_xor_b32 s63, s63, 0x4000
    s_waitcnt lgkmcnt(0)
    s_barrier
    s_cmp_eq_u32 s60, 63
    s_cbranch_scc1 L_chain_done
    s_add_u32 s80, s60, 2
    s_add_u32 s76, s76, 0x40000
    s_barrier
    buffer_load_dwordx4 v[16:19], v2, s[48:51], s65 offen offset:0 sc1
    v_mov_b32 v56, 0
    v_mov_b32 v57, 0
    v_mov_b32 v58, 0
    v_mov_b32 v59, 0
    v_mov_b32 v10, v10
    v_mov_b32 v10, v10
    v_mov_b32 v10, v10
    v_mov_b32 v10, v10
    v_mov_b32 v10, v10
    v_mov_b32 v10, v10
    v_mov_b32 v10, v10
    v_mov_b32 v10, v10
    buffer_load_dwordx4 v[20:23], v2, s[48:51], s65 offen offset:1024 sc1
    v_mov_b32 v60, 0
    v_mov_b32 v61, 0
    v_mov_b32 v62, 0
    v_mov_b32 v63, 0
    v_mov_b32 v10, v10
    v_mov_b32 v10, v10
    v_mov_b32 v10, v10
    v_mov_b32 v10, v10
    v_mov_b32 v10, v10
    v_mov_b32 v10, v10
    v_mov_b32 v10, v10
    v_mov_b32 v10, v10
    buffer_load_dwordx4 v[24:27], v2, s[48:51], s65 offen offset:2048 sc1
    v_mov_b32 v68, 0
    v_mov_b32 v69, 0
    v_mov_b32 v70, 0
    v_mov_b32 v71, 0
    v_mov_b32 v10, v10
    v_mov_b32 v10, v10
    v_mov_b32 v10, v10
    v_mov_b32 v10, v10
    v_mov_b32 v10, v10
    v_mov_b32 v10, v10
    v_mov_b32 v10, v10
    v_mov_b32 v10, v10
    buffer_load_dwordx4 v[28:31], v2, s[48:51], s65 offen offset:3072 sc1
LhF_rot:
    s_waitcnt vmcnt(3)
    v_cmp_eq_u32 vcc, -1, v16
    s_cbranch_vccz LhF_got0
    buffer_load_dwordx4 v[16:19], v2, s[48:51], s65 offen offset:0 sc1
    s_waitcnt vmcnt(3)
    v_cmp_eq_u32 vcc, -1, v20
    s_cbranch_vccz LhF_got1
    buffer_load_dwordx4 v[20:23], v2, s[48:51], s65 offen offset:1024 sc1
    s_waitcnt vmcnt(3)
    v_cmp_eq_u32 vcc, -1, v24
    s_cbranch_vccz LhF_got2
    buffer_load_dwordx4 v[24:27], v2, s[48:51], s65 offen offset:2048 sc1
    s_waitcnt vmcnt(3)
    v_cmp_eq_u32 vcc, -1, v28
    s_cbranch_vccz LhF_got3
    buffer_load_dwordx4 v[28:31], v2, s[48:51], s65 offen offset:3072 sc1
    s_sub_u32 s46, s46, 1
    s_cbranch_scc0 LhF_rot
    s_mov_b32 s46, 0
    s_branch LhF_late
LhF_redo:
    buffer_load_dwordx4 v[16:19], v2, s[48:51], s65 offen offset:0 sc1
    buffer_load_dwordx4 v[20:23], v2, s[48:51], s65 offen offset:1024 sc1
    buffer_load_dwordx4 v[24:27], v2, s[48:51], s65 offen offset:2048 sc1
    buffer_load_dwordx4 v[28:31], v2, s[48:51], s65 offen offset:3072 sc1
    v_mov_b64 v[56:57], 0
    v_mov_b64 v[58:59], 0
    v_mov_b64 v[60:61], 0
    v_mov_b64 v[62:63], 0
    s_branch LhF_rot
LhF_late:
    s_waitcnt vmcnt(3)
LhF_got0:
    v_smfmac_f32_16x16x64_bf16 v[56:59], v[16:19], a[192:199], v1
    v_smfmac_f32_16x16x64_bf16 v[60:63], v[16:19], a[200:207], v1
    s_waitcnt vmcnt(2)
    v_smfmac_f32_16x16x64_bf16 v[56:59], v[20:23], a[208:215], v1
    v_mov_b32 v8, v20
    v_smfmac_f32_16x16x64_bf16 v[60:63], v[20:23], a[216:223], v1
    s_waitcnt vmcnt(1)
    v_smfmac_f32_16x16x64_bf16 v[56:59], v[24:27], a[224:231], v1
    v_max_u32 v8, v8, v24
    v_smfmac_f32_16x16x64_bf16 v[60:63], v[24:27], a[232:239], v1
    s_waitcnt vmcnt(0)
    v_smfmac_f32_16x16x64_bf16 v[56:59], v[28:31], a[240:247], v1
    v_max_u32 v8, v8, v28
    v_cmp_eq_u32 vcc, -1, v8
    v_smfmac_f32_16x16x64_bf16 v[60:63], v[28:31], a[248:255], v1
    s_cbranch_vccnz LhF_bad0
LhF_ok0:
    s_nop 2
    v_cvt_pk_bf16_f32 v64, v56, v57
    v_cvt_pk_bf16_f32 v65, v58, v59
    s_nop 1
    v_cvt_pk_bf16_f32 v66, v60, v61
    v_cvt_pk_bf16_f32 v67, v62, v63
    ds_write_b128 v9, v[64:67] offset:12288
    s_branch LhF_join
LhF_bad0:
    s_sub_u32 s46, s46, 1
    s_cbranch_scc0 LhF_redo
    s_mov_b32 s46, 0
    s_branch LhF_ok0
LhF_got1:
    v_smfmac_f32_16x16x64_bf16 v[56:59], v[20:23], a[208:215], v1
    v_smfmac_f32_16x16x64_bf16 v[60:63], v[20:23], a[216:223], v1
    s_waitcnt vmcnt(2)
    v_smfmac_f32_16x16x64_bf16 v[56:59], v[24:27], a[224:231], v1
    v_mov_b32 v8, v24
    v_smfmac_f32_16x16x64_bf16 v[60:63], v[24:27], a[232:239], v1
    s_waitcnt vmcnt(1)
    v_smfmac_f32_16x16x64_bf16 v[56:59], v[28:31], a[240:247], v1
    v_max_u32 v8, v8, v28
    v_smfmac_f32_16x16x64_bf16 v[60:63], v[28:31], a[248:255], v1
    s_waitcnt vmcnt(0)
    v_smfmac_f32_16x16x64_bf16 v[56:59], v[16:19], a[192:199], v1
    v_max_u32 v8, v8, v16
    v_cmp_eq_u32 vcc, -1, v8
    v_smfmac_f32_16x16x64_bf16 v[60:63], v[16:19], a[200:207], v1
    s_cbranch_vccnz LhF_bad1
LhF_ok1:
    s_nop 2
    v_cvt_pk_bf16_f32 v64, v56, v57
    v_cvt_pk_bf16_f32 v65, v58, v59
    s_nop 1
    v_cvt_pk_bf16_f32 v66, v60, v61
    v_cvt_pk_bf16_f32 v67, v62, v63
    ds_write_b128 v9, v[64:67] offset:12288
    s_branch LhF_join
LhF_bad1:
    s_sub_u32 s46, s46, 1
    s_cbranch_scc0 LhF_redo
    s_mov_b32 s46, 0
    s_branch LhF_ok1
LhF_got2:
    v_smfmac_f32_16x16x64_bf16 v[56:59], v[24:27], a[224:231], v1
    v_smfmac_f32_16x16x64_bf16 v[60:63], v[24:27], a[232:239], v1
    s_waitcnt vmcnt(2)
    v_smfmac_f32_16x16x64_bf16 v[56:59], v[28:31], a[240:247], v1
    v_mov_b32 v8, v28
    v_smfmac_f32_16x16x64_bf16 v[60:63], v[28:31], a[248:255], v1
    s_waitcnt vmcnt(1)
    v_smfmac_f32_16x16x64_bf16 v[56:59], v[16:19], a[192:199], v1
    v_max_u32 v8, v8, v16
    v_smfmac_f32_16x16x64_bf16 v[60:63], v[16:19], a[200:207], v1
    s_waitcnt vmcnt(0)
    v_smfmac_f32_16x16x64_bf16 v[56:59], v[20:23], a[208:215], v1
    v_max_u32 v8, v8, v20
    v_cmp_eq_u32 vcc, -1, v8
    v_smfmac_f32_16x16x64_bf16 v[60:63], v[20:23], a[216:223], v1
    s_cbranch_vccnz LhF_bad2
LhF_ok2:
    s_nop 2
    v_cvt_pk_bf16_f32 v64, v56, v57
    v_cvt_pk_bf16_f32 v65, v58, v59
    s_nop 1
    v_cvt_pk_bf16_f32 v66, v60, v61
    v_cvt_pk_bf16_f32 v67, v62, v63
    ds_write_b128 v9, v[64:67] offset:12288
    s_branch LhF_join
LhF_bad2:
    s_sub_u32 s46, s46, 1
    s_cbranch_scc0 LhF_redo
    s_mov_b32 s46, 0
    s_branch LhF_ok2
LhF_got3:
    v_smfmac_f32_16x16x64_bf16 v[56:59], v[28:31], a[240:247], v1
    v_smfmac_f32_16x16x64_bf16 v[60:63], v[28:31], a[248:255], v1
    s_waitcnt vmcnt(2)
    v_smfmac_f32_16x16x64_bf16 v[56:59], v[16:19], a[192:199], v1
    v_mov_b32 v8, v16
    v_smfmac_f32_16x16x64_bf16 v[60:63], v[16:19], a[200:207], v1
    s_waitcnt vmcnt(1)
    v_smfmac_f32_16x16x64_bf16 v[56:59], v[20:23], a[208:215], v1
    v_max_u32 v8, v8, v20
    v_smfmac_f32_16x16x64_bf16 v[60:63], v[20:23], a[216:223], v1
    s_waitcnt vmcnt(0)
    v_smfmac_f32_16x16x64_bf16 v[56:59], v[24:27], a[224:231], v1
    v_max_u32 v8, v8, v24
    v_cmp_eq_u32 vcc, -1, v8
    v_smfmac_f32_16x16x64_bf16 v[60:63], v[24:27], a[232:239], v1
    s_cbranch_vccnz LhF_bad3
LhF_ok3:
    s_nop 2
    v_cvt_pk_bf16_f32 v64, v56, v57
    v_cvt_pk_bf16_f32 v65, v58, v59
    s_nop 1
    v_cvt_pk_bf16_f32 v66, v60, v61
    v_cvt_pk_bf16_f32 v67, v62, v63
    ds_write_b128 v9, v[64:67] offset:12288
    s_branch LhF_join
LhF_bad3:
    s_sub_u32 s46, s46, 1
    s_cbranch_scc0 LhF_redo
    s_mov_b32 s46, 0
    s_branch LhF_ok3
LhF_join:
    s_cmp_ge_u32 s4, 2
    s_cbranch_scc1 Lh_w23
    s_cmp_ge_u32 s61, s80
    s_cbranch_scc0 Lh_kvwait
    s_waitcnt lgkmcnt(0)
    s_barrier
Lh_kvok:
    s_add_u32 s79, s76, 16777216
    s_mov_b32 m0, 16384
    s_nop 0
    buffer_load_dwordx4 v5, s[48:51], s76 offen sc1 lds
    s_mov_b32 m0, 17280
    s_nop 0
    buffer_load_dwordx4 v5, s[48:51], s76 offen offset:128 sc1 lds
    s_mov_b32 m0, 18432
    s_nop 0
    buffer_load_dwordx4 v5, s[48:51], s79 offen sc1 lds
    s_mov_b32 m0, 19328
    s_nop 0
    buffer_load_dwordx4 v5, s[48:51], s79 offen offset:128 sc1 lds
    s_add_u32 s80, s80, 2
    s_min_u32 s80, s80, 64
    s_cmp_ge_u32 s61, s80
    s_cbranch_scc1 Lh_next
    s_mov_b32 s80, 0
kv_6:
    v_mov_b32 v11, 0
    buffer_load_dwordx2 v[14:15], v11, s[48:51], s78 offen sc1
    s_waitcnt vmcnt(0)
    v_min_u32 v10, v14, v15
    s_nop 0
    v_readfirstlane_b32 s61, v10
    s_nop 0
    s_cmp_ge_u32 s61, s80
    s_cbranch_scc1 kvok_7
    s_sub_u32 s46, s46, 1
    s_cbranch_scc0 kv_6
    s_mov_b32 s46, 0
    s_branch kvok_7
kvok_7:
    s_branch Lh_next
Lh_kvwait:
    s_waitcnt lgkmcnt(0)
    s_barrier
kv_8:
    v_mov_b32 v11, 0
    buffer_load_dwordx2 v[14:15], v11, s[48:51], s78 offen sc1
    s_waitcnt vmcnt(0)
    v_min_u32 v10, v14, v15
    s_nop 0
    v_readfirstlane_b32 s61, v10
    s_nop 0
    s_cmp_ge_u32 s61, s80
    s_cbranch_scc1 kvok_9
    s_sub_u32 s46, s46, 1
    s_cbranch_scc0 kv_8
    s_mov_b32 s46, 0
    s_branch kvok_9
kvok_9:
    s_branch Lh_kvok
Lh_w23:
    s_cmp_eq_u32 s4, 3
    s_waitcnt lgkmcnt(0)
    s_barrier
    s_cbranch_scc1 Lh_next
    v_mov_b32 v10, s60
    v_mov_b32 v11, 4096
    s_mov_b64 exec, 1
    buffer_store_dword v10, v11, s[48:51], s78 offen sc1
    s_mov_b64 exec, -1
Lh_next:
    s_waitcnt vmcnt(0)
    s_xor_b32 s65, s65, 0x4000
    s_add_u32 s60, s60, 1
    s_branch Lh_step
Ll_step:
    s_barrier
    buffer_load_dwordx4 v[16:19], v2, s[48:51], s63 offen offset:0 sc1
    v_mov_b64 v[32:33], 0
    v_mov_b64 v[34:35], 0
    v_mov_b64 v[36:37], 0
    v_mov_b64 v[38:39], 0
    ds_read_b128 v[124:127], v2 offset:16384
    ds_read_b128 v[128:131], v2 offset:17408
    v_mov_b32 v10, v10
    v_mov_b32 v10, v10
    v_mov_b32 v10, v10
    v_mov_b32 v10, v10
    v_mov_b32 v10, v10
    v_mov_b32 v10, v10
    v_mov_b32 v10, v10
    v_mov_b32 v10, v10
    buffer_load_dwordx4 v[20:23], v2, s[48:51], s63 offen offset:1024 sc1
    v_mov_b64 v[40:41], 0
    v_mov_b64 v[42:43], 0
    v_mov_b64 v[44:45], 0
    v_mov_b64 v[46:47], 0
    ds_read_b128 v[132:135], v2 offset:18432
    ds_read_b128 v[136:139], v2 offset:19456
    v_mov_b32 v10, v10
    v_mov_b32 v10, v10
    v_mov_b32 v10, v10
    v_mov_b32 v10, v10
    v_mov_b32 v10, v10
    v_mov_b32 v10, v10
    v_mov_b32 v10, v10
    v_mov_b32 v10, v10
    buffer_load_dwordx4 v[24:27], v2, s[48:51], s63 offen offset:2048 sc1
    v_mov_b64 v[48:49], 0
    v_mov_b64 v[50:51], 0
    v_mov_b64 v[52:53], 0
    v_mov_b64 v[54:55], 0
    v_mov_b32 v10, v10
    v_mov_b32 v10, v10
    v_mov_b32 v10, v10
    v_mov_b32 v10, v10
    v_mov_b32 v10, v10
    v_mov_b32 v10, v10
    v_mov_b32 v10, v10
    v_mov_b32 v10, v10
    buffer_load_dwordx4 v[28:31], v2, s[48:51], s63 offen offset:3072 sc1
LlA_rot:
    s_waitcnt vmcnt(3)
    v_max_u32 v8, v16, v18
    v_cmp_eq_u32 vcc, -1, v8
    s_cbranch_vccz LlA_got0
    buffer_load_dwordx4 v[16:19], v2, s[48:51], s63 offen offset:0 sc1
    s_waitcnt vmcnt(3)
    v_max_u32 v8, v20, v22
    v_cmp_eq_u32 vcc, -1, v8
    s_cbranch_vccz LlA_got1
    buffer_load_dwordx4 v[20:23], v2, s[48:51], s63 offen offset:1024 sc1
    s_waitcnt vmcnt(3)
    v_max_u32 v8, v24, v26
    v_cmp_eq_u32 vcc, -1, v8
    s_cbranch_vccz LlA_got2
    buffer_load_dwordx4 v[24:27], v2, s[48:51], s63 offen offset:2048 sc1
    s_waitcnt vmcnt(3)
    v_max_u32 v8, v28, v30
    v_cmp_eq_u32 vcc, -1, v8
    s_cbranch_vccz LlA_got3
    buffer_load_dwordx4 v[28:31], v2, s[48:51], s63 offen offset:3072 sc1
    s_sub_u32 s46, s46, 1
    s_cbranch_scc0 LlA_rot
    s_mov_b32 s46, 0
    s_branch LlA_late
LlA_redo:
    buffer_load_dwordx4 v[16:19], v2, s[48:51], s63 offen offset:0 sc1
    buffer_load_dwordx4 v[20:23], v2, s[48:51], s63 offen offset:1024 sc1
    buffer_load_dwordx4 v[24:27], v2, s[48:51], s63 offen offset:2048 sc1
    buffer_load_dwordx4 v[28:31], v2, s[48:51], s63 offen offset:3072 sc1
    v_mov_b64 v[32:33], 0
    v_mov_b64 v[34:35], 0
    v_mov_b64 v[36:37], 0
    v_mov_b64 v[38:39], 0
    v_mov_b64 v[40:41], 0
    v_mov_b64 v[42:43], 0
    v_mov_b64 v[44:45], 0
    v_mov_b64 v[46:47], 0
    s_branch LlA_rot
LlA_late:
    s_waitcnt vmcnt(3)
LlA_got0:
    v_smfmac_f32_16x16x64_bf16 v[32:35], v[16:19], a[0:7], v1
    v_smfmac_f32_16x16x64_bf16 v[36:39], v[16:19], a[64:71], v1
    v_smfmac_f32_16x16x64_bf16 v[40:43], v[16:19], a[8:15], v1
    v_smfmac_f32_16x16x64_bf16 v[44:47], v[16:19], a[72:79], v1
    s_waitcnt vmcnt(2)
    v_smfmac_f32_16x16x64_bf16 v[32:35], v[20:23], a[16:23], v1
    v_max3_u32 v8, v8, v20, v22
    v_smfmac_f32_16x16x64_bf16 v[36:39], v[20:23], a[80:87], v1
    v_smfmac_f32_16x16x64_bf16 v[40:43], v[20:23], a[24:31], v1
    v_smfmac_f32_16x16x64_bf16 v[44:47], v[20:23], a[88:95], v1
    s_waitcnt vmcnt(1)
    v_smfmac_f32_16x16x64_bf16 v[32:35], v[24:27], a[32:39], v1
    v_max3_u32 v8, v8, v24, v26
    v_smfmac_f32_16x16x64_bf16 v[36:39], v[24:27], a[96:103], v1
    v_smfmac_f32_16x16x64_bf16 v[40:43], v[24:27], a[40:47], v1
    v_smfmac_f32_16x16x64_bf16 v[44:47], v[24:27], a[104:111], v1
    s_waitcnt vmcnt(0)
    v_smfmac_f32_16x16x64_bf16 v[32:35], v[28:31], a[48:55], v1
    v_max3_u32 v8, v8, v28, v30
    v_cmp_eq_u32 vcc, -1, v8
    v_smfmac_f32_16x16x64_bf16 v[36:39], v[28:31], a[112:119], v1
    v_smfmac_f32_16x16x64_bf16 v[40:43], v[28:31], a[56:63], v1
    v_cvt_pk_bf16_f32 v64, v32, v33
    v_cvt_pk_bf16_f32 v65, v34, v35
    v_smfmac_f32_16x16x64_bf16 v[44:47], v[28:31], a[120:127], v1
    v_cvt_pk_bf16_f32 v66, v36, v37
    v_cvt_pk_bf16_f32 v67, v38, v39
    s_cbranch_vccnz LlA_bad0
LlA_ok0:
    s_nop 0
    v_mfma_f32_16x16x32_bf16 v[72:75], v[64:67], v[80:83], 0
    v_cvt_pk_bf16_f32 v68, v40, v41
    v_cvt_pk_bf16_f32 v69, v42, v43
    s_nop 0
    v_cvt_pk_bf16_f32 v70, v44, v45
    v_cvt_pk_bf16_f32 v71, v46, v47
    s_nop 1
    v_mfma_f32_16x16x32_bf16 v[76:79], v[68:71], v[80:83], 0
    v_smfmac_f32_16x16x64_bf16 v[48:51], v[16:19], a[128:135], v1
    v_pk_mul_f32 v[72:73], v[72:73], v[12:13]
    v_pk_mul_f32 v[74:75], v[74:75], v[12:13]
    v_smfmac_f32_16x16x64_bf16 v[52:55], v[16:19], a[136:143], v1
    s_branch LlA_join
LlA_bad0:
    s_sub_u32 s46, s46, 1
    s_cbranch_scc0 LlA_redo
    s_mov_b32 s46, 0
    s_branch LlA_ok0
LlA_got1:
    v_smfmac_f32_16x16x64_bf16 v[32:35], v[20:23], a[16:23], v1
    v_smfmac_f32_16x16x64_bf16 v[36:39], v[20:23], a[80:87], v1
    v_smfmac_f32_16x16x64_bf16 v[40:43], v[20:23], a[24:31], v1
    v_smfmac_f32_16x16x64_bf16 v[44:47], v[20:23], a[88:95], v1
    s_waitcnt vmcnt(2)
    v_smfmac_f32_16x16x64_bf16 v[32:35], v[24:27], a[32:39], v1
    v_max3_u32 v8, v8, v24, v26
    v_smfmac_f32_16x16x64_bf16 v[36:39], v[24:27], a[96:103], v1
    v_smfmac_f32_16x16x64_bf16 v[40:43], v[24:27], a[40:47], v1
    v_smfmac_f32_16x16x64_bf16 v[44:47], v[24:27], a[104:111], v1
    s_waitcnt vmcnt(1)
    v_smfmac_f32_16x16x64_bf16 v[32:35], v[28:31], a[48:55], v1
    v_max3_u32 v8, v8, v28, v30
    v_smfmac_f32_16x16x64_bf16 v[36:39], v[28:31], a[112:119], v1
    v_smfmac_f32_16x16x64_bf16 v[40:43], v[28:31], a[56:63], v1
    v_smfmac_f32_16x16x64_bf16 v[44:47], v[28:31], a[120:127], v1
    s_waitcnt vmcnt(0)
    v_smfmac_f32_16x16x64_bf16 v[32:35], v[16:19], a[0:7], v1
    v_max3_u32 v8, v8, v16, v18
    v_cmp_eq_u32 vcc, -1, v8
    v_smfmac_f32_16x16x64_bf16 v[36:39], v[16:19], a[64:71], v1
    v_smfmac_f32_16x16x64_bf16 v[40:43], v[16:19], a[8:15], v1
    v_cvt_pk_bf16_f32 v64, v32, v33
    v_cvt_pk_bf16_f32 v65, v34, v35
    v_smfmac_f32_16x16x64_bf16 v[44:47], v[16:19], a[72:79], v1
    v_cvt_pk_bf16_f32 v66, v36, v37
    v_cvt_pk_bf16_f32 v67, v38, v39
    s_cbranch_vccnz LlA_bad1
LlA_ok1:
    s_nop 0
    v_mfma_f32_16x16x32_bf16 v[72:75], v[64:67], v[80:83], 0
    v_cvt_pk_bf16_f32 v68, v40, v41
    v_cvt_pk_bf16_f32 v69, v42, v43
    s_nop 0
    v_cvt_pk_bf16_f32 v70, v44, v45
    v_cvt_pk_bf16_f32 v71, v46, v47
    s_nop 1
    v_mfma_f32_16x16x32_bf16 v[76:79], v[68:71], v[80:83], 0
    v_smfmac_f32_16x16x64_bf16 v[48:51], v[16:19], a[128:135], v1
    v_pk_mul_f32 v[72:73], v[72:73], v[12:13]
    v_pk_mul_f32 v[74:75], v[74:75], v[12:13]
    v_smfmac_f32_16x16x64_bf16 v[52:55], v[16:19], a[136:143], v1
    s_branch LlA_join
LlA_bad1:
    s_sub_u32 s46, s46, 1
    s_cbranch_scc0 LlA_redo
    s_mov_b32 s46, 0
    s_branch LlA_ok1
LlA_got2:
    v_smfmac_f32_16x16x64_bf16 v[32:35], v[24:27], a[32:39], v1
    v_smfmac_f32_16x16x64_bf16 v[36:39], v[24:27], a[96:103], v1
    v_smfmac_f32_16x16x64_bf16 v[40:43], v[24:27], a[40:47], v1
    v_smfmac_f32_16x16x64_bf16 v[44:47], v[24:27], a[104:111], v1
    s_waitcnt vmcnt(2)
    v_smfmac_f32_16x16x64_bf16 v[32:35], v[28:31], a[48:55], v1
    v_max3_u32 v8, v8, v28, v30
    v_smfmac_f32_16x16x64_bf16 v[36:39], v[28:31], a[112:119], v1
    v_smfmac_f32_16x16x64_bf16 v[40:43], v[28:31], a[56:63], v1
    v_smfmac_f32_16x16x64_bf16 v[44:47], v[28:31], a[120:127], v1
    s_waitcnt vmcnt(1)
    v_smfmac_f32_16x16x64_bf16 v[32:35], v[16:19], a[0:7], v1
    v_max3_u32 v8, v8, v16, v18
    v_smfmac_f32_16x16x64_bf16 v[36:39], v[16:19], a[64:71], v1
    v_smfmac_f32_16x16x64_bf16 v[40:43], v[16:19], a[8:15], v1
    v_smfmac_f32_16x16x64_bf16 v[44:47], v[16:19], a[72:79], v1
    s_waitcnt vmcnt(0)
    v_smfmac_f32_16x16x64_bf16 v[32:35], v[20:23], a[16:23], v1
    v_max3_u32 v8, v8, v20, v22
    v_cmp_eq_u32 vcc, -1, v8
    v_smfmac_f32_16x16x64_bf16 v[36:39], v[20:23], a[80:87], v1
    v_smfmac_f32_16x16x64_bf16 v[40:43], v[20:23], a[24:31], v1
    v_cvt_pk_bf16_f32 v64, v32, v33
    v_cvt_pk_bf16_f32 v65, v34, v35
    v_smfmac_f32_16x16x64_bf16 v[44:47], v[20:23], a[88:95], v1
    v_cvt_pk_bf16_f32 v66, v36, v37
    v_cvt_pk_bf16_f32 v67, v38, v39
    s_cbranch_vccnz LlA_bad2
LlA_ok2:
    s_nop 0
    v_mfma_f32_16x16x32_bf16 v[72:75], v[64:67], v[80:83], 0
    v_cvt_pk_bf16_f32 v68, v40, v41
    v_cvt_pk_bf16_f32 v69, v42, v43
    s_nop 0
    v_cvt_pk_bf16_f32 v70, v44, v45
    v_cvt_pk_bf16_f32 v71, v46, v47
    s_nop 1
    v_mfma_f32_16x16x32_bf16 v[76:79], v[68:71], v[80:83], 0
    v_smfmac_f32_16x16x64_bf16 v[48:51], v[16:19], a[128:135], v1
    v_pk_mul_f32 v[72:73], v[72:73], v[12:13]
    v_pk_mul_f32 v[74:75], v[74:75], v[12:13]
    v_smfmac_f32_16x16x64_bf16 v[52:55], v[16:19], a[136:143], v1
    s_branch LlA_join
LlA_bad2:
    s_sub_u32 s46, s46, 1
    s_cbranch_scc0 LlA_redo
    s_mov_b32 s46, 0
    s_branch LlA_ok2
LlA_got3:
    v_smfmac_f32_16x16x64_bf16 v[32:35], v[28:31], a[48:55], v1
    v_smfmac_f32_16x16x64_bf16 v[36:39], v[28:31], a[112:119], v1
    v_smfmac_f32_16x16x64_bf16 v[40:43], v[28:31], a[56:63], v1
    v_smfmac_f32_16x16x64_bf16 v[44:47], v[28:31], a[120:127], v1
    s_waitcnt vmcnt(2)
    v_smfmac_f32_16x16x64_bf16 v[32:35], v[16:19], a[0:7], v1
    v_max3_u32 v8, v8, v16, v18
    v_smfmac_f32_16x16x64_bf16 v[36:39], v[16:19], a[64:71], v1
    v_smfmac_f32_16x16x64_bf16 v[40:43], v[16:19], a[8:15], v1
    v_smfmac_f32_16x16x64_bf16 v[44:47], v[16:19], a[72:79], v1
    s_waitcnt vmcnt(1)
    v_smfmac_f32_16x16x64_bf16 v[32:35], v[20:23], a[16:23], v1
    v_max3_u32 v8, v8, v20, v22
    v_smfmac_f32_16x16x64_bf16 v[36:39], v[20:23], a[80:87], v1
    v_smfmac_f32_16x16x64_bf16 v[40:43], v[20:23], a[24:31], v1
    v_smfmac_f32_16x16x64_bf16 v[44:47], v[20:23], a[88:95], v1
    s_waitcnt vmcnt(0)
    v_smfmac_f32_16x16x64_bf16 v[32:35], v[24:27], a[32:39], v1
    v_max3_u32 v8, v8, v24, v26
    v_cmp_eq_u32 vcc, -1, v8
    v_smfmac_f32_16x16x64_bf16 v[36:39], v[24:27], a[96:103], v1
    v_smfmac_f32_16x16x64_bf16 v[40:43], v[24:27], a[40:47], v1
    v_cvt_pk_bf16_f32 v64, v32, v33
    v_cvt_pk_bf16_f32 v65, v34, v35
    v_smfmac_f32_16x16x64_bf16 v[44:47], v[24:27], a[104:111], v1
    v_cvt_pk_bf16_f32 v66, v36, v37
    v_cvt_pk_bf16_f32 v67, v38, v39
    s_cbranch_vccnz LlA_bad3
LlA_ok3:
    s_nop 0
    v_mfma_f32_16x16x32_bf16 v[72:75], v[64:67], v[80:83], 0
    v_cvt_pk_bf16_f32 v68, v40, v41
    v_cvt_pk_bf16_f32 v69, v42, v43
    s_nop 0
    v_cvt_pk_bf16_f32 v70, v44, v45
    v_cvt_pk_bf16_f32 v71, v46, v47
    s_nop 1
    v_mfma_f32_16x16x32_bf16 v[76:79], v[68:71], v[80:83], 0
    v_smfmac_f32_16x16x64_bf16 v[48:51], v[16:19], a[128:135], v1
    v_pk_mul_f32 v[72:73], v[72:73], v[12:13]
    v_pk_mul_f32 v[74:75], v[74:75], v[12:13]
    v_smfmac_f32_16x16x64_bf16 v[52:55], v[16:19], a[136:143], v1
    s_branch LlA_join
LlA_bad3:
    s_sub_u32 s46, s46, 1
    s_cbranch_scc0 LlA_redo
    s_mov_b32 s46, 0
    s_branch LlA_ok3
LlA_join:
    v_smfmac_f32_16x16x64_bf16 v[48:51], v[20:23], a[144:151], v1
    v_pk_mul_f32 v[76:77], v[76:77], v[12:13]
    v_pk_mul_f32 v[78:79], v[78:79], v[12:13]
    v_smfmac_f32_16x16x64_bf16 v[52:55], v[20:23], a[152:159], v1
    s_cmp_eq_u32 s60, 63
    v_smfmac_f32_16x16x64_bf16 v[48:51], v[24:27], a[160:167], v1
    s_cbranch_scc1 Ll_last
    v_smfmac_f32_16x16x64_bf16 v[52:55], v[24:27], a[168:175], v1
    s_barrier
    ds_read_b128 v[96:99], v2 offset:1024
    ds_read_b128 v[100:103], v2 offset:2048
    ds_read_b128 v[104:107], v2 offset:3072
    ds_read_b128 v[108:111], v2 offset:5120
    ds_read_b128 v[112:115], v2 offset:6144
    ds_read_b128 v[116:119], v2 offset:7168
    s_waitcnt lgkmcnt(5)
    v_pk_fma_f32 v[72:73], v[96:97], v[12:13], v[72:73]
    v_pk_fma_f32 v[74:75], v[98:99], v[12:13], v[74:75]
    s_waitcnt lgkmcnt(3)
    v_pk_fma_f32 v[72:73], v[100:101], v[12:13], v[72:73]
    v_pk_fma_f32 v[74:75], v[102:103], v[12:13], v[74:75]
    v_pk_fma_f32 v[72:73], v[104:105], v[12:13], v[72:73]
    v_pk_fma_f32 v[74:75], v[106:107], v[12:13], v[74:75]
    v_cvt_pk_bf16_f32 v120, v72, v73
    v_cvt_pk_bf16_f32 v121, v74, v75
    s_waitcnt lgkmcnt(0)
    v_pk_fma_f32 v[76:77], v[108:109], v[12:13], v[76:77]
    v_pk_fma_f32 v[78:79], v[110:111], v[12:13], v[78:79]
    v_pk_fma_f32 v[76:77], v[112:113], v[12:13], v[76:77]
    v_pk_fma_f32 v[78:79], v[114:115], v[12:13], v[78:79]
    v_pk_fma_f32 v[76:77], v[116:117], v[12:13], v[76:77]
    v_pk_fma_f32 v[78:79], v[118:119], v[12:13], v[78:79]
    v_cvt_pk_bf16_f32 v122, v76, v77
    v_cvt_pk_bf16_f32 v123, v78, v79
    s_nop 1
    v_mfma_f32_16x16x32_bf16 v[140:143], v[124:127], v[120:123], 0
    v_mfma_f32_16x16x32_bf16 v[144:147], v[128:131], v[120:123], 0
    v_mfma_f32_16x16x32_bf16 v[148:151], v[120:123], v[120:123], 0
    s_mov_b64 exec, s[82:83]
    buffer_store_dwordx4 v[140:143], v2, s[48:51], s67 offen
    s_nop 1
    buffer_store_dwordx4 v[144:147], v2, s[48:51], s67 offen offset:128
    s_nop 2
    buffer_store_dwordx4 v[148:151], v2, s[48:51], s67 offen offset:1024
    s_mov_b64 exec, -1
    v_smfmac_f32_16x16x64_bf16 v[48:51], v[28:31], a[176:183], v1
    v_smfmac_f32_16x16x64_bf16 v[52:55], v[28:31], a[184:191], v1
    v_mov_b32_dpp v140, v144 row_ror:8 row_mask:0xf bank_mask:0xc
    v_mov_b32_dpp v141, v145 row_ror:8 row_mask:0xf bank_mask:0xc
    v_mov_b32_dpp v142, v146 row_ror:8 row_mask:0xf bank_mask:0xc
    v_mov_b32_dpp v143, v147 row_ror:8 row_mask:0xf bank_mask:0xc
    v_mov_b32 v10, v10
    v_mov_b32 v10, v10
    v_mov_b32 v10, v10
    v_mov_b32 v10, v10
    v_mov_b32 v10, v10
    v_mov_b32 v10, v10
    v_mov_b32 v10, v10
    v_mov_b32 v10, v10
    v_mov_b32 v10, v10
    v_mov_b32 v10, v10
    buffer_load_dwordx4 v[152:155], v2, s[48:51], s68 offen sc1
    buffer_load_dwordx4 v[156:159], v2, s[48:51], s69 offen sc1
    buffer_load_dwordx4 v[160:163], v2, s[48:51], s70 offen sc1
    buffer_load_dword v164, v6, s[48:51], s67 offen sc1
    buffer_load_dword v165, v6, s[48:51], s68 offen sc1
    buffer_load_dword v166, v6, s[48:51], s69 offen sc1
    buffer_load_dword v167, v6, s[48:51], s70 offen sc1
    v_cvt_pk_bf16_f32 v64, v48, v49
    v_cvt_pk_bf16_f32 v65, v50, v51
    v_cvt_pk_bf16_f32 v66, v52, v53
    v_cvt_pk_bf16_f32 v67, v54, v55
    s_barrier
    ds_read_b128 v[96:99], v2 offset:9216
    ds_read_b128 v[100:103], v2 offset:10240
    ds_read_b128 v[104:107], v2 offset:11264
    v_mfma_f32_16x16x32_bf16 v[184:187], v[84:87], v[64:67], 0
    buffer_load_dwordx4 v[168:171], v2, s[48:51], s68 offen sc1
    buffer_load_dwordx4 v[172:175], v2, s[48:51], s69 offen sc1
    buffer_load_dwordx4 v[176:179], v2, s[48:51], s70 offen sc1
    buffer_load_dword v180, v6, s[48:51], s67 offen sc1
    buffer_load_dword v181, v6, s[48:51], s68 offen sc1
    buffer_load_dword v182, v6, s[48:51], s69 offen sc1
    buffer_load_dword v183, v6, s[48:51], s70 offen sc1
    s_waitcnt lgkmcnt(2)
    v_mfma_f32_16x16x32_bf16 v[184:187], v[84:87], v[96:99], v[184:187]
    s_waitcnt lgkmcnt(1)
    v_mfma_f32_16x16x32_bf16 v[184:187], v[84:87], v[100:103], v[184:187]
    s_waitcnt lgkmcnt(0)
    v_mfma_f32_16x16x32_bf16 v[184:187], v[84:87], v[104:107], v[184:187]
    buffer_load_dwordx4 v[16:19], v2, s[48:51], s68 offen sc1
    buffer_load_dwordx4 v[20:23], v2, s[48:51], s69 offen sc1
    buffer_load_dwordx4 v[24:27], v2, s[48:51], s70 offen sc1
    buffer_load_dword v28, v6, s[48:51], s67 offen sc1
    buffer_load_dword v29, v6, s[48:51], s68 offen sc1
    buffer_load_dword v30, v6, s[48:51], s69 offen sc1
    buffer_load_dword v31, v6, s[48:51], s70 offen sc1
    s_nop 0
    v_cvt_pk_bf16_f32 v188, v184, v185
    v_cvt_pk_bf16_f32 v192, v186, v187
    s_waitcnt vmcnt(20)
    v_pk_add_f32 v[228:229], v[140:141], v[152:153]
    v_pk_add_f32 v[230:231], v[142:143], v[154:155]
    s_waitcnt vmcnt(18)
    v_pk_add_f32 v[216:217], v[156:157], v[160:161]
    v_pk_add_f32 v[218:219], v[158:159], v[162:163]
    v_max3_u32 v8, v152, v156, v160
    v_pk_add_f32 v[228:229], v[228:229], v[216:217]
    v_pk_add_f32 v[230:231], v[230:231], v[218:219]
    s_waitcnt vmcnt(14)
    v_max3_u32 v8, v8, v164, v165
    v_max3_u32 v8, v8, v166, v167
    v_cmp_eq_u32 vcc, -1, v8
    v_add_f32 v216, v164, v165
    v_add_f32 v217, v166, v167
    v_max3_f32 v236, v228, v229, v230
    v_add_f32 v232, v216, v217
    v_max3_f32 v236, v236, v231, v232
    s_cbranch_vccnz Ll_redoD
Ll_okD:
    s_nop 0
    v_max_f32_dpp v236, v236, v236 row_ror:8 row_mask:0xf bank_mask:0xf
    v_mov_b32 v216, v236
    s_nop 1
    v_permlane16_swap_b32 v236, v216
    v_max_f32 v236, v236, v216
    v_mov_b32 v216, v236
    s_nop 1
    v_permlane32_swap_b32 v236, v216
    v_max_f32 v236, v236, v216
    v_sub_f32 v232, v232, v236
    v_pk_add_f32 v[228:229], v[228:229], v[236:237] op_sel_hi:[1,0] neg_lo:[0,1] neg_hi:[0,1]
    v_exp_f32 v232, v232
    v_pk_add_f32 v[230:231], v[230:231], v[236:237] op_sel_hi:[1,0] neg_lo:[0,1] neg_hi:[0,1]
    v_exp_f32 v228, v228
    v_mov_b32_dpp v216, v232 row_ror:8 row_mask:0xf bank_mask:0xf
    v_exp_f32 v229, v229
    v_cvt_pk_bf16_f32 v200, v232, v216
    v_exp_f32 v230, v230
    v_exp_f32 v231, v231
    v_mfma_f32_16x16x32_bf16 v[204:207], v[88:91], v[200:203], 0
    v_cvt_pk_bf16_f32 v196, v228, v229
    v_cvt_pk_bf16_f32 v197, v230, v231
    v_mfma_f32_16x16x32_bf16 v[208:211], v[188:191], v[200:203], 0
    v_mov_b32_dpp v198, v196 row_ror:8 row_mask:0xf bank_mask:0xf
    v_mov_b32_dpp v199, v197 row_ror:8 row_mask:0xf bank_mask:0xf
    v_mfma_f32_16x16x32_bf16 v[212:215], v[192:195], v[200:203], 0
    v_mfma_f32_16x16x32_bf16 v[204:207], v[88:91], v[196:199], v[204:207]
    v_mfma_f32_16x16x32_bf16 v[208:211], v[132:135], v[196:199], v[208:211]
    v_mfma_f32_16x16x32_bf16 v[212:215], v[136:139], v[196:199], v[212:215]
    v_rcp_f32 v236, v204
    s_mov_b64 exec, s[82:83]
    s_nop 1
    v_pk_mul_f32 v[208:209], v[208:209], v[236:237] op_sel_hi:[1,0]
    v_pk_mul_f32 v[210:211], v[210:211], v[236:237] op_sel_hi:[1,0]
    v_cvt_pk_bf16_f32 v216, v208, v209
    v_cvt_pk_bf16_f32 v217, v210, v211
    v_pk_mul_f32 v[212:213], v[212:213], v[236:237] op_sel_hi:[1,0]
    v_pk_mul_f32 v[214:215], v[214:215], v[236:237] op_sel_hi:[1,0]
    v_cvt_pk_bf16_f32 v218, v212, v213
    v_cvt_pk_bf16_f32 v219, v214, v215
    buffer_store_dwordx4 v[216:219], v3, s[48:51], s66 offen
    s_mov_b64 exec, -1
    v_mov_b32_dpp v120, v188 quad_perm:[0,1,2,3] row_mask:0xf bank_mask:0x3
    v_mov_b32_dpp v121, v192 quad_perm:[0,1,2,3] row_mask:0xf bank_mask:0x3
    v_mov_b32_dpp v122, v188 row_ror:8 row_mask:0xf bank_mask:0x3
    v_mov_b32_dpp v123, v192 row_ror:8 row_mask:0xf bank_mask:0x3
    s_barrier
    buffer_load_dwordx4 v[16:19], v2, s[48:51], s65 offen offset:0 sc1
    v_mov_b32 v56, 0
    v_mov_b32 v57, 0
    v_mov_b32 v58, 0
    v_mov_b32 v59, 0
    v_mov_b32 v10, v10
    v_mov_b32 v10, v10
    v_mov_b32 v10, v10
    v_mov_b32 v10, v10
    v_mov_b32 v10, v10
    v_mov_b32 v10, v10
    v_mov_b32 v10, v10
    v_mov_b32 v10, v10
    buffer_load_dwordx4 v[20:23], v2, s[48:51], s65 offen offset:1024 sc1
    v_mov_b32 v60, 0
    v_mov_b32 v61, 0
    v_mov_b32 v62, 0
    v_mov_b32 v63, 0
    v_mov_b32 v10, v10
    v_mov_b32 v10, v10
    v_mov_b32 v10, v10
    v_mov_b32 v10, v10
    v_mov_b32 v10, v10
    v_mov_b32 v10, v10
    v_mov_b32 v10, v10
    v_mov_b32 v10, v10
    buffer_load_dwordx4 v[24:27], v2, s[48:51], s65 offen offset:2048 sc1
    v_mov_b32 v68, 0
    v_mov_b32 v69, 0
    v_mov_b32 v70, 0
    v_mov_b32 v71, 0
    v_mov_b32 v10, v10
    v_mov_b32 v10, v10
    v_mov_b32 v10, v10
    v_mov_b32 v10, v10
    v_mov_b32 v10, v10
    v_mov_b32 v10, v10
    v_mov_b32 v10, v10
    v_mov_b32 v10, v10
    buffer_load_dwordx4 v[28:31], v2, s[48:51], s65 offen offset:3072 sc1
LlF_rot:
    s_waitcnt vmcnt(3)
    v_cmp_eq_u32 vcc, -1, v16
    s_cbranch_vccz LlF_got0
    buffer_load_dwordx4 v[16:19], v2, s[48:51], s65 offen offset:0 sc1
    s_waitcnt vmcnt(3)
    v_cmp_eq_u32 vcc, -1, v20
    s_cbranch_vccz LlF_got1
    buffer_load_dwordx4 v[20:23], v2, s[48:51], s65 offen offset:1024 sc1
    s_waitcnt vmcnt(3)
    v_cmp_eq_u32 vcc, -1, v24
    s_cbranch_vccz LlF_got2
    buffer_load_dwordx4 v[24:27], v2, s[48:51], s65 offen offset:2048 sc1
    s_waitcnt vmcnt(3)
    v_cmp_eq_u32 vcc, -1, v28
    s_cbranch_vccz LlF_got3
    buffer_load_dwordx4 v[28:31], v2, s[48:51], s65 offen offset:3072 sc1
    s_sub_u32 s46, s46, 1
    s_cbranch_scc0 LlF_rot
    s_mov_b32 s46, 0
    s_branch LlF_late
LlF_redo:
    buffer_load_dwordx4 v[16:19], v2, s[48:51], s65 offen offset:0 sc1
    buffer_load_dwordx4 v[20:23], v2, s[48:51], s65 offen offset:1024 sc1
    buffer_load_dwordx4 v[24:27], v2, s[48:51], s65 offen offset:2048 sc1
    buffer_load_dwordx4 v[28:31], v2, s[48:51], s65 offen offset:3072 sc1
    v_mov_b64 v[56:57], 0
    v_mov_b64 v[58:59], 0
    v_mov_b64 v[60:61], 0
    v_mov_b64 v[62:63], 0
    s_branch LlF_rot
LlF_late:
    s_waitcnt vmcnt(3)
LlF_got0:
    v_smfmac_f32_16x16x64_bf16 v[56:59], v[16:19], a[192:199], v1
    v_smfmac_f32_16x16x64_bf16 v[60:63], v[16:19], a[200:207], v1
    s_waitcnt vmcnt(2)
    v_smfmac_f32_16x16x64_bf16 v[56:59], v[20:23], a[208:215], v1
    v_mov_b32 v8, v20
    v_smfmac_f32_16x16x64_bf16 v[60:63], v[20:23], a[216:223], v1
    s_waitcnt vmcnt(1)
    v_smfmac_f32_16x16x64_bf16 v[56:59], v[24:27], a[224:231], v1
    v_max_u32 v8, v8, v24
    v_smfmac_f32_16x16x64_bf16 v[60:63], v[24:27], a[232:239], v1
    s_waitcnt vmcnt(0)
    v_smfmac_f32_16x16x64_bf16 v[56:59], v[28:31], a[240:247], v1
    v_max_u32 v8, v8, v28
    v_cmp_eq_u32 vcc, -1, v8
    v_smfmac_f32_16x16x64_bf16 v[60:63], v[28:31], a[248:255], v1
    s_cbranch_vccnz LlF_bad0
LlF_ok0:
    s_nop 2
    v_cvt_pk_bf16_f32 v64, v56, v57
    v_cvt_pk_bf16_f32 v65, v58, v59
    s_nop 1
    v_cvt_pk_bf16_f32 v66, v60, v61
    v_cvt_pk_bf16_f32 v67, v62, v63
    s_branch LlF_join
LlF_bad0:
    s_sub_u32 s46, s46, 1
    s_cbranch_scc0 LlF_redo
    s_mov_b32 s46, 0
    s_branch LlF_ok0
LlF_got1:
    v_smfmac_f32_16x16x64_bf16 v[56:59], v[20:23], a[208:215], v1
    v_smfmac_f32_16x16x64_bf16 v[60:63], v[20:23], a[216:223], v1
    s_waitcnt vmcnt(2)
    v_smfmac_f32_16x16x64_bf16 v[56:59], v[24:27], a[224:231], v1
    v_mov_b32 v8, v24
    v_smfmac_f32_16x16x64_bf16 v[60:63], v[24:27], a[232:239], v1
    s_waitcnt vmcnt(1)
    v_smfmac_f32_16x16x64_bf16 v[56:59], v[28:31], a[240:247], v1
    v_max_u32 v8, v8, v28
    v_smfmac_f32_16x16x64_bf16 v[60:63], v[28:31], a[248:255], v1
    s_waitcnt vmcnt(0)
    v_smfmac_f32_16x16x64_bf16 v[56:59], v[16:19], a[192:199], v1
    v_max_u32 v8, v8, v16
    v_cmp_eq_u32 vcc, -1, v8
    v_smfmac_f32_16x16x64_bf16 v[60:63], v[16:19], a[200:207], v1
    s_cbranch_vccnz LlF_bad1
LlF_ok1:
    s_nop 2
    v_cvt_pk_bf16_f32 v64, v56, v57
    v_cvt_pk_bf16_f32 v65, v58, v59
    s_nop 1
    v_cvt_pk_bf16_f32 v66, v60, v61
    v_cvt_pk_bf16_f32 v67, v62, v63
    s_branch LlF_join
LlF_bad1:
    s_sub_u32 s46, s46, 1
    s_cbranch_scc0 LlF_redo
    s_mov_b32 s46, 0
    s_branch LlF_ok1
LlF_got2:
    v_smfmac_f32_16x16x64_bf16 v[56:59], v[24:27], a[224:231], v1
    v_smfmac_f32_16x16x64_bf16 v[60:63], v[24:27], a[232:239], v1
    s_waitcnt vmcnt(2)
    v_smfmac_f32_16x16x64_bf16 v[56:59], v[28:31], a[240:247], v1
    v_mov_b32 v8, v28
    v_smfmac_f32_16x16x64_bf16 v[60:63], v[28:31], a[248:255], v1
    s_waitcnt vmcnt(1)
    v_smfmac_f32_16x16x64_bf16 v[56:59], v[16:19], a[192:199], v1
    v_max_u32 v8, v8, v16
    v_smfmac_f32_16x16x64_bf16 v[60:63], v[16:19], a[200:207], v1
    s_waitcnt vmcnt(0)
    v_smfmac_f32_16x16x64_bf16 v[56:59], v[20:23], a[208:215], v1
    v_max_u32 v8, v8, v20
    v_cmp_eq_u32 vcc, -1, v8
    v_smfmac_f32_16x16x64_bf16 v[60:63], v[20:23], a[216:223], v1
    s_cbranch_vccnz LlF_bad2
LlF_ok2:
    s_nop 2
    v_cvt_pk_bf16_f32 v64, v56, v57
    v_cvt_pk_bf16_f32 v65, v58, v59
    s_nop 1
    v_cvt_pk_bf16_f32 v66, v60, v61
    v_cvt_pk_bf16_f32 v67, v62, v63
    s_branch LlF_join
LlF_bad2:
    s_sub_u32 s46, s46, 1
    s_cbranch_scc0 LlF_redo
    s_mov_b32 s46, 0
    s_branch LlF_ok2
LlF_got3:
    v_smfmac_f32_16x16x64_bf16 v[56:59], v[28:31], a[240:247], v1
    v_smfmac_f32_16x16x64_bf16 v[60:63], v[28:31], a[248:255], v1
    s_waitcnt vmcnt(2)
    v_smfmac_f32_16x16x64_bf16 v[56:59], v[16:19], a[192:199], v1
    v_mov_b32 v8, v16
    v_smfmac_f32_16x16x64_bf16 v[60:63], v[16:19], a[200:207], v1
    s_waitcnt vmcnt(1)
    v_smfmac_f32_16x16x64_bf16 v[56:59], v[20:23], a[208:215], v1
    v_max_u32 v8, v8, v20
    v_smfmac_f32_16x16x64_bf16 v[60:63], v[20:23], a[216:223], v1
    s_waitcnt vmcnt(0)
    v_smfmac_f32_16x16x64_bf16 v[56:59], v[24:27], a[224:231], v1
    v_max_u32 v8, v8, v24
    v_cmp_eq_u32 vcc, -1, v8
    v_smfmac_f32_16x16x64_bf16 v[60:63], v[24:27], a[232:239], v1
    s_cbranch_vccnz LlF_bad3
LlF_ok3:
    s_nop 2
    v_cvt_pk_bf16_f32 v64, v56, v57
    v_cvt_pk_bf16_f32 v65, v58, v59
    s_nop 1
    v_cvt_pk_bf16_f32 v66, v60, v61
    v_cvt_pk_bf16_f32 v67, v62, v63
    s_branch LlF_join
LlF_bad3:
    s_sub_u32 s46, s46, 1
    s_cbranch_scc0 LlF_redo
    s_mov_b32 s46, 0
    s_branch LlF_ok3
LlF_join:
    s_nop 0
    v_mfma_f32_16x16x32_bf16 v[224:227], v[64:67], v[80:83], 0
    s_barrier
    ds_read_b128 v[96:99], v2 offset:13312
    ds_read_b128 v[100:103], v2 offset:14336
    ds_read_b128 v[104:107], v2 offset:15360
    buffer_store_dwordx4 v[120:123], v2, s[48:51], s77 offen sc1
    s_waitcnt lgkmcnt(2)
    v_mfma_f32_16x16x32_bf16 v[224:227], v[96:99], v[80:83], v[224:227]
    s_waitcnt lgkmcnt(1)
    v_mfma_f32_16x16x32_bf16 v[224:227], v[100:103], v[80:83], v[224:227]
    s_waitcnt lgkmcnt(0)
    v_mfma_f32_16x16x32_bf16 v[224:227], v[104:107], v[80:83], v[224:227]
    s_nop 7
    v_cvt_pk_bf16_f32 v216, v224, v225
    v_cvt_pk_bf16_f32 v217, v226, v227
    buffer_store_dwordx2 v[216:217], v233, s[48:51], s72 offen offset:0 sc1
    buffer_store_dwordx2 v[216:217], v233, s[48:51], s72 offen offset:512 sc1
    s_xor_b32 s66, s66, 0x4000
    s_xor_b32 s79, s64, 0x4000
    buffer_store_dwordx2 v[92:93], v4, s[48:51], s66 offen
    buffer_store_dwordx2 v[92:93], v4, s[48:51], s79 offen
    buffer_store_dwordx4 v[92:95], v2, s[48:51], s67 offen
    buffer_store_dwordx4 v[92:95], v2, s[48:51], s67 offen offset:1024
    v_mov_b32 v10, v10
    v_mov_b32 v10, v10
    v_mov_b32 v10, v10
    v_mov_b32 v10, v10
    v_mov_b32 v10, v10
    v_mov_b32 v10, v10
    v_mov_b32 v10, v10
    v_mov_b32 v10, v10
    v_mov_b32 v10, v10
    v_mov_b32 v10, v10
    v_mov_b32 v10, v10
    v_mov_b32 v10, v10
    v_mov_b32 v10, v10
    v_mov_b32 v10, v10
    v_mov_b32 v10, v10
    v_mov_b32 v10, v10
    v_mov_b32 v10, v10
    v_mov_b32 v10, v10
    v_mov_b32 v10, v10
    v_mov_b32 v10, v10
    v_mov_b32 v10, v10
    v_mov_b32 v10, v10
    v_mov_b32 v10, v10
    v_mov_b32 v10, v10
    v_mov_b32 v10, v10
    v_mov_b32 v10, v10
    v_mov_b32 v10, v10
    v_mov_b32 v10, v10
    v_mov_b32 v10, v10
    v_mov_b32 v10, v10
    v_mov_b32 v10, v10
    v_mov_b32 v10, v10
    v_mov_b32 v10, v10
    v_mov_b32 v10, v10
    v_mov_b32 v10, v10
    v_mov_b32 v10, v10
    v_mov_b32 v10, v10
    v_mov_b32 v10, v10
    v_mov_b32 v10, v10
    v_mov_b32 v10, v10
    v_mov_b32 v10, v10
    v_mov_b32 v10, v10
    v_mov_b32 v10, v10
    v_mov_b32 v10, v10
    v_mov_b32 v10, v10
    v_mov_b32 v10, v10
    v_mov_b32 v10, v10
    v_mov_b32 v10, v10
    v_mov_b32 v10, v10
    v_mov_b32 v10, v10
    v_mov_b32 v10, v10
    v_mov_b32 v10, v10
    v_mov_b32 v10, v10
    v_mov_b32 v10, v10
    v_mov_b32 v10, v10
    buffer_load_dwordx2 v[152:153], v233, s[48:51], s73 offen offset:0 sc1
    buffer_load_dwordx2 v[154:155], v233, s[48:51], s74 offen offset:0 sc1
    buffer_load_dwordx2 v[156:157], v233, s[48:51], s75 offen offset:0 sc1
    v_mov_b32 v10, v10
    v_mov_b32 v10, v10
    v_mov_b32 v10, v10
    v_mov_b32 v10, v10
    v_mov_b32 v10, v10
    v_mov_b32 v10, v10
    v_mov_b32 v10, v10
    v_mov_b32 v10, v10
    v_mov_b32 v10, v10
    v_mov_b32 v10, v10
    v_mov_b32 v10, v10
    v_mov_b32 v10, v10
    v_mov_b32 v10, v10
    v_mov_b32 v10, v10
    v_mov_b32 v10, v10
    v_mov_b32 v10, v10
    v_mov_b32 v10, v10
    v_mov_b32 v10, v10
    v_mov_b32 v10, v10
    v_mov_b32 v10, v10
    v_mov_b32 v10, v10
    v_mov_b32 v10, v10
    v_mov_b32 v10, v10
    v_mov_b32 v10, v10
    v_mov_b32 v10, v10
    v_mov_b32 v10, v10
    v_mov_b32 v10, v10
    v_mov_b32 v10, v10
    v_mov_b32 v10, v10
    v_mov_b32 v10, v10
    v_mov_b32 v10, v10
    v_mov_b32 v10, v10
    v_mov_b32 v10, v10
    v_mov_b32 v10, v10
    v_mov_b32 v10, v10
    v_mov_b32 v10, v10
    v_mov_b32 v10, v10
    v_mov_b32 v10, v10
    v_mov_b32 v10, v10
    v_mov_b32 v10, v10
    v_mov_b32 v10, v10
    v_mov_b32 v10, v10
    v_mov_b32 v10, v10
    v_mov_b32 v10, v10
    v_mov_b32 v10, v10
    buffer_load_dwordx2 v[158:159], v233, s[48:51], s73 offen offset:512 sc1
    buffer_load_dwordx2 v[160:161], v233, s[48:51], s74 offen offset:512 sc1
    buffer_load_dwordx2 v[162:163], v233, s[48:51], s75 offen offset:512 sc1
    s_waitcnt vmcnt(5)
    v_lshlrev_b32 v216, 16, v152
    v_and_b32 v217, 0xffff0000, v152
    v_lshlrev_b32 v218, 16, v153
    v_and_b32 v219, 0xffff0000, v153
    v_pk_add_f32 v[228:229], v[224:225], v[216:217]
    v_pk_add_f32 v[230:231], v[226:227], v[218:219]
    s_waitcnt vmcnt(4)
    v_lshlrev_b32 v216, 16, v154
    v_and_b32 v217, 0xffff0000, v154
    v_lshlrev_b32 v218, 16, v155
    v_and_b32 v219, 0xffff0000, v155
    v_pk_add_f32 v[228:229], v[228:229], v[216:217]
    v_pk_add_f32 v[230:231], v[230:231], v[218:219]
    s_waitcnt vmcnt(3)
    v_max3_u32 v8, v152, v154, v156
    v_cmp_eq_u32 vcc, -1, v8
    v_lshlrev_b32 v216, 16, v156
    v_and_b32 v217, 0xffff0000, v156
    v_lshlrev_b32 v218, 16, v157
    v_and_b32 v219, 0xffff0000, v157
    v_pk_add_f32 v[228:229], v[228:229], v[216:217]
    v_pk_add_f32 v[230:231], v[230:231], v[218:219]
    v_cvt_pk_bf16_f32 v220, v228, v229
    v_cvt_pk_bf16_f32 v221, v230, v231
    s_cbranch_vccnz Ll_redoH
Ll_okH:
    buffer_store_dwordx2 v[220:221], v4, s[48:51], s64 offen
    s_add_u32 s60, s60, 1
    s_xor_b32 s64, s64, 0x4000
    s_xor_b32 s63, s63, 0x4000
    s_xor_b32 s65, s65, 0x4000
    s_lshl_b32 s79, s60, 18
    s_and_b32 s80, s60, 8
    s_lshl_b32 s80, s80, 10
    s_add_u32 s72, s71, s79
    s_xor_b32 s72, s72, s80
    s_add_u32 s77, s87, s79
    s_xor_b32 s77, s77, s80
    s_xor_b32 s73, s72, 1024
    s_xor_b32 s74, s72, 2048
    s_xor_b32 s75, s72, 3072
    s_branch Ll_step
Ll_redoD:
    s_waitcnt vmcnt(13)
    v_pk_add_f32 v[228:229], v[140:141], v[168:169]
    v_pk_add_f32 v[230:231], v[142:143], v[170:171]
    s_waitcnt vmcnt(11)
    v_pk_add_f32 v[216:217], v[172:173], v[176:177]
    v_pk_add_f32 v[218:219], v[174:175], v[178:179]
    v_max3_u32 v8, v168, v172, v176
    v_pk_add_f32 v[228:229], v[228:229], v[216:217]
    v_pk_add_f32 v[230:231], v[230:231], v[218:219]
    s_waitcnt vmcnt(7)
    v_max3_u32 v8, v8, v180, v181
    v_max3_u32 v8, v8, v182, v183
    v_cmp_eq_u32 vcc, -1, v8
    v_add_f32 v216, v180, v181
    v_add_f32 v217, v182, v183
    v_max3_f32 v236, v228, v229, v230
    v_add_f32 v232, v216, v217
    v_max3_f32 v236, v236, v231, v232
    s_cbranch_vccz Ll_okD
    buffer_load_dwordx4 v[152:155], v2, s[48:51], s68 offen sc1
    buffer_load_dwordx4 v[156:159], v2, s[48:51], s69 offen sc1
    buffer_load_dwordx4 v[160:163], v2, s[48:51], s70 offen sc1
    buffer_load_dword v164, v6, s[48:51], s67 offen sc1
    buffer_load_dword v165, v6, s[48:51], s68 offen sc1
    buffer_load_dword v166, v6, s[48:51], s69 offen sc1
    buffer_load_dword v167, v6, s[48:51], s70 offen sc1
    s_waitcnt vmcnt(13)
    v_pk_add_f32 v[228:229], v[140:141], v[16:17]
    v_pk_add_f32 v[230:231], v[142:143], v[18:19]
    s_waitcnt vmcnt(11)
    v_pk_add_f32 v[216:217], v[20:21], v[24:25]
    v_pk_add_f32 v[218:219], v[22:23], v[26:27]
    v_max3_u32 v8, v16, v20, v24
    v_pk_add_f32 v[228:229], v[228:229], v[216:217]
    v_pk_add_f32 v[230:231], v[230:231], v[218:219]
    s_waitcnt vmcnt(7)
    v_max3_u32 v8, v8, v28, v29
    v_max3_u32 v8, v8, v30, v31
    v_cmp_eq_u32 vcc, -1, v8
    v_add_f32 v216, v28, v29
    v_add_f32 v217, v30, v31
    v_max3_f32 v236, v228, v229, v230
    v_add_f32 v232, v216, v217
    v_max3_f32 v236, v236, v231, v232
    s_cbranch_vccz Ll_okD
top_10:
    buffer_load_dwordx4 v[168:171], v2, s[48:51], s68 offen sc1
    buffer_load_dwordx4 v[172:175], v2, s[48:51], s69 offen sc1
    buffer_load_dwordx4 v[176:179], v2, s[48:51], s70 offen sc1
    buffer_load_dword v180, v6, s[48:51], s67 offen sc1
    buffer_load_dword v181, v6, s[48:51], s68 offen sc1
    buffer_load_dword v182, v6, s[48:51], s69 offen sc1
    buffer_load_dword v183, v6, s[48:51], s70 offen sc1
    s_waitcnt vmcnt(13)
    v_pk_add_f32 v[228:229], v[140:141], v[152:153]
    v_pk_add_f32 v[230:231], v[142:143], v[154:155]
    s_waitcnt vmcnt(11)
    v_pk_add_f32 v[216:217], v[156:157], v[160:161]
    v_pk_add_f32 v[218:219], v[158:159], v[162:163]
    v_max3_u32 v8, v152, v156, v160
    v_pk_add_f32 v[228:229], v[228:229], v[216:217]
    v_pk_add_f32 v[230:231], v[230:231], v[218:219]
    s_waitcnt vmcnt(7)
    v_max3_u32 v8, v8, v164, v165
    v_max3_u32 v8, v8, v166, v167
    v_cmp_eq_u32 vcc, -1, v8
    v_add_f32 v216, v164, v165
    v_add_f32 v217, v166, v167
    v_max3_f32 v236, v228, v229, v230
    v_add_f32 v232, v216, v217
    v_max3_f32 v236, v236, v231, v232
    s_cbranch_vccz Ll_okD
    buffer_load_dwordx4 v[152:155], v2, s[48:51], s68 offen sc1
    buffer_load_dwordx4 v[156:159], v2, s[48:51], s69 offen sc1
    buffer_load_dwordx4 v[160:163], v2, s[48:51], s70 offen sc1
    buffer_load_dword v164, v6, s[48:51], s67 offen sc1
    buffer_load_dword v165, v6, s[48:51], s68 offen sc1
    buffer_load_dword v166, v6, s[48:51], s69 offen sc1
    buffer_load_dword v167, v6, s[48:51], s70 offen sc1
    s_waitcnt vmcnt(13)
    v_pk_add_f32 v[228:229], v[140:141], v[168:169]
    v_pk_add_f32 v[230:231], v[142:143], v[170:171]
    s_waitcnt vmcnt(11)
    v_pk_add_f32 v[216:217], v[172:173], v[176:177]
    v_pk_add_f32 v[218:219], v[174:175], v[178:179]
    v_max3_u32 v8, v168, v172, v176
    v_pk_add_f32 v[228:229], v[228:229], v[216:217]
    v_pk_add_f32 v[230:231], v[230:231], v[218:219]
    s_waitcnt vmcnt(7)
    v_max3_u32 v8, v8, v180, v181
    v_max3_u32 v8, v8, v182, v183
    v_cmp_eq_u32 vcc, -1, v8
    v_add_f32 v216, v180, v181
    v_add_f32 v217, v182, v183
    v_max3_f32 v236, v228, v229, v230
    v_add_f32 v232, v216, v217
    v_max3_f32 v236, v236, v231, v232
    s_cbranch_vccz Ll_okD
    s_sub_u32 s46, s46, 1
    s_cbranch_scc0 top_10
    s_mov_b32 s46, 0
    s_branch Ll_okD
Ll_redoH:
top_11:
    buffer_load_dwordx2 v[152:153], v233, s[48:51], s73 offen offset:0 sc1
    buffer_load_dwordx2 v[154:155], v233, s[48:51], s74 offen offset:0 sc1
    buffer_load_dwordx2 v[156:157], v233, s[48:51], s75 offen offset:0 sc1
    s_waitcnt vmcnt(3)
    v_max3_u32 v8, v158, v160, v162
    v_cmp_eq_u32 vcc, -1, v8
    s_cbranch_vccz Ll_sumH1
    buffer_load_dwordx2 v[158:159], v233, s[48:51], s73 offen offset:512 sc1
    buffer_load_dwordx2 v[160:161], v233, s[48:51], s74 offen offset:512 sc1
    buffer_load_dwordx2 v[162:163], v233, s[48:51], s75 offen offset:512 sc1
    s_waitcnt vmcnt(3)
    v_max3_u32 v8, v152, v154, v156
    v_cmp_eq_u32 vcc, -1, v8
    s_cbranch_vccz Ll_sumH0
    s_sub_u32 s46, s46, 1
    s_cbranch_scc0 top_11
    s_mov_b32 s46, 0
    s_branch Ll_okH
Ll_sumH0:
    v_lshlrev_b32 v216, 16, v152
    v_and_b32 v217, 0xffff0000, v152
    v_lshlrev_b32 v218, 16, v153
    v_and_b32 v219, 0xffff0000, v153
    v_pk_add_f32 v[228:229], v[224:225], v[216:217]
    v_pk_add_f32 v[230:231], v[226:227], v[218:219]
    v_lshlrev_b32 v216, 16, v154
    v_and_b32 v217, 0xffff0000, v154
    v_lshlrev_b32 v218, 16, v155
    v_and_b32 v219, 0xffff0000, v155
    v_pk_add_f32 v[228:229], v[228:229], v[216:217]
    v_pk_add_f32 v[230:231], v[230:231], v[218:219]
    v_lshlrev_b32 v216, 16, v156
    v_and_b32 v217, 0xffff0000, v156
    v_lshlrev_b32 v218, 16, v157
    v_and_b32 v219, 0xffff0000, v157
    v_pk_add_f32 v[228:229], v[228:229], v[216:217]
    v_pk_add_f32 v[230:231], v[230:231], v[218:219]
    v_cvt_pk_bf16_f32 v220, v228, v229
    v_cvt_pk_bf16_f32 v221, v230, v231
    s_branch Ll_okH
Ll_sumH1:
    v_lshlrev_b32 v216, 16, v158
    v_and_b32 v217, 0xffff0000, v158
    v_lshlrev_b32 v218, 16, v159
    v_and_b32 v219, 0xffff0000, v159
    v_pk_add_f32 v[228:229], v[224:225], v[216:217]
    v_pk_add_f32 v[230:231], v[226:227], v[218:219]
    v_lshlrev_b32 v216, 16, v160
    v_and_b32 v217, 0xffff0000, v160
    v_lshlrev_b32 v218, 16, v161
    v_and_b32 v219, 0xffff0000, v161
    v_pk_add_f32 v[228:229], v[228:229], v[216:217]
    v_pk_add_f32 v[230:231], v[230:231], v[218:219]
    v_lshlrev_b32 v216, 16, v162
    v_and_b32 v217, 0xffff0000, v162
    v_lshlrev_b32 v218, 16, v163
    v_and_b32 v219, 0xffff0000, v163
    v_pk_add_f32 v[228:229], v[228:229], v[216:217]
    v_pk_add_f32 v[230:231], v[230:231], v[218:219]
    v_cvt_pk_bf16_f32 v220, v228, v229
    v_cvt_pk_bf16_f32 v221, v230, v231
    s_branch Ll_okH
Ll_last:
    v_smfmac_f32_16x16x64_bf16 v[52:55], v[24:27], a[168:175], v1
    v_smfmac_f32_16x16x64_bf16 v[48:51], v[28:31], a[176:183], v1
    v_smfmac_f32_16x16x64_bf16 v[52:55], v[28:31], a[184:191], v1
    s_barrier
    ds_read_b128 v[96:99], v2 offset:1024
    ds_read_b128 v[100:103], v2 offset:2048
    ds_read_b128 v[104:107], v2 offset:3072
    ds_read_b128 v[108:111], v2 offset:5120
    ds_read_b128 v[112:115], v2 offset:6144
    ds_read_b128 v[116:119], v2 offset:7168
    s_waitcnt lgkmcnt(5)
    v_pk_fma_f32 v[72:73], v[96:97], v[12:13], v[72:73]
    v_pk_fma_f32 v[74:75], v[98:99], v[12:13], v[74:75]
    s_waitcnt lgkmcnt(3)
    v_pk_fma_f32 v[72:73], v[100:101], v[12:13], v[72:73]
    v_pk_fma_f32 v[74:75], v[102:103], v[12:13], v[74:75]
    v_pk_fma_f32 v[72:73], v[104:105], v[12:13], v[72:73]
    v_pk_fma_f32 v[74:75], v[106:107], v[12:13], v[74:75]
    v_cvt_pk_bf16_f32 v120, v72, v73
    v_cvt_pk_bf16_f32 v121, v74, v75
    s_waitcnt lgkmcnt(0)
    v_pk_fma_f32 v[76:77], v[108:109], v[12:13], v[76:77]
    v_pk_fma_f32 v[78:79], v[110:111], v[12:13], v[78:79]
    v_pk_fma_f32 v[76:77], v[112:113], v[12:13], v[76:77]
    v_pk_fma_f32 v[78:79], v[114:115], v[12:13], v[78:79]
    v_pk_fma_f32 v[76:77], v[116:117], v[12:13], v[76:77]
    v_pk_fma_f32 v[78:79], v[118:119], v[12:13], v[78:79]
    v_cvt_pk_bf16_f32 v122, v76, v77
    v_cvt_pk_bf16_f32 v123, v78, v79
    v_mov_b32 v10, s60
    v_mov_b32 v11, 4096
    s_mov_b64 exec, 1
    buffer_store_dword v10, v11, s[48:51], s78 offen sc1
    s_mov_b64 exec, -1
    v_cvt_pk_bf16_f32 v64, v48, v49
    v_cvt_pk_bf16_f32 v65, v50, v51
    v_cvt_pk_bf16_f32 v66, v52, v53
    v_cvt_pk_bf16_f32 v67, v54, v55
    s_barrier
    ds_read_b128 v[96:99], v2 offset:9216
    ds_read_b128 v[100:103], v2 offset:10240
    ds_read_b128 v[104:107], v2 offset:11264
    v_mfma_f32_16x16x32_bf16 v[184:187], v[84:87], v[64:67], 0
    s_waitcnt lgkmcnt(2)
    v_mfma_f32_16x16x32_bf16 v[184:187], v[84:87], v[96:99], v[184:187]
    s_waitcnt lgkmcnt(1)
    v_mfma_f32_16x16x32_bf16 v[184:187], v[84:87], v[100:103], v[184:187]
    s_waitcnt lgkmcnt(0)
    v_mfma_f32_16x16x32_bf16 v[184:187], v[84:87], v[104:107], v[184:187]
    s_nop 7
    v_cvt_pk_bf16_f32 v188, v184, v185
    v_cvt_pk_bf16_f32 v192, v186, v187
    s_nop 0
    v_mov_b32_dpp v120, v188 quad_perm:[0,1,2,3] row_mask:0xf bank_mask:0x3
    v_mov_b32_dpp v121, v192 quad_perm:[0,1,2,3] row_mask:0xf bank_mask:0x3
    v_mov_b32_dpp v122, v188 row_ror:8 row_mask:0xf bank_mask:0x3
    v_mov_b32_dpp v123, v192 row_ror:8 row_mask:0xf bank_mask:0x3
    buffer_store_dwordx4 v[120:123], v2, s[48:51], s77 offen sc1
    s_waitcnt vmcnt(0)
    v_mov_b32 v10, 64
    v_mov_b32 v11, 4096
    s_mov_b64 exec, 1
    buffer_store_dword v10, v11, s[48:51], s78 offen sc1
    s_mov_b64 exec, -1
    s_branch L_chain_done
L_chain_done:
    s_endpgm
L_worker:
    s_lshr_b32 s60, s6, 3
    s_and_b32 s61, s6, 7
    s_lshl_b32 s62, s47, 3
    s_add_u32 s62, s62, s61
    v_lshlrev_b32 v1, 4, v0
    s_mov_b32 s63, 0
    s_mov_b32 s64, 0
    s_mov_b32 s65, 0
    s_lshl_b32 s68, s62, 7
    s_lshl_b32 s69, s4, 4
    s_add_u32 s68, s68, s69
    s_lshl_b32 s69, s60, 2
    s_add_u32 s68, s68, s69
    s_add_u32 s68, s68, 3145728
    s_lshl_b32 s69, s47, 2
    s_add_u32 s69, s69, s4
    s_lshl_b32 s69, s69, 7
    s_lshl_b32 s70, s61, 2
    s_add_u32 s69, s69, s70
    s_add_u32 s69, s69, 3153920
    s_cmp_eq_u32 s60, 2
    s_cselect_b32 s68, s69, s68
    s_add_u32 s69, s70, s4
    s_lshl_b32 s69, s69, 7
    s_lshl_b32 s70, s47, 2
    s_add_u32 s69, s69, s70
    s_add_u32 s69, s69, 3162112
    s_cmp_eq_u32 s60, 3
    s_cselect_b32 s68, s69, s68
    s_cselect_b32 s70, s47, -1
    s_cmp_eq_u32 s70, s4
    s_cselect_b32 s70, -1, 0
    v_mov_b32 v3, s70
    v_mov_b32 v4, 0
    s_mov_b64 exec, 1
    buffer_store_dword v3, v4, s[48:51], s68 offen sc1
    s_mov_b64 exec, -1
Lw_noclr:
    s_cmp_lt_u32 s60, 2
    s_cbranch_scc1 Lw_nopoi
    s_lshl_b32 s69, s47, 7
    s_lshl_b32 s70, s6, 2
    s_add_u32 s69, s69, s70
    s_add_u32 s69, s69, s4
    s_cmp_eq_u32 s69, 96
    s_cbranch_scc0 Lw_noprobe
    v_mov_b32 v3, 0
    s_mov_b32 s74, -1
    s_mov_b32 s75, -1
    s_mov_b32 s76, 0
    s_mov_b64 exec, 1
Lp_loop:
    s_mov_b32 s77, 167772160
    s_memtime s[78:79]
    s_waitcnt lgkmcnt(0)
    buffer_store_dword v3, v3, s[48:51], s77 offen sc1
    s_waitcnt vmcnt(0)
    s_memtime s[80:81]
    s_waitcnt lgkmcnt(0)
    s_sub_u32 s80, s80, s78
    s_min_u32 s74, s74, s80
    s_mov_b32 s77, 167780352
    s_memtime s[78:79]
    s_waitcnt lgkmcnt(0)
    buffer_store_dword v3, v3, s[48:51], s77 offen sc1
    s_waitcnt vmcnt(0)
    s_memtime s[80:81]
    s_waitcnt lgkmcnt(0)
    s_sub_u32 s80, s80, s78
    s_min_u32 s75, s75, s80
    s_add_u32 s76, s76, 1
    s_cmp_lt_u32 s76, 4
    s_cbranch_scc1 Lp_loop
    s_cmp_gt_u32 s75, s74
    s_cselect_b32 s76, 3, 2
    v_mov_b32 v4, s76
    global_store_dword v3, v4, s[42:43] offset:8 sc1
    s_waitcnt vmcnt(0)
    s_mov_b64 exec, -1
Lw_noprobe:
    s_barrier
    v_mov_b32 v3, 0
sel_12:
    global_load_dword v4, v3, s[42:43] offset:8 sc1
    s_waitcnt vmcnt(0)
    v_readfirstlane_b32 s64, v4
    s_nop 0
    s_cmp_lg_u32 s64, 0
    s_cbranch_scc1 selok_13
    s_sub_u32 s46, s46, 1
    s_cbranch_scc0 sel_12
    s_mov_b32 s46, 0
    s_branch selok_13
selok_13:
    s_and_b32 s64, s64, 1
    s_lshl_b32 s70, s47, 4
    s_add_u32 s70, s70, s6
    s_sub_u32 s70, s70, 16
    s_lshr_b32 s69, s70, 3
    s_xor_b32 s69, s69, s64
    s_and_b32 s69, s69, 1
    s_lshl_b32 s69, s69, 13
    s_lshl_b32 s71, s70, 18
    s_add_u32 s71, s71, s69
    s_add_u32 s71, s71, 134217728
    s_lshl_b32 s69, s4, 16
    s_add_u32 s71, s71, s69
    v_mov_b32 v16, -1
    v_mov_b32 v17, -1
    v_mov_b32 v18, -1
    v_mov_b32 v19, -1
    s_add_u32 s69, s71, 0
    buffer_store_dwordx4 v[16:19], v1, s[48:51], s69 offen offset:0 sc1
    buffer_store_dwordx4 v[16:19], v1, s[48:51], s69 offen offset:1024 sc1
    buffer_store_dwordx4 v[16:19], v1, s[48:51], s69 offen offset:2048 sc1
    buffer_store_dwordx4 v[16:19], v1, s[48:51], s69 offen offset:3072 sc1
    s_add_u32 s69, s71, 4096
    buffer_store_dwordx4 v[16:19], v1, s[48:51], s69 offen offset:0 sc1
    buffer_store_dwordx4 v[16:19], v1, s[48:51], s69 offen offset:1024 sc1
    buffer_store_dwordx4 v[16:19], v1, s[48:51], s69 offen offset:2048 sc1
    buffer_store_dwordx4 v[16:19], v1, s[48:51], s69 offen offset:3072 sc1
    s_add_u32 s69, s71, 16384
    buffer_store_dwordx4 v[16:19], v1, s[48:51], s69 offen offset:0 sc1
    buffer_store_dwordx4 v[16:19], v1, s[48:51], s69 offen offset:1024 sc1
    buffer_store_dwordx4 v[16:19], v1, s[48:51], s69 offen offset:2048 sc1
    buffer_store_dwordx4 v[16:19], v1, s[48:51], s69 offen offset:3072 sc1
    s_add_u32 s69, s71, 20480
    buffer_store_dwordx4 v[16:19], v1, s[48:51], s69 offen offset:0 sc1
    buffer_store_dwordx4 v[16:19], v1, s[48:51], s69 offen offset:1024 sc1
    buffer_store_dwordx4 v[16:19], v1, s[48:51], s69 offen offset:2048 sc1
    buffer_store_dwordx4 v[16:19], v1, s[48:51], s69 offen offset:3072 sc1
    s_add_u32 s69, s71, 32768
    buffer_store_dwordx4 v[16:19], v1, s[48:51], s69 offen offset:0 sc1
    buffer_store_dwordx4 v[16:19], v1, s[48:51], s69 offen offset:1024 sc1
    buffer_store_dwordx4 v[16:19], v1, s[48:51], s69 offen offset:2048 sc1
    buffer_store_dwordx4 v[16:19], v1, s[48:51], s69 offen offset:3072 sc1
    s_add_u32 s69, s71, 36864
    buffer_store_dwordx4 v[16:19], v1, s[48:51], s69 offen offset:0 sc1
    buffer_store_dwordx4 v[16:19], v1, s[48:51], s69 offen offset:1024 sc1
    buffer_store_dwordx4 v[16:19], v1, s[48:51], s69 offen offset:2048 sc1
    buffer_store_dwordx4 v[16:19], v1, s[48:51], s69 offen offset:3072 sc1
    s_add_u32 s69, s71, 49152
    buffer_store_dwordx4 v[16:19], v1, s[48:51], s69 offen offset:0 sc1
    buffer_store_dwordx4 v[16:19], v1, s[48:51], s69 offen offset:1024 sc1
    buffer_store_dwordx4 v[16:19], v1, s[48:51], s69 offen offset:2048 sc1
    buffer_store_dwordx4 v[16:19], v1, s[48:51], s69 offen offset:3072 sc1
    s_add_u32 s69, s71, 53248
    buffer_store_dwordx4 v[16:19], v1, s[48:51], s69 offen offset:0 sc1
    buffer_store_dwordx4 v[16:19], v1, s[48:51], s69 offen offset:1024 sc1
    buffer_store_dwordx4 v[16:19], v1, s[48:51], s69 offen offset:2048 sc1
    buffer_store_dwordx4 v[16:19], v1, s[48:51], s69 offen offset:3072 sc1
Lw_nopoi:
    s_mov_b32 s56, s8
    s_and_b32 s57, s9, 0xffff
    s_mov_b32 s58, 4194304
    s_mov_b32 s59, 0x20000
    v_lshrrev_b32 v3, 3, v0
    s_lshl_b32 s69, s4, 3
    v_add_u32 v3, s69, v3
    v_bfe_u32 v4, v3, 1, 3
    v_and_b32 v2, 7, v0
    v_xor_b32 v2, v2, v4
    v_lshlrev_b32 v2, 4, v2
    v_lshl_add_u32 v2, v3, 11, v2
    v_and_b32 v3, 31, v0
    v_lshlrev_b32 v5, 7, v3
    v_bfe_u32 v4, v3, 1, 3
    v_lshrrev_b32 v3, 5, v0
    v_add_u32 v6, 0, v3
    v_xor_b32 v6, v6, v4
    v_lshl_add_u32 v8, v6, 4, v5
    v_add_u32 v12, 0x10000, v8
    v_add_u32 v6, 2, v3
    v_xor_b32 v6, v6, v4
    v_lshl_add_u32 v9, v6, 4, v5
    v_add_u32 v13, 0x10000, v9
    v_add_u32 v6, 4, v3
    v_xor_b32 v6, v6, v4
    v_lshl_add_u32 v10, v6, 4, v5
    v_add_u32 v14, 0x10000, v10
    v_add_u32 v6, 6, v3
    v_xor_b32 v6, v6, v4
    v_lshl_add_u32 v11, v6, 4, v5
    v_add_u32 v15, 0x10000, v11
    s_lshl_b32 s66, s4, 10
    s_cmp_eq_u32 s60, 3
    s_cbranch_scc1 Lw_nox
    s_add_u32 m0, s66, 0
    s_nop 0
    buffer_load_dwordx4 v2, s[56:59], s65 offen offset:0 lds
    s_add_u32 m0, s66, 3968
    s_nop 0
    buffer_load_dwordx4 v2, s[56:59], s65 offen offset:128 lds
    s_add_u32 m0, s66, 7936
    s_nop 0
    buffer_load_dwordx4 v2, s[56:59], s65 offen offset:256 lds
    s_add_u32 m0, s66, 11904
    s_nop 0
    buffer_load_dwordx4 v2, s[56:59], s65 offen offset:384 lds
    s_add_u32 m0, s66, 15872
    s_nop 0
    buffer_load_dwordx4 v2, s[56:59], s65 offen offset:512 lds
    s_add_u32 m0, s66, 19840
    s_nop 0
    buffer_load_dwordx4 v2, s[56:59], s65 offen offset:640 lds
    s_add_u32 m0, s66, 23808
    s_nop 0
    buffer_load_dwordx4 v2, s[56:59], s65 offen offset:768 lds
    s_add_u32 m0, s66, 27776
    s_nop 0
    buffer_load_dwordx4 v2, s[56:59], s65 offen offset:896 lds
    s_add_u32 m0, s66, 31744
    s_nop 0
    buffer_load_dwordx4 v2, s[56:59], s65 offen offset:1024 lds
    s_add_u32 m0, s66, 35712
    s_nop 0
    buffer_load_dwordx4 v2, s[56:59], s65 offen offset:1152 lds
    s_add_u32 m0, s66, 39680
    s_nop 0
    buffer_load_dwordx4 v2, s[56:59], s65 offen offset:1280 lds
    s_add_u32 m0, s66, 43648
    s_nop 0
    buffer_load_dwordx4 v2, s[56:59], s65 offen offset:1408 lds
    s_add_u32 m0, s66, 47616
    s_nop 0
    buffer_load_dwordx4 v2, s[56:59], s65 offen offset:1536 lds
    s_add_u32 m0, s66, 51584
    s_nop 0
    buffer_load_dwordx4 v2, s[56:59], s65 offen offset:1664 lds
    s_add_u32 m0, s66, 55552
    s_nop 0
    buffer_load_dwordx4 v2, s[56:59], s65 offen offset:1792 lds
    s_add_u32 m0, s66, 59520
    s_nop 0
    buffer_load_dwordx4 v2, s[56:59], s65 offen offset:1920 lds
Lw_nox:
    s_mov_b32 s65, 0x10000
    s_cmp_eq_u32 s60, 0
    s_cselect_b64 s[74:75], s[14:15], s[16:17]
    s_cmp_eq_u32 s60, 2
    s_cselect_b64 s[74:75], s[12:13], s[74:75]
    s_lshl_b32 s70, s62, 8
    s_lshl_b32 s69, s47, 21
    s_lshl_b32 s71, s61, 8
    s_add_u32 s69, s69, s71
    s_cmp_eq_u32 s60, 3
    s_cselect_b64 s[74:75], s[18:19], s[74:75]
    s_cselect_b32 s70, s69, s70
    s_cselect_b32 s71, 11, 13
    s_lshl_b32 s69, s4, 6
    s_add_u32 s70, s70, s69
    s_mov_b32 s52, s74
    s_and_b32 s53, s75, 0xffff
    s_mov_b32 s54, 8388608
    s_mov_b32 s55, 0x20000
    v_lshrrev_b32 v3, 2, v0
    v_lshlrev_b32 v3, s71, v3
    v_and_b32 v4, 3, v0
    v_lshl_add_u32 v16, v4, 4, v3
    v_lshrrev_b32 v3, 5, v0
    v_bfe_u32 v4, v0, 2, 2
    v_lshl_add_u32 v3, v3, 3, v4
    v_lshlrev_b32 v17, 6, v3
    v_bfe_u32 v3, v0, 4, 1
    v_lshl_add_u32 v17, v3, 5, v17
    v_and_b32 v3, 1, v0
    v_lshl_add_u32 v17, v3, 4, v17
    v_bfe_u32 v3, v0, 1, 1
    v_lshl_add_u32 v17, v3, 3, v17
    s_mul_i32 s66, s4, 24576
    s_add_u32 s66, s66, 65536
    v_add_u32 v17, s66, v17
    s_lshl_b32 s67, 16, s71
    s_add_u32 m0, s66, 0
    s_nop 0
    buffer_load_dwordx4 v16, s[52:55], s70 offen lds
    s_add_u32 s70, s70, s67
    s_add_u32 m0, s66, 1024
    s_nop 0
    buffer_load_dwordx4 v16, s[52:55], s70 offen lds
    s_add_u32 s70, s70, s67
    s_add_u32 m0, s66, 2048
    s_nop 0
    buffer_load_dwordx4 v16, s[52:55], s70 offen lds
    s_add_u32 s70, s70, s67
    s_add_u32 m0, s66, 3072
    s_nop 0
    buffer_load_dwordx4 v16, s[52:55], s70 offen lds
    s_add_u32 s70, s70, s67
    s_add_u32 m0, s66, 4096
    s_nop 0
    buffer_load_dwordx4 v16, s[52:55], s70 offen lds
    s_add_u32 s70, s70, s67
    s_add_u32 m0, s66, 5120
    s_nop 0
    buffer_load_dwordx4 v16, s[52:55], s70 offen lds
    s_add_u32 s70, s70, s67
    s_add_u32 m0, s66, 6144
    s_nop 0
    buffer_load_dwordx4 v16, s[52:55], s70 offen lds
    s_add_u32 s70, s70, s67
    s_add_u32 m0, s66, 7168
    s_nop 0
    buffer_load_dwordx4 v16, s[52:55], s70 offen lds
    s_add_u32 s70, s70, s67
    s_add_u32 m0, s66, 8192
    s_nop 0
    buffer_load_dwordx4 v16, s[52:55], s70 offen lds
    s_add_u32 s70, s70, s67
    s_add_u32 m0, s66, 9216
    s_nop 0
    buffer_load_dwordx4 v16, s[52:55], s70 offen lds
    s_add_u32 s70, s70, s67
    s_add_u32 m0, s66, 10240
    s_nop 0
    buffer_load_dwordx4 v16, s[52:55], s70 offen lds
    s_add_u32 s70, s70, s67
    s_add_u32 m0, s66, 11264
    s_nop 0
    buffer_load_dwordx4 v16, s[52:55], s70 offen lds
    s_add_u32 s70, s70, s67
    s_add_u32 m0, s66, 12288
    s_nop 0
    buffer_load_dwordx4 v16, s[52:55], s70 offen lds
    s_add_u32 s70, s70, s67
    s_add_u32 m0, s66, 13312
    s_nop 0
    buffer_load_dwordx4 v16, s[52:55], s70 offen lds
    s_add_u32 s70, s70, s67
    s_add_u32 m0, s66, 14336
    s_nop 0
    buffer_load_dwordx4 v16, s[52:55], s70 offen lds
    s_add_u32 s70, s70, s67
    s_add_u32 m0, s66, 15360
    s_nop 0
    buffer_load_dwordx4 v16, s[52:55], s70 offen lds
    s_add_u32 s70, s70, s67
    s_add_u32 m0, s66, 16384
    s_nop 0
    buffer_load_dwordx4 v16, s[52:55], s70 offen lds
    s_add_u32 s70, s70, s67
    s_add_u32 m0, s66, 17408
    s_nop 0
    buffer_load_dwordx4 v16, s[52:55], s70 offen lds
    s_add_u32 s70, s70, s67
    s_add_u32 m0, s66, 18432
    s_nop 0
    buffer_load_dwordx4 v16, s[52:55], s70 offen lds
    s_add_u32 s70, s70, s67
    s_add_u32 m0, s66, 19456
    s_nop 0
    buffer_load_dwordx4 v16, s[52:55], s70 offen lds
    s_add_u32 s70, s70, s67
    s_add_u32 m0, s66, 20480
    s_nop 0
    buffer_load_dwordx4 v16, s[52:55], s70 offen lds
    s_add_u32 s70, s70, s67
    s_add_u32 m0, s66, 21504
    s_nop 0
    buffer_load_dwordx4 v16, s[52:55], s70 offen lds
    s_add_u32 s70, s70, s67
    s_add_u32 m0, s66, 22528
    s_nop 0
    buffer_load_dwordx4 v16, s[52:55], s70 offen lds
    s_add_u32 s70, s70, s67
    s_add_u32 m0, s66, 23552
    s_nop 0
    buffer_load_dwordx4 v16, s[52:55], s70 offen lds
    s_add_u32 s70, s70, s67
    s_waitcnt vmcnt(20)
    s_barrier
    s_cmp_eq_u32 s4, 0
    s_cbranch_scc0 Lw_nosig
    s_lshl_b32 s7, s5, 5
    v_mov_b32 v3, s7
    v_mov_b32 v4, 1
    s_mov_b64 exec, 1
    global_atomic_add v3, v4, s[42:43] offset:4 sc1
    s_mov_b64 exec, -1
Lw_nosig:
    ds_read_b64_tr_b16 a[0:1], v17 offset:0
    ds_read_b64_tr_b16 a[2:3], v17 offset:256
    ds_read_b64_tr_b16 a[4:5], v17 offset:1024
    ds_read_b64_tr_b16 a[6:7], v17 offset:1280
    ds_read_b64_tr_b16 a[8:9], v17 offset:2048
    ds_read_b64_tr_b16 a[10:11], v17 offset:2304
    ds_read_b64_tr_b16 a[12:13], v17 offset:3072
    ds_read_b64_tr_b16 a[14:15], v17 offset:3328
    s_waitcnt lgkmcnt(0)
    s_add_u32 m0, s66, 0
    s_nop 0
    buffer_load_dwordx4 v16, s[52:55], s70 offen lds
    s_add_u32 s70, s70, s67
    s_add_u32 m0, s66, 1024
    s_nop 0
    buffer_load_dwordx4 v16, s[52:55], s70 offen lds
    s_add_u32 s70, s70, s67
    s_add_u32 m0, s66, 2048
    s_nop 0
    buffer_load_dwordx4 v16, s[52:55], s70 offen lds
    s_add_u32 s70, s70, s67
    s_add_u32 m0, s66, 3072
    s_nop 0
    buffer_load_dwordx4 v16, s[52:55], s70 offen lds
    s_add_u32 s70, s70, s67
    s_waitcnt vmcnt(20)
    ds_read_b64_tr_b16 a[16:17], v17 offset:4096
    ds_read_b64_tr_b16 a[18:19], v17 offset:4352
    ds_read_b64_tr_b16 a[20:21], v17 offset:5120
    ds_read_b64_tr_b16 a[22:23], v17 offset:5376
    ds_read_b64_tr_b16 a[24:25], v17 offset:6144
    ds_read_b64_tr_b16 a[26:27], v17 offset:6400
    ds_read_b64_tr_b16 a[28:29], v17 offset:7168
    ds_read_b64_tr_b16 a[30:31], v17 offset:7424
    s_waitcnt lgkmcnt(0)
    s_add_u32 m0, s66, 4096
    s_nop 0
    buffer_load_dwordx4 v16, s[52:55], s70 offen lds
    s_add_u32 s70, s70, s67
    s_add_u32 m0, s66, 5120
    s_nop 0
    buffer_load_dwordx4 v16, s[52:55], s70 offen lds
    s_add_u32 s70, s70, s67
    s_add_u32 m0, s66, 6144
    s_nop 0
    buffer_load_dwordx4 v16, s[52:55], s70 offen lds
    s_add_u32 s70, s70, s67
    s_add_u32 m0, s66, 7168
    s_nop 0
    buffer_load_dwordx4 v16, s[52:55], s70 offen lds
    s_add_u32 s70, s70, s67
    s_waitcnt vmcnt(20)
    ds_read_b64_tr_b16 a[32:33], v17 offset:8192
    ds_read_b64_tr_b16 a[34:35], v17 offset:8448
    ds_read_b64_tr_b16 a[36:37], v17 offset:9216
    ds_read_b64_tr_b16 a[38:39], v17 offset:9472
    ds_read_b64_tr_b16 a[40:41], v17 offset:10240
    ds_read_b64_tr_b16 a[42:43], v17 offset:10496
    ds_read_b64_tr_b16 a[44:45], v17 offset:11264
    ds_read_b64_tr_b16 a[46:47], v17 offset:11520
    s_waitcnt lgkmcnt(0)
    s_add_u32 m0, s66, 8192
    s_nop 0
    buffer_load_dwordx4 v16, s[52:55], s70 offen lds
    s_add_u32 s70, s70, s67
    s_add_u32 m0, s66, 9216
    s_nop 0
    buffer_load_dwordx4 v16, s[52:55], s70 offen lds
    s_add_u32 s70, s70, s67
    s_add_u32 m0, s66, 10240
    s_nop 0
    buffer_load_dwordx4 v16, s[52:55], s70 offen lds
    s_add_u32 s70, s70, s67
    s_add_u32 m0, s66, 11264
    s_nop 0
    buffer_load_dwordx4 v16, s[52:55], s70 offen lds
    s_add_u32 s70, s70, s67
    s_waitcnt vmcnt(20)
    ds_read_b64_tr_b16 a[48:49], v17 offset:12288
    ds_read_b64_tr_b16 a[50:51], v17 offset:12544
    ds_read_b64_tr_b16 a[52:53], v17 offset:13312
    ds_read_b64_tr_b16 a[54:55], v17 offset:13568
    ds_read_b64_tr_b16 a[56:57], v17 offset:14336
    ds_read_b64_tr_b16 a[58:59], v17 offset:14592
    ds_read_b64_tr_b16 a[60:61], v17 offset:15360
    ds_read_b64_tr_b16 a[62:63], v17 offset:15616
    s_waitcnt lgkmcnt(0)
    s_add_u32 m0, s66, 12288
    s_nop 0
    buffer_load_dwordx4 v16, s[52:55], s70 offen lds
    s_add_u32 s70, s70, s67
    s_add_u32 m0, s66, 13312
    s_nop 0
    buffer_load_dwordx4 v16, s[52:55], s70 offen lds
    s_add_u32 s70, s70, s67
    s_add_u32 m0, s66, 14336
    s_nop 0
    buffer_load_dwordx4 v16, s[52:55], s70 offen lds
    s_add_u32 s70, s70, s67
    s_add_u32 m0, s66, 15360
    s_nop 0
    buffer_load_dwordx4 v16, s[52:55], s70 offen lds
    s_add_u32 s70, s70, s67
    s_waitcnt vmcnt(20)
    ds_read_b64_tr_b16 a[64:65], v17 offset:16384
    ds_read_b64_tr_b16 a[66:67], v17 offset:16640
    ds_read_b64_tr_b16 a[68:69], v17 offset:17408
    ds_read_b64_tr_b16 a[70:71], v17 offset:17664
    ds_read_b64_tr_b16 a[72:73], v17 offset:18432
    ds_read_b64_tr_b16 a[74:75], v17 offset:18688
    ds_read_b64_tr_b16 a[76:77], v17 offset:19456
    ds_read_b64_tr_b16 a[78:79], v17 offset:19712
    s_waitcnt lgkmcnt(0)
    s_add_u32 m0, s66, 16384
    s_nop 0
    buffer_load_dwordx4 v16, s[52:55], s70 offen lds
    s_add_u32 s70, s70, s67
    s_add_u32 m0, s66, 17408
    s_nop 0
    buffer_load_dwordx4 v16, s[52:55], s70 offen lds
    s_add_u32 s70, s70, s67
    s_add_u32 m0, s66, 18432
    s_nop 0
    buffer_load_dwordx4 v16, s[52:55], s70 offen lds
    s_add_u32 s70, s70, s67
    s_add_u32 m0, s66, 19456
    s_nop 0
    buffer_load_dwordx4 v16, s[52:55], s70 offen lds
    s_add_u32 s70, s70, s67
    s_waitcnt vmcnt(20)
    ds_read_b64_tr_b16 a[80:81], v17 offset:20480
    ds_read_b64_tr_b16 a[82:83], v17 offset:20736
    ds_read_b64_tr_b16 a[84:85], v17 offset:21504
    ds_read_b64_tr_b16 a[86:87], v17 offset:21760
    ds_read_b64_tr_b16 a[88:89], v17 offset:22528
    ds_read_b64_tr_b16 a[90:91], v17 offset:22784
    ds_read_b64_tr_b16 a[92:93], v17 offset:23552
    ds_read_b64_tr_b16 a[94:95], v17 offset:23808
    s_waitcnt lgkmcnt(0)
    s_add_u32 m0, s66, 20480
    s_nop 0
    buffer_load_dwordx4 v16, s[52:55], s70 offen lds
    s_add_u32 s70, s70, s67
    s_add_u32 m0, s66, 21504
    s_nop 0
    buffer_load_dwordx4 v16, s[52:55], s70 offen lds
    s_add_u32 s70, s70, s67
    s_add_u32 m0, s66, 22528
    s_nop 0
    buffer_load_dwordx4 v16, s[52:55], s70 offen lds
    s_add_u32 s70, s70, s67
    s_add_u32 m0, s66, 23552
    s_nop 0
    buffer_load_dwordx4 v16, s[52:55], s70 offen lds
    s_add_u32 s70, s70, s67
    s_waitcnt vmcnt(20)
    ds_read_b64_tr_b16 a[96:97], v17 offset:0
    ds_read_b64_tr_b16 a[98:99], v17 offset:256
    ds_read_b64_tr_b16 a[100:101], v17 offset:1024
    ds_read_b64_tr_b16 a[102:103], v17 offset:1280
    ds_read_b64_tr_b16 a[104:105], v17 offset:2048
    ds_read_b64_tr_b16 a[106:107], v17 offset:2304
    ds_read_b64_tr_b16 a[108:109], v17 offset:3072
    ds_read_b64_tr_b16 a[110:111], v17 offset:3328
    s_waitcnt lgkmcnt(0)
    s_add_u32 m0, s66, 0
    s_nop 0
    buffer_load_dwordx4 v16, s[52:55], s70 offen lds
    s_add_u32 s70, s70, s67
    s_add_u32 m0, s66, 1024
    s_nop 0
    buffer_load_dwordx4 v16, s[52:55], s70 offen lds
    s_add_u32 s70, s70, s67
    s_add_u32 m0, s66, 2048
    s_nop 0
    buffer_load_dwordx4 v16, s[52:55], s70 offen lds
    s_add_u32 s70, s70, s67
    s_add_u32 m0, s66, 3072
    s_nop 0
    buffer_load_dwordx4 v16, s[52:55], s70 offen lds
    s_add_u32 s70, s70, s67
    s_waitcnt vmcnt(20)
    ds_read_b64_tr_b16 a[112:113], v17 offset:4096
    ds_read_b64_tr_b16 a[114:115], v17 offset:4352
    ds_read_b64_tr_b16 a[116:117], v17 offset:5120
    ds_read_b64_tr_b16 a[118:119], v17 offset:5376
    ds_read_b64_tr_b16 a[120:121], v17 offset:6144
    ds_read_b64_tr_b16 a[122:123], v17 offset:6400
    ds_read_b64_tr_b16 a[124:125], v17 offset:7168
    ds_read_b64_tr_b16 a[126:127], v17 offset:7424
    s_waitcnt lgkmcnt(0)
    s_add_u32 m0, s66, 4096
    s_nop 0
    buffer_load_dwordx4 v16, s[52:55], s70 offen lds
    s_add_u32 s70, s70, s67
    s_add_u32 m0, s66, 5120
    s_nop 0
    buffer_load_dwordx4 v16, s[52:55], s70 offen lds
    s_add_u32 s70, s70, s67
    s_add_u32 m0, s66, 6144
    s_nop 0
    buffer_load_dwordx4 v16, s[52:55], s70 offen lds
    s_add_u32 s70, s70, s67
    s_add_u32 m0, s66, 7168
    s_nop 0
    buffer_load_dwordx4 v16, s[52:55], s70 offen lds
    s_add_u32 s70, s70, s67
    s_waitcnt vmcnt(20)
    ds_read_b64_tr_b16 a[128:129], v17 offset:8192
    ds_read_b64_tr_b16 a[130:131], v17 offset:8448
    ds_read_b64_tr_b16 a[132:133], v17 offset:9216
    ds_read_b64_tr_b16 a[134:135], v17 offset:9472
    ds_read_b64_tr_b16 a[136:137], v17 offset:10240
    ds_read_b64_tr_b16 a[138:139], v17 offset:10496
    ds_read_b64_tr_b16 a[140:141], v17 offset:11264
    ds_read_b64_tr_b16 a[142:143], v17 offset:11520
    s_waitcnt lgkmcnt(0)
    s_add_u32 m0, s66, 8192
    s_nop 0
    buffer_load_dwordx4 v16, s[52:55], s70 offen lds
    s_add_u32 s70, s70, s67
    s_add_u32 m0, s66, 9216
    s_nop 0
    buffer_load_dwordx4 v16, s[52:55], s70 offen lds
    s_add_u32 s70, s70, s67
    s_add_u32 m0, s66, 10240
    s_nop 0
    buffer_load_dwordx4 v16, s[52:55], s70 offen lds
    s_add_u32 s70, s70, s67
    s_add_u32 m0, s66, 11264
    s_nop 0
    buffer_load_dwordx4 v16, s[52:55], s70 offen lds
    s_add_u32 s70, s70, s67
    s_waitcnt vmcnt(20)
    ds_read_b64_tr_b16 a[144:145], v17 offset:12288
    ds_read_b64_tr_b16 a[146:147], v17 offset:12544
    ds_read_b64_tr_b16 a[148:149], v17 offset:13312
    ds_read_b64_tr_b16 a[150:151], v17 offset:13568
    ds_read_b64_tr_b16 a[152:153], v17 offset:14336
    ds_read_b64_tr_b16 a[154:155], v17 offset:14592
    ds_read_b64_tr_b16 a[156:157], v17 offset:15360
    ds_read_b64_tr_b16 a[158:159], v17 offset:15616
    s_waitcnt lgkmcnt(0)
    s_add_u32 m0, s66, 12288
    s_nop 0
    buffer_load_dwordx4 v16, s[52:55], s70 offen lds
    s_add_u32 s70, s70, s67
    s_add_u32 m0, s66, 13312
    s_nop 0
    buffer_load_dwordx4 v16, s[52:55], s70 offen lds
    s_add_u32 s70, s70, s67
    s_add_u32 m0, s66, 14336
    s_nop 0
    buffer_load_dwordx4 v16, s[52:55], s70 offen lds
    s_add_u32 s70, s70, s67
    s_add_u32 m0, s66, 15360
    s_nop 0
    buffer_load_dwordx4 v16, s[52:55], s70 offen lds
    s_add_u32 s70, s70, s67
    s_waitcnt vmcnt(20)
    ds_read_b64_tr_b16 a[160:161], v17 offset:16384
    ds_read_b64_tr_b16 a[162:163], v17 offset:16640
    ds_read_b64_tr_b16 a[164:165], v17 offset:17408
    ds_read_b64_tr_b16 a[166:167], v17 offset:17664
    ds_read_b64_tr_b16 a[168:169], v17 offset:18432
    ds_read_b64_tr_b16 a[170:171], v17 offset:18688
    ds_read_b64_tr_b16 a[172:173], v17 offset:19456
    ds_read_b64_tr_b16 a[174:175], v17 offset:19712
    s_waitcnt vmcnt(16)
    ds_read_b64_tr_b16 a[176:177], v17 offset:20480
    ds_read_b64_tr_b16 a[178:179], v17 offset:20736
    ds_read_b64_tr_b16 a[180:181], v17 offset:21504
    ds_read_b64_tr_b16 a[182:183], v17 offset:21760
    ds_read_b64_tr_b16 a[184:185], v17 offset:22528
    ds_read_b64_tr_b16 a[186:187], v17 offset:22784
    ds_read_b64_tr_b16 a[188:189], v17 offset:23552
    ds_read_b64_tr_b16 a[190:191], v17 offset:23808
    s_waitcnt vmcnt(12)
    ds_read_b64_tr_b16 a[192:193], v17 offset:0
    ds_read_b64_tr_b16 a[194:195], v17 offset:256
    ds_read_b64_tr_b16 a[196:197], v17 offset:1024
    ds_read_b64_tr_b16 a[198:199], v17 offset:1280
    ds_read_b64_tr_b16 a[200:201], v17 offset:2048
    ds_read_b64_tr_b16 a[202:203], v17 offset:2304
    ds_read_b64_tr_b16 a[204:205], v17 offset:3072
    ds_read_b64_tr_b16 a[206:207], v17 offset:3328
    s_waitcnt vmcnt(8)
    ds_read_b64_tr_b16 a[208:209], v17 offset:4096
    ds_read_b64_tr_b16 a[210:211], v17 offset:4352
    ds_read_b64_tr_b16 a[212:213], v17 offset:5120
    ds_read_b64_tr_b16 a[214:215], v17 offset:5376
    ds_read_b64_tr_b16 a[216:217], v17 offset:6144
    ds_read_b64_tr_b16 a[218:219], v17 offset:6400
    ds_read_b64_tr_b16 a[220:221], v17 offset:7168
    ds_read_b64_tr_b16 a[222:223], v17 offset:7424
    s_waitcnt vmcnt(4)
    ds_read_b64_tr_b16 a[224:225], v17 offset:8192
    ds_read_b64_tr_b16 a[226:227], v17 offset:8448
    ds_read_b64_tr_b16 a[228:229], v17 offset:9216
    ds_read_b64_tr_b16 a[230:231], v17 offset:9472
    ds_read_b64_tr_b16 a[232:233], v17 offset:10240
    ds_read_b64_tr_b16 a[234:235], v17 offset:10496
    ds_read_b64_tr_b16 a[236:237], v17 offset:11264
    ds_read_b64_tr_b16 a[238:239], v17 offset:11520
    s_waitcnt vmcnt(0)
    ds_read_b64_tr_b16 a[240:241], v17 offset:12288
    ds_read_b64_tr_b16 a[242:243], v17 offset:12544
    ds_read_b64_tr_b16 a[244:245], v17 offset:13312
    ds_read_b64_tr_b16 a[246:247], v17 offset:13568
    ds_read_b64_tr_b16 a[248:249], v17 offset:14336
    ds_read_b64_tr_b16 a[250:251], v17 offset:14592
    ds_read_b64_tr_b16 a[252:253], v17 offset:15360
    ds_read_b64_tr_b16 a[254:255], v17 offset:15616
    s_waitcnt lgkmcnt(0)
    s_lshl_b32 s66, s4, 10
    s_cmp_lt_u32 s60, 2
    s_cbranch_scc1 Lw_go
    v_and_b32 v3, 7, v0
    v_lshlrev_b32 v3, 5, v3
rdy_14:
    global_load_dwordx2 v[16:17], v3, s[42:43] offset:4 sc1
    s_waitcnt vmcnt(0)
    v_cmp_ne_u32 vcc, 32, v16
    s_cbranch_vccz rdyok_15
    s_sub_u32 s46, s46, 1
    s_cbranch_scc0 rdy_14
    s_mov_b32 s46, 0
    s_branch rdyok_15
rdyok_15:
Lw_go:
    s_barrier
    s_cmp_eq_u32 s60, 0
    s_cbranch_scc1 Lw_K
    s_cmp_eq_u32 s60, 1
    s_cbranch_scc1 Lw_V
    s_cmp_eq_u32 s60, 2
    s_cbranch_scc1 Lw_Q
    s_mov_b32 s56, s40
    s_and_b32 s57, s41, 0xffff
    s_mov_b32 s58, 8388608
    s_mov_b32 s59, 0x20000
    v_mov_b32 v8, v1
    v_add_u32 v12, 0x10000, v1
    v_lshlrev_b32 v5, 2, v0
    v_and_b32 v3, 31, v0
    v_lshrrev_b32 v4, 5, v0
    v_lshlrev_b32 v4, 4, v4
    v_lshl_add_u32 v6, v3, 12, v4
    s_lshl_b32 s74, s47, 9
    s_add_u32 s74, s74, 3153920
    s_lshl_b32 s69, s61, 2
    s_add_u32 s69, s69, s4
    s_lshl_b32 s75, s69, 7
    s_add_u32 s75, s75, 3162112
    s_lshl_b32 s76, s69, 14
    s_add_u32 s76, s76, 100663296
    s_lshl_b32 s67, s69, 6
    s_lshl_b32 s65, s47, 16
    s_lshl_b32 s66, s4, 14
    s_add_u32 s65, s65, s66
    s_add_u32 s65, s65, 67108864
    s_mov_b32 s73, 0
Lw_Oloop:
    s_cmp_eq_u32 s73, 1
    s_cbranch_scc1 have_16
    s_and_b32 s69, s63, 3
    s_lshl_b32 s69, s69, 7
    s_add_u32 s71, s69, s74
    s_lshr_b32 s70, s63, 2
    s_add_u32 s70, s70, 1
    s_mov_b64 exec, 255
w_21:
    buffer_load_dword v4, v5, s[48:51], s71 offen sc1
    s_waitcnt vmcnt(0)
    v_cmp_gt_u32 vcc, s70, v4
    s_cbranch_vccz wok_22
    s_sleep 2
    s_sub_u32 s46, s46, 1
    s_cbranch_scc0 w_21
    s_mov_b32 s46, 0
    s_branch wok_22
wok_22:
    s_mov_b64 exec, -1
    s_add_u32 m0, s66, 0
    s_add_u32 s69, s65, 0
    buffer_load_dwordx4 v1, s[48:51], s69 offen offset:0 sc1 lds
    buffer_load_dwordx4 v1, s[48:51], s69 offen offset:1024 sc1 lds
    buffer_load_dwordx4 v1, s[48:51], s69 offen offset:2048 sc1 lds
    buffer_load_dwordx4 v1, s[48:51], s69 offen offset:3072 sc1 lds
    s_add_u32 m0, s66, 4096
    s_add_u32 s69, s65, 4096
    buffer_load_dwordx4 v1, s[48:51], s69 offen offset:0 sc1 lds
    buffer_load_dwordx4 v1, s[48:51], s69 offen offset:1024 sc1 lds
    buffer_load_dwordx4 v1, s[48:51], s69 offen offset:2048 sc1 lds
    buffer_load_dwordx4 v1, s[48:51], s69 offen offset:3072 sc1 lds
    s_add_u32 m0, s66, 8192
    s_add_u32 s69, s65, 8192
    buffer_load_dwordx4 v1, s[48:51], s69 offen offset:0 sc1 lds
    buffer_load_dwordx4 v1, s[48:51], s69 offen offset:1024 sc1 lds
    buffer_load_dwordx4 v1, s[48:51], s69 offen offset:2048 sc1 lds
    buffer_load_dwordx4 v1, s[48:51], s69 offen offset:3072 sc1 lds
    s_add_u32 m0, s66, 12288
    s_add_u32 s69, s65, 12288
    buffer_load_dwordx4 v1, s[48:51], s69 offen offset:0 sc1 lds
    buffer_load_dwordx4 v1, s[48:51], s69 offen offset:1024 sc1 lds
    buffer_load_dwordx4 v1, s[48:51], s69 offen offset:2048 sc1 lds
    buffer_load_dwordx4 v1, s[48:51], s69 offen offset:3072 sc1 lds
    s_add_u32 s65, s65, 0x40000
have_16:
    s_waitcnt vmcnt(0)
    s_barrier
    s_mov_b32 s73, 0
    s_add_u32 s77, s63, 1
    s_cmp_eq_u32 s77, 64
    s_cbranch_scc1 nopre_17
    s_and_b32 s69, s77, 3
    s_lshl_b32 s69, s69, 7
    s_add_u32 s71, s69, s74
    s_lshr_b32 s70, s77, 2
    s_add_u32 s70, s70, 1
    s_mov_b64 exec, 0xff
    buffer_load_dword v4, v5, s[48:51], s71 offen sc1
    s_waitcnt vmcnt(0)
    v_cmp_gt_u32 vcc, s70, v4
    s_mov_b64 exec, -1
    s_cbranch_vccnz nopre_17
    s_mov_b32 s73, 1
    s_add_u32 m0, s66, 65536
    s_add_u32 s69, s65, 0
    buffer_load_dwordx4 v1, s[48:51], s69 offen offset:0 sc1 lds
    buffer_load_dwordx4 v1, s[48:51], s69 offen offset:1024 sc1 lds
    buffer_load_dwordx4 v1, s[48:51], s69 offen offset:2048 sc1 lds
    buffer_load_dwordx4 v1, s[48:51], s69 offen offset:3072 sc1 lds
    s_add_u32 m0, s66, 69632
    s_add_u32 s69, s65, 4096
    buffer_load_dwordx4 v1, s[48:51], s69 offen offset:0 sc1 lds
    buffer_load_dwordx4 v1, s[48:51], s69 offen offset:1024 sc1 lds
    buffer_load_dwordx4 v1, s[48:51], s69 offen offset:2048 sc1 lds
    buffer_load_dwordx4 v1, s[48:51], s69 offen offset:3072 sc1 lds
    s_add_u32 m0, s66, 73728
    s_add_u32 s69, s65, 8192
    buffer_load_dwordx4 v1, s[48:51], s69 offen offset:0 sc1 lds
    buffer_load_dwordx4 v1, s[48:51], s69 offen offset:1024 sc1 lds
    buffer_load_dwordx4 v1, s[48:51], s69 offen offset:2048 sc1 lds
    buffer_load_dwordx4 v1, s[48:51], s69 offen offset:3072 sc1 lds
    s_add_u32 m0, s66, 77824
    s_add_u32 s69, s65, 12288
    buffer_load_dwordx4 v1, s[48:51], s69 offen offset:0 sc1 lds
    buffer_load_dwordx4 v1, s[48:51], s69 offen offset:1024 sc1 lds
    buffer_load_dwordx4 v1, s[48:51], s69 offen offset:2048 sc1 lds
    buffer_load_dwordx4 v1, s[48:51], s69 offen offset:3072 sc1 lds
    s_add_u32 s65, s65, 0x40000
nopre_17:
    ds_read_b128 v[16:19], v8 offset:0
    ds_read_b128 v[20:23], v8 offset:1024
    ds_read_b128 v[24:27], v8 offset:2048
    ds_read_b128 v[28:31], v8 offset:3072
    ds_read_b128 v[32:35], v8 offset:4096
    s_waitcnt lgkmcnt(4)
    v_mfma_f32_32x32x16_bf16 v[48:63], a[0:3], v[16:19], 0
    ds_read_b128 v[36:39], v8 offset:5120
    s_waitcnt lgkmcnt(4)
    v_mfma_f32_32x32x16_bf16 v[48:63], a[4:7], v[20:23], v[48:63]
    ds_read_b128 v[40:43], v8 offset:6144
    s_waitcnt lgkmcnt(4)
    v_mfma_f32_32x32x16_bf16 v[48:63], a[8:11], v[24:27], v[48:63]
    ds_read_b128 v[44:47], v8 offset:7168
    s_waitcnt lgkmcnt(4)
    v_mfma_f32_32x32x16_bf16 v[48:63], a[12:15], v[28:31], v[48:63]
    ds_read_b128 v[16:19], v8 offset:8192
    s_waitcnt lgkmcnt(4)
    v_mfma_f32_32x32x16_bf16 v[48:63], a[16:19], v[32:35], v[48:63]
    ds_read_b128 v[20:23], v8 offset:9216
    s_waitcnt lgkmcnt(4)
    v_mfma_f32_32x32x16_bf16 v[48:63], a[20:23], v[36:39], v[48:63]
    ds_read_b128 v[24:27], v8 offset:10240
    s_waitcnt lgkmcnt(4)
    v_mfma_f32_32x32x16_bf16 v[48:63], a[24:27], v[40:43], v[48:63]
    ds_read_b128 v[28:31], v8 offset:11264
    s_waitcnt lgkmcnt(4)
    v_mfma_f32_32x32x16_bf16 v[48:63], a[28:31], v[44:47], v[48:63]
    ds_read_b128 v[32:35], v8 offset:12288
    s_waitcnt lgkmcnt(4)
    v_mfma_f32_32x32x16_bf16 v[48:63], a[32:35], v[16:19], v[48:63]
    ds_read_b128 v[36:39], v8 offset:13312
    s_waitcnt lgkmcnt(4)
    v_mfma_f32_32x32x16_bf16 v[48:63], a[36:39], v[20:23], v[48:63]
    ds_read_b128 v[40:43], v8 offset:14336
    s_waitcnt lgkmcnt(4)
    v_mfma_f32_32x32x16_bf16 v[48:63], a[40:43], v[24:27], v[48:63]
    ds_read_b128 v[44:47], v8 offset:15360
    s_waitcnt lgkmcnt(4)
    v_mfma_f32_32x32x16_bf16 v[48:63], a[44:47], v[28:31], v[48:63]
    ds_read_b128 v[16:19], v8 offset:16384
    s_waitcnt lgkmcnt(4)
    v_mfma_f32_32x32x16_bf16 v[48:63], a[48:51], v[32:35], v[48:63]
    ds_read_b128 v[20:23], v8 offset:17408
    s_waitcnt lgkmcnt(4)
    v_mfma_f32_32x32x16_bf16 v[48:63], a[52:55], v[36:39], v[48:63]
    ds_read_b128 v[24:27], v8 offset:18432
    s_waitcnt lgkmcnt(4)
    v_mfma_f32_32x32x16_bf16 v[48:63], a[56:59], v[40:43], v[48:63]
    ds_read_b128 v[28:31], v8 offset:19456
    s_waitcnt lgkmcnt(4)
    v_mfma_f32_32x32x16_bf16 v[48:63], a[60:63], v[44:47], v[48:63]
    ds_read_b128 v[32:35], v8 offset:20480
    s_waitcnt lgkmcnt(4)
    v_mfma_f32_32x32x16_bf16 v[48:63], a[64:67], v[16:19], v[48:63]
    ds_read_b128 v[36:39], v8 offset:21504
    s_waitcnt lgkmcnt(4)
    v_mfma_f32_32x32x16_bf16 v[48:63], a[68:71], v[20:23], v[48:63]
    ds_read_b128 v[40:43], v8 offset:22528
    s_waitcnt lgkmcnt(4)
    v_mfma_f32_32x32x16_bf16 v[48:63], a[72:75], v[24:27], v[48:63]
    ds_read_b128 v[44:47], v8 offset:23552
    s_waitcnt lgkmcnt(4)
    v_mfma_f32_32x32x16_bf16 v[48:63], a[76:79], v[28:31], v[48:63]
    ds_read_b128 v[16:19], v8 offset:24576
    s_waitcnt lgkmcnt(4)
    v_mfma_f32_32x32x16_bf16 v[48:63], a[80:83], v[32:35], v[48:63]
    ds_read_b128 v[20:23], v8 offset:25600
    s_waitcnt lgkmcnt(4)
    v_mfma_f32_32x32x16_bf16 v[48:63], a[84:87], v[36:39], v[48:63]
    ds_read_b128 v[24:27], v8 offset:26624
    s_waitcnt lgkmcnt(4)
    v_mfma_f32_32x32x16_bf16 v[48:63], a[88:91], v[40:43], v[48:63]
    ds_read_b128 v[28:31], v8 offset:27648
    s_waitcnt lgkmcnt(4)
    v_mfma_f32_32x32x16_bf16 v[48:63], a[92:95], v[44:47], v[48:63]
    ds_read_b128 v[32:35], v8 offset:28672
    s_waitcnt lgkmcnt(4)
    v_mfma_f32_32x32x16_bf16 v[48:63], a[96:99], v[16:19], v[48:63]
    ds_read_b128 v[36:39], v8 offset:29696
    s_waitcnt lgkmcnt(4)
    v_mfma_f32_32x32x16_bf16 v[48:63], a[100:103], v[20:23], v[48:63]
    ds_read_b128 v[40:43], v8 offset:30720
    s_waitcnt lgkmcnt(4)
    v_mfma_f32_32x32x16_bf16 v[48:63], a[104:107], v[24:27], v[48:63]
    ds_read_b128 v[44:47], v8 offset:31744
    s_waitcnt lgkmcnt(4)
    v_mfma_f32_32x32x16_bf16 v[48:63], a[108:111], v[28:31], v[48:63]
    ds_read_b128 v[16:19], v8 offset:32768
    s_waitcnt lgkmcnt(4)
    v_mfma_f32_32x32x16_bf16 v[48:63], a[112:115], v[32:35], v[48:63]
    ds_read_b128 v[20:23], v8 offset:33792
    s_waitcnt lgkmcnt(4)
    v_mfma_f32_32x32x16_bf16 v[48:63], a[116:119], v[36:39], v[48:63]
    ds_read_b128 v[24:27], v8 offset:34816
    s_waitcnt lgkmcnt(4)
    v_mfma_f32_32x32x16_bf16 v[48:63], a[120:123], v[40:43], v[48:63]
    ds_read_b128 v[28:31], v8 offset:35840
    s_waitcnt lgkmcnt(4)
    v_mfma_f32_32x32x16_bf16 v[48:63], a[124:127], v[44:47], v[48:63]
    ds_read_b128 v[32:35], v8 offset:36864
    s_waitcnt lgkmcnt(4)
    v_mfma_f32_32x32x16_bf16 v[48:63], a[128:131], v[16:19], v[48:63]
    ds_read_b128 v[36:39], v8 offset:37888
    s_waitcnt lgkmcnt(4)
    v_mfma_f32_32x32x16_bf16 v[48:63], a[132:135], v[20:23], v[48:63]
    ds_read_b128 v[40:43], v8 offset:38912
    s_waitcnt lgkmcnt(4)
    v_mfma_f32_32x32x16_bf16 v[48:63], a[136:139], v[24:27], v[48:63]
    ds_read_b128 v[44:47], v8 offset:39936
    s_waitcnt lgkmcnt(4)
    v_mfma_f32_32x32x16_bf16 v[48:63], a[140:143], v[28:31], v[48:63]
    ds_read_b128 v[16:19], v8 offset:40960
    s_waitcnt lgkmcnt(4)
    v_mfma_f32_32x32x16_bf16 v[48:63], a[144:147], v[32:35], v[48:63]
    ds_read_b128 v[20:23], v8 offset:41984
    s_waitcnt lgkmcnt(4)
    v_mfma_f32_32x32x16_bf16 v[48:63], a[148:151], v[36:39], v[48:63]
    ds_read_b128 v[24:27], v8 offset:43008
    s_waitcnt lgkmcnt(4)
    v_mfma_f32_32x32x16_bf16 v[48:63], a[152:155], v[40:43], v[48:63]
    ds_read_b128 v[28:31], v8 offset:44032
    s_waitcnt lgkmcnt(4)
    v_mfma_f32_32x32x16_bf16 v[48:63], a[156:159], v[44:47], v[48:63]
    ds_read_b128 v[32:35], v8 offset:45056
    s_waitcnt lgkmcnt(4)
    v_mfma_f32_32x32x16_bf16 v[48:63], a[160:163], v[16:19], v[48:63]
    ds_read_b128 v[36:39], v8 offset:46080
    s_waitcnt lgkmcnt(4)
    v_mfma_f32_32x32x16_bf16 v[48:63], a[164:167], v[20:23], v[48:63]
    ds_read_b128 v[40:43], v8 offset:47104
    s_waitcnt lgkmcnt(4)
    v_mfma_f32_32x32x16_bf16 v[48:63], a[168:171], v[24:27], v[48:63]
    ds_read_b128 v[44:47], v8 offset:48128
    s_waitcnt lgkmcnt(4)
    v_mfma_f32_32x32x16_bf16 v[48:63], a[172:175], v[28:31], v[48:63]
    ds_read_b128 v[16:19], v8 offset:49152
    s_waitcnt lgkmcnt(4)
    v_mfma_f32_32x32x16_bf16 v[48:63], a[176:179], v[32:35], v[48:63]
    ds_read_b128 v[20:23], v8 offset:50176
    s_waitcnt lgkmcnt(4)
    v_mfma_f32_32x32x16_bf16 v[48:63], a[180:183], v[36:39], v[48:63]
    ds_read_b128 v[24:27], v8 offset:51200
    s_waitcnt lgkmcnt(4)
    v_mfma_f32_32x32x16_bf16 v[48:63], a[184:187], v[40:43], v[48:63]
    ds_read_b128 v[28:31], v8 offset:52224
    s_waitcnt lgkmcnt(4)
    v_mfma_f32_32x32x16_bf16 v[48:63], a[188:191], v[44:47], v[48:63]
    ds_read_b128 v[32:35], v8 offset:53248
    s_waitcnt lgkmcnt(4)
    v_mfma_f32_32x32x16_bf16 v[48:63], a[192:195], v[16:19], v[48:63]
    ds_read_b128 v[36:39], v8 offset:54272
    s_waitcnt lgkmcnt(4)
    v_mfma_f32_32x32x16_bf16 v[48:63], a[196:199], v[20:23], v[48:63]
    ds_read_b128 v[40:43], v8 offset:55296
    s_waitcnt lgkmcnt(4)
    v_mfma_f32_32x32x16_bf16 v[48:63], a[200:203], v[24:27], v[48:63]
    ds_read_b128 v[44:47], v8 offset:56320
    s_waitcnt lgkmcnt(4)
    v_mfma_f32_32x32x16_bf16 v[48:63], a[204:207], v[28:31], v[48:63]
    ds_read_b128 v[16:19], v8 offset:57344
    s_waitcnt lgkmcnt(4)
    v_mfma_f32_32x32x16_bf16 v[48:63], a[208:211], v[32:35], v[48:63]
    ds_read_b128 v[20:23], v8 offset:58368
    s_waitcnt lgkmcnt(4)
    v_mfma_f32_32x32x16_bf16 v[48:63], a[212:215], v[36:39], v[48:63]
    ds_read_b128 v[24:27], v8 offset:59392
    s_waitcnt lgkmcnt(4)
    v_mfma_f32_32x32x16_bf16 v[48:63], a[216:219], v[40:43], v[48:63]
    ds_read_b128 v[28:31], v8 offset:60416
    s_waitcnt lgkmcnt(4)
    v_mfma_f32_32x32x16_bf16 v[48:63], a[220:223], v[44:47], v[48:63]
    ds_read_b128 v[32:35], v8 offset:61440
    s_waitcnt lgkmcnt(4)
    v_mfma_f32_32x32x16_bf16 v[48:63], a[224:227], v[16:19], v[48:63]
    ds_read_b128 v[36:39], v8 offset:62464
    s_waitcnt lgkmcnt(4)
    v_mfma_f32_32x32x16_bf16 v[48:63], a[228:231], v[20:23], v[48:63]
    ds_read_b128 v[40:43], v8 offset:63488
    s_waitcnt lgkmcnt(4)
    v_mfma_f32_32x32x16_bf16 v[48:63], a[232:235], v[24:27], v[48:63]
    ds_read_b128 v[44:47], v8 offset:64512
    s_waitcnt lgkmcnt(4)
    v_mfma_f32_32x32x16_bf16 v[48:63], a[236:239], v[28:31], v[48:63]
    s_waitcnt lgkmcnt(3)
    v_mfma_f32_32x32x16_bf16 v[48:63], a[240:243], v[32:35], v[48:63]
    s_waitcnt lgkmcnt(2)
    v_mfma_f32_32x32x16_bf16 v[48:63], a[244:247], v[36:39], v[48:63]
    s_waitcnt lgkmcnt(1)
    v_mfma_f32_32x32x16_bf16 v[48:63], a[248:251], v[40:43], v[48:63]
    s_waitcnt lgkmcnt(0)
    v_mfma_f32_32x32x16_bf16 v[48:63], a[252:255], v[44:47], v[48:63]
    s_cmp_eq_u32 s4, s47
    s_cbranch_scc1 own_18
    s_lshl_b32 s71, s63, 19
    s_add_u32 s71, s71, s76
    s_lshl_b32 s69, s47, 12
    s_add_u32 s71, s71, s69
    s_nop 5
    buffer_store_dwordx4 v[48:51], v1, s[48:51], s71 offen offset:0 sc1
    buffer_store_dwordx4 v[52:55], v1, s[48:51], s71 offen offset:1024 sc1
    buffer_store_dwordx4 v[56:59], v1, s[48:51], s71 offen offset:2048 sc1
    buffer_store_dwordx4 v[60:63], v1, s[48:51], s71 offen offset:3072 sc1
    s_add_u32 s70, s63, 1
    s_waitcnt vmcnt(0)
    v_mov_b32 v3, s70
    v_mov_b32 v4, 0
    s_mov_b64 exec, 1
    buffer_store_dword v3, v4, s[48:51], s68 offen sc1
    s_mov_b64 exec, -1
    s_branch nxt_19
own_18:
    s_cmp_eq_u32 s63, 0
    s_cbranch_scc1 nofin_20
    s_sub_u32 s77, s63, 1
    s_add_u32 s70, s77, 1
    s_mov_b64 exec, 15
w_23:
    buffer_load_dword v4, v5, s[48:51], s75 offen sc1
    s_waitcnt vmcnt(0)
    v_cmp_gt_u32 vcc, s70, v4
    s_cbranch_vccz wok_24
    s_sleep 2
    s_sub_u32 s46, s46, 1
    s_cbranch_scc0 w_23
    s_mov_b32 s46, 0
    s_branch wok_24
wok_24:
    s_mov_b64 exec, -1
    s_lshl_b32 s71, s77, 19
    s_add_u32 s71, s71, s76
    s_xor_b32 s69, s47, 1
    s_lshl_b32 s69, s69, 12
    s_add_u32 s69, s69, s71
    buffer_load_dwordx4 v[112:115], v1, s[48:51], s69 offen offset:0 sc1
    buffer_load_dwordx4 v[116:119], v1, s[48:51], s69 offen offset:1024 sc1
    buffer_load_dwordx4 v[120:123], v1, s[48:51], s69 offen offset:2048 sc1
    buffer_load_dwordx4 v[124:127], v1, s[48:51], s69 offen offset:3072 sc1
    s_xor_b32 s69, s47, 2
    s_lshl_b32 s69, s69, 12
    s_add_u32 s69, s69, s71
    buffer_load_dwordx4 v[128:131], v1, s[48:51], s69 offen offset:0 sc1
    buffer_load_dwordx4 v[132:135], v1, s[48:51], s69 offen offset:1024 sc1
    buffer_load_dwordx4 v[136:139], v1, s[48:51], s69 offen offset:2048 sc1
    buffer_load_dwordx4 v[140:143], v1, s[48:51], s69 offen offset:3072 sc1
    s_xor_b32 s69, s47, 3
    s_lshl_b32 s69, s69, 12
    s_add_u32 s69, s69, s71
    buffer_load_dwordx4 v[144:147], v1, s[48:51], s69 offen offset:0 sc1
    buffer_load_dwordx4 v[148:151], v1, s[48:51], s69 offen offset:1024 sc1
    buffer_load_dwordx4 v[152:155], v1, s[48:51], s69 offen offset:2048 sc1
    buffer_load_dwordx4 v[156:159], v1, s[48:51], s69 offen offset:3072 sc1
    s_waitcnt vmcnt(8)
    v_pk_add_f32 v[96:97], v[96:97], v[112:113]
    v_pk_add_f32 v[98:99], v[98:99], v[114:115]
    v_pk_add_f32 v[100:101], v[100:101], v[116:117]
    v_pk_add_f32 v[102:103], v[102:103], v[118:119]
    v_pk_add_f32 v[104:105], v[104:105], v[120:121]
    v_pk_add_f32 v[106:107], v[106:107], v[122:123]
    v_pk_add_f32 v[108:109], v[108:109], v[124:125]
    v_pk_add_f32 v[110:111], v[110:111], v[126:127]
    s_waitcnt vmcnt(4)
    v_pk_add_f32 v[96:97], v[96:97], v[128:129]
    v_pk_add_f32 v[98:99], v[98:99], v[130:131]
    v_pk_add_f32 v[100:101], v[100:101], v[132:133]
    v_pk_add_f32 v[102:103], v[102:103], v[134:135]
    v_pk_add_f32 v[104:105], v[104:105], v[136:137]
    v_pk_add_f32 v[106:107], v[106:107], v[138:139]
    v_pk_add_f32 v[108:109], v[108:109], v[140:141]
    v_pk_add_f32 v[110:111], v[110:111], v[142:143]
    s_waitcnt vmcnt(0)
    v_pk_add_f32 v[96:97], v[96:97], v[144:145]
    v_pk_add_f32 v[98:99], v[98:99], v[146:147]
    v_pk_add_f32 v[100:101], v[100:101], v[148:149]
    v_pk_add_f32 v[102:103], v[102:103], v[150:151]
    v_pk_add_f32 v[104:105], v[104:105], v[152:153]
    v_pk_add_f32 v[106:107], v[106:107], v[154:155]
    v_pk_add_f32 v[108:109], v[108:109], v[156:157]
    v_pk_add_f32 v[110:111], v[110:111], v[158:159]
    s_lshl_b32 s69, s77, 17
    s_add_u32 s69, s69, s67
    v_cvt_pk_bf16_f32 v80, v96, v97
    v_cvt_pk_bf16_f32 v81, v98, v99
    v_cvt_pk_bf16_f32 v82, v100, v101
    v_cvt_pk_bf16_f32 v83, v102, v103
    buffer_store_dwordx4 v[80:83], v6, s[56:59], s69 offen offset:0
    v_cvt_pk_bf16_f32 v84, v104, v105
    v_cvt_pk_bf16_f32 v85, v106, v107
    v_cvt_pk_bf16_f32 v86, v108, v109
    v_cvt_pk_bf16_f32 v87, v110, v111
    buffer_store_dwordx4 v[84:87], v6, s[56:59], s69 offen offset:32
nofin_20:
    s_nop 7
    v_mov_b64 v[96:97], v[48:49]
    v_mov_b64 v[98:99], v[50:51]
    v_mov_b64 v[100:101], v[52:53]
    v_mov_b64 v[102:103], v[54:55]
    v_mov_b64 v[104:105], v[56:57]
    v_mov_b64 v[106:107], v[58:59]
    v_mov_b64 v[108:109], v[60:61]
    v_mov_b64 v[110:111], v[62:63]
nxt_19:
    s_add_u32 s63, s63, 1
    s_cmp_eq_u32 s73, 1
    s_cbranch_scc1 have_25
    s_and_b32 s69, s63, 3
    s_lshl_b32 s69, s69, 7
    s_add_u32 s71, s69, s74
    s_lshr_b32 s70, s63, 2
    s_add_u32 s70, s70, 1
    s_mov_b64 exec, 255
w_30:
    buffer_load_dword v4, v5, s[48:51], s71 offen sc1
    s_waitcnt vmcnt(0)
    v_cmp_gt_u32 vcc, s70, v4
    s_cbranch_vccz wok_31
    s_sleep 2
    s_sub_u32 s46, s46, 1
    s_cbranch_scc0 w_30
    s_mov_b32 s46, 0
    s_branch wok_31
wok_31:
    s_mov_b64 exec, -1
    s_add_u32 m0, s66, 65536
    s_add_u32 s69, s65, 0
    buffer_load_dwordx4 v1, s[48:51], s69 offen offset:0 sc1 lds
    buffer_load_dwordx4 v1, s[48:51], s69 offen offset:1024 sc1 lds
    buffer_load_dwordx4 v1, s[48:51], s69 offen offset:2048 sc1 lds
    buffer_load_dwordx4 v1, s[48:51], s69 offen offset:3072 sc1 lds
    s_add_u32 m0, s66, 69632
    s_add_u32 s69, s65, 4096
    buffer_load_dwordx4 v1, s[48:51], s69 offen offset:0 sc1 lds
    buffer_load_dwordx4 v1, s[48:51], s69 offen offset:1024 sc1 lds
    buffer_load_dwordx4 v1, s[48:51], s69 offen offset:2048 sc1 lds
    buffer_load_dwordx4 v1, s[48:51], s69 offen offset:3072 sc1 lds
    s_add_u32 m0, s66, 73728
    s_add_u32 s69, s65, 8192
    buffer_load_dwordx4 v1, s[48:51], s69 offen offset:0 sc1 lds
    buffer_load_dwordx4 v1, s[48:51], s69 offen offset:1024 sc1 lds
    buffer_load_dwordx4 v1, s[48:51], s69 offen offset:2048 sc1 lds
    buffer_load_dwordx4 v1, s[48:51], s69 offen offset:3072 sc1 lds
    s_add_u32 m0, s66, 77824
    s_add_u32 s69, s65, 12288
    buffer_load_dwordx4 v1, s[48:51], s69 offen offset:0 sc1 lds
    buffer_load_dwordx4 v1, s[48:51], s69 offen offset:1024 sc1 lds
    buffer_load_dwordx4 v1, s[48:51], s69 offen offset:2048 sc1 lds
    buffer_load_dwordx4 v1, s[48:51], s69 offen offset:3072 sc1 lds
    s_add_u32 s65, s65, 0x40000
have_25:
    s_waitcnt vmcnt(0)
    s_barrier
    s_mov_b32 s73, 0
    s_add_u32 s77, s63, 1
    s_cmp_eq_u32 s77, 64
    s_cbranch_scc1 nopre_26
    s_and_b32 s69, s77, 3
    s_lshl_b32 s69, s69, 7
    s_add_u32 s71, s69, s74
    s_lshr_b32 s70, s77, 2
    s_add_u32 s70, s70, 1
    s_mov_b64 exec, 0xff
    buffer_load_dword v4, v5, s[48:51], s71 offen sc1
    s_waitcnt vmcnt(0)
    v_cmp_gt_u32 vcc, s70, v4
    s_mov_b64 exec, -1
    s_cbranch_vccnz nopre_26
    s_mov_b32 s73, 1
    s_add_u32 m0, s66, 0
    s_add_u32 s69, s65, 0
    buffer_load_dwordx4 v1, s[48:51], s69 offen offset:0 sc1 lds
    buffer_load_dwordx4 v1, s[48:51], s69 offen offset:1024 sc1 lds
    buffer_load_dwordx4 v1, s[48:51], s69 offen offset:2048 sc1 lds
    buffer_load_dwordx4 v1, s[48:51], s69 offen offset:3072 sc1 lds
    s_add_u32 m0, s66, 4096
    s_add_u32 s69, s65, 4096
    buffer_load_dwordx4 v1, s[48:51], s69 offen offset:0 sc1 lds
    buffer_load_dwordx4 v1, s[48:51], s69 offen offset:1024 sc1 lds
    buffer_load_dwordx4 v1, s[48:51], s69 offen offset:2048 sc1 lds
    buffer_load_dwordx4 v1, s[48:51], s69 offen offset:3072 sc1 lds
    s_add_u32 m0, s66, 8192
    s_add_u32 s69, s65, 8192
    buffer_load_dwordx4 v1, s[48:51], s69 offen offset:0 sc1 lds
    buffer_load_dwordx4 v1, s[48:51], s69 offen offset:1024 sc1 lds
    buffer_load_dwordx4 v1, s[48:51], s69 offen offset:2048 sc1 lds
    buffer_load_dwordx4 v1, s[48:51], s69 offen offset:3072 sc1 lds
    s_add_u32 m0, s66, 12288
    s_add_u32 s69, s65, 12288
    buffer_load_dwordx4 v1, s[48:51], s69 offen offset:0 sc1 lds
    buffer_load_dwordx4 v1, s[48:51], s69 offen offset:1024 sc1 lds
    buffer_load_dwordx4 v1, s[48:51], s69 offen offset:2048 sc1 lds
    buffer_load_dwordx4 v1, s[48:51], s69 offen offset:3072 sc1 lds
    s_add_u32 s65, s65, 0x40000
nopre_26:
    ds_read_b128 v[16:19], v12 offset:0
    ds_read_b128 v[20:23], v12 offset:1024
    ds_read_b128 v[24:27], v12 offset:2048
    ds_read_b128 v[28:31], v12 offset:3072
    ds_read_b128 v[32:35], v12 offset:4096
    s_waitcnt lgkmcnt(4)
    v_mfma_f32_32x32x16_bf16 v[64:79], a[0:3], v[16:19], 0
    ds_read_b128 v[36:39], v12 offset:5120
    s_waitcnt lgkmcnt(4)
    v_mfma_f32_32x32x16_bf16 v[64:79], a[4:7], v[20:23], v[64:79]
    ds_read_b128 v[40:43], v12 offset:6144
    s_waitcnt lgkmcnt(4)
    v_mfma_f32_32x32x16_bf16 v[64:79], a[8:11], v[24:27], v[64:79]
    ds_read_b128 v[44:47], v12 offset:7168
    s_waitcnt lgkmcnt(4)
    v_mfma_f32_32x32x16_bf16 v[64:79], a[12:15], v[28:31], v[64:79]
    ds_read_b128 v[16:19], v12 offset:8192
    s_waitcnt lgkmcnt(4)
    v_mfma_f32_32x32x16_bf16 v[64:79], a[16:19], v[32:35], v[64:79]
    ds_read_b128 v[20:23], v12 offset:9216
    s_waitcnt lgkmcnt(4)
    v_mfma_f32_32x32x16_bf16 v[64:79], a[20:23], v[36:39], v[64:79]
    ds_read_b128 v[24:27], v12 offset:10240
    s_waitcnt lgkmcnt(4)
    v_mfma_f32_32x32x16_bf16 v[64:79], a[24:27], v[40:43], v[64:79]
    ds_read_b128 v[28:31], v12 offset:11264
    s_waitcnt lgkmcnt(4)
    v_mfma_f32_32x32x16_bf16 v[64:79], a[28:31], v[44:47], v[64:79]
    ds_read_b128 v[32:35], v12 offset:12288
    s_waitcnt lgkmcnt(4)
    v_mfma_f32_32x32x16_bf16 v[64:79], a[32:35], v[16:19], v[64:79]
    ds_read_b128 v[36:39], v12 offset:13312
    s_waitcnt lgkmcnt(4)
    v_mfma_f32_32x32x16_bf16 v[64:79], a[36:39], v[20:23], v[64:79]
    ds_read_b128 v[40:43], v12 offset:14336
    s_waitcnt lgkmcnt(4)
    v_mfma_f32_32x32x16_bf16 v[64:79], a[40:43], v[24:27], v[64:79]
    ds_read_b128 v[44:47], v12 offset:15360
    s_waitcnt lgkmcnt(4)
    v_mfma_f32_32x32x16_bf16 v[64:79], a[44:47], v[28:31], v[64:79]
    ds_read_b128 v[16:19], v12 offset:16384
    s_waitcnt lgkmcnt(4)
    v_mfma_f32_32x32x16_bf16 v[64:79], a[48:51], v[32:35], v[64:79]
    ds_read_b128 v[20:23], v12 offset:17408
    s_waitcnt lgkmcnt(4)
    v_mfma_f32_32x32x16_bf16 v[64:79], a[52:55], v[36:39], v[64:79]
    ds_read_b128 v[24:27], v12 offset:18432
    s_waitcnt lgkmcnt(4)
    v_mfma_f32_32x32x16_bf16 v[64:79], a[56:59], v[40:43], v[64:79]
    ds_read_b128 v[28:31], v12 offset:19456
    s_waitcnt lgkmcnt(4)
    v_mfma_f32_32x32x16_bf16 v[64:79], a[60:63], v[44:47], v[64:79]
    ds_read_b128 v[32:35], v12 offset:20480
    s_waitcnt lgkmcnt(4)
    v_mfma_f32_32x32x16_bf16 v[64:79], a[64:67], v[16:19], v[64:79]
    ds_read_b128 v[36:39], v12 offset:21504
    s_waitcnt lgkmcnt(4)
    v_mfma_f32_32x32x16_bf16 v[64:79], a[68:71], v[20:23], v[64:79]
    ds_read_b128 v[40:43], v12 offset:22528
    s_waitcnt lgkmcnt(4)
    v_mfma_f32_32x32x16_bf16 v[64:79], a[72:75], v[24:27], v[64:79]
    ds_read_b128 v[44:47], v12 offset:23552
    s_waitcnt lgkmcnt(4)
    v_mfma_f32_32x32x16_bf16 v[64:79], a[76:79], v[28:31], v[64:79]
    ds_read_b128 v[16:19], v12 offset:24576
    s_waitcnt lgkmcnt(4)
    v_mfma_f32_32x32x16_bf16 v[64:79], a[80:83], v[32:35], v[64:79]
    ds_read_b128 v[20:23], v12 offset:25600
    s_waitcnt lgkmcnt(4)
    v_mfma_f32_32x32x16_bf16 v[64:79], a[84:87], v[36:39], v[64:79]
    ds_read_b128 v[24:27], v12 offset:26624
    s_waitcnt lgkmcnt(4)
    v_mfma_f32_32x32x16_bf16 v[64:79], a[88:91], v[40:43], v[64:79]
    ds_read_b128 v[28:31], v12 offset:27648
    s_waitcnt lgkmcnt(4)
    v_mfma_f32_32x32x16_bf16 v[64:79], a[92:95], v[44:47], v[64:79]
    ds_read_b128 v[32:35], v12 offset:28672
    s_waitcnt lgkmcnt(4)
    v_mfma_f32_32x32x16_bf16 v[64:79], a[96:99], v[16:19], v[64:79]
    ds_read_b128 v[36:39], v12 offset:29696
    s_waitcnt lgkmcnt(4)
    v_mfma_f32_32x32x16_bf16 v[64:79], a[100:103], v[20:23], v[64:79]
    ds_read_b128 v[40:43], v12 offset:30720
    s_waitcnt lgkmcnt(4)
    v_mfma_f32_32x32x16_bf16 v[64:79], a[104:107], v[24:27], v[64:79]
    ds_read_b128 v[44:47], v12 offset:31744
    s_waitcnt lgkmcnt(4)
    v_mfma_f32_32x32x16_bf16 v[64:79], a[108:111], v[28:31], v[64:79]
    ds_read_b128 v[16:19], v12 offset:32768
    s_waitcnt lgkmcnt(4)
    v_mfma_f32_32x32x16_bf16 v[64:79], a[112:115], v[32:35], v[64:79]
    ds_read_b128 v[20:23], v12 offset:33792
    s_waitcnt lgkmcnt(4)
    v_mfma_f32_32x32x16_bf16 v[64:79], a[116:119], v[36:39], v[64:79]
    ds_read_b128 v[24:27], v12 offset:34816
    s_waitcnt lgkmcnt(4)
    v_mfma_f32_32x32x16_bf16 v[64:79], a[120:123], v[40:43], v[64:79]
    ds_read_b128 v[28:31], v12 offset:35840
    s_waitcnt lgkmcnt(4)
    v_mfma_f32_32x32x16_bf16 v[64:79], a[124:127], v[44:47], v[64:79]
    ds_read_b128 v[32:35], v12 offset:36864
    s_waitcnt lgkmcnt(4)
    v_mfma_f32_32x32x16_bf16 v[64:79], a[128:131], v[16:19], v[64:79]
    ds_read_b128 v[36:39], v12 offset:37888
    s_waitcnt lgkmcnt(4)
    v_mfma_f32_32x32x16_bf16 v[64:79], a[132:135], v[20:23], v[64:79]
    ds_read_b128 v[40:43], v12 offset:38912
    s_waitcnt lgkmcnt(4)
    v_mfma_f32_32x32x16_bf16 v[64:79], a[136:139], v[24:27], v[64:79]
    ds_read_b128 v[44:47], v12 offset:39936
    s_waitcnt lgkmcnt(4)
    v_mfma_f32_32x32x16_bf16 v[64:79], a[140:143], v[28:31], v[64:79]
    ds_read_b128 v[16:19], v12 offset:40960
    s_waitcnt lgkmcnt(4)
    v_mfma_f32_32x32x16_bf16 v[64:79], a[144:147], v[32:35], v[64:79]
    ds_read_b128 v[20:23], v12 offset:41984
    s_waitcnt lgkmcnt(4)
    v_mfma_f32_32x32x16_bf16 v[64:79], a[148:151], v[36:39], v[64:79]
    ds_read_b128 v[24:27], v12 offset:43008
    s_waitcnt lgkmcnt(4)
    v_mfma_f32_32x32x16_bf16 v[64:79], a[152:155], v[40:43], v[64:79]
    ds_read_b128 v[28:31], v12 offset:44032
    s_waitcnt lgkmcnt(4)
    v_mfma_f32_32x32x16_bf16 v[64:79], a[156:159], v[44:47], v[64:79]
    ds_read_b128 v[32:35], v12 offset:45056
    s_waitcnt lgkmcnt(4)
    v_mfma_f32_32x32x16_bf16 v[64:79], a[160:163], v[16:19], v[64:79]
    ds_read_b128 v[36:39], v12 offset:46080
    s_waitcnt lgkmcnt(4)
    v_mfma_f32_32x32x16_bf16 v[64:79], a[164:167], v[20:23], v[64:79]
    ds_read_b128 v[40:43], v12 offset:47104
    s_waitcnt lgkmcnt(4)
    v_mfma_f32_32x32x16_bf16 v[64:79], a[168:171], v[24:27], v[64:79]
    ds_read_b128 v[44:47], v12 offset:48128
    s_waitcnt lgkmcnt(4)
    v_mfma_f32_32x32x16_bf16 v[64:79], a[172:175], v[28:31], v[64:79]
    ds_read_b128 v[16:19], v12 offset:49152
    s_waitcnt lgkmcnt(4)
    v_mfma_f32_32x32x16_bf16 v[64:79], a[176:179], v[32:35], v[64:79]
    ds_read_b128 v[20:23], v12 offset:50176
    s_waitcnt lgkmcnt(4)
    v_mfma_f32_32x32x16_bf16 v[64:79], a[180:183], v[36:39], v[64:79]
    ds_read_b128 v[24:27], v12 offset:51200
    s_waitcnt lgkmcnt(4)
    v_mfma_f32_32x32x16_bf16 v[64:79], a[184:187], v[40:43], v[64:79]
    ds_read_b128 v[28:31], v12 offset:52224
    s_waitcnt lgkmcnt(4)
    v_mfma_f32_32x32x16_bf16 v[64:79], a[188:191], v[44:47], v[64:79]
    ds_read_b128 v[32:35], v12 offset:53248
    s_waitcnt lgkmcnt(4)
    v_mfma_f32_32x32x16_bf16 v[64:79], a[192:195], v[16:19], v[64:79]
    ds_read_b128 v[36:39], v12 offset:54272
    s_waitcnt lgkmcnt(4)
    v_mfma_f32_32x32x16_bf16 v[64:79], a[196:199], v[20:23], v[64:79]
    ds_read_b128 v[40:43], v12 offset:55296
    s_waitcnt lgkmcnt(4)
    v_mfma_f32_32x32x16_bf16 v[64:79], a[200:203], v[24:27], v[64:79]
    ds_read_b128 v[44:47], v12 offset:56320
    s_waitcnt lgkmcnt(4)
    v_mfma_f32_32x32x16_bf16 v[64:79], a[204:207], v[28:31], v[64:79]
    ds_read_b128 v[16:19], v12 offset:57344
    s_waitcnt lgkmcnt(4)
    v_mfma_f32_32x32x16_bf16 v[64:79], a[208:211], v[32:35], v[64:79]
    ds_read_b128 v[20:23], v12 offset:58368
    s_waitcnt lgkmcnt(4)
    v_mfma_f32_32x32x16_bf16 v[64:79], a[212:215], v[36:39], v[64:79]
    ds_read_b128 v[24:27], v12 offset:59392
    s_waitcnt lgkmcnt(4)
    v_mfma_f32_32x32x16_bf16 v[64:79], a[216:219], v[40:43], v[64:79]
    ds_read_b128 v[28:31], v12 offset:60416
    s_waitcnt lgkmcnt(4)
    v_mfma_f32_32x32x16_bf16 v[64:79], a[220:223], v[44:47], v[64:79]
    ds_read_b128 v[32:35], v12 offset:61440
    s_waitcnt lgkmcnt(4)
    v_mfma_f32_32x32x16_bf16 v[64:79], a[224:227], v[16:19], v[64:79]
    ds_read_b128 v[36:39], v12 offset:62464
    s_waitcnt lgkmcnt(4)
    v_mfma_f32_32x32x16_bf16 v[64:79], a[228:231], v[20:23], v[64:79]
    ds_read_b128 v[40:43], v12 offset:63488
    s_waitcnt lgkmcnt(4)
    v_mfma_f32_32x32x16_bf16 v[64:79], a[232:235], v[24:27], v[64:79]
    ds_read_b128 v[44:47], v12 offset:64512
    s_waitcnt lgkmcnt(4)
    v_mfma_f32_32x32x16_bf16 v[64:79], a[236:239], v[28:31], v[64:79]
    s_waitcnt lgkmcnt(3)
    v_mfma_f32_32x32x16_bf16 v[64:79], a[240:243], v[32:35], v[64:79]
    s_waitcnt lgkmcnt(2)
    v_mfma_f32_32x32x16_bf16 v[64:79], a[244:247], v[36:39], v[64:79]
    s_waitcnt lgkmcnt(1)
    v_mfma_f32_32x32x16_bf16 v[64:79], a[248:251], v[40:43], v[64:79]
    s_waitcnt lgkmcnt(0)
    v_mfma_f32_32x32x16_bf16 v[64:79], a[252:255], v[44:47], v[64:79]
    s_cmp_eq_u32 s4, s47
    s_cbranch_scc1 own_27
    s_lshl_b32 s71, s63, 19
    s_add_u32 s71, s71, s76
    s_lshl_b32 s69, s47, 12
    s_add_u32 s71, s71, s69
    s_nop 5
    buffer_store_dwordx4 v[64:67], v1, s[48:51], s71 offen offset:0 sc1
    buffer_store_dwordx4 v[68:71], v1, s[48:51], s71 offen offset:1024 sc1
    buffer_store_dwordx4 v[72:75], v1, s[48:51], s71 offen offset:2048 sc1
    buffer_store_dwordx4 v[76:79], v1, s[48:51], s71 offen offset:3072 sc1
    s_add_u32 s70, s63, 1
    s_waitcnt vmcnt(0)
    v_mov_b32 v3, s70
    v_mov_b32 v4, 0
    s_mov_b64 exec, 1
    buffer_store_dword v3, v4, s[48:51], s68 offen sc1
    s_mov_b64 exec, -1
    s_branch nxt_28
own_27:
    s_cmp_eq_u32 s63, 0
    s_cbranch_scc1 nofin_29
    s_sub_u32 s77, s63, 1
    s_add_u32 s70, s77, 1
    s_mov_b64 exec, 15
w_32:
    buffer_load_dword v4, v5, s[48:51], s75 offen sc1
    s_waitcnt vmcnt(0)
    v_cmp_gt_u32 vcc, s70, v4
    s_cbranch_vccz wok_33
    s_sleep 2
    s_sub_u32 s46, s46, 1
    s_cbranch_scc0 w_32
    s_mov_b32 s46, 0
    s_branch wok_33
wok_33:
    s_mov_b64 exec, -1
    s_lshl_b32 s71, s77, 19
    s_add_u32 s71, s71, s76
    s_xor_b32 s69, s47, 1
    s_lshl_b32 s69, s69, 12
    s_add_u32 s69, s69, s71
    buffer_load_dwordx4 v[112:115], v1, s[48:51], s69 offen offset:0 sc1
    buffer_load_dwordx4 v[116:119], v1, s[48:51], s69 offen offset:1024 sc1
    buffer_load_dwordx4 v[120:123], v1, s[48:51], s69 offen offset:2048 sc1
    buffer_load_dwordx4 v[124:127], v1, s[48:51], s69 offen offset:3072 sc1
    s_xor_b32 s69, s47, 2
    s_lshl_b32 s69, s69, 12
    s_add_u32 s69, s69, s71
    buffer_load_dwordx4 v[128:131], v1, s[48:51], s69 offen offset:0 sc1
    buffer_load_dwordx4 v[132:135], v1, s[48:51], s69 offen offset:1024 sc1
    buffer_load_dwordx4 v[136:139], v1, s[48:51], s69 offen offset:2048 sc1
    buffer_load_dwordx4 v[140:143], v1, s[48:51], s69 offen offset:3072 sc1
    s_xor_b32 s69, s47, 3
    s_lshl_b32 s69, s69, 12
    s_add_u32 s69, s69, s71
    buffer_load_dwordx4 v[144:147], v1, s[48:51], s69 offen offset:0 sc1
    buffer_load_dwordx4 v[148:151], v1, s[48:51], s69 offen offset:1024 sc1
    buffer_load_dwordx4 v[152:155], v1, s[48:51], s69 offen offset:2048 sc1
    buffer_load_dwordx4 v[156:159], v1, s[48:51], s69 offen offset:3072 sc1
    s_waitcnt vmcnt(8)
    v_pk_add_f32 v[96:97], v[96:97], v[112:113]
    v_pk_add_f32 v[98:99], v[98:99], v[114:115]
    v_pk_add_f32 v[100:101], v[100:101], v[116:117]
    v_pk_add_f32 v[102:103], v[102:103], v[118:119]
    v_pk_add_f32 v[104:105], v[104:105], v[120:121]
    v_pk_add_f32 v[106:107], v[106:107], v[122:123]
    v_pk_add_f32 v[108:109], v[108:109], v[124:125]
    v_pk_add_f32 v[110:111], v[110:111], v[126:127]
    s_waitcnt vmcnt(4)
    v_pk_add_f32 v[96:97], v[96:97], v[128:129]
    v_pk_add_f32 v[98:99], v[98:99], v[130:131]
    v_pk_add_f32 v[100:101], v[100:101], v[132:133]
    v_pk_add_f32 v[102:103], v[102:103], v[134:135]
    v_pk_add_f32 v[104:105], v[104:105], v[136:137]
    v_pk_add_f32 v[106:107], v[106:107], v[138:139]
    v_pk_add_f32 v[108:109], v[108:109], v[140:141]
    v_pk_add_f32 v[110:111], v[110:111], v[142:143]
    s_waitcnt vmcnt(0)
    v_pk_add_f32 v[96:97], v[96:97], v[144:145]
    v_pk_add_f32 v[98:99], v[98:99], v[146:147]
    v_pk_add_f32 v[100:101], v[100:101], v[148:149]
    v_pk_add_f32 v[102:103], v[102:103], v[150:151]
    v_pk_add_f32 v[104:105], v[104:105], v[152:153]
    v_pk_add_f32 v[106:107], v[106:107], v[154:155]
    v_pk_add_f32 v[108:109], v[108:109], v[156:157]
    v_pk_add_f32 v[110:111], v[110:111], v[158:159]
    s_lshl_b32 s69, s77, 17
    s_add_u32 s69, s69, s67
    v_cvt_pk_bf16_f32 v80, v96, v97
    v_cvt_pk_bf16_f32 v81, v98, v99
    v_cvt_pk_bf16_f32 v82, v100, v101
    v_cvt_pk_bf16_f32 v83, v102, v103
    buffer_store_dwordx4 v[80:83], v6, s[56:59], s69 offen offset:0
    v_cvt_pk_bf16_f32 v84, v104, v105
    v_cvt_pk_bf16_f32 v85, v106, v107
    v_cvt_pk_bf16_f32 v86, v108, v109
    v_cvt_pk_bf16_f32 v87, v110, v111
    buffer_store_dwordx4 v[84:87], v6, s[56:59], s69 offen offset:32
nofin_29:
    s_nop 7
    v_mov_b64 v[96:97], v[64:65]
    v_mov_b64 v[98:99], v[66:67]
    v_mov_b64 v[100:101], v[68:69]
    v_mov_b64 v[102:103], v[70:71]
    v_mov_b64 v[104:105], v[72:73]
    v_mov_b64 v[106:107], v[74:75]
    v_mov_b64 v[108:109], v[76:77]
    v_mov_b64 v[110:111], v[78:79]
nxt_28:
    s_add_u32 s63, s63, 1
    s_cmp_lt_u32 s63, 64
    s_cbranch_scc1 Lw_Oloop
    s_cmp_eq_u32 s4, s47
    s_cbranch_scc0 Lw_end
    s_mov_b32 s77, 63
    s_add_u32 s70, s77, 1
    s_mov_b64 exec, 15
w_34:
    buffer_load_dword v4, v5, s[48:51], s75 offen sc1
    s_waitcnt vmcnt(0)
    v_cmp_gt_u32 vcc, s70, v4
    s_cbranch_vccz wok_35
    s_sleep 2
    s_sub_u32 s46, s46, 1
    s_cbranch_scc0 w_34
    s_mov_b32 s46, 0
    s_branch wok_35
wok_35:
    s_mov_b64 exec, -1
    s_lshl_b32 s71, s77, 19
    s_add_u32 s71, s71, s76
    s_xor_b32 s69, s47, 1
    s_lshl_b32 s69, s69, 12
    s_add_u32 s69, s69, s71
    buffer_load_dwordx4 v[112:115], v1, s[48:51], s69 offen offset:0 sc1
    buffer_load_dwordx4 v[116:119], v1, s[48:51], s69 offen offset:1024 sc1
    buffer_load_dwordx4 v[120:123], v1, s[48:51], s69 offen offset:2048 sc1
    buffer_load_dwordx4 v[124:127], v1, s[48:51], s69 offen offset:3072 sc1
    s_xor_b32 s69, s47, 2
    s_lshl_b32 s69, s69, 12
    s_add_u32 s69, s69, s71
    buffer_load_dwordx4 v[128:131], v1, s[48:51], s69 offen offset:0 sc1
    buffer_load_dwordx4 v[132:135], v1, s[48:51], s69 offen offset:1024 sc1
    buffer_load_dwordx4 v[136:139], v1, s[48:51], s69 offen offset:2048 sc1
    buffer_load_dwordx4 v[140:143], v1, s[48:51], s69 offen offset:3072 sc1
    s_xor_b32 s69, s47, 3
    s_lshl_b32 s69, s69, 12
    s_add_u32 s69, s69, s71
    buffer_load_dwordx4 v[144:147], v1, s[48:51], s69 offen offset:0 sc1
    buffer_load_dwordx4 v[148:151], v1, s[48:51], s69 offen offset:1024 sc1
    buffer_load_dwordx4 v[152:155], v1, s[48:51], s69 offen offset:2048 sc1
    buffer_load_dwordx4 v[156:159], v1, s[48:51], s69 offen offset:3072 sc1
    s_waitcnt vmcnt(8)
    v_pk_add_f32 v[96:97], v[96:97], v[112:113]
    v_pk_add_f32 v[98:99], v[98:99], v[114:115]
    v_pk_add_f32 v[100:101], v[100:101], v[116:117]
    v_pk_add_f32 v[102:103], v[102:103], v[118:119]
    v_pk_add_f32 v[104:105], v[104:105], v[120:121]
    v_pk_add_f32 v[106:107], v[106:107], v[122:123]
    v_pk_add_f32 v[108:109], v[108:109], v[124:125]
    v_pk_add_f32 v[110:111], v[110:111], v[126:127]
    s_waitcnt vmcnt(4)
    v_pk_add_f32 v[96:97], v[96:97], v[128:129]
    v_pk_add_f32 v[98:99], v[98:99], v[130:131]
    v_pk_add_f32 v[100:101], v[100:101], v[132:133]
    v_pk_add_f32 v[102:103], v[102:103], v[134:135]
    v_pk_add_f32 v[104:105], v[104:105], v[136:137]
    v_pk_add_f32 v[106:107], v[106:107], v[138:139]
    v_pk_add_f32 v[108:109], v[108:109], v[140:141]
    v_pk_add_f32 v[110:111], v[110:111], v[142:143]
    s_waitcnt vmcnt(0)
    v_pk_add_f32 v[96:97], v[96:97], v[144:145]
    v_pk_add_f32 v[98:99], v[98:99], v[146:147]
    v_pk_add_f32 v[100:101], v[100:101], v[148:149]
    v_pk_add_f32 v[102:103], v[102:103], v[150:151]
    v_pk_add_f32 v[104:105], v[104:105], v[152:153]
    v_pk_add_f32 v[106:107], v[106:107], v[154:155]
    v_pk_add_f32 v[108:109], v[108:109], v[156:157]
    v_pk_add_f32 v[110:111], v[110:111], v[158:159]
    s_lshl_b32 s69, s77, 17
    s_add_u32 s69, s69, s67
    v_cvt_pk_bf16_f32 v80, v96, v97
    v_cvt_pk_bf16_f32 v81, v98, v99
    v_cvt_pk_bf16_f32 v82, v100, v101
    v_cvt_pk_bf16_f32 v83, v102, v103
    buffer_store_dwordx4 v[80:83], v6, s[56:59], s69 offen offset:0
    v_cvt_pk_bf16_f32 v84, v104, v105
    v_cvt_pk_bf16_f32 v85, v106, v107
    v_cvt_pk_bf16_f32 v86, v108, v109
    v_cvt_pk_bf16_f32 v87, v110, v111
    buffer_store_dwordx4 v[84:87], v6, s[56:59], s69 offen offset:32
    s_branch Lw_end
Lw_Q:
    s_lshl_b32 s69, s4, 11
    s_add_u32 s69, s69, 131072
    v_add_u32 v5, s69, v1
    s_lshl_b32 s69, s4, 13
    s_add_u32 s69, s69, 131072
    v_add_u32 v243, s69, v1
    v_mov_b32 v6, 0x3e0293ee
    v_mov_b32 v7, v6
    v_lshrrev_b32 v3, 5, v0
    v_and_b32 v4, 7, v0
    v_lshlrev_b32 v4, 4, v4
    v_lshl_add_u32 v240, v3, 8, v4
    v_add_u32 v240, 128, v240
    v_lshl_add_u32 v241, v3, 9, v4
    v_bfe_u32 v4, v0, 3, 2
    v_lshl_add_u32 v241, v4, 2, v241
    v_bfe_u32 v4, v0, 1, 2
    v_and_b32 v242, 1, v0
    v_lshlrev_b32 v242, 2, v242
    v_lshl_add_u32 v242, v4, 4, v242
    v_and_b32 v4, 31, v0
    v_lshlrev_b32 v3, 2, v3
    v_sub_u32 v4, v4, v3
    v_cmp_le_i32 s[8:9], 0, v4
    v_cmp_le_i32 s[10:11], 1, v4
    v_cmp_le_i32 s[12:13], 2, v4
    v_cmp_le_i32 s[14:15], 3, v4
    v_cmp_le_i32 s[16:17], 8, v4
    v_cmp_le_i32 s[18:19], 9, v4
    v_cmp_le_i32 s[20:21], 10, v4
    v_cmp_le_i32 s[22:23], 11, v4
    v_cmp_le_i32 s[24:25], 16, v4
    v_cmp_le_i32 s[26:27], 17, v4
    v_cmp_le_i32 s[28:29], 18, v4
    v_cmp_le_i32 s[30:31], 19, v4
    v_cmp_le_i32 s[32:33], 24, v4
    v_cmp_le_i32 s[34:35], 25, v4
    v_cmp_le_i32 s[36:37], 26, v4
    v_cmp_le_i32 s[38:39], 27, v4
    v_mov_b64 v[226:227], 0
    v_mov_b64 v[230:231], 0
    v_mov_b64 v[234:235], 0
    v_mov_b64 v[238:239], 0
    s_mov_b32 s72, -1
Lw_Qloop:
    s_cmp_eq_u32 s72, 15
    s_cbranch_scc1 Lw_Qatt
    ds_read_b128 v[16:19], v8 offset:0
    ds_read_b128 v[20:23], v9 offset:0
    ds_read_b128 v[24:27], v10 offset:0
    ds_read_b128 v[28:31], v11 offset:0
    ds_read_b128 v[32:35], v8 offset:4096
    s_waitcnt lgkmcnt(4)
    v_mfma_f32_32x32x16_bf16 v[48:63], a[0:3], v[16:19], 0
    ds_read_b128 v[36:39], v9 offset:4096
    s_waitcnt lgkmcnt(4)
    v_mfma_f32_32x32x16_bf16 v[48:63], a[4:7], v[20:23], v[48:63]
    ds_read_b128 v[40:43], v10 offset:4096
    s_waitcnt lgkmcnt(4)
    v_mfma_f32_32x32x16_bf16 v[48:63], a[8:11], v[24:27], v[48:63]
    ds_read_b128 v[44:47], v11 offset:4096
    s_waitcnt lgkmcnt(4)
    v_mfma_f32_32x32x16_bf16 v[48:63], a[12:15], v[28:31], v[48:63]
    ds_read_b128 v[16:19], v8 offset:8192
    s_waitcnt lgkmcnt(4)
    v_mfma_f32_32x32x16_bf16 v[48:63], a[16:19], v[32:35], v[48:63]
    ds_read_b128 v[20:23], v9 offset:8192
    s_waitcnt lgkmcnt(4)
    v_mfma_f32_32x32x16_bf16 v[48:63], a[20:23], v[36:39], v[48:63]
    ds_read_b128 v[24:27], v10 offset:8192
    s_waitcnt lgkmcnt(4)
    v_mfma_f32_32x32x16_bf16 v[48:63], a[24:27], v[40:43], v[48:63]
    ds_read_b128 v[28:31], v11 offset:8192
    s_waitcnt lgkmcnt(4)
    v_mfma_f32_32x32x16_bf16 v[48:63], a[28:31], v[44:47], v[48:63]
    ds_read_b128 v[32:35], v8 offset:12288
    s_waitcnt lgkmcnt(4)
    v_mfma_f32_32x32x16_bf16 v[48:63], a[32:35], v[16:19], v[48:63]
    ds_read_b128 v[36:39], v9 offset:12288
    s_waitcnt lgkmcnt(4)
    v_mfma_f32_32x32x16_bf16 v[48:63], a[36:39], v[20:23], v[48:63]
    ds_read_b128 v[40:43], v10 offset:12288
    s_waitcnt lgkmcnt(4)
    v_mfma_f32_32x32x16_bf16 v[48:63], a[40:43], v[24:27], v[48:63]
    ds_read_b128 v[44:47], v11 offset:12288
    s_waitcnt lgkmcnt(4)
    v_mfma_f32_32x32x16_bf16 v[48:63], a[44:47], v[28:31], v[48:63]
    ds_read_b128 v[16:19], v8 offset:16384
    s_waitcnt lgkmcnt(4)
    v_mfma_f32_32x32x16_bf16 v[48:63], a[48:51], v[32:35], v[48:63]
    s_add_u32 m0, s66, 65536
    s_nop 0
    buffer_load_dwordx4 v2, s[56:59], s65 offen offset:0 lds
    ds_read_b128 v[20:23], v9 offset:16384
    s_waitcnt lgkmcnt(4)
    v_mfma_f32_32x32x16_bf16 v[48:63], a[52:55], v[36:39], v[48:63]
    ds_read_b128 v[24:27], v10 offset:16384
    s_waitcnt lgkmcnt(4)
    v_mfma_f32_32x32x16_bf16 v[48:63], a[56:59], v[40:43], v[48:63]
    s_add_u32 m0, s66, 69504
    s_nop 0
    buffer_load_dwordx4 v2, s[56:59], s65 offen offset:128 lds
    ds_read_b128 v[28:31], v11 offset:16384
    s_waitcnt lgkmcnt(4)
    v_mfma_f32_32x32x16_bf16 v[48:63], a[60:63], v[44:47], v[48:63]
    ds_read_b128 v[32:35], v8 offset:20480
    s_waitcnt lgkmcnt(4)
    v_mfma_f32_32x32x16_bf16 v[48:63], a[64:67], v[16:19], v[48:63]
    s_add_u32 m0, s66, 73472
    s_nop 0
    buffer_load_dwordx4 v2, s[56:59], s65 offen offset:256 lds
    ds_read_b128 v[36:39], v9 offset:20480
    s_waitcnt lgkmcnt(4)
    v_mfma_f32_32x32x16_bf16 v[48:63], a[68:71], v[20:23], v[48:63]
    ds_read_b128 v[40:43], v10 offset:20480
    s_waitcnt lgkmcnt(4)
    v_mfma_f32_32x32x16_bf16 v[48:63], a[72:75], v[24:27], v[48:63]
    s_add_u32 m0, s66, 77440
    s_nop 0
    buffer_load_dwordx4 v2, s[56:59], s65 offen offset:384 lds
    ds_read_b128 v[44:47], v11 offset:20480
    s_waitcnt lgkmcnt(4)
    v_mfma_f32_32x32x16_bf16 v[48:63], a[76:79], v[28:31], v[48:63]
    ds_read_b128 v[16:19], v8 offset:24576
    s_waitcnt lgkmcnt(4)
    v_mfma_f32_32x32x16_bf16 v[48:63], a[80:83], v[32:35], v[48:63]
    s_add_u32 m0, s66, 81408
    s_nop 0
    buffer_load_dwordx4 v2, s[56:59], s65 offen offset:512 lds
    ds_read_b128 v[20:23], v9 offset:24576
    s_waitcnt lgkmcnt(4)
    v_mfma_f32_32x32x16_bf16 v[48:63], a[84:87], v[36:39], v[48:63]
    ds_read_b128 v[24:27], v10 offset:24576
    s_waitcnt lgkmcnt(4)
    v_mfma_f32_32x32x16_bf16 v[48:63], a[88:91], v[40:43], v[48:63]
    s_add_u32 m0, s66, 85376
    s_nop 0
    buffer_load_dwordx4 v2, s[56:59], s65 offen offset:640 lds
    ds_read_b128 v[28:31], v11 offset:24576
    s_waitcnt lgkmcnt(4)
    v_mfma_f32_32x32x16_bf16 v[48:63], a[92:95], v[44:47], v[48:63]
    ds_read_b128 v[32:35], v8 offset:28672
    s_waitcnt lgkmcnt(4)
    v_mfma_f32_32x32x16_bf16 v[48:63], a[96:99], v[16:19], v[48:63]
    s_add_u32 m0, s66, 89344
    s_nop 0
    buffer_load_dwordx4 v2, s[56:59], s65 offen offset:768 lds
    ds_read_b128 v[36:39], v9 offset:28672
    s_waitcnt lgkmcnt(4)
    v_mfma_f32_32x32x16_bf16 v[48:63], a[100:103], v[20:23], v[48:63]
    ds_read_b128 v[40:43], v10 offset:28672
    s_waitcnt lgkmcnt(4)
    v_mfma_f32_32x32x16_bf16 v[48:63], a[104:107], v[24:27], v[48:63]
    s_add_u32 m0, s66, 93312
    s_nop 0
    buffer_load_dwordx4 v2, s[56:59], s65 offen offset:896 lds
    ds_read_b128 v[44:47], v11 offset:28672
    s_waitcnt lgkmcnt(4)
    v_mfma_f32_32x32x16_bf16 v[48:63], a[108:111], v[28:31], v[48:63]
    ds_read_b128 v[16:19], v8 offset:32768
    s_waitcnt lgkmcnt(4)
    v_mfma_f32_32x32x16_bf16 v[48:63], a[112:115], v[32:35], v[48:63]
    s_add_u32 m0, s66, 97280
    s_nop 0
    buffer_load_dwordx4 v2, s[56:59], s65 offen offset:1024 lds
    ds_read_b128 v[20:23], v9 offset:32768
    s_waitcnt lgkmcnt(4)
    v_mfma_f32_32x32x16_bf16 v[48:63], a[116:119], v[36:39], v[48:63]
    ds_read_b128 v[24:27], v10 offset:32768
    s_waitcnt lgkmcnt(4)
    v_mfma_f32_32x32x16_bf16 v[48:63], a[120:123], v[40:43], v[48:63]
    s_add_u32 m0, s66, 101248
    s_nop 0
    buffer_load_dwordx4 v2, s[56:59], s65 offen offset:1152 lds
    ds_read_b128 v[28:31], v11 offset:32768
    s_waitcnt lgkmcnt(4)
    v_mfma_f32_32x32x16_bf16 v[48:63], a[124:127], v[44:47], v[48:63]
    ds_read_b128 v[32:35], v8 offset:36864
    s_waitcnt lgkmcnt(4)
    v_mfma_f32_32x32x16_bf16 v[48:63], a[128:131], v[16:19], v[48:63]
    s_add_u32 m0, s66, 105216
    s_nop 0
    buffer_load_dwordx4 v2, s[56:59], s65 offen offset:1280 lds
    ds_read_b128 v[36:39], v9 offset:36864
    s_waitcnt lgkmcnt(4)
    v_mfma_f32_32x32x16_bf16 v[48:63], a[132:135], v[20:23], v[48:63]
    ds_read_b128 v[40:43], v10 offset:36864
    s_waitcnt lgkmcnt(4)
    v_mfma_f32_32x32x16_bf16 v[48:63], a[136:139], v[24:27], v[48:63]
    s_add_u32 m0, s66, 109184
    s_nop 0
    buffer_load_dwordx4 v2, s[56:59], s65 offen offset:1408 lds
    ds_read_b128 v[44:47], v11 offset:36864
    s_waitcnt lgkmcnt(4)
    v_mfma_f32_32x32x16_bf16 v[48:63], a[140:143], v[28:31], v[48:63]
    ds_read_b128 v[16:19], v8 offset:40960
    s_waitcnt lgkmcnt(4)
    v_mfma_f32_32x32x16_bf16 v[48:63], a[144:147], v[32:35], v[48:63]
    s_add_u32 m0, s66, 113152
    s_nop 0
    buffer_load_dwordx4 v2, s[56:59], s65 offen offset:1536 lds
    ds_read_b128 v[20:23], v9 offset:40960
    s_waitcnt lgkmcnt(4)
    v_mfma_f32_32x32x16_bf16 v[48:63], a[148:151], v[36:39], v[48:63]
    ds_read_b128 v[24:27], v10 offset:40960
    s_waitcnt lgkmcnt(4)
    v_mfma_f32_32x32x16_bf16 v[48:63], a[152:155], v[40:43], v[48:63]
    s_add_u32 m0, s66, 117120
    s_nop 0
    buffer_load_dwordx4 v2, s[56:59], s65 offen offset:1664 lds
    ds_read_b128 v[28:31], v11 offset:40960
    s_waitcnt lgkmcnt(4)
    v_mfma_f32_32x32x16_bf16 v[48:63], a[156:159], v[44:47], v[48:63]
    ds_read_b128 v[32:35], v8 offset:45056
    s_waitcnt lgkmcnt(4)
    v_mfma_f32_32x32x16_bf16 v[48:63], a[160:163], v[16:19], v[48:63]
    s_add_u32 m0, s66, 121088
    s_nop 0
    buffer_load_dwordx4 v2, s[56:59], s65 offen offset:1792 lds
    ds_read_b128 v[36:39], v9 offset:45056
    s_waitcnt lgkmcnt(4)
    v_mfma_f32_32x32x16_bf16 v[48:63], a[164:167], v[20:23], v[48:63]
    ds_read_b128 v[40:43], v10 offset:45056
    s_waitcnt lgkmcnt(4)
    v_mfma_f32_32x32x16_bf16 v[48:63], a[168:171], v[24:27], v[48:63]
    s_add_u32 m0, s66, 125056
    s_nop 0
    buffer_load_dwordx4 v2, s[56:59], s65 offen offset:1920 lds
    ds_read_b128 v[44:47], v11 offset:45056
    s_waitcnt lgkmcnt(4)
    v_mfma_f32_32x32x16_bf16 v[48:63], a[172:175], v[28:31], v[48:63]
    ds_read_b128 v[16:19], v8 offset:49152
    s_waitcnt lgkmcnt(4)
    v_mfma_f32_32x32x16_bf16 v[48:63], a[176:179], v[32:35], v[48:63]
    ds_read_b128 v[20:23], v9 offset:49152
    s_waitcnt lgkmcnt(4)
    v_mfma_f32_32x32x16_bf16 v[48:63], a[180:183], v[36:39], v[48:63]
    ds_read_b128 v[24:27], v10 offset:49152
    s_waitcnt lgkmcnt(4)
    v_mfma_f32_32x32x16_bf16 v[48:63], a[184:187], v[40:43], v[48:63]
    ds_read_b128 v[28:31], v11 offset:49152
    s_waitcnt lgkmcnt(4)
    v_mfma_f32_32x32x16_bf16 v[48:63], a[188:191], v[44:47], v[48:63]
    ds_read_b128 v[32:35], v8 offset:53248
    s_waitcnt lgkmcnt(4)
    v_mfma_f32_32x32x16_bf16 v[48:63], a[192:195], v[16:19], v[48:63]
    ds_read_b128 v[36:39], v9 offset:53248
    s_waitcnt lgkmcnt(4)
    v_mfma_f32_32x32x16_bf16 v[48:63], a[196:199], v[20:23], v[48:63]
    ds_read_b128 v[40:43], v10 offset:53248
    s_waitcnt lgkmcnt(4)
    v_mfma_f32_32x32x16_bf16 v[48:63], a[200:203], v[24:27], v[48:63]
    ds_read_b128 v[44:47], v11 offset:53248
    s_waitcnt lgkmcnt(4)
    v_mfma_f32_32x32x16_bf16 v[48:63], a[204:207], v[28:31], v[48:63]
    ds_read_b128 v[16:19], v8 offset:57344
    s_waitcnt lgkmcnt(4)
    v_mfma_f32_32x32x16_bf16 v[48:63], a[208:211], v[32:35], v[48:63]
    ds_read_b128 v[20:23], v9 offset:57344
    s_waitcnt lgkmcnt(4)
    v_mfma_f32_32x32x16_bf16 v[48:63], a[212:215], v[36:39], v[48:63]
    ds_read_b128 v[24:27], v10 offset:57344
    s_waitcnt lgkmcnt(4)
    v_mfma_f32_32x32x16_bf16 v[48:63], a[216:219], v[40:43], v[48:63]
    ds_read_b128 v[28:31], v11 offset:57344
    s_waitcnt lgkmcnt(4)
    v_mfma_f32_32x32x16_bf16 v[48:63], a[220:223], v[44:47], v[48:63]
    ds_read_b128 v[32:35], v8 offset:61440
    s_waitcnt lgkmcnt(4)
    v_mfma_f32_32x32x16_bf16 v[48:63], a[224:227], v[16:19], v[48:63]
    ds_read_b128 v[36:39], v9 offset:61440
    s_waitcnt lgkmcnt(4)
    v_mfma_f32_32x32x16_bf16 v[48:63], a[228:231], v[20:23], v[48:63]
    ds_read_b128 v[40:43], v10 offset:61440
    s_waitcnt lgkmcnt(4)
    v_mfma_f32_32x32x16_bf16 v[48:63], a[232:235], v[24:27], v[48:63]
    ds_read_b128 v[44:47], v11 offset:61440
    s_waitcnt lgkmcnt(4)
    v_mfma_f32_32x32x16_bf16 v[48:63], a[236:239], v[28:31], v[48:63]
    s_waitcnt vmcnt(0) lgkmcnt(0)
    s_barrier
    ds_read_b128 v[16:19], v12 offset:0
    v_mfma_f32_32x32x16_bf16 v[48:63], a[240:243], v[32:35], v[48:63]
    ds_read_b128 v[20:23], v13 offset:0
    v_mfma_f32_32x32x16_bf16 v[48:63], a[244:247], v[36:39], v[48:63]
    ds_read_b128 v[24:27], v14 offset:0
    v_mfma_f32_32x32x16_bf16 v[48:63], a[248:251], v[40:43], v[48:63]
    ds_read_b128 v[28:31], v15 offset:0
    v_mfma_f32_32x32x16_bf16 v[48:63], a[252:255], v[44:47], v[48:63]
    s_add_u32 s63, s63, 1
    s_add_u32 s65, s65, 0x10000
    ds_read_b128 v[32:35], v12 offset:4096
    s_waitcnt lgkmcnt(4)
    v_mfma_f32_32x32x16_bf16 v[64:79], a[0:3], v[16:19], 0
    ds_read_b128 v[36:39], v13 offset:4096
    s_waitcnt lgkmcnt(4)
    v_mfma_f32_32x32x16_bf16 v[64:79], a[4:7], v[20:23], v[64:79]
    ds_read_b128 v[40:43], v14 offset:4096
    s_waitcnt lgkmcnt(4)
    v_mfma_f32_32x32x16_bf16 v[64:79], a[8:11], v[24:27], v[64:79]
    v_pk_mul_f32 v[48:49], v[48:49], v[6:7]
    v_cvt_pk_bf16_f32 v80, v48, v49
    ds_read_b128 v[44:47], v15 offset:4096
    s_waitcnt lgkmcnt(4)
    v_mfma_f32_32x32x16_bf16 v[64:79], a[12:15], v[28:31], v[64:79]
    v_pk_mul_f32 v[50:51], v[50:51], v[6:7]
    v_cvt_pk_bf16_f32 v81, v50, v51
    ds_read_b128 v[16:19], v12 offset:8192
    s_waitcnt lgkmcnt(4)
    v_mfma_f32_32x32x16_bf16 v[64:79], a[16:19], v[32:35], v[64:79]
    v_pk_mul_f32 v[52:53], v[52:53], v[6:7]
    v_cvt_pk_bf16_f32 v82, v52, v53
    ds_read_b128 v[20:23], v13 offset:8192
    s_waitcnt lgkmcnt(4)
    v_mfma_f32_32x32x16_bf16 v[64:79], a[20:23], v[36:39], v[64:79]
    v_pk_mul_f32 v[54:55], v[54:55], v[6:7]
    v_cvt_pk_bf16_f32 v83, v54, v55
    ds_write_b128 v5, v[80:83] offset:0
    ds_read_b128 v[24:27], v14 offset:8192
    s_waitcnt lgkmcnt(5)
    v_mfma_f32_32x32x16_bf16 v[64:79], a[24:27], v[40:43], v[64:79]
    v_pk_mul_f32 v[56:57], v[56:57], v[6:7]
    v_cvt_pk_bf16_f32 v84, v56, v57
    ds_read_b128 v[28:31], v15 offset:8192
    s_waitcnt lgkmcnt(5)
    v_mfma_f32_32x32x16_bf16 v[64:79], a[28:31], v[44:47], v[64:79]
    v_pk_mul_f32 v[58:59], v[58:59], v[6:7]
    v_cvt_pk_bf16_f32 v85, v58, v59
    ds_read_b128 v[32:35], v12 offset:12288
    s_waitcnt lgkmcnt(5)
    v_mfma_f32_32x32x16_bf16 v[64:79], a[32:35], v[16:19], v[64:79]
    v_pk_mul_f32 v[60:61], v[60:61], v[6:7]
    v_cvt_pk_bf16_f32 v86, v60, v61
    ds_read_b128 v[36:39], v13 offset:12288
    s_waitcnt lgkmcnt(5)
    v_mfma_f32_32x32x16_bf16 v[64:79], a[36:39], v[20:23], v[64:79]
    v_pk_mul_f32 v[62:63], v[62:63], v[6:7]
    v_cvt_pk_bf16_f32 v87, v62, v63
    ds_write_b128 v5, v[84:87] offset:1024
    ds_read_b128 v[40:43], v14 offset:12288
    s_waitcnt lgkmcnt(5)
    v_mfma_f32_32x32x16_bf16 v[64:79], a[40:43], v[24:27], v[64:79]
    ds_read_b128 v[44:47], v15 offset:12288
    s_waitcnt lgkmcnt(5)
    v_mfma_f32_32x32x16_bf16 v[64:79], a[44:47], v[28:31], v[64:79]
    ds_read_b128 v[16:19], v12 offset:16384
    s_waitcnt lgkmcnt(5)
    v_mfma_f32_32x32x16_bf16 v[64:79], a[48:51], v[32:35], v[64:79]
    s_add_u32 m0, s66, 0
    s_nop 0
    buffer_load_dwordx4 v2, s[56:59], s65 offen offset:0 lds
    ds_read_b128 v[20:23], v13 offset:16384
    s_waitcnt lgkmcnt(5)
    v_mfma_f32_32x32x16_bf16 v[64:79], a[52:55], v[36:39], v[64:79]
    ds_read_b128 v[24:27], v14 offset:16384
    s_waitcnt lgkmcnt(4)
    v_mfma_f32_32x32x16_bf16 v[64:79], a[56:59], v[40:43], v[64:79]
    s_add_u32 m0, s66, 3968
    s_nop 0
    buffer_load_dwordx4 v2, s[56:59], s65 offen offset:128 lds
    ds_read_b128 v[28:31], v15 offset:16384
    s_waitcnt lgkmcnt(4)
    v_mfma_f32_32x32x16_bf16 v[64:79], a[60:63], v[44:47], v[64:79]
    ds_read_b128 v[32:35], v12 offset:20480
    s_waitcnt lgkmcnt(4)
    v_mfma_f32_32x32x16_bf16 v[64:79], a[64:67], v[16:19], v[64:79]
    s_add_u32 m0, s66, 7936
    s_nop 0
    buffer_load_dwordx4 v2, s[56:59], s65 offen offset:256 lds
    ds_read_b128 v[36:39], v13 offset:20480
    s_waitcnt lgkmcnt(4)
    v_mfma_f32_32x32x16_bf16 v[64:79], a[68:71], v[20:23], v[64:79]
    ds_read_b128 v[40:43], v14 offset:20480
    s_waitcnt lgkmcnt(4)
    v_mfma_f32_32x32x16_bf16 v[64:79], a[72:75], v[24:27], v[64:79]
    s_add_u32 m0, s66, 11904
    s_nop 0
    buffer_load_dwordx4 v2, s[56:59], s65 offen offset:384 lds
    ds_read_b128 v[44:47], v15 offset:20480
    s_waitcnt lgkmcnt(4)
    v_mfma_f32_32x32x16_bf16 v[64:79], a[76:79], v[28:31], v[64:79]
    ds_read_b128 v[16:19], v12 offset:24576
    s_waitcnt lgkmcnt(4)
    v_mfma_f32_32x32x16_bf16 v[64:79], a[80:83], v[32:35], v[64:79]
    s_add_u32 m0, s66, 15872
    s_nop 0
    buffer_load_dwordx4 v2, s[56:59], s65 offen offset:512 lds
    ds_read_b128 v[20:23], v13 offset:24576
    s_waitcnt lgkmcnt(4)
    v_mfma_f32_32x32x16_bf16 v[64:79], a[84:87], v[36:39], v[64:79]
    ds_read_b128 v[24:27], v14 offset:24576
    s_waitcnt lgkmcnt(4)
    v_mfma_f32_32x32x16_bf16 v[64:79], a[88:91], v[40:43], v[64:79]
    s_add_u32 m0, s66, 19840
    s_nop 0
    buffer_load_dwordx4 v2, s[56:59], s65 offen offset:640 lds
    ds_read_b128 v[28:31], v15 offset:24576
    s_waitcnt lgkmcnt(4)
    v_mfma_f32_32x32x16_bf16 v[64:79], a[92:95], v[44:47], v[64:79]
    ds_read_b128 v[32:35], v12 offset:28672
    s_waitcnt lgkmcnt(4)
    v_mfma_f32_32x32x16_bf16 v[64:79], a[96:99], v[16:19], v[64:79]
    s_add_u32 m0, s66, 23808
    s_nop 0
    buffer_load_dwordx4 v2, s[56:59], s65 offen offset:768 lds
    ds_read_b128 v[36:39], v13 offset:28672
    s_waitcnt lgkmcnt(4)
    v_mfma_f32_32x32x16_bf16 v[64:79], a[100:103], v[20:23], v[64:79]
    ds_read_b128 v[40:43], v14 offset:28672
    s_waitcnt lgkmcnt(4)
    v_mfma_f32_32x32x16_bf16 v[64:79], a[104:107], v[24:27], v[64:79]
    s_add_u32 m0, s66, 27776
    s_nop 0
    buffer_load_dwordx4 v2, s[56:59], s65 offen offset:896 lds
    ds_read_b128 v[44:47], v15 offset:28672
    s_waitcnt lgkmcnt(4)
    v_mfma_f32_32x32x16_bf16 v[64:79], a[108:111], v[28:31], v[64:79]
    ds_read_b128 v[16:19], v12 offset:32768
    s_waitcnt lgkmcnt(4)
    v_mfma_f32_32x32x16_bf16 v[64:79], a[112:115], v[32:35], v[64:79]
    s_add_u32 m0, s66, 31744
    s_nop 0
    buffer_load_dwordx4 v2, s[56:59], s65 offen offset:1024 lds
    ds_read_b128 v[20:23], v13 offset:32768
    s_waitcnt lgkmcnt(4)
    v_mfma_f32_32x32x16_bf16 v[64:79], a[116:119], v[36:39], v[64:79]
    ds_read_b128 v[24:27], v14 offset:32768
    s_waitcnt lgkmcnt(4)
    v_mfma_f32_32x32x16_bf16 v[64:79], a[120:123], v[40:43], v[64:79]
    s_add_u32 m0, s66, 35712
    s_nop 0
    buffer_load_dwordx4 v2, s[56:59], s65 offen offset:1152 lds
    ds_read_b128 v[28:31], v15 offset:32768
    s_waitcnt lgkmcnt(4)
    v_mfma_f32_32x32x16_bf16 v[64:79], a[124:127], v[44:47], v[64:79]
    ds_read_b128 v[32:35], v12 offset:36864
    s_waitcnt lgkmcnt(4)
    v_mfma_f32_32x32x16_bf16 v[64:79], a[128:131], v[16:19], v[64:79]
    s_add_u32 m0, s66, 39680
    s_nop 0
    buffer_load_dwordx4 v2, s[56:59], s65 offen offset:1280 lds
    ds_read_b128 v[36:39], v13 offset:36864
    s_waitcnt lgkmcnt(4)
    v_mfma_f32_32x32x16_bf16 v[64:79], a[132:135], v[20:23], v[64:79]
    ds_read_b128 v[40:43], v14 offset:36864
    s_waitcnt lgkmcnt(4)
    v_mfma_f32_32x32x16_bf16 v[64:79], a[136:139], v[24:27], v[64:79]
    s_add_u32 m0, s66, 43648
    s_nop 0
    buffer_load_dwordx4 v2, s[56:59], s65 offen offset:1408 lds
    ds_read_b128 v[44:47], v15 offset:36864
    s_waitcnt lgkmcnt(4)
    v_mfma_f32_32x32x16_bf16 v[64:79], a[140:143], v[28:31], v[64:79]
    ds_read_b128 v[16:19], v12 offset:40960
    s_waitcnt lgkmcnt(4)
    v_mfma_f32_32x32x16_bf16 v[64:79], a[144:147], v[32:35], v[64:79]
    s_add_u32 m0, s66, 47616
    s_nop 0
    buffer_load_dwordx4 v2, s[56:59], s65 offen offset:1536 lds
    ds_read_b128 v[20:23], v13 offset:40960
    s_waitcnt lgkmcnt(4)
    v_mfma_f32_32x32x16_bf16 v[64:79], a[148:151], v[36:39], v[64:79]
    ds_read_b128 v[24:27], v14 offset:40960
    s_waitcnt lgkmcnt(4)
    v_mfma_f32_32x32x16_bf16 v[64:79], a[152:155], v[40:43], v[64:79]
    s_add_u32 m0, s66, 51584
    s_nop 0
    buffer_load_dwordx4 v2, s[56:59], s65 offen offset:1664 lds
    ds_read_b128 v[28:31], v15 offset:40960
    s_waitcnt lgkmcnt(4)
    v_mfma_f32_32x32x16_bf16 v[64:79], a[156:159], v[44:47], v[64:79]
    ds_read_b128 v[32:35], v12 offset:45056
    s_waitcnt lgkmcnt(4)
    v_mfma_f32_32x32x16_bf16 v[64:79], a[160:163], v[16:19], v[64:79]
    s_add_u32 m0, s66, 55552
    s_nop 0
    buffer_load_dwordx4 v2, s[56:59], s65 offen offset:1792 lds
    ds_read_b128 v[36:39], v13 offset:45056
    s_waitcnt lgkmcnt(4)
    v_mfma_f32_32x32x16_bf16 v[64:79], a[164:167], v[20:23], v[64:79]
    ds_read_b128 v[40:43], v14 offset:45056
    s_waitcnt lgkmcnt(4)
    v_mfma_f32_32x32x16_bf16 v[64:79], a[168:171], v[24:27], v[64:79]
    s_add_u32 m0, s66, 59520
    s_nop 0
    buffer_load_dwordx4 v2, s[56:59], s65 offen offset:1920 lds
    ds_read_b128 v[44:47], v15 offset:45056
    s_waitcnt lgkmcnt(4)
    v_mfma_f32_32x32x16_bf16 v[64:79], a[172:175], v[28:31], v[64:79]
    ds_read_b128 v[16:19], v12 offset:49152
    s_waitcnt lgkmcnt(4)
    v_mfma_f32_32x32x16_bf16 v[64:79], a[176:179], v[32:35], v[64:79]
    ds_read_b128 v[20:23], v13 offset:49152
    s_waitcnt lgkmcnt(4)
    v_mfma_f32_32x32x16_bf16 v[64:79], a[180:183], v[36:39], v[64:79]
    ds_read_b128 v[24:27], v14 offset:49152
    s_waitcnt lgkmcnt(4)
    v_mfma_f32_32x32x16_bf16 v[64:79], a[184:187], v[40:43], v[64:79]
    ds_read_b128 v[28:31], v15 offset:49152
    s_waitcnt lgkmcnt(4)
    v_mfma_f32_32x32x16_bf16 v[64:79], a[188:191], v[44:47], v[64:79]
    ds_read_b128 v[32:35], v12 offset:53248
    s_waitcnt lgkmcnt(4)
    v_mfma_f32_32x32x16_bf16 v[64:79], a[192:195], v[16:19], v[64:79]
    ds_read_b128 v[36:39], v13 offset:53248
    s_waitcnt lgkmcnt(4)
    v_mfma_f32_32x32x16_bf16 v[64:79], a[196:199], v[20:23], v[64:79]
    ds_read_b128 v[40:43], v14 offset:53248
    s_waitcnt lgkmcnt(4)
    v_mfma_f32_32x32x16_bf16 v[64:79], a[200:203], v[24:27], v[64:79]
    ds_read_b128 v[44:47], v15 offset:53248
    s_waitcnt lgkmcnt(4)
    v_mfma_f32_32x32x16_bf16 v[64:79], a[204:207], v[28:31], v[64:79]
    ds_read_b128 v[16:19], v12 offset:57344
    s_waitcnt lgkmcnt(4)
    v_mfma_f32_32x32x16_bf16 v[64:79], a[208:211], v[32:35], v[64:79]
    ds_read_b128 v[20:23], v13 offset:57344
    s_waitcnt lgkmcnt(4)
    v_mfma_f32_32x32x16_bf16 v[64:79], a[212:215], v[36:39], v[64:79]
    ds_read_b128 v[24:27], v14 offset:57344
    s_waitcnt lgkmcnt(4)
    v_mfma_f32_32x32x16_bf16 v[64:79], a[216:219], v[40:43], v[64:79]
    ds_read_b128 v[28:31], v15 offset:57344
    s_waitcnt lgkmcnt(4)
    v_mfma_f32_32x32x16_bf16 v[64:79], a[220:223], v[44:47], v[64:79]
    ds_read_b128 v[32:35], v12 offset:61440
    s_waitcnt lgkmcnt(4)
    v_mfma_f32_32x32x16_bf16 v[64:79], a[224:227], v[16:19], v[64:79]
    ds_read_b128 v[36:39], v13 offset:61440
    s_waitcnt lgkmcnt(4)
    v_mfma_f32_32x32x16_bf16 v[64:79], a[228:231], v[20:23], v[64:79]
    ds_read_b128 v[40:43], v14 offset:61440
    s_waitcnt lgkmcnt(4)
    v_mfma_f32_32x32x16_bf16 v[64:79], a[232:235], v[24:27], v[64:79]
    ds_read_b128 v[44:47], v15 offset:61440
    s_waitcnt lgkmcnt(4)
    v_mfma_f32_32x32x16_bf16 v[64:79], a[236:239], v[28:31], v[64:79]
    s_waitcnt vmcnt(0) lgkmcnt(0)
    s_barrier
    ds_read_b128 v[16:19], v8 offset:0
    v_mfma_f32_32x32x16_bf16 v[64:79], a[240:243], v[32:35], v[64:79]
    ds_read_b128 v[20:23], v9 offset:0
    v_mfma_f32_32x32x16_bf16 v[64:79], a[244:247], v[36:39], v[64:79]
    ds_read_b128 v[24:27], v10 offset:0
    v_mfma_f32_32x32x16_bf16 v[64:79], a[248:251], v[40:43], v[64:79]
    ds_read_b128 v[28:31], v11 offset:0
    v_mfma_f32_32x32x16_bf16 v[64:79], a[252:255], v[44:47], v[64:79]
    s_add_u32 s63, s63, 1
    s_add_u32 s65, s65, 0x10000
    ds_read_b128 v[32:35], v8 offset:4096
    s_waitcnt lgkmcnt(4)
    v_mfma_f32_32x32x16_bf16 v[48:63], a[0:3], v[16:19], 0
    ds_read_b128 v[36:39], v9 offset:4096
    s_waitcnt lgkmcnt(4)
    v_mfma_f32_32x32x16_bf16 v[48:63], a[4:7], v[20:23], v[48:63]
    ds_read_b128 v[40:43], v10 offset:4096
    s_waitcnt lgkmcnt(4)
    v_mfma_f32_32x32x16_bf16 v[48:63], a[8:11], v[24:27], v[48:63]
    v_pk_mul_f32 v[64:65], v[64:65], v[6:7]
    v_cvt_pk_bf16_f32 v80, v64, v65
    ds_read_b128 v[44:47], v11 offset:4096
    s_waitcnt lgkmcnt(4)
    v_mfma_f32_32x32x16_bf16 v[48:63], a[12:15], v[28:31], v[48:63]
    v_pk_mul_f32 v[66:67], v[66:67], v[6:7]
    v_cvt_pk_bf16_f32 v81, v66, v67
    ds_read_b128 v[16:19], v8 offset:8192
    s_waitcnt lgkmcnt(4)
    v_mfma_f32_32x32x16_bf16 v[48:63], a[16:19], v[32:35], v[48:63]
    v_pk_mul_f32 v[68:69], v[68:69], v[6:7]
    v_cvt_pk_bf16_f32 v82, v68, v69
    ds_read_b128 v[20:23], v9 offset:8192
    s_waitcnt lgkmcnt(4)
    v_mfma_f32_32x32x16_bf16 v[48:63], a[20:23], v[36:39], v[48:63]
    v_pk_mul_f32 v[70:71], v[70:71], v[6:7]
    v_cvt_pk_bf16_f32 v83, v70, v71
    ds_write_b128 v5, v[80:83] offset:8192
    ds_read_b128 v[24:27], v10 offset:8192
    s_waitcnt lgkmcnt(5)
    v_mfma_f32_32x32x16_bf16 v[48:63], a[24:27], v[40:43], v[48:63]
    v_pk_mul_f32 v[72:73], v[72:73], v[6:7]
    v_cvt_pk_bf16_f32 v84, v72, v73
    ds_read_b128 v[28:31], v11 offset:8192
    s_waitcnt lgkmcnt(5)
    v_mfma_f32_32x32x16_bf16 v[48:63], a[28:31], v[44:47], v[48:63]
    v_pk_mul_f32 v[74:75], v[74:75], v[6:7]
    v_cvt_pk_bf16_f32 v85, v74, v75
    ds_read_b128 v[32:35], v8 offset:12288
    s_waitcnt lgkmcnt(5)
    v_mfma_f32_32x32x16_bf16 v[48:63], a[32:35], v[16:19], v[48:63]
    v_pk_mul_f32 v[76:77], v[76:77], v[6:7]
    v_cvt_pk_bf16_f32 v86, v76, v77
    ds_read_b128 v[36:39], v9 offset:12288
    s_waitcnt lgkmcnt(5)
    v_mfma_f32_32x32x16_bf16 v[48:63], a[36:39], v[20:23], v[48:63]
    v_pk_mul_f32 v[78:79], v[78:79], v[6:7]
    v_cvt_pk_bf16_f32 v87, v78, v79
    ds_write_b128 v5, v[84:87] offset:9216
    ds_read_b128 v[40:43], v10 offset:12288
    s_waitcnt lgkmcnt(5)
    v_mfma_f32_32x32x16_bf16 v[48:63], a[40:43], v[24:27], v[48:63]
    ds_read_b128 v[44:47], v11 offset:12288
    s_waitcnt lgkmcnt(5)
    v_mfma_f32_32x32x16_bf16 v[48:63], a[44:47], v[28:31], v[48:63]
    ds_read_b128 v[16:19], v8 offset:16384
    s_waitcnt lgkmcnt(5)
    v_mfma_f32_32x32x16_bf16 v[48:63], a[48:51], v[32:35], v[48:63]
    s_add_u32 m0, s66, 65536
    s_nop 0
    buffer_load_dwordx4 v2, s[56:59], s65 offen offset:0 lds
    ds_read_b128 v[20:23], v9 offset:16384
    s_waitcnt lgkmcnt(5)
    v_mfma_f32_32x32x16_bf16 v[48:63], a[52:55], v[36:39], v[48:63]
    ds_read_b128 v[24:27], v10 offset:16384
    s_waitcnt lgkmcnt(4)
    v_mfma_f32_32x32x16_bf16 v[48:63], a[56:59], v[40:43], v[48:63]
    s_add_u32 m0, s66, 69504
    s_nop 0
    buffer_load_dwordx4 v2, s[56:59], s65 offen offset:128 lds
    ds_read_b128 v[28:31], v11 offset:16384
    s_waitcnt lgkmcnt(4)
    v_mfma_f32_32x32x16_bf16 v[48:63], a[60:63], v[44:47], v[48:63]
    ds_read_b128 v[32:35], v8 offset:20480
    s_waitcnt lgkmcnt(4)
    v_mfma_f32_32x32x16_bf16 v[48:63], a[64:67], v[16:19], v[48:63]
    s_add_u32 m0, s66, 73472
    s_nop 0
    buffer_load_dwordx4 v2, s[56:59], s65 offen offset:256 lds
    ds_read_b128 v[36:39], v9 offset:20480
    s_waitcnt lgkmcnt(4)
    v_mfma_f32_32x32x16_bf16 v[48:63], a[68:71], v[20:23], v[48:63]
    ds_read_b128 v[40:43], v10 offset:20480
    s_waitcnt lgkmcnt(4)
    v_mfma_f32_32x32x16_bf16 v[48:63], a[72:75], v[24:27], v[48:63]
    s_add_u32 m0, s66, 77440
    s_nop 0
    buffer_load_dwordx4 v2, s[56:59], s65 offen offset:384 lds
    ds_read_b128 v[44:47], v11 offset:20480
    s_waitcnt lgkmcnt(4)
    v_mfma_f32_32x32x16_bf16 v[48:63], a[76:79], v[28:31], v[48:63]
    ds_read_b128 v[16:19], v8 offset:24576
    s_waitcnt lgkmcnt(4)
    v_mfma_f32_32x32x16_bf16 v[48:63], a[80:83], v[32:35], v[48:63]
    s_add_u32 m0, s66, 81408
    s_nop 0
    buffer_load_dwordx4 v2, s[56:59], s65 offen offset:512 lds
    ds_read_b128 v[20:23], v9 offset:24576
    s_waitcnt lgkmcnt(4)
    v_mfma_f32_32x32x16_bf16 v[48:63], a[84:87], v[36:39], v[48:63]
    ds_read_b128 v[24:27], v10 offset:24576
    s_waitcnt lgkmcnt(4)
    v_mfma_f32_32x32x16_bf16 v[48:63], a[88:91], v[40:43], v[48:63]
    s_add_u32 m0, s66, 85376
    s_nop 0
    buffer_load_dwordx4 v2, s[56:59], s65 offen offset:640 lds
    ds_read_b128 v[28:31], v11 offset:24576
    s_waitcnt lgkmcnt(4)
    v_mfma_f32_32x32x16_bf16 v[48:63], a[92:95], v[44:47], v[48:63]
    ds_read_b128 v[32:35], v8 offset:28672
    s_waitcnt lgkmcnt(4)
    v_mfma_f32_32x32x16_bf16 v[48:63], a[96:99], v[16:19], v[48:63]
    s_add_u32 m0, s66, 89344
    s_nop 0
    buffer_load_dwordx4 v2, s[56:59], s65 offen offset:768 lds
    ds_read_b128 v[36:39], v9 offset:28672
    s_waitcnt lgkmcnt(4)
    v_mfma_f32_32x32x16_bf16 v[48:63], a[100:103], v[20:23], v[48:63]
    ds_read_b128 v[40:43], v10 offset:28672
    s_waitcnt lgkmcnt(4)
    v_mfma_f32_32x32x16_bf16 v[48:63], a[104:107], v[24:27], v[48:63]
    s_add_u32 m0, s66, 93312
    s_nop 0
    buffer_load_dwordx4 v2, s[56:59], s65 offen offset:896 lds
    ds_read_b128 v[44:47], v11 offset:28672
    s_waitcnt lgkmcnt(4)
    v_mfma_f32_32x32x16_bf16 v[48:63], a[108:111], v[28:31], v[48:63]
    ds_read_b128 v[16:19], v8 offset:32768
    s_waitcnt lgkmcnt(4)
    v_mfma_f32_32x32x16_bf16 v[48:63], a[112:115], v[32:35], v[48:63]
    s_add_u32 m0, s66, 97280
    s_nop 0
    buffer_load_dwordx4 v2, s[56:59], s65 offen offset:1024 lds
    ds_read_b128 v[20:23], v9 offset:32768
    s_waitcnt lgkmcnt(4)
    v_mfma_f32_32x32x16_bf16 v[48:63], a[116:119], v[36:39], v[48:63]
    ds_read_b128 v[24:27], v10 offset:32768
    s_waitcnt lgkmcnt(4)
    v_mfma_f32_32x32x16_bf16 v[48:63], a[120:123], v[40:43], v[48:63]
    s_add_u32 m0, s66, 101248
    s_nop 0
    buffer_load_dwordx4 v2, s[56:59], s65 offen offset:1152 lds
    ds_read_b128 v[28:31], v11 offset:32768
    s_waitcnt lgkmcnt(4)
    v_mfma_f32_32x32x16_bf16 v[48:63], a[124:127], v[44:47], v[48:63]
    ds_read_b128 v[32:35], v8 offset:36864
    s_waitcnt lgkmcnt(4)
    v_mfma_f32_32x32x16_bf16 v[48:63], a[128:131], v[16:19], v[48:63]
    s_add_u32 m0, s66, 105216
    s_nop 0
    buffer_load_dwordx4 v2, s[56:59], s65 offen offset:1280 lds
    ds_read_b128 v[36:39], v9 offset:36864
    s_waitcnt lgkmcnt(4)
    v_mfma_f32_32x32x16_bf16 v[48:63], a[132:135], v[20:23], v[48:63]
    ds_read_b128 v[40:43], v10 offset:36864
    s_waitcnt lgkmcnt(4)
    v_mfma_f32_32x32x16_bf16 v[48:63], a[136:139], v[24:27], v[48:63]
    s_add_u32 m0, s66, 109184
    s_nop 0
    buffer_load_dwordx4 v2, s[56:59], s65 offen offset:1408 lds
    ds_read_b128 v[44:47], v11 offset:36864
    s_waitcnt lgkmcnt(4)
    v_mfma_f32_32x32x16_bf16 v[48:63], a[140:143], v[28:31], v[48:63]
    ds_read_b128 v[16:19], v8 offset:40960
    s_waitcnt lgkmcnt(4)
    v_mfma_f32_32x32x16_bf16 v[48:63], a[144:147], v[32:35], v[48:63]
    s_add_u32 m0, s66, 113152
    s_nop 0
    buffer_load_dwordx4 v2, s[56:59], s65 offen offset:1536 lds
    ds_read_b128 v[20:23], v9 offset:40960
    s_waitcnt lgkmcnt(4)
    v_mfma_f32_32x32x16_bf16 v[48:63], a[148:151], v[36:39], v[48:63]
    ds_read_b128 v[24:27], v10 offset:40960
    s_waitcnt lgkmcnt(4)
    v_mfma_f32_32x32x16_bf16 v[48:63], a[152:155], v[40:43], v[48:63]
    s_add_u32 m0, s66, 117120
    s_nop 0
    buffer_load_dwordx4 v2, s[56:59], s65 offen offset:1664 lds
    ds_read_b128 v[28:31], v11 offset:40960
    s_waitcnt lgkmcnt(4)
    v_mfma_f32_32x32x16_bf16 v[48:63], a[156:159], v[44:47], v[48:63]
    ds_read_b128 v[32:35], v8 offset:45056
    s_waitcnt lgkmcnt(4)
    v_mfma_f32_32x32x16_bf16 v[48:63], a[160:163], v[16:19], v[48:63]
    s_add_u32 m0, s66, 121088
    s_nop 0
    buffer_load_dwordx4 v2, s[56:59], s65 offen offset:1792 lds
    ds_read_b128 v[36:39], v9 offset:45056
    s_waitcnt lgkmcnt(4)
    v_mfma_f32_32x32x16_bf16 v[48:63], a[164:167], v[20:23], v[48:63]
    ds_read_b128 v[40:43], v10 offset:45056
    s_waitcnt lgkmcnt(4)
    v_mfma_f32_32x32x16_bf16 v[48:63], a[168:171], v[24:27], v[48:63]
    s_add_u32 m0, s66, 125056
    s_nop 0
    buffer_load_dwordx4 v2, s[56:59], s65 offen offset:1920 lds
    ds_read_b128 v[44:47], v11 offset:45056
    s_waitcnt lgkmcnt(4)
    v_mfma_f32_32x32x16_bf16 v[48:63], a[172:175], v[28:31], v[48:63]
    ds_read_b128 v[16:19], v8 offset:49152
    s_waitcnt lgkmcnt(4)
    v_mfma_f32_32x32x16_bf16 v[48:63], a[176:179], v[32:35], v[48:63]
    ds_read_b128 v[20:23], v9 offset:49152
    s_waitcnt lgkmcnt(4)
    v_mfma_f32_32x32x16_bf16 v[48:63], a[180:183], v[36:39], v[48:63]
    ds_read_b128 v[24:27], v10 offset:49152
    s_waitcnt lgkmcnt(4)
    v_mfma_f32_32x32x16_bf16 v[48:63], a[184:187], v[40:43], v[48:63]
    ds_read_b128 v[28:31], v11 offset:49152
    s_waitcnt lgkmcnt(4)
    v_mfma_f32_32x32x16_bf16 v[48:63], a[188:191], v[44:47], v[48:63]
    ds_read_b128 v[32:35], v8 offset:53248
    s_waitcnt lgkmcnt(4)
    v_mfma_f32_32x32x16_bf16 v[48:63], a[192:195], v[16:19], v[48:63]
    ds_read_b128 v[36:39], v9 offset:53248
    s_waitcnt lgkmcnt(4)
    v_mfma_f32_32x32x16_bf16 v[48:63], a[196:199], v[20:23], v[48:63]
    ds_read_b128 v[40:43], v10 offset:53248
    s_waitcnt lgkmcnt(4)
    v_mfma_f32_32x32x16_bf16 v[48:63], a[200:203], v[24:27], v[48:63]
    ds_read_b128 v[44:47], v11 offset:53248
    s_waitcnt lgkmcnt(4)
    v_mfma_f32_32x32x16_bf16 v[48:63], a[204:207], v[28:31], v[48:63]
    ds_read_b128 v[16:19], v8 offset:57344
    s_waitcnt lgkmcnt(4)
    v_mfma_f32_32x32x16_bf16 v[48:63], a[208:211], v[32:35], v[48:63]
    ds_read_b128 v[20:23], v9 offset:57344
    s_waitcnt lgkmcnt(4)
    v_mfma_f32_32x32x16_bf16 v[48:63], a[212:215], v[36:39], v[48:63]
    ds_read_b128 v[24:27], v10 offset:57344
    s_waitcnt lgkmcnt(4)
    v_mfma_f32_32x32x16_bf16 v[48:63], a[216:219], v[40:43], v[48:63]
    ds_read_b128 v[28:31], v11 offset:57344
    s_waitcnt lgkmcnt(4)
    v_mfma_f32_32x32x16_bf16 v[48:63], a[220:223], v[44:47], v[48:63]
    ds_read_b128 v[32:35], v8 offset:61440
    s_waitcnt lgkmcnt(4)
    v_mfma_f32_32x32x16_bf16 v[48:63], a[224:227], v[16:19], v[48:63]
    ds_read_b128 v[36:39], v9 offset:61440
    s_waitcnt lgkmcnt(4)
    v_mfma_f32_32x32x16_bf16 v[48:63], a[228:231], v[20:23], v[48:63]
    ds_read_b128 v[40:43], v10 offset:61440
    s_waitcnt lgkmcnt(4)
    v_mfma_f32_32x32x16_bf16 v[48:63], a[232:235], v[24:27], v[48:63]
    ds_read_b128 v[44:47], v11 offset:61440
    s_waitcnt lgkmcnt(4)
    v_mfma_f32_32x32x16_bf16 v[48:63], a[236:239], v[28:31], v[48:63]
    s_waitcnt vmcnt(0) lgkmcnt(0)
    s_barrier
    ds_read_b128 v[16:19], v12 offset:0
    v_mfma_f32_32x32x16_bf16 v[48:63], a[240:243], v[32:35], v[48:63]
    ds_read_b128 v[20:23], v13 offset:0
    v_mfma_f32_32x32x16_bf16 v[48:63], a[244:247], v[36:39], v[48:63]
    ds_read_b128 v[24:27], v14 offset:0
    v_mfma_f32_32x32x16_bf16 v[48:63], a[248:251], v[40:43], v[48:63]
    ds_read_b128 v[28:31], v15 offset:0
    v_mfma_f32_32x32x16_bf16 v[48:63], a[252:255], v[44:47], v[48:63]
    s_add_u32 s63, s63, 1
    s_add_u32 s65, s65, 0x10000
    ds_read_b128 v[32:35], v12 offset:4096
    s_waitcnt lgkmcnt(4)
    v_mfma_f32_32x32x16_bf16 v[64:79], a[0:3], v[16:19], 0
    ds_read_b128 v[36:39], v13 offset:4096
    s_waitcnt lgkmcnt(4)
    v_mfma_f32_32x32x16_bf16 v[64:79], a[4:7], v[20:23], v[64:79]
    ds_read_b128 v[40:43], v14 offset:4096
    s_waitcnt lgkmcnt(4)
    v_mfma_f32_32x32x16_bf16 v[64:79], a[8:11], v[24:27], v[64:79]
    v_pk_mul_f32 v[48:49], v[48:49], v[6:7]
    v_cvt_pk_bf16_f32 v80, v48, v49
    ds_read_b128 v[44:47], v15 offset:4096
    s_waitcnt lgkmcnt(4)
    v_mfma_f32_32x32x16_bf16 v[64:79], a[12:15], v[28:31], v[64:79]
    v_pk_mul_f32 v[50:51], v[50:51], v[6:7]
    v_cvt_pk_bf16_f32 v81, v50, v51
    ds_read_b128 v[16:19], v12 offset:8192
    s_waitcnt lgkmcnt(4)
    v_mfma_f32_32x32x16_bf16 v[64:79], a[16:19], v[32:35], v[64:79]
    v_pk_mul_f32 v[52:53], v[52:53], v[6:7]
    v_cvt_pk_bf16_f32 v82, v52, v53
    ds_read_b128 v[20:23], v13 offset:8192
    s_waitcnt lgkmcnt(4)
    v_mfma_f32_32x32x16_bf16 v[64:79], a[20:23], v[36:39], v[64:79]
    v_pk_mul_f32 v[54:55], v[54:55], v[6:7]
    v_cvt_pk_bf16_f32 v83, v54, v55
    ds_write_b128 v5, v[80:83] offset:16384
    ds_read_b128 v[24:27], v14 offset:8192
    s_waitcnt lgkmcnt(5)
    v_mfma_f32_32x32x16_bf16 v[64:79], a[24:27], v[40:43], v[64:79]
    v_pk_mul_f32 v[56:57], v[56:57], v[6:7]
    v_cvt_pk_bf16_f32 v84, v56, v57
    ds_read_b128 v[28:31], v15 offset:8192
    s_waitcnt lgkmcnt(5)
    v_mfma_f32_32x32x16_bf16 v[64:79], a[28:31], v[44:47], v[64:79]
    v_pk_mul_f32 v[58:59], v[58:59], v[6:7]
    v_cvt_pk_bf16_f32 v85, v58, v59
    ds_read_b128 v[32:35], v12 offset:12288
    s_waitcnt lgkmcnt(5)
    v_mfma_f32_32x32x16_bf16 v[64:79], a[32:35], v[16:19], v[64:79]
    v_pk_mul_f32 v[60:61], v[60:61], v[6:7]
    v_cvt_pk_bf16_f32 v86, v60, v61
    ds_read_b128 v[36:39], v13 offset:12288
    s_waitcnt lgkmcnt(5)
    v_mfma_f32_32x32x16_bf16 v[64:79], a[36:39], v[20:23], v[64:79]
    v_pk_mul_f32 v[62:63], v[62:63], v[6:7]
    v_cvt_pk_bf16_f32 v87, v62, v63
    ds_write_b128 v5, v[84:87] offset:17408
    ds_read_b128 v[40:43], v14 offset:12288
    s_waitcnt lgkmcnt(5)
    v_mfma_f32_32x32x16_bf16 v[64:79], a[40:43], v[24:27], v[64:79]
    ds_read_b128 v[44:47], v15 offset:12288
    s_waitcnt lgkmcnt(5)
    v_mfma_f32_32x32x16_bf16 v[64:79], a[44:47], v[28:31], v[64:79]
    ds_read_b128 v[16:19], v12 offset:16384
    s_waitcnt lgkmcnt(5)
    v_mfma_f32_32x32x16_bf16 v[64:79], a[48:51], v[32:35], v[64:79]
    s_add_u32 m0, s66, 0
    s_nop 0
    buffer_load_dwordx4 v2, s[56:59], s65 offen offset:0 lds
    ds_read_b128 v[20:23], v13 offset:16384
    s_waitcnt lgkmcnt(5)
    v_mfma_f32_32x32x16_bf16 v[64:79], a[52:55], v[36:39], v[64:79]
    ds_read_b128 v[24:27], v14 offset:16384
    s_waitcnt lgkmcnt(4)
    v_mfma_f32_32x32x16_bf16 v[64:79], a[56:59], v[40:43], v[64:79]
    s_add_u32 m0, s66, 3968
    s_nop 0
    buffer_load_dwordx4 v2, s[56:59], s65 offen offset:128 lds
    ds_read_b128 v[28:31], v15 offset:16384
    s_waitcnt lgkmcnt(4)
    v_mfma_f32_32x32x16_bf16 v[64:79], a[60:63], v[44:47], v[64:79]
    ds_read_b128 v[32:35], v12 offset:20480
    s_waitcnt lgkmcnt(4)
    v_mfma_f32_32x32x16_bf16 v[64:79], a[64:67], v[16:19], v[64:79]
    s_add_u32 m0, s66, 7936
    s_nop 0
    buffer_load_dwordx4 v2, s[56:59], s65 offen offset:256 lds
    ds_read_b128 v[36:39], v13 offset:20480
    s_waitcnt lgkmcnt(4)
    v_mfma_f32_32x32x16_bf16 v[64:79], a[68:71], v[20:23], v[64:79]
    ds_read_b128 v[40:43], v14 offset:20480
    s_waitcnt lgkmcnt(4)
    v_mfma_f32_32x32x16_bf16 v[64:79], a[72:75], v[24:27], v[64:79]
    s_add_u32 m0, s66, 11904
    s_nop 0
    buffer_load_dwordx4 v2, s[56:59], s65 offen offset:384 lds
    ds_read_b128 v[44:47], v15 offset:20480
    s_waitcnt lgkmcnt(4)
    v_mfma_f32_32x32x16_bf16 v[64:79], a[76:79], v[28:31], v[64:79]
    ds_read_b128 v[16:19], v12 offset:24576
    s_waitcnt lgkmcnt(4)
    v_mfma_f32_32x32x16_bf16 v[64:79], a[80:83], v[32:35], v[64:79]
    s_add_u32 m0, s66, 15872
    s_nop 0
    buffer_load_dwordx4 v2, s[56:59], s65 offen offset:512 lds
    ds_read_b128 v[20:23], v13 offset:24576
    s_waitcnt lgkmcnt(4)
    v_mfma_f32_32x32x16_bf16 v[64:79], a[84:87], v[36:39], v[64:79]
    ds_read_b128 v[24:27], v14 offset:24576
    s_waitcnt lgkmcnt(4)
    v_mfma_f32_32x32x16_bf16 v[64:79], a[88:91], v[40:43], v[64:79]
    s_add_u32 m0, s66, 19840
    s_nop 0
    buffer_load_dwordx4 v2, s[56:59], s65 offen offset:640 lds
    ds_read_b128 v[28:31], v15 offset:24576
    s_waitcnt lgkmcnt(4)
    v_mfma_f32_32x32x16_bf16 v[64:79], a[92:95], v[44:47], v[64:79]
    ds_read_b128 v[32:35], v12 offset:28672
    s_waitcnt lgkmcnt(4)
    v_mfma_f32_32x32x16_bf16 v[64:79], a[96:99], v[16:19], v[64:79]
    s_add_u32 m0, s66, 23808
    s_nop 0
    buffer_load_dwordx4 v2, s[56:59], s65 offen offset:768 lds
    ds_read_b128 v[36:39], v13 offset:28672
    s_waitcnt lgkmcnt(4)
    v_mfma_f32_32x32x16_bf16 v[64:79], a[100:103], v[20:23], v[64:79]
    ds_read_b128 v[40:43], v14 offset:28672
    s_waitcnt lgkmcnt(4)
    v_mfma_f32_32x32x16_bf16 v[64:79], a[104:107], v[24:27], v[64:79]
    s_add_u32 m0, s66, 27776
    s_nop 0
    buffer_load_dwordx4 v2, s[56:59], s65 offen offset:896 lds
    ds_read_b128 v[44:47], v15 offset:28672
    s_waitcnt lgkmcnt(4)
    v_mfma_f32_32x32x16_bf16 v[64:79], a[108:111], v[28:31], v[64:79]
    ds_read_b128 v[16:19], v12 offset:32768
    s_waitcnt lgkmcnt(4)
    v_mfma_f32_32x32x16_bf16 v[64:79], a[112:115], v[32:35], v[64:79]
    s_add_u32 m0, s66, 31744
    s_nop 0
    buffer_load_dwordx4 v2, s[56:59], s65 offen offset:1024 lds
    ds_read_b128 v[20:23], v13 offset:32768
    s_waitcnt lgkmcnt(4)
    v_mfma_f32_32x32x16_bf16 v[64:79], a[116:119], v[36:39], v[64:79]
    ds_read_b128 v[24:27], v14 offset:32768
    s_waitcnt lgkmcnt(4)
    v_mfma_f32_32x32x16_bf16 v[64:79], a[120:123], v[40:43], v[64:79]
    s_add_u32 m0, s66, 35712
    s_nop 0
    buffer_load_dwordx4 v2, s[56:59], s65 offen offset:1152 lds
    ds_read_b128 v[28:31], v15 offset:32768
    s_waitcnt lgkmcnt(4)
    v_mfma_f32_32x32x16_bf16 v[64:79], a[124:127], v[44:47], v[64:79]
    ds_read_b128 v[32:35], v12 offset:36864
    s_waitcnt lgkmcnt(4)
    v_mfma_f32_32x32x16_bf16 v[64:79], a[128:131], v[16:19], v[64:79]
    s_add_u32 m0, s66, 39680
    s_nop 0
    buffer_load_dwordx4 v2, s[56:59], s65 offen offset:1280 lds
    ds_read_b128 v[36:39], v13 offset:36864
    s_waitcnt lgkmcnt(4)
    v_mfma_f32_32x32x16_bf16 v[64:79], a[132:135], v[20:23], v[64:79]
    ds_read_b128 v[40:43], v14 offset:36864
    s_waitcnt lgkmcnt(4)
    v_mfma_f32_32x32x16_bf16 v[64:79], a[136:139], v[24:27], v[64:79]
    s_add_u32 m0, s66, 43648
    s_nop 0
    buffer_load_dwordx4 v2, s[56:59], s65 offen offset:1408 lds
    ds_read_b128 v[44:47], v15 offset:36864
    s_waitcnt lgkmcnt(4)
    v_mfma_f32_32x32x16_bf16 v[64:79], a[140:143], v[28:31], v[64:79]
    ds_read_b128 v[16:19], v12 offset:40960
    s_waitcnt lgkmcnt(4)
    v_mfma_f32_32x32x16_bf16 v[64:79], a[144:147], v[32:35], v[64:79]
    s_add_u32 m0, s66, 47616
    s_nop 0
    buffer_load_dwordx4 v2, s[56:59], s65 offen offset:1536 lds
    ds_read_b128 v[20:23], v13 offset:40960
    s_waitcnt lgkmcnt(4)
    v_mfma_f32_32x32x16_bf16 v[64:79], a[148:151], v[36:39], v[64:79]
    ds_read_b128 v[24:27], v14 offset:40960
    s_waitcnt lgkmcnt(4)
    v_mfma_f32_32x32x16_bf16 v[64:79], a[152:155], v[40:43], v[64:79]
    s_add_u32 m0, s66, 51584
    s_nop 0
    buffer_load_dwordx4 v2, s[56:59], s65 offen offset:1664 lds
    ds_read_b128 v[28:31], v15 offset:40960
    s_waitcnt lgkmcnt(4)
    v_mfma_f32_32x32x16_bf16 v[64:79], a[156:159], v[44:47], v[64:79]
    ds_read_b128 v[32:35], v12 offset:45056
    s_waitcnt lgkmcnt(4)
    v_mfma_f32_32x32x16_bf16 v[64:79], a[160:163], v[16:19], v[64:79]
    s_add_u32 m0, s66, 55552
    s_nop 0
    buffer_load_dwordx4 v2, s[56:59], s65 offen offset:1792 lds
    ds_read_b128 v[36:39], v13 offset:45056
    s_waitcnt lgkmcnt(4)
    v_mfma_f32_32x32x16_bf16 v[64:79], a[164:167], v[20:23], v[64:79]
    ds_read_b128 v[40:43], v14 offset:45056
    s_waitcnt lgkmcnt(4)
    v_mfma_f32_32x32x16_bf16 v[64:79], a[168:171], v[24:27], v[64:79]
    s_add_u32 m0, s66, 59520
    s_nop 0
    buffer_load_dwordx4 v2, s[56:59], s65 offen offset:1920 lds
    ds_read_b128 v[44:47], v15 offset:45056
    s_waitcnt lgkmcnt(4)
    v_mfma_f32_32x32x16_bf16 v[64:79], a[172:175], v[28:31], v[64:79]
    ds_read_b128 v[16:19], v12 offset:49152
    s_waitcnt lgkmcnt(4)
    v_mfma_f32_32x32x16_bf16 v[64:79], a[176:179], v[32:35], v[64:79]
    ds_read_b128 v[20:23], v13 offset:49152
    s_waitcnt lgkmcnt(4)
    v_mfma_f32_32x32x16_bf16 v[64:79], a[180:183], v[36:39], v[64:79]
    ds_read_b128 v[24:27], v14 offset:49152
    s_waitcnt lgkmcnt(4)
    v_mfma_f32_32x32x16_bf16 v[64:79], a[184:187], v[40:43], v[64:79]
    ds_read_b128 v[28:31], v15 offset:49152
    s_waitcnt lgkmcnt(4)
    v_mfma_f32_32x32x16_bf16 v[64:79], a[188:191], v[44:47], v[64:79]
    ds_read_b128 v[32:35], v12 offset:53248
    s_waitcnt lgkmcnt(4)
    v_mfma_f32_32x32x16_bf16 v[64:79], a[192:195], v[16:19], v[64:79]
    ds_read_b128 v[36:39], v13 offset:53248
    s_waitcnt lgkmcnt(4)
    v_mfma_f32_32x32x16_bf16 v[64:79], a[196:199], v[20:23], v[64:79]
    ds_read_b128 v[40:43], v14 offset:53248
    s_waitcnt lgkmcnt(4)
    v_mfma_f32_32x32x16_bf16 v[64:79], a[200:203], v[24:27], v[64:79]
    ds_read_b128 v[44:47], v15 offset:53248
    s_waitcnt lgkmcnt(4)
    v_mfma_f32_32x32x16_bf16 v[64:79], a[204:207], v[28:31], v[64:79]
    ds_read_b128 v[16:19], v12 offset:57344
    s_waitcnt lgkmcnt(4)
    v_mfma_f32_32x32x16_bf16 v[64:79], a[208:211], v[32:35], v[64:79]
    ds_read_b128 v[20:23], v13 offset:57344
    s_waitcnt lgkmcnt(4)
    v_mfma_f32_32x32x16_bf16 v[64:79], a[212:215], v[36:39], v[64:79]
    ds_read_b128 v[24:27], v14 offset:57344
    s_waitcnt lgkmcnt(4)
    v_mfma_f32_32x32x16_bf16 v[64:79], a[216:219], v[40:43], v[64:79]
    ds_read_b128 v[28:31], v15 offset:57344
    s_waitcnt lgkmcnt(4)
    v_mfma_f32_32x32x16_bf16 v[64:79], a[220:223], v[44:47], v[64:79]
    ds_read_b128 v[32:35], v12 offset:61440
    s_waitcnt lgkmcnt(4)
    v_mfma_f32_32x32x16_bf16 v[64:79], a[224:227], v[16:19], v[64:79]
    ds_read_b128 v[36:39], v13 offset:61440
    s_waitcnt lgkmcnt(4)
    v_mfma_f32_32x32x16_bf16 v[64:79], a[228:231], v[20:23], v[64:79]
    ds_read_b128 v[40:43], v14 offset:61440
    s_waitcnt lgkmcnt(4)
    v_mfma_f32_32x32x16_bf16 v[64:79], a[232:235], v[24:27], v[64:79]
    ds_read_b128 v[44:47], v15 offset:61440
    s_waitcnt lgkmcnt(4)
    v_mfma_f32_32x32x16_bf16 v[64:79], a[236:239], v[28:31], v[64:79]
    s_waitcnt vmcnt(0) lgkmcnt(0)
    s_barrier
    v_mfma_f32_32x32x16_bf16 v[64:79], a[240:243], v[32:35], v[64:79]
    v_mfma_f32_32x32x16_bf16 v[64:79], a[244:247], v[36:39], v[64:79]
    v_mfma_f32_32x32x16_bf16 v[64:79], a[248:251], v[40:43], v[64:79]
    v_mfma_f32_32x32x16_bf16 v[64:79], a[252:255], v[44:47], v[64:79]
    s_add_u32 s63, s63, 1
    s_add_u32 s65, s65, 0x10000
    s_nop 9
    v_pk_mul_f32 v[64:65], v[64:65], v[6:7]
    v_cvt_pk_bf16_f32 v80, v64, v65
    v_pk_mul_f32 v[66:67], v[66:67], v[6:7]
    v_cvt_pk_bf16_f32 v81, v66, v67
    v_pk_mul_f32 v[68:69], v[68:69], v[6:7]
    v_cvt_pk_bf16_f32 v82, v68, v69
    v_pk_mul_f32 v[70:71], v[70:71], v[6:7]
    v_cvt_pk_bf16_f32 v83, v70, v71
    ds_write_b128 v5, v[80:83] offset:24576
    v_pk_mul_f32 v[72:73], v[72:73], v[6:7]
    v_cvt_pk_bf16_f32 v84, v72, v73
    v_pk_mul_f32 v[74:75], v[74:75], v[6:7]
    v_cvt_pk_bf16_f32 v85, v74, v75
    v_pk_mul_f32 v[76:77], v[76:77], v[6:7]
    v_cvt_pk_bf16_f32 v86, v76, v77
    v_pk_mul_f32 v[78:79], v[78:79], v[6:7]
    v_cvt_pk_bf16_f32 v87, v78, v79
    ds_write_b128 v5, v[84:87] offset:25600
    s_cmp_eq_u32 s72, -1
    s_cbranch_scc1 Lw_Qpick
Lw_Qatt:
    s_lshl_b32 s70, s72, 2
    s_add_u32 s70, s70, s4
    s_add_u32 s73, s70, 1
    s_lshl_b32 s71, s62, 7
    s_add_u32 s71, s71, 3145728
    s_mov_b64 exec, 255
w_36:
    buffer_load_dword v4, v242, s[48:51], s71 offen sc1
    s_waitcnt vmcnt(0)
    v_cmp_gt_u32 vcc, s73, v4
    s_cbranch_vccz wok_37
    s_sleep 2
    s_sub_u32 s46, s46, 1
    s_cbranch_scc0 w_36
    s_mov_b32 s46, 0
    s_branch wok_37
wok_37:
    s_mov_b64 exec, -1
    s_lshl_b32 s67, s70, 18
    s_lshl_b32 s69, s62, 13
    s_add_u32 s67, s67, s69
    s_add_u32 s69, s67, 16777216
    buffer_load_dwordx4 v[128:131], v1, s[48:51], s69 offen offset:0 sc1
    buffer_load_dwordx4 v[132:135], v1, s[48:51], s69 offen offset:1024 sc1
    buffer_load_dwordx4 v[136:139], v1, s[48:51], s69 offen offset:2048 sc1
    buffer_load_dwordx4 v[140:143], v1, s[48:51], s69 offen offset:3072 sc1
    s_add_u32 s69, s67, 16781312
    buffer_load_dwordx4 v[144:147], v1, s[48:51], s69 offen offset:0 sc1
    buffer_load_dwordx4 v[148:151], v1, s[48:51], s69 offen offset:1024 sc1
    buffer_load_dwordx4 v[152:155], v1, s[48:51], s69 offen offset:2048 sc1
    buffer_load_dwordx4 v[156:159], v1, s[48:51], s69 offen offset:3072 sc1
    s_add_u32 s69, s67, 33554432
    buffer_load_dwordx4 v[192:195], v1, s[48:51], s69 offen offset:0 sc1
    buffer_load_dwordx4 v[196:199], v1, s[48:51], s69 offen offset:1024 sc1
    buffer_load_dwordx4 v[200:203], v1, s[48:51], s69 offen offset:2048 sc1
    buffer_load_dwordx4 v[204:207], v1, s[48:51], s69 offen offset:3072 sc1
    s_add_u32 s69, s67, 33558528
    buffer_load_dwordx4 v[208:211], v1, s[48:51], s69 offen offset:0 sc1
    buffer_load_dwordx4 v[212:215], v1, s[48:51], s69 offen offset:1024 sc1
    buffer_load_dwordx4 v[216:219], v1, s[48:51], s69 offen offset:2048 sc1
    buffer_load_dwordx4 v[220:223], v1, s[48:51], s69 offen offset:3072 sc1
    s_waitcnt vmcnt(15)
    v_mfma_f32_32x32x16_bf16 v[48:63], v[128:131], v[96:99], 0
    s_waitcnt vmcnt(14)
    v_mfma_f32_32x32x16_bf16 v[48:63], v[132:135], v[100:103], v[48:63]
    s_waitcnt vmcnt(13)
    v_mfma_f32_32x32x16_bf16 v[48:63], v[136:139], v[104:107], v[48:63]
    s_waitcnt vmcnt(12)
    v_mfma_f32_32x32x16_bf16 v[48:63], v[140:143], v[108:111], v[48:63]
    s_waitcnt vmcnt(11)
    v_mfma_f32_32x32x16_bf16 v[48:63], v[144:147], v[112:115], v[48:63]
    s_waitcnt vmcnt(10)
    v_mfma_f32_32x32x16_bf16 v[48:63], v[148:151], v[116:119], v[48:63]
    s_waitcnt vmcnt(9)
    v_mfma_f32_32x32x16_bf16 v[48:63], v[152:155], v[120:123], v[48:63]
    s_waitcnt vmcnt(8)
    v_mfma_f32_32x32x16_bf16 v[48:63], v[156:159], v[124:127], v[48:63]
    s_add_u32 s71, s71, 4096
    s_mov_b64 exec, 15
w_38:
    buffer_load_dword v4, v1, s[48:51], s71 offen sc1
    s_waitcnt vmcnt(0)
    v_cmp_gt_u32 vcc, s73, v4
    s_cbranch_vccz wok_39
    s_sleep 2
    s_sub_u32 s46, s46, 1
    s_cbranch_scc0 w_38
    s_mov_b32 s46, 0
    s_branch wok_39
wok_39:
    s_mov_b64 exec, -1
    s_lshr_b32 s69, s70, 3
    s_xor_b32 s69, s69, s64
    s_and_b32 s69, s69, 1
    s_lshl_b32 s69, s69, 13
    s_lshl_b32 s71, s70, 18
    s_add_u32 s71, s71, s69
    s_add_u32 s71, s71, 150994944
    s_lshr_b32 s69, s62, 1
    s_lshl_b32 s69, s69, 14
    s_add_u32 s71, s71, s69
    s_and_b32 s69, s62, 1
    s_lshl_b32 s69, s69, 12
    s_add_u32 s71, s71, s69
    buffer_load_dwordx4 v[160:163], v240, s[48:51], s71 offen offset:0 sc1
    buffer_load_dwordx4 v[164:167], v240, s[48:51], s71 offen offset:512 sc1
    buffer_load_dwordx4 v[168:171], v240, s[48:51], s71 offen offset:1024 sc1
    buffer_load_dwordx4 v[172:175], v240, s[48:51], s71 offen offset:1536 sc1
    buffer_load_dwordx4 v[176:179], v240, s[48:51], s71 offen offset:2048 sc1
    buffer_load_dwordx4 v[180:183], v240, s[48:51], s71 offen offset:2560 sc1
    buffer_load_dwordx4 v[184:187], v240, s[48:51], s71 offen offset:3072 sc1
    buffer_load_dwordx4 v[188:191], v240, s[48:51], s71 offen offset:3584 sc1
    buffer_load_dword v224, v241, s[48:51], s71 offen offset:0 sc1
    buffer_load_dword v225, v241, s[48:51], s71 offen offset:256 sc1
    buffer_load_dword v228, v241, s[48:51], s71 offen offset:1024 sc1
    buffer_load_dword v229, v241, s[48:51], s71 offen offset:1280 sc1
    buffer_load_dword v232, v241, s[48:51], s71 offen offset:2048 sc1
    buffer_load_dword v233, v241, s[48:51], s71 offen offset:2304 sc1
    buffer_load_dword v236, v241, s[48:51], s71 offen offset:3072 sc1
    buffer_load_dword v237, v241, s[48:51], s71 offen offset:3328 sc1
    v_mov_b32 v244, 0xceabdc6e
    v_cndmask_b32 v48, v244, v48, s[8:9]
    v_cndmask_b32 v49, v244, v49, s[10:11]
    v_cndmask_b32 v50, v244, v50, s[12:13]
    v_cndmask_b32 v51, v244, v51, s[14:15]
    v_cndmask_b32 v52, v244, v52, s[16:17]
    v_cndmask_b32 v53, v244, v53, s[18:19]
    v_cndmask_b32 v54, v244, v54, s[20:21]
    v_cndmask_b32 v55, v244, v55, s[22:23]
    v_cndmask_b32 v56, v244, v56, s[24:25]
    v_cndmask_b32 v57, v244, v57, s[26:27]
    v_cndmask_b32 v58, v244, v58, s[28:29]
    v_cndmask_b32 v59, v244, v59, s[30:31]
    v_cndmask_b32 v60, v244, v60, s[32:33]
    v_cndmask_b32 v61, v244, v61, s[34:35]
    v_cndmask_b32 v62, v244, v62, s[36:37]
    v_cndmask_b32 v63, v244, v63, s[38:39]
    v_max3_f32 v244, v48, v49, v50
    v_max3_f32 v244, v244, v51, v52
    v_max3_f32 v244, v244, v53, v54
    v_max3_f32 v244, v244, v55, v56
    v_max3_f32 v244, v244, v57, v58
    v_max3_f32 v244, v244, v59, v60
    v_max3_f32 v244, v244, v61, v62
    v_max_f32 v244, v244, v63
    s_waitcnt vmcnt(15)
    v_mfma_f32_32x32x16_bf16 v[64:79], v[160:163], v[96:99], 0
    s_waitcnt vmcnt(14)
    v_mfma_f32_32x32x16_bf16 v[64:79], v[164:167], v[100:103], v[64:79]
    s_waitcnt vmcnt(13)
    v_mfma_f32_32x32x16_bf16 v[64:79], v[168:171], v[104:107], v[64:79]
    s_waitcnt vmcnt(12)
    v_mfma_f32_32x32x16_bf16 v[64:79], v[172:175], v[108:111], v[64:79]
    s_waitcnt vmcnt(11)
    v_mfma_f32_32x32x16_bf16 v[64:79], v[176:179], v[112:115], v[64:79]
    s_waitcnt vmcnt(10)
    v_mfma_f32_32x32x16_bf16 v[64:79], v[180:183], v[116:119], v[64:79]
    s_waitcnt vmcnt(9)
    v_mfma_f32_32x32x16_bf16 v[64:79], v[184:187], v[120:123], v[64:79]
    s_waitcnt vmcnt(8)
    v_mfma_f32_32x32x16_bf16 v[64:79], v[188:191], v[124:127], v[64:79]
    s_nop 11
    v_max3_f32 v244, v244, v64, v65
    v_max3_f32 v244, v244, v66, v67
    v_mov_b32 v246, v244
    s_nop 1
    v_permlane32_swap_b32 v244, v246
    v_max_f32 v244, v244, v246
    v_pk_add_f32 v[48:49], v[48:49], v[244:245] op_sel_hi:[1,0] neg_lo:[0,1] neg_hi:[0,1]
    v_pk_add_f32 v[50:51], v[50:51], v[244:245] op_sel_hi:[1,0] neg_lo:[0,1] neg_hi:[0,1]
    v_pk_add_f32 v[52:53], v[52:53], v[244:245] op_sel_hi:[1,0] neg_lo:[0,1] neg_hi:[0,1]
    v_pk_add_f32 v[54:55], v[54:55], v[244:245] op_sel_hi:[1,0] neg_lo:[0,1] neg_hi:[0,1]
    v_pk_add_f32 v[56:57], v[56:57], v[244:245] op_sel_hi:[1,0] neg_lo:[0,1] neg_hi:[0,1]
    v_pk_add_f32 v[58:59], v[58:59], v[244:245] op_sel_hi:[1,0] neg_lo:[0,1] neg_hi:[0,1]
    v_pk_add_f32 v[60:61], v[60:61], v[244:245] op_sel_hi:[1,0] neg_lo:[0,1] neg_hi:[0,1]
    v_pk_add_f32 v[62:63], v[62:63], v[244:245] op_sel_hi:[1,0] neg_lo:[0,1] neg_hi:[0,1]
    v_pk_add_f32 v[64:65], v[64:65], v[244:245] op_sel_hi:[1,0] neg_lo:[0,1] neg_hi:[0,1]
    v_pk_add_f32 v[66:67], v[66:67], v[244:245] op_sel_hi:[1,0] neg_lo:[0,1] neg_hi:[0,1]
    v_exp_f32 v48, v48
    v_exp_f32 v49, v49
    v_exp_f32 v50, v50
    v_exp_f32 v51, v51
    v_exp_f32 v52, v52
    v_exp_f32 v53, v53
    v_exp_f32 v54, v54
    v_exp_f32 v55, v55
    v_exp_f32 v56, v56
    v_exp_f32 v57, v57
    v_exp_f32 v58, v58
    v_exp_f32 v59, v59
    v_exp_f32 v60, v60
    v_exp_f32 v61, v61
    v_exp_f32 v62, v62
    v_exp_f32 v63, v63
    v_exp_f32 v64, v64
    v_exp_f32 v65, v65
    v_exp_f32 v66, v66
    v_exp_f32 v67, v67
    v_cvt_pk_bf16_f32 v80, v48, v49
    v_cvt_pk_bf16_f32 v81, v50, v51
    v_cvt_pk_bf16_f32 v82, v52, v53
    v_cvt_pk_bf16_f32 v83, v54, v55
    v_cvt_pk_bf16_f32 v84, v56, v57
    v_cvt_pk_bf16_f32 v85, v58, v59
    v_cvt_pk_bf16_f32 v86, v60, v61
    v_cvt_pk_bf16_f32 v87, v62, v63
    v_cvt_pk_bf16_f32 v88, v64, v65
    v_cvt_pk_bf16_f32 v89, v66, v67
    v_mov_b64 v[90:91], 0
    s_waitcnt vmcnt(0)
    v_mfma_f32_32x32x16_bf16 v[128:143], v[192:195], v[80:83], 0
    v_pk_add_f32 v[246:247], v[48:49], v[50:51]
    v_pk_add_f32 v[246:247], v[246:247], v[52:53]
    v_pk_add_f32 v[246:247], v[246:247], v[54:55]
    v_mfma_f32_32x32x16_bf16 v[128:143], v[196:199], v[84:87], v[128:143]
    v_pk_add_f32 v[246:247], v[246:247], v[56:57]
    v_pk_add_f32 v[246:247], v[246:247], v[58:59]
    v_pk_add_f32 v[246:247], v[246:247], v[60:61]
    v_mfma_f32_32x32x16_bf16 v[128:143], v[224:227], v[88:91], v[128:143]
    v_pk_add_f32 v[246:247], v[246:247], v[62:63]
    v_pk_add_f32 v[246:247], v[246:247], v[64:65]
    v_pk_add_f32 v[246:247], v[246:247], v[66:67]
    v_mfma_f32_32x32x16_bf16 v[144:159], v[200:203], v[80:83], 0
    v_add_f32 v246, v246, v247
    v_mov_b32 v247, v246
    s_nop 1
    v_permlane32_swap_b32 v246, v247
    v_mfma_f32_32x32x16_bf16 v[144:159], v[204:207], v[84:87], v[144:159]
    v_add_f32 v246, v246, v247
    v_rcp_f32 v246, v246
    v_mfma_f32_32x32x16_bf16 v[144:159], v[228:231], v[88:91], v[144:159]
    v_mfma_f32_32x32x16_bf16 v[160:175], v[208:211], v[80:83], 0
    v_mfma_f32_32x32x16_bf16 v[160:175], v[212:215], v[84:87], v[160:175]
    v_mfma_f32_32x32x16_bf16 v[160:175], v[232:235], v[88:91], v[160:175]
    v_mfma_f32_32x32x16_bf16 v[176:191], v[216:219], v[80:83], 0
    v_mfma_f32_32x32x16_bf16 v[176:191], v[220:223], v[84:87], v[176:191]
    v_mfma_f32_32x32x16_bf16 v[176:191], v[236:239], v[88:91], v[176:191]
    s_add_u32 s69, s67, 67108864
    v_pk_mul_f32 v[128:129], v[128:129], v[246:247] op_sel_hi:[1,0]
    v_cvt_pk_bf16_f32 v48, v128, v129
    v_pk_mul_f32 v[130:131], v[130:131], v[246:247] op_sel_hi:[1,0]
    v_cvt_pk_bf16_f32 v49, v130, v131
    v_pk_mul_f32 v[132:133], v[132:133], v[246:247] op_sel_hi:[1,0]
    v_cvt_pk_bf16_f32 v50, v132, v133
    v_pk_mul_f32 v[134:135], v[134:135], v[246:247] op_sel_hi:[1,0]
    v_cvt_pk_bf16_f32 v51, v134, v135
    buffer_store_dwordx4 v[48:51], v1, s[48:51], s69 offen offset:0
    v_pk_mul_f32 v[136:137], v[136:137], v[246:247] op_sel_hi:[1,0]
    v_cvt_pk_bf16_f32 v52, v136, v137
    v_pk_mul_f32 v[138:139], v[138:139], v[246:247] op_sel_hi:[1,0]
    v_cvt_pk_bf16_f32 v53, v138, v139
    v_pk_mul_f32 v[140:141], v[140:141], v[246:247] op_sel_hi:[1,0]
    v_cvt_pk_bf16_f32 v54, v140, v141
    v_pk_mul_f32 v[142:143], v[142:143], v[246:247] op_sel_hi:[1,0]
    v_cvt_pk_bf16_f32 v55, v142, v143
    buffer_store_dwordx4 v[52:55], v1, s[48:51], s69 offen offset:1024
    v_pk_mul_f32 v[144:145], v[144:145], v[246:247] op_sel_hi:[1,0]
    v_cvt_pk_bf16_f32 v56, v144, v145
    v_pk_mul_f32 v[146:147], v[146:147], v[246:247] op_sel_hi:[1,0]
    v_cvt_pk_bf16_f32 v57, v146, v147
    v_pk_mul_f32 v[148:149], v[148:149], v[246:247] op_sel_hi:[1,0]
    v_cvt_pk_bf16_f32 v58, v148, v149
    v_pk_mul_f32 v[150:151], v[150:151], v[246:247] op_sel_hi:[1,0]
    v_cvt_pk_bf16_f32 v59, v150, v151
    buffer_store_dwordx4 v[56:59], v1, s[48:51], s69 offen offset:2048
    v_pk_mul_f32 v[152:153], v[152:153], v[246:247] op_sel_hi:[1,0]
    v_cvt_pk_bf16_f32 v60, v152, v153
    v_pk_mul_f32 v[154:155], v[154:155], v[246:247] op_sel_hi:[1,0]
    v_cvt_pk_bf16_f32 v61, v154, v155
    v_pk_mul_f32 v[156:157], v[156:157], v[246:247] op_sel_hi:[1,0]
    v_cvt_pk_bf16_f32 v62, v156, v157
    v_pk_mul_f32 v[158:159], v[158:159], v[246:247] op_sel_hi:[1,0]
    v_cvt_pk_bf16_f32 v63, v158, v159
    buffer_store_dwordx4 v[60:63], v1, s[48:51], s69 offen offset:3072
    s_add_u32 s69, s67, 67112960
    v_pk_mul_f32 v[160:161], v[160:161], v[246:247] op_sel_hi:[1,0]
    v_cvt_pk_bf16_f32 v48, v160, v161
    v_pk_mul_f32 v[162:163], v[162:163], v[246:247] op_sel_hi:[1,0]
    v_cvt_pk_bf16_f32 v49, v162, v163
    v_pk_mul_f32 v[164:165], v[164:165], v[246:247] op_sel_hi:[1,0]
    v_cvt_pk_bf16_f32 v50, v164, v165
    v_pk_mul_f32 v[166:167], v[166:167], v[246:247] op_sel_hi:[1,0]
    v_cvt_pk_bf16_f32 v51, v166, v167
    buffer_store_dwordx4 v[48:51], v1, s[48:51], s69 offen offset:0
    v_pk_mul_f32 v[168:169], v[168:169], v[246:247] op_sel_hi:[1,0]
    v_cvt_pk_bf16_f32 v52, v168, v169
    v_pk_mul_f32 v[170:171], v[170:171], v[246:247] op_sel_hi:[1,0]
    v_cvt_pk_bf16_f32 v53, v170, v171
    v_pk_mul_f32 v[172:173], v[172:173], v[246:247] op_sel_hi:[1,0]
    v_cvt_pk_bf16_f32 v54, v172, v173
    v_pk_mul_f32 v[174:175], v[174:175], v[246:247] op_sel_hi:[1,0]
    v_cvt_pk_bf16_f32 v55, v174, v175
    buffer_store_dwordx4 v[52:55], v1, s[48:51], s69 offen offset:1024
    v_pk_mul_f32 v[176:177], v[176:177], v[246:247] op_sel_hi:[1,0]
    v_cvt_pk_bf16_f32 v56, v176, v177
    v_pk_mul_f32 v[178:179], v[178:179], v[246:247] op_sel_hi:[1,0]
    v_cvt_pk_bf16_f32 v57, v178, v179
    v_pk_mul_f32 v[180:181], v[180:181], v[246:247] op_sel_hi:[1,0]
    v_cvt_pk_bf16_f32 v58, v180, v181
    v_pk_mul_f32 v[182:183], v[182:183], v[246:247] op_sel_hi:[1,0]
    v_cvt_pk_bf16_f32 v59, v182, v183
    buffer_store_dwordx4 v[56:59], v1, s[48:51], s69 offen offset:2048
    v_pk_mul_f32 v[184:185], v[184:185], v[246:247] op_sel_hi:[1,0]
    v_cvt_pk_bf16_f32 v60, v184, v185
    v_pk_mul_f32 v[186:187], v[186:187], v[246:247] op_sel_hi:[1,0]
    v_cvt_pk_bf16_f32 v61, v186, v187
    v_pk_mul_f32 v[188:189], v[188:189], v[246:247] op_sel_hi:[1,0]
    v_cvt_pk_bf16_f32 v62, v188, v189
    v_pk_mul_f32 v[190:191], v[190:191], v[246:247] op_sel_hi:[1,0]
    v_cvt_pk_bf16_f32 v63, v190, v191
    buffer_store_dwordx4 v[60:63], v1, s[48:51], s69 offen offset:3072
    s_add_u32 s70, s72, 1
    s_waitcnt vmcnt(0)
    v_mov_b32 v3, s70
    v_mov_b32 v4, 0
    s_mov_b64 exec, 1
    buffer_store_dword v3, v4, s[48:51], s68 offen
    s_mov_b64 exec, -1
    s_cmp_eq_u32 s72, 15
    s_cbranch_scc1 Lw_end
Lw_Qpick:
    s_waitcnt lgkmcnt(0)
    s_barrier
    ds_read_b128 v[96:99], v243 offset:0
    ds_read_b128 v[100:103], v243 offset:1024
    ds_read_b128 v[104:107], v243 offset:2048
    ds_read_b128 v[108:111], v243 offset:3072
    ds_read_b128 v[112:115], v243 offset:4096
    ds_read_b128 v[116:119], v243 offset:5120
    ds_read_b128 v[120:123], v243 offset:6144
    ds_read_b128 v[124:127], v243 offset:7168
    s_add_u32 s72, s72, 1
    s_waitcnt lgkmcnt(0)
    s_barrier
    s_branch Lw_Qloop
Lw_end:
    s_endpgm
Lw_K:
    s_lshl_b32 s67, s62, 2
    s_add_u32 s67, s67, s4
    s_lshl_b32 s67, s67, 11
    s_add_u32 s67, s67, 16777216
    ds_read_b128 v[16:19], v8 offset:0
    ds_read_b128 v[20:23], v9 offset:0
    ds_read_b128 v[24:27], v10 offset:0
    ds_read_b128 v[28:31], v11 offset:0
    ds_read_b128 v[32:35], v8 offset:4096
    s_waitcnt lgkmcnt(4)
    v_mfma_f32_32x32x16_bf16 v[48:63], a[0:3], v[16:19], 0
    ds_read_b128 v[36:39], v9 offset:4096
    s_waitcnt lgkmcnt(4)
    v_mfma_f32_32x32x16_bf16 v[48:63], a[4:7], v[20:23], v[48:63]
    ds_read_b128 v[40:43], v10 offset:4096
    s_waitcnt lgkmcnt(4)
    v_mfma_f32_32x32x16_bf16 v[48:63], a[8:11], v[24:27], v[48:63]
    ds_read_b128 v[44:47], v11 offset:4096
    s_waitcnt lgkmcnt(4)
    v_mfma_f32_32x32x16_bf16 v[48:63], a[12:15], v[28:31], v[48:63]
    ds_read_b128 v[16:19], v8 offset:8192
    s_waitcnt lgkmcnt(4)
    v_mfma_f32_32x32x16_bf16 v[48:63], a[16:19], v[32:35], v[48:63]
    ds_read_b128 v[20:23], v9 offset:8192
    s_waitcnt lgkmcnt(4)
    v_mfma_f32_32x32x16_bf16 v[48:63], a[20:23], v[36:39], v[48:63]
    ds_read_b128 v[24:27], v10 offset:8192
    s_waitcnt lgkmcnt(4)
    v_mfma_f32_32x32x16_bf16 v[48:63], a[24:27], v[40:43], v[48:63]
    ds_read_b128 v[28:31], v11 offset:8192
    s_waitcnt lgkmcnt(4)
    v_mfma_f32_32x32x16_bf16 v[48:63], a[28:31], v[44:47], v[48:63]
    ds_read_b128 v[32:35], v8 offset:12288
    s_waitcnt lgkmcnt(4)
    v_mfma_f32_32x32x16_bf16 v[48:63], a[32:35], v[16:19], v[48:63]
    ds_read_b128 v[36:39], v9 offset:12288
    s_waitcnt lgkmcnt(4)
    v_mfma_f32_32x32x16_bf16 v[48:63], a[36:39], v[20:23], v[48:63]
    ds_read_b128 v[40:43], v10 offset:12288
    s_waitcnt lgkmcnt(4)
    v_mfma_f32_32x32x16_bf16 v[48:63], a[40:43], v[24:27], v[48:63]
    ds_read_b128 v[44:47], v11 offset:12288
    s_waitcnt lgkmcnt(4)
    v_mfma_f32_32x32x16_bf16 v[48:63], a[44:47], v[28:31], v[48:63]
    ds_read_b128 v[16:19], v8 offset:16384
    s_waitcnt lgkmcnt(4)
    v_mfma_f32_32x32x16_bf16 v[48:63], a[48:51], v[32:35], v[48:63]
    s_add_u32 m0, s66, 65536
    s_nop 0
    buffer_load_dwordx4 v2, s[56:59], s65 offen offset:0 lds
    ds_read_b128 v[20:23], v9 offset:16384
    s_waitcnt lgkmcnt(4)
    v_mfma_f32_32x32x16_bf16 v[48:63], a[52:55], v[36:39], v[48:63]
    ds_read_b128 v[24:27], v10 offset:16384
    s_waitcnt lgkmcnt(4)
    v_mfma_f32_32x32x16_bf16 v[48:63], a[56:59], v[40:43], v[48:63]
    s_add_u32 m0, s66, 69504
    s_nop 0
    buffer_load_dwordx4 v2, s[56:59], s65 offen offset:128 lds
    ds_read_b128 v[28:31], v11 offset:16384
    s_waitcnt lgkmcnt(4)
    v_mfma_f32_32x32x16_bf16 v[48:63], a[60:63], v[44:47], v[48:63]
    ds_read_b128 v[32:35], v8 offset:20480
    s_waitcnt lgkmcnt(4)
    v_mfma_f32_32x32x16_bf16 v[48:63], a[64:67], v[16:19], v[48:63]
    s_add_u32 m0, s66, 73472
    s_nop 0
    buffer_load_dwordx4 v2, s[56:59], s65 offen offset:256 lds
    ds_read_b128 v[36:39], v9 offset:20480
    s_waitcnt lgkmcnt(4)
    v_mfma_f32_32x32x16_bf16 v[48:63], a[68:71], v[20:23], v[48:63]
    ds_read_b128 v[40:43], v10 offset:20480
    s_waitcnt lgkmcnt(4)
    v_mfma_f32_32x32x16_bf16 v[48:63], a[72:75], v[24:27], v[48:63]
    s_add_u32 m0, s66, 77440
    s_nop 0
    buffer_load_dwordx4 v2, s[56:59], s65 offen offset:384 lds
    ds_read_b128 v[44:47], v11 offset:20480
    s_waitcnt lgkmcnt(4)
    v_mfma_f32_32x32x16_bf16 v[48:63], a[76:79], v[28:31], v[48:63]
    ds_read_b128 v[16:19], v8 offset:24576
    s_waitcnt lgkmcnt(4)
    v_mfma_f32_32x32x16_bf16 v[48:63], a[80:83], v[32:35], v[48:63]
    s_add_u32 m0, s66, 81408
    s_nop 0
    buffer_load_dwordx4 v2, s[56:59], s65 offen offset:512 lds
    ds_read_b128 v[20:23], v9 offset:24576
    s_waitcnt lgkmcnt(4)
    v_mfma_f32_32x32x16_bf16 v[48:63], a[84:87], v[36:39], v[48:63]
    ds_read_b128 v[24:27], v10 offset:24576
    s_waitcnt lgkmcnt(4)
    v_mfma_f32_32x32x16_bf16 v[48:63], a[88:91], v[40:43], v[48:63]
    s_add_u32 m0, s66, 85376
    s_nop 0
    buffer_load_dwordx4 v2, s[56:59], s65 offen offset:640 lds
    ds_read_b128 v[28:31], v11 offset:24576
    s_waitcnt lgkmcnt(4)
    v_mfma_f32_32x32x16_bf16 v[48:63], a[92:95], v[44:47], v[48:63]
    ds_read_b128 v[32:35], v8 offset:28672
    s_waitcnt lgkmcnt(4)
    v_mfma_f32_32x32x16_bf16 v[48:63], a[96:99], v[16:19], v[48:63]
    s_add_u32 m0, s66, 89344
    s_nop 0
    buffer_load_dwordx4 v2, s[56:59], s65 offen offset:768 lds
    ds_read_b128 v[36:39], v9 offset:28672
    s_waitcnt lgkmcnt(4)
    v_mfma_f32_32x32x16_bf16 v[48:63], a[100:103], v[20:23], v[48:63]
    ds_read_b128 v[40:43], v10 offset:28672
    s_waitcnt lgkmcnt(4)
    v_mfma_f32_32x32x16_bf16 v[48:63], a[104:107], v[24:27], v[48:63]
    s_add_u32 m0, s66, 93312
    s_nop 0
    buffer_load_dwordx4 v2, s[56:59], s65 offen offset:896 lds
    ds_read_b128 v[44:47], v11 offset:28672
    s_waitcnt lgkmcnt(4)
    v_mfma_f32_32x32x16_bf16 v[48:63], a[108:111], v[28:31], v[48:63]
    ds_read_b128 v[16:19], v8 offset:32768
    s_waitcnt lgkmcnt(4)
    v_mfma_f32_32x32x16_bf16 v[48:63], a[112:115], v[32:35], v[48:63]
    s_add_u32 m0, s66, 97280
    s_nop 0
    buffer_load_dwordx4 v2, s[56:59], s65 offen offset:1024 lds
    ds_read_b128 v[20:23], v9 offset:32768
    s_waitcnt lgkmcnt(4)
    v_mfma_f32_32x32x16_bf16 v[48:63], a[116:119], v[36:39], v[48:63]
    ds_read_b128 v[24:27], v10 offset:32768
    s_waitcnt lgkmcnt(4)
    v_mfma_f32_32x32x16_bf16 v[48:63], a[120:123], v[40:43], v[48:63]
    s_add_u32 m0, s66, 101248
    s_nop 0
    buffer_load_dwordx4 v2, s[56:59], s65 offen offset:1152 lds
    ds_read_b128 v[28:31], v11 offset:32768
    s_waitcnt lgkmcnt(4)
    v_mfma_f32_32x32x16_bf16 v[48:63], a[124:127], v[44:47], v[48:63]
    ds_read_b128 v[32:35], v8 offset:36864
    s_waitcnt lgkmcnt(4)
    v_mfma_f32_32x32x16_bf16 v[48:63], a[128:131], v[16:19], v[48:63]
    s_add_u32 m0, s66, 105216
    s_nop 0
    buffer_load_dwordx4 v2, s[56:59], s65 offen offset:1280 lds
    ds_read_b128 v[36:39], v9 offset:36864
    s_waitcnt lgkmcnt(4)
    v_mfma_f32_32x32x16_bf16 v[48:63], a[132:135], v[20:23], v[48:63]
    ds_read_b128 v[40:43], v10 offset:36864
    s_waitcnt lgkmcnt(4)
    v_mfma_f32_32x32x16_bf16 v[48:63], a[136:139], v[24:27], v[48:63]
    s_add_u32 m0, s66, 109184
    s_nop 0
    buffer_load_dwordx4 v2, s[56:59], s65 offen offset:1408 lds
    ds_read_b128 v[44:47], v11 offset:36864
    s_waitcnt lgkmcnt(4)
    v_mfma_f32_32x32x16_bf16 v[48:63], a[140:143], v[28:31], v[48:63]
    ds_read_b128 v[16:19], v8 offset:40960
    s_waitcnt lgkmcnt(4)
    v_mfma_f32_32x32x16_bf16 v[48:63], a[144:147], v[32:35], v[48:63]
    s_add_u32 m0, s66, 113152
    s_nop 0
    buffer_load_dwordx4 v2, s[56:59], s65 offen offset:1536 lds
    ds_read_b128 v[20:23], v9 offset:40960
    s_waitcnt lgkmcnt(4)
    v_mfma_f32_32x32x16_bf16 v[48:63], a[148:151], v[36:39], v[48:63]
    ds_read_b128 v[24:27], v10 offset:40960
    s_waitcnt lgkmcnt(4)
    v_mfma_f32_32x32x16_bf16 v[48:63], a[152:155], v[40:43], v[48:63]
    s_add_u32 m0, s66, 117120
    s_nop 0
    buffer_load_dwordx4 v2, s[56:59], s65 offen offset:1664 lds
    ds_read_b128 v[28:31], v11 offset:40960
    s_waitcnt lgkmcnt(4)
    v_mfma_f32_32x32x16_bf16 v[48:63], a[156:159], v[44:47], v[48:63]
    ds_read_b128 v[32:35], v8 offset:45056
    s_waitcnt lgkmcnt(4)
    v_mfma_f32_32x32x16_bf16 v[48:63], a[160:163], v[16:19], v[48:63]
    s_add_u32 m0, s66, 121088
    s_nop 0
    buffer_load_dwordx4 v2, s[56:59], s65 offen offset:1792 lds
    ds_read_b128 v[36:39], v9 offset:45056
    s_waitcnt lgkmcnt(4)
    v_mfma_f32_32x32x16_bf16 v[48:63], a[164:167], v[20:23], v[48:63]
    ds_read_b128 v[40:43], v10 offset:45056
    s_waitcnt lgkmcnt(4)
    v_mfma_f32_32x32x16_bf16 v[48:63], a[168:171], v[24:27], v[48:63]
    s_add_u32 m0, s66, 125056
    s_nop 0
    buffer_load_dwordx4 v2, s[56:59], s65 offen offset:1920 lds
    ds_read_b128 v[44:47], v11 offset:45056
    s_waitcnt lgkmcnt(4)
    v_mfma_f32_32x32x16_bf16 v[48:63], a[172:175], v[28:31], v[48:63]
    ds_read_b128 v[16:19], v8 offset:49152
    s_waitcnt lgkmcnt(4)
    v_mfma_f32_32x32x16_bf16 v[48:63], a[176:179], v[32:35], v[48:63]
    ds_read_b128 v[20:23], v9 offset:49152
    s_waitcnt lgkmcnt(4)
    v_mfma_f32_32x32x16_bf16 v[48:63], a[180:183], v[36:39], v[48:63]
    ds_read_b128 v[24:27], v10 offset:49152
    s_waitcnt lgkmcnt(4)
    v_mfma_f32_32x32x16_bf16 v[48:63], a[184:187], v[40:43], v[48:63]
    ds_read_b128 v[28:31], v11 offset:49152
    s_waitcnt lgkmcnt(4)
    v_mfma_f32_32x32x16_bf16 v[48:63], a[188:191], v[44:47], v[48:63]
    ds_read_b128 v[32:35], v8 offset:53248
    s_waitcnt lgkmcnt(4)
    v_mfma_f32_32x32x16_bf16 v[48:63], a[192:195], v[16:19], v[48:63]
    ds_read_b128 v[36:39], v9 offset:53248
    s_waitcnt lgkmcnt(4)
    v_mfma_f32_32x32x16_bf16 v[48:63], a[196:199], v[20:23], v[48:63]
    ds_read_b128 v[40:43], v10 offset:53248
    s_waitcnt lgkmcnt(4)
    v_mfma_f32_32x32x16_bf16 v[48:63], a[200:203], v[24:27], v[48:63]
    ds_read_b128 v[44:47], v11 offset:53248
    s_waitcnt lgkmcnt(4)
    v_mfma_f32_32x32x16_bf16 v[48:63], a[204:207], v[28:31], v[48:63]
    ds_read_b128 v[16:19], v8 offset:57344
    s_waitcnt lgkmcnt(4)
    v_mfma_f32_32x32x16_bf16 v[48:63], a[208:211], v[32:35], v[48:63]
    ds_read_b128 v[20:23], v9 offset:57344
    s_waitcnt lgkmcnt(4)
    v_mfma_f32_32x32x16_bf16 v[48:63], a[212:215], v[36:39], v[48:63]
    ds_read_b128 v[24:27], v10 offset:57344
    s_waitcnt lgkmcnt(4)
    v_mfma_f32_32x32x16_bf16 v[48:63], a[216:219], v[40:43], v[48:63]
    ds_read_b128 v[28:31], v11 offset:57344
    s_waitcnt lgkmcnt(4)
    v_mfma_f32_32x32x16_bf16 v[48:63], a[220:223], v[44:47], v[48:63]
    ds_read_b128 v[32:35], v8 offset:61440
    s_waitcnt lgkmcnt(4)
    v_mfma_f32_32x32x16_bf16 v[48:63], a[224:227], v[16:19], v[48:63]
    ds_read_b128 v[36:39], v9 offset:61440
    s_waitcnt lgkmcnt(4)
    v_mfma_f32_32x32x16_bf16 v[48:63], a[228:231], v[20:23], v[48:63]
    ds_read_b128 v[40:43], v10 offset:61440
    s_waitcnt lgkmcnt(4)
    v_mfma_f32_32x32x16_bf16 v[48:63], a[232:235], v[24:27], v[48:63]
    ds_read_b128 v[44:47], v11 offset:61440
    s_waitcnt lgkmcnt(4)
    v_mfma_f32_32x32x16_bf16 v[48:63], a[236:239], v[28:31], v[48:63]
    s_waitcnt vmcnt(0) lgkmcnt(0)
    s_barrier
    ds_read_b128 v[16:19], v12 offset:0
    v_mfma_f32_32x32x16_bf16 v[48:63], a[240:243], v[32:35], v[48:63]
    ds_read_b128 v[20:23], v13 offset:0
    v_mfma_f32_32x32x16_bf16 v[48:63], a[244:247], v[36:39], v[48:63]
    ds_read_b128 v[24:27], v14 offset:0
    v_mfma_f32_32x32x16_bf16 v[48:63], a[248:251], v[40:43], v[48:63]
    ds_read_b128 v[28:31], v15 offset:0
    v_mfma_f32_32x32x16_bf16 v[48:63], a[252:255], v[44:47], v[48:63]
    s_add_u32 s63, s63, 1
    s_add_u32 s65, s65, 0x10000
Lw_Kloop:
    ds_read_b128 v[32:35], v12 offset:4096
    s_waitcnt lgkmcnt(4)
    v_mfma_f32_32x32x16_bf16 v[64:79], a[0:3], v[16:19], 0
    ds_read_b128 v[36:39], v13 offset:4096
    s_waitcnt lgkmcnt(4)
    v_mfma_f32_32x32x16_bf16 v[64:79], a[4:7], v[20:23], v[64:79]
    ds_read_b128 v[40:43], v14 offset:4096
    s_waitcnt lgkmcnt(4)
    v_mfma_f32_32x32x16_bf16 v[64:79], a[8:11], v[24:27], v[64:79]
    v_cvt_pk_bf16_f32 v80, v48, v49
    ds_read_b128 v[44:47], v15 offset:4096
    s_waitcnt lgkmcnt(4)
    v_mfma_f32_32x32x16_bf16 v[64:79], a[12:15], v[28:31], v[64:79]
    v_cvt_pk_bf16_f32 v81, v50, v51
    ds_read_b128 v[16:19], v12 offset:8192
    s_waitcnt lgkmcnt(4)
    v_mfma_f32_32x32x16_bf16 v[64:79], a[16:19], v[32:35], v[64:79]
    v_cvt_pk_bf16_f32 v82, v52, v53
    ds_read_b128 v[20:23], v13 offset:8192
    s_waitcnt lgkmcnt(4)
    v_mfma_f32_32x32x16_bf16 v[64:79], a[20:23], v[36:39], v[64:79]
    v_cvt_pk_bf16_f32 v83, v54, v55
    buffer_store_dwordx4 v[80:83], v1, s[48:51], s67 offen offset:0 sc1
    ds_read_b128 v[24:27], v14 offset:8192
    s_waitcnt lgkmcnt(4)
    v_mfma_f32_32x32x16_bf16 v[64:79], a[24:27], v[40:43], v[64:79]
    v_cvt_pk_bf16_f32 v84, v56, v57
    ds_read_b128 v[28:31], v15 offset:8192
    s_waitcnt lgkmcnt(4)
    v_mfma_f32_32x32x16_bf16 v[64:79], a[28:31], v[44:47], v[64:79]
    v_cvt_pk_bf16_f32 v85, v58, v59
    ds_read_b128 v[32:35], v12 offset:12288
    s_waitcnt lgkmcnt(4)
    v_mfma_f32_32x32x16_bf16 v[64:79], a[32:35], v[16:19], v[64:79]
    v_cvt_pk_bf16_f32 v86, v60, v61
    ds_read_b128 v[36:39], v13 offset:12288
    s_waitcnt lgkmcnt(4)
    v_mfma_f32_32x32x16_bf16 v[64:79], a[36:39], v[20:23], v[64:79]
    v_cvt_pk_bf16_f32 v87, v62, v63
    buffer_store_dwordx4 v[84:87], v1, s[48:51], s67 offen offset:1024 sc1
    ds_read_b128 v[40:43], v14 offset:12288
    s_waitcnt lgkmcnt(4)
    v_mfma_f32_32x32x16_bf16 v[64:79], a[40:43], v[24:27], v[64:79]
    ds_read_b128 v[44:47], v15 offset:12288
    s_waitcnt lgkmcnt(4)
    v_mfma_f32_32x32x16_bf16 v[64:79], a[44:47], v[28:31], v[64:79]
    ds_read_b128 v[16:19], v12 offset:16384
    s_waitcnt lgkmcnt(4)
    v_mfma_f32_32x32x16_bf16 v[64:79], a[48:51], v[32:35], v[64:79]
    s_add_u32 m0, s66, 0
    s_nop 0
    buffer_load_dwordx4 v2, s[56:59], s65 offen offset:0 lds
    ds_read_b128 v[20:23], v13 offset:16384
    s_waitcnt lgkmcnt(4)
    v_mfma_f32_32x32x16_bf16 v[64:79], a[52:55], v[36:39], v[64:79]
    ds_read_b128 v[24:27], v14 offset:16384
    s_waitcnt lgkmcnt(4)
    v_mfma_f32_32x32x16_bf16 v[64:79], a[56:59], v[40:43], v[64:79]
    s_add_u32 m0, s66, 3968
    s_nop 0
    buffer_load_dwordx4 v2, s[56:59], s65 offen offset:128 lds
    ds_read_b128 v[28:31], v15 offset:16384
    s_waitcnt lgkmcnt(4)
    v_mfma_f32_32x32x16_bf16 v[64:79], a[60:63], v[44:47], v[64:79]
    ds_read_b128 v[32:35], v12 offset:20480
    s_waitcnt lgkmcnt(4)
    v_mfma_f32_32x32x16_bf16 v[64:79], a[64:67], v[16:19], v[64:79]
    s_add_u32 m0, s66, 7936
    s_nop 0
    buffer_load_dwordx4 v2, s[56:59], s65 offen offset:256 lds
    ds_read_b128 v[36:39], v13 offset:20480
    s_waitcnt lgkmcnt(4)
    v_mfma_f32_32x32x16_bf16 v[64:79], a[68:71], v[20:23], v[64:79]
    ds_read_b128 v[40:43], v14 offset:20480
    s_waitcnt lgkmcnt(4)
    v_mfma_f32_32x32x16_bf16 v[64:79], a[72:75], v[24:27], v[64:79]
    s_add_u32 m0, s66, 11904
    s_nop 0
    buffer_load_dwordx4 v2, s[56:59], s65 offen offset:384 lds
    ds_read_b128 v[44:47], v15 offset:20480
    s_waitcnt lgkmcnt(4)
    v_mfma_f32_32x32x16_bf16 v[64:79], a[76:79], v[28:31], v[64:79]
    ds_read_b128 v[16:19], v12 offset:24576
    s_waitcnt lgkmcnt(4)
    v_mfma_f32_32x32x16_bf16 v[64:79], a[80:83], v[32:35], v[64:79]
    s_add_u32 m0, s66, 15872
    s_nop 0
    buffer_load_dwordx4 v2, s[56:59], s65 offen offset:512 lds
    ds_read_b128 v[20:23], v13 offset:24576
    s_waitcnt lgkmcnt(4)
    v_mfma_f32_32x32x16_bf16 v[64:79], a[84:87], v[36:39], v[64:79]
    ds_read_b128 v[24:27], v14 offset:24576
    s_waitcnt lgkmcnt(4)
    v_mfma_f32_32x32x16_bf16 v[64:79], a[88:91], v[40:43], v[64:79]
    s_add_u32 m0, s66, 19840
    s_nop 0
    buffer_load_dwordx4 v2, s[56:59], s65 offen offset:640 lds
    ds_read_b128 v[28:31], v15 offset:24576
    s_waitcnt lgkmcnt(4)
    v_mfma_f32_32x32x16_bf16 v[64:79], a[92:95], v[44:47], v[64:79]
    ds_read_b128 v[32:35], v12 offset:28672
    s_waitcnt lgkmcnt(4)
    v_mfma_f32_32x32x16_bf16 v[64:79], a[96:99], v[16:19], v[64:79]
    s_add_u32 m0, s66, 23808
    s_nop 0
    buffer_load_dwordx4 v2, s[56:59], s65 offen offset:768 lds
    ds_read_b128 v[36:39], v13 offset:28672
    s_waitcnt lgkmcnt(4)
    v_mfma_f32_32x32x16_bf16 v[64:79], a[100:103], v[20:23], v[64:79]
    ds_read_b128 v[40:43], v14 offset:28672
    s_waitcnt lgkmcnt(4)
    v_mfma_f32_32x32x16_bf16 v[64:79], a[104:107], v[24:27], v[64:79]
    s_add_u32 m0, s66, 27776
    s_nop 0
    buffer_load_dwordx4 v2, s[56:59], s65 offen offset:896 lds
    ds_read_b128 v[44:47], v15 offset:28672
    s_waitcnt lgkmcnt(4)
    v_mfma_f32_32x32x16_bf16 v[64:79], a[108:111], v[28:31], v[64:79]
    ds_read_b128 v[16:19], v12 offset:32768
    s_waitcnt lgkmcnt(4)
    v_mfma_f32_32x32x16_bf16 v[64:79], a[112:115], v[32:35], v[64:79]
    s_add_u32 m0, s66, 31744
    s_nop 0
    buffer_load_dwordx4 v2, s[56:59], s65 offen offset:1024 lds
    ds_read_b128 v[20:23], v13 offset:32768
    s_waitcnt lgkmcnt(4)
    v_mfma_f32_32x32x16_bf16 v[64:79], a[116:119], v[36:39], v[64:79]
    ds_read_b128 v[24:27], v14 offset:32768
    s_waitcnt lgkmcnt(4)
    v_mfma_f32_32x32x16_bf16 v[64:79], a[120:123], v[40:43], v[64:79]
    s_add_u32 m0, s66, 35712
    s_nop 0
    buffer_load_dwordx4 v2, s[56:59], s65 offen offset:1152 lds
    ds_read_b128 v[28:31], v15 offset:32768
    s_waitcnt lgkmcnt(4)
    v_mfma_f32_32x32x16_bf16 v[64:79], a[124:127], v[44:47], v[64:79]
    ds_read_b128 v[32:35], v12 offset:36864
    s_waitcnt lgkmcnt(4)
    v_mfma_f32_32x32x16_bf16 v[64:79], a[128:131], v[16:19], v[64:79]
    s_add_u32 m0, s66, 39680
    s_nop 0
    buffer_load_dwordx4 v2, s[56:59], s65 offen offset:1280 lds
    ds_read_b128 v[36:39], v13 offset:36864
    s_waitcnt lgkmcnt(4)
    v_mfma_f32_32x32x16_bf16 v[64:79], a[132:135], v[20:23], v[64:79]
    ds_read_b128 v[40:43], v14 offset:36864
    s_waitcnt lgkmcnt(4)
    v_mfma_f32_32x32x16_bf16 v[64:79], a[136:139], v[24:27], v[64:79]
    s_add_u32 m0, s66, 43648
    s_nop 0
    buffer_load_dwordx4 v2, s[56:59], s65 offen offset:1408 lds
    ds_read_b128 v[44:47], v15 offset:36864
    s_waitcnt lgkmcnt(4)
    v_mfma_f32_32x32x16_bf16 v[64:79], a[140:143], v[28:31], v[64:79]
    ds_read_b128 v[16:19], v12 offset:40960
    s_waitcnt lgkmcnt(4)
    v_mfma_f32_32x32x16_bf16 v[64:79], a[144:147], v[32:35], v[64:79]
    s_add_u32 m0, s66, 47616
    s_nop 0
    buffer_load_dwordx4 v2, s[56:59], s65 offen offset:1536 lds
    ds_read_b128 v[20:23], v13 offset:40960
    s_waitcnt lgkmcnt(4)
    v_mfma_f32_32x32x16_bf16 v[64:79], a[148:151], v[36:39], v[64:79]
    ds_read_b128 v[24:27], v14 offset:40960
    s_waitcnt lgkmcnt(4)
    v_mfma_f32_32x32x16_bf16 v[64:79], a[152:155], v[40:43], v[64:79]
    s_add_u32 m0, s66, 51584
    s_nop 0
    buffer_load_dwordx4 v2, s[56:59], s65 offen offset:1664 lds
    ds_read_b128 v[28:31], v15 offset:40960
    s_waitcnt lgkmcnt(4)
    v_mfma_f32_32x32x16_bf16 v[64:79], a[156:159], v[44:47], v[64:79]
    ds_read_b128 v[32:35], v12 offset:45056
    s_waitcnt lgkmcnt(4)
    v_mfma_f32_32x32x16_bf16 v[64:79], a[160:163], v[16:19], v[64:79]
    s_add_u32 m0, s66, 55552
    s_nop 0
    buffer_load_dwordx4 v2, s[56:59], s65 offen offset:1792 lds
    ds_read_b128 v[36:39], v13 offset:45056
    s_waitcnt lgkmcnt(4)
    v_mfma_f32_32x32x16_bf16 v[64:79], a[164:167], v[20:23], v[64:79]
    ds_read_b128 v[40:43], v14 offset:45056
    s_waitcnt lgkmcnt(4)
    v_mfma_f32_32x32x16_bf16 v[64:79], a[168:171], v[24:27], v[64:79]
    s_add_u32 m0, s66, 59520
    s_nop 0
    buffer_load_dwordx4 v2, s[56:59], s65 offen offset:1920 lds
    ds_read_b128 v[44:47], v15 offset:45056
    s_waitcnt lgkmcnt(4)
    v_mfma_f32_32x32x16_bf16 v[64:79], a[172:175], v[28:31], v[64:79]
    ds_read_b128 v[16:19], v12 offset:49152
    s_waitcnt lgkmcnt(4)
    v_mfma_f32_32x32x16_bf16 v[64:79], a[176:179], v[32:35], v[64:79]
    ds_read_b128 v[20:23], v13 offset:49152
    s_waitcnt lgkmcnt(4)
    v_mfma_f32_32x32x16_bf16 v[64:79], a[180:183], v[36:39], v[64:79]
    ds_read_b128 v[24:27], v14 offset:49152
    s_waitcnt lgkmcnt(4)
    v_mfma_f32_32x32x16_bf16 v[64:79], a[184:187], v[40:43], v[64:79]
    s_waitcnt vmcnt(16)
    v_mov_b32 v3, s63
    v_mov_b32 v4, 0
    s_mov_b64 exec, 1
    buffer_store_dword v3, v4, s[48:51], s68 offen sc1
    s_mov_b64 exec, -1
    s_add_u32 s67, s67, 0x40000
    ds_read_b128 v[28:31], v15 offset:49152
    s_waitcnt lgkmcnt(4)
    v_mfma_f32_32x32x16_bf16 v[64:79], a[188:191], v[44:47], v[64:79]
    ds_read_b128 v[32:35], v12 offset:53248
    s_waitcnt lgkmcnt(4)
    v_mfma_f32_32x32x16_bf16 v[64:79], a[192:195], v[16:19], v[64:79]
    ds_read_b128 v[36:39], v13 offset:53248
    s_waitcnt lgkmcnt(4)
    v_mfma_f32_32x32x16_bf16 v[64:79], a[196:199], v[20:23], v[64:79]
    ds_read_b128 v[40:43], v14 offset:53248
    s_waitcnt lgkmcnt(4)
    v_mfma_f32_32x32x16_bf16 v[64:79], a[200:203], v[24:27], v[64:79]
    ds_read_b128 v[44:47], v15 offset:53248
    s_waitcnt lgkmcnt(4)
    v_mfma_f32_32x32x16_bf16 v[64:79], a[204:207], v[28:31], v[64:79]
    ds_read_b128 v[16:19], v12 offset:57344
    s_waitcnt lgkmcnt(4)
    v_mfma_f32_32x32x16_bf16 v[64:79], a[208:211], v[32:35], v[64:79]
    ds_read_b128 v[20:23], v13 offset:57344
    s_waitcnt lgkmcnt(4)
    v_mfma_f32_32x32x16_bf16 v[64:79], a[212:215], v[36:39], v[64:79]
    ds_read_b128 v[24:27], v14 offset:57344
    s_waitcnt lgkmcnt(4)
    v_mfma_f32_32x32x16_bf16 v[64:79], a[216:219], v[40:43], v[64:79]
    ds_read_b128 v[28:31], v15 offset:57344
    s_waitcnt lgkmcnt(4)
    v_mfma_f32_32x32x16_bf16 v[64:79], a[220:223], v[44:47], v[64:79]
    ds_read_b128 v[32:35], v12 offset:61440
    s_waitcnt lgkmcnt(4)
    v_mfma_f32_32x32x16_bf16 v[64:79], a[224:227], v[16:19], v[64:79]
    ds_read_b128 v[36:39], v13 offset:61440
    s_waitcnt lgkmcnt(4)
    v_mfma_f32_32x32x16_bf16 v[64:79], a[228:231], v[20:23], v[64:79]
    ds_read_b128 v[40:43], v14 offset:61440
    s_waitcnt lgkmcnt(4)
    v_mfma_f32_32x32x16_bf16 v[64:79], a[232:235], v[24:27], v[64:79]
    ds_read_b128 v[44:47], v15 offset:61440
    s_waitcnt lgkmcnt(4)
    v_mfma_f32_32x32x16_bf16 v[64:79], a[236:239], v[28:31], v[64:79]
    s_waitcnt vmcnt(1) lgkmcnt(0)
    s_barrier
    ds_read_b128 v[16:19], v8 offset:0
    v_mfma_f32_32x32x16_bf16 v[64:79], a[240:243], v[32:35], v[64:79]
    ds_read_b128 v[20:23], v9 offset:0
    v_mfma_f32_32x32x16_bf16 v[64:79], a[244:247], v[36:39], v[64:79]
    ds_read_b128 v[24:27], v10 offset:0
    v_mfma_f32_32x32x16_bf16 v[64:79], a[248:251], v[40:43], v[64:79]
    ds_read_b128 v[28:31], v11 offset:0
    v_mfma_f32_32x32x16_bf16 v[64:79], a[252:255], v[44:47], v[64:79]
    s_add_u32 s63, s63, 1
    s_add_u32 s65, s65, 0x10000
    s_cmp_eq_u32 s63, 64
    s_cbranch_scc1 Lw_Kend
    ds_read_b128 v[32:35], v8 offset:4096
    s_waitcnt lgkmcnt(4)
    v_mfma_f32_32x32x16_bf16 v[48:63], a[0:3], v[16:19], 0
    ds_read_b128 v[36:39], v9 offset:4096
    s_waitcnt lgkmcnt(4)
    v_mfma_f32_32x32x16_bf16 v[48:63], a[4:7], v[20:23], v[48:63]
    ds_read_b128 v[40:43], v10 offset:4096
    s_waitcnt lgkmcnt(4)
    v_mfma_f32_32x32x16_bf16 v[48:63], a[8:11], v[24:27], v[48:63]
    v_cvt_pk_bf16_f32 v80, v64, v65
    ds_read_b128 v[44:47], v11 offset:4096
    s_waitcnt lgkmcnt(4)
    v_mfma_f32_32x32x16_bf16 v[48:63], a[12:15], v[28:31], v[48:63]
    v_cvt_pk_bf16_f32 v81, v66, v67
    ds_read_b128 v[16:19], v8 offset:8192
    s_waitcnt lgkmcnt(4)
    v_mfma_f32_32x32x16_bf16 v[48:63], a[16:19], v[32:35], v[48:63]
    v_cvt_pk_bf16_f32 v82, v68, v69
    ds_read_b128 v[20:23], v9 offset:8192
    s_waitcnt lgkmcnt(4)
    v_mfma_f32_32x32x16_bf16 v[48:63], a[20:23], v[36:39], v[48:63]
    v_cvt_pk_bf16_f32 v83, v70, v71
    buffer_store_dwordx4 v[80:83], v1, s[48:51], s67 offen offset:0 sc1
    ds_read_b128 v[24:27], v10 offset:8192
    s_waitcnt lgkmcnt(4)
    v_mfma_f32_32x32x16_bf16 v[48:63], a[24:27], v[40:43], v[48:63]
    v_cvt_pk_bf16_f32 v84, v72, v73
    ds_read_b128 v[28:31], v11 offset:8192
    s_waitcnt lgkmcnt(4)
    v_mfma_f32_32x32x16_bf16 v[48:63], a[28:31], v[44:47], v[48:63]
    v_cvt_pk_bf16_f32 v85, v74, v75
    ds_read_b128 v[32:35], v8 offset:12288
    s_waitcnt lgkmcnt(4)
    v_mfma_f32_32x32x16_bf16 v[48:63], a[32:35], v[16:19], v[48:63]
    v_cvt_pk_bf16_f32 v86, v76, v77
    ds_read_b128 v[36:39], v9 offset:12288
    s_waitcnt lgkmcnt(4)
    v_mfma_f32_32x32x16_bf16 v[48:63], a[36:39], v[20:23], v[48:63]
    v_cvt_pk_bf16_f32 v87, v78, v79
    buffer_store_dwordx4 v[84:87], v1, s[48:51], s67 offen offset:1024 sc1
    ds_read_b128 v[40:43], v10 offset:12288
    s_waitcnt lgkmcnt(4)
    v_mfma_f32_32x32x16_bf16 v[48:63], a[40:43], v[24:27], v[48:63]
    ds_read_b128 v[44:47], v11 offset:12288
    s_waitcnt lgkmcnt(4)
    v_mfma_f32_32x32x16_bf16 v[48:63], a[44:47], v[28:31], v[48:63]
    ds_read_b128 v[16:19], v8 offset:16384
    s_waitcnt lgkmcnt(4)
    v_mfma_f32_32x32x16_bf16 v[48:63], a[48:51], v[32:35], v[48:63]
    s_add_u32 m0, s66, 65536
    s_nop 0
    buffer_load_dwordx4 v2, s[56:59], s65 offen offset:0 lds
    ds_read_b128 v[20:23], v9 offset:16384
    s_waitcnt lgkmcnt(4)
    v_mfma_f32_32x32x16_bf16 v[48:63], a[52:55], v[36:39], v[48:63]
    ds_read_b128 v[24:27], v10 offset:16384
    s_waitcnt lgkmcnt(4)
    v_mfma_f32_32x32x16_bf16 v[48:63], a[56:59], v[40:43], v[48:63]
    s_add_u32 m0, s66, 69504
    s_nop 0
    buffer_load_dwordx4 v2, s[56:59], s65 offen offset:128 lds
    ds_read_b128 v[28:31], v11 offset:16384
    s_waitcnt lgkmcnt(4)
    v_mfma_f32_32x32x16_bf16 v[48:63], a[60:63], v[44:47], v[48:63]
    ds_read_b128 v[32:35], v8 offset:20480
    s_waitcnt lgkmcnt(4)
    v_mfma_f32_32x32x16_bf16 v[48:63], a[64:67], v[16:19], v[48:63]
    s_add_u32 m0, s66, 73472
    s_nop 0
    buffer_load_dwordx4 v2, s[56:59], s65 offen offset:256 lds
    ds_read_b128 v[36:39], v9 offset:20480
    s_waitcnt lgkmcnt(4)
    v_mfma_f32_32x32x16_bf16 v[48:63], a[68:71], v[20:23], v[48:63]
    ds_read_b128 v[40:43], v10 offset:20480
    s_waitcnt lgkmcnt(4)
    v_mfma_f32_32x32x16_bf16 v[48:63], a[72:75], v[24:27], v[48:63]
    s_add_u32 m0, s66, 77440
    s_nop 0
    buffer_load_dwordx4 v2, s[56:59], s65 offen offset:384 lds
    ds_read_b128 v[44:47], v11 offset:20480
    s_waitcnt lgkmcnt(4)
    v_mfma_f32_32x32x16_bf16 v[48:63], a[76:79], v[28:31], v[48:63]
    ds_read_b128 v[16:19], v8 offset:24576
    s_waitcnt lgkmcnt(4)
    v_mfma_f32_32x32x16_bf16 v[48:63], a[80:83], v[32:35], v[48:63]
    s_add_u32 m0, s66, 81408
    s_nop 0
    buffer_load_dwordx4 v2, s[56:59], s65 offen offset:512 lds
    ds_read_b128 v[20:23], v9 offset:24576
    s_waitcnt lgkmcnt(4)
    v_mfma_f32_32x32x16_bf16 v[48:63], a[84:87], v[36:39], v[48:63]
    ds_read_b128 v[24:27], v10 offset:24576
    s_waitcnt lgkmcnt(4)
    v_mfma_f32_32x32x16_bf16 v[48:63], a[88:91], v[40:43], v[48:63]
    s_add_u32 m0, s66, 85376
    s_nop 0
    buffer_load_dwordx4 v2, s[56:59], s65 offen offset:640 lds
    ds_read_b128 v[28:31], v11 offset:24576
    s_waitcnt lgkmcnt(4)
    v_mfma_f32_32x32x16_bf16 v[48:63], a[92:95], v[44:47], v[48:63]
    ds_read_b128 v[32:35], v8 offset:28672
    s_waitcnt lgkmcnt(4)
    v_mfma_f32_32x32x16_bf16 v[48:63], a[96:99], v[16:19], v[48:63]
    s_add_u32 m0, s66, 89344
    s_nop 0
    buffer_load_dwordx4 v2, s[56:59], s65 offen offset:768 lds
    ds_read_b128 v[36:39], v9 offset:28672
    s_waitcnt lgkmcnt(4)
    v_mfma_f32_32x32x16_bf16 v[48:63], a[100:103], v[20:23], v[48:63]
    ds_read_b128 v[40:43], v10 offset:28672
    s_waitcnt lgkmcnt(4)
    v_mfma_f32_32x32x16_bf16 v[48:63], a[104:107], v[24:27], v[48:63]
    s_add_u32 m0, s66, 93312
    s_nop 0
    buffer_load_dwordx4 v2, s[56:59], s65 offen offset:896 lds
    ds_read_b128 v[44:47], v11 offset:28672
    s_waitcnt lgkmcnt(4)
    v_mfma_f32_32x32x16_bf16 v[48:63], a[108:111], v[28:31], v[48:63]
    ds_read_b128 v[16:19], v8 offset:32768
    s_waitcnt lgkmcnt(4)
    v_mfma_f32_32x32x16_bf16 v[48:63], a[112:115], v[32:35], v[48:63]
    s_add_u32 m0, s66, 97280
    s_nop 0
    buffer_load_dwordx4 v2, s[56:59], s65 offen offset:1024 lds
    ds_read_b128 v[20:23], v9 offset:32768
    s_waitcnt lgkmcnt(4)
    v_mfma_f32_32x32x16_bf16 v[48:63], a[116:119], v[36:39], v[48:63]
    ds_read_b128 v[24:27], v10 offset:32768
    s_waitcnt lgkmcnt(4)
    v_mfma_f32_32x32x16_bf16 v[48:63], a[120:123], v[40:43], v[48:63]
    s_add_u32 m0, s66, 101248
    s_nop 0
    buffer_load_dwordx4 v2, s[56:59], s65 offen offset:1152 lds
    ds_read_b128 v[28:31], v11 offset:32768
    s_waitcnt lgkmcnt(4)
    v_mfma_f32_32x32x16_bf16 v[48:63], a[124:127], v[44:47], v[48:63]
    ds_read_b128 v[32:35], v8 offset:36864
    s_waitcnt lgkmcnt(4)
    v_mfma_f32_32x32x16_bf16 v[48:63], a[128:131], v[16:19], v[48:63]
    s_add_u32 m0, s66, 105216
    s_nop 0
    buffer_load_dwordx4 v2, s[56:59], s65 offen offset:1280 lds
    ds_read_b128 v[36:39], v9 offset:36864
    s_waitcnt lgkmcnt(4)
    v_mfma_f32_32x32x16_bf16 v[48:63], a[132:135], v[20:23], v[48:63]
    ds_read_b128 v[40:43], v10 offset:36864
    s_waitcnt lgkmcnt(4)
    v_mfma_f32_32x32x16_bf16 v[48:63], a[136:139], v[24:27], v[48:63]
    s_add_u32 m0, s66, 109184
    s_nop 0
    buffer_load_dwordx4 v2, s[56:59], s65 offen offset:1408 lds
    ds_read_b128 v[44:47], v11 offset:36864
    s_waitcnt lgkmcnt(4)
    v_mfma_f32_32x32x16_bf16 v[48:63], a[140:143], v[28:31], v[48:63]
    ds_read_b128 v[16:19], v8 offset:40960
    s_waitcnt lgkmcnt(4)
    v_mfma_f32_32x32x16_bf16 v[48:63], a[144:147], v[32:35], v[48:63]
    s_add_u32 m0, s66, 113152
    s_nop 0
    buffer_load_dwordx4 v2, s[56:59], s65 offen offset:1536 lds
    ds_read_b128 v[20:23], v9 offset:40960
    s_waitcnt lgkmcnt(4)
    v_mfma_f32_32x32x16_bf16 v[48:63], a[148:151], v[36:39], v[48:63]
    ds_read_b128 v[24:27], v10 offset:40960
    s_waitcnt lgkmcnt(4)
    v_mfma_f32_32x32x16_bf16 v[48:63], a[152:155], v[40:43], v[48:63]
    s_add_u32 m0, s66, 117120
    s_nop 0
    buffer_load_dwordx4 v2, s[56:59], s65 offen offset:1664 lds
    ds_read_b128 v[28:31], v11 offset:40960
    s_waitcnt lgkmcnt(4)
    v_mfma_f32_32x32x16_bf16 v[48:63], a[156:159], v[44:47], v[48:63]
    ds_read_b128 v[32:35], v8 offset:45056
    s_waitcnt lgkmcnt(4)
    v_mfma_f32_32x32x16_bf16 v[48:63], a[160:163], v[16:19], v[48:63]
    s_add_u32 m0, s66, 121088
    s_nop 0
    buffer_load_dwordx4 v2, s[56:59], s65 offen offset:1792 lds
    ds_read_b128 v[36:39], v9 offset:45056
    s_waitcnt lgkmcnt(4)
    v_mfma_f32_32x32x16_bf16 v[48:63], a[164:167], v[20:23], v[48:63]
    ds_read_b128 v[40:43], v10 offset:45056
    s_waitcnt lgkmcnt(4)
    v_mfma_f32_32x32x16_bf16 v[48:63], a[168:171], v[24:27], v[48:63]
    s_add_u32 m0, s66, 125056
    s_nop 0
    buffer_load_dwordx4 v2, s[56:59], s65 offen offset:1920 lds
    ds_read_b128 v[44:47], v11 offset:45056
    s_waitcnt lgkmcnt(4)
    v_mfma_f32_32x32x16_bf16 v[48:63], a[172:175], v[28:31], v[48:63]
    ds_read_b128 v[16:19], v8 offset:49152
    s_waitcnt lgkmcnt(4)
    v_mfma_f32_32x32x16_bf16 v[48:63], a[176:179], v[32:35], v[48:63]
    ds_read_b128 v[20:23], v9 offset:49152
    s_waitcnt lgkmcnt(4)
    v_mfma_f32_32x32x16_bf16 v[48:63], a[180:183], v[36:39], v[48:63]
    ds_read_b128 v[24:27], v10 offset:49152
    s_waitcnt lgkmcnt(4)
    v_mfma_f32_32x32x16_bf16 v[48:63], a[184:187], v[40:43], v[48:63]
    s_waitcnt vmcnt(16)
    v_mov_b32 v3, s63
    v_mov_b32 v4, 0
    s_mov_b64 exec, 1
    buffer_store_dword v3, v4, s[48:51], s68 offen sc1
    s_mov_b64 exec, -1
    s_add_u32 s67, s67, 0x40000
    ds_read_b128 v[28:31], v11 offset:49152
    s_waitcnt lgkmcnt(4)
    v_mfma_f32_32x32x16_bf16 v[48:63], a[188:191], v[44:47], v[48:63]
    ds_read_b128 v[32:35], v8 offset:53248
    s_waitcnt lgkmcnt(4)
    v_mfma_f32_32x32x16_bf16 v[48:63], a[192:195], v[16:19], v[48:63]
    ds_read_b128 v[36:39], v9 offset:53248
    s_waitcnt lgkmcnt(4)
    v_mfma_f32_32x32x16_bf16 v[48:63], a[196:199], v[20:23], v[48:63]
    ds_read_b128 v[40:43], v10 offset:53248
    s_waitcnt lgkmcnt(4)
    v_mfma_f32_32x32x16_bf16 v[48:63], a[200:203], v[24:27], v[48:63]
    ds_read_b128 v[44:47], v11 offset:53248
    s_waitcnt lgkmcnt(4)
    v_mfma_f32_32x32x16_bf16 v[48:63], a[204:207], v[28:31], v[48:63]
    ds_read_b128 v[16:19], v8 offset:57344
    s_waitcnt lgkmcnt(4)
    v_mfma_f32_32x32x16_bf16 v[48:63], a[208:211], v[32:35], v[48:63]
    ds_read_b128 v[20:23], v9 offset:57344
    s_waitcnt lgkmcnt(4)
    v_mfma_f32_32x32x16_bf16 v[48:63], a[212:215], v[36:39], v[48:63]
    ds_read_b128 v[24:27], v10 offset:57344
    s_waitcnt lgkmcnt(4)
    v_mfma_f32_32x32x16_bf16 v[48:63], a[216:219], v[40:43], v[48:63]
    ds_read_b128 v[28:31], v11 offset:57344
    s_waitcnt lgkmcnt(4)
    v_mfma_f32_32x32x16_bf16 v[48:63], a[220:223], v[44:47], v[48:63]
    ds_read_b128 v[32:35], v8 offset:61440
    s_waitcnt lgkmcnt(4)
    v_mfma_f32_32x32x16_bf16 v[48:63], a[224:227], v[16:19], v[48:63]
    ds_read_b128 v[36:39], v9 offset:61440
    s_waitcnt lgkmcnt(4)
    v_mfma_f32_32x32x16_bf16 v[48:63], a[228:231], v[20:23], v[48:63]
    ds_read_b128 v[40:43], v10 offset:61440
    s_waitcnt lgkmcnt(4)
    v_mfma_f32_32x32x16_bf16 v[48:63], a[232:235], v[24:27], v[48:63]
    ds_read_b128 v[44:47], v11 offset:61440
    s_waitcnt lgkmcnt(4)
    v_mfma_f32_32x32x16_bf16 v[48:63], a[236:239], v[28:31], v[48:63]
    s_waitcnt vmcnt(1) lgkmcnt(0)
    s_barrier
    ds_read_b128 v[16:19], v12 offset:0
    v_mfma_f32_32x32x16_bf16 v[48:63], a[240:243], v[32:35], v[48:63]
    ds_read_b128 v[20:23], v13 offset:0
    v_mfma_f32_32x32x16_bf16 v[48:63], a[244:247], v[36:39], v[48:63]
    ds_read_b128 v[24:27], v14 offset:0
    v_mfma_f32_32x32x16_bf16 v[48:63], a[248:251], v[40:43], v[48:63]
    ds_read_b128 v[28:31], v15 offset:0
    v_mfma_f32_32x32x16_bf16 v[48:63], a[252:255], v[44:47], v[48:63]
    s_add_u32 s63, s63, 1
    s_add_u32 s65, s65, 0x10000
    s_branch Lw_Kloop
Lw_Kend:
    s_nop 7
    v_cvt_pk_bf16_f32 v80, v64, v65
    v_cvt_pk_bf16_f32 v81, v66, v67
    v_cvt_pk_bf16_f32 v82, v68, v69
    v_cvt_pk_bf16_f32 v83, v70, v71
    buffer_store_dwordx4 v[80:83], v1, s[48:51], s67 offen offset:0 sc1
    v_cvt_pk_bf16_f32 v84, v72, v73
    v_cvt_pk_bf16_f32 v85, v74, v75
    v_cvt_pk_bf16_f32 v86, v76, v77
    v_cvt_pk_bf16_f32 v87, v78, v79
    buffer_store_dwordx4 v[84:87], v1, s[48:51], s67 offen offset:1024 sc1
    s_waitcnt vmcnt(0)
    v_mov_b32 v3, 64
    v_mov_b32 v4, 0
    s_mov_b64 exec, 1
    buffer_store_dword v3, v4, s[48:51], s68 offen sc1
    s_mov_b64 exec, -1
    s_waitcnt vmcnt(0) lgkmcnt(0)
    s_branch L_ssm
Lw_V:
    s_lshl_b32 s67, s62, 2
    s_add_u32 s67, s67, s4
    s_lshl_b32 s67, s67, 11
    s_add_u32 s67, s67, 33554432
    ds_read_b128 v[16:19], v8 offset:0
    ds_read_b128 v[20:23], v9 offset:0
    ds_read_b128 v[24:27], v10 offset:0
    ds_read_b128 v[28:31], v11 offset:0
    ds_read_b128 v[32:35], v8 offset:4096
    s_waitcnt lgkmcnt(4)
    v_mfma_f32_32x32x16_bf16 v[48:63], v[16:19], a[0:3], 0
    ds_read_b128 v[36:39], v9 offset:4096
    s_waitcnt lgkmcnt(4)
    v_mfma_f32_32x32x16_bf16 v[48:63], v[20:23], a[4:7], v[48:63]
    ds_read_b128 v[40:43], v10 offset:4096
    s_waitcnt lgkmcnt(4)
    v_mfma_f32_32x32x16_bf16 v[48:63], v[24:27], a[8:11], v[48:63]
    ds_read_b128 v[44:47], v11 offset:4096
    s_waitcnt lgkmcnt(4)
    v_mfma_f32_32x32x16_bf16 v[48:63], v[28:31], a[12:15], v[48:63]
    ds_read_b128 v[16:19], v8 offset:8192
    s_waitcnt lgkmcnt(4)
    v_mfma_f32_32x32x16_bf16 v[48:63], v[32:35], a[16:19], v[48:63]
    ds_read_b128 v[20:23], v9 offset:8192
    s_waitcnt lgkmcnt(4)
    v_mfma_f32_32x32x16_bf16 v[48:63], v[36:39], a[20:23], v[48:63]
    ds_read_b128 v[24:27], v10 offset:8192
    s_waitcnt lgkmcnt(4)
    v_mfma_f32_32x32x16_bf16 v[48:63], v[40:43], a[24:27], v[48:63]
    ds_read_b128 v[28:31], v11 offset:8192
    s_waitcnt lgkmcnt(4)
    v_mfma_f32_32x32x16_bf16 v[48:63], v[44:47], a[28:31], v[48:63]
    ds_read_b128 v[32:35], v8 offset:12288
    s_waitcnt lgkmcnt(4)
    v_mfma_f32_32x32x16_bf16 v[48:63], v[16:19], a[32:35], v[48:63]
    ds_read_b128 v[36:39], v9 offset:12288
    s_waitcnt lgkmcnt(4)
    v_mfma_f32_32x32x16_bf16 v[48:63], v[20:23], a[36:39], v[48:63]
    ds_read_b128 v[40:43], v10 offset:12288
    s_waitcnt lgkmcnt(4)
    v_mfma_f32_32x32x16_bf16 v[48:63], v[24:27], a[40:43], v[48:63]
    ds_read_b128 v[44:47], v11 offset:12288
    s_waitcnt lgkmcnt(4)
    v_mfma_f32_32x32x16_bf16 v[48:63], v[28:31], a[44:47], v[48:63]
    ds_read_b128 v[16:19], v8 offset:16384
    s_waitcnt lgkmcnt(4)
    v_mfma_f32_32x32x16_bf16 v[48:63], v[32:35], a[48:51], v[48:63]
    s_add_u32 m0, s66, 65536
    s_nop 0
    buffer_load_dwordx4 v2, s[56:59], s65 offen offset:0 lds
    ds_read_b128 v[20:23], v9 offset:16384
    s_waitcnt lgkmcnt(4)
    v_mfma_f32_32x32x16_bf16 v[48:63], v[36:39], a[52:55], v[48:63]
    ds_read_b128 v[24:27], v10 offset:16384
    s_waitcnt lgkmcnt(4)
    v_mfma_f32_32x32x16_bf16 v[48:63], v[40:43], a[56:59], v[48:63]
    s_add_u32 m0, s66, 69504
    s_nop 0
    buffer_load_dwordx4 v2, s[56:59], s65 offen offset:128 lds
    ds_read_b128 v[28:31], v11 offset:16384
    s_waitcnt lgkmcnt(4)
    v_mfma_f32_32x32x16_bf16 v[48:63], v[44:47], a[60:63], v[48:63]
    ds_read_b128 v[32:35], v8 offset:20480
    s_waitcnt lgkmcnt(4)
    v_mfma_f32_32x32x16_bf16 v[48:63], v[16:19], a[64:67], v[48:63]
    s_add_u32 m0, s66, 73472
    s_nop 0
    buffer_load_dwordx4 v2, s[56:59], s65 offen offset:256 lds
    ds_read_b128 v[36:39], v9 offset:20480
    s_waitcnt lgkmcnt(4)
    v_mfma_f32_32x32x16_bf16 v[48:63], v[20:23], a[68:71], v[48:63]
    ds_read_b128 v[40:43], v10 offset:20480
    s_waitcnt lgkmcnt(4)
    v_mfma_f32_32x32x16_bf16 v[48:63], v[24:27], a[72:75], v[48:63]
    s_add_u32 m0, s66, 77440
    s_nop 0
    buffer_load_dwordx4 v2, s[56:59], s65 offen offset:384 lds
    ds_read_b128 v[44:47], v11 offset:20480
    s_waitcnt lgkmcnt(4)
    v_mfma_f32_32x32x16_bf16 v[48:63], v[28:31], a[76:79], v[48:63]
    ds_read_b128 v[16:19], v8 offset:24576
    s_waitcnt lgkmcnt(4)
    v_mfma_f32_32x32x16_bf16 v[48:63], v[32:35], a[80:83], v[48:63]
    s_add_u32 m0, s66, 81408
    s_nop 0
    buffer_load_dwordx4 v2, s[56:59], s65 offen offset:512 lds
    ds_read_b128 v[20:23], v9 offset:24576
    s_waitcnt lgkmcnt(4)
    v_mfma_f32_32x32x16_bf16 v[48:63], v[36:39], a[84:87], v[48:63]
    ds_read_b128 v[24:27], v10 offset:24576
    s_waitcnt lgkmcnt(4)
    v_mfma_f32_32x32x16_bf16 v[48:63], v[40:43], a[88:91], v[48:63]
    s_add_u32 m0, s66, 85376
    s_nop 0
    buffer_load_dwordx4 v2, s[56:59], s65 offen offset:640 lds
    ds_read_b128 v[28:31], v11 offset:24576
    s_waitcnt lgkmcnt(4)
    v_mfma_f32_32x32x16_bf16 v[48:63], v[44:47], a[92:95], v[48:63]
    ds_read_b128 v[32:35], v8 offset:28672
    s_waitcnt lgkmcnt(4)
    v_mfma_f32_32x32x16_bf16 v[48:63], v[16:19], a[96:99], v[48:63]
    s_add_u32 m0, s66, 89344
    s_nop 0
    buffer_load_dwordx4 v2, s[56:59], s65 offen offset:768 lds
    ds_read_b128 v[36:39], v9 offset:28672
    s_waitcnt lgkmcnt(4)
    v_mfma_f32_32x32x16_bf16 v[48:63], v[20:23], a[100:103], v[48:63]
    ds_read_b128 v[40:43], v10 offset:28672
    s_waitcnt lgkmcnt(4)
    v_mfma_f32_32x32x16_bf16 v[48:63], v[24:27], a[104:107], v[48:63]
    s_add_u32 m0, s66, 93312
    s_nop 0
    buffer_load_dwordx4 v2, s[56:59], s65 offen offset:896 lds
    ds_read_b128 v[44:47], v11 offset:28672
    s_waitcnt lgkmcnt(4)
    v_mfma_f32_32x32x16_bf16 v[48:63], v[28:31], a[108:111], v[48:63]
    ds_read_b128 v[16:19], v8 offset:32768
    s_waitcnt lgkmcnt(4)
    v_mfma_f32_32x32x16_bf16 v[48:63], v[32:35], a[112:115], v[48:63]
    s_add_u32 m0, s66, 97280
    s_nop 0
    buffer_load_dwordx4 v2, s[56:59], s65 offen offset:1024 lds
    ds_read_b128 v[20:23], v9 offset:32768
    s_waitcnt lgkmcnt(4)
    v_mfma_f32_32x32x16_bf16 v[48:63], v[36:39], a[116:119], v[48:63]
    ds_read_b128 v[24:27], v10 offset:32768
    s_waitcnt lgkmcnt(4)
    v_mfma_f32_32x32x16_bf16 v[48:63], v[40:43], a[120:123], v[48:63]
    s_add_u32 m0, s66, 101248
    s_nop 0
    buffer_load_dwordx4 v2, s[56:59], s65 offen offset:1152 lds
    ds_read_b128 v[28:31], v11 offset:32768
    s_waitcnt lgkmcnt(4)
    v_mfma_f32_32x32x16_bf16 v[48:63], v[44:47], a[124:127], v[48:63]
    ds_read_b128 v[32:35], v8 offset:36864
    s_waitcnt lgkmcnt(4)
    v_mfma_f32_32x32x16_bf16 v[48:63], v[16:19], a[128:131], v[48:63]
    s_add_u32 m0, s66, 105216
    s_nop 0
    buffer_load_dwordx4 v2, s[56:59], s65 offen offset:1280 lds
    ds_read_b128 v[36:39], v9 offset:36864
    s_waitcnt lgkmcnt(4)
    v_mfma_f32_32x32x16_bf16 v[48:63], v[20:23], a[132:135], v[48:63]
    ds_read_b128 v[40:43], v10 offset:36864
    s_waitcnt lgkmcnt(4)
    v_mfma_f32_32x32x16_bf16 v[48:63], v[24:27], a[136:139], v[48:63]
    s_add_u32 m0, s66, 109184
    s_nop 0
    buffer_load_dwordx4 v2, s[56:59], s65 offen offset:1408 lds
    ds_read_b128 v[44:47], v11 offset:36864
    s_waitcnt lgkmcnt(4)
    v_mfma_f32_32x32x16_bf16 v[48:63], v[28:31], a[140:143], v[48:63]
    ds_read_b128 v[16:19], v8 offset:40960
    s_waitcnt lgkmcnt(4)
    v_mfma_f32_32x32x16_bf16 v[48:63], v[32:35], a[144:147], v[48:63]
    s_add_u32 m0, s66, 113152
    s_nop 0
    buffer_load_dwordx4 v2, s[56:59], s65 offen offset:1536 lds
    ds_read_b128 v[20:23], v9 offset:40960
    s_waitcnt lgkmcnt(4)
    v_mfma_f32_32x32x16_bf16 v[48:63], v[36:39], a[148:151], v[48:63]
    ds_read_b128 v[24:27], v10 offset:40960
    s_waitcnt lgkmcnt(4)
    v_mfma_f32_32x32x16_bf16 v[48:63], v[40:43], a[152:155], v[48:63]
    s_add_u32 m0, s66, 117120
    s_nop 0
    buffer_load_dwordx4 v2, s[56:59], s65 offen offset:1664 lds
    ds_read_b128 v[28:31], v11 offset:40960
    s_waitcnt lgkmcnt(4)
    v_mfma_f32_32x32x16_bf16 v[48:63], v[44:47], a[156:159], v[48:63]
    ds_read_b128 v[32:35], v8 offset:45056
    s_waitcnt lgkmcnt(4)
    v_mfma_f32_32x32x16_bf16 v[48:63], v[16:19], a[160:163], v[48:63]
    s_add_u32 m0, s66, 121088
    s_nop 0
    buffer_load_dwordx4 v2, s[56:59], s65 offen offset:1792 lds
    ds_read_b128 v[36:39], v9 offset:45056
    s_waitcnt lgkmcnt(4)
    v_mfma_f32_32x32x16_bf16 v[48:63], v[20:23], a[164:167], v[48:63]
    ds_read_b128 v[40:43], v10 offset:45056
    s_waitcnt lgkmcnt(4)
    v_mfma_f32_32x32x16_bf16 v[48:63], v[24:27], a[168:171], v[48:63]
    s_add_u32 m0, s66, 125056
    s_nop 0
    buffer_load_dwordx4 v2, s[56:59], s65 offen offset:1920 lds
    ds_read_b128 v[44:47], v11 offset:45056
    s_waitcnt lgkmcnt(4)
    v_mfma_f32_32x32x16_bf16 v[48:63], v[28:31], a[172:175], v[48:63]
    ds_read_b128 v[16:19], v8 offset:49152
    s_waitcnt lgkmcnt(4)
    v_mfma_f32_32x32x16_bf16 v[48:63], v[32:35], a[176:179], v[48:63]
    ds_read_b128 v[20:23], v9 offset:49152
    s_waitcnt lgkmcnt(4)
    v_mfma_f32_32x32x16_bf16 v[48:63], v[36:39], a[180:183], v[48:63]
    ds_read_b128 v[24:27], v10 offset:49152
    s_waitcnt lgkmcnt(4)
    v_mfma_f32_32x32x16_bf16 v[48:63], v[40:43], a[184:187], v[48:63]
    ds_read_b128 v[28:31], v11 offset:49152
    s_waitcnt lgkmcnt(4)
    v_mfma_f32_32x32x16_bf16 v[48:63], v[44:47], a[188:191], v[48:63]
    ds_read_b128 v[32:35], v8 offset:53248
    s_waitcnt lgkmcnt(4)
    v_mfma_f32_32x32x16_bf16 v[48:63], v[16:19], a[192:195], v[48:63]
    ds_read_b128 v[36:39], v9 offset:53248
    s_waitcnt lgkmcnt(4)
    v_mfma_f32_32x32x16_bf16 v[48:63], v[20:23], a[196:199], v[48:63]
    ds_read_b128 v[40:43], v10 offset:53248
    s_waitcnt lgkmcnt(4)
    v_mfma_f32_32x32x16_bf16 v[48:63], v[24:27], a[200:203], v[48:63]
    ds_read_b128 v[44:47], v11 offset:53248
    s_waitcnt lgkmcnt(4)
    v_mfma_f32_32x32x16_bf16 v[48:63], v[28:31], a[204:207], v[48:63]
    ds_read_b128 v[16:19], v8 offset:57344
    s_waitcnt lgkmcnt(4)
    v_mfma_f32_32x32x16_bf16 v[48:63], v[32:35], a[208:211], v[48:63]
    ds_read_b128 v[20:23], v9 offset:57344
    s_waitcnt lgkmcnt(4)
    v_mfma_f32_32x32x16_bf16 v[48:63], v[36:39], a[212:215], v[48:63]
    ds_read_b128 v[24:27], v10 offset:57344
    s_waitcnt lgkmcnt(4)
    v_mfma_f32_32x32x16_bf16 v[48:63], v[40:43], a[216:219], v[48:63]
    ds_read_b128 v[28:31], v11 offset:57344
    s_waitcnt lgkmcnt(4)
    v_mfma_f32_32x32x16_bf16 v[48:63], v[44:47], a[220:223], v[48:63]
    ds_read_b128 v[32:35], v8 offset:61440
    s_waitcnt lgkmcnt(4)
    v_mfma_f32_32x32x16_bf16 v[48:63], v[16:19], a[224:227], v[48:63]
    ds_read_b128 v[36:39], v9 offset:61440
    s_waitcnt lgkmcnt(4)
    v_mfma_f32_32x32x16_bf16 v[48:63], v[20:23], a[228:231], v[48:63]
    ds_read_b128 v[40:43], v10 offset:61440
    s_waitcnt lgkmcnt(4)
    v_mfma_f32_32x32x16_bf16 v[48:63], v[24:27], a[232:235], v[48:63]
    ds_read_b128 v[44:47], v11 offset:61440
    s_waitcnt lgkmcnt(4)
    v_mfma_f32_32x32x16_bf16 v[48:63], v[28:31], a[236:239], v[48:63]
    s_waitcnt vmcnt(0) lgkmcnt(0)
    s_barrier
    ds_read_b128 v[16:19], v12 offset:0
    v_mfma_f32_32x32x16_bf16 v[48:63], v[32:35], a[240:243], v[48:63]
    ds_read_b128 v[20:23], v13 offset:0
    v_mfma_f32_32x32x16_bf16 v[48:63], v[36:39], a[244:247], v[48:63]
    ds_read_b128 v[24:27], v14 offset:0
    v_mfma_f32_32x32x16_bf16 v[48:63], v[40:43], a[248:251], v[48:63]
    ds_read_b128 v[28:31], v15 offset:0
    v_mfma_f32_32x32x16_bf16 v[48:63], v[44:47], a[252:255], v[48:63]
    s_add_u32 s63, s63, 1
    s_add_u32 s65, s65, 0x10000
Lw_Vloop:
    ds_read_b128 v[32:35], v12 offset:4096
    s_waitcnt lgkmcnt(4)
    v_mfma_f32_32x32x16_bf16 v[64:79], v[16:19], a[0:3], 0
    ds_read_b128 v[36:39], v13 offset:4096
    s_waitcnt lgkmcnt(4)
    v_mfma_f32_32x32x16_bf16 v[64:79], v[20:23], a[4:7], v[64:79]
    ds_read_b128 v[40:43], v14 offset:4096
    s_waitcnt lgkmcnt(4)
    v_mfma_f32_32x32x16_bf16 v[64:79], v[24:27], a[8:11], v[64:79]
    v_cvt_pk_bf16_f32 v80, v48, v49
    ds_read_b128 v[44:47], v15 offset:4096
    s_waitcnt lgkmcnt(4)
    v_mfma_f32_32x32x16_bf16 v[64:79], v[28:31], a[12:15], v[64:79]
    v_cvt_pk_bf16_f32 v81, v50, v51
    ds_read_b128 v[16:19], v12 offset:8192
    s_waitcnt lgkmcnt(4)
    v_mfma_f32_32x32x16_bf16 v[64:79], v[32:35], a[16:19], v[64:79]
    v_cvt_pk_bf16_f32 v82, v52, v53
    ds_read_b128 v[20:23], v13 offset:8192
    s_waitcnt lgkmcnt(4)
    v_mfma_f32_32x32x16_bf16 v[64:79], v[36:39], a[20:23], v[64:79]
    v_cvt_pk_bf16_f32 v83, v54, v55
    buffer_store_dwordx4 v[80:83], v1, s[48:51], s67 offen offset:0 sc1
    ds_read_b128 v[24:27], v14 offset:8192
    s_waitcnt lgkmcnt(4)
    v_mfma_f32_32x32x16_bf16 v[64:79], v[40:43], a[24:27], v[64:79]
    v_cvt_pk_bf16_f32 v84, v56, v57
    ds_read_b128 v[28:31], v15 offset:8192
    s_waitcnt lgkmcnt(4)
    v_mfma_f32_32x32x16_bf16 v[64:79], v[44:47], a[28:31], v[64:79]
    v_cvt_pk_bf16_f32 v85, v58, v59
    ds_read_b128 v[32:35], v12 offset:12288
    s_waitcnt lgkmcnt(4)
    v_mfma_f32_32x32x16_bf16 v[64:79], v[16:19], a[32:35], v[64:79]
    v_cvt_pk_bf16_f32 v86, v60, v61
    ds_read_b128 v[36:39], v13 offset:12288
    s_waitcnt lgkmcnt(4)
    v_mfma_f32_32x32x16_bf16 v[64:79], v[20:23], a[36:39], v[64:79]
    v_cvt_pk_bf16_f32 v87, v62, v63
    buffer_store_dwordx4 v[84:87], v1, s[48:51], s67 offen offset:1024 sc1
    ds_read_b128 v[40:43], v14 offset:12288
    s_waitcnt lgkmcnt(4)
    v_mfma_f32_32x32x16_bf16 v[64:79], v[24:27], a[40:43], v[64:79]
    ds_read_b128 v[44:47], v15 offset:12288
    s_waitcnt lgkmcnt(4)
    v_mfma_f32_32x32x16_bf16 v[64:79], v[28:31], a[44:47], v[64:79]
    ds_read_b128 v[16:19], v12 offset:16384
    s_waitcnt lgkmcnt(4)
    v_mfma_f32_32x32x16_bf16 v[64:79], v[32:35], a[48:51], v[64:79]
    s_add_u32 m0, s66, 0
    s_nop 0
    buffer_load_dwordx4 v2, s[56:59], s65 offen offset:0 lds
    ds_read_b128 v[20:23], v13 offset:16384
    s_waitcnt lgkmcnt(4)
    v_mfma_f32_32x32x16_bf16 v[64:79], v[36:39], a[52:55], v[64:79]
    ds_read_b128 v[24:27], v14 offset:16384
    s_waitcnt lgkmcnt(4)
    v_mfma_f32_32x32x16_bf16 v[64:79], v[40:43], a[56:59], v[64:79]
    s_add_u32 m0, s66, 3968
    s_nop 0
    buffer_load_dwordx4 v2, s[56:59], s65 offen offset:128 lds
    ds_read_b128 v[28:31], v15 offset:16384
    s_waitcnt lgkmcnt(4)
    v_mfma_f32_32x32x16_bf16 v[64:79], v[44:47], a[60:63], v[64:79]
    ds_read_b128 v[32:35], v12 offset:20480
    s_waitcnt lgkmcnt(4)
    v_mfma_f32_32x32x16_bf16 v[64:79], v[16:19], a[64:67], v[64:79]
    s_add_u32 m0, s66, 7936
    s_nop 0
    buffer_load_dwordx4 v2, s[56:59], s65 offen offset:256 lds
    ds_read_b128 v[36:39], v13 offset:20480
    s_waitcnt lgkmcnt(4)
    v_mfma_f32_32x32x16_bf16 v[64:79], v[20:23], a[68:71], v[64:79]
    ds_read_b128 v[40:43], v14 offset:20480
    s_waitcnt lgkmcnt(4)
    v_mfma_f32_32x32x16_bf16 v[64:79], v[24:27], a[72:75], v[64:79]
    s_add_u32 m0, s66, 11904
    s_nop 0
    buffer_load_dwordx4 v2, s[56:59], s65 offen offset:384 lds
    ds_read_b128 v[44:47], v15 offset:20480
    s_waitcnt lgkmcnt(4)
    v_mfma_f32_32x32x16_bf16 v[64:79], v[28:31], a[76:79], v[64:79]
    ds_read_b128 v[16:19], v12 offset:24576
    s_waitcnt lgkmcnt(4)
    v_mfma_f32_32x32x16_bf16 v[64:79], v[32:35], a[80:83], v[64:79]
    s_add_u32 m0, s66, 15872
    s_nop 0
    buffer_load_dwordx4 v2, s[56:59], s65 offen offset:512 lds
    ds_read_b128 v[20:23], v13 offset:24576
    s_waitcnt lgkmcnt(4)
    v_mfma_f32_32x32x16_bf16 v[64:79], v[36:39], a[84:87], v[64:79]
    ds_read_b128 v[24:27], v14 offset:24576
    s_waitcnt lgkmcnt(4)
    v_mfma_f32_32x32x16_bf16 v[64:79], v[40:43], a[88:91], v[64:79]
    s_add_u32 m0, s66, 19840
    s_nop 0
    buffer_load_dwordx4 v2, s[56:59], s65 offen offset:640 lds
    ds_read_b128 v[28:31], v15 offset:24576
    s_waitcnt lgkmcnt(4)
    v_mfma_f32_32x32x16_bf16 v[64:79], v[44:47], a[92:95], v[64:79]
    ds_read_b128 v[32:35], v12 offset:28672
    s_waitcnt lgkmcnt(4)
    v_mfma_f32_32x32x16_bf16 v[64:79], v[16:19], a[96:99], v[64:79]
    s_add_u32 m0, s66, 23808
    s_nop 0
    buffer_load_dwordx4 v2, s[56:59], s65 offen offset:768 lds
    ds_read_b128 v[36:39], v13 offset:28672
    s_waitcnt lgkmcnt(4)
    v_mfma_f32_32x32x16_bf16 v[64:79], v[20:23], a[100:103], v[64:79]
    ds_read_b128 v[40:43], v14 offset:28672
    s_waitcnt lgkmcnt(4)
    v_mfma_f32_32x32x16_bf16 v[64:79], v[24:27], a[104:107], v[64:79]
    s_add_u32 m0, s66, 27776
    s_nop 0
    buffer_load_dwordx4 v2, s[56:59], s65 offen offset:896 lds
    ds_read_b128 v[44:47], v15 offset:28672
    s_waitcnt lgkmcnt(4)
    v_mfma_f32_32x32x16_bf16 v[64:79], v[28:31], a[108:111], v[64:79]
    ds_read_b128 v[16:19], v12 offset:32768
    s_waitcnt lgkmcnt(4)
    v_mfma_f32_32x32x16_bf16 v[64:79], v[32:35], a[112:115], v[64:79]
    s_add_u32 m0, s66, 31744
    s_nop 0
    buffer_load_dwordx4 v2, s[56:59], s65 offen offset:1024 lds
    ds_read_b128 v[20:23], v13 offset:32768
    s_waitcnt lgkmcnt(4)
    v_mfma_f32_32x32x16_bf16 v[64:79], v[36:39], a[116:119], v[64:79]
    ds_read_b128 v[24:27], v14 offset:32768
    s_waitcnt lgkmcnt(4)
    v_mfma_f32_32x32x16_bf16 v[64:79], v[40:43], a[120:123], v[64:79]
    s_add_u32 m0, s66, 35712
    s_nop 0
    buffer_load_dwordx4 v2, s[56:59], s65 offen offset:1152 lds
    ds_read_b128 v[28:31], v15 offset:32768
    s_waitcnt lgkmcnt(4)
    v_mfma_f32_32x32x16_bf16 v[64:79], v[44:47], a[124:127], v[64:79]
    ds_read_b128 v[32:35], v12 offset:36864
    s_waitcnt lgkmcnt(4)
    v_mfma_f32_32x32x16_bf16 v[64:79], v[16:19], a[128:131], v[64:79]
    s_add_u32 m0, s66, 39680
    s_nop 0
    buffer_load_dwordx4 v2, s[56:59], s65 offen offset:1280 lds
    ds_read_b128 v[36:39], v13 offset:36864
    s_waitcnt lgkmcnt(4)
    v_mfma_f32_32x32x16_bf16 v[64:79], v[20:23], a[132:135], v[64:79]
    ds_read_b128 v[40:43], v14 offset:36864
    s_waitcnt lgkmcnt(4)
    v_mfma_f32_32x32x16_bf16 v[64:79], v[24:27], a[136:139], v[64:79]
    s_add_u32 m0, s66, 43648
    s_nop 0
    buffer_load_dwordx4 v2, s[56:59], s65 offen offset:1408 lds
    ds_read_b128 v[44:47], v15 offset:36864
    s_waitcnt lgkmcnt(4)
    v_mfma_f32_32x32x16_bf16 v[64:79], v[28:31], a[140:143], v[64:79]
    ds_read_b128 v[16:19], v12 offset:40960
    s_waitcnt lgkmcnt(4)
    v_mfma_f32_32x32x16_bf16 v[64:79], v[32:35], a[144:147], v[64:79]
    s_add_u32 m0, s66, 47616
    s_nop 0
    buffer_load_dwordx4 v2, s[56:59], s65 offen offset:1536 lds
    ds_read_b128 v[20:23], v13 offset:40960
    s_waitcnt lgkmcnt(4)
    v_mfma_f32_32x32x16_bf16 v[64:79], v[36:39], a[148:151], v[64:79]
    ds_read_b128 v[24:27], v14 offset:40960
    s_waitcnt lgkmcnt(4)
    v_mfma_f32_32x32x16_bf16 v[64:79], v[40:43], a[152:155], v[64:79]
    s_add_u32 m0, s66, 51584
    s_nop 0
    buffer_load_dwordx4 v2, s[56:59], s65 offen offset:1664 lds
    ds_read_b128 v[28:31], v15 offset:40960
    s_waitcnt lgkmcnt(4)
    v_mfma_f32_32x32x16_bf16 v[64:79], v[44:47], a[156:159], v[64:79]
    ds_read_b128 v[32:35], v12 offset:45056
    s_waitcnt lgkmcnt(4)
    v_mfma_f32_32x32x16_bf16 v[64:79], v[16:19], a[160:163], v[64:79]
    s_add_u32 m0, s66, 55552
    s_nop 0
    buffer_load_dwordx4 v2, s[56:59], s65 offen offset:1792 lds
    ds_read_b128 v[36:39], v13 offset:45056
    s_waitcnt lgkmcnt(4)
    v_mfma_f32_32x32x16_bf16 v[64:79], v[20:23], a[164:167], v[64:79]
    ds_read_b128 v[40:43], v14 offset:45056
    s_waitcnt lgkmcnt(4)
    v_mfma_f32_32x32x16_bf16 v[64:79], v[24:27], a[168:171], v[64:79]
    s_add_u32 m0, s66, 59520
    s_nop 0
    buffer_load_dwordx4 v2, s[56:59], s65 offen offset:1920 lds
    ds_read_b128 v[44:47], v15 offset:45056
    s_waitcnt lgkmcnt(4)
    v_mfma_f32_32x32x16_bf16 v[64:79], v[28:31], a[172:175], v[64:79]
    ds_read_b128 v[16:19], v12 offset:49152
    s_waitcnt lgkmcnt(4)
    v_mfma_f32_32x32x16_bf16 v[64:79], v[32:35], a[176:179], v[64:79]
    ds_read_b128 v[20:23], v13 offset:49152
    s_waitcnt lgkmcnt(4)
    v_mfma_f32_32x32x16_bf16 v[64:79], v[36:39], a[180:183], v[64:79]
    ds_read_b128 v[24:27], v14 offset:49152
    s_waitcnt lgkmcnt(4)
    v_mfma_f32_32x32x16_bf16 v[64:79], v[40:43], a[184:187], v[64:79]
    s_waitcnt vmcnt(16)
    v_mov_b32 v3, s63
    v_mov_b32 v4, 0
    s_mov_b64 exec, 1
    buffer_store_dword v3, v4, s[48:51], s68 offen sc1
    s_mov_b64 exec, -1
    s_add_u32 s67, s67, 0x40000
    ds_read_b128 v[28:31], v15 offset:49152
    s_waitcnt lgkmcnt(4)
    v_mfma_f32_32x32x16_bf16 v[64:79], v[44:47], a[188:191], v[64:79]
    ds_read_b128 v[32:35], v12 offset:53248
    s_waitcnt lgkmcnt(4)
    v_mfma_f32_32x32x16_bf16 v[64:79], v[16:19], a[192:195], v[64:79]
    ds_read_b128 v[36:39], v13 offset:53248
    s_waitcnt lgkmcnt(4)
    v_mfma_f32_32x32x16_bf16 v[64:79], v[20:23], a[196:199], v[64:79]
    ds_read_b128 v[40:43], v14 offset:53248
    s_waitcnt lgkmcnt(4)
    v_mfma_f32_32x32x16_bf16 v[64:79], v[24:27], a[200:203], v[64:79]
    ds_read_b128 v[44:47], v15 offset:53248
    s_waitcnt lgkmcnt(4)
    v_mfma_f32_32x32x16_bf16 v[64:79], v[28:31], a[204:207], v[64:79]
    ds_read_b128 v[16:19], v12 offset:57344
    s_waitcnt lgkmcnt(4)
    v_mfma_f32_32x32x16_bf16 v[64:79], v[32:35], a[208:211], v[64:79]
    ds_read_b128 v[20:23], v13 offset:57344
    s_waitcnt lgkmcnt(4)
    v_mfma_f32_32x32x16_bf16 v[64:79], v[36:39], a[212:215], v[64:79]
    ds_read_b128 v[24:27], v14 offset:57344
    s_waitcnt lgkmcnt(4)
    v_mfma_f32_32x32x16_bf16 v[64:79], v[40:43], a[216:219], v[64:79]
    ds_read_b128 v[28:31], v15 offset:57344
    s_waitcnt lgkmcnt(4)
    v_mfma_f32_32x32x16_bf16 v[64:79], v[44:47], a[220:223], v[64:79]
    ds_read_b128 v[32:35], v12 offset:61440
    s_waitcnt lgkmcnt(4)
    v_mfma_f32_32x32x16_bf16 v[64:79], v[16:19], a[224:227], v[64:79]
    ds_read_b128 v[36:39], v13 offset:61440
    s_waitcnt lgkmcnt(4)
    v_mfma_f32_32x32x16_bf16 v[64:79], v[20:23], a[228:231], v[64:79]
    ds_read_b128 v[40:43], v14 offset:61440
    s_waitcnt lgkmcnt(4)
    v_mfma_f32_32x32x16_bf16 v[64:79], v[24:27], a[232:235], v[64:79]
    ds_read_b128 v[44:47], v15 offset:61440
    s_waitcnt lgkmcnt(4)
    v_mfma_f32_32x32x16_bf16 v[64:79], v[28:31], a[236:239], v[64:79]
    s_waitcnt vmcnt(1) lgkmcnt(0)
    s_barrier
    ds_read_b128 v[16:19], v8 offset:0
    v_mfma_f32_32x32x16_bf16 v[64:79], v[32:35], a[240:243], v[64:79]
    ds_read_b128 v[20:23], v9 offset:0
    v_mfma_f32_32x32x16_bf16 v[64:79], v[36:39], a[244:247], v[64:79]
    ds_read_b128 v[24:27], v10 offset:0
    v_mfma_f32_32x32x16_bf16 v[64:79], v[40:43], a[248:251], v[64:79]
    ds_read_b128 v[28:31], v11 offset:0
    v_mfma_f32_32x32x16_bf16 v[64:79], v[44:47], a[252:255], v[64:79]
    s_add_u32 s63, s63, 1
    s_add_u32 s65, s65, 0x10000
    s_cmp_eq_u32 s63, 64
    s_cbranch_scc1 Lw_Vend
    ds_read_b128 v[32:35], v8 offset:4096
    s_waitcnt lgkmcnt(4)
    v_mfma_f32_32x32x16_bf16 v[48:63], v[16:19], a[0:3], 0
    ds_read_b128 v[36:39], v9 offset:4096
    s_waitcnt lgkmcnt(4)
    v_mfma_f32_32x32x16_bf16 v[48:63], v[20:23], a[4:7], v[48:63]
    ds_read_b128 v[40:43], v10 offset:4096
    s_waitcnt lgkmcnt(4)
    v_mfma_f32_32x32x16_bf16 v[48:63], v[24:27], a[8:11], v[48:63]
    v_cvt_pk_bf16_f32 v80, v64, v65
    ds_read_b128 v[44:47], v11 offset:4096
    s_waitcnt lgkmcnt(4)
    v_mfma_f32_32x32x16_bf16 v[48:63], v[28:31], a[12:15], v[48:63]
    v_cvt_pk_bf16_f32 v81, v66, v67
    ds_read_b128 v[16:19], v8 offset:8192
    s_waitcnt lgkmcnt(4)
    v_mfma_f32_32x32x16_bf16 v[48:63], v[32:35], a[16:19], v[48:63]
    v_cvt_pk_bf16_f32 v82, v68, v69
    ds_read_b128 v[20:23], v9 offset:8192
    s_waitcnt lgkmcnt(4)
    v_mfma_f32_32x32x16_bf16 v[48:63], v[36:39], a[20:23], v[48:63]
    v_cvt_pk_bf16_f32 v83, v70, v71
    buffer_store_dwordx4 v[80:83], v1, s[48:51], s67 offen offset:0 sc1
    ds_read_b128 v[24:27], v10 offset:8192
    s_waitcnt lgkmcnt(4)
    v_mfma_f32_32x32x16_bf16 v[48:63], v[40:43], a[24:27], v[48:63]
    v_cvt_pk_bf16_f32 v84, v72, v73
    ds_read_b128 v[28:31], v11 offset:8192
    s_waitcnt lgkmcnt(4)
    v_mfma_f32_32x32x16_bf16 v[48:63], v[44:47], a[28:31], v[48:63]
    v_cvt_pk_bf16_f32 v85, v74, v75
    ds_read_b128 v[32:35], v8 offset:12288
    s_waitcnt lgkmcnt(4)
    v_mfma_f32_32x32x16_bf16 v[48:63], v[16:19], a[32:35], v[48:63]
    v_cvt_pk_bf16_f32 v86, v76, v77
    ds_read_b128 v[36:39], v9 offset:12288
    s_waitcnt lgkmcnt(4)
    v_mfma_f32_32x32x16_bf16 v[48:63], v[20:23], a[36:39], v[48:63]
    v_cvt_pk_bf16_f32 v87, v78, v79
    buffer_store_dwordx4 v[84:87], v1, s[48:51], s67 offen offset:1024 sc1
    ds_read_b128 v[40:43], v10 offset:12288
    s_waitcnt lgkmcnt(4)
    v_mfma_f32_32x32x16_bf16 v[48:63], v[24:27], a[40:43], v[48:63]
    ds_read_b128 v[44:47], v11 offset:12288
    s_waitcnt lgkmcnt(4)
    v_mfma_f32_32x32x16_bf16 v[48:63], v[28:31], a[44:47], v[48:63]
    ds_read_b128 v[16:19], v8 offset:16384
    s_waitcnt lgkmcnt(4)
    v_mfma_f32_32x32x16_bf16 v[48:63], v[32:35], a[48:51], v[48:63]
    s_add_u32 m0, s66, 65536
    s_nop 0
    buffer_load_dwordx4 v2, s[56:59], s65 offen offset:0 lds
    ds_read_b128 v[20:23], v9 offset:16384
    s_waitcnt lgkmcnt(4)
    v_mfma_f32_32x32x16_bf16 v[48:63], v[36:39], a[52:55], v[48:63]
    ds_read_b128 v[24:27], v10 offset:16384
    s_waitcnt lgkmcnt(4)
    v_mfma_f32_32x32x16_bf16 v[48:63], v[40:43], a[56:59], v[48:63]
    s_add_u32 m0, s66, 69504
    s_nop 0
    buffer_load_dwordx4 v2, s[56:59], s65 offen offset:128 lds
    ds_read_b128 v[28:31], v11 offset:16384
    s_waitcnt lgkmcnt(4)
    v_mfma_f32_32x32x16_bf16 v[48:63], v[44:47], a[60:63], v[48:63]
    ds_read_b128 v[32:35], v8 offset:20480
    s_waitcnt lgkmcnt(4)
    v_mfma_f32_32x32x16_bf16 v[48:63], v[16:19], a[64:67], v[48:63]
    s_add_u32 m0, s66, 73472
    s_nop 0
    buffer_load_dwordx4 v2, s[56:59], s65 offen offset:256 lds
    ds_read_b128 v[36:39], v9 offset:20480
    s_waitcnt lgkmcnt(4)
    v_mfma_f32_32x32x16_bf16 v[48:63], v[20:23], a[68:71], v[48:63]
    ds_read_b128 v[40:43], v10 offset:20480
    s_waitcnt lgkmcnt(4)
    v_mfma_f32_32x32x16_bf16 v[48:63], v[24:27], a[72:75], v[48:63]
    s_add_u32 m0, s66, 77440
    s_nop 0
    buffer_load_dwordx4 v2, s[56:59], s65 offen offset:384 lds
    ds_read_b128 v[44:47], v11 offset:20480
    s_waitcnt lgkmcnt(4)
    v_mfma_f32_32x32x16_bf16 v[48:63], v[28:31], a[76:79], v[48:63]
    ds_read_b128 v[16:19], v8 offset:24576
    s_waitcnt lgkmcnt(4)
    v_mfma_f32_32x32x16_bf16 v[48:63], v[32:35], a[80:83], v[48:63]
    s_add_u32 m0, s66, 81408
    s_nop 0
    buffer_load_dwordx4 v2, s[56:59], s65 offen offset:512 lds
    ds_read_b128 v[20:23], v9 offset:24576
    s_waitcnt lgkmcnt(4)
    v_mfma_f32_32x32x16_bf16 v[48:63], v[36:39], a[84:87], v[48:63]
    ds_read_b128 v[24:27], v10 offset:24576
    s_waitcnt lgkmcnt(4)
    v_mfma_f32_32x32x16_bf16 v[48:63], v[40:43], a[88:91], v[48:63]
    s_add_u32 m0, s66, 85376
    s_nop 0
    buffer_load_dwordx4 v2, s[56:59], s65 offen offset:640 lds
    ds_read_b128 v[28:31], v11 offset:24576
    s_waitcnt lgkmcnt(4)
    v_mfma_f32_32x32x16_bf16 v[48:63], v[44:47], a[92:95], v[48:63]
    ds_read_b128 v[32:35], v8 offset:28672
    s_waitcnt lgkmcnt(4)
    v_mfma_f32_32x32x16_bf16 v[48:63], v[16:19], a[96:99], v[48:63]
    s_add_u32 m0, s66, 89344
    s_nop 0
    buffer_load_dwordx4 v2, s[56:59], s65 offen offset:768 lds
    ds_read_b128 v[36:39], v9 offset:28672
    s_waitcnt lgkmcnt(4)
    v_mfma_f32_32x32x16_bf16 v[48:63], v[20:23], a[100:103], v[48:63]
    ds_read_b128 v[40:43], v10 offset:28672
    s_waitcnt lgkmcnt(4)
    v_mfma_f32_32x32x16_bf16 v[48:63], v[24:27], a[104:107], v[48:63]
    s_add_u32 m0, s66, 93312
    s_nop 0
    buffer_load_dwordx4 v2, s[56:59], s65 offen offset:896 lds
    ds_read_b128 v[44:47], v11 offset:28672
    s_waitcnt lgkmcnt(4)
    v_mfma_f32_32x32x16_bf16 v[48:63], v[28:31], a[108:111], v[48:63]
    ds_read_b128 v[16:19], v8 offset:32768
    s_waitcnt lgkmcnt(4)
    v_mfma_f32_32x32x16_bf16 v[48:63], v[32:35], a[112:115], v[48:63]
    s_add_u32 m0, s66, 97280
    s_nop 0
    buffer_load_dwordx4 v2, s[56:59], s65 offen offset:1024 lds
    ds_read_b128 v[20:23], v9 offset:32768
    s_waitcnt lgkmcnt(4)
    v_mfma_f32_32x32x16_bf16 v[48:63], v[36:39], a[116:119], v[48:63]
    ds_read_b128 v[24:27], v10 offset:32768
    s_waitcnt lgkmcnt(4)
    v_mfma_f32_32x32x16_bf16 v[48:63], v[40:43], a[120:123], v[48:63]
    s_add_u32 m0, s66, 101248
    s_nop 0
    buffer_load_dwordx4 v2, s[56:59], s65 offen offset:1152 lds
    ds_read_b128 v[28:31], v11 offset:32768
    s_waitcnt lgkmcnt(4)
    v_mfma_f32_32x32x16_bf16 v[48:63], v[44:47], a[124:127], v[48:63]
    ds_read_b128 v[32:35], v8 offset:36864
    s_waitcnt lgkmcnt(4)
    v_mfma_f32_32x32x16_bf16 v[48:63], v[16:19], a[128:131], v[48:63]
    s_add_u32 m0, s66, 105216
    s_nop 0
    buffer_load_dwordx4 v2, s[56:59], s65 offen offset:1280 lds
    ds_read_b128 v[36:39], v9 offset:36864
    s_waitcnt lgkmcnt(4)
    v_mfma_f32_32x32x16_bf16 v[48:63], v[20:23], a[132:135], v[48:63]
    ds_read_b128 v[40:43], v10 offset:36864
    s_waitcnt lgkmcnt(4)
    v_mfma_f32_32x32x16_bf16 v[48:63], v[24:27], a[136:139], v[48:63]
    s_add_u32 m0, s66, 109184
    s_nop 0
    buffer_load_dwordx4 v2, s[56:59], s65 offen offset:1408 lds
    ds_read_b128 v[44:47], v11 offset:36864
    s_waitcnt lgkmcnt(4)
    v_mfma_f32_32x32x16_bf16 v[48:63], v[28:31], a[140:143], v[48:63]
    ds_read_b128 v[16:19], v8 offset:40960
    s_waitcnt lgkmcnt(4)
    v_mfma_f32_32x32x16_bf16 v[48:63], v[32:35], a[144:147], v[48:63]
    s_add_u32 m0, s66, 113152
    s_nop 0
    buffer_load_dwordx4 v2, s[56:59], s65 offen offset:1536 lds
    ds_read_b128 v[20:23], v9 offset:40960
    s_waitcnt lgkmcnt(4)
    v_mfma_f32_32x32x16_bf16 v[48:63], v[36:39], a[148:151], v[48:63]
    ds_read_b128 v[24:27], v10 offset:40960
    s_waitcnt lgkmcnt(4)
    v_mfma_f32_32x32x16_bf16 v[48:63], v[40:43], a[152:155], v[48:63]
    s_add_u32 m0, s66, 117120
    s_nop 0
    buffer_load_dwordx4 v2, s[56:59], s65 offen offset:1664 lds
    ds_read_b128 v[28:31], v11 offset:40960
    s_waitcnt lgkmcnt(4)
    v_mfma_f32_32x32x16_bf16 v[48:63], v[44:47], a[156:159], v[48:63]
    ds_read_b128 v[32:35], v8 offset:45056
    s_waitcnt lgkmcnt(4)
    v_mfma_f32_32x32x16_bf16 v[48:63], v[16:19], a[160:163], v[48:63]
    s_add_u32 m0, s66, 121088
    s_nop 0
    buffer_load_dwordx4 v2, s[56:59], s65 offen offset:1792 lds
    ds_read_b128 v[36:39], v9 offset:45056
    s_waitcnt lgkmcnt(4)
    v_mfma_f32_32x32x16_bf16 v[48:63], v[20:23], a[164:167], v[48:63]
    ds_read_b128 v[40:43], v10 offset:45056
    s_waitcnt lgkmcnt(4)
    v_mfma_f32_32x32x16_bf16 v[48:63], v[24:27], a[168:171], v[48:63]
    s_add_u32 m0, s66, 125056
    s_nop 0
    buffer_load_dwordx4 v2, s[56:59], s65 offen offset:1920 lds
    ds_read_b128 v[44:47], v11 offset:45056
    s_waitcnt lgkmcnt(4)
    v_mfma_f32_32x32x16_bf16 v[48:63], v[28:31], a[172:175], v[48:63]
    ds_read_b128 v[16:19], v8 offset:49152
    s_waitcnt lgkmcnt(4)
    v_mfma_f32_32x32x16_bf16 v[48:63], v[32:35], a[176:179], v[48:63]
    ds_read_b128 v[20:23], v9 offset:49152
    s_waitcnt lgkmcnt(4)
    v_mfma_f32_32x32x16_bf16 v[48:63], v[36:39], a[180:183], v[48:63]
    ds_read_b128 v[24:27], v10 offset:49152
    s_waitcnt lgkmcnt(4)
    v_mfma_f32_32x32x16_bf16 v[48:63], v[40:43], a[184:187], v[48:63]
    s_waitcnt vmcnt(16)
    v_mov_b32 v3, s63
    v_mov_b32 v4, 0
    s_mov_b64 exec, 1
    buffer_store_dword v3, v4, s[48:51], s68 offen sc1
    s_mov_b64 exec, -1
    s_add_u32 s67, s67, 0x40000
    ds_read_b128 v[28:31], v11 offset:49152
    s_waitcnt lgkmcnt(4)
    v_mfma_f32_32x32x16_bf16 v[48:63], v[44:47], a[188:191], v[48:63]
    ds_read_b128 v[32:35], v8 offset:53248
    s_waitcnt lgkmcnt(4)
    v_mfma_f32_32x32x16_bf16 v[48:63], v[16:19], a[192:195], v[48:63]
    ds_read_b128 v[36:39], v9 offset:53248
    s_waitcnt lgkmcnt(4)
    v_mfma_f32_32x32x16_bf16 v[48:63], v[20:23], a[196:199], v[48:63]
    ds_read_b128 v[40:43], v10 offset:53248
    s_waitcnt lgkmcnt(4)
    v_mfma_f32_32x32x16_bf16 v[48:63], v[24:27], a[200:203], v[48:63]
    ds_read_b128 v[44:47], v11 offset:53248
    s_waitcnt lgkmcnt(4)
    v_mfma_f32_32x32x16_bf16 v[48:63], v[28:31], a[204:207], v[48:63]
    ds_read_b128 v[16:19], v8 offset:57344
    s_waitcnt lgkmcnt(4)
    v_mfma_f32_32x32x16_bf16 v[48:63], v[32:35], a[208:211], v[48:63]
    ds_read_b128 v[20:23], v9 offset:57344
    s_waitcnt lgkmcnt(4)
    v_mfma_f32_32x32x16_bf16 v[48:63], v[36:39], a[212:215], v[48:63]
    ds_read_b128 v[24:27], v10 offset:57344
    s_waitcnt lgkmcnt(4)
    v_mfma_f32_32x32x16_bf16 v[48:63], v[40:43], a[216:219], v[48:63]
    ds_read_b128 v[28:31], v11 offset:57344
    s_waitcnt lgkmcnt(4)
    v_mfma_f32_32x32x16_bf16 v[48:63], v[44:47], a[220:223], v[48:63]
    ds_read_b128 v[32:35], v8 offset:61440
    s_waitcnt lgkmcnt(4)
    v_mfma_f32_32x32x16_bf16 v[48:63], v[16:19], a[224:227], v[48:63]
    ds_read_b128 v[36:39], v9 offset:61440
    s_waitcnt lgkmcnt(4)
    v_mfma_f32_32x32x16_bf16 v[48:63], v[20:23], a[228:231], v[48:63]
    ds_read_b128 v[40:43], v10 offset:61440
    s_waitcnt lgkmcnt(4)
    v_mfma_f32_32x32x16_bf16 v[48:63], v[24:27], a[232:235], v[48:63]
    ds_read_b128 v[44:47], v11 offset:61440
    s_waitcnt lgkmcnt(4)
    v_mfma_f32_32x32x16_bf16 v[48:63], v[28:31], a[236:239], v[48:63]
    s_waitcnt vmcnt(1) lgkmcnt(0)
    s_barrier
    ds_read_b128 v[16:19], v12 offset:0
    v_mfma_f32_32x32x16_bf16 v[48:63], v[32:35], a[240:243], v[48:63]
    ds_read_b128 v[20:23], v13 offset:0
    v_mfma_f32_32x32x16_bf16 v[48:63], v[36:39], a[244:247], v[48:63]
    ds_read_b128 v[24:27], v14 offset:0
    v_mfma_f32_32x32x16_bf16 v[48:63], v[40:43], a[248:251], v[48:63]
    ds_read_b128 v[28:31], v15 offset:0
    v_mfma_f32_32x32x16_bf16 v[48:63], v[44:47], a[252:255], v[48:63]
    s_add_u32 s63, s63, 1
    s_add_u32 s65, s65, 0x10000
    s_branch Lw_Vloop
Lw_Vend:
    s_nop 7
    v_cvt_pk_bf16_f32 v80, v64, v65
    v_cvt_pk_bf16_f32 v81, v66, v67
    v_cvt_pk_bf16_f32 v82, v68, v69
    v_cvt_pk_bf16_f32 v83, v70, v71
    buffer_store_dwordx4 v[80:83], v1, s[48:51], s67 offen offset:0 sc1
    v_cvt_pk_bf16_f32 v84, v72, v73
    v_cvt_pk_bf16_f32 v85, v74, v75
    v_cvt_pk_bf16_f32 v86, v76, v77
    v_cvt_pk_bf16_f32 v87, v78, v79
    buffer_store_dwordx4 v[84:87], v1, s[48:51], s67 offen offset:1024 sc1
    s_waitcnt vmcnt(0)
    v_mov_b32 v3, 64
    v_mov_b32 v4, 0
    s_mov_b64 exec, 1
    buffer_store_dword v3, v4, s[48:51], s68 offen sc1
    s_mov_b64 exec, -1
    s_waitcnt vmcnt(0) lgkmcnt(0)
    s_branch L_ssm
L_ssm:
    s_barrier
    s_lshl_b32 s60, s47, 4
    s_add_u32 s60, s60, s6
    s_lshl_b32 s60, s60, 2
    s_add_u32 s60, s60, s4
    s_lshl_b32 s61, s60, 3
    s_load_dwordx2 s[64:65], s[36:37], s61
    s_load_dwordx2 s[66:67], s[38:39], s61
    s_lshl_b32 s62, s60, 10
    v_lshl_add_u32 v2, v0, 2, s62
    global_load_dword v16, v2, s[24:25] offset:0
    global_load_dword v17, v2, s[26:27] offset:0
    global_load_dword v18, v2, s[28:29] offset:0
    global_load_dword v19, v2, s[30:31] offset:0
    global_load_dword v20, v2, s[32:33] offset:0
    global_load_dword v21, v2, s[34:35] offset:0
    global_load_dword v22, v2, s[24:25] offset:256
    global_load_dword v23, v2, s[26:27] offset:256
    global_load_dword v24, v2, s[28:29] offset:256
    global_load_dword v25, v2, s[30:31] offset:256
    global_load_dword v26, v2, s[32:33] offset:256
    global_load_dword v27, v2, s[34:35] offset:256
    global_load_dword v28, v2, s[24:25] offset:512
    global_load_dword v29, v2, s[26:27] offset:512
    global_load_dword v30, v2, s[28:29] offset:512
    global_load_dword v31, v2, s[30:31] offset:512
    global_load_dword v32, v2, s[32:33] offset:512
    global_load_dword v33, v2, s[34:35] offset:512
    global_load_dword v34, v2, s[24:25] offset:768
    global_load_dword v35, v2, s[26:27] offset:768
    global_load_dword v36, v2, s[28:29] offset:768
    global_load_dword v37, v2, s[30:31] offset:768
    global_load_dword v38, v2, s[32:33] offset:768
    global_load_dword v39, v2, s[34:35] offset:768
    s_mov_b32 s52, s22
    s_and_b32 s53, s23, 0xffff
    s_mov_b32 s54, 4194304
    s_mov_b32 s55, 0x20000
    s_mov_b32 s56, s40
    s_and_b32 s57, s41, 0xffff
    s_mov_b32 s58, 8388608
    s_mov_b32 s59, 0x20000
    v_and_b32 v4, 31, v0
    v_lshrrev_b32 v5, 5, v0
    v_lshlrev_b32 v3, 16, v4
    v_lshl_add_u32 v3, v5, 13, v3
    s_add_u32 s62, s61, 0
    buffer_load_dwordx2 v[192:193], v3, s[52:55], s62 offen offset:0
    buffer_load_dwordx2 v[194:195], v3, s[52:55], s62 offen offset:2048
    s_add_u32 s62, s61, 4096
    buffer_load_dwordx2 v[196:197], v3, s[52:55], s62 offen offset:0
    buffer_load_dwordx2 v[198:199], v3, s[52:55], s62 offen offset:2048
    s_add_u32 s62, s61, 16384
    buffer_load_dwordx2 v[200:201], v3, s[52:55], s62 offen offset:0
    buffer_load_dwordx2 v[202:203], v3, s[52:55], s62 offen offset:2048
    s_add_u32 s62, s61, 20480
    buffer_load_dwordx2 v[204:205], v3, s[52:55], s62 offen offset:0
    buffer_load_dwordx2 v[206:207], v3, s[52:55], s62 offen offset:2048
    s_add_u32 s62, s61, 32768
    buffer_load_dwordx2 v[208:209], v3, s[52:55], s62 offen offset:0
    buffer_load_dwordx2 v[210:211], v3, s[52:55], s62 offen offset:2048
    s_add_u32 s62, s61, 36864
    buffer_load_dwordx2 v[212:213], v3, s[52:55], s62 offen offset:0
    buffer_load_dwordx2 v[214:215], v3, s[52:55], s62 offen offset:2048
    s_add_u32 s62, s61, 49152
    buffer_load_dwordx2 v[216:217], v3, s[52:55], s62 offen offset:0
    buffer_load_dwordx2 v[218:219], v3, s[52:55], s62 offen offset:2048
    s_add_u32 s62, s61, 53248
    buffer_load_dwordx2 v[220:221], v3, s[52:55], s62 offen offset:0
    buffer_load_dwordx2 v[222:223], v3, s[52:55], s62 offen offset:2048
    s_add_u32 s62, s61, 2097152
    buffer_load_dwordx2 v[224:225], v3, s[52:55], s62 offen offset:0
    buffer_load_dwordx2 v[226:227], v3, s[52:55], s62 offen offset:2048
    s_add_u32 s62, s61, 2101248
    buffer_load_dwordx2 v[228:229], v3, s[52:55], s62 offen offset:0
    buffer_load_dwordx2 v[230:231], v3, s[52:55], s62 offen offset:2048
    s_add_u32 s62, s61, 2113536
    buffer_load_dwordx2 v[232:233], v3, s[52:55], s62 offen offset:0
    buffer_load_dwordx2 v[234:235], v3, s[52:55], s62 offen offset:2048
    s_add_u32 s62, s61, 2117632
    buffer_load_dwordx2 v[236:237], v3, s[52:55], s62 offen offset:0
    buffer_load_dwordx2 v[238:239], v3, s[52:55], s62 offen offset:2048
    s_add_u32 s62, s61, 2129920
    buffer_load_dwordx2 v[240:241], v3, s[52:55], s62 offen offset:0
    buffer_load_dwordx2 v[242:243], v3, s[52:55], s62 offen offset:2048
    s_add_u32 s62, s61, 2134016
    buffer_load_dwordx2 v[244:245], v3, s[52:55], s62 offen offset:0
    buffer_load_dwordx2 v[246:247], v3, s[52:55], s62 offen offset:2048
    s_add_u32 s62, s61, 2146304
    buffer_load_dwordx2 v[248:249], v3, s[52:55], s62 offen offset:0
    buffer_load_dwordx2 v[250:251], v3, s[52:55], s62 offen offset:2048
    s_add_u32 s62, s61, 2150400
    buffer_load_dwordx2 v[252:253], v3, s[52:55], s62 offen offset:0
    buffer_load_dwordx2 v[254:255], v3, s[52:55], s62 offen offset:2048
    s_mul_i32 s62, s4, 40960
    v_lshl_add_u32 v6, v0, 2, s62
    v_mul_u32_u24 v7, 272, v4
    v_lshl_add_u32 v7, v5, 4, v7
    v_add_u32 v7, s62, v7
    v_lshlrev_b32 v8, 5, v4
    v_lshl_add_u32 v8, v5, 4, v8
    v_add_u32 v8, s62, v8
    v_sub_u32 v2, 4, v5
    v_lshlrev_b32 v9, v2, v4
    v_add_u32 v9, s62, v9
    v_lshl_add_u32 v10, v4, 2, s62
    v_lshl_add_u32 v11, v0, 6, s62
    v_and_b32 v2, 3, v0
    v_mul_u32_u24 v12, 4160, v2
    v_lshrrev_b32 v2, 2, v4
    v_sub_u32 v2, 7, v2
    v_lshl_add_u32 v12, v2, 3, v12
    v_lshl_add_u32 v12, v5, 4, v12
    v_add_u32 v12, s62, v12
    v_mul_u32_u24 v14, 80, v4
    v_add_u32 v14, s62, v14
    v_lshl_add_u32 v13, v5, 4, v14
    v_add_u32 v13, 80, v13
    v_lshl_add_u32 v14, v5, 3, v14
    s_add_u32 s62, s62, 24320
    v_lshlrev_b32 v2, 5, v0
    v_sub_u32 v3, 2047, v2
    v_cvt_f32_i32 v76, v3
    v_cvt_pk_bf16_f32 v76, v76, v76
    v_and_b32 v76, 0xffff, v76
    v_subrev_u32 v76, 17024, v76
    v_cmp_gt_i32 vcc, 0x100, v3
    s_nop 1
    v_cndmask_b32 v76, v76, v3, vcc
    v_lshl_add_u32 v40, v76, 2, s62
    v_sub_u32 v3, 2046, v2
    v_cvt_f32_i32 v76, v3
    v_cvt_pk_bf16_f32 v76, v76, v76
    v_and_b32 v76, 0xffff, v76
    v_subrev_u32 v76, 17024, v76
    v_cmp_gt_i32 vcc, 0x100, v3
    s_nop 1
    v_cndmask_b32 v76, v76, v3, vcc
    v_lshl_add_u32 v41, v76, 2, s62
    v_sub_u32 v3, 2045, v2
    v_cvt_f32_i32 v76, v3
    v_cvt_pk_bf16_f32 v76, v76, v76
    v_and_b32 v76, 0xffff, v76
    v_subrev_u32 v76, 17024, v76
    v_cmp_gt_i32 vcc, 0x100, v3
    s_nop 1
    v_cndmask_b32 v76, v76, v3, vcc
    v_lshl_add_u32 v42, v76, 2, s62
    v_sub_u32 v3, 2044, v2
    v_cvt_f32_i32 v76, v3
    v_cvt_pk_bf16_f32 v76, v76, v76
    v_and_b32 v76, 0xffff, v76
    v_subrev_u32 v76, 17024, v76
    v_cmp_gt_i32 vcc, 0x100, v3
    s_nop 1
    v_cndmask_b32 v76, v76, v3, vcc
    v_lshl_add_u32 v43, v76, 2, s62
    v_sub_u32 v3, 2043, v2
    v_cvt_f32_i32 v76, v3
    v_cvt_pk_bf16_f32 v76, v76, v76
    v_and_b32 v76, 0xffff, v76
    v_subrev_u32 v76, 17024, v76
    v_cmp_gt_i32 vcc, 0x100, v3
    s_nop 1
    v_cndmask_b32 v76, v76, v3, vcc
    v_lshl_add_u32 v44, v76, 2, s62
    v_sub_u32 v3, 2042, v2
    v_cvt_f32_i32 v76, v3
    v_cvt_pk_bf16_f32 v76, v76, v76
    v_and_b32 v76, 0xffff, v76
    v_subrev_u32 v76, 17024, v76
    v_cmp_gt_i32 vcc, 0x100, v3
    s_nop 1
    v_cndmask_b32 v76, v76, v3, vcc
    v_lshl_add_u32 v45, v76, 2, s62
    v_sub_u32 v3, 2041, v2
    v_cvt_f32_i32 v76, v3
    v_cvt_pk_bf16_f32 v76, v76, v76
    v_and_b32 v76, 0xffff, v76
    v_subrev_u32 v76, 17024, v76
    v_cmp_gt_i32 vcc, 0x100, v3
    s_nop 1
    v_cndmask_b32 v76, v76, v3, vcc
    v_lshl_add_u32 v46, v76, 2, s62
    v_sub_u32 v3, 2040, v2
    v_cvt_f32_i32 v76, v3
    v_cvt_pk_bf16_f32 v76, v76, v76
    v_and_b32 v76, 0xffff, v76
    v_subrev_u32 v76, 17024, v76
    v_cmp_gt_i32 vcc, 0x100, v3
    s_nop 1
    v_cndmask_b32 v76, v76, v3, vcc
    v_lshl_add_u32 v47, v76, 2, s62
    v_sub_u32 v3, 2039, v2
    v_cvt_f32_i32 v76, v3
    v_cvt_pk_bf16_f32 v76, v76, v76
    v_and_b32 v76, 0xffff, v76
    v_subrev_u32 v76, 17024, v76
    v_cmp_gt_i32 vcc, 0x100, v3
    s_nop 1
    v_cndmask_b32 v76, v76, v3, vcc
    v_lshl_add_u32 v48, v76, 2, s62
    v_sub_u32 v3, 2038, v2
    v_cvt_f32_i32 v76, v3
    v_cvt_pk_bf16_f32 v76, v76, v76
    v_and_b32 v76, 0xffff, v76
    v_subrev_u32 v76, 17024, v76
    v_cmp_gt_i32 vcc, 0x100, v3
    s_nop 1
    v_cndmask_b32 v76, v76, v3, vcc
    v_lshl_add_u32 v49, v76, 2, s62
    v_sub_u32 v3, 2037, v2
    v_cvt_f32_i32 v76, v3
    v_cvt_pk_bf16_f32 v76, v76, v76
    v_and_b32 v76, 0xffff, v76
    v_subrev_u32 v76, 17024, v76
    v_cmp_gt_i32 vcc, 0x100, v3
    s_nop 1
    v_cndmask_b32 v76, v76, v3, vcc
    v_lshl_add_u32 v50, v76, 2, s62
    v_sub_u32 v3, 2036, v2
    v_cvt_f32_i32 v76, v3
    v_cvt_pk_bf16_f32 v76, v76, v76
    v_and_b32 v76, 0xffff, v76
    v_subrev_u32 v76, 17024, v76
    v_cmp_gt_i32 vcc, 0x100, v3
    s_nop 1
    v_cndmask_b32 v76, v76, v3, vcc
    v_lshl_add_u32 v51, v76, 2, s62
    v_sub_u32 v3, 2035, v2
    v_cvt_f32_i32 v76, v3
    v_cvt_pk_bf16_f32 v76, v76, v76
    v_and_b32 v76, 0xffff, v76
    v_subrev_u32 v76, 17024, v76
    v_cmp_gt_i32 vcc, 0x100, v3
    s_nop 1
    v_cndmask_b32 v76, v76, v3, vcc
    v_lshl_add_u32 v52, v76, 2, s62
    v_sub_u32 v3, 2034, v2
    v_cvt_f32_i32 v76, v3
    v_cvt_pk_bf16_f32 v76, v76, v76
    v_and_b32 v76, 0xffff, v76
    v_subrev_u32 v76, 17024, v76
    v_cmp_gt_i32 vcc, 0x100, v3
    s_nop 1
    v_cndmask_b32 v76, v76, v3, vcc
    v_lshl_add_u32 v53, v76, 2, s62
    v_sub_u32 v3, 2033, v2
    v_cvt_f32_i32 v76, v3
    v_cvt_pk_bf16_f32 v76, v76, v76
    v_and_b32 v76, 0xffff, v76
    v_subrev_u32 v76, 17024, v76
    v_cmp_gt_i32 vcc, 0x100, v3
    s_nop 1
    v_cndmask_b32 v76, v76, v3, vcc
    v_lshl_add_u32 v54, v76, 2, s62
    v_sub_u32 v3, 2032, v2
    v_cvt_f32_i32 v76, v3
    v_cvt_pk_bf16_f32 v76, v76, v76
    v_and_b32 v76, 0xffff, v76
    v_subrev_u32 v76, 17024, v76
    v_cmp_gt_i32 vcc, 0x100, v3
    s_nop 1
    v_cndmask_b32 v76, v76, v3, vcc
    v_lshl_add_u32 v55, v76, 2, s62
    v_sub_u32 v3, 2031, v2
    v_cvt_f32_i32 v76, v3
    v_cvt_pk_bf16_f32 v76, v76, v76
    v_and_b32 v76, 0xffff, v76
    v_subrev_u32 v76, 17024, v76
    v_cmp_gt_i32 vcc, 0x100, v3
    s_nop 1
    v_cndmask_b32 v76, v76, v3, vcc
    v_lshl_add_u32 v56, v76, 2, s62
    v_sub_u32 v3, 2030, v2
    v_cvt_f32_i32 v76, v3
    v_cvt_pk_bf16_f32 v76, v76, v76
    v_and_b32 v76, 0xffff, v76
    v_subrev_u32 v76, 17024, v76
    v_cmp_gt_i32 vcc, 0x100, v3
    s_nop 1
    v_cndmask_b32 v76, v76, v3, vcc
    v_lshl_add_u32 v57, v76, 2, s62
    v_sub_u32 v3, 2029, v2
    v_cvt_f32_i32 v76, v3
    v_cvt_pk_bf16_f32 v76, v76, v76
    v_and_b32 v76, 0xffff, v76
    v_subrev_u32 v76, 17024, v76
    v_cmp_gt_i32 vcc, 0x100, v3
    s_nop 1
    v_cndmask_b32 v76, v76, v3, vcc
    v_lshl_add_u32 v58, v76, 2, s62
    v_sub_u32 v3, 2028, v2
    v_cvt_f32_i32 v76, v3
    v_cvt_pk_bf16_f32 v76, v76, v76
    v_and_b32 v76, 0xffff, v76
    v_subrev_u32 v76, 17024, v76
    v_cmp_gt_i32 vcc, 0x100, v3
    s_nop 1
    v_cndmask_b32 v76, v76, v3, vcc
    v_lshl_add_u32 v59, v76, 2, s62
    v_sub_u32 v3, 2027, v2
    v_cvt_f32_i32 v76, v3
    v_cvt_pk_bf16_f32 v76, v76, v76
    v_and_b32 v76, 0xffff, v76
    v_subrev_u32 v76, 17024, v76
    v_cmp_gt_i32 vcc, 0x100, v3
    s_nop 1
    v_cndmask_b32 v76, v76, v3, vcc
    v_lshl_add_u32 v60, v76, 2, s62
    v_sub_u32 v3, 2026, v2
    v_cvt_f32_i32 v76, v3
    v_cvt_pk_bf16_f32 v76, v76, v76
    v_and_b32 v76, 0xffff, v76
    v_subrev_u32 v76, 17024, v76
    v_cmp_gt_i32 vcc, 0x100, v3
    s_nop 1
    v_cndmask_b32 v76, v76, v3, vcc
    v_lshl_add_u32 v61, v76, 2, s62
    v_sub_u32 v3, 2025, v2
    v_cvt_f32_i32 v76, v3
    v_cvt_pk_bf16_f32 v76, v76, v76
    v_and_b32 v76, 0xffff, v76
    v_subrev_u32 v76, 17024, v76
    v_cmp_gt_i32 vcc, 0x100, v3
    s_nop 1
    v_cndmask_b32 v76, v76, v3, vcc
    v_lshl_add_u32 v62, v76, 2, s62
    v_sub_u32 v3, 2024, v2
    v_cvt_f32_i32 v76, v3
    v_cvt_pk_bf16_f32 v76, v76, v76
    v_and_b32 v76, 0xffff, v76
    v_subrev_u32 v76, 17024, v76
    v_cmp_gt_i32 vcc, 0x100, v3
    s_nop 1
    v_cndmask_b32 v76, v76, v3, vcc
    v_lshl_add_u32 v63, v76, 2, s62
    v_sub_u32 v3, 2023, v2
    v_cvt_f32_i32 v76, v3
    v_cvt_pk_bf16_f32 v76, v76, v76
    v_and_b32 v76, 0xffff, v76
    v_subrev_u32 v76, 17024, v76
    v_cmp_gt_i32 vcc, 0x100, v3
    s_nop 1
    v_cndmask_b32 v76, v76, v3, vcc
    v_lshl_add_u32 v64, v76, 2, s62
    v_sub_u32 v3, 2022, v2
    v_cvt_f32_i32 v76, v3
    v_cvt_pk_bf16_f32 v76, v76, v76
    v_and_b32 v76, 0xffff, v76
    v_subrev_u32 v76, 17024, v76
    v_cmp_gt_i32 vcc, 0x100, v3
    s_nop 1
    v_cndmask_b32 v76, v76, v3, vcc
    v_lshl_add_u32 v65, v76, 2, s62
    v_sub_u32 v3, 2021, v2
    v_cvt_f32_i32 v76, v3
    v_cvt_pk_bf16_f32 v76, v76, v76
    v_and_b32 v76, 0xffff, v76
    v_subrev_u32 v76, 17024, v76
    v_cmp_gt_i32 vcc, 0x100, v3
    s_nop 1
    v_cndmask_b32 v76, v76, v3, vcc
    v_lshl_add_u32 v66, v76, 2, s62
    v_sub_u32 v3, 2020, v2
    v_cvt_f32_i32 v76, v3
    v_cvt_pk_bf16_f32 v76, v76, v76
    v_and_b32 v76, 0xffff, v76
    v_subrev_u32 v76, 17024, v76
    v_cmp_gt_i32 vcc, 0x100, v3
    s_nop 1
    v_cndmask_b32 v76, v76, v3, vcc
    v_lshl_add_u32 v67, v76, 2, s62
    v_sub_u32 v3, 2019, v2
    v_cvt_f32_i32 v76, v3
    v_cvt_pk_bf16_f32 v76, v76, v76
    v_and_b32 v76, 0xffff, v76
    v_subrev_u32 v76, 17024, v76
    v_cmp_gt_i32 vcc, 0x100, v3
    s_nop 1
    v_cndmask_b32 v76, v76, v3, vcc
    v_lshl_add_u32 v68, v76, 2, s62
    v_sub_u32 v3, 2018, v2
    v_cvt_f32_i32 v76, v3
    v_cvt_pk_bf16_f32 v76, v76, v76
    v_and_b32 v76, 0xffff, v76
    v_subrev_u32 v76, 17024, v76
    v_cmp_gt_i32 vcc, 0x100, v3
    s_nop 1
    v_cndmask_b32 v76, v76, v3, vcc
    v_lshl_add_u32 v69, v76, 2, s62
    v_sub_u32 v3, 2017, v2
    v_cvt_f32_i32 v76, v3
    v_cvt_pk_bf16_f32 v76, v76, v76
    v_and_b32 v76, 0xffff, v76
    v_subrev_u32 v76, 17024, v76
    v_cmp_gt_i32 vcc, 0x100, v3
    s_nop 1
    v_cndmask_b32 v76, v76, v3, vcc
    v_lshl_add_u32 v70, v76, 2, s62
    v_sub_u32 v3, 2016, v2
    v_cvt_f32_i32 v76, v3
    v_cvt_pk_bf16_f32 v76, v76, v76
    v_and_b32 v76, 0xffff, v76
    v_subrev_u32 v76, 17024, v76
    v_cmp_gt_i32 vcc, 0x100, v3
    s_nop 1
    v_cndmask_b32 v76, v76, v3, vcc
    v_lshl_add_u32 v71, v76, 2, s62
    v_sub_u32 v3, 2015, v2
    v_cvt_f32_i32 v76, v3
    v_cvt_pk_bf16_f32 v76, v76, v76
    v_and_b32 v76, 0xffff, v76
    v_subrev_u32 v76, 17024, v76
    v_cmp_gt_i32 vcc, 0x100, v3
    s_nop 1
    v_cndmask_b32 v76, v76, v3, vcc
    v_mov_b32 v77, 672
    v_cmp_gt_i32 vcc, 0, v3
    s_nop 1
    v_cndmask_b32 v76, v76, v77, vcc
    v_lshl_add_u32 v72, v76, 2, s62
    v_sub_u32 v3, 2014, v2
    v_cvt_f32_i32 v76, v3
    v_cvt_pk_bf16_f32 v76, v76, v76
    v_and_b32 v76, 0xffff, v76
    v_subrev_u32 v76, 17024, v76
    v_cmp_gt_i32 vcc, 0x100, v3
    s_nop 1
    v_cndmask_b32 v76, v76, v3, vcc
    v_mov_b32 v77, 672
    v_cmp_gt_i32 vcc, 0, v3
    s_nop 1
    v_cndmask_b32 v76, v76, v77, vcc
    v_lshl_add_u32 v73, v76, 2, s62
    v_sub_u32 v3, 2013, v2
    v_cvt_f32_i32 v76, v3
    v_cvt_pk_bf16_f32 v76, v76, v76
    v_and_b32 v76, 0xffff, v76
    v_subrev_u32 v76, 17024, v76
    v_cmp_gt_i32 vcc, 0x100, v3
    s_nop 1
    v_cndmask_b32 v76, v76, v3, vcc
    v_mov_b32 v77, 672
    v_cmp_gt_i32 vcc, 0, v3
    s_nop 1
    v_cndmask_b32 v76, v76, v77, vcc
    v_lshl_add_u32 v74, v76, 2, s62
    v_mov_b32 v2, 0
    ds_write_b32 v6, v2 offset:27008
    ds_write_b32 v6, v2 offset:16640
    ds_write_b32 v6, v2 offset:16896
    ds_write_b32 v6, v2 offset:17152
    ds_write_b32 v6, v2 offset:17408
    ds_write_b32 v6, v2 offset:17664
    ds_write_b32 v6, v2 offset:17920
    ds_write_b32 v6, v2 offset:18176
    ds_write_b32 v6, v2 offset:18432
    ds_write_b32 v6, v2 offset:18688
    ds_write_b32 v6, v2 offset:18944
    s_mov_b32 s63, 0
    s_waitcnt lgkmcnt(0) vmcnt(32)
Ls_chan:
    s_lshl_b32 s61, s64, 16
    v_mov_b32 v15, 0x3fb8aa3b
    v_mul_f32 v15, s61, v15
    v_exp_f32 v15, v15
    s_bitcmp1_b32 s63, 0
    s_mov_b32 s68, 0x01000c0c
    s_mov_b32 s69, 0x05040100
    s_mov_b32 s70, 0x03020504
    s_mov_b32 s71, 0x03020706
    s_cmov_b32 s68, 0x03020c0c
    s_cmov_b32 s69, 0x07060302
    s_cmov_b32 s70, 0x05040100
    s_cmov_b32 s71, 0x07060100
    v_cvt_pk_bf16_f32 v15, v15, v15
    v_lshlrev_b32 v15, 16, v15
    v_lshlrev_b32 v76, 16, v16
    v_lshlrev_b32 v77, 16, v17
    v_lshlrev_b32 v90, 16, v18
    v_lshlrev_b32 v91, 16, v19
    v_lshlrev_b32 v92, 16, v20
    v_lshlrev_b32 v93, 16, v21
    v_mul_f32 v76, v15, v76
    v_mul_f32 v77, v15, v77
    v_mul_f32 v90, v15, v90
    v_mul_f32 v91, v15, v91
    v_mul_f32 v76, 0x3fb8aa3b, v76
    v_mul_f32 v77, 0.15915494, v77
    v_pk_mul_f32 v[94:95], v[92:93], v[90:91] op_sel_hi:[1,0]
    v_pk_fma_f32 v[94:95], v[92:93], v[90:91], v[94:95] op_sel:[1,1,0] op_sel_hi:[0,1,1] neg_lo:[1,0,0]
    v_mul_f32 v2, 0x3f800000, v76
    v_mul_f32 v3, 0x3f800000, v77
    v_exp_f32 v2, v2
    v_fract_f32 v3, v3
    v_cos_f32 v80, v3
    v_sin_f32 v81, v3
    s_nop 0
    v_pk_mul_f32 v[80:81], v[80:81], v[2:3] op_sel_hi:[1,0]
    v_mul_f32 v2, 0x41000000, v76
    v_mul_f32 v3, 0x41000000, v77
    v_exp_f32 v2, v2
    v_fract_f32 v3, v3
    v_cos_f32 v82, v3
    v_sin_f32 v83, v3
    s_nop 0
    v_pk_mul_f32 v[82:83], v[82:83], v[2:3] op_sel_hi:[1,0]
    v_mul_f32 v2, 0x43800000, v76
    v_mul_f32 v3, 0x43800000, v77
    v_exp_f32 v2, v2
    v_fract_f32 v3, v3
    v_cos_f32 v84, v3
    v_sin_f32 v85, v3
    s_nop 0
    v_pk_mul_f32 v[84:85], v[84:85], v[2:3] op_sel_hi:[1,0]
    v_mov_b32 v117, 0x3f80
    ds_write_b32 v6, v117 offset:5712
    v_cvt_pk_bf16_f32 v114, v82, v83
    ds_write_b32 v6, v114 offset:5984
    v_pk_mul_f32 v[110:111], v[82:83], v[82:83] op_sel_hi:[1,0]
    v_pk_fma_f32 v[110:111], v[82:83], v[82:83], v[110:111] op_sel:[1,1,0] op_sel_hi:[0,1,1] neg_lo:[1,0,0]
    v_cvt_pk_bf16_f32 v115, v110, v111
    ds_write_b32 v6, v115 offset:6256
    v_pk_mul_f32 v[112:113], v[110:111], v[82:83] op_sel_hi:[1,0]
    v_pk_fma_f32 v[112:113], v[110:111], v[82:83], v[112:113] op_sel:[1,1,0] op_sel_hi:[0,1,1] neg_lo:[1,0,0]
    v_cvt_pk_bf16_f32 v116, v112, v113
    ds_write_b32 v6, v116 offset:6528
    v_pk_mul_f32 v[110:111], v[112:113], v[82:83] op_sel_hi:[1,0]
    v_pk_fma_f32 v[110:111], v[112:113], v[82:83], v[110:111] op_sel:[1,1,0] op_sel_hi:[0,1,1] neg_lo:[1,0,0]
    v_cvt_pk_bf16_f32 v117, v110, v111
    ds_write_b32 v6, v117 offset:6800
    v_pk_mul_f32 v[112:113], v[110:111], v[82:83] op_sel_hi:[1,0]
    v_pk_fma_f32 v[112:113], v[110:111], v[82:83], v[112:113] op_sel:[1,1,0] op_sel_hi:[0,1,1] neg_lo:[1,0,0]
    v_cvt_pk_bf16_f32 v114, v112, v113
    ds_write_b32 v6, v114 offset:7072
    v_pk_mul_f32 v[110:111], v[112:113], v[82:83] op_sel_hi:[1,0]
    v_pk_fma_f32 v[110:111], v[112:113], v[82:83], v[110:111] op_sel:[1,1,0] op_sel_hi:[0,1,1] neg_lo:[1,0,0]
    v_cvt_pk_bf16_f32 v115, v110, v111
    ds_write_b32 v6, v115 offset:7344
    v_pk_mul_f32 v[112:113], v[110:111], v[82:83] op_sel_hi:[1,0]
    v_pk_fma_f32 v[112:113], v[110:111], v[82:83], v[112:113] op_sel:[1,1,0] op_sel_hi:[0,1,1] neg_lo:[1,0,0]
    v_cvt_pk_bf16_f32 v116, v112, v113
    ds_write_b32 v6, v116 offset:7616
    v_pk_mul_f32 v[110:111], v[112:113], v[82:83] op_sel_hi:[1,0]
    v_pk_fma_f32 v[110:111], v[112:113], v[82:83], v[110:111] op_sel:[1,1,0] op_sel_hi:[0,1,1] neg_lo:[1,0,0]
    v_cvt_pk_bf16_f32 v117, v110, v111
    ds_write_b32 v6, v117 offset:7888
    v_pk_mul_f32 v[112:113], v[110:111], v[82:83] op_sel_hi:[1,0]
    v_pk_fma_f32 v[112:113], v[110:111], v[82:83], v[112:113] op_sel:[1,1,0] op_sel_hi:[0,1,1] neg_lo:[1,0,0]
    v_cvt_pk_bf16_f32 v114, v112, v113
    ds_write_b32 v6, v114 offset:8160
    v_pk_mul_f32 v[110:111], v[112:113], v[82:83] op_sel_hi:[1,0]
    v_pk_fma_f32 v[110:111], v[112:113], v[82:83], v[110:111] op_sel:[1,1,0] op_sel_hi:[0,1,1] neg_lo:[1,0,0]
    v_cvt_pk_bf16_f32 v115, v110, v111
    ds_write_b32 v6, v115 offset:8432
    v_pk_mul_f32 v[112:113], v[110:111], v[82:83] op_sel_hi:[1,0]
    v_pk_fma_f32 v[112:113], v[110:111], v[82:83], v[112:113] op_sel:[1,1,0] op_sel_hi:[0,1,1] neg_lo:[1,0,0]
    v_cvt_pk_bf16_f32 v116, v112, v113
    ds_write_b32 v6, v116 offset:8704
    v_pk_mul_f32 v[110:111], v[112:113], v[82:83] op_sel_hi:[1,0]
    v_pk_fma_f32 v[110:111], v[112:113], v[82:83], v[110:111] op_sel:[1,1,0] op_sel_hi:[0,1,1] neg_lo:[1,0,0]
    v_cvt_pk_bf16_f32 v117, v110, v111
    ds_write_b32 v6, v117 offset:8976
    v_pk_mul_f32 v[112:113], v[110:111], v[82:83] op_sel_hi:[1,0]
    v_pk_fma_f32 v[112:113], v[110:111], v[82:83], v[112:113] op_sel:[1,1,0] op_sel_hi:[0,1,1] neg_lo:[1,0,0]
    v_cvt_pk_bf16_f32 v114, v112, v113
    ds_write_b32 v6, v114 offset:9248
    v_pk_mul_f32 v[110:111], v[112:113], v[82:83] op_sel_hi:[1,0]
    v_pk_fma_f32 v[110:111], v[112:113], v[82:83], v[110:111] op_sel:[1,1,0] op_sel_hi:[0,1,1] neg_lo:[1,0,0]
    v_cvt_pk_bf16_f32 v115, v110, v111
    ds_write_b32 v6, v115 offset:9520
    v_pk_mul_f32 v[112:113], v[110:111], v[82:83] op_sel_hi:[1,0]
    v_pk_fma_f32 v[112:113], v[110:111], v[82:83], v[112:113] op_sel:[1,1,0] op_sel_hi:[0,1,1] neg_lo:[1,0,0]
    v_cvt_pk_bf16_f32 v116, v112, v113
    ds_write_b32 v6, v116 offset:9792
    v_pk_mul_f32 v[110:111], v[112:113], v[82:83] op_sel_hi:[1,0]
    v_pk_fma_f32 v[110:111], v[112:113], v[82:83], v[110:111] op_sel:[1,1,0] op_sel_hi:[0,1,1] neg_lo:[1,0,0]
    v_cvt_pk_bf16_f32 v117, v110, v111
    ds_write_b32 v6, v117 offset:10064
    v_pk_mul_f32 v[112:113], v[110:111], v[82:83] op_sel_hi:[1,0]
    v_pk_fma_f32 v[112:113], v[110:111], v[82:83], v[112:113] op_sel:[1,1,0] op_sel_hi:[0,1,1] neg_lo:[1,0,0]
    v_cvt_pk_bf16_f32 v114, v112, v113
    ds_write_b32 v6, v114 offset:10336
    v_pk_mul_f32 v[110:111], v[112:113], v[82:83] op_sel_hi:[1,0]
    v_pk_fma_f32 v[110:111], v[112:113], v[82:83], v[110:111] op_sel:[1,1,0] op_sel_hi:[0,1,1] neg_lo:[1,0,0]
    v_cvt_pk_bf16_f32 v115, v110, v111
    ds_write_b32 v6, v115 offset:10608
    v_pk_mul_f32 v[112:113], v[110:111], v[82:83] op_sel_hi:[1,0]
    v_pk_fma_f32 v[112:113], v[110:111], v[82:83], v[112:113] op_sel:[1,1,0] op_sel_hi:[0,1,1] neg_lo:[1,0,0]
    v_cvt_pk_bf16_f32 v116, v112, v113
    ds_write_b32 v6, v116 offset:10880
    v_pk_mul_f32 v[110:111], v[112:113], v[82:83] op_sel_hi:[1,0]
    v_pk_fma_f32 v[110:111], v[112:113], v[82:83], v[110:111] op_sel:[1,1,0] op_sel_hi:[0,1,1] neg_lo:[1,0,0]
    v_cvt_pk_bf16_f32 v117, v110, v111
    ds_write_b32 v6, v117 offset:11152
    v_pk_mul_f32 v[112:113], v[110:111], v[82:83] op_sel_hi:[1,0]
    v_pk_fma_f32 v[112:113], v[110:111], v[82:83], v[112:113] op_sel:[1,1,0] op_sel_hi:[0,1,1] neg_lo:[1,0,0]
    v_cvt_pk_bf16_f32 v114, v112, v113
    ds_write_b32 v6, v114 offset:11424
    v_pk_mul_f32 v[110:111], v[112:113], v[82:83] op_sel_hi:[1,0]
    v_pk_fma_f32 v[110:111], v[112:113], v[82:83], v[110:111] op_sel:[1,1,0] op_sel_hi:[0,1,1] neg_lo:[1,0,0]
    v_cvt_pk_bf16_f32 v115, v110, v111
    ds_write_b32 v6, v115 offset:11696
    v_pk_mul_f32 v[112:113], v[110:111], v[82:83] op_sel_hi:[1,0]
    v_pk_fma_f32 v[112:113], v[110:111], v[82:83], v[112:113] op_sel:[1,1,0] op_sel_hi:[0,1,1] neg_lo:[1,0,0]
    v_cvt_pk_bf16_f32 v116, v112, v113
    ds_write_b32 v6, v116 offset:11968
    v_pk_mul_f32 v[110:111], v[112:113], v[82:83] op_sel_hi:[1,0]
    v_pk_fma_f32 v[110:111], v[112:113], v[82:83], v[110:111] op_sel:[1,1,0] op_sel_hi:[0,1,1] neg_lo:[1,0,0]
    v_cvt_pk_bf16_f32 v117, v110, v111
    ds_write_b32 v6, v117 offset:12240
    v_pk_mul_f32 v[112:113], v[110:111], v[82:83] op_sel_hi:[1,0]
    v_pk_fma_f32 v[112:113], v[110:111], v[82:83], v[112:113] op_sel:[1,1,0] op_sel_hi:[0,1,1] neg_lo:[1,0,0]
    v_cvt_pk_bf16_f32 v114, v112, v113
    ds_write_b32 v6, v114 offset:12512
    v_pk_mul_f32 v[110:111], v[112:113], v[82:83] op_sel_hi:[1,0]
    v_pk_fma_f32 v[110:111], v[112:113], v[82:83], v[110:111] op_sel:[1,1,0] op_sel_hi:[0,1,1] neg_lo:[1,0,0]
    v_cvt_pk_bf16_f32 v115, v110, v111
    ds_write_b32 v6, v115 offset:12784
    v_pk_mul_f32 v[112:113], v[110:111], v[82:83] op_sel_hi:[1,0]
    v_pk_fma_f32 v[112:113], v[110:111], v[82:83], v[112:113] op_sel:[1,1,0] op_sel_hi:[0,1,1] neg_lo:[1,0,0]
    v_cvt_pk_bf16_f32 v116, v112, v113
    ds_write_b32 v6, v116 offset:13056
    v_pk_mul_f32 v[110:111], v[112:113], v[82:83] op_sel_hi:[1,0]
    v_pk_fma_f32 v[110:111], v[112:113], v[82:83], v[110:111] op_sel:[1,1,0] op_sel_hi:[0,1,1] neg_lo:[1,0,0]
    v_cvt_pk_bf16_f32 v117, v110, v111
    ds_write_b32 v6, v117 offset:13328
    v_pk_mul_f32 v[112:113], v[110:111], v[82:83] op_sel_hi:[1,0]
    v_pk_fma_f32 v[112:113], v[110:111], v[82:83], v[112:113] op_sel:[1,1,0] op_sel_hi:[0,1,1] neg_lo:[1,0,0]
    v_cvt_pk_bf16_f32 v114, v112, v113
    ds_write_b32 v6, v114 offset:13600
    v_pk_mul_f32 v[110:111], v[112:113], v[82:83] op_sel_hi:[1,0]
    v_pk_fma_f32 v[110:111], v[112:113], v[82:83], v[110:111] op_sel:[1,1,0] op_sel_hi:[0,1,1] neg_lo:[1,0,0]
    v_cvt_pk_bf16_f32 v115, v110, v111
    ds_write_b32 v6, v115 offset:13872
    v_pk_mul_f32 v[112:113], v[110:111], v[82:83] op_sel_hi:[1,0]
    v_pk_fma_f32 v[112:113], v[110:111], v[82:83], v[112:113] op_sel:[1,1,0] op_sel_hi:[0,1,1] neg_lo:[1,0,0]
    v_cvt_pk_bf16_f32 v116, v112, v113
    ds_write_b32 v6, v116 offset:14144
    v_cvt_pk_bf16_f32 v117, v94, -v95
    ds_write_b32 v6, v117 offset:0
    v_pk_mul_f32 v[96:97], v[94:95], v[80:81] op_sel_hi:[1,0]
    v_pk_fma_f32 v[96:97], v[94:95], v[80:81], v[96:97] op_sel:[1,1,0] op_sel_hi:[0,1,1] neg_lo:[1,0,0]
    v_cvt_pk_bf16_f32 v114, v96, -v97
    ds_write_b32 v6, v114 offset:272
    v_pk_mul_f32 v[98:99], v[96:97], v[80:81] op_sel_hi:[1,0]
    v_pk_fma_f32 v[98:99], v[96:97], v[80:81], v[98:99] op_sel:[1,1,0] op_sel_hi:[0,1,1] neg_lo:[1,0,0]
    v_cvt_pk_bf16_f32 v115, v98, -v99
    ds_write_b32 v6, v115 offset:544
    v_pk_mul_f32 v[100:101], v[98:99], v[80:81] op_sel_hi:[1,0]
    v_pk_fma_f32 v[100:101], v[98:99], v[80:81], v[100:101] op_sel:[1,1,0] op_sel_hi:[0,1,1] neg_lo:[1,0,0]
    v_cvt_pk_bf16_f32 v116, v100, -v101
    ds_write_b32 v6, v116 offset:816
    v_pk_mul_f32 v[102:103], v[100:101], v[80:81] op_sel_hi:[1,0]
    v_pk_fma_f32 v[102:103], v[100:101], v[80:81], v[102:103] op_sel:[1,1,0] op_sel_hi:[0,1,1] neg_lo:[1,0,0]
    v_cvt_pk_bf16_f32 v117, v102, -v103
    ds_write_b32 v6, v117 offset:1088
    v_pk_mul_f32 v[104:105], v[102:103], v[80:81] op_sel_hi:[1,0]
    v_pk_fma_f32 v[104:105], v[102:103], v[80:81], v[104:105] op_sel:[1,1,0] op_sel_hi:[0,1,1] neg_lo:[1,0,0]
    v_cvt_pk_bf16_f32 v114, v104, -v105
    ds_write_b32 v6, v114 offset:1360
    v_pk_mul_f32 v[106:107], v[104:105], v[80:81] op_sel_hi:[1,0]
    v_pk_fma_f32 v[106:107], v[104:105], v[80:81], v[106:107] op_sel:[1,1,0] op_sel_hi:[0,1,1] neg_lo:[1,0,0]
    v_cvt_pk_bf16_f32 v115, v106, -v107
    ds_write_b32 v6, v115 offset:1632
    v_pk_mul_f32 v[108:109], v[106:107], v[80:81] op_sel_hi:[1,0]
    v_pk_fma_f32 v[108:109], v[106:107], v[80:81], v[108:109] op_sel:[1,1,0] op_sel_hi:[0,1,1] neg_lo:[1,0,0]
    v_cvt_pk_bf16_f32 v116, v108, -v109
    ds_write_b32 v6, v116 offset:1904
    v_pk_mul_f32 v[110:111], v[94:95], v[84:85] op_sel_hi:[1,0]
    v_pk_fma_f32 v[110:111], v[94:95], v[84:85], v[110:111] op_sel:[1,1,0] op_sel_hi:[0,1,1] neg_lo:[1,0,0]
    v_cvt_pk_bf16_f32 v117, v110, -v111
    ds_write_b32 v6, v117 offset:2176
    v_pk_mul_f32 v[112:113], v[98:99], v[84:85] op_sel_hi:[1,0]
    v_pk_fma_f32 v[112:113], v[98:99], v[84:85], v[112:113] op_sel:[1,1,0] op_sel_hi:[0,1,1] neg_lo:[1,0,0]
    v_cvt_pk_bf16_f32 v114, v112, -v113
    ds_write_b32 v6, v114 offset:2448
    v_pk_mul_f32 v[110:111], v[102:103], v[84:85] op_sel_hi:[1,0]
    v_pk_fma_f32 v[110:111], v[102:103], v[84:85], v[110:111] op_sel:[1,1,0] op_sel_hi:[0,1,1] neg_lo:[1,0,0]
    v_cvt_pk_bf16_f32 v115, v110, -v111
    ds_write_b32 v6, v115 offset:2720
    v_pk_mul_f32 v[112:113], v[106:107], v[84:85] op_sel_hi:[1,0]
    v_pk_fma_f32 v[112:113], v[106:107], v[84:85], v[112:113] op_sel:[1,1,0] op_sel_hi:[0,1,1] neg_lo:[1,0,0]
    v_cvt_pk_bf16_f32 v116, v112, -v113
    ds_write_b32 v6, v116 offset:2992
    v_pk_mul_f32 v[86:87], v[84:85], v[84:85] op_sel_hi:[1,0]
    v_pk_fma_f32 v[86:87], v[84:85], v[84:85], v[86:87] op_sel:[1,1,0] op_sel_hi:[0,1,1] neg_lo:[1,0,0]
    v_pk_mul_f32 v[110:111], v[94:95], v[86:87] op_sel_hi:[1,0]
    v_pk_fma_f32 v[110:111], v[94:95], v[86:87], v[110:111] op_sel:[1,1,0] op_sel_hi:[0,1,1] neg_lo:[1,0,0]
    v_cvt_pk_bf16_f32 v117, v110, -v111
    ds_write_b32 v6, v117 offset:3264
    v_pk_mul_f32 v[112:113], v[102:103], v[86:87] op_sel_hi:[1,0]
    v_pk_fma_f32 v[112:113], v[102:103], v[86:87], v[112:113] op_sel:[1,1,0] op_sel_hi:[0,1,1] neg_lo:[1,0,0]
    v_cvt_pk_bf16_f32 v114, v112, -v113
    ds_write_b32 v6, v114 offset:3536
    v_pk_mul_f32 v[88:89], v[86:87], v[84:85] op_sel_hi:[1,0]
    v_pk_fma_f32 v[88:89], v[86:87], v[84:85], v[88:89] op_sel:[1,1,0] op_sel_hi:[0,1,1] neg_lo:[1,0,0]
    v_pk_mul_f32 v[110:111], v[94:95], v[88:89] op_sel_hi:[1,0]
    v_pk_fma_f32 v[110:111], v[94:95], v[88:89], v[110:111] op_sel:[1,1,0] op_sel_hi:[0,1,1] neg_lo:[1,0,0]
    v_cvt_pk_bf16_f32 v115, v110, -v111
    ds_write_b32 v6, v115 offset:3808
    v_pk_mul_f32 v[112:113], v[102:103], v[88:89] op_sel_hi:[1,0]
    v_pk_fma_f32 v[112:113], v[102:103], v[88:89], v[112:113] op_sel:[1,1,0] op_sel_hi:[0,1,1] neg_lo:[1,0,0]
    v_cvt_pk_bf16_f32 v116, v112, -v113
    ds_write_b32 v6, v116 offset:4080
    v_pk_mul_f32 v[86:87], v[88:89], v[84:85] op_sel_hi:[1,0]
    v_pk_fma_f32 v[86:87], v[88:89], v[84:85], v[86:87] op_sel:[1,1,0] op_sel_hi:[0,1,1] neg_lo:[1,0,0]
    v_pk_mul_f32 v[110:111], v[94:95], v[86:87] op_sel_hi:[1,0]
    v_pk_fma_f32 v[110:111], v[94:95], v[86:87], v[110:111] op_sel:[1,1,0] op_sel_hi:[0,1,1] neg_lo:[1,0,0]
    v_cvt_pk_bf16_f32 v117, v110, -v111
    ds_write_b32 v6, v117 offset:4352
    v_pk_mul_f32 v[88:89], v[86:87], v[84:85] op_sel_hi:[1,0]
    v_pk_fma_f32 v[88:89], v[86:87], v[84:85], v[88:89] op_sel:[1,1,0] op_sel_hi:[0,1,1] neg_lo:[1,0,0]
    v_pk_mul_f32 v[110:111], v[94:95], v[88:89] op_sel_hi:[1,0]
    v_pk_fma_f32 v[110:111], v[94:95], v[88:89], v[110:111] op_sel:[1,1,0] op_sel_hi:[0,1,1] neg_lo:[1,0,0]
    v_cvt_pk_bf16_f32 v114, v110, -v111
    ds_write_b32 v6, v114 offset:4624
    v_pk_mul_f32 v[86:87], v[88:89], v[84:85] op_sel_hi:[1,0]
    v_pk_fma_f32 v[86:87], v[88:89], v[84:85], v[86:87] op_sel:[1,1,0] op_sel_hi:[0,1,1] neg_lo:[1,0,0]
    v_pk_mul_f32 v[110:111], v[94:95], v[86:87] op_sel_hi:[1,0]
    v_pk_fma_f32 v[110:111], v[94:95], v[86:87], v[110:111] op_sel:[1,1,0] op_sel_hi:[0,1,1] neg_lo:[1,0,0]
    v_cvt_pk_bf16_f32 v115, v110, -v111
    ds_write_b32 v6, v115 offset:4896
    v_pk_mul_f32 v[88:89], v[86:87], v[84:85] op_sel_hi:[1,0]
    v_pk_fma_f32 v[88:89], v[86:87], v[84:85], v[88:89] op_sel:[1,1,0] op_sel_hi:[0,1,1] neg_lo:[1,0,0]
    v_pk_mul_f32 v[110:111], v[94:95], v[88:89] op_sel_hi:[1,0]
    v_pk_fma_f32 v[110:111], v[94:95], v[88:89], v[110:111] op_sel:[1,1,0] op_sel_hi:[0,1,1] neg_lo:[1,0,0]
    v_cvt_pk_bf16_f32 v116, v110, -v111
    ds_write_b32 v6, v116 offset:5168
    v_pk_mul_f32 v[86:87], v[88:89], v[84:85] op_sel_hi:[1,0]
    v_pk_fma_f32 v[86:87], v[88:89], v[84:85], v[86:87] op_sel:[1,1,0] op_sel_hi:[0,1,1] neg_lo:[1,0,0]
    v_pk_mul_f32 v[110:111], v[94:95], v[86:87] op_sel_hi:[1,0]
    v_pk_fma_f32 v[110:111], v[94:95], v[86:87], v[110:111] op_sel:[1,1,0] op_sel_hi:[0,1,1] neg_lo:[1,0,0]
    v_cvt_pk_bf16_f32 v117, v110, -v111
    ds_write_b32 v6, v117 offset:5440
    s_waitcnt lgkmcnt(0)
    ds_read_b128 v[176:179], v7 offset:0
    ds_read_b128 v[160:163], v7 offset:5712
    ds_read_b128 v[180:183], v7 offset:32
    ds_read_b128 v[164:167], v7 offset:5744
    ds_read_b128 v[184:187], v7 offset:64
    ds_read_b128 v[168:171], v7 offset:5776
    ds_read_b128 v[188:191], v7 offset:96
    ds_read_b128 v[172:175], v7 offset:5808
    s_waitcnt lgkmcnt(6)
    v_mfma_f32_32x32x16_bf16 v[128:143], v[176:179], v[160:163], 0
    s_waitcnt lgkmcnt(4)
    v_mfma_f32_32x32x16_bf16 v[128:143], v[180:183], v[164:167], v[128:143]
    s_waitcnt lgkmcnt(2)
    v_mfma_f32_32x32x16_bf16 v[128:143], v[184:187], v[168:171], v[128:143]
    s_waitcnt lgkmcnt(0)
    v_mfma_f32_32x32x16_bf16 v[128:143], v[188:191], v[172:175], v[128:143]
    ds_read_b128 v[176:179], v7 offset:128
    ds_read_b128 v[160:163], v7 offset:5840
    ds_read_b128 v[180:183], v7 offset:160
    ds_read_b128 v[164:167], v7 offset:5872
    ds_read_b128 v[184:187], v7 offset:192
    ds_read_b128 v[168:171], v7 offset:5904
    ds_read_b128 v[188:191], v7 offset:224
    ds_read_b128 v[172:175], v7 offset:5936
    s_waitcnt lgkmcnt(6)
    v_mfma_f32_32x32x16_bf16 v[128:143], v[176:179], v[160:163], v[128:143]
    s_waitcnt lgkmcnt(4)
    v_mfma_f32_32x32x16_bf16 v[128:143], v[180:183], v[164:167], v[128:143]
    s_waitcnt lgkmcnt(2)
    v_mfma_f32_32x32x16_bf16 v[128:143], v[184:187], v[168:171], v[128:143]
    s_waitcnt lgkmcnt(0)
    v_mfma_f32_32x32x16_bf16 v[128:143], v[188:191], v[172:175], v[128:143]
    v_and_b32 v76, 0xffff0000, v16
    v_and_b32 v77, 0xffff0000, v17
    v_and_b32 v90, 0xffff0000, v18
    v_and_b32 v91, 0xffff0000, v19
    v_and_b32 v92, 0xffff0000, v20
    v_and_b32 v93, 0xffff0000, v21
    v_mul_f32 v76, v15, v76
    v_mul_f32 v77, v15, v77
    v_mul_f32 v90, v15, v90
    v_mul_f32 v91, v15, v91
    v_mul_f32 v76, 0x3fb8aa3b, v76
    v_mul_f32 v77, 0.15915494, v77
    v_pk_mul_f32 v[94:95], v[92:93], v[90:91] op_sel_hi:[1,0]
    v_pk_fma_f32 v[94:95], v[92:93], v[90:91], v[94:95] op_sel:[1,1,0] op_sel_hi:[0,1,1] neg_lo:[1,0,0]
    v_mul_f32 v2, 0x3f800000, v76
    v_mul_f32 v3, 0x3f800000, v77
    v_exp_f32 v2, v2
    v_fract_f32 v3, v3
    v_cos_f32 v80, v3
    v_sin_f32 v81, v3
    s_nop 0
    v_pk_mul_f32 v[80:81], v[80:81], v[2:3] op_sel_hi:[1,0]
    v_mul_f32 v2, 0x41000000, v76
    v_mul_f32 v3, 0x41000000, v77
    v_exp_f32 v2, v2
    v_fract_f32 v3, v3
    v_cos_f32 v82, v3
    v_sin_f32 v83, v3
    s_nop 0
    v_pk_mul_f32 v[82:83], v[82:83], v[2:3] op_sel_hi:[1,0]
    v_mul_f32 v2, 0x43800000, v76
    v_mul_f32 v3, 0x43800000, v77
    v_exp_f32 v2, v2
    v_fract_f32 v3, v3
    v_cos_f32 v84, v3
    v_sin_f32 v85, v3
    s_nop 0
    v_pk_mul_f32 v[84:85], v[84:85], v[2:3] op_sel_hi:[1,0]
    v_mov_b32 v117, 0x3f80
    ds_write_b32 v6, v117 offset:5712
    v_cvt_pk_bf16_f32 v114, v82, v83
    ds_write_b32 v6, v114 offset:5984
    v_pk_mul_f32 v[110:111], v[82:83], v[82:83] op_sel_hi:[1,0]
    v_pk_fma_f32 v[110:111], v[82:83], v[82:83], v[110:111] op_sel:[1,1,0] op_sel_hi:[0,1,1] neg_lo:[1,0,0]
    v_cvt_pk_bf16_f32 v115, v110, v111
    ds_write_b32 v6, v115 offset:6256
    v_pk_mul_f32 v[112:113], v[110:111], v[82:83] op_sel_hi:[1,0]
    v_pk_fma_f32 v[112:113], v[110:111], v[82:83], v[112:113] op_sel:[1,1,0] op_sel_hi:[0,1,1] neg_lo:[1,0,0]
    v_cvt_pk_bf16_f32 v116, v112, v113
    ds_write_b32 v6, v116 offset:6528
    v_pk_mul_f32 v[110:111], v[112:113], v[82:83] op_sel_hi:[1,0]
    v_pk_fma_f32 v[110:111], v[112:113], v[82:83], v[110:111] op_sel:[1,1,0] op_sel_hi:[0,1,1] neg_lo:[1,0,0]
    v_cvt_pk_bf16_f32 v117, v110, v111
    ds_write_b32 v6, v117 offset:6800
    v_pk_mul_f32 v[112:113], v[110:111], v[82:83] op_sel_hi:[1,0]
    v_pk_fma_f32 v[112:113], v[110:111], v[82:83], v[112:113] op_sel:[1,1,0] op_sel_hi:[0,1,1] neg_lo:[1,0,0]
    v_cvt_pk_bf16_f32 v114, v112, v113
    ds_write_b32 v6, v114 offset:7072
    v_pk_mul_f32 v[110:111], v[112:113], v[82:83] op_sel_hi:[1,0]
    v_pk_fma_f32 v[110:111], v[112:113], v[82:83], v[110:111] op_sel:[1,1,0] op_sel_hi:[0,1,1] neg_lo:[1,0,0]
    v_cvt_pk_bf16_f32 v115, v110, v111
    ds_write_b32 v6, v115 offset:7344
    v_pk_mul_f32 v[112:113], v[110:111], v[82:83] op_sel_hi:[1,0]
    v_pk_fma_f32 v[112:113], v[110:111], v[82:83], v[112:113] op_sel:[1,1,0] op_sel_hi:[0,1,1] neg_lo:[1,0,0]
    v_cvt_pk_bf16_f32 v116, v112, v113
    ds_write_b32 v6, v116 offset:7616
    v_pk_mul_f32 v[110:111], v[112:113], v[82:83] op_sel_hi:[1,0]
    v_pk_fma_f32 v[110:111], v[112:113], v[82:83], v[110:111] op_sel:[1,1,0] op_sel_hi:[0,1,1] neg_lo:[1,0,0]
    v_cvt_pk_bf16_f32 v117, v110, v111
    ds_write_b32 v6, v117 offset:7888
    v_pk_mul_f32 v[112:113], v[110:111], v[82:83] op_sel_hi:[1,0]
    v_pk_fma_f32 v[112:113], v[110:111], v[82:83], v[112:113] op_sel:[1,1,0] op_sel_hi:[0,1,1] neg_lo:[1,0,0]
    v_cvt_pk_bf16_f32 v114, v112, v113
    ds_write_b32 v6, v114 offset:8160
    v_pk_mul_f32 v[110:111], v[112:113], v[82:83] op_sel_hi:[1,0]
    v_pk_fma_f32 v[110:111], v[112:113], v[82:83], v[110:111] op_sel:[1,1,0] op_sel_hi:[0,1,1] neg_lo:[1,0,0]
    v_cvt_pk_bf16_f32 v115, v110, v111
    ds_write_b32 v6, v115 offset:8432
    v_pk_mul_f32 v[112:113], v[110:111], v[82:83] op_sel_hi:[1,0]
    v_pk_fma_f32 v[112:113], v[110:111], v[82:83], v[112:113] op_sel:[1,1,0] op_sel_hi:[0,1,1] neg_lo:[1,0,0]
    v_cvt_pk_bf16_f32 v116, v112, v113
    ds_write_b32 v6, v116 offset:8704
    v_pk_mul_f32 v[110:111], v[112:113], v[82:83] op_sel_hi:[1,0]
    v_pk_fma_f32 v[110:111], v[112:113], v[82:83], v[110:111] op_sel:[1,1,0] op_sel_hi:[0,1,1] neg_lo:[1,0,0]
    v_cvt_pk_bf16_f32 v117, v110, v111
    ds_write_b32 v6, v117 offset:8976
    v_pk_mul_f32 v[112:113], v[110:111], v[82:83] op_sel_hi:[1,0]
    v_pk_fma_f32 v[112:113], v[110:111], v[82:83], v[112:113] op_sel:[1,1,0] op_sel_hi:[0,1,1] neg_lo:[1,0,0]
    v_cvt_pk_bf16_f32 v114, v112, v113
    ds_write_b32 v6, v114 offset:9248
    v_pk_mul_f32 v[110:111], v[112:113], v[82:83] op_sel_hi:[1,0]
    v_pk_fma_f32 v[110:111], v[112:113], v[82:83], v[110:111] op_sel:[1,1,0] op_sel_hi:[0,1,1] neg_lo:[1,0,0]
    v_cvt_pk_bf16_f32 v115, v110, v111
    ds_write_b32 v6, v115 offset:9520
    v_pk_mul_f32 v[112:113], v[110:111], v[82:83] op_sel_hi:[1,0]
    v_pk_fma_f32 v[112:113], v[110:111], v[82:83], v[112:113] op_sel:[1,1,0] op_sel_hi:[0,1,1] neg_lo:[1,0,0]
    v_cvt_pk_bf16_f32 v116, v112, v113
    ds_write_b32 v6, v116 offset:9792
    v_pk_mul_f32 v[110:111], v[112:113], v[82:83] op_sel_hi:[1,0]
    v_pk_fma_f32 v[110:111], v[112:113], v[82:83], v[110:111] op_sel:[1,1,0] op_sel_hi:[0,1,1] neg_lo:[1,0,0]
    v_cvt_pk_bf16_f32 v117, v110, v111
    ds_write_b32 v6, v117 offset:10064
    v_pk_mul_f32 v[112:113], v[110:111], v[82:83] op_sel_hi:[1,0]
    v_pk_fma_f32 v[112:113], v[110:111], v[82:83], v[112:113] op_sel:[1,1,0] op_sel_hi:[0,1,1] neg_lo:[1,0,0]
    v_cvt_pk_bf16_f32 v114, v112, v113
    ds_write_b32 v6, v114 offset:10336
    v_pk_mul_f32 v[110:111], v[112:113], v[82:83] op_sel_hi:[1,0]
    v_pk_fma_f32 v[110:111], v[112:113], v[82:83], v[110:111] op_sel:[1,1,0] op_sel_hi:[0,1,1] neg_lo:[1,0,0]
    v_cvt_pk_bf16_f32 v115, v110, v111
    ds_write_b32 v6, v115 offset:10608
    v_pk_mul_f32 v[112:113], v[110:111], v[82:83] op_sel_hi:[1,0]
    v_pk_fma_f32 v[112:113], v[110:111], v[82:83], v[112:113] op_sel:[1,1,0] op_sel_hi:[0,1,1] neg_lo:[1,0,0]
    v_cvt_pk_bf16_f32 v116, v112, v113
    ds_write_b32 v6, v116 offset:10880
    v_pk_mul_f32 v[110:111], v[112:113], v[82:83] op_sel_hi:[1,0]
    v_pk_fma_f32 v[110:111], v[112:113], v[82:83], v[110:111] op_sel:[1,1,0] op_sel_hi:[0,1,1] neg_lo:[1,0,0]
    v_cvt_pk_bf16_f32 v117, v110, v111
    ds_write_b32 v6, v117 offset:11152
    v_pk_mul_f32 v[112:113], v[110:111], v[82:83] op_sel_hi:[1,0]
    v_pk_fma_f32 v[112:113], v[110:111], v[82:83], v[112:113] op_sel:[1,1,0] op_sel_hi:[0,1,1] neg_lo:[1,0,0]
    v_cvt_pk_bf16_f32 v114, v112, v113
    ds_write_b32 v6, v114 offset:11424
    v_pk_mul_f32 v[110:111], v[112:113], v[82:83] op_sel_hi:[1,0]
    v_pk_fma_f32 v[110:111], v[112:113], v[82:83], v[110:111] op_sel:[1,1,0] op_sel_hi:[0,1,1] neg_lo:[1,0,0]
    v_cvt_pk_bf16_f32 v115, v110, v111
    ds_write_b32 v6, v115 offset:11696
    v_pk_mul_f32 v[112:113], v[110:111], v[82:83] op_sel_hi:[1,0]
    v_pk_fma_f32 v[112:113], v[110:111], v[82:83], v[112:113] op_sel:[1,1,0] op_sel_hi:[0,1,1] neg_lo:[1,0,0]
    v_cvt_pk_bf16_f32 v116, v112, v113
    ds_write_b32 v6, v116 offset:11968
    v_pk_mul_f32 v[110:111], v[112:113], v[82:83] op_sel_hi:[1,0]
    v_pk_fma_f32 v[110:111], v[112:113], v[82:83], v[110:111] op_sel:[1,1,0] op_sel_hi:[0,1,1] neg_lo:[1,0,0]
    v_cvt_pk_bf16_f32 v117, v110, v111
    ds_write_b32 v6, v117 offset:12240
    v_pk_mul_f32 v[112:113], v[110:111], v[82:83] op_sel_hi:[1,0]
    v_pk_fma_f32 v[112:113], v[110:111], v[82:83], v[112:113] op_sel:[1,1,0] op_sel_hi:[0,1,1] neg_lo:[1,0,0]
    v_cvt_pk_bf16_f32 v114, v112, v113
    ds_write_b32 v6, v114 offset:12512
    v_pk_mul_f32 v[110:111], v[112:113], v[82:83] op_sel_hi:[1,0]
    v_pk_fma_f32 v[110:111], v[112:113], v[82:83], v[110:111] op_sel:[1,1,0] op_sel_hi:[0,1,1] neg_lo:[1,0,0]
    v_cvt_pk_bf16_f32 v115, v110, v111
    ds_write_b32 v6, v115 offset:12784
    v_pk_mul_f32 v[112:113], v[110:111], v[82:83] op_sel_hi:[1,0]
    v_pk_fma_f32 v[112:113], v[110:111], v[82:83], v[112:113] op_sel:[1,1,0] op_sel_hi:[0,1,1] neg_lo:[1,0,0]
    v_cvt_pk_bf16_f32 v116, v112, v113
    ds_write_b32 v6, v116 offset:13056
    v_pk_mul_f32 v[110:111], v[112:113], v[82:83] op_sel_hi:[1,0]
    v_pk_fma_f32 v[110:111], v[112:113], v[82:83], v[110:111] op_sel:[1,1,0] op_sel_hi:[0,1,1] neg_lo:[1,0,0]
    v_cvt_pk_bf16_f32 v117, v110, v111
    ds_write_b32 v6, v117 offset:13328
    v_pk_mul_f32 v[112:113], v[110:111], v[82:83] op_sel_hi:[1,0]
    v_pk_fma_f32 v[112:113], v[110:111], v[82:83], v[112:113] op_sel:[1,1,0] op_sel_hi:[0,1,1] neg_lo:[1,0,0]
    v_cvt_pk_bf16_f32 v114, v112, v113
    ds_write_b32 v6, v114 offset:13600
    v_pk_mul_f32 v[110:111], v[112:113], v[82:83] op_sel_hi:[1,0]
    v_pk_fma_f32 v[110:111], v[112:113], v[82:83], v[110:111] op_sel:[1,1,0] op_sel_hi:[0,1,1] neg_lo:[1,0,0]
    v_cvt_pk_bf16_f32 v115, v110, v111
    ds_write_b32 v6, v115 offset:13872
    v_pk_mul_f32 v[112:113], v[110:111], v[82:83] op_sel_hi:[1,0]
    v_pk_fma_f32 v[112:113], v[110:111], v[82:83], v[112:113] op_sel:[1,1,0] op_sel_hi:[0,1,1] neg_lo:[1,0,0]
    v_cvt_pk_bf16_f32 v116, v112, v113
    ds_write_b32 v6, v116 offset:14144
    v_cvt_pk_bf16_f32 v117, v94, -v95
    ds_write_b32 v6, v117 offset:0
    v_pk_mul_f32 v[96:97], v[94:95], v[80:81] op_sel_hi:[1,0]
    v_pk_fma_f32 v[96:97], v[94:95], v[80:81], v[96:97] op_sel:[1,1,0] op_sel_hi:[0,1,1] neg_lo:[1,0,0]
    v_cvt_pk_bf16_f32 v114, v96, -v97
    ds_write_b32 v6, v114 offset:272
    v_pk_mul_f32 v[98:99], v[96:97], v[80:81] op_sel_hi:[1,0]
    v_pk_fma_f32 v[98:99], v[96:97], v[80:81], v[98:99] op_sel:[1,1,0] op_sel_hi:[0,1,1] neg_lo:[1,0,0]
    v_cvt_pk_bf16_f32 v115, v98, -v99
    ds_write_b32 v6, v115 offset:544
    v_pk_mul_f32 v[100:101], v[98:99], v[80:81] op_sel_hi:[1,0]
    v_pk_fma_f32 v[100:101], v[98:99], v[80:81], v[100:101] op_sel:[1,1,0] op_sel_hi:[0,1,1] neg_lo:[1,0,0]
    v_cvt_pk_bf16_f32 v116, v100, -v101
    ds_write_b32 v6, v116 offset:816
    v_pk_mul_f32 v[102:103], v[100:101], v[80:81] op_sel_hi:[1,0]
    v_pk_fma_f32 v[102:103], v[100:101], v[80:81], v[102:103] op_sel:[1,1,0] op_sel_hi:[0,1,1] neg_lo:[1,0,0]
    v_cvt_pk_bf16_f32 v117, v102, -v103
    ds_write_b32 v6, v117 offset:1088
    v_pk_mul_f32 v[104:105], v[102:103], v[80:81] op_sel_hi:[1,0]
    v_pk_fma_f32 v[104:105], v[102:103], v[80:81], v[104:105] op_sel:[1,1,0] op_sel_hi:[0,1,1] neg_lo:[1,0,0]
    v_cvt_pk_bf16_f32 v114, v104, -v105
    ds_write_b32 v6, v114 offset:1360
    v_pk_mul_f32 v[106:107], v[104:105], v[80:81] op_sel_hi:[1,0]
    v_pk_fma_f32 v[106:107], v[104:105], v[80:81], v[106:107] op_sel:[1,1,0] op_sel_hi:[0,1,1] neg_lo:[1,0,0]
    v_cvt_pk_bf16_f32 v115, v106, -v107
    ds_write_b32 v6, v115 offset:1632
    v_pk_mul_f32 v[108:109], v[106:107], v[80:81] op_sel_hi:[1,0]
    v_pk_fma_f32 v[108:109], v[106:107], v[80:81], v[108:109] op_sel:[1,1,0] op_sel_hi:[0,1,1] neg_lo:[1,0,0]
    v_cvt_pk_bf16_f32 v116, v108, -v109
    ds_write_b32 v6, v116 offset:1904
    v_pk_mul_f32 v[110:111], v[94:95], v[84:85] op_sel_hi:[1,0]
    v_pk_fma_f32 v[110:111], v[94:95], v[84:85], v[110:111] op_sel:[1,1,0] op_sel_hi:[0,1,1] neg_lo:[1,0,0]
    v_cvt_pk_bf16_f32 v117, v110, -v111
    ds_write_b32 v6, v117 offset:2176
    v_pk_mul_f32 v[112:113], v[98:99], v[84:85] op_sel_hi:[1,0]
    v_pk_fma_f32 v[112:113], v[98:99], v[84:85], v[112:113] op_sel:[1,1,0] op_sel_hi:[0,1,1] neg_lo:[1,0,0]
    v_cvt_pk_bf16_f32 v114, v112, -v113
    ds_write_b32 v6, v114 offset:2448
    v_pk_mul_f32 v[110:111], v[102:103], v[84:85] op_sel_hi:[1,0]
    v_pk_fma_f32 v[110:111], v[102:103], v[84:85], v[110:111] op_sel:[1,1,0] op_sel_hi:[0,1,1] neg_lo:[1,0,0]
    v_cvt_pk_bf16_f32 v115, v110, -v111
    ds_write_b32 v6, v115 offset:2720
    v_pk_mul_f32 v[112:113], v[106:107], v[84:85] op_sel_hi:[1,0]
    v_pk_fma_f32 v[112:113], v[106:107], v[84:85], v[112:113] op_sel:[1,1,0] op_sel_hi:[0,1,1] neg_lo:[1,0,0]
    v_cvt_pk_bf16_f32 v116, v112, -v113
    ds_write_b32 v6, v116 offset:2992
    v_pk_mul_f32 v[86:87], v[84:85], v[84:85] op_sel_hi:[1,0]
    v_pk_fma_f32 v[86:87], v[84:85], v[84:85], v[86:87] op_sel:[1,1,0] op_sel_hi:[0,1,1] neg_lo:[1,0,0]
    v_pk_mul_f32 v[110:111], v[94:95], v[86:87] op_sel_hi:[1,0]
    v_pk_fma_f32 v[110:111], v[94:95], v[86:87], v[110:111] op_sel:[1,1,0] op_sel_hi:[0,1,1] neg_lo:[1,0,0]
    v_cvt_pk_bf16_f32 v117, v110, -v111
    ds_write_b32 v6, v117 offset:3264
    v_pk_mul_f32 v[112:113], v[102:103], v[86:87] op_sel_hi:[1,0]
    v_pk_fma_f32 v[112:113], v[102:103], v[86:87], v[112:113] op_sel:[1,1,0] op_sel_hi:[0,1,1] neg_lo:[1,0,0]
    v_cvt_pk_bf16_f32 v114, v112, -v113
    ds_write_b32 v6, v114 offset:3536
    v_pk_mul_f32 v[88:89], v[86:87], v[84:85] op_sel_hi:[1,0]
    v_pk_fma_f32 v[88:89], v[86:87], v[84:85], v[88:89] op_sel:[1,1,0] op_sel_hi:[0,1,1] neg_lo:[1,0,0]
    v_pk_mul_f32 v[110:111], v[94:95], v[88:89] op_sel_hi:[1,0]
    v_pk_fma_f32 v[110:111], v[94:95], v[88:89], v[110:111] op_sel:[1,1,0] op_sel_hi:[0,1,1] neg_lo:[1,0,0]
    v_cvt_pk_bf16_f32 v115, v110, -v111
    ds_write_b32 v6, v115 offset:3808
    v_pk_mul_f32 v[112:113], v[102:103], v[88:89] op_sel_hi:[1,0]
    v_pk_fma_f32 v[112:113], v[102:103], v[88:89], v[112:113] op_sel:[1,1,0] op_sel_hi:[0,1,1] neg_lo:[1,0,0]
    v_cvt_pk_bf16_f32 v116, v112, -v113
    ds_write_b32 v6, v116 offset:4080
    v_pk_mul_f32 v[86:87], v[88:89], v[84:85] op_sel_hi:[1,0]
    v_pk_fma_f32 v[86:87], v[88:89], v[84:85], v[86:87] op_sel:[1,1,0] op_sel_hi:[0,1,1] neg_lo:[1,0,0]
    v_pk_mul_f32 v[110:111], v[94:95], v[86:87] op_sel_hi:[1,0]
    v_pk_fma_f32 v[110:111], v[94:95], v[86:87], v[110:111] op_sel:[1,1,0] op_sel_hi:[0,1,1] neg_lo:[1,0,0]
    v_cvt_pk_bf16_f32 v117, v110, -v111
    ds_write_b32 v6, v117 offset:4352
    v_pk_mul_f32 v[88:89], v[86:87], v[84:85] op_sel_hi:[1,0]
    v_pk_fma_f32 v[88:89], v[86:87], v[84:85], v[88:89] op_sel:[1,1,0] op_sel_hi:[0,1,1] neg_lo:[1,0,0]
    v_pk_mul_f32 v[110:111], v[94:95], v[88:89] op_sel_hi:[1,0]
    v_pk_fma_f32 v[110:111], v[94:95], v[88:89], v[110:111] op_sel:[1,1,0] op_sel_hi:[0,1,1] neg_lo:[1,0,0]
    v_cvt_pk_bf16_f32 v114, v110, -v111
    ds_write_b32 v6, v114 offset:4624
    v_pk_mul_f32 v[86:87], v[88:89], v[84:85] op_sel_hi:[1,0]
    v_pk_fma_f32 v[86:87], v[88:89], v[84:85], v[86:87] op_sel:[1,1,0] op_sel_hi:[0,1,1] neg_lo:[1,0,0]
    v_pk_mul_f32 v[110:111], v[94:95], v[86:87] op_sel_hi:[1,0]
    v_pk_fma_f32 v[110:111], v[94:95], v[86:87], v[110:111] op_sel:[1,1,0] op_sel_hi:[0,1,1] neg_lo:[1,0,0]
    v_cvt_pk_bf16_f32 v115, v110, -v111
    ds_write_b32 v6, v115 offset:4896
    v_pk_mul_f32 v[88:89], v[86:87], v[84:85] op_sel_hi:[1,0]
    v_pk_fma_f32 v[88:89], v[86:87], v[84:85], v[88:89] op_sel:[1,1,0] op_sel_hi:[0,1,1] neg_lo:[1,0,0]
    v_pk_mul_f32 v[110:111], v[94:95], v[88:89] op_sel_hi:[1,0]
    v_pk_fma_f32 v[110:111], v[94:95], v[88:89], v[110:111] op_sel:[1,1,0] op_sel_hi:[0,1,1] neg_lo:[1,0,0]
    v_cvt_pk_bf16_f32 v116, v110, -v111
    ds_write_b32 v6, v116 offset:5168
    v_pk_mul_f32 v[86:87], v[88:89], v[84:85] op_sel_hi:[1,0]
    v_pk_fma_f32 v[86:87], v[88:89], v[84:85], v[86:87] op_sel:[1,1,0] op_sel_hi:[0,1,1] neg_lo:[1,0,0]
    v_pk_mul_f32 v[110:111], v[94:95], v[86:87] op_sel_hi:[1,0]
    v_pk_fma_f32 v[110:111], v[94:95], v[86:87], v[110:111] op_sel:[1,1,0] op_sel_hi:[0,1,1] neg_lo:[1,0,0]
    v_cvt_pk_bf16_f32 v117, v110, -v111
    ds_write_b32 v6, v117 offset:5440
    s_waitcnt lgkmcnt(0)
    ds_read_b128 v[176:179], v7 offset:0
    ds_read_b128 v[160:163], v7 offset:5712
    ds_read_b128 v[180:183], v7 offset:32
    ds_read_b128 v[164:167], v7 offset:5744
    ds_read_b128 v[184:187], v7 offset:64
    ds_read_b128 v[168:171], v7 offset:5776
    ds_read_b128 v[188:191], v7 offset:96
    ds_read_b128 v[172:175], v7 offset:5808
    s_waitcnt lgkmcnt(6)
    v_mfma_f32_32x32x16_bf16 v[128:143], v[176:179], v[160:163], v[128:143]
    s_waitcnt lgkmcnt(4)
    v_mfma_f32_32x32x16_bf16 v[128:143], v[180:183], v[164:167], v[128:143]
    s_waitcnt lgkmcnt(2)
    v_mfma_f32_32x32x16_bf16 v[128:143], v[184:187], v[168:171], v[128:143]
    s_waitcnt lgkmcnt(0)
    v_mfma_f32_32x32x16_bf16 v[128:143], v[188:191], v[172:175], v[128:143]
    ds_read_b128 v[176:179], v7 offset:128
    ds_read_b128 v[160:163], v7 offset:5840
    ds_read_b128 v[180:183], v7 offset:160
    ds_read_b128 v[164:167], v7 offset:5872
    ds_read_b128 v[184:187], v7 offset:192
    ds_read_b128 v[168:171], v7 offset:5904
    ds_read_b128 v[188:191], v7 offset:224
    ds_read_b128 v[172:175], v7 offset:5936
    s_waitcnt lgkmcnt(6)
    v_mfma_f32_32x32x16_bf16 v[128:143], v[176:179], v[160:163], v[128:143]
    s_waitcnt lgkmcnt(4)
    v_mfma_f32_32x32x16_bf16 v[128:143], v[180:183], v[164:167], v[128:143]
    s_waitcnt lgkmcnt(2)
    v_mfma_f32_32x32x16_bf16 v[128:143], v[184:187], v[168:171], v[128:143]
    s_waitcnt lgkmcnt(0)
    v_mfma_f32_32x32x16_bf16 v[128:143], v[188:191], v[172:175], v[128:143]
    s_waitcnt vmcnt(0)
    v_perm_b32 v176, v194, v192, s69
    v_perm_b32 v177, v198, v196, s69
    ds_write_b64 v14, v[176:177] offset:19200
    v_perm_b32 v178, v202, v200, s69
    v_perm_b32 v179, v206, v204, s69
    ds_write_b64 v14, v[178:179] offset:19216
    v_perm_b32 v180, v210, v208, s69
    v_perm_b32 v181, v214, v212, s69
    ds_write_b64 v14, v[180:181] offset:19232
    v_perm_b32 v182, v218, v216, s69
    v_perm_b32 v183, v222, v220, s69
    ds_write_b64 v14, v[182:183] offset:19248
    v_perm_b32 v184, v226, v224, s69
    v_perm_b32 v185, v230, v228, s69
    ds_write_b64 v14, v[184:185] offset:21760
    v_perm_b32 v186, v234, v232, s69
    v_perm_b32 v187, v238, v236, s69
    ds_write_b64 v14, v[186:187] offset:21776
    v_perm_b32 v188, v242, v240, s69
    v_perm_b32 v189, v246, v244, s69
    ds_write_b64 v14, v[188:189] offset:21792
    v_perm_b32 v190, v250, v248, s69
    v_perm_b32 v191, v254, v252, s69
    ds_write_b64 v14, v[190:191] offset:21808
    ds_write_b32 v8, v128 offset:24320
    ds_write_b32 v8, v129 offset:24324
    ds_write_b32 v8, v130 offset:24328
    ds_write_b32 v8, v131 offset:24332
    s_mov_b64 exec, 0xffffffff
    ds_write_b32 v9, v132 offset:25344
    ds_write_b32 v10, v136 offset:26368
    ds_write_b32 v9, v133 offset:25348
    ds_write_b32 v10, v137 offset:26496
    ds_write_b32 v9, v134 offset:25352
    ds_write_b32 v10, v138 offset:26624
    ds_write_b32 v9, v135 offset:25356
    ds_write_b32 v10, v139 offset:26752
    s_not_b64 exec, exec
    ds_write_b32 v9, v132 offset:25856
    ds_write_b32 v9, v133 offset:25860
    ds_write_b32 v9, v134 offset:26112
    ds_write_b32 v9, v135 offset:26116
    ds_write_b32 v10, v136 offset:26880
    s_mov_b64 exec, -1
    s_waitcnt lgkmcnt(0)
    ds_read_b32 v76, v40
    ds_read_b32 v77, v41
    ds_read_b32 v78, v42
    ds_read_b32 v79, v43
    ds_read_b32 v80, v44
    ds_read_b32 v81, v45
    ds_read_b32 v82, v46
    ds_read_b32 v83, v47
    ds_read_b32 v84, v48
    ds_read_b32 v85, v49
    ds_read_b32 v86, v50
    ds_read_b32 v87, v51
    s_waitcnt lgkmcnt(0)
    ds_read_b32 v88, v52
    ds_read_b32 v89, v53
    ds_read_b32 v90, v54
    ds_read_b32 v91, v55
    ds_read_b32 v92, v56
    ds_read_b32 v93, v57
    ds_read_b32 v94, v58
    ds_read_b32 v95, v59
    ds_read_b32 v96, v60
    ds_read_b32 v97, v61
    ds_read_b32 v98, v62
    ds_read_b32 v99, v63
    s_waitcnt lgkmcnt(0)
    ds_read_b32 v100, v64
    ds_read_b32 v101, v65
    ds_read_b32 v102, v66
    ds_read_b32 v103, v67
    ds_read_b32 v104, v68
    ds_read_b32 v105, v69
    ds_read_b32 v106, v70
    ds_read_b32 v107, v71
    ds_read_b32 v108, v72
    ds_read_b32 v109, v73
    ds_read_b32 v110, v74
    s_waitcnt lgkmcnt(0)
    v_cvt_pk_bf16_f32 v160, v79, v80
    v_cvt_pk_bf16_f32 v161, v81, v82
    v_cvt_pk_bf16_f32 v162, v83, v84
    v_cvt_pk_bf16_f32 v163, v85, v86
    ds_write_b128 v11, v[160:163] offset:0
    v_cvt_pk_bf16_f32 v164, v87, v88
    v_cvt_pk_bf16_f32 v165, v89, v90
    v_cvt_pk_bf16_f32 v166, v91, v92
    v_cvt_pk_bf16_f32 v167, v93, v94
    ds_write_b128 v11, v[164:167] offset:16
    v_cvt_pk_bf16_f32 v168, v95, v96
    v_cvt_pk_bf16_f32 v169, v97, v98
    v_cvt_pk_bf16_f32 v170, v99, v100
    v_cvt_pk_bf16_f32 v171, v101, v102
    ds_write_b128 v11, v[168:171] offset:32
    v_cvt_pk_bf16_f32 v172, v103, v104
    v_cvt_pk_bf16_f32 v173, v105, v106
    v_cvt_pk_bf16_f32 v174, v107, v108
    v_cvt_pk_bf16_f32 v175, v109, v110
    ds_write_b128 v11, v[172:175] offset:48
    v_cvt_pk_bf16_f32 v176, v78, v79
    v_cvt_pk_bf16_f32 v177, v80, v81
    v_cvt_pk_bf16_f32 v178, v82, v83
    v_cvt_pk_bf16_f32 v179, v84, v85
    ds_write_b128 v11, v[176:179] offset:4160
    v_cvt_pk_bf16_f32 v180, v86, v87
    v_cvt_pk_bf16_f32 v181, v88, v89
    v_cvt_pk_bf16_f32 v182, v90, v91
    v_cvt_pk_bf16_f32 v183, v92, v93
    ds_write_b128 v11, v[180:183] offset:4176
    v_cvt_pk_bf16_f32 v184, v94, v95
    v_cvt_pk_bf16_f32 v185, v96, v97
    v_cvt_pk_bf16_f32 v186, v98, v99
    v_cvt_pk_bf16_f32 v187, v100, v101
    ds_write_b128 v11, v[184:187] offset:4192
    v_cvt_pk_bf16_f32 v188, v102, v103
    v_cvt_pk_bf16_f32 v189, v104, v105
    v_cvt_pk_bf16_f32 v190, v106, v107
    v_cvt_pk_bf16_f32 v191, v108, v109
    ds_write_b128 v11, v[188:191] offset:4208
    v_cvt_pk_bf16_f32 v160, v77, v78
    v_cvt_pk_bf16_f32 v161, v79, v80
    v_cvt_pk_bf16_f32 v162, v81, v82
    v_cvt_pk_bf16_f32 v163, v83, v84
    ds_write_b128 v11, v[160:163] offset:8320
    v_cvt_pk_bf16_f32 v164, v85, v86
    v_cvt_pk_bf16_f32 v165, v87, v88
    v_cvt_pk_bf16_f32 v166, v89, v90
    v_cvt_pk_bf16_f32 v167, v91, v92
    ds_write_b128 v11, v[164:167] offset:8336
    v_cvt_pk_bf16_f32 v168, v93, v94
    v_cvt_pk_bf16_f32 v169, v95, v96
    v_cvt_pk_bf16_f32 v170, v97, v98
    v_cvt_pk_bf16_f32 v171, v99, v100
    ds_write_b128 v11, v[168:171] offset:8352
    v_cvt_pk_bf16_f32 v172, v101, v102
    v_cvt_pk_bf16_f32 v173, v103, v104
    v_cvt_pk_bf16_f32 v174, v105, v106
    v_cvt_pk_bf16_f32 v175, v107, v108
    ds_write_b128 v11, v[172:175] offset:8368
    v_cvt_pk_bf16_f32 v176, v76, v77
    v_cvt_pk_bf16_f32 v177, v78, v79
    v_cvt_pk_bf16_f32 v178, v80, v81
    v_cvt_pk_bf16_f32 v179, v82, v83
    ds_write_b128 v11, v[176:179] offset:12480
    v_cvt_pk_bf16_f32 v180, v84, v85
    v_cvt_pk_bf16_f32 v181, v86, v87
    v_cvt_pk_bf16_f32 v182, v88, v89
    v_cvt_pk_bf16_f32 v183, v90, v91
    ds_write_b128 v11, v[180:183] offset:12496
    v_cvt_pk_bf16_f32 v184, v92, v93
    v_cvt_pk_bf16_f32 v185, v94, v95
    v_cvt_pk_bf16_f32 v186, v96, v97
    v_cvt_pk_bf16_f32 v187, v98, v99
    ds_write_b128 v11, v[184:187] offset:12512
    v_cvt_pk_bf16_f32 v188, v100, v101
    v_cvt_pk_bf16_f32 v189, v102, v103
    v_cvt_pk_bf16_f32 v190, v104, v105
    v_cvt_pk_bf16_f32 v191, v106, v107
    ds_write_b128 v11, v[188:191] offset:12528
    v_mov_b32 v2, 0
    v_lshrrev_b32 v3, 4, v0
    v_mul_u32_u24 v3, 4096, v3
    v_add_u32 v3, v3, v6
    ds_write_b32 v3, v2 offset:4096
    s_lshl_b32 s61, s66, 16
    v_perm_b32 v128, v192, v192, s68
    v_mul_f32 v128, s61, v128
    v_perm_b32 v129, v194, v194, s68
    v_mul_f32 v129, s61, v129
    v_perm_b32 v130, v196, v196, s68
    v_mul_f32 v130, s61, v130
    v_perm_b32 v131, v198, v198, s68
    v_mul_f32 v131, s61, v131
    v_perm_b32 v132, v200, v200, s68
    v_mul_f32 v132, s61, v132
    v_perm_b32 v133, v202, v202, s68
    v_mul_f32 v133, s61, v133
    v_perm_b32 v134, v204, v204, s68
    v_mul_f32 v134, s61, v134
    v_perm_b32 v135, v206, v206, s68
    v_mul_f32 v135, s61, v135
    v_perm_b32 v136, v208, v208, s68
    v_mul_f32 v136, s61, v136
    v_perm_b32 v137, v210, v210, s68
    v_mul_f32 v137, s61, v137
    v_perm_b32 v138, v212, v212, s68
    v_mul_f32 v138, s61, v138
    v_perm_b32 v139, v214, v214, s68
    v_mul_f32 v139, s61, v139
    v_perm_b32 v140, v216, v216, s68
    v_mul_f32 v140, s61, v140
    v_perm_b32 v141, v218, v218, s68
    v_mul_f32 v141, s61, v141
    v_perm_b32 v142, v220, v220, s68
    v_mul_f32 v142, s61, v142
    v_perm_b32 v143, v222, v222, s68
    v_mul_f32 v143, s61, v143
    v_perm_b32 v144, v224, v224, s68
    v_mul_f32 v144, s61, v144
    v_perm_b32 v145, v226, v226, s68
    v_mul_f32 v145, s61, v145
    v_perm_b32 v146, v228, v228, s68
    v_mul_f32 v146, s61, v146
    v_perm_b32 v147, v230, v230, s68
    v_mul_f32 v147, s61, v147
    v_perm_b32 v148, v232, v232, s68
    v_mul_f32 v148, s61, v148
    v_perm_b32 v149, v234, v234, s68
    v_mul_f32 v149, s61, v149
    v_perm_b32 v150, v236, v236, s68
    v_mul_f32 v150, s61, v150
    v_perm_b32 v151, v238, v238, s68
    v_mul_f32 v151, s61, v151
    v_perm_b32 v152, v240, v240, s68
    v_mul_f32 v152, s61, v152
    v_perm_b32 v153, v242, v242, s68
    v_mul_f32 v153, s61, v153
    v_perm_b32 v154, v244, v244, s68
    v_mul_f32 v154, s61, v154
    v_perm_b32 v155, v246, v246, s68
    v_mul_f32 v155, s61, v155
    v_perm_b32 v156, v248, v248, s68
    v_mul_f32 v156, s61, v156
    v_perm_b32 v157, v250, v250, s68
    v_mul_f32 v157, s61, v157
    v_perm_b32 v158, v252, v252, s68
    v_mul_f32 v158, s61, v158
    v_perm_b32 v159, v254, v254, s68
    v_mul_f32 v159, s61, v159
    s_waitcnt lgkmcnt(0)
    ds_read_b128 v[160:163], v13 offset:21680
    ds_read_b64 v[176:177], v12 offset:4032
    ds_read_b64 v[178:179], v12 offset:4040
    ds_read_b128 v[164:167], v13 offset:21712
    ds_read_b64 v[180:181], v12 offset:4064
    ds_read_b64 v[182:183], v12 offset:4072
    ds_read_b128 v[168:171], v13 offset:21600
    ds_read_b64 v[184:185], v12 offset:3968
    ds_read_b64 v[186:187], v12 offset:3976
    ds_read_b128 v[172:175], v13 offset:21632
    ds_read_b64 v[188:189], v12 offset:4000
    ds_read_b64 v[190:191], v12 offset:4008
    s_waitcnt lgkmcnt(9)
    v_mfma_f32_32x32x16_bf16 v[144:159], v[176:179], v[160:163], v[144:159]
    ds_read_b128 v[160:163], v13 offset:21520
    ds_read_b64 v[176:177], v12 offset:3904
    ds_read_b64 v[178:179], v12 offset:3912
    s_waitcnt lgkmcnt(9)
    v_mfma_f32_32x32x16_bf16 v[144:159], v[180:183], v[164:167], v[144:159]
    ds_read_b128 v[164:167], v13 offset:21552
    ds_read_b64 v[180:181], v12 offset:3936
    ds_read_b64 v[182:183], v12 offset:3944
    s_waitcnt lgkmcnt(9)
    v_mfma_f32_32x32x16_bf16 v[144:159], v[184:187], v[168:171], v[144:159]
    ds_read_b128 v[168:171], v13 offset:21440
    ds_read_b64 v[184:185], v12 offset:3840
    ds_read_b64 v[186:187], v12 offset:3848
    s_waitcnt lgkmcnt(9)
    v_mfma_f32_32x32x16_bf16 v[144:159], v[188:191], v[172:175], v[144:159]
    ds_read_b128 v[172:175], v13 offset:21472
    ds_read_b64 v[188:189], v12 offset:3872
    ds_read_b64 v[190:191], v12 offset:3880
    s_waitcnt lgkmcnt(9)
    v_mfma_f32_32x32x16_bf16 v[144:159], v[176:179], v[160:163], v[144:159]
    ds_read_b128 v[160:163], v13 offset:21360
    ds_read_b64 v[176:177], v12 offset:3776
    ds_read_b64 v[178:179], v12 offset:3784
    s_waitcnt lgkmcnt(9)
    v_mfma_f32_32x32x16_bf16 v[144:159], v[180:183], v[164:167], v[144:159]
    ds_read_b128 v[164:167], v13 offset:21392
    ds_read_b64 v[180:181], v12 offset:3808
    ds_read_b64 v[182:183], v12 offset:3816
    s_waitcnt lgkmcnt(9)
    v_mfma_f32_32x32x16_bf16 v[144:159], v[184:187], v[168:171], v[144:159]
    ds_read_b128 v[168:171], v13 offset:21280
    ds_read_b64 v[184:185], v12 offset:3712
    ds_read_b64 v[186:187], v12 offset:3720
    s_waitcnt lgkmcnt(9)
    v_mfma_f32_32x32x16_bf16 v[144:159], v[188:191], v[172:175], v[144:159]
    ds_read_b128 v[172:175], v13 offset:21312
    ds_read_b64 v[188:189], v12 offset:3744
    ds_read_b64 v[190:191], v12 offset:3752
    s_waitcnt lgkmcnt(9)
    v_mfma_f32_32x32x16_bf16 v[144:159], v[176:179], v[160:163], v[144:159]
    ds_read_b128 v[160:163], v13 offset:21200
    ds_read_b64 v[176:177], v12 offset:3648
    ds_read_b64 v[178:179], v12 offset:3656
    s_waitcnt lgkmcnt(9)
    v_mfma_f32_32x32x16_bf16 v[144:159], v[180:183], v[164:167], v[144:159]
    ds_read_b128 v[164:167], v13 offset:21232
    ds_read_b64 v[180:181], v12 offset:3680
    ds_read_b64 v[182:183], v12 offset:3688
    s_waitcnt lgkmcnt(9)
    v_mfma_f32_32x32x16_bf16 v[144:159], v[184:187], v[168:171], v[144:159]
    ds_read_b128 v[168:171], v13 offset:21120
    ds_read_b64 v[184:185], v12 offset:3584
    ds_read_b64 v[186:187], v12 offset:3592
    s_waitcnt lgkmcnt(9)
    v_mfma_f32_32x32x16_bf16 v[144:159], v[188:191], v[172:175], v[144:159]
    ds_read_b128 v[172:175], v13 offset:21152
    ds_read_b64 v[188:189], v12 offset:3616
    ds_read_b64 v[190:191], v12 offset:3624
    s_waitcnt lgkmcnt(9)
    v_mfma_f32_32x32x16_bf16 v[144:159], v[176:179], v[160:163], v[144:159]
    ds_read_b128 v[160:163], v13 offset:21040
    ds_read_b64 v[176:177], v12 offset:3520
    ds_read_b64 v[178:179], v12 offset:3528
    s_waitcnt lgkmcnt(9)
    v_mfma_f32_32x32x16_bf16 v[144:159], v[180:183], v[164:167], v[144:159]
    ds_read_b128 v[164:167], v13 offset:21072
    ds_read_b64 v[180:181], v12 offset:3552
    ds_read_b64 v[182:183], v12 offset:3560
    s_waitcnt lgkmcnt(9)
    v_mfma_f32_32x32x16_bf16 v[144:159], v[184:187], v[168:171], v[144:159]
    ds_read_b128 v[168:171], v13 offset:20960
    ds_read_b64 v[184:185], v12 offset:3456
    ds_read_b64 v[186:187], v12 offset:3464
    s_waitcnt lgkmcnt(9)
    v_mfma_f32_32x32x16_bf16 v[144:159], v[188:191], v[172:175], v[144:159]
    ds_read_b128 v[172:175], v13 offset:20992
    ds_read_b64 v[188:189], v12 offset:3488
    ds_read_b64 v[190:191], v12 offset:3496
    s_waitcnt lgkmcnt(9)
    v_mfma_f32_32x32x16_bf16 v[144:159], v[176:179], v[160:163], v[144:159]
    ds_read_b128 v[160:163], v13 offset:20880
    ds_read_b64 v[176:177], v12 offset:3392
    ds_read_b64 v[178:179], v12 offset:3400
    s_waitcnt lgkmcnt(9)
    v_mfma_f32_32x32x16_bf16 v[144:159], v[180:183], v[164:167], v[144:159]
    ds_read_b128 v[164:167], v13 offset:20912
    ds_read_b64 v[180:181], v12 offset:3424
    ds_read_b64 v[182:183], v12 offset:3432
    s_waitcnt lgkmcnt(9)
    v_mfma_f32_32x32x16_bf16 v[144:159], v[184:187], v[168:171], v[144:159]
    ds_read_b128 v[168:171], v13 offset:20800
    ds_read_b64 v[184:185], v12 offset:3328
    ds_read_b64 v[186:187], v12 offset:3336
    s_waitcnt lgkmcnt(9)
    v_mfma_f32_32x32x16_bf16 v[144:159], v[188:191], v[172:175], v[144:159]
    ds_read_b128 v[172:175], v13 offset:20832
    ds_read_b64 v[188:189], v12 offset:3360
    ds_read_b64 v[190:191], v12 offset:3368
    s_waitcnt lgkmcnt(9)
    v_mfma_f32_32x32x16_bf16 v[144:159], v[176:179], v[160:163], v[144:159]
    ds_read_b128 v[160:163], v13 offset:20720
    ds_read_b64 v[176:177], v12 offset:3264
    ds_read_b64 v[178:179], v12 offset:3272
    s_waitcnt lgkmcnt(9)
    v_mfma_f32_32x32x16_bf16 v[144:159], v[180:183], v[164:167], v[144:159]
    ds_read_b128 v[164:167], v13 offset:20752
    ds_read_b64 v[180:181], v12 offset:3296
    ds_read_b64 v[182:183], v12 offset:3304
    s_waitcnt lgkmcnt(9)
    v_mfma_f32_32x32x16_bf16 v[144:159], v[184:187], v[168:171], v[144:159]
    ds_read_b128 v[168:171], v13 offset:20640
    ds_read_b64 v[184:185], v12 offset:3200
    ds_read_b64 v[186:187], v12 offset:3208
    s_waitcnt lgkmcnt(9)
    v_mfma_f32_32x32x16_bf16 v[144:159], v[188:191], v[172:175], v[144:159]
    ds_read_b128 v[172:175], v13 offset:20672
    ds_read_b64 v[188:189], v12 offset:3232
    ds_read_b64 v[190:191], v12 offset:3240
    s_waitcnt lgkmcnt(9)
    v_mfma_f32_32x32x16_bf16 v[144:159], v[176:179], v[160:163], v[144:159]
    ds_read_b128 v[160:163], v13 offset:20560
    ds_read_b64 v[176:177], v12 offset:3136
    ds_read_b64 v[178:179], v12 offset:3144
    s_waitcnt lgkmcnt(9)
    v_mfma_f32_32x32x16_bf16 v[144:159], v[180:183], v[164:167], v[144:159]
    ds_read_b128 v[164:167], v13 offset:20592
    ds_read_b64 v[180:181], v12 offset:3168
    ds_read_b64 v[182:183], v12 offset:3176
    s_waitcnt lgkmcnt(9)
    v_mfma_f32_32x32x16_bf16 v[144:159], v[184:187], v[168:171], v[144:159]
    ds_read_b128 v[168:171], v13 offset:20480
    ds_read_b64 v[184:185], v12 offset:3072
    ds_read_b64 v[186:187], v12 offset:3080
    s_waitcnt lgkmcnt(9)
    v_mfma_f32_32x32x16_bf16 v[144:159], v[188:191], v[172:175], v[144:159]
    ds_read_b128 v[172:175], v13 offset:20512
    ds_read_b64 v[188:189], v12 offset:3104
    ds_read_b64 v[190:191], v12 offset:3112
    s_waitcnt lgkmcnt(9)
    v_mfma_f32_32x32x16_bf16 v[144:159], v[176:179], v[160:163], v[144:159]
    ds_read_b128 v[160:163], v13 offset:20400
    ds_read_b64 v[176:177], v12 offset:3008
    ds_read_b64 v[178:179], v12 offset:3016
    s_waitcnt lgkmcnt(9)
    v_mfma_f32_32x32x16_bf16 v[144:159], v[180:183], v[164:167], v[144:159]
    ds_read_b128 v[164:167], v13 offset:20432
    ds_read_b64 v[180:181], v12 offset:3040
    ds_read_b64 v[182:183], v12 offset:3048
    s_waitcnt lgkmcnt(9)
    v_mfma_f32_32x32x16_bf16 v[144:159], v[184:187], v[168:171], v[144:159]
    ds_read_b128 v[168:171], v13 offset:20320
    ds_read_b64 v[184:185], v12 offset:2944
    ds_read_b64 v[186:187], v12 offset:2952
    s_waitcnt lgkmcnt(9)
    v_mfma_f32_32x32x16_bf16 v[144:159], v[188:191], v[172:175], v[144:159]
    ds_read_b128 v[172:175], v13 offset:20352
    ds_read_b64 v[188:189], v12 offset:2976
    ds_read_b64 v[190:191], v12 offset:2984
    s_waitcnt lgkmcnt(9)
    v_mfma_f32_32x32x16_bf16 v[144:159], v[176:179], v[160:163], v[144:159]
    ds_read_b128 v[160:163], v13 offset:20240
    ds_read_b64 v[176:177], v12 offset:2880
    ds_read_b64 v[178:179], v12 offset:2888
    s_waitcnt lgkmcnt(9)
    v_mfma_f32_32x32x16_bf16 v[144:159], v[180:183], v[164:167], v[144:159]
    ds_read_b128 v[164:167], v13 offset:20272
    ds_read_b64 v[180:181], v12 offset:2912
    ds_read_b64 v[182:183], v12 offset:2920
    s_waitcnt lgkmcnt(9)
    v_mfma_f32_32x32x16_bf16 v[144:159], v[184:187], v[168:171], v[144:159]
    ds_read_b128 v[168:171], v13 offset:20160
    ds_read_b64 v[184:185], v12 offset:2816
    ds_read_b64 v[186:187], v12 offset:2824
    s_waitcnt lgkmcnt(9)
    v_mfma_f32_32x32x16_bf16 v[144:159], v[188:191], v[172:175], v[144:159]
    ds_read_b128 v[172:175], v13 offset:20192
    ds_read_b64 v[188:189], v12 offset:2848
    ds_read_b64 v[190:191], v12 offset:2856
    s_waitcnt lgkmcnt(9)
    v_mfma_f32_32x32x16_bf16 v[144:159], v[176:179], v[160:163], v[144:159]
    ds_read_b128 v[160:163], v13 offset:20080
    ds_read_b64 v[176:177], v12 offset:2752
    ds_read_b64 v[178:179], v12 offset:2760
    s_waitcnt lgkmcnt(9)
    v_mfma_f32_32x32x16_bf16 v[144:159], v[180:183], v[164:167], v[144:159]
    ds_read_b128 v[164:167], v13 offset:20112
    ds_read_b64 v[180:181], v12 offset:2784
    ds_read_b64 v[182:183], v12 offset:2792
    s_waitcnt lgkmcnt(9)
    v_mfma_f32_32x32x16_bf16 v[144:159], v[184:187], v[168:171], v[144:159]
    ds_read_b128 v[168:171], v13 offset:20000
    ds_read_b64 v[184:185], v12 offset:2688
    ds_read_b64 v[186:187], v12 offset:2696
    s_waitcnt lgkmcnt(9)
    v_mfma_f32_32x32x16_bf16 v[144:159], v[188:191], v[172:175], v[144:159]
    ds_read_b128 v[172:175], v13 offset:20032
    ds_read_b64 v[188:189], v12 offset:2720
    ds_read_b64 v[190:191], v12 offset:2728
    s_waitcnt lgkmcnt(9)
    v_mfma_f32_32x32x16_bf16 v[144:159], v[176:179], v[160:163], v[144:159]
    ds_read_b128 v[160:163], v13 offset:19920
    ds_read_b64 v[176:177], v12 offset:2624
    ds_read_b64 v[178:179], v12 offset:2632
    s_waitcnt lgkmcnt(9)
    v_mfma_f32_32x32x16_bf16 v[144:159], v[180:183], v[164:167], v[144:159]
    ds_read_b128 v[164:167], v13 offset:19952
    ds_read_b64 v[180:181], v12 offset:2656
    ds_read_b64 v[182:183], v12 offset:2664
    s_waitcnt lgkmcnt(9)
    v_mfma_f32_32x32x16_bf16 v[144:159], v[184:187], v[168:171], v[144:159]
    ds_read_b128 v[168:171], v13 offset:19840
    ds_read_b64 v[184:185], v12 offset:2560
    ds_read_b64 v[186:187], v12 offset:2568
    s_waitcnt lgkmcnt(9)
    v_mfma_f32_32x32x16_bf16 v[144:159], v[188:191], v[172:175], v[144:159]
    ds_read_b128 v[172:175], v13 offset:19872
    ds_read_b64 v[188:189], v12 offset:2592
    ds_read_b64 v[190:191], v12 offset:2600
    s_waitcnt lgkmcnt(9)
    v_mfma_f32_32x32x16_bf16 v[144:159], v[176:179], v[160:163], v[144:159]
    ds_read_b128 v[160:163], v13 offset:19760
    ds_read_b64 v[176:177], v12 offset:2496
    ds_read_b64 v[178:179], v12 offset:2504
    s_waitcnt lgkmcnt(9)
    v_mfma_f32_32x32x16_bf16 v[144:159], v[180:183], v[164:167], v[144:159]
    ds_read_b128 v[164:167], v13 offset:19792
    ds_read_b64 v[180:181], v12 offset:2528
    ds_read_b64 v[182:183], v12 offset:2536
    s_waitcnt lgkmcnt(9)
    v_mfma_f32_32x32x16_bf16 v[144:159], v[184:187], v[168:171], v[144:159]
    ds_read_b128 v[168:171], v13 offset:19680
    ds_read_b64 v[184:185], v12 offset:2432
    ds_read_b64 v[186:187], v12 offset:2440
    s_waitcnt lgkmcnt(9)
    v_mfma_f32_32x32x16_bf16 v[144:159], v[188:191], v[172:175], v[144:159]
    ds_read_b128 v[172:175], v13 offset:19712
    ds_read_b64 v[188:189], v12 offset:2464
    ds_read_b64 v[190:191], v12 offset:2472
    s_waitcnt lgkmcnt(9)
    v_mfma_f32_32x32x16_bf16 v[144:159], v[176:179], v[160:163], v[144:159]
    ds_read_b128 v[160:163], v13 offset:19600
    ds_read_b64 v[176:177], v12 offset:2368
    ds_read_b64 v[178:179], v12 offset:2376
    s_waitcnt lgkmcnt(9)
    v_mfma_f32_32x32x16_bf16 v[144:159], v[180:183], v[164:167], v[144:159]
    ds_read_b128 v[164:167], v13 offset:19632
    ds_read_b64 v[180:181], v12 offset:2400
    ds_read_b64 v[182:183], v12 offset:2408
    s_waitcnt lgkmcnt(9)
    v_mfma_f32_32x32x16_bf16 v[144:159], v[184:187], v[168:171], v[144:159]
    ds_read_b128 v[168:171], v13 offset:19520
    ds_read_b64 v[184:185], v12 offset:2304
    ds_read_b64 v[186:187], v12 offset:2312
    s_waitcnt lgkmcnt(9)
    v_mfma_f32_32x32x16_bf16 v[144:159], v[188:191], v[172:175], v[144:159]
    ds_read_b128 v[172:175], v13 offset:19552
    ds_read_b64 v[188:189], v12 offset:2336
    ds_read_b64 v[190:191], v12 offset:2344
    s_waitcnt lgkmcnt(9)
    v_mfma_f32_32x32x16_bf16 v[144:159], v[176:179], v[160:163], v[144:159]
    ds_read_b128 v[160:163], v13 offset:19440
    ds_read_b64 v[176:177], v12 offset:2240
    ds_read_b64 v[178:179], v12 offset:2248
    s_waitcnt lgkmcnt(9)
    v_mfma_f32_32x32x16_bf16 v[144:159], v[180:183], v[164:167], v[144:159]
    ds_read_b128 v[164:167], v13 offset:19472
    ds_read_b64 v[180:181], v12 offset:2272
    ds_read_b64 v[182:183], v12 offset:2280
    s_waitcnt lgkmcnt(9)
    v_mfma_f32_32x32x16_bf16 v[144:159], v[184:187], v[168:171], v[144:159]
    ds_read_b128 v[168:171], v13 offset:19360
    ds_read_b64 v[184:185], v12 offset:2176
    ds_read_b64 v[186:187], v12 offset:2184
    s_waitcnt lgkmcnt(9)
    v_mfma_f32_32x32x16_bf16 v[144:159], v[188:191], v[172:175], v[144:159]
    ds_read_b128 v[172:175], v13 offset:19392
    ds_read_b64 v[188:189], v12 offset:2208
    ds_read_b64 v[190:191], v12 offset:2216
    s_waitcnt lgkmcnt(9)
    v_mfma_f32_32x32x16_bf16 v[144:159], v[176:179], v[160:163], v[144:159]
    ds_read_b128 v[160:163], v13 offset:19280
    ds_read_b64 v[176:177], v12 offset:2112
    ds_read_b64 v[178:179], v12 offset:2120
    s_waitcnt lgkmcnt(9)
    v_mfma_f32_32x32x16_bf16 v[144:159], v[180:183], v[164:167], v[144:159]
    ds_read_b128 v[164:167], v13 offset:19312
    ds_read_b64 v[180:181], v12 offset:2144
    ds_read_b64 v[182:183], v12 offset:2152
    s_waitcnt lgkmcnt(9)
    v_mfma_f32_32x32x16_bf16 v[144:159], v[184:187], v[168:171], v[144:159]
    ds_read_b128 v[168:171], v13 offset:19200
    ds_read_b64 v[184:185], v12 offset:2048
    ds_read_b64 v[186:187], v12 offset:2056
    s_waitcnt lgkmcnt(9)
    v_mfma_f32_32x32x16_bf16 v[144:159], v[188:191], v[172:175], v[144:159]
    ds_read_b128 v[172:175], v13 offset:19232
    ds_read_b64 v[188:189], v12 offset:2080
    ds_read_b64 v[190:191], v12 offset:2088
    s_waitcnt lgkmcnt(9)
    v_mfma_f32_32x32x16_bf16 v[144:159], v[176:179], v[160:163], v[144:159]
    ds_read_b128 v[160:163], v13 offset:19120
    ds_read_b64 v[176:177], v12 offset:1984
    ds_read_b64 v[178:179], v12 offset:1992
    s_waitcnt lgkmcnt(9)
    v_mfma_f32_32x32x16_bf16 v[144:159], v[180:183], v[164:167], v[144:159]
    ds_read_b64 v[180:181], v12 offset:4032
    ds_read_b64 v[182:183], v12 offset:4040
    s_waitcnt lgkmcnt(8)
    v_mfma_f32_32x32x16_bf16 v[144:159], v[184:187], v[168:171], v[144:159]
    ds_read_b128 v[164:167], v13 offset:19152
    ds_read_b64 v[184:185], v12 offset:2016
    ds_read_b64 v[186:187], v12 offset:2024
    s_waitcnt lgkmcnt(8)
    v_mfma_f32_32x32x16_bf16 v[144:159], v[188:191], v[172:175], v[144:159]
    ds_read_b64 v[188:189], v12 offset:4064
    ds_read_b64 v[190:191], v12 offset:4072
    s_waitcnt lgkmcnt(7)
    v_mfma_f32_32x32x16_bf16 v[144:159], v[176:179], v[160:163], v[144:159]
    ds_read_b128 v[168:171], v13 offset:19040
    ds_read_b64 v[176:177], v12 offset:1920
    ds_read_b64 v[178:179], v12 offset:1928
    s_waitcnt lgkmcnt(8)
    v_mfma_f32_32x32x16_bf16 v[128:143], v[180:183], v[160:163], v[128:143]
    ds_read_b64 v[180:181], v12 offset:3968
    ds_read_b64 v[182:183], v12 offset:3976
    s_waitcnt lgkmcnt(7)
    v_mfma_f32_32x32x16_bf16 v[144:159], v[184:187], v[164:167], v[144:159]
    ds_read_b128 v[172:175], v13 offset:19072
    ds_read_b64 v[184:185], v12 offset:1952
    ds_read_b64 v[186:187], v12 offset:1960
    s_waitcnt lgkmcnt(8)
    v_mfma_f32_32x32x16_bf16 v[128:143], v[188:191], v[164:167], v[128:143]
    ds_read_b64 v[188:189], v12 offset:4000
    ds_read_b64 v[190:191], v12 offset:4008
    s_waitcnt lgkmcnt(7)
    v_mfma_f32_32x32x16_bf16 v[144:159], v[176:179], v[168:171], v[144:159]
    ds_read_b128 v[160:163], v13 offset:18960
    ds_read_b64 v[176:177], v12 offset:1856
    ds_read_b64 v[178:179], v12 offset:1864
    s_waitcnt lgkmcnt(8)
    v_mfma_f32_32x32x16_bf16 v[128:143], v[180:183], v[168:171], v[128:143]
    ds_read_b64 v[180:181], v12 offset:3904
    ds_read_b64 v[182:183], v12 offset:3912
    s_waitcnt lgkmcnt(7)
    v_mfma_f32_32x32x16_bf16 v[144:159], v[184:187], v[172:175], v[144:159]
    ds_read_b128 v[164:167], v13 offset:18992
    ds_read_b64 v[184:185], v12 offset:1888
    ds_read_b64 v[186:187], v12 offset:1896
    s_waitcnt lgkmcnt(8)
    v_mfma_f32_32x32x16_bf16 v[128:143], v[188:191], v[172:175], v[128:143]
    ds_read_b64 v[188:189], v12 offset:3936
    ds_read_b64 v[190:191], v12 offset:3944
    s_waitcnt lgkmcnt(7)
    v_mfma_f32_32x32x16_bf16 v[144:159], v[176:179], v[160:163], v[144:159]
    ds_read_b128 v[168:171], v13 offset:18880
    ds_read_b64 v[176:177], v12 offset:1792
    ds_read_b64 v[178:179], v12 offset:1800
    s_waitcnt lgkmcnt(8)
    v_mfma_f32_32x32x16_bf16 v[128:143], v[180:183], v[160:163], v[128:143]
    ds_read_b64 v[180:181], v12 offset:3840
    ds_read_b64 v[182:183], v12 offset:3848
    s_waitcnt lgkmcnt(7)
    v_mfma_f32_32x32x16_bf16 v[144:159], v[184:187], v[164:167], v[144:159]
    ds_read_b128 v[172:175], v13 offset:18912
    ds_read_b64 v[184:185], v12 offset:1824
    ds_read_b64 v[186:187], v12 offset:1832
    s_waitcnt lgkmcnt(8)
    v_mfma_f32_32x32x16_bf16 v[128:143], v[188:191], v[164:167], v[128:143]
    ds_read_b64 v[188:189], v12 offset:3872
    ds_read_b64 v[190:191], v12 offset:3880
    s_waitcnt lgkmcnt(7)
    v_mfma_f32_32x32x16_bf16 v[144:159], v[176:179], v[168:171], v[144:159]
    ds_read_b128 v[160:163], v13 offset:18800
    ds_read_b64 v[176:177], v12 offset:1728
    ds_read_b64 v[178:179], v12 offset:1736
    s_waitcnt lgkmcnt(8)
    v_mfma_f32_32x32x16_bf16 v[128:143], v[180:183], v[168:171], v[128:143]
    ds_read_b64 v[180:181], v12 offset:3776
    ds_read_b64 v[182:183], v12 offset:3784
    s_waitcnt lgkmcnt(7)
    v_mfma_f32_32x32x16_bf16 v[144:159], v[184:187], v[172:175], v[144:159]
    ds_read_b128 v[164:167], v13 offset:18832
    ds_read_b64 v[184:185], v12 offset:1760
    ds_read_b64 v[186:187], v12 offset:1768
    s_waitcnt lgkmcnt(8)
    v_mfma_f32_32x32x16_bf16 v[128:143], v[188:191], v[172:175], v[128:143]
    ds_read_b64 v[188:189], v12 offset:3808
    ds_read_b64 v[190:191], v12 offset:3816
    s_waitcnt lgkmcnt(7)
    v_mfma_f32_32x32x16_bf16 v[144:159], v[176:179], v[160:163], v[144:159]
    ds_read_b128 v[168:171], v13 offset:18720
    ds_read_b64 v[176:177], v12 offset:1664
    ds_read_b64 v[178:179], v12 offset:1672
    s_waitcnt lgkmcnt(8)
    v_mfma_f32_32x32x16_bf16 v[128:143], v[180:183], v[160:163], v[128:143]
    ds_read_b64 v[180:181], v12 offset:3712
    ds_read_b64 v[182:183], v12 offset:3720
    s_waitcnt lgkmcnt(7)
    v_mfma_f32_32x32x16_bf16 v[144:159], v[184:187], v[164:167], v[144:159]
    ds_read_b128 v[172:175], v13 offset:18752
    ds_read_b64 v[184:185], v12 offset:1696
    ds_read_b64 v[186:187], v12 offset:1704
    s_waitcnt lgkmcnt(8)
    v_mfma_f32_32x32x16_bf16 v[128:143], v[188:191], v[164:167], v[128:143]
    ds_read_b64 v[188:189], v12 offset:3744
    ds_read_b64 v[190:191], v12 offset:3752
    s_waitcnt lgkmcnt(7)
    v_mfma_f32_32x32x16_bf16 v[144:159], v[176:179], v[168:171], v[144:159]
    ds_read_b128 v[160:163], v13 offset:18640
    ds_read_b64 v[176:177], v12 offset:1600
    ds_read_b64 v[178:179], v12 offset:1608
    s_waitcnt lgkmcnt(8)
    v_mfma_f32_32x32x16_bf16 v[128:143], v[180:183], v[168:171], v[128:143]
    ds_read_b64 v[180:181], v12 offset:3648
    ds_read_b64 v[182:183], v12 offset:3656
    s_waitcnt lgkmcnt(7)
    v_mfma_f32_32x32x16_bf16 v[144:159], v[184:187], v[172:175], v[144:159]
    ds_read_b128 v[164:167], v13 offset:18672
    ds_read_b64 v[184:185], v12 offset:1632
    ds_read_b64 v[186:187], v12 offset:1640
    s_waitcnt lgkmcnt(8)
    v_mfma_f32_32x32x16_bf16 v[128:143], v[188:191], v[172:175], v[128:143]
    ds_read_b64 v[188:189], v12 offset:3680
    ds_read_b64 v[190:191], v12 offset:3688
    s_waitcnt lgkmcnt(7)
    v_mfma_f32_32x32x16_bf16 v[144:159], v[176:179], v[160:163], v[144:159]
    ds_read_b128 v[168:171], v13 offset:18560
    ds_read_b64 v[176:177], v12 offset:1536
    ds_read_b64 v[178:179], v12 offset:1544
    s_waitcnt lgkmcnt(8)
    v_mfma_f32_32x32x16_bf16 v[128:143], v[180:183], v[160:163], v[128:143]
    ds_read_b64 v[180:181], v12 offset:3584
    ds_read_b64 v[182:183], v12 offset:3592
    s_waitcnt lgkmcnt(7)
    v_mfma_f32_32x32x16_bf16 v[144:159], v[184:187], v[164:167], v[144:159]
    ds_read_b128 v[172:175], v13 offset:18592
    ds_read_b64 v[184:185], v12 offset:1568
    ds_read_b64 v[186:187], v12 offset:1576
    s_waitcnt lgkmcnt(8)
    v_mfma_f32_32x32x16_bf16 v[128:143], v[188:191], v[164:167], v[128:143]
    ds_read_b64 v[188:189], v12 offset:3616
    ds_read_b64 v[190:191], v12 offset:3624
    s_waitcnt lgkmcnt(7)
    v_mfma_f32_32x32x16_bf16 v[144:159], v[176:179], v[168:171], v[144:159]
    ds_read_b128 v[160:163], v13 offset:18480
    ds_read_b64 v[176:177], v12 offset:1472
    ds_read_b64 v[178:179], v12 offset:1480
    s_waitcnt lgkmcnt(8)
    v_mfma_f32_32x32x16_bf16 v[128:143], v[180:183], v[168:171], v[128:143]
    ds_read_b64 v[180:181], v12 offset:3520
    ds_read_b64 v[182:183], v12 offset:3528
    s_waitcnt lgkmcnt(7)
    v_mfma_f32_32x32x16_bf16 v[144:159], v[184:187], v[172:175], v[144:159]
    ds_read_b128 v[164:167], v13 offset:18512
    ds_read_b64 v[184:185], v12 offset:1504
    ds_read_b64 v[186:187], v12 offset:1512
    s_waitcnt lgkmcnt(8)
    v_mfma_f32_32x32x16_bf16 v[128:143], v[188:191], v[172:175], v[128:143]
    ds_read_b64 v[188:189], v12 offset:3552
    ds_read_b64 v[190:191], v12 offset:3560
    s_waitcnt lgkmcnt(7)
    v_mfma_f32_32x32x16_bf16 v[144:159], v[176:179], v[160:163], v[144:159]
    ds_read_b128 v[168:171], v13 offset:18400
    ds_read_b64 v[176:177], v12 offset:1408
    ds_read_b64 v[178:179], v12 offset:1416
    s_waitcnt lgkmcnt(8)
    v_mfma_f32_32x32x16_bf16 v[128:143], v[180:183], v[160:163], v[128:143]
    ds_read_b64 v[180:181], v12 offset:3456
    ds_read_b64 v[182:183], v12 offset:3464
    s_waitcnt lgkmcnt(7)
    v_mfma_f32_32x32x16_bf16 v[144:159], v[184:187], v[164:167], v[144:159]
    ds_read_b128 v[172:175], v13 offset:18432
    ds_read_b64 v[184:185], v12 offset:1440
    ds_read_b64 v[186:187], v12 offset:1448
    s_waitcnt lgkmcnt(8)
    v_mfma_f32_32x32x16_bf16 v[128:143], v[188:191], v[164:167], v[128:143]
    ds_read_b64 v[188:189], v12 offset:3488
    ds_read_b64 v[190:191], v12 offset:3496
    s_waitcnt lgkmcnt(7)
    v_mfma_f32_32x32x16_bf16 v[144:159], v[176:179], v[168:171], v[144:159]
    ds_read_b128 v[160:163], v13 offset:18320
    ds_read_b64 v[176:177], v12 offset:1344
    ds_read_b64 v[178:179], v12 offset:1352
    s_waitcnt lgkmcnt(8)
    v_mfma_f32_32x32x16_bf16 v[128:143], v[180:183], v[168:171], v[128:143]
    ds_read_b64 v[180:181], v12 offset:3392
    ds_read_b64 v[182:183], v12 offset:3400
    s_waitcnt lgkmcnt(7)
    v_mfma_f32_32x32x16_bf16 v[144:159], v[184:187], v[172:175], v[144:159]
    ds_read_b128 v[164:167], v13 offset:18352
    ds_read_b64 v[184:185], v12 offset:1376
    ds_read_b64 v[186:187], v12 offset:1384
    s_waitcnt lgkmcnt(8)
    v_mfma_f32_32x32x16_bf16 v[128:143], v[188:191], v[172:175], v[128:143]
    ds_read_b64 v[188:189], v12 offset:3424
    ds_read_b64 v[190:191], v12 offset:3432
    s_waitcnt lgkmcnt(7)
    v_mfma_f32_32x32x16_bf16 v[144:159], v[176:179], v[160:163], v[144:159]
    ds_read_b128 v[168:171], v13 offset:18240
    ds_read_b64 v[176:177], v12 offset:1280
    ds_read_b64 v[178:179], v12 offset:1288
    s_waitcnt lgkmcnt(8)
    v_mfma_f32_32x32x16_bf16 v[128:143], v[180:183], v[160:163], v[128:143]
    ds_read_b64 v[180:181], v12 offset:3328
    ds_read_b64 v[182:183], v12 offset:3336
    s_waitcnt lgkmcnt(7)
    v_mfma_f32_32x32x16_bf16 v[144:159], v[184:187], v[164:167], v[144:159]
    ds_read_b128 v[172:175], v13 offset:18272
    ds_read_b64 v[184:185], v12 offset:1312
    ds_read_b64 v[186:187], v12 offset:1320
    s_waitcnt lgkmcnt(8)
    v_mfma_f32_32x32x16_bf16 v[128:143], v[188:191], v[164:167], v[128:143]
    ds_read_b64 v[188:189], v12 offset:3360
    ds_read_b64 v[190:191], v12 offset:3368
    s_waitcnt lgkmcnt(7)
    v_mfma_f32_32x32x16_bf16 v[144:159], v[176:179], v[168:171], v[144:159]
    ds_read_b128 v[160:163], v13 offset:18160
    ds_read_b64 v[176:177], v12 offset:1216
    ds_read_b64 v[178:179], v12 offset:1224
    s_waitcnt lgkmcnt(8)
    v_mfma_f32_32x32x16_bf16 v[128:143], v[180:183], v[168:171], v[128:143]
    ds_read_b64 v[180:181], v12 offset:3264
    ds_read_b64 v[182:183], v12 offset:3272
    s_waitcnt lgkmcnt(7)
    v_mfma_f32_32x32x16_bf16 v[144:159], v[184:187], v[172:175], v[144:159]
    ds_read_b128 v[164:167], v13 offset:18192
    ds_read_b64 v[184:185], v12 offset:1248
    ds_read_b64 v[186:187], v12 offset:1256
    s_waitcnt lgkmcnt(8)
    v_mfma_f32_32x32x16_bf16 v[128:143], v[188:191], v[172:175], v[128:143]
    ds_read_b64 v[188:189], v12 offset:3296
    ds_read_b64 v[190:191], v12 offset:3304
    s_waitcnt lgkmcnt(7)
    v_mfma_f32_32x32x16_bf16 v[144:159], v[176:179], v[160:163], v[144:159]
    ds_read_b128 v[168:171], v13 offset:18080
    ds_read_b64 v[176:177], v12 offset:1152
    ds_read_b64 v[178:179], v12 offset:1160
    s_waitcnt lgkmcnt(8)
    v_mfma_f32_32x32x16_bf16 v[128:143], v[180:183], v[160:163], v[128:143]
    ds_read_b64 v[180:181], v12 offset:3200
    ds_read_b64 v[182:183], v12 offset:3208
    s_waitcnt lgkmcnt(7)
    v_mfma_f32_32x32x16_bf16 v[144:159], v[184:187], v[164:167], v[144:159]
    ds_read_b128 v[172:175], v13 offset:18112
    ds_read_b64 v[184:185], v12 offset:1184
    ds_read_b64 v[186:187], v12 offset:1192
    s_waitcnt lgkmcnt(8)
    v_mfma_f32_32x32x16_bf16 v[128:143], v[188:191], v[164:167], v[128:143]
    ds_read_b64 v[188:189], v12 offset:3232
    ds_read_b64 v[190:191], v12 offset:3240
    s_waitcnt lgkmcnt(7)
    v_mfma_f32_32x32x16_bf16 v[144:159], v[176:179], v[168:171], v[144:159]
    ds_read_b128 v[160:163], v13 offset:18000
    ds_read_b64 v[176:177], v12 offset:1088
    ds_read_b64 v[178:179], v12 offset:1096
    s_waitcnt lgkmcnt(8)
    v_mfma_f32_32x32x16_bf16 v[128:143], v[180:183], v[168:171], v[128:143]
    ds_read_b64 v[180:181], v12 offset:3136
    ds_read_b64 v[182:183], v12 offset:3144
    s_waitcnt lgkmcnt(7)
    v_mfma_f32_32x32x16_bf16 v[144:159], v[184:187], v[172:175], v[144:159]
    ds_read_b128 v[164:167], v13 offset:18032
    ds_read_b64 v[184:185], v12 offset:1120
    ds_read_b64 v[186:187], v12 offset:1128
    s_waitcnt lgkmcnt(8)
    v_mfma_f32_32x32x16_bf16 v[128:143], v[188:191], v[172:175], v[128:143]
    ds_read_b64 v[188:189], v12 offset:3168
    ds_read_b64 v[190:191], v12 offset:3176
    s_waitcnt lgkmcnt(7)
    v_mfma_f32_32x32x16_bf16 v[144:159], v[176:179], v[160:163], v[144:159]
    ds_read_b128 v[168:171], v13 offset:17920
    ds_read_b64 v[176:177], v12 offset:1024
    ds_read_b64 v[178:179], v12 offset:1032
    s_waitcnt lgkmcnt(8)
    v_mfma_f32_32x32x16_bf16 v[128:143], v[180:183], v[160:163], v[128:143]
    ds_read_b64 v[180:181], v12 offset:3072
    ds_read_b64 v[182:183], v12 offset:3080
    s_waitcnt lgkmcnt(7)
    v_mfma_f32_32x32x16_bf16 v[144:159], v[184:187], v[164:167], v[144:159]
    ds_read_b128 v[172:175], v13 offset:17952
    ds_read_b64 v[184:185], v12 offset:1056
    ds_read_b64 v[186:187], v12 offset:1064
    s_waitcnt lgkmcnt(8)
    v_mfma_f32_32x32x16_bf16 v[128:143], v[188:191], v[164:167], v[128:143]
    ds_read_b64 v[188:189], v12 offset:3104
    ds_read_b64 v[190:191], v12 offset:3112
    s_waitcnt lgkmcnt(7)
    v_mfma_f32_32x32x16_bf16 v[144:159], v[176:179], v[168:171], v[144:159]
    ds_read_b128 v[160:163], v13 offset:17840
    ds_read_b64 v[176:177], v12 offset:960
    ds_read_b64 v[178:179], v12 offset:968
    s_waitcnt lgkmcnt(8)
    v_mfma_f32_32x32x16_bf16 v[128:143], v[180:183], v[168:171], v[128:143]
    ds_read_b64 v[180:181], v12 offset:3008
    ds_read_b64 v[182:183], v12 offset:3016
    s_waitcnt lgkmcnt(7)
    v_mfma_f32_32x32x16_bf16 v[144:159], v[184:187], v[172:175], v[144:159]
    ds_read_b128 v[164:167], v13 offset:17872
    ds_read_b64 v[184:185], v12 offset:992
    ds_read_b64 v[186:187], v12 offset:1000
    s_waitcnt lgkmcnt(8)
    v_mfma_f32_32x32x16_bf16 v[128:143], v[188:191], v[172:175], v[128:143]
    ds_read_b64 v[188:189], v12 offset:3040
    ds_read_b64 v[190:191], v12 offset:3048
    s_waitcnt lgkmcnt(7)
    v_mfma_f32_32x32x16_bf16 v[144:159], v[176:179], v[160:163], v[144:159]
    ds_read_b128 v[168:171], v13 offset:17760
    ds_read_b64 v[176:177], v12 offset:896
    ds_read_b64 v[178:179], v12 offset:904
    s_waitcnt lgkmcnt(8)
    v_mfma_f32_32x32x16_bf16 v[128:143], v[180:183], v[160:163], v[128:143]
    ds_read_b64 v[180:181], v12 offset:2944
    ds_read_b64 v[182:183], v12 offset:2952
    s_waitcnt lgkmcnt(7)
    v_mfma_f32_32x32x16_bf16 v[144:159], v[184:187], v[164:167], v[144:159]
    ds_read_b128 v[172:175], v13 offset:17792
    ds_read_b64 v[184:185], v12 offset:928
    ds_read_b64 v[186:187], v12 offset:936
    s_waitcnt lgkmcnt(8)
    v_mfma_f32_32x32x16_bf16 v[128:143], v[188:191], v[164:167], v[128:143]
    ds_read_b64 v[188:189], v12 offset:2976
    ds_read_b64 v[190:191], v12 offset:2984
    s_waitcnt lgkmcnt(7)
    v_mfma_f32_32x32x16_bf16 v[144:159], v[176:179], v[168:171], v[144:159]
    ds_read_b128 v[160:163], v13 offset:17680
    ds_read_b64 v[176:177], v12 offset:832
    ds_read_b64 v[178:179], v12 offset:840
    s_waitcnt lgkmcnt(8)
    v_mfma_f32_32x32x16_bf16 v[128:143], v[180:183], v[168:171], v[128:143]
    ds_read_b64 v[180:181], v12 offset:2880
    ds_read_b64 v[182:183], v12 offset:2888
    s_waitcnt lgkmcnt(7)
    v_mfma_f32_32x32x16_bf16 v[144:159], v[184:187], v[172:175], v[144:159]
    ds_read_b128 v[164:167], v13 offset:17712
    ds_read_b64 v[184:185], v12 offset:864
    ds_read_b64 v[186:187], v12 offset:872
    s_waitcnt lgkmcnt(8)
    v_mfma_f32_32x32x16_bf16 v[128:143], v[188:191], v[172:175], v[128:143]
    ds_read_b64 v[188:189], v12 offset:2912
    ds_read_b64 v[190:191], v12 offset:2920
    s_waitcnt lgkmcnt(7)
    v_mfma_f32_32x32x16_bf16 v[144:159], v[176:179], v[160:163], v[144:159]
    ds_read_b128 v[168:171], v13 offset:17600
    ds_read_b64 v[176:177], v12 offset:768
    ds_read_b64 v[178:179], v12 offset:776
    s_waitcnt lgkmcnt(8)
    v_mfma_f32_32x32x16_bf16 v[128:143], v[180:183], v[160:163], v[128:143]
    ds_read_b64 v[180:181], v12 offset:2816
    ds_read_b64 v[182:183], v12 offset:2824
    s_waitcnt lgkmcnt(7)
    v_mfma_f32_32x32x16_bf16 v[144:159], v[184:187], v[164:167], v[144:159]
    ds_read_b128 v[172:175], v13 offset:17632
    ds_read_b64 v[184:185], v12 offset:800
    ds_read_b64 v[186:187], v12 offset:808
    s_waitcnt lgkmcnt(8)
    v_mfma_f32_32x32x16_bf16 v[128:143], v[188:191], v[164:167], v[128:143]
    ds_read_b64 v[188:189], v12 offset:2848
    ds_read_b64 v[190:191], v12 offset:2856
    s_waitcnt lgkmcnt(7)
    v_mfma_f32_32x32x16_bf16 v[144:159], v[176:179], v[168:171], v[144:159]
    ds_read_b128 v[160:163], v13 offset:17520
    ds_read_b64 v[176:177], v12 offset:704
    ds_read_b64 v[178:179], v12 offset:712
    s_waitcnt lgkmcnt(8)
    v_mfma_f32_32x32x16_bf16 v[128:143], v[180:183], v[168:171], v[128:143]
    ds_read_b64 v[180:181], v12 offset:2752
    ds_read_b64 v[182:183], v12 offset:2760
    s_waitcnt lgkmcnt(7)
    v_mfma_f32_32x32x16_bf16 v[144:159], v[184:187], v[172:175], v[144:159]
    ds_read_b128 v[164:167], v13 offset:17552
    ds_read_b64 v[184:185], v12 offset:736
    ds_read_b64 v[186:187], v12 offset:744
    s_waitcnt lgkmcnt(8)
    v_mfma_f32_32x32x16_bf16 v[128:143], v[188:191], v[172:175], v[128:143]
    ds_read_b64 v[188:189], v12 offset:2784
    ds_read_b64 v[190:191], v12 offset:2792
    s_waitcnt lgkmcnt(7)
    v_mfma_f32_32x32x16_bf16 v[144:159], v[176:179], v[160:163], v[144:159]
    ds_read_b128 v[168:171], v13 offset:17440
    ds_read_b64 v[176:177], v12 offset:640
    ds_read_b64 v[178:179], v12 offset:648
    s_waitcnt lgkmcnt(8)
    v_mfma_f32_32x32x16_bf16 v[128:143], v[180:183], v[160:163], v[128:143]
    ds_read_b64 v[180:181], v12 offset:2688
    ds_read_b64 v[182:183], v12 offset:2696
    s_waitcnt lgkmcnt(7)
    v_mfma_f32_32x32x16_bf16 v[144:159], v[184:187], v[164:167], v[144:159]
    ds_read_b128 v[172:175], v13 offset:17472
    ds_read_b64 v[184:185], v12 offset:672
    ds_read_b64 v[186:187], v12 offset:680
    s_waitcnt lgkmcnt(8)
    v_mfma_f32_32x32x16_bf16 v[128:143], v[188:191], v[164:167], v[128:143]
    ds_read_b64 v[188:189], v12 offset:2720
    ds_read_b64 v[190:191], v12 offset:2728
    s_waitcnt lgkmcnt(7)
    v_mfma_f32_32x32x16_bf16 v[144:159], v[176:179], v[168:171], v[144:159]
    ds_read_b128 v[160:163], v13 offset:17360
    ds_read_b64 v[176:177], v12 offset:576
    ds_read_b64 v[178:179], v12 offset:584
    s_waitcnt lgkmcnt(8)
    v_mfma_f32_32x32x16_bf16 v[128:143], v[180:183], v[168:171], v[128:143]
    ds_read_b64 v[180:181], v12 offset:2624
    ds_read_b64 v[182:183], v12 offset:2632
    s_waitcnt lgkmcnt(7)
    v_mfma_f32_32x32x16_bf16 v[144:159], v[184:187], v[172:175], v[144:159]
    ds_read_b128 v[164:167], v13 offset:17392
    ds_read_b64 v[184:185], v12 offset:608
    ds_read_b64 v[186:187], v12 offset:616
    s_waitcnt lgkmcnt(8)
    v_mfma_f32_32x32x16_bf16 v[128:143], v[188:191], v[172:175], v[128:143]
    ds_read_b64 v[188:189], v12 offset:2656
    ds_read_b64 v[190:191], v12 offset:2664
    s_waitcnt lgkmcnt(7)
    v_mfma_f32_32x32x16_bf16 v[144:159], v[176:179], v[160:163], v[144:159]
    ds_read_b128 v[168:171], v13 offset:17280
    ds_read_b64 v[176:177], v12 offset:512
    ds_read_b64 v[178:179], v12 offset:520
    s_waitcnt lgkmcnt(8)
    v_mfma_f32_32x32x16_bf16 v[128:143], v[180:183], v[160:163], v[128:143]
    ds_read_b64 v[180:181], v12 offset:2560
    ds_read_b64 v[182:183], v12 offset:2568
    s_waitcnt lgkmcnt(7)
    v_mfma_f32_32x32x16_bf16 v[144:159], v[184:187], v[164:167], v[144:159]
    ds_read_b128 v[172:175], v13 offset:17312
    ds_read_b64 v[184:185], v12 offset:544
    ds_read_b64 v[186:187], v12 offset:552
    s_waitcnt lgkmcnt(8)
    v_mfma_f32_32x32x16_bf16 v[128:143], v[188:191], v[164:167], v[128:143]
    ds_read_b64 v[188:189], v12 offset:2592
    ds_read_b64 v[190:191], v12 offset:2600
    s_waitcnt lgkmcnt(7)
    v_mfma_f32_32x32x16_bf16 v[144:159], v[176:179], v[168:171], v[144:159]
    ds_read_b128 v[160:163], v13 offset:17200
    ds_read_b64 v[176:177], v12 offset:448
    ds_read_b64 v[178:179], v12 offset:456
    s_waitcnt lgkmcnt(8)
    v_mfma_f32_32x32x16_bf16 v[128:143], v[180:183], v[168:171], v[128:143]
    ds_read_b64 v[180:181], v12 offset:2496
    ds_read_b64 v[182:183], v12 offset:2504
    s_waitcnt lgkmcnt(7)
    v_mfma_f32_32x32x16_bf16 v[144:159], v[184:187], v[172:175], v[144:159]
    ds_read_b128 v[164:167], v13 offset:17232
    ds_read_b64 v[184:185], v12 offset:480
    ds_read_b64 v[186:187], v12 offset:488
    s_waitcnt lgkmcnt(8)
    v_mfma_f32_32x32x16_bf16 v[128:143], v[188:191], v[172:175], v[128:143]
    ds_read_b64 v[188:189], v12 offset:2528
    ds_read_b64 v[190:191], v12 offset:2536
    s_waitcnt lgkmcnt(7)
    v_mfma_f32_32x32x16_bf16 v[144:159], v[176:179], v[160:163], v[144:159]
    ds_read_b128 v[168:171], v13 offset:17120
    ds_read_b64 v[176:177], v12 offset:384
    ds_read_b64 v[178:179], v12 offset:392
    s_waitcnt lgkmcnt(8)
    v_mfma_f32_32x32x16_bf16 v[128:143], v[180:183], v[160:163], v[128:143]
    ds_read_b64 v[180:181], v12 offset:2432
    ds_read_b64 v[182:183], v12 offset:2440
    s_waitcnt lgkmcnt(7)
    v_mfma_f32_32x32x16_bf16 v[144:159], v[184:187], v[164:167], v[144:159]
    ds_read_b128 v[172:175], v13 offset:17152
    ds_read_b64 v[184:185], v12 offset:416
    ds_read_b64 v[186:187], v12 offset:424
    s_waitcnt lgkmcnt(8)
    v_mfma_f32_32x32x16_bf16 v[128:143], v[188:191], v[164:167], v[128:143]
    ds_read_b64 v[188:189], v12 offset:2464
    ds_read_b64 v[190:191], v12 offset:2472
    s_waitcnt lgkmcnt(7)
    v_mfma_f32_32x32x16_bf16 v[144:159], v[176:179], v[168:171], v[144:159]
    ds_read_b128 v[160:163], v13 offset:17040
    ds_read_b64 v[176:177], v12 offset:320
    ds_read_b64 v[178:179], v12 offset:328
    s_waitcnt lgkmcnt(8)
    v_mfma_f32_32x32x16_bf16 v[128:143], v[180:183], v[168:171], v[128:143]
    ds_read_b64 v[180:181], v12 offset:2368
    ds_read_b64 v[182:183], v12 offset:2376
    s_waitcnt lgkmcnt(7)
    v_mfma_f32_32x32x16_bf16 v[144:159], v[184:187], v[172:175], v[144:159]
    ds_read_b128 v[164:167], v13 offset:17072
    ds_read_b64 v[184:185], v12 offset:352
    ds_read_b64 v[186:187], v12 offset:360
    s_waitcnt lgkmcnt(8)
    v_mfma_f32_32x32x16_bf16 v[128:143], v[188:191], v[172:175], v[128:143]
    ds_read_b64 v[188:189], v12 offset:2400
    ds_read_b64 v[190:191], v12 offset:2408
    s_waitcnt lgkmcnt(7)
    v_mfma_f32_32x32x16_bf16 v[144:159], v[176:179], v[160:163], v[144:159]
    ds_read_b128 v[168:171], v13 offset:16960
    ds_read_b64 v[176:177], v12 offset:256
    ds_read_b64 v[178:179], v12 offset:264
    s_waitcnt lgkmcnt(8)
    v_mfma_f32_32x32x16_bf16 v[128:143], v[180:183], v[160:163], v[128:143]
    ds_read_b64 v[180:181], v12 offset:2304
    ds_read_b64 v[182:183], v12 offset:2312
    s_waitcnt lgkmcnt(7)
    v_mfma_f32_32x32x16_bf16 v[144:159], v[184:187], v[164:167], v[144:159]
    ds_read_b128 v[172:175], v13 offset:16992
    ds_read_b64 v[184:185], v12 offset:288
    ds_read_b64 v[186:187], v12 offset:296
    s_waitcnt lgkmcnt(8)
    v_mfma_f32_32x32x16_bf16 v[128:143], v[188:191], v[164:167], v[128:143]
    ds_read_b64 v[188:189], v12 offset:2336
    ds_read_b64 v[190:191], v12 offset:2344
    s_waitcnt lgkmcnt(7)
    v_mfma_f32_32x32x16_bf16 v[144:159], v[176:179], v[168:171], v[144:159]
    ds_read_b128 v[160:163], v13 offset:16880
    ds_read_b64 v[176:177], v12 offset:192
    ds_read_b64 v[178:179], v12 offset:200
    s_waitcnt lgkmcnt(8)
    v_mfma_f32_32x32x16_bf16 v[128:143], v[180:183], v[168:171], v[128:143]
    ds_read_b64 v[180:181], v12 offset:2240
    ds_read_b64 v[182:183], v12 offset:2248
    s_waitcnt lgkmcnt(7)
    v_mfma_f32_32x32x16_bf16 v[144:159], v[184:187], v[172:175], v[144:159]
    ds_read_b128 v[164:167], v13 offset:16912
    ds_read_b64 v[184:185], v12 offset:224
    ds_read_b64 v[186:187], v12 offset:232
    s_waitcnt lgkmcnt(8)
    v_mfma_f32_32x32x16_bf16 v[128:143], v[188:191], v[172:175], v[128:143]
    ds_read_b64 v[188:189], v12 offset:2272
    ds_read_b64 v[190:191], v12 offset:2280
    s_waitcnt lgkmcnt(7)
    v_mfma_f32_32x32x16_bf16 v[144:159], v[176:179], v[160:163], v[144:159]
    ds_read_b128 v[168:171], v13 offset:16800
    ds_read_b64 v[176:177], v12 offset:128
    ds_read_b64 v[178:179], v12 offset:136
    s_waitcnt lgkmcnt(8)
    v_mfma_f32_32x32x16_bf16 v[128:143], v[180:183], v[160:163], v[128:143]
    ds_read_b64 v[180:181], v12 offset:2176
    ds_read_b64 v[182:183], v12 offset:2184
    s_waitcnt lgkmcnt(7)
    v_mfma_f32_32x32x16_bf16 v[144:159], v[184:187], v[164:167], v[144:159]
    ds_read_b128 v[172:175], v13 offset:16832
    ds_read_b64 v[184:185], v12 offset:160
    ds_read_b64 v[186:187], v12 offset:168
    s_waitcnt lgkmcnt(8)
    v_mfma_f32_32x32x16_bf16 v[128:143], v[188:191], v[164:167], v[128:143]
    ds_read_b64 v[188:189], v12 offset:2208
    ds_read_b64 v[190:191], v12 offset:2216
    s_waitcnt lgkmcnt(7)
    v_mfma_f32_32x32x16_bf16 v[144:159], v[176:179], v[168:171], v[144:159]
    ds_read_b128 v[160:163], v13 offset:16720
    ds_read_b64 v[176:177], v12 offset:64
    ds_read_b64 v[178:179], v12 offset:72
    s_waitcnt lgkmcnt(8)
    v_mfma_f32_32x32x16_bf16 v[128:143], v[180:183], v[168:171], v[128:143]
    ds_read_b64 v[180:181], v12 offset:2112
    ds_read_b64 v[182:183], v12 offset:2120
    s_waitcnt lgkmcnt(7)
    v_mfma_f32_32x32x16_bf16 v[144:159], v[184:187], v[172:175], v[144:159]
    ds_read_b128 v[164:167], v13 offset:16752
    ds_read_b64 v[184:185], v12 offset:96
    ds_read_b64 v[186:187], v12 offset:104
    s_waitcnt lgkmcnt(8)
    v_mfma_f32_32x32x16_bf16 v[128:143], v[188:191], v[172:175], v[128:143]
    ds_read_b64 v[188:189], v12 offset:2144
    ds_read_b64 v[190:191], v12 offset:2152
    s_waitcnt lgkmcnt(7)
    v_mfma_f32_32x32x16_bf16 v[144:159], v[176:179], v[160:163], v[144:159]
    ds_read_b128 v[168:171], v13 offset:16640
    ds_read_b64 v[176:177], v12 offset:0
    ds_read_b64 v[178:179], v12 offset:8
    s_waitcnt lgkmcnt(8)
    v_mfma_f32_32x32x16_bf16 v[128:143], v[180:183], v[160:163], v[128:143]
    ds_read_b64 v[180:181], v12 offset:2048
    ds_read_b64 v[182:183], v12 offset:2056
    s_waitcnt lgkmcnt(7)
    v_mfma_f32_32x32x16_bf16 v[144:159], v[184:187], v[164:167], v[144:159]
    ds_read_b128 v[172:175], v13 offset:16672
    ds_read_b64 v[184:185], v12 offset:32
    ds_read_b64 v[186:187], v12 offset:40
    s_waitcnt lgkmcnt(8)
    v_mfma_f32_32x32x16_bf16 v[128:143], v[188:191], v[164:167], v[128:143]
    ds_read_b64 v[188:189], v12 offset:2080
    ds_read_b64 v[190:191], v12 offset:2088
    s_waitcnt lgkmcnt(7)
    v_mfma_f32_32x32x16_bf16 v[144:159], v[176:179], v[168:171], v[144:159]
    s_waitcnt lgkmcnt(5)
    v_mfma_f32_32x32x16_bf16 v[128:143], v[180:183], v[168:171], v[128:143]
    s_waitcnt lgkmcnt(2)
    v_mfma_f32_32x32x16_bf16 v[144:159], v[184:187], v[172:175], v[144:159]
    s_waitcnt lgkmcnt(0)
    v_mfma_f32_32x32x16_bf16 v[128:143], v[188:191], v[172:175], v[128:143]
    v_mov_b32 v16, v22
    v_mov_b32 v17, v23
    v_mov_b32 v18, v24
    v_mov_b32 v19, v25
    v_mov_b32 v20, v26
    v_mov_b32 v21, v27
    v_mov_b32 v22, v28
    v_mov_b32 v23, v29
    v_mov_b32 v24, v30
    v_mov_b32 v25, v31
    v_mov_b32 v26, v32
    v_mov_b32 v27, v33
    v_mov_b32 v28, v34
    v_mov_b32 v29, v35
    v_mov_b32 v30, v36
    v_mov_b32 v31, v37
    v_mov_b32 v32, v38
    v_mov_b32 v33, v39
    v_cvt_pk_bf16_f32 v2, v128, v129
    v_perm_b32 v192, v2, v192, s70
    v_perm_b32 v194, v2, v194, s71
    v_cvt_pk_bf16_f32 v2, v130, v131
    v_perm_b32 v196, v2, v196, s70
    v_perm_b32 v198, v2, v198, s71
    v_cvt_pk_bf16_f32 v2, v132, v133
    v_perm_b32 v200, v2, v200, s70
    v_perm_b32 v202, v2, v202, s71
    v_cvt_pk_bf16_f32 v2, v134, v135
    v_perm_b32 v204, v2, v204, s70
    v_perm_b32 v206, v2, v206, s71
    v_cvt_pk_bf16_f32 v2, v136, v137
    v_perm_b32 v208, v2, v208, s70
    v_perm_b32 v210, v2, v210, s71
    v_cvt_pk_bf16_f32 v2, v138, v139
    v_perm_b32 v212, v2, v212, s70
    v_perm_b32 v214, v2, v214, s71
    v_cvt_pk_bf16_f32 v2, v140, v141
    v_perm_b32 v216, v2, v216, s70
    v_perm_b32 v218, v2, v218, s71
    v_cvt_pk_bf16_f32 v2, v142, v143
    v_perm_b32 v220, v2, v220, s70
    v_perm_b32 v222, v2, v222, s71
    v_cvt_pk_bf16_f32 v2, v144, v145
    v_perm_b32 v224, v2, v224, s70
    v_perm_b32 v226, v2, v226, s71
    v_cvt_pk_bf16_f32 v2, v146, v147
    v_perm_b32 v228, v2, v228, s70
    v_perm_b32 v230, v2, v230, s71
    v_cvt_pk_bf16_f32 v2, v148, v149
    v_perm_b32 v232, v2, v232, s70
    v_perm_b32 v234, v2, v234, s71
    v_cvt_pk_bf16_f32 v2, v150, v151
    v_perm_b32 v236, v2, v236, s70
    v_perm_b32 v238, v2, v238, s71
    v_cvt_pk_bf16_f32 v2, v152, v153
    v_perm_b32 v240, v2, v240, s70
    v_perm_b32 v242, v2, v242, s71
    v_cvt_pk_bf16_f32 v2, v154, v155
    v_perm_b32 v244, v2, v244, s70
    v_perm_b32 v246, v2, v246, s71
    v_cvt_pk_bf16_f32 v2, v156, v157
    v_perm_b32 v248, v2, v248, s70
    v_perm_b32 v250, v2, v250, s71
    v_cvt_pk_bf16_f32 v2, v158, v159
    v_perm_b32 v252, v2, v252, s70
    v_perm_b32 v254, v2, v254, s71
    s_lshr_b64 s[64:65], s[64:65], 16
    s_lshr_b64 s[66:67], s[66:67], 16
    s_bitcmp1_b32 s63, 0
    s_cbranch_scc0 Ls_noswap
    v_swap_b32 v192, v193
    v_swap_b32 v194, v195
    v_swap_b32 v196, v197
    v_swap_b32 v198, v199
    v_swap_b32 v200, v201
    v_swap_b32 v202, v203
    v_swap_b32 v204, v205
    v_swap_b32 v206, v207
    v_swap_b32 v208, v209
    v_swap_b32 v210, v211
    v_swap_b32 v212, v213
    v_swap_b32 v214, v215
    v_swap_b32 v216, v217
    v_swap_b32 v218, v219
    v_swap_b32 v220, v221
    v_swap_b32 v222, v223
    v_swap_b32 v224, v225
    v_swap_b32 v226, v227
    v_swap_b32 v228, v229
    v_swap_b32 v230, v231
    v_swap_b32 v232, v233
    v_swap_b32 v234, v235
    v_swap_b32 v236, v237
    v_swap_b32 v238, v239
    v_swap_b32 v240, v241
    v_swap_b32 v242, v243
    v_swap_b32 v244, v245
    v_swap_b32 v246, v247
    v_swap_b32 v248, v249
    v_swap_b32 v250, v251
    v_swap_b32 v252, v253
    v_swap_b32 v254, v255
Ls_noswap:
    s_add_u32 s63, s63, 1
    s_cmp_lt_u32 s63, 4
    s_cbranch_scc1 Ls_chan
    s_barrier
    v_mul_u32_u24 v2, 1040, v4
    v_lshl_add_u32 v2, v5, 7, v2
    s_lshl_b32 s61, s4, 3
    v_add_u32 v2, s61, v2
    ds_write_b64 v2, v[192:193] offset:0
    ds_write_b64 v2, v[194:195] offset:32
    ds_write_b64 v2, v[196:197] offset:64
    ds_write_b64 v2, v[198:199] offset:96
    ds_write_b64 v2, v[200:201] offset:256
    ds_write_b64 v2, v[202:203] offset:288
    ds_write_b64 v2, v[204:205] offset:320
    ds_write_b64 v2, v[206:207] offset:352
    ds_write_b64 v2, v[208:209] offset:512
    ds_write_b64 v2, v[210:211] offset:544
    ds_write_b64 v2, v[212:213] offset:576
    ds_write_b64 v2, v[214:215] offset:608
    ds_write_b64 v2, v[216:217] offset:768
    ds_write_b64 v2, v[218:219] offset:800
    ds_write_b64 v2, v[220:221] offset:832
    ds_write_b64 v2, v[222:223] offset:864
    ds_write_b64 v2, v[224:225] offset:33280
    ds_write_b64 v2, v[226:227] offset:33312
    ds_write_b64 v2, v[228:229] offset:33344
    ds_write_b64 v2, v[230:231] offset:33376
    ds_write_b64 v2, v[232:233] offset:33536
    ds_write_b64 v2, v[234:235] offset:33568
    ds_write_b64 v2, v[236:237] offset:33600
    ds_write_b64 v2, v[238:239] offset:33632
    ds_write_b64 v2, v[240:241] offset:33792
    ds_write_b64 v2, v[242:243] offset:33824
    ds_write_b64 v2, v[244:245] offset:33856
    ds_write_b64 v2, v[246:247] offset:33888
    ds_write_b64 v2, v[248:249] offset:34048
    ds_write_b64 v2, v[250:251] offset:34080
    ds_write_b64 v2, v[252:253] offset:34112
    ds_write_b64 v2, v[254:255] offset:34144
    s_mul_i32 s61, s4, 16640
    v_lshl_add_u32 v3, v0, 4, s61
    v_lshrrev_b32 v4, 1, v0
    v_and_b32 v5, 1, v0
    v_lshlrev_b32 v5, 4, v5
    v_lshl_add_u32 v4, v4, 12, v5
    s_lshr_b32 s61, s60, 2
    s_lshl_b32 s61, s61, 5
    s_lshl_b32 s62, s4, 21
    s_add_u32 s61, s61, s62
    s_add_u32 s61, s61, 2048
    s_waitcnt lgkmcnt(0)
    s_barrier
    ds_read_b128 v[76:79], v3 offset:0
    ds_read_b128 v[80:83], v3 offset:1040
    ds_read_b128 v[84:87], v3 offset:2080
    ds_read_b128 v[88:91], v3 offset:3120
    ds_read_b128 v[92:95], v3 offset:4160
    ds_read_b128 v[96:99], v3 offset:5200
    ds_read_b128 v[100:103], v3 offset:6240
    ds_read_b128 v[104:107], v3 offset:7280
    s_waitcnt lgkmcnt(7)
    s_add_u32 s62, s61, 0
    buffer_store_dwordx4 v[76:79], v4, s[56:59], s62 offen
    s_waitcnt lgkmcnt(6)
    s_add_u32 s62, s61, 131072
    buffer_store_dwordx4 v[80:83], v4, s[56:59], s62 offen
    s_waitcnt lgkmcnt(5)
    s_add_u32 s62, s61, 262144
    buffer_store_dwordx4 v[84:87], v4, s[56:59], s62 offen
    s_waitcnt lgkmcnt(4)
    s_add_u32 s62, s61, 393216
    buffer_store_dwordx4 v[88:91], v4, s[56:59], s62 offen
    s_waitcnt lgkmcnt(3)
    s_add_u32 s62, s61, 524288
    buffer_store_dwordx4 v[92:95], v4, s[56:59], s62 offen
    s_waitcnt lgkmcnt(2)
    s_add_u32 s62, s61, 655360
    buffer_store_dwordx4 v[96:99], v4, s[56:59], s62 offen
    s_waitcnt lgkmcnt(1)
    s_add_u32 s62, s61, 786432
    buffer_store_dwordx4 v[100:103], v4, s[56:59], s62 offen
    s_waitcnt lgkmcnt(0)
    s_add_u32 s62, s61, 917504
    buffer_store_dwordx4 v[104:107], v4, s[56:59], s62 offen
    s_waitcnt vmcnt(0)
    ds_read_b128 v[76:79], v3 offset:8320
    ds_read_b128 v[80:83], v3 offset:9360
    ds_read_b128 v[84:87], v3 offset:10400
    ds_read_b128 v[88:91], v3 offset:11440
    ds_read_b128 v[92:95], v3 offset:12480
    ds_read_b128 v[96:99], v3 offset:13520
    ds_read_b128 v[100:103], v3 offset:14560
    ds_read_b128 v[104:107], v3 offset:15600
    s_waitcnt lgkmcnt(7)
    s_add_u32 s62, s61, 1048576
    buffer_store_dwordx4 v[76:79], v4, s[56:59], s62 offen
    s_waitcnt lgkmcnt(6)
    s_add_u32 s62, s61, 1179648
    buffer_store_dwordx4 v[80:83], v4, s[56:59], s62 offen
    s_waitcnt lgkmcnt(5)
    s_add_u32 s62, s61, 1310720
    buffer_store_dwordx4 v[84:87], v4, s[56:59], s62 offen
    s_waitcnt lgkmcnt(4)
    s_add_u32 s62, s61, 1441792
    buffer_store_dwordx4 v[88:91], v4, s[56:59], s62 offen
    s_waitcnt lgkmcnt(3)
    s_add_u32 s62, s61, 1572864
    buffer_store_dwordx4 v[92:95], v4, s[56:59], s62 offen
    s_waitcnt lgkmcnt(2)
    s_add_u32 s62, s61, 1703936
    buffer_store_dwordx4 v[96:99], v4, s[56:59], s62 offen
    s_waitcnt lgkmcnt(1)
    s_add_u32 s62, s61, 1835008
    buffer_store_dwordx4 v[100:103], v4, s[56:59], s62 offen
    s_waitcnt lgkmcnt(0)
    s_add_u32 s62, s61, 1966080
    buffer_store_dwordx4 v[104:107], v4, s[56:59], s62 offen
    s_endpgm
.section .rodata,"a"
.p2align 6
.amdhsa_kernel concat_heads__memory_aug_recurrent_mem_tr__ssm_conv_s4__prompt_kernel
  .amdhsa_next_free_vgpr 512
  .amdhsa_next_free_sgpr 102
  .amdhsa_accum_offset 256
  .amdhsa_group_segment_fixed_size 0
  .amdhsa_kernarg_size 152
  .amdhsa_user_sgpr_count 2
  .amdhsa_user_sgpr_kernarg_segment_ptr 1
  .amdhsa_system_sgpr_workgroup_id_x 1
  .amdhsa_float_denorm_mode_32 3
.end_amdhsa_kernel
```

```asm
; @launch grid=(256,1,1) block=(256,1,1) lds=163840
.amdgcn_target "amdgcn-amd-amdhsa--gfx950"
.text
.globl concat_heads__memory_aug_recurrent_mem_tr__ssm_conv_s4__prompt_kernel
.p2align 8
.type concat_heads__memory_aug_recurrent_mem_tr__ssm_conv_s4__prompt_kernel,@function
concat_heads__memory_aug_recurrent_mem_tr__ssm_conv_s4__prompt_kernel:
 s_cmp_ge_u32 s2, 256
 s_cbranch_scc1 L_exit
 s_load_dwordx4 s[40:43], s[0:1], 128
 s_load_dwordx2 s[44:45], s[0:1], 144
 s_load_dwordx16 s[8:23], s[0:1], 0
 s_load_dwordx16 s[24:39], s[0:1], 64
 s_getreg_b32 s5, hwreg(HW_REG_XCC_ID, 0, 3)
 v_lshrrev_b32 v1, 6, v0
 s_nop 0
 v_readfirstlane_b32 s4, v1
 v_and_b32 v0, 63, v0
 s_mov_b32 s46, 400000
 s_lshl_b32 s7, s5, 5
 v_mov_b32 v1, s7
 v_mov_b32 v2, 1
 v_mov_b32 v3, 0
 v_mov_b32 v4, 0
 s_waitcnt lgkmcnt(0)
 s_cmp_eq_u32 s4, 0
 s_cbranch_scc0 L_no_ticket
 s_mov_b64 exec, 1
 global_atomic_add v3, v1, v2, s[42:43] sc0 sc1
 s_waitcnt vmcnt(0)
 ds_write_b32 v4, v3
 s_waitcnt lgkmcnt(0)
 s_mov_b64 exec, -1
L_no_ticket:
 s_barrier
 ds_read_b32 v3, v4
 s_waitcnt lgkmcnt(0)
 v_readfirstlane_b32 s6, v3
 s_barrier
 s_mov_b32 s48, s44
 s_and_b32 s49, s45, 0xffff
 s_mov_b32 s50, 268435456
 s_mov_b32 s51, 0x20000
 s_cmp_ge_u32 s6, 32
 s_cbranch_scc1 L_exit
 s_and_b32 s47, s5, 3
 s_cmp_lt_u32 s5, 4
 s_cbranch_scc1 L_chain
 s_branch L_worker
L_exit:
 s_endpgm
L_chain:
 v_lshlrev_b32 v233, 3, v0
 v_lshlrev_b32 v2, 4, v0
 v_lshrrev_b32 v30, 4, v0
 v_and_b32 v31, 7, v0
 v_bfe_u32 v29, v0, 3, 1
 v_lshlrev_b32 v3, 4, v31
 v_lshl_add_u32 v3, v30, 10, v3
 v_lshl_add_u32 v4, v29, 3, v3
 s_lshl_b32 s81, s47, 5
 s_add_u32 s81, s81, s6
 s_lshl_b32 s79, s81, 11
 s_add_u32 s67, s79, 2359296
 s_add_u32 s76, s79, 16777216
 s_lshr_b32 s79, s81, 2
 s_lshl_b32 s79, s79, 7
 s_and_b32 s80, s81, 3
 s_lshl_b32 s80, s80, 4
 s_add_u32 s78, s79, s80
 s_add_u32 s78, s78, 3145728
 s_lshr_b32 s79, s6, 1
 s_lshl_b32 s79, s79, 14
 s_and_b32 s80, s6, 1
 s_lshl_b32 s80, s80, 12
 s_add_u32 s71, s79, s80
 s_lshl_b32 s79, s47, 10
 s_add_u32 s71, s71, s79
 s_lshl_b32 s79, s47, 15
 s_lshr_b32 s80, s6, 3
 s_lshl_b32 s80, s80, 12
 s_add_u32 s66, s79, s80
 s_and_b32 s80, s6, 7
 s_lshl_b32 s80, s80, 7
 s_add_u32 s66, s66, s80
 v_mov_b32 v92, -1
 v_mov_b32 v93, -1
 v_mov_b32 v94, -1
 v_mov_b32 v95, -1
 s_cmp_eq_u32 s4, 0
 s_cbranch_scc0 Lc_noinit
 s_add_u32 s79, s66, 2097152
 buffer_store_dwordx2 v[92:93], v4, s[48:51], s79 offen
 s_add_u32 s79, s66, 2113536
 buffer_store_dwordx2 v[92:93], v4, s[48:51], s79 offen
 s_add_u32 s79, s66, 2228224
 buffer_store_dwordx2 v[92:93], v4, s[48:51], s79 offen
 s_add_u32 s79, s66, 2244608
 buffer_store_dwordx2 v[92:93], v4, s[48:51], s79 offen
 buffer_store_dwordx4 v[92:95], v2, s[48:51], s67 offen
 buffer_store_dwordx4 v[92:95], v2, s[48:51], s67 offen offset:1024
 s_add_u32 s79, s71, 134217728
 buffer_store_dwordx4 v[92:95], v2, s[48:51], s79 offen sc1
 s_add_u32 s79, s71, 134225920
 buffer_store_dwordx4 v[92:95], v2, s[48:51], s79 offen sc1
 v_mov_b32 v10, 0
 v_mov_b32 v11, 4096
 s_mov_b64 exec, 1
 buffer_store_dword v10, v11, s[48:51], s78 offen sc1
 s_mov_b64 exec, -1
 s_waitcnt vmcnt(0)
 v_mov_b32 v10, 0
 v_mov_b32 v11, 1
 s_mov_b64 exec, 1
 global_atomic_add v11, v10, v11, s[42:43] offset:4 sc0 sc1
 s_waitcnt vmcnt(0)
 v_readfirstlane_b32 s7, v11
 s_nop 0
 s_cmp_eq_u32 s7, 127
 s_cbranch_scc0 arr_1
 v_mov_b32 v11, 1
 global_atomic_or v10, v11, s[42:43] offset:132 sc1
arr_1:
 s_mov_b64 exec, -1
Lc_noinit:
 v_bfe_u32 v19, v0, 2, 3
 v_and_b32 v20, 32, v0
 v_add_u32 v19, v19, v20
 v_and_b32 v20, 3, v0
 v_lshlrev_b32 v20, 4, v20
 v_lshl_add_u32 v16, v19, 13, v20
 v_lshl_add_u32 v17, v19, 11, v20
 v_lshrrev_b32 v21, 5, v0
 v_lshlrev_b32 v21, 4, v21
 v_bfe_u32 v22, v0, 4, 1
 v_lshl_add_u32 v21, v22, 2, v21
 v_bfe_u32 v22, v0, 2, 1
 v_add_u32 v21, v21, v22
 v_bfe_u32 v22, v0, 3, 1
 v_lshl_add_u32 v21, v22, 3, v21
 v_lshl_add_u32 v18, v21, 6, v20
 s_mul_i32 s65, s4, 40960
 v_add_u32 v18, s65, v18
 s_lshl_b32 s63, s4, 21
 s_lshl_b32 s7, s47, 5
 s_add_u32 s7, s7, s6
 s_lshl_b32 s7, s7, 6
 s_add_u32 s63, s63, s7
 s_lshl_b32 s64, s47, 2
 s_add_u32 s64, s64, s4
 s_lshl_b32 s64, s64, 19
 s_lshl_b32 s7, s6, 6
 s_add_u32 s64, s64, s7
 s_mov_b32 s52, s14
 s_and_b32 s53, s15, 0xffff
 s_mov_b32 s54, 8388608
 s_mov_b32 s55, 0x20000
 s_add_u32 m0, s65, 0
 s_add_u32 s7, s63, 0
 buffer_load_dwordx4 v16, s[52:55], s7 offen nt lds
 s_add_u32 m0, s65, 1024
 s_add_u32 s7, s63, 524288
 buffer_load_dwordx4 v16, s[52:55], s7 offen nt lds
 s_add_u32 m0, s65, 2048
 s_add_u32 s7, s63, 1048576
 buffer_load_dwordx4 v16, s[52:55], s7 offen nt lds
 s_add_u32 m0, s65, 3072
 s_add_u32 s7, s63, 1572864
 buffer_load_dwordx4 v16, s[52:55], s7 offen nt lds
 s_add_u32 m0, s65, 4096
 s_add_u32 s7, s63, 65536
 buffer_load_dwordx4 v16, s[52:55], s7 offen nt lds
 s_add_u32 m0, s65, 5120
 s_add_u32 s7, s63, 589824
 buffer_load_dwordx4 v16, s[52:55], s7 offen nt lds
 s_add_u32 m0, s65, 6144
 s_add_u32 s7, s63, 1114112
 buffer_load_dwordx4 v16, s[52:55], s7 offen nt lds
 s_add_u32 m0, s65, 7168
 s_add_u32 s7, s63, 1638400
 buffer_load_dwordx4 v16, s[52:55], s7 offen nt lds
 s_add_u32 m0, s65, 8192
 s_add_u32 s7, s63, 131072
 buffer_load_dwordx4 v16, s[52:55], s7 offen nt lds
 s_add_u32 m0, s65, 9216
 s_add_u32 s7, s63, 655360
 buffer_load_dwordx4 v16, s[52:55], s7 offen nt lds
 s_add_u32 m0, s65, 10240
 s_add_u32 s7, s63, 1179648
 buffer_load_dwordx4 v16, s[52:55], s7 offen nt lds
 s_add_u32 m0, s65, 11264
 s_add_u32 s7, s63, 1703936
 buffer_load_dwordx4 v16, s[52:55], s7 offen nt lds
 s_add_u32 m0, s65, 12288
 s_add_u32 s7, s63, 196608
 buffer_load_dwordx4 v16, s[52:55], s7 offen nt lds
 s_add_u32 m0, s65, 13312
 s_add_u32 s7, s63, 720896
 buffer_load_dwordx4 v16, s[52:55], s7 offen nt lds
 s_add_u32 m0, s65, 14336
 s_add_u32 s7, s63, 1245184
 buffer_load_dwordx4 v16, s[52:55], s7 offen nt lds
 s_add_u32 m0, s65, 15360
 s_add_u32 s7, s63, 1769472
 buffer_load_dwordx4 v16, s[52:55], s7 offen nt lds
 s_mov_b32 s56, s12
 s_and_b32 s57, s13, 0xffff
 s_mov_b32 s58, 8388608
 s_mov_b32 s59, 0x20000
 s_add_u32 m0, s65, 16384
 s_add_u32 s7, s63, 0
 buffer_load_dwordx4 v16, s[56:59], s7 offen nt lds
 s_add_u32 m0, s65, 17408
 s_add_u32 s7, s63, 524288
 buffer_load_dwordx4 v16, s[56:59], s7 offen nt lds
 s_add_u32 m0, s65, 18432
 s_add_u32 s7, s63, 1048576
 buffer_load_dwordx4 v16, s[56:59], s7 offen nt lds
 s_add_u32 m0, s65, 19456
 s_add_u32 s7, s63, 1572864
 buffer_load_dwordx4 v16, s[56:59], s7 offen nt lds
 s_add_u32 m0, s65, 20480
 s_add_u32 s7, s63, 65536
 buffer_load_dwordx4 v16, s[56:59], s7 offen nt lds
 s_add_u32 m0, s65, 21504
 s_add_u32 s7, s63, 589824
 buffer_load_dwordx4 v16, s[56:59], s7 offen nt lds
 s_add_u32 m0, s65, 22528
 s_add_u32 s7, s63, 1114112
 buffer_load_dwordx4 v16, s[56:59], s7 offen nt lds
 s_add_u32 m0, s65, 23552
 s_add_u32 s7, s63, 1638400
 buffer_load_dwordx4 v16, s[56:59], s7 offen nt lds
 s_add_u32 m0, s65, 24576
 s_add_u32 s7, s63, 131072
 buffer_load_dwordx4 v16, s[56:59], s7 offen nt lds
 s_add_u32 m0, s65, 25600
 s_add_u32 s7, s63, 655360
 buffer_load_dwordx4 v16, s[56:59], s7 offen nt lds
 s_add_u32 m0, s65, 26624
 s_add_u32 s7, s63, 1179648
 buffer_load_dwordx4 v16, s[56:59], s7 offen nt lds
 s_add_u32 m0, s65, 27648
 s_add_u32 s7, s63, 1703936
 buffer_load_dwordx4 v16, s[56:59], s7 offen nt lds
 s_add_u32 m0, s65, 28672
 s_add_u32 s7, s63, 196608
 buffer_load_dwordx4 v16, s[56:59], s7 offen nt lds
 s_add_u32 m0, s65, 29696
 s_add_u32 s7, s63, 720896
 buffer_load_dwordx4 v16, s[56:59], s7 offen nt lds
 s_add_u32 m0, s65, 30720
 s_add_u32 s7, s63, 1245184
 buffer_load_dwordx4 v16, s[56:59], s7 offen nt lds
 s_add_u32 m0, s65, 31744
 s_add_u32 s7, s63, 1769472
 buffer_load_dwordx4 v16, s[56:59], s7 offen nt lds
 s_mov_b32 s52, s16
 s_and_b32 s53, s17, 0xffff
 s_mov_b32 s54, 8388608
 s_mov_b32 s55, 0x20000
 s_add_u32 m0, s65, 32768
 s_add_u32 s7, s63, 0
 buffer_load_dwordx4 v16, s[52:55], s7 offen nt lds
 s_add_u32 m0, s65, 33792
 s_add_u32 s7, s63, 524288
 buffer_load_dwordx4 v16, s[52:55], s7 offen nt lds
 s_add_u32 m0, s65, 34816
 s_add_u32 s7, s63, 1048576
 buffer_load_dwordx4 v16, s[52:55], s7 offen nt lds
 s_add_u32 m0, s65, 35840
 s_add_u32 s7, s63, 1572864
 buffer_load_dwordx4 v16, s[52:55], s7 offen nt lds
 s_add_u32 m0, s65, 36864
 s_add_u32 s7, s63, 65536
 buffer_load_dwordx4 v16, s[52:55], s7 offen nt lds
 s_add_u32 m0, s65, 37888
 s_add_u32 s7, s63, 589824
 buffer_load_dwordx4 v16, s[52:55], s7 offen nt lds
 s_add_u32 m0, s65, 38912
 s_add_u32 s7, s63, 1114112
 buffer_load_dwordx4 v16, s[52:55], s7 offen nt lds
 s_add_u32 m0, s65, 39936
 s_add_u32 s7, s63, 1638400
 buffer_load_dwordx4 v16, s[52:55], s7 offen nt lds
 v_and_b32 v28, 15, v0
 v_mov_b32 v1, 0x4444
 v_mov_b32 v27, 0xeeee
 v_cmp_eq_u32 vcc, 1, v29
 s_nop 1
 v_cndmask_b32 v1, v1, v27, vcc
 v_mov_b32 v12, 0x3e0293ee
 v_cndmask_b32 v12, v12, 1.0, vcc
 v_mov_b32 v13, v12
 v_lshlrev_b32 v27, 4, v29
 v_add_u32 v27, v27, v31
 v_lshlrev_b32 v5, 9, v30
 v_lshl_add_u32 v5, v27, 4, v5
 v_lshrrev_b32 v26, 1, v30
 v_and_b32 v25, 1, v30
 v_lshlrev_b32 v6, 8, v26
 v_lshl_add_u32 v6, v31, 4, v6
 v_lshl_add_u32 v6, v25, 3, v6
 v_lshl_add_u32 v6, v29, 2, v6
 v_add_u32 v6, 1536, v6
 s_lshl_b32 s79, s4, 10
 v_add_u32 v9, s79, v2
 s_mov_b32 s79, 16256
 s_mov_b32 s80, 1065353216
 v_lshlrev_b32 v24, 2, v25
 v_add_u32 v23, 0, v24
 v_cmp_eq_u32 vcc, v23, v28
 v_mov_b32 v22, s79
 s_nop 0
 v_cndmask_b32 v80, 0, v22, vcc
 v_add_u32 v23, 1, v23
 v_cmp_eq_u32 vcc, v23, v28
 v_mov_b32 v22, s80
 s_nop 0
 v_cndmask_b32 v80, v80, v22, vcc
 v_lshlrev_b32 v23, 1, v24
 v_add_u32 v23, 0, v23
 v_cmp_eq_u32 vcc, v23, v28
 v_mov_b32 v22, s79
 s_nop 0
 v_cndmask_b32 v84, 0, v22, vcc
 v_add_u32 v23, 1, v23
 v_cmp_eq_u32 vcc, v23, v28
 v_mov_b32 v22, s80
 s_nop 0
 v_cndmask_b32 v84, v84, v22, vcc
 v_mov_b32 v88, 0x3f803f80
 v_add_u32 v23, 2, v24
 v_cmp_eq_u32 vcc, v23, v28
 v_mov_b32 v22, s79
 s_nop 0
 v_cndmask_b32 v81, 0, v22, vcc
 v_add_u32 v23, 1, v23
 v_cmp_eq_u32 vcc, v23, v28
 v_mov_b32 v22, s80
 s_nop 0
 v_cndmask_b32 v81, v81, v22, vcc
 v_lshlrev_b32 v23, 1, v24
 v_add_u32 v23, 4, v23
 v_cmp_eq_u32 vcc, v23, v28
 v_mov_b32 v22, s79
 s_nop 0
 v_cndmask_b32 v85, 0, v22, vcc
 v_add_u32 v23, 1, v23
 v_cmp_eq_u32 vcc, v23, v28
 v_mov_b32 v22, s80
 s_nop 0
 v_cndmask_b32 v85, v85, v22, vcc
 v_mov_b32 v89, 0x3f803f80
 v_add_u32 v23, 8, v24
 v_cmp_eq_u32 vcc, v23, v28
 v_mov_b32 v22, s79
 s_nop 0
 v_cndmask_b32 v82, 0, v22, vcc
 v_add_u32 v23, 1, v23
 v_cmp_eq_u32 vcc, v23, v28
 v_mov_b32 v22, s80
 s_nop 0
 v_cndmask_b32 v82, v82, v22, vcc
 v_lshlrev_b32 v23, 1, v24
 v_add_u32 v23, 2, v23
 v_cmp_eq_u32 vcc, v23, v28
 v_mov_b32 v22, s79
 s_nop 0
 v_cndmask_b32 v86, 0, v22, vcc
 v_add_u32 v23, 1, v23
 v_cmp_eq_u32 vcc, v23, v28
 v_mov_b32 v22, s80
 s_nop 0
 v_cndmask_b32 v86, v86, v22, vcc
 v_mov_b32 v90, 0x3f803f80
 v_add_u32 v23, 10, v24
 v_cmp_eq_u32 vcc, v23, v28
 v_mov_b32 v22, s79
 s_nop 0
 v_cndmask_b32 v83, 0, v22, vcc
 v_add_u32 v23, 1, v23
 v_cmp_eq_u32 vcc, v23, v28
 v_mov_b32 v22, s80
 s_nop 0
 v_cndmask_b32 v83, v83, v22, vcc
 v_lshlrev_b32 v23, 1, v24
 v_add_u32 v23, 6, v23
 v_cmp_eq_u32 vcc, v23, v28
 v_mov_b32 v22, s79
 s_nop 0
 v_cndmask_b32 v87, 0, v22, vcc
 v_add_u32 v23, 1, v23
 v_cmp_eq_u32 vcc, v23, v28
 v_mov_b32 v22, s80
 s_nop 0
 v_cndmask_b32 v87, v87, v22, vcc
 v_mov_b32 v91, 0x3f803f80
 v_mov_b64 v[32:33], 0
 v_mov_b64 v[34:35], 0
 v_mov_b64 v[36:37], 0
 v_mov_b64 v[38:39], 0
 v_mov_b64 v[40:41], 0
 v_mov_b64 v[42:43], 0
 v_mov_b64 v[44:45], 0
 v_mov_b64 v[46:47], 0
 v_mov_b64 v[48:49], 0
 v_mov_b64 v[50:51], 0
 v_mov_b64 v[52:53], 0
 v_mov_b64 v[54:55], 0
 v_mov_b64 v[56:57], 0
 v_mov_b64 v[58:59], 0
 v_mov_b64 v[60:61], 0
 v_mov_b64 v[62:63], 0
 v_mov_b64 v[188:189], 0
 v_mov_b64 v[190:191], 0
 v_mov_b64 v[192:193], 0
 v_mov_b64 v[194:195], 0
 v_mov_b64 v[196:197], 0
 v_mov_b64 v[198:199], 0
 v_mov_b64 v[200:201], 0
 v_mov_b64 v[202:203], 0
 s_mov_b32 s82, 0x00ff00ff
 s_mov_b32 s83, 0x00ff00ff
 s_mov_b32 s84, 0xff00ff00
 s_mov_b32 s85, 0xff00ff00
 s_lshr_b32 s87, s81, 3
 s_lshl_b32 s87, s87, 14
 s_and_b32 s79, s81, 7
 s_lshl_b32 s79, s79, 10
 s_add_u32 s87, s87, s79
 s_xor_b32 s68, s67, 2048
 s_xor_b32 s69, s67, 4096
 s_xor_b32 s70, s67, 6144
 s_waitcnt vmcnt(36)
 ds_read_b64_tr_b16 a[64:65], v18 offset:0
 ds_read_b64_tr_b16 a[66:67], v18 offset:128
 ds_read_b64_tr_b16 a[68:69], v18 offset:2048
 ds_read_b64_tr_b16 a[70:71], v18 offset:2176
 ds_read_b64_tr_b16 a[72:73], v18 offset:8
 ds_read_b64_tr_b16 a[74:75], v18 offset:136
 ds_read_b64_tr_b16 a[76:77], v18 offset:2056
 ds_read_b64_tr_b16 a[78:79], v18 offset:2184
 s_waitcnt lgkmcnt(0)
 s_add_u32 m0, s65, 0
 s_add_u32 s7, s63, 131072
 buffer_load_dwordx4 v16, s[52:55], s7 offen nt lds
 s_add_u32 m0, s65, 1024
 s_add_u32 s7, s63, 655360
 buffer_load_dwordx4 v16, s[52:55], s7 offen nt lds
 s_add_u32 m0, s65, 2048
 s_add_u32 s7, s63, 1179648
 buffer_load_dwordx4 v16, s[52:55], s7 offen nt lds
 s_add_u32 m0, s65, 3072
 s_add_u32 s7, s63, 1703936
 buffer_load_dwordx4 v16, s[52:55], s7 offen nt lds
 s_waitcnt vmcnt(36)
 ds_read_b64_tr_b16 a[80:81], v18 offset:4096
 ds_read_b64_tr_b16 a[82:83], v18 offset:4224
 ds_read_b64_tr_b16 a[84:85], v18 offset:6144
 ds_read_b64_tr_b16 a[86:87], v18 offset:6272
 ds_read_b64_tr_b16 a[88:89], v18 offset:4104
 ds_read_b64_tr_b16 a[90:91], v18 offset:4232
 ds_read_b64_tr_b16 a[92:93], v18 offset:6152
 ds_read_b64_tr_b16 a[94:95], v18 offset:6280
 s_waitcnt lgkmcnt(0)
 s_add_u32 m0, s65, 4096
 s_add_u32 s7, s63, 196608
 buffer_load_dwordx4 v16, s[52:55], s7 offen nt lds
 s_add_u32 m0, s65, 5120
 s_add_u32 s7, s63, 720896
 buffer_load_dwordx4 v16, s[52:55], s7 offen nt lds
 s_add_u32 m0, s65, 6144
 s_add_u32 s7, s63, 1245184
 buffer_load_dwordx4 v16, s[52:55], s7 offen nt lds
 s_add_u32 m0, s65, 7168
 s_add_u32 s7, s63, 1769472
 buffer_load_dwordx4 v16, s[52:55], s7 offen nt lds
 s_waitcnt vmcnt(36)
 ds_read_b64_tr_b16 a[96:97], v18 offset:8192
 ds_read_b64_tr_b16 a[98:99], v18 offset:8320
 ds_read_b64_tr_b16 a[100:101], v18 offset:10240
 ds_read_b64_tr_b16 a[102:103], v18 offset:10368
 ds_read_b64_tr_b16 a[104:105], v18 offset:8200
 ds_read_b64_tr_b16 a[106:107], v18 offset:8328
 ds_read_b64_tr_b16 a[108:109], v18 offset:10248
 ds_read_b64_tr_b16 a[110:111], v18 offset:10376
 s_waitcnt lgkmcnt(0)
 s_mov_b32 s56, s18
 s_and_b32 s57, s19, 0xffff
 s_mov_b32 s58, 8388608
 s_mov_b32 s59, 0x20000
 s_add_u32 m0, s65, 8192
 s_add_u32 s7, s64, 0
 buffer_load_dwordx4 v17, s[56:59], s7 offen nt lds
 s_add_u32 m0, s65, 9216
 s_add_u32 s7, s64, 131072
 buffer_load_dwordx4 v17, s[56:59], s7 offen nt lds
 s_add_u32 m0, s65, 10240
 s_add_u32 s7, s64, 262144
 buffer_load_dwordx4 v17, s[56:59], s7 offen nt lds
 s_add_u32 m0, s65, 11264
 s_add_u32 s7, s64, 393216
 buffer_load_dwordx4 v17, s[56:59], s7 offen nt lds
 s_waitcnt vmcnt(36)
 ds_read_b64_tr_b16 a[112:113], v18 offset:12288
 ds_read_b64_tr_b16 a[114:115], v18 offset:12416
 ds_read_b64_tr_b16 a[116:117], v18 offset:14336
 ds_read_b64_tr_b16 a[118:119], v18 offset:14464
 ds_read_b64_tr_b16 a[120:121], v18 offset:12296
 ds_read_b64_tr_b16 a[122:123], v18 offset:12424
 ds_read_b64_tr_b16 a[124:125], v18 offset:14344
 ds_read_b64_tr_b16 a[126:127], v18 offset:14472
 s_waitcnt lgkmcnt(0)
 s_add_u32 m0, s65, 12288
 s_add_u32 s7, s64, 16384
 buffer_load_dwordx4 v17, s[56:59], s7 offen nt lds
 s_add_u32 m0, s65, 13312
 s_add_u32 s7, s64, 147456
 buffer_load_dwordx4 v17, s[56:59], s7 offen nt lds
 s_add_u32 m0, s65, 14336
 s_add_u32 s7, s64, 278528
 buffer_load_dwordx4 v17, s[56:59], s7 offen nt lds
 s_add_u32 m0, s65, 15360
 s_add_u32 s7, s64, 409600
 buffer_load_dwordx4 v17, s[56:59], s7 offen nt lds
 s_waitcnt vmcnt(36)
 ds_read_b64_tr_b16 a[0:1], v18 offset:16384
 ds_read_b64_tr_b16 a[2:3], v18 offset:16512
 ds_read_b64_tr_b16 a[4:5], v18 offset:18432
 ds_read_b64_tr_b16 a[6:7], v18 offset:18560
 ds_read_b64_tr_b16 a[8:9], v18 offset:16392
 ds_read_b64_tr_b16 a[10:11], v18 offset:16520
 ds_read_b64_tr_b16 a[12:13], v18 offset:18440
 ds_read_b64_tr_b16 a[14:15], v18 offset:18568
 s_waitcnt lgkmcnt(0)
 s_add_u32 m0, s65, 16384
 s_add_u32 s7, s64, 32768
 buffer_load_dwordx4 v17, s[56:59], s7 offen nt lds
 s_add_u32 m0, s65, 17408
 s_add_u32 s7, s64, 163840
 buffer_load_dwordx4 v17, s[56:59], s7 offen nt lds
 s_add_u32 m0, s65, 18432
 s_add_u32 s7, s64, 294912
 buffer_load_dwordx4 v17, s[56:59], s7 offen nt lds
 s_add_u32 m0, s65, 19456
 s_add_u32 s7, s64, 425984
 buffer_load_dwordx4 v17, s[56:59], s7 offen nt lds
 s_waitcnt vmcnt(36)
 ds_read_b64_tr_b16 a[16:17], v18 offset:20480
 ds_read_b64_tr_b16 a[18:19], v18 offset:20608
 ds_read_b64_tr_b16 a[20:21], v18 offset:22528
 ds_read_b64_tr_b16 a[22:23], v18 offset:22656
 ds_read_b64_tr_b16 a[24:25], v18 offset:20488
 ds_read_b64_tr_b16 a[26:27], v18 offset:20616
 ds_read_b64_tr_b16 a[28:29], v18 offset:22536
 ds_read_b64_tr_b16 a[30:31], v18 offset:22664
 s_waitcnt lgkmcnt(0)
 s_add_u32 m0, s65, 20480
 s_add_u32 s7, s64, 49152
 buffer_load_dwordx4 v17, s[56:59], s7 offen nt lds
 s_add_u32 m0, s65, 21504
 s_add_u32 s7, s64, 180224
 buffer_load_dwordx4 v17, s[56:59], s7 offen nt lds
 s_add_u32 m0, s65, 22528
 s_add_u32 s7, s64, 311296
 buffer_load_dwordx4 v17, s[56:59], s7 offen nt lds
 s_add_u32 m0, s65, 23552
 s_add_u32 s7, s64, 442368
 buffer_load_dwordx4 v17, s[56:59], s7 offen nt lds
 s_waitcnt vmcnt(36)
 ds_read_b64_tr_b16 a[32:33], v18 offset:24576
 ds_read_b64_tr_b16 a[34:35], v18 offset:24704
 ds_read_b64_tr_b16 a[36:37], v18 offset:26624
 ds_read_b64_tr_b16 a[38:39], v18 offset:26752
 ds_read_b64_tr_b16 a[40:41], v18 offset:24584
 ds_read_b64_tr_b16 a[42:43], v18 offset:24712
 ds_read_b64_tr_b16 a[44:45], v18 offset:26632
 ds_read_b64_tr_b16 a[46:47], v18 offset:26760
 s_waitcnt vmcnt(32)
 ds_read_b64_tr_b16 a[48:49], v18 offset:28672
 ds_read_b64_tr_b16 a[50:51], v18 offset:28800
 ds_read_b64_tr_b16 a[52:53], v18 offset:30720
 ds_read_b64_tr_b16 a[54:55], v18 offset:30848
 ds_read_b64_tr_b16 a[56:57], v18 offset:28680
 ds_read_b64_tr_b16 a[58:59], v18 offset:28808
 ds_read_b64_tr_b16 a[60:61], v18 offset:30728
 ds_read_b64_tr_b16 a[62:63], v18 offset:30856
 s_waitcnt vmcnt(28)
 ds_read_b64_tr_b16 a[128:129], v18 offset:32768
 ds_read_b64_tr_b16 a[130:131], v18 offset:32896
 ds_read_b64_tr_b16 a[132:133], v18 offset:34816
 ds_read_b64_tr_b16 a[134:135], v18 offset:34944
 ds_read_b64_tr_b16 a[136:137], v18 offset:32776
 ds_read_b64_tr_b16 a[138:139], v18 offset:32904
 ds_read_b64_tr_b16 a[140:141], v18 offset:34824
 ds_read_b64_tr_b16 a[142:143], v18 offset:34952
 s_waitcnt vmcnt(24)
 ds_read_b64_tr_b16 a[144:145], v18 offset:36864
 ds_read_b64_tr_b16 a[146:147], v18 offset:36992
 ds_read_b64_tr_b16 a[148:149], v18 offset:38912
 ds_read_b64_tr_b16 a[150:151], v18 offset:39040
 ds_read_b64_tr_b16 a[152:153], v18 offset:36872
 ds_read_b64_tr_b16 a[154:155], v18 offset:37000
 ds_read_b64_tr_b16 a[156:157], v18 offset:38920
 ds_read_b64_tr_b16 a[158:159], v18 offset:39048
 s_waitcnt vmcnt(20)
 ds_read_b64_tr_b16 a[160:161], v18 offset:0
 ds_read_b64_tr_b16 a[162:163], v18 offset:128
 ds_read_b64_tr_b16 a[164:165], v18 offset:2048
 ds_read_b64_tr_b16 a[166:167], v18 offset:2176
 ds_read_b64_tr_b16 a[168:169], v18 offset:8
 ds_read_b64_tr_b16 a[170:171], v18 offset:136
 ds_read_b64_tr_b16 a[172:173], v18 offset:2056
 ds_read_b64_tr_b16 a[174:175], v18 offset:2184
 s_waitcnt vmcnt(16)
 ds_read_b64_tr_b16 a[176:177], v18 offset:4096
 ds_read_b64_tr_b16 a[178:179], v18 offset:4224
 ds_read_b64_tr_b16 a[180:181], v18 offset:6144
 ds_read_b64_tr_b16 a[182:183], v18 offset:6272
 ds_read_b64_tr_b16 a[184:185], v18 offset:4104
 ds_read_b64_tr_b16 a[186:187], v18 offset:4232
 ds_read_b64_tr_b16 a[188:189], v18 offset:6152
 ds_read_b64_tr_b16 a[190:191], v18 offset:6280
 s_waitcnt vmcnt(12)
 ds_read_b64_tr_b16 a[192:193], v18 offset:8192
 ds_read_b64_tr_b16 a[194:195], v18 offset:8320
 ds_read_b64_tr_b16 a[196:197], v18 offset:10240
 ds_read_b64_tr_b16 a[198:199], v18 offset:10368
 ds_read_b64_tr_b16 a[200:201], v18 offset:8200
 ds_read_b64_tr_b16 a[202:203], v18 offset:8328
 ds_read_b64_tr_b16 a[204:205], v18 offset:10248
 ds_read_b64_tr_b16 a[206:207], v18 offset:10376
 s_waitcnt vmcnt(8)
 ds_read_b64_tr_b16 a[208:209], v18 offset:12288
 ds_read_b64_tr_b16 a[210:211], v18 offset:12416
 ds_read_b64_tr_b16 a[212:213], v18 offset:14336
 ds_read_b64_tr_b16 a[214:215], v18 offset:14464
 ds_read_b64_tr_b16 a[216:217], v18 offset:12296
 ds_read_b64_tr_b16 a[218:219], v18 offset:12424
 ds_read_b64_tr_b16 a[220:221], v18 offset:14344
 ds_read_b64_tr_b16 a[222:223], v18 offset:14472
 s_waitcnt vmcnt(4)
 ds_read_b64_tr_b16 a[224:225], v18 offset:16384
 ds_read_b64_tr_b16 a[226:227], v18 offset:16512
 ds_read_b64_tr_b16 a[228:229], v18 offset:18432
 ds_read_b64_tr_b16 a[230:231], v18 offset:18560
 ds_read_b64_tr_b16 a[232:233], v18 offset:16392
 ds_read_b64_tr_b16 a[234:235], v18 offset:16520
 ds_read_b64_tr_b16 a[236:237], v18 offset:18440
 ds_read_b64_tr_b16 a[238:239], v18 offset:18568
 s_waitcnt vmcnt(0)
 ds_read_b64_tr_b16 a[240:241], v18 offset:20480
 ds_read_b64_tr_b16 a[242:243], v18 offset:20608
 ds_read_b64_tr_b16 a[244:245], v18 offset:22528
 ds_read_b64_tr_b16 a[246:247], v18 offset:22656
 ds_read_b64_tr_b16 a[248:249], v18 offset:20488
 ds_read_b64_tr_b16 a[250:251], v18 offset:20616
 ds_read_b64_tr_b16 a[252:253], v18 offset:22536
 ds_read_b64_tr_b16 a[254:255], v18 offset:22664
 s_waitcnt lgkmcnt(0)
 s_lshl_b32 s79, s47, 15
 s_lshl_b32 s80, s4, 12
 s_add_u32 s79, s79, s80
 s_add_u32 s63, s79, 2097152
 s_add_u32 s65, s79, 2228224
 s_add_u32 s64, s66, 2113536
 s_add_u32 s66, s66, 2228224
 s_mov_b32 s60, 0
 s_mov_b32 s62, 0
 s_mov_b32 s61, 0
 s_barrier
 v_mov_b32 v10, 0
news_2:
 global_load_dword v11, v10, s[42:43] offset:132 sc1
 s_waitcnt vmcnt(0)
 v_readfirstlane_b32 s7, v11
 s_nop 0
 s_bfe_u32 s62, s7, 0x10005
 s_and_b32 s7, s7, 19
 s_cmp_eq_u32 s7, 19
 s_cbranch_scc1 newsok_3
 s_sleep 2
 s_sub_u32 s46, s46, 1
 s_cbranch_scc0 news_2
 s_mov_b32 s46, 0
 s_branch newsok_3
newsok_3:
 s_and_b32 s79, s62, 1
 s_lshl_b32 s79, s79, 13
 s_add_u32 s71, s71, s79
 s_add_u32 s71, s71, 134217728
 s_add_u32 s87, s87, s79
 s_add_u32 s87, s87, 155189248
 s_lshl_b32 s79, s60, 18
 s_and_b32 s80, s60, 8
 s_lshl_b32 s80, s80, 10
 s_add_u32 s72, s71, s79
 s_xor_b32 s72, s72, s80
 s_add_u32 s77, s87, s79
 s_xor_b32 s77, s77, s80
 s_xor_b32 s73, s72, 1024
 s_xor_b32 s74, s72, 2048
 s_xor_b32 s75, s72, 3072
 s_cmp_eq_u32 s4, 1
 s_cbranch_scc0 Lc_first
 s_mov_b32 s80, 1
kv_4:
 v_mov_b32 v11, 0
 buffer_load_dwordx2 v[14:15], v11, s[48:51], s78 offen sc1
 s_waitcnt vmcnt(0)
 v_min_u32 v10, v14, v15
 s_nop 0
 v_readfirstlane_b32 s61, v10
 s_nop 0
 s_cmp_ge_u32 s61, s80
 s_cbranch_scc1 kvok_5
 s_sub_u32 s46, s46, 1
 s_cbranch_scc0 kv_4
 s_mov_b32 s46, 0
 s_branch kvok_5
kvok_5:
 s_add_u32 s79, s76, 16777216
 s_mov_b32 m0, 16384
 s_nop 0
 buffer_load_dwordx4 v5, s[48:51], s76 offen sc1 lds
 s_mov_b32 m0, 17280
 s_nop 0
 buffer_load_dwordx4 v5, s[48:51], s76 offen offset:128 sc1 lds
 s_mov_b32 m0, 18432
 s_nop 0
 buffer_load_dwordx4 v5, s[48:51], s79 offen sc1 lds
 s_mov_b32 m0, 19328
 s_nop 0
 buffer_load_dwordx4 v5, s[48:51], s79 offen offset:128 sc1 lds
 s_waitcnt vmcnt(0)
Lc_first:
 s_barrier
 ds_read_b128 v[124:127], v2 offset:16384
 ds_read_b128 v[128:131], v2 offset:17408
 ds_read_b128 v[132:135], v2 offset:18432
 ds_read_b128 v[136:139], v2 offset:19456
 s_mov_b32 s52, s10
 s_and_b32 s53, s11, 0xffff
 s_mov_b32 s54, 16384
 s_mov_b32 s55, 0x20000
 v_lshrrev_b32 v10, 3, v0
 v_and_b32 v11, 7, v0
 v_lshlrev_b32 v11, 11, v11
 v_lshl_add_u32 v10, v10, 6, v11
 s_lshl_b32 s79, s4, 9
 buffer_load_dwordx4 v[16:19], v10, s[52:55], s79 offen offset:0
 buffer_load_dwordx4 v[20:23], v10, s[52:55], s79 offen offset:16
 buffer_load_dwordx4 v[24:27], v10, s[52:55], s79 offen offset:32
 buffer_load_dwordx4 v[28:31], v10, s[52:55], s79 offen offset:48
 s_cmp_eq_u32 s4, 0
 s_cbranch_scc1 LlA_rot
 s_branch LhA_rot
Lh_step:
 s_barrier
 buffer_load_dwordx4 v[16:19], v2, s[48:51], s63 offen offset:0 sc1
 v_mov_b64 v[32:33], 0
 v_mov_b64 v[34:35], 0
 v_mov_b64 v[36:37], 0
 v_mov_b64 v[38:39], 0
 v_mov_b32 v10, v10
 v_mov_b32 v10, v10
 v_mov_b32 v10, v10
 v_mov_b32 v10, v10
 v_mov_b32 v10, v10
 v_mov_b32 v10, v10
 v_mov_b32 v10, v10
 v_mov_b32 v10, v10
 buffer_load_dwordx4 v[20:23], v2, s[48:51], s63 offen offset:1024 sc1
 v_mov_b64 v[40:41], 0
 v_mov_b64 v[42:43], 0
 v_mov_b64 v[44:45], 0
 v_mov_b64 v[46:47], 0
 v_mov_b32 v10, v10
 v_mov_b32 v10, v10
 v_mov_b32 v10, v10
 v_mov_b32 v10, v10
 v_mov_b32 v10, v10
 v_mov_b32 v10, v10
 v_mov_b32 v10, v10
 v_mov_b32 v10, v10
 buffer_load_dwordx4 v[24:27], v2, s[48:51], s63 offen offset:2048 sc1
 v_mov_b64 v[48:49], 0
 v_mov_b64 v[50:51], 0
 v_mov_b64 v[52:53], 0
 v_mov_b64 v[54:55], 0
 v_mov_b32 v10, v10
 v_mov_b32 v10, v10
 v_mov_b32 v10, v10
 v_mov_b32 v10, v10
 v_mov_b32 v10, v10
 v_mov_b32 v10, v10
 v_mov_b32 v10, v10
 v_mov_b32 v10, v10
 buffer_load_dwordx4 v[28:31], v2, s[48:51], s63 offen offset:3072 sc1
LhA_rot:
 s_waitcnt vmcnt(3)
 v_max_u32 v8, v16, v18
 v_cmp_eq_u32 vcc, -1, v8
 s_cbranch_vccz LhA_got0
 buffer_load_dwordx4 v[16:19], v2, s[48:51], s63 offen offset:0 sc1
 s_waitcnt vmcnt(3)
 v_max_u32 v8, v20, v22
 v_cmp_eq_u32 vcc, -1, v8
 s_cbranch_vccz LhA_got1
 buffer_load_dwordx4 v[20:23], v2, s[48:51], s63 offen offset:1024 sc1
 s_waitcnt vmcnt(3)
 v_max_u32 v8, v24, v26
 v_cmp_eq_u32 vcc, -1, v8
 s_cbranch_vccz LhA_got2
 buffer_load_dwordx4 v[24:27], v2, s[48:51], s63 offen offset:2048 sc1
 s_waitcnt vmcnt(3)
 v_max_u32 v8, v28, v30
 v_cmp_eq_u32 vcc, -1, v8
 s_cbranch_vccz LhA_got3
 buffer_load_dwordx4 v[28:31], v2, s[48:51], s63 offen offset:3072 sc1
 s_sub_u32 s46, s46, 1
 s_cbranch_scc0 LhA_rot
 s_mov_b32 s46, 0
 s_branch LhA_late
LhA_redo:
 buffer_load_dwordx4 v[16:19], v2, s[48:51], s63 offen offset:0 sc1
 buffer_load_dwordx4 v[20:23], v2, s[48:51], s63 offen offset:1024 sc1
 buffer_load_dwordx4 v[24:27], v2, s[48:51], s63 offen offset:2048 sc1
 buffer_load_dwordx4 v[28:31], v2, s[48:51], s63 offen offset:3072 sc1
 v_mov_b64 v[32:33], 0
 v_mov_b64 v[34:35], 0
 v_mov_b64 v[36:37], 0
 v_mov_b64 v[38:39], 0
 v_mov_b64 v[40:41], 0
 v_mov_b64 v[42:43], 0
 v_mov_b64 v[44:45], 0
 v_mov_b64 v[46:47], 0
 s_branch LhA_rot
LhA_late:
 s_waitcnt vmcnt(3)
LhA_got0:
 v_smfmac_f32_16x16x64_bf16 v[32:35], v[16:19], a[0:7], v1
 v_smfmac_f32_16x16x64_bf16 v[36:39], v[16:19], a[64:71], v1
 v_smfmac_f32_16x16x64_bf16 v[40:43], v[16:19], a[8:15], v1
 v_smfmac_f32_16x16x64_bf16 v[44:47], v[16:19], a[72:79], v1
 s_waitcnt vmcnt(2)
 v_smfmac_f32_16x16x64_bf16 v[32:35], v[20:23], a[16:23], v1
 v_max3_u32 v8, v8, v20, v22
 v_smfmac_f32_16x16x64_bf16 v[36:39], v[20:23], a[80:87], v1
 v_smfmac_f32_16x16x64_bf16 v[40:43], v[20:23], a[24:31], v1
 v_smfmac_f32_16x16x64_bf16 v[44:47], v[20:23], a[88:95], v1
 s_waitcnt vmcnt(1)
 v_smfmac_f32_16x16x64_bf16 v[32:35], v[24:27], a[32:39], v1
 v_max3_u32 v8, v8, v24, v26
 v_smfmac_f32_16x16x64_bf16 v[36:39], v[24:27], a[96:103], v1
 v_smfmac_f32_16x16x64_bf16 v[40:43], v[24:27], a[40:47], v1
 v_smfmac_f32_16x16x64_bf16 v[44:47], v[24:27], a[104:111], v1
 s_waitcnt vmcnt(0)
 v_smfmac_f32_16x16x64_bf16 v[32:35], v[28:31], a[48:55], v1
 v_max3_u32 v8, v8, v28, v30
 v_cmp_eq_u32 vcc, -1, v8
 v_smfmac_f32_16x16x64_bf16 v[36:39], v[28:31], a[112:119], v1
 v_smfmac_f32_16x16x64_bf16 v[40:43], v[28:31], a[56:63], v1
 v_cvt_pk_bf16_f32 v64, v32, v33
 v_cvt_pk_bf16_f32 v65, v34, v35
 v_smfmac_f32_16x16x64_bf16 v[44:47], v[28:31], a[120:127], v1
 v_cvt_pk_bf16_f32 v66, v36, v37
 v_cvt_pk_bf16_f32 v67, v38, v39
 s_cbranch_vccnz LhA_bad0
LhA_ok0:
 s_nop 0
 v_mfma_f32_16x16x32_bf16 v[72:75], v[64:67], v[80:83], 0
 v_cvt_pk_bf16_f32 v68, v40, v41
 v_cvt_pk_bf16_f32 v69, v42, v43
 s_nop 0
 v_cvt_pk_bf16_f32 v70, v44, v45
 v_cvt_pk_bf16_f32 v71, v46, v47
 s_nop 1
 v_mfma_f32_16x16x32_bf16 v[76:79], v[68:71], v[80:83], 0
 ds_write_b128 v9, v[72:75] offset:0
 v_smfmac_f32_16x16x64_bf16 v[48:51], v[16:19], a[128:135], v1
 v_smfmac_f32_16x16x64_bf16 v[52:55], v[16:19], a[136:143], v1
 ds_write_b128 v9, v[76:79] offset:4096
 v_smfmac_f32_16x16x64_bf16 v[48:51], v[20:23], a[144:151], v1
 s_branch LhA_join
LhA_bad0:
 s_sub_u32 s46, s46, 1
 s_cbranch_scc0 LhA_redo
 s_mov_b32 s46, 0
 s_branch LhA_ok0
LhA_got1:
 v_smfmac_f32_16x16x64_bf16 v[32:35], v[20:23], a[16:23], v1
 v_smfmac_f32_16x16x64_bf16 v[36:39], v[20:23], a[80:87], v1
 v_smfmac_f32_16x16x64_bf16 v[40:43], v[20:23], a[24:31], v1
 v_smfmac_f32_16x16x64_bf16 v[44:47], v[20:23], a[88:95], v1
 s_waitcnt vmcnt(2)
 v_smfmac_f32_16x16x64_bf16 v[32:35], v[24:27], a[32:39], v1
 v_max3_u32 v8, v8, v24, v26
 v_smfmac_f32_16x16x64_bf16 v[36:39], v[24:27], a[96:103], v1
 v_smfmac_f32_16x16x64_bf16 v[40:43], v[24:27], a[40:47], v1
 v_smfmac_f32_16x16x64_bf16 v[44:47], v[24:27], a[104:111], v1
 s_waitcnt vmcnt(1)
 v_smfmac_f32_16x16x64_bf16 v[32:35], v[28:31], a[48:55], v1
 v_max3_u32 v8, v8, v28, v30
 v_smfmac_f32_16x16x64_bf16 v[36:39], v[28:31], a[112:119], v1
 v_smfmac_f32_16x16x64_bf16 v[40:43], v[28:31], a[56:63], v1
 v_smfmac_f32_16x16x64_bf16 v[44:47], v[28:31], a[120:127], v1
 s_waitcnt vmcnt(0)
 v_smfmac_f32_16x16x64_bf16 v[32:35], v[16:19], a[0:7], v1
 v_max3_u32 v8, v8, v16, v18
 v_cmp_eq_u32 vcc, -1, v8
 v_smfmac_f32_16x16x64_bf16 v[36:39], v[16:19], a[64:71], v1
 v_smfmac_f32_16x16x64_bf16 v[40:43], v[16:19], a[8:15], v1
 v_cvt_pk_bf16_f32 v64, v32, v33
 v_cvt_pk_bf16_f32 v65, v34, v35
 v_smfmac_f32_16x16x64_bf16 v[44:47], v[16:19], a[72:79], v1
 v_cvt_pk_bf16_f32 v66, v36, v37
 v_cvt_pk_bf16_f32 v67, v38, v39
 s_cbranch_vccnz LhA_bad1
LhA_ok1:
 s_nop 0
 v_mfma_f32_16x16x32_bf16 v[72:75], v[64:67], v[80:83], 0
 v_cvt_pk_bf16_f32 v68, v40, v41
 v_cvt_pk_bf16_f32 v69, v42, v43
 s_nop 0
 v_cvt_pk_bf16_f32 v70, v44, v45
 v_cvt_pk_bf16_f32 v71, v46, v47
 s_nop 1
 v_mfma_f32_16x16x32_bf16 v[76:79], v[68:71], v[80:83], 0
 ds_write_b128 v9, v[72:75] offset:0
 v_smfmac_f32_16x16x64_bf16 v[48:51], v[16:19], a[128:135], v1
 v_smfmac_f32_16x16x64_bf16 v[52:55], v[16:19], a[136:143], v1
 ds_write_b128 v9, v[76:79] offset:4096
 v_smfmac_f32_16x16x64_bf16 v[48:51], v[20:23], a[144:151], v1
 s_branch LhA_join
LhA_bad1:
 s_sub_u32 s46, s46, 1
 s_cbranch_scc0 LhA_redo
 s_mov_b32 s46, 0
 s_branch LhA_ok1
LhA_got2:
 v_smfmac_f32_16x16x64_bf16 v[32:35], v[24:27], a[32:39], v1
 v_smfmac_f32_16x16x64_bf16 v[36:39], v[24:27], a[96:103], v1
 v_smfmac_f32_16x16x64_bf16 v[40:43], v[24:27], a[40:47], v1
 v_smfmac_f32_16x16x64_bf16 v[44:47], v[24:27], a[104:111], v1
 s_waitcnt vmcnt(2)
 v_smfmac_f32_16x16x64_bf16 v[32:35], v[28:31], a[48:55], v1
 v_max3_u32 v8, v8, v28, v30
 v_smfmac_f32_16x16x64_bf16 v[36:39], v[28:31], a[112:119], v1
 v_smfmac_f32_16x16x64_bf16 v[40:43], v[28:31], a[56:63], v1
 v_smfmac_f32_16x16x64_bf16 v[44:47], v[28:31], a[120:127], v1
 s_waitcnt vmcnt(1)
 v_smfmac_f32_16x16x64_bf16 v[32:35], v[16:19], a[0:7], v1
 v_max3_u32 v8, v8, v16, v18
 v_smfmac_f32_16x16x64_bf16 v[36:39], v[16:19], a[64:71], v1
 v_smfmac_f32_16x16x64_bf16 v[40:43], v[16:19], a[8:15], v1
 v_smfmac_f32_16x16x64_bf16 v[44:47], v[16:19], a[72:79], v1
 s_waitcnt vmcnt(0)
 v_smfmac_f32_16x16x64_bf16 v[32:35], v[20:23], a[16:23], v1
 v_max3_u32 v8, v8, v20, v22
 v_cmp_eq_u32 vcc, -1, v8
 v_smfmac_f32_16x16x64_bf16 v[36:39], v[20:23], a[80:87], v1
 v_smfmac_f32_16x16x64_bf16 v[40:43], v[20:23], a[24:31], v1
 v_cvt_pk_bf16_f32 v64, v32, v33
 v_cvt_pk_bf16_f32 v65, v34, v35
 v_smfmac_f32_16x16x64_bf16 v[44:47], v[20:23], a[88:95], v1
 v_cvt_pk_bf16_f32 v66, v36, v37
 v_cvt_pk_bf16_f32 v67, v38, v39
 s_cbranch_vccnz LhA_bad2
LhA_ok2:
 s_nop 0
 v_mfma_f32_16x16x32_bf16 v[72:75], v[64:67], v[80:83], 0
 v_cvt_pk_bf16_f32 v68, v40, v41
 v_cvt_pk_bf16_f32 v69, v42, v43
 s_nop 0
 v_cvt_pk_bf16_f32 v70, v44, v45
 v_cvt_pk_bf16_f32 v71, v46, v47
 s_nop 1
 v_mfma_f32_16x16x32_bf16 v[76:79], v[68:71], v[80:83], 0
 ds_write_b128 v9, v[72:75] offset:0
 v_smfmac_f32_16x16x64_bf16 v[48:51], v[16:19], a[128:135], v1
 v_smfmac_f32_16x16x64_bf16 v[52:55], v[16:19], a[136:143], v1
 ds_write_b128 v9, v[76:79] offset:4096
 v_smfmac_f32_16x16x64_bf16 v[48:51], v[20:23], a[144:151], v1
 s_branch LhA_join
LhA_bad2:
 s_sub_u32 s46, s46, 1
 s_cbranch_scc0 LhA_redo
 s_mov_b32 s46, 0
 s_branch LhA_ok2
LhA_got3:
 v_smfmac_f32_16x16x64_bf16 v[32:35], v[28:31], a[48:55], v1
 v_smfmac_f32_16x16x64_bf16 v[36:39], v[28:31], a[112:119], v1
 v_smfmac_f32_16x16x64_bf16 v[40:43], v[28:31], a[56:63], v1
 v_smfmac_f32_16x16x64_bf16 v[44:47], v[28:31], a[120:127], v1
 s_waitcnt vmcnt(2)
 v_smfmac_f32_16x16x64_bf16 v[32:35], v[16:19], a[0:7], v1
 v_max3_u32 v8, v8, v16, v18
 v_smfmac_f32_16x16x64_bf16 v[36:39], v[16:19], a[64:71], v1
 v_smfmac_f32_16x16x64_bf16 v[40:43], v[16:19], a[8:15], v1
 v_smfmac_f32_16x16x64_bf16 v[44:47], v[16:19], a[72:79], v1
 s_waitcnt vmcnt(1)
 v_smfmac_f32_16x16x64_bf16 v[32:35], v[20:23], a[16:23], v1
 v_max3_u32 v8, v8, v20, v22
 v_smfmac_f32_16x16x64_bf16 v[36:39], v[20:23], a[80:87], v1
 v_smfmac_f32_16x16x64_bf16 v[40:43], v[20:23], a[24:31], v1
 v_smfmac_f32_16x16x64_bf16 v[44:47], v[20:23], a[88:95], v1
 s_waitcnt vmcnt(0)
 v_smfmac_f32_16x16x64_bf16 v[32:35], v[24:27], a[32:39], v1
 v_max3_u32 v8, v8, v24, v26
 v_cmp_eq_u32 vcc, -1, v8
 v_smfmac_f32_16x16x64_bf16 v[36:39], v[24:27], a[96:103], v1
 v_smfmac_f32_16x16x64_bf16 v[40:43], v[24:27], a[40:47], v1
 v_cvt_pk_bf16_f32 v64, v32, v33
 v_cvt_pk_bf16_f32 v65, v34, v35
 v_smfmac_f32_16x16x64_bf16 v[44:47], v[24:27], a[104:111], v1
 v_cvt_pk_bf16_f32 v66, v36, v37
 v_cvt_pk_bf16_f32 v67, v38, v39
 s_cbranch_vccnz LhA_bad3
LhA_ok3:
 s_nop 0
 v_mfma_f32_16x16x32_bf16 v[72:75], v[64:67], v[80:83], 0
 v_cvt_pk_bf16_f32 v68, v40, v41
 v_cvt_pk_bf16_f32 v69, v42, v43
 s_nop 0
 v_cvt_pk_bf16_f32 v70, v44, v45
 v_cvt_pk_bf16_f32 v71, v46, v47
 s_nop 1
 v_mfma_f32_16x16x32_bf16 v[76:79], v[68:71], v[80:83], 0
 ds_write_b128 v9, v[72:75] offset:0
 v_smfmac_f32_16x16x64_bf16 v[48:51], v[16:19], a[128:135], v1
 v_smfmac_f32_16x16x64_bf16 v[52:55], v[16:19], a[136:143], v1
 ds_write_b128 v9, v[76:79] offset:4096
 v_smfmac_f32_16x16x64_bf16 v[48:51], v[20:23], a[144:151], v1
 s_branch LhA_join
LhA_bad3:
 s_sub_u32 s46, s46, 1
 s_cbranch_scc0 LhA_redo
 s_mov_b32 s46, 0
 s_branch LhA_ok3
LhA_join:
 v_smfmac_f32_16x16x64_bf16 v[52:55], v[20:23], a[152:159], v1
 s_waitcnt lgkmcnt(0)
 s_barrier
 v_smfmac_f32_16x16x64_bf16 v[48:51], v[24:27], a[160:167], v1
 v_smfmac_f32_16x16x64_bf16 v[52:55], v[24:27], a[168:175], v1
 v_smfmac_f32_16x16x64_bf16 v[48:51], v[28:31], a[176:183], v1
 v_smfmac_f32_16x16x64_bf16 v[52:55], v[28:31], a[184:191], v1
 s_nop 3
 v_cvt_pk_bf16_f32 v64, v48, v49
 v_cvt_pk_bf16_f32 v65, v50, v51
 s_nop 1
 v_cvt_pk_bf16_f32 v66, v52, v53
 v_cvt_pk_bf16_f32 v67, v54, v55
 ds_write_b128 v9, v[64:67] offset:8192
 s_xor_b32 s63, s63, 0x4000
 s_waitcnt lgkmcnt(0)
 s_barrier
 s_cmp_eq_u32 s60, 63
 s_cbranch_scc1 L_chain_done
 s_add_u32 s80, s60, 2
 s_add_u32 s76, s76, 0x40000
 s_barrier
 buffer_load_dwordx4 v[16:19], v2, s[48:51], s65 offen offset:0 sc1
 v_mov_b32 v56, 0
 v_mov_b32 v57, 0
 v_mov_b32 v58, 0
 v_mov_b32 v59, 0
 v_mov_b32 v10, v10
 v_mov_b32 v10, v10
 v_mov_b32 v10, v10
 v_mov_b32 v10, v10
 v_mov_b32 v10, v10
 v_mov_b32 v10, v10
 v_mov_b32 v10, v10
 v_mov_b32 v10, v10
 buffer_load_dwordx4 v[20:23], v2, s[48:51], s65 offen offset:1024 sc1
 v_mov_b32 v60, 0
 v_mov_b32 v61, 0
 v_mov_b32 v62, 0
 v_mov_b32 v63, 0
 v_mov_b32 v10, v10
 v_mov_b32 v10, v10
 v_mov_b32 v10, v10
 v_mov_b32 v10, v10
 v_mov_b32 v10, v10
 v_mov_b32 v10, v10
 v_mov_b32 v10, v10
 v_mov_b32 v10, v10
 buffer_load_dwordx4 v[24:27], v2, s[48:51], s65 offen offset:2048 sc1
 v_mov_b32 v68, 0
 v_mov_b32 v69, 0
 v_mov_b32 v70, 0
 v_mov_b32 v71, 0
 v_mov_b32 v10, v10
 v_mov_b32 v10, v10
 v_mov_b32 v10, v10
 v_mov_b32 v10, v10
 v_mov_b32 v10, v10
 v_mov_b32 v10, v10
 v_mov_b32 v10, v10
 v_mov_b32 v10, v10
 buffer_load_dwordx4 v[28:31], v2, s[48:51], s65 offen offset:3072 sc1
LhF_rot:
 s_waitcnt vmcnt(3)
 v_cmp_eq_u32 vcc, -1, v16
 s_cbranch_vccz LhF_got0
 buffer_load_dwordx4 v[16:19], v2, s[48:51], s65 offen offset:0 sc1
 s_waitcnt vmcnt(3)
 v_cmp_eq_u32 vcc, -1, v20
 s_cbranch_vccz LhF_got1
 buffer_load_dwordx4 v[20:23], v2, s[48:51], s65 offen offset:1024 sc1
 s_waitcnt vmcnt(3)
 v_cmp_eq_u32 vcc, -1, v24
 s_cbranch_vccz LhF_got2
 buffer_load_dwordx4 v[24:27], v2, s[48:51], s65 offen offset:2048 sc1
 s_waitcnt vmcnt(3)
 v_cmp_eq_u32 vcc, -1, v28
 s_cbranch_vccz LhF_got3
 buffer_load_dwordx4 v[28:31], v2, s[48:51], s65 offen offset:3072 sc1
 s_sub_u32 s46, s46, 1
 s_cbranch_scc0 LhF_rot
 s_mov_b32 s46, 0
 s_branch LhF_late
LhF_redo:
 buffer_load_dwordx4 v[16:19], v2, s[48:51], s65 offen offset:0 sc1
 buffer_load_dwordx4 v[20:23], v2, s[48:51], s65 offen offset:1024 sc1
 buffer_load_dwordx4 v[24:27], v2, s[48:51], s65 offen offset:2048 sc1
 buffer_load_dwordx4 v[28:31], v2, s[48:51], s65 offen offset:3072 sc1
 v_mov_b64 v[56:57], 0
 v_mov_b64 v[58:59], 0
 v_mov_b64 v[60:61], 0
 v_mov_b64 v[62:63], 0
 s_branch LhF_rot
LhF_late:
 s_waitcnt vmcnt(3)
LhF_got0:
 v_smfmac_f32_16x16x64_bf16 v[56:59], v[16:19], a[192:199], v1
 v_smfmac_f32_16x16x64_bf16 v[60:63], v[16:19], a[200:207], v1
 s_waitcnt vmcnt(2)
 v_smfmac_f32_16x16x64_bf16 v[56:59], v[20:23], a[208:215], v1
 v_mov_b32 v8, v20
 v_smfmac_f32_16x16x64_bf16 v[60:63], v[20:23], a[216:223], v1
 s_waitcnt vmcnt(1)
 v_smfmac_f32_16x16x64_bf16 v[56:59], v[24:27], a[224:231], v1
 v_max_u32 v8, v8, v24
 v_smfmac_f32_16x16x64_bf16 v[60:63], v[24:27], a[232:239], v1
 s_waitcnt vmcnt(0)
 v_smfmac_f32_16x16x64_bf16 v[56:59], v[28:31], a[240:247], v1
 v_max_u32 v8, v8, v28
 v_cmp_eq_u32 vcc, -1, v8
 v_smfmac_f32_16x16x64_bf16 v[60:63], v[28:31], a[248:255], v1
 s_cbranch_vccnz LhF_bad0
LhF_ok0:
 s_nop 2
 v_cvt_pk_bf16_f32 v64, v56, v57
 v_cvt_pk_bf16_f32 v65, v58, v59
 s_nop 1
 v_cvt_pk_bf16_f32 v66, v60, v61
 v_cvt_pk_bf16_f32 v67, v62, v63
 ds_write_b128 v9, v[64:67] offset:12288
 s_branch LhF_join
LhF_bad0:
 s_sub_u32 s46, s46, 1
 s_cbranch_scc0 LhF_redo
 s_mov_b32 s46, 0
 s_branch LhF_ok0
LhF_got1:
 v_smfmac_f32_16x16x64_bf16 v[56:59], v[20:23], a[208:215], v1
 v_smfmac_f32_16x16x64_bf16 v[60:63], v[20:23], a[216:223], v1
 s_waitcnt vmcnt(2)
 v_smfmac_f32_16x16x64_bf16 v[56:59], v[24:27], a[224:231], v1
 v_mov_b32 v8, v24
 v_smfmac_f32_16x16x64_bf16 v[60:63], v[24:27], a[232:239], v1
 s_waitcnt vmcnt(1)
 v_smfmac_f32_16x16x64_bf16 v[56:59], v[28:31], a[240:247], v1
 v_max_u32 v8, v8, v28
 v_smfmac_f32_16x16x64_bf16 v[60:63], v[28:31], a[248:255], v1
 s_waitcnt vmcnt(0)
 v_smfmac_f32_16x16x64_bf16 v[56:59], v[16:19], a[192:199], v1
 v_max_u32 v8, v8, v16
 v_cmp_eq_u32 vcc, -1, v8
 v_smfmac_f32_16x16x64_bf16 v[60:63], v[16:19], a[200:207], v1
 s_cbranch_vccnz LhF_bad1
LhF_ok1:
 s_nop 2
 v_cvt_pk_bf16_f32 v64, v56, v57
 v_cvt_pk_bf16_f32 v65, v58, v59
 s_nop 1
 v_cvt_pk_bf16_f32 v66, v60, v61
 v_cvt_pk_bf16_f32 v67, v62, v63
 ds_write_b128 v9, v[64:67] offset:12288
 s_branch LhF_join
LhF_bad1:
 s_sub_u32 s46, s46, 1
 s_cbranch_scc0 LhF_redo
 s_mov_b32 s46, 0
 s_branch LhF_ok1
LhF_got2:
 v_smfmac_f32_16x16x64_bf16 v[56:59], v[24:27], a[224:231], v1
 v_smfmac_f32_16x16x64_bf16 v[60:63], v[24:27], a[232:239], v1
 s_waitcnt vmcnt(2)
 v_smfmac_f32_16x16x64_bf16 v[56:59], v[28:31], a[240:247], v1
 v_mov_b32 v8, v28
 v_smfmac_f32_16x16x64_bf16 v[60:63], v[28:31], a[248:255], v1
 s_waitcnt vmcnt(1)
 v_smfmac_f32_16x16x64_bf16 v[56:59], v[16:19], a[192:199], v1
 v_max_u32 v8, v8, v16
 v_smfmac_f32_16x16x64_bf16 v[60:63], v[16:19], a[200:207], v1
 s_waitcnt vmcnt(0)
 v_smfmac_f32_16x16x64_bf16 v[56:59], v[20:23], a[208:215], v1
 v_max_u32 v8, v8, v20
 v_cmp_eq_u32 vcc, -1, v8
 v_smfmac_f32_16x16x64_bf16 v[60:63], v[20:23], a[216:223], v1
 s_cbranch_vccnz LhF_bad2
LhF_ok2:
 s_nop 2
 v_cvt_pk_bf16_f32 v64, v56, v57
 v_cvt_pk_bf16_f32 v65, v58, v59
 s_nop 1
 v_cvt_pk_bf16_f32 v66, v60, v61
 v_cvt_pk_bf16_f32 v67, v62, v63
 ds_write_b128 v9, v[64:67] offset:12288
 s_branch LhF_join
LhF_bad2:
 s_sub_u32 s46, s46, 1
 s_cbranch_scc0 LhF_redo
 s_mov_b32 s46, 0
 s_branch LhF_ok2
LhF_got3:
 v_smfmac_f32_16x16x64_bf16 v[56:59], v[28:31], a[240:247], v1
 v_smfmac_f32_16x16x64_bf16 v[60:63], v[28:31], a[248:255], v1
 s_waitcnt vmcnt(2)
 v_smfmac_f32_16x16x64_bf16 v[56:59], v[16:19], a[192:199], v1
 v_mov_b32 v8, v16
 v_smfmac_f32_16x16x64_bf16 v[60:63], v[16:19], a[200:207], v1
 s_waitcnt vmcnt(1)
 v_smfmac_f32_16x16x64_bf16 v[56:59], v[20:23], a[208:215], v1
 v_max_u32 v8, v8, v20
 v_smfmac_f32_16x16x64_bf16 v[60:63], v[20:23], a[216:223], v1
 s_waitcnt vmcnt(0)
 v_smfmac_f32_16x16x64_bf16 v[56:59], v[24:27], a[224:231], v1
 v_max_u32 v8, v8, v24
 v_cmp_eq_u32 vcc, -1, v8
 v_smfmac_f32_16x16x64_bf16 v[60:63], v[24:27], a[232:239], v1
 s_cbranch_vccnz LhF_bad3
LhF_ok3:
 s_nop 2
 v_cvt_pk_bf16_f32 v64, v56, v57
 v_cvt_pk_bf16_f32 v65, v58, v59
 s_nop 1
 v_cvt_pk_bf16_f32 v66, v60, v61
 v_cvt_pk_bf16_f32 v67, v62, v63
 ds_write_b128 v9, v[64:67] offset:12288
 s_branch LhF_join
LhF_bad3:
 s_sub_u32 s46, s46, 1
 s_cbranch_scc0 LhF_redo
 s_mov_b32 s46, 0
 s_branch LhF_ok3
LhF_join:
 s_cmp_ge_u32 s4, 2
 s_cbranch_scc1 Lh_w23
 s_cmp_ge_u32 s61, s80
 s_cbranch_scc0 Lh_kvwait
 s_waitcnt lgkmcnt(0)
 s_barrier
Lh_kvok:
 s_add_u32 s79, s76, 16777216
 s_mov_b32 m0, 16384
 s_nop 0
 buffer_load_dwordx4 v5, s[48:51], s76 offen sc1 lds
 s_mov_b32 m0, 17280
 s_nop 0
 buffer_load_dwordx4 v5, s[48:51], s76 offen offset:128 sc1 lds
 s_mov_b32 m0, 18432
 s_nop 0
 buffer_load_dwordx4 v5, s[48:51], s79 offen sc1 lds
 s_mov_b32 m0, 19328
 s_nop 0
 buffer_load_dwordx4 v5, s[48:51], s79 offen offset:128 sc1 lds
 s_add_u32 s80, s80, 2
 s_min_u32 s80, s80, 64
 s_cmp_ge_u32 s61, s80
 s_cbranch_scc1 Lh_next
 s_mov_b32 s80, 0
kv_6:
 v_mov_b32 v11, 0
 buffer_load_dwordx2 v[14:15], v11, s[48:51], s78 offen sc1
 s_waitcnt vmcnt(0)
 v_min_u32 v10, v14, v15
 s_nop 0
 v_readfirstlane_b32 s61, v10
 s_nop 0
 s_cmp_ge_u32 s61, s80
 s_cbranch_scc1 kvok_7
 s_sub_u32 s46, s46, 1
 s_cbranch_scc0 kv_6
 s_mov_b32 s46, 0
 s_branch kvok_7
kvok_7:
 s_branch Lh_next
Lh_kvwait:
 s_waitcnt lgkmcnt(0)
 s_barrier
kv_8:
 v_mov_b32 v11, 0
 buffer_load_dwordx2 v[14:15], v11, s[48:51], s78 offen sc1
 s_waitcnt vmcnt(0)
 v_min_u32 v10, v14, v15
 s_nop 0
 v_readfirstlane_b32 s61, v10
 s_nop 0
 s_cmp_ge_u32 s61, s80
 s_cbranch_scc1 kvok_9
 s_sub_u32 s46, s46, 1
 s_cbranch_scc0 kv_8
 s_mov_b32 s46, 0
 s_branch kvok_9
kvok_9:
 s_branch Lh_kvok
Lh_w23:
 s_cmp_eq_u32 s4, 3
 s_waitcnt lgkmcnt(0)
 s_barrier
 s_cbranch_scc1 Lh_next
 v_mov_b32 v10, s60
 v_mov_b32 v11, 4096
 s_mov_b64 exec, 1
 buffer_store_dword v10, v11, s[48:51], s78 offen sc1
 s_mov_b64 exec, -1
Lh_next:
 s_waitcnt vmcnt(0)
 s_xor_b32 s65, s65, 0x4000
 s_add_u32 s60, s60, 1
 s_branch Lh_step
Ll_step:
 s_barrier
 buffer_load_dwordx4 v[16:19], v2, s[48:51], s63 offen offset:0 sc1
 v_mov_b64 v[32:33], 0
 v_mov_b64 v[34:35], 0
 v_mov_b64 v[36:37], 0
 v_mov_b64 v[38:39], 0
 ds_read_b128 v[124:127], v2 offset:16384
 ds_read_b128 v[128:131], v2 offset:17408
 v_mov_b32 v10, v10
 v_mov_b32 v10, v10
 v_mov_b32 v10, v10
 v_mov_b32 v10, v10
 v_mov_b32 v10, v10
 v_mov_b32 v10, v10
 v_mov_b32 v10, v10
 v_mov_b32 v10, v10
 buffer_load_dwordx4 v[20:23], v2, s[48:51], s63 offen offset:1024 sc1
 v_mov_b64 v[40:41], 0
 v_mov_b64 v[42:43], 0
 v_mov_b64 v[44:45], 0
 v_mov_b64 v[46:47], 0
 ds_read_b128 v[132:135], v2 offset:18432
 ds_read_b128 v[136:139], v2 offset:19456
 v_mov_b32 v10, v10
 v_mov_b32 v10, v10
 v_mov_b32 v10, v10
 v_mov_b32 v10, v10
 v_mov_b32 v10, v10
 v_mov_b32 v10, v10
 v_mov_b32 v10, v10
 v_mov_b32 v10, v10
 buffer_load_dwordx4 v[24:27], v2, s[48:51], s63 offen offset:2048 sc1
 v_mov_b64 v[48:49], 0
 v_mov_b64 v[50:51], 0
 v_mov_b64 v[52:53], 0
 v_mov_b64 v[54:55], 0
 v_mov_b32 v10, v10
 v_mov_b32 v10, v10
 v_mov_b32 v10, v10
 v_mov_b32 v10, v10
 v_mov_b32 v10, v10
 v_mov_b32 v10, v10
 v_mov_b32 v10, v10
 v_mov_b32 v10, v10
 buffer_load_dwordx4 v[28:31], v2, s[48:51], s63 offen offset:3072 sc1
LlA_rot:
 s_waitcnt vmcnt(3)
 v_max_u32 v8, v16, v18
 v_cmp_eq_u32 vcc, -1, v8
 s_cbranch_vccz LlA_got0
 buffer_load_dwordx4 v[16:19], v2, s[48:51], s63 offen offset:0 sc1
 s_waitcnt vmcnt(3)
 v_max_u32 v8, v20, v22
 v_cmp_eq_u32 vcc, -1, v8
 s_cbranch_vccz LlA_got1
 buffer_load_dwordx4 v[20:23], v2, s[48:51], s63 offen offset:1024 sc1
 s_waitcnt vmcnt(3)
 v_max_u32 v8, v24, v26
 v_cmp_eq_u32 vcc, -1, v8
 s_cbranch_vccz LlA_got2
 buffer_load_dwordx4 v[24:27], v2, s[48:51], s63 offen offset:2048 sc1
 s_waitcnt vmcnt(3)
 v_max_u32 v8, v28, v30
 v_cmp_eq_u32 vcc, -1, v8
 s_cbranch_vccz LlA_got3
 buffer_load_dwordx4 v[28:31], v2, s[48:51], s63 offen offset:3072 sc1
 s_sub_u32 s46, s46, 1
 s_cbranch_scc0 LlA_rot
 s_mov_b32 s46, 0
 s_branch LlA_late
LlA_redo:
 buffer_load_dwordx4 v[16:19], v2, s[48:51], s63 offen offset:0 sc1
 buffer_load_dwordx4 v[20:23], v2, s[48:51], s63 offen offset:1024 sc1
 buffer_load_dwordx4 v[24:27], v2, s[48:51], s63 offen offset:2048 sc1
 buffer_load_dwordx4 v[28:31], v2, s[48:51], s63 offen offset:3072 sc1
 v_mov_b64 v[32:33], 0
 v_mov_b64 v[34:35], 0
 v_mov_b64 v[36:37], 0
 v_mov_b64 v[38:39], 0
 v_mov_b64 v[40:41], 0
 v_mov_b64 v[42:43], 0
 v_mov_b64 v[44:45], 0
 v_mov_b64 v[46:47], 0
 s_branch LlA_rot
LlA_late:
 s_waitcnt vmcnt(3)
LlA_got0:
 v_smfmac_f32_16x16x64_bf16 v[32:35], v[16:19], a[0:7], v1
 v_smfmac_f32_16x16x64_bf16 v[36:39], v[16:19], a[64:71], v1
 v_smfmac_f32_16x16x64_bf16 v[40:43], v[16:19], a[8:15], v1
 v_smfmac_f32_16x16x64_bf16 v[44:47], v[16:19], a[72:79], v1
 s_waitcnt vmcnt(2)
 v_smfmac_f32_16x16x64_bf16 v[32:35], v[20:23], a[16:23], v1
 v_max3_u32 v8, v8, v20, v22
 v_smfmac_f32_16x16x64_bf16 v[36:39], v[20:23], a[80:87], v1
 v_smfmac_f32_16x16x64_bf16 v[40:43], v[20:23], a[24:31], v1
 v_smfmac_f32_16x16x64_bf16 v[44:47], v[20:23], a[88:95], v1
 s_waitcnt vmcnt(1)
 v_smfmac_f32_16x16x64_bf16 v[32:35], v[24:27], a[32:39], v1
 v_max3_u32 v8, v8, v24, v26
 v_smfmac_f32_16x16x64_bf16 v[36:39], v[24:27], a[96:103], v1
 v_smfmac_f32_16x16x64_bf16 v[40:43], v[24:27], a[40:47], v1
 v_smfmac_f32_16x16x64_bf16 v[44:47], v[24:27], a[104:111], v1
 s_waitcnt vmcnt(0)
 v_smfmac_f32_16x16x64_bf16 v[32:35], v[28:31], a[48:55], v1
 v_max3_u32 v8, v8, v28, v30
 v_cmp_eq_u32 vcc, -1, v8
 v_smfmac_f32_16x16x64_bf16 v[36:39], v[28:31], a[112:119], v1
 v_smfmac_f32_16x16x64_bf16 v[40:43], v[28:31], a[56:63], v1
 v_cvt_pk_bf16_f32 v64, v32, v33
 v_cvt_pk_bf16_f32 v65, v34, v35
 v_smfmac_f32_16x16x64_bf16 v[44:47], v[28:31], a[120:127], v1
 v_cvt_pk_bf16_f32 v66, v36, v37
 v_cvt_pk_bf16_f32 v67, v38, v39
 s_cbranch_vccnz LlA_bad0
LlA_ok0:
 s_nop 0
 v_mfma_f32_16x16x32_bf16 v[72:75], v[64:67], v[80:83], 0
 v_cvt_pk_bf16_f32 v68, v40, v41
 v_cvt_pk_bf16_f32 v69, v42, v43
 s_nop 0
 v_cvt_pk_bf16_f32 v70, v44, v45
 v_cvt_pk_bf16_f32 v71, v46, v47
 s_nop 1
 v_mfma_f32_16x16x32_bf16 v[76:79], v[68:71], v[80:83], 0
 v_smfmac_f32_16x16x64_bf16 v[48:51], v[16:19], a[128:135], v1
 v_pk_mul_f32 v[72:73], v[72:73], v[12:13]
 v_pk_mul_f32 v[74:75], v[74:75], v[12:13]
 v_smfmac_f32_16x16x64_bf16 v[52:55], v[16:19], a[136:143], v1
 s_branch LlA_join
LlA_bad0:
 s_sub_u32 s46, s46, 1
 s_cbranch_scc0 LlA_redo
 s_mov_b32 s46, 0
 s_branch LlA_ok0
LlA_got1:
 v_smfmac_f32_16x16x64_bf16 v[32:35], v[20:23], a[16:23], v1
 v_smfmac_f32_16x16x64_bf16 v[36:39], v[20:23], a[80:87], v1
 v_smfmac_f32_16x16x64_bf16 v[40:43], v[20:23], a[24:31], v1
 v_smfmac_f32_16x16x64_bf16 v[44:47], v[20:23], a[88:95], v1
 s_waitcnt vmcnt(2)
 v_smfmac_f32_16x16x64_bf16 v[32:35], v[24:27], a[32:39], v1
 v_max3_u32 v8, v8, v24, v26
 v_smfmac_f32_16x16x64_bf16 v[36:39], v[24:27], a[96:103], v1
 v_smfmac_f32_16x16x64_bf16 v[40:43], v[24:27], a[40:47], v1
 v_smfmac_f32_16x16x64_bf16 v[44:47], v[24:27], a[104:111], v1
 s_waitcnt vmcnt(1)
 v_smfmac_f32_16x16x64_bf16 v[32:35], v[28:31], a[48:55], v1
 v_max3_u32 v8, v8, v28, v30
 v_smfmac_f32_16x16x64_bf16 v[36:39], v[28:31], a[112:119], v1
 v_smfmac_f32_16x16x64_bf16 v[40:43], v[28:31], a[56:63], v1
 v_smfmac_f32_16x16x64_bf16 v[44:47], v[28:31], a[120:127], v1
 s_waitcnt vmcnt(0)
 v_smfmac_f32_16x16x64_bf16 v[32:35], v[16:19], a[0:7], v1
 v_max3_u32 v8, v8, v16, v18
 v_cmp_eq_u32 vcc, -1, v8
 v_smfmac_f32_16x16x64_bf16 v[36:39], v[16:19], a[64:71], v1
 v_smfmac_f32_16x16x64_bf16 v[40:43], v[16:19], a[8:15], v1
 v_cvt_pk_bf16_f32 v64, v32, v33
 v_cvt_pk_bf16_f32 v65, v34, v35
 v_smfmac_f32_16x16x64_bf16 v[44:47], v[16:19], a[72:79], v1
 v_cvt_pk_bf16_f32 v66, v36, v37
 v_cvt_pk_bf16_f32 v67, v38, v39
 s_cbranch_vccnz LlA_bad1
LlA_ok1:
 s_nop 0
 v_mfma_f32_16x16x32_bf16 v[72:75], v[64:67], v[80:83], 0
 v_cvt_pk_bf16_f32 v68, v40, v41
 v_cvt_pk_bf16_f32 v69, v42, v43
 s_nop 0
 v_cvt_pk_bf16_f32 v70, v44, v45
 v_cvt_pk_bf16_f32 v71, v46, v47
 s_nop 1
 v_mfma_f32_16x16x32_bf16 v[76:79], v[68:71], v[80:83], 0
 v_smfmac_f32_16x16x64_bf16 v[48:51], v[16:19], a[128:135], v1
 v_pk_mul_f32 v[72:73], v[72:73], v[12:13]
 v_pk_mul_f32 v[74:75], v[74:75], v[12:13]
 v_smfmac_f32_16x16x64_bf16 v[52:55], v[16:19], a[136:143], v1
 s_branch LlA_join
LlA_bad1:
 s_sub_u32 s46, s46, 1
 s_cbranch_scc0 LlA_redo
 s_mov_b32 s46, 0
 s_branch LlA_ok1
LlA_got2:
 v_smfmac_f32_16x16x64_bf16 v[32:35], v[24:27], a[32:39], v1
 v_smfmac_f32_16x16x64_bf16 v[36:39], v[24:27], a[96:103], v1
 v_smfmac_f32_16x16x64_bf16 v[40:43], v[24:27], a[40:47], v1
 v_smfmac_f32_16x16x64_bf16 v[44:47], v[24:27], a[104:111], v1
 s_waitcnt vmcnt(2)
 v_smfmac_f32_16x16x64_bf16 v[32:35], v[28:31], a[48:55], v1
 v_max3_u32 v8, v8, v28, v30
 v_smfmac_f32_16x16x64_bf16 v[36:39], v[28:31], a[112:119], v1
 v_smfmac_f32_16x16x64_bf16 v[40:43], v[28:31], a[56:63], v1
 v_smfmac_f32_16x16x64_bf16 v[44:47], v[28:31], a[120:127], v1
 s_waitcnt vmcnt(1)
 v_smfmac_f32_16x16x64_bf16 v[32:35], v[16:19], a[0:7], v1
 v_max3_u32 v8, v8, v16, v18
 v_smfmac_f32_16x16x64_bf16 v[36:39], v[16:19], a[64:71], v1
 v_smfmac_f32_16x16x64_bf16 v[40:43], v[16:19], a[8:15], v1
 v_smfmac_f32_16x16x64_bf16 v[44:47], v[16:19], a[72:79], v1
 s_waitcnt vmcnt(0)
 v_smfmac_f32_16x16x64_bf16 v[32:35], v[20:23], a[16:23], v1
 v_max3_u32 v8, v8, v20, v22
 v_cmp_eq_u32 vcc, -1, v8
 v_smfmac_f32_16x16x64_bf16 v[36:39], v[20:23], a[80:87], v1
 v_smfmac_f32_16x16x64_bf16 v[40:43], v[20:23], a[24:31], v1
 v_cvt_pk_bf16_f32 v64, v32, v33
 v_cvt_pk_bf16_f32 v65, v34, v35
 v_smfmac_f32_16x16x64_bf16 v[44:47], v[20:23], a[88:95], v1
 v_cvt_pk_bf16_f32 v66, v36, v37
 v_cvt_pk_bf16_f32 v67, v38, v39
 s_cbranch_vccnz LlA_bad2
LlA_ok2:
 s_nop 0
 v_mfma_f32_16x16x32_bf16 v[72:75], v[64:67], v[80:83], 0
 v_cvt_pk_bf16_f32 v68, v40, v41
 v_cvt_pk_bf16_f32 v69, v42, v43
 s_nop 0
 v_cvt_pk_bf16_f32 v70, v44, v45
 v_cvt_pk_bf16_f32 v71, v46, v47
 s_nop 1
 v_mfma_f32_16x16x32_bf16 v[76:79], v[68:71], v[80:83], 0
 v_smfmac_f32_16x16x64_bf16 v[48:51], v[16:19], a[128:135], v1
 v_pk_mul_f32 v[72:73], v[72:73], v[12:13]
 v_pk_mul_f32 v[74:75], v[74:75], v[12:13]
 v_smfmac_f32_16x16x64_bf16 v[52:55], v[16:19], a[136:143], v1
 s_branch LlA_join
LlA_bad2:
 s_sub_u32 s46, s46, 1
 s_cbranch_scc0 LlA_redo
 s_mov_b32 s46, 0
 s_branch LlA_ok2
LlA_got3:
 v_smfmac_f32_16x16x64_bf16 v[32:35], v[28:31], a[48:55], v1
 v_smfmac_f32_16x16x64_bf16 v[36:39], v[28:31], a[112:119], v1
 v_smfmac_f32_16x16x64_bf16 v[40:43], v[28:31], a[56:63], v1
 v_smfmac_f32_16x16x64_bf16 v[44:47], v[28:31], a[120:127], v1
 s_waitcnt vmcnt(2)
 v_smfmac_f32_16x16x64_bf16 v[32:35], v[16:19], a[0:7], v1
 v_max3_u32 v8, v8, v16, v18
 v_smfmac_f32_16x16x64_bf16 v[36:39], v[16:19], a[64:71], v1
 v_smfmac_f32_16x16x64_bf16 v[40:43], v[16:19], a[8:15], v1
 v_smfmac_f32_16x16x64_bf16 v[44:47], v[16:19], a[72:79], v1
 s_waitcnt vmcnt(1)
 v_smfmac_f32_16x16x64_bf16 v[32:35], v[20:23], a[16:23], v1
 v_max3_u32 v8, v8, v20, v22
 v_smfmac_f32_16x16x64_bf16 v[36:39], v[20:23], a[80:87], v1
 v_smfmac_f32_16x16x64_bf16 v[40:43], v[20:23], a[24:31], v1
 v_smfmac_f32_16x16x64_bf16 v[44:47], v[20:23], a[88:95], v1
 s_waitcnt vmcnt(0)
 v_smfmac_f32_16x16x64_bf16 v[32:35], v[24:27], a[32:39], v1
 v_max3_u32 v8, v8, v24, v26
 v_cmp_eq_u32 vcc, -1, v8
 v_smfmac_f32_16x16x64_bf16 v[36:39], v[24:27], a[96:103], v1
 v_smfmac_f32_16x16x64_bf16 v[40:43], v[24:27], a[40:47], v1
 v_cvt_pk_bf16_f32 v64, v32, v33
 v_cvt_pk_bf16_f32 v65, v34, v35
 v_smfmac_f32_16x16x64_bf16 v[44:47], v[24:27], a[104:111], v1
 v_cvt_pk_bf16_f32 v66, v36, v37
 v_cvt_pk_bf16_f32 v67, v38, v39
 s_cbranch_vccnz LlA_bad3
LlA_ok3:
 s_nop 0
 v_mfma_f32_16x16x32_bf16 v[72:75], v[64:67], v[80:83], 0
 v_cvt_pk_bf16_f32 v68, v40, v41
 v_cvt_pk_bf16_f32 v69, v42, v43
 s_nop 0
 v_cvt_pk_bf16_f32 v70, v44, v45
 v_cvt_pk_bf16_f32 v71, v46, v47
 s_nop 1
 v_mfma_f32_16x16x32_bf16 v[76:79], v[68:71], v[80:83], 0
 v_smfmac_f32_16x16x64_bf16 v[48:51], v[16:19], a[128:135], v1
 v_pk_mul_f32 v[72:73], v[72:73], v[12:13]
 v_pk_mul_f32 v[74:75], v[74:75], v[12:13]
 v_smfmac_f32_16x16x64_bf16 v[52:55], v[16:19], a[136:143], v1
 s_branch LlA_join
LlA_bad3:
 s_sub_u32 s46, s46, 1
 s_cbranch_scc0 LlA_redo
 s_mov_b32 s46, 0
 s_branch LlA_ok3
LlA_join:
 v_smfmac_f32_16x16x64_bf16 v[48:51], v[20:23], a[144:151], v1
 v_pk_mul_f32 v[76:77], v[76:77], v[12:13]
 v_pk_mul_f32 v[78:79], v[78:79], v[12:13]
 v_smfmac_f32_16x16x64_bf16 v[52:55], v[20:23], a[152:159], v1
 s_cmp_eq_u32 s60, 63
 v_smfmac_f32_16x16x64_bf16 v[48:51], v[24:27], a[160:167], v1
 s_cbranch_scc1 Ll_last
 v_smfmac_f32_16x16x64_bf16 v[52:55], v[24:27], a[168:175], v1
 s_barrier
 ds_read_b128 v[96:99], v2 offset:1024
 ds_read_b128 v[100:103], v2 offset:2048
 ds_read_b128 v[104:107], v2 offset:3072
 ds_read_b128 v[108:111], v2 offset:5120
 ds_read_b128 v[112:115], v2 offset:6144
 ds_read_b128 v[116:119], v2 offset:7168
 s_waitcnt lgkmcnt(5)
 v_pk_fma_f32 v[72:73], v[96:97], v[12:13], v[72:73]
 v_pk_fma_f32 v[74:75], v[98:99], v[12:13], v[74:75]
 s_waitcnt lgkmcnt(3)
 v_pk_fma_f32 v[72:73], v[100:101], v[12:13], v[72:73]
 v_pk_fma_f32 v[74:75], v[102:103], v[12:13], v[74:75]
 v_pk_fma_f32 v[72:73], v[104:105], v[12:13], v[72:73]
 v_pk_fma_f32 v[74:75], v[106:107], v[12:13], v[74:75]
 v_cvt_pk_bf16_f32 v120, v72, v73
 v_cvt_pk_bf16_f32 v121, v74, v75
 s_waitcnt lgkmcnt(0)
 v_pk_fma_f32 v[76:77], v[108:109], v[12:13], v[76:77]
 v_pk_fma_f32 v[78:79], v[110:111], v[12:13], v[78:79]
 v_pk_fma_f32 v[76:77], v[112:113], v[12:13], v[76:77]
 v_pk_fma_f32 v[78:79], v[114:115], v[12:13], v[78:79]
 v_pk_fma_f32 v[76:77], v[116:117], v[12:13], v[76:77]
 v_pk_fma_f32 v[78:79], v[118:119], v[12:13], v[78:79]
 v_cvt_pk_bf16_f32 v122, v76, v77
 v_cvt_pk_bf16_f32 v123, v78, v79
 s_nop 1
 v_mfma_f32_16x16x32_bf16 v[140:143], v[124:127], v[120:123], 0
 v_mfma_f32_16x16x32_bf16 v[144:147], v[128:131], v[120:123], 0
 v_mfma_f32_16x16x32_bf16 v[148:151], v[120:123], v[120:123], 0
 s_mov_b64 exec, s[82:83]
 buffer_store_dwordx4 v[140:143], v2, s[48:51], s67 offen
 s_nop 1
 buffer_store_dwordx4 v[144:147], v2, s[48:51], s67 offen offset:128
 s_nop 2
 buffer_store_dwordx4 v[148:151], v2, s[48:51], s67 offen offset:1024
 s_mov_b64 exec, -1
 v_smfmac_f32_16x16x64_bf16 v[48:51], v[28:31], a[176:183], v1
 v_smfmac_f32_16x16x64_bf16 v[52:55], v[28:31], a[184:191], v1
 v_mov_b32_dpp v140, v144 row_ror:8 row_mask:0xf bank_mask:0xc
 v_mov_b32_dpp v141, v145 row_ror:8 row_mask:0xf bank_mask:0xc
 v_mov_b32_dpp v142, v146 row_ror:8 row_mask:0xf bank_mask:0xc
 v_mov_b32_dpp v143, v147 row_ror:8 row_mask:0xf bank_mask:0xc
 v_mov_b32 v10, v10
 v_mov_b32 v10, v10
 v_mov_b32 v10, v10
 v_mov_b32 v10, v10
 v_mov_b32 v10, v10
 v_mov_b32 v10, v10
 v_mov_b32 v10, v10
 v_mov_b32 v10, v10
 v_mov_b32 v10, v10
 v_mov_b32 v10, v10
 buffer_load_dwordx4 v[152:155], v2, s[48:51], s68 offen sc1
 buffer_load_dwordx4 v[156:159], v2, s[48:51], s69 offen sc1
 buffer_load_dwordx4 v[160:163], v2, s[48:51], s70 offen sc1
 buffer_load_dword v164, v6, s[48:51], s67 offen sc1
 buffer_load_dword v165, v6, s[48:51], s68 offen sc1
 buffer_load_dword v166, v6, s[48:51], s69 offen sc1
 buffer_load_dword v167, v6, s[48:51], s70 offen sc1
 v_cvt_pk_bf16_f32 v64, v48, v49
 v_cvt_pk_bf16_f32 v65, v50, v51
 v_cvt_pk_bf16_f32 v66, v52, v53
 v_cvt_pk_bf16_f32 v67, v54, v55
 s_barrier
 ds_read_b128 v[96:99], v2 offset:9216
 ds_read_b128 v[100:103], v2 offset:10240
 ds_read_b128 v[104:107], v2 offset:11264
 v_mfma_f32_16x16x32_bf16 v[184:187], v[84:87], v[64:67], 0
 buffer_load_dwordx4 v[168:171], v2, s[48:51], s68 offen sc1
 buffer_load_dwordx4 v[172:175], v2, s[48:51], s69 offen sc1
 buffer_load_dwordx4 v[176:179], v2, s[48:51], s70 offen sc1
 buffer_load_dword v180, v6, s[48:51], s67 offen sc1
 buffer_load_dword v181, v6, s[48:51], s68 offen sc1
 buffer_load_dword v182, v6, s[48:51], s69 offen sc1
 buffer_load_dword v183, v6, s[48:51], s70 offen sc1
 s_waitcnt lgkmcnt(2)
 v_mfma_f32_16x16x32_bf16 v[184:187], v[84:87], v[96:99], v[184:187]
 s_waitcnt lgkmcnt(1)
 v_mfma_f32_16x16x32_bf16 v[184:187], v[84:87], v[100:103], v[184:187]
 s_waitcnt lgkmcnt(0)
 v_mfma_f32_16x16x32_bf16 v[184:187], v[84:87], v[104:107], v[184:187]
 buffer_load_dwordx4 v[16:19], v2, s[48:51], s68 offen sc1
 buffer_load_dwordx4 v[20:23], v2, s[48:51], s69 offen sc1
 buffer_load_dwordx4 v[24:27], v2, s[48:51], s70 offen sc1
 buffer_load_dword v28, v6, s[48:51], s67 offen sc1
 buffer_load_dword v29, v6, s[48:51], s68 offen sc1
 buffer_load_dword v30, v6, s[48:51], s69 offen sc1
 buffer_load_dword v31, v6, s[48:51], s70 offen sc1
 s_nop 0
 v_cvt_pk_bf16_f32 v188, v184, v185
 v_cvt_pk_bf16_f32 v192, v186, v187
 s_waitcnt vmcnt(20)
 v_pk_add_f32 v[228:229], v[140:141], v[152:153]
 v_pk_add_f32 v[230:231], v[142:143], v[154:155]
 s_waitcnt vmcnt(18)
 v_pk_add_f32 v[216:217], v[156:157], v[160:161]
 v_pk_add_f32 v[218:219], v[158:159], v[162:163]
 v_max3_u32 v8, v152, v156, v160
 v_pk_add_f32 v[228:229], v[228:229], v[216:217]
 v_pk_add_f32 v[230:231], v[230:231], v[218:219]
 s_waitcnt vmcnt(14)
 v_max3_u32 v8, v8, v164, v165
 v_max3_u32 v8, v8, v166, v167
 v_cmp_eq_u32 vcc, -1, v8
 v_add_f32 v216, v164, v165
 v_add_f32 v217, v166, v167
 v_max3_f32 v236, v228, v229, v230
 v_add_f32 v232, v216, v217
 v_max3_f32 v236, v236, v231, v232
 s_cbranch_vccnz Ll_redoD
Ll_okD:
 s_nop 0
 v_max_f32_dpp v236, v236, v236 row_ror:8 row_mask:0xf bank_mask:0xf
 v_mov_b32 v216, v236
 s_nop 1
 v_permlane16_swap_b32 v236, v216
 v_max_f32 v236, v236, v216
 v_mov_b32 v216, v236
 s_nop 1
 v_permlane32_swap_b32 v236, v216
 v_max_f32 v236, v236, v216
 v_sub_f32 v232, v232, v236
 v_pk_add_f32 v[228:229], v[228:229], v[236:237] op_sel_hi:[1,0] neg_lo:[0,1] neg_hi:[0,1]
 v_exp_f32 v232, v232
 v_pk_add_f32 v[230:231], v[230:231], v[236:237] op_sel_hi:[1,0] neg_lo:[0,1] neg_hi:[0,1]
 v_exp_f32 v228, v228
 v_mov_b32_dpp v216, v232 row_ror:8 row_mask:0xf bank_mask:0xf
 v_exp_f32 v229, v229
 v_cvt_pk_bf16_f32 v200, v232, v216
 v_exp_f32 v230, v230
 v_exp_f32 v231, v231
 v_mfma_f32_16x16x32_bf16 v[204:207], v[88:91], v[200:203], 0
 v_cvt_pk_bf16_f32 v196, v228, v229
 v_cvt_pk_bf16_f32 v197, v230, v231
 v_mfma_f32_16x16x32_bf16 v[208:211], v[188:191], v[200:203], 0
 v_mov_b32_dpp v198, v196 row_ror:8 row_mask:0xf bank_mask:0xf
 v_mov_b32_dpp v199, v197 row_ror:8 row_mask:0xf bank_mask:0xf
 v_mfma_f32_16x16x32_bf16 v[212:215], v[192:195], v[200:203], 0
 v_mfma_f32_16x16x32_bf16 v[204:207], v[88:91], v[196:199], v[204:207]
 v_mfma_f32_16x16x32_bf16 v[208:211], v[132:135], v[196:199], v[208:211]
 v_mfma_f32_16x16x32_bf16 v[212:215], v[136:139], v[196:199], v[212:215]
 v_rcp_f32 v236, v204
 s_mov_b64 exec, s[82:83]
 s_nop 1
 v_pk_mul_f32 v[208:209], v[208:209], v[236:237] op_sel_hi:[1,0]
 v_pk_mul_f32 v[210:211], v[210:211], v[236:237] op_sel_hi:[1,0]
 v_cvt_pk_bf16_f32 v216, v208, v209
 v_cvt_pk_bf16_f32 v217, v210, v211
 v_pk_mul_f32 v[212:213], v[212:213], v[236:237] op_sel_hi:[1,0]
 v_pk_mul_f32 v[214:215], v[214:215], v[236:237] op_sel_hi:[1,0]
 v_cvt_pk_bf16_f32 v218, v212, v213
 v_cvt_pk_bf16_f32 v219, v214, v215
 buffer_store_dwordx4 v[216:219], v3, s[48:51], s66 offen
 s_mov_b64 exec, -1
 v_mov_b32_dpp v120, v188 quad_perm:[0,1,2,3] row_mask:0xf bank_mask:0x3
 v_mov_b32_dpp v121, v192 quad_perm:[0,1,2,3] row_mask:0xf bank_mask:0x3
 v_mov_b32_dpp v122, v188 row_ror:8 row_mask:0xf bank_mask:0x3
 v_mov_b32_dpp v123, v192 row_ror:8 row_mask:0xf bank_mask:0x3
 s_barrier
 buffer_load_dwordx4 v[16:19], v2, s[48:51], s65 offen offset:0 sc1
 v_mov_b32 v56, 0
 v_mov_b32 v57, 0
 v_mov_b32 v58, 0
 v_mov_b32 v59, 0
 v_mov_b32 v10, v10
 v_mov_b32 v10, v10
 v_mov_b32 v10, v10
 v_mov_b32 v10, v10
 v_mov_b32 v10, v10
 v_mov_b32 v10, v10
 v_mov_b32 v10, v10
 v_mov_b32 v10, v10
 buffer_load_dwordx4 v[20:23], v2, s[48:51], s65 offen offset:1024 sc1
 v_mov_b32 v60, 0
 v_mov_b32 v61, 0
 v_mov_b32 v62, 0
 v_mov_b32 v63, 0
 v_mov_b32 v10, v10
 v_mov_b32 v10, v10
 v_mov_b32 v10, v10
 v_mov_b32 v10, v10
 v_mov_b32 v10, v10
 v_mov_b32 v10, v10
 v_mov_b32 v10, v10
 v_mov_b32 v10, v10
 buffer_load_dwordx4 v[24:27], v2, s[48:51], s65 offen offset:2048 sc1
 v_mov_b32 v68, 0
 v_mov_b32 v69, 0
 v_mov_b32 v70, 0
 v_mov_b32 v71, 0
 v_mov_b32 v10, v10
 v_mov_b32 v10, v10
 v_mov_b32 v10, v10
 v_mov_b32 v10, v10
 v_mov_b32 v10, v10
 v_mov_b32 v10, v10
 v_mov_b32 v10, v10
 v_mov_b32 v10, v10
 buffer_load_dwordx4 v[28:31], v2, s[48:51], s65 offen offset:3072 sc1
LlF_rot:
 s_waitcnt vmcnt(3)
 v_cmp_eq_u32 vcc, -1, v16
 s_cbranch_vccz LlF_got0
 buffer_load_dwordx4 v[16:19], v2, s[48:51], s65 offen offset:0 sc1
 s_waitcnt vmcnt(3)
 v_cmp_eq_u32 vcc, -1, v20
 s_cbranch_vccz LlF_got1
 buffer_load_dwordx4 v[20:23], v2, s[48:51], s65 offen offset:1024 sc1
 s_waitcnt vmcnt(3)
 v_cmp_eq_u32 vcc, -1, v24
 s_cbranch_vccz LlF_got2
 buffer_load_dwordx4 v[24:27], v2, s[48:51], s65 offen offset:2048 sc1
 s_waitcnt vmcnt(3)
 v_cmp_eq_u32 vcc, -1, v28
 s_cbranch_vccz LlF_got3
 buffer_load_dwordx4 v[28:31], v2, s[48:51], s65 offen offset:3072 sc1
 s_sub_u32 s46, s46, 1
 s_cbranch_scc0 LlF_rot
 s_mov_b32 s46, 0
 s_branch LlF_late
LlF_redo:
 buffer_load_dwordx4 v[16:19], v2, s[48:51], s65 offen offset:0 sc1
 buffer_load_dwordx4 v[20:23], v2, s[48:51], s65 offen offset:1024 sc1
 buffer_load_dwordx4 v[24:27], v2, s[48:51], s65 offen offset:2048 sc1
 buffer_load_dwordx4 v[28:31], v2, s[48:51], s65 offen offset:3072 sc1
 v_mov_b64 v[56:57], 0
 v_mov_b64 v[58:59], 0
 v_mov_b64 v[60:61], 0
 v_mov_b64 v[62:63], 0
 s_branch LlF_rot
LlF_late:
 s_waitcnt vmcnt(3)
LlF_got0:
 v_smfmac_f32_16x16x64_bf16 v[56:59], v[16:19], a[192:199], v1
 v_smfmac_f32_16x16x64_bf16 v[60:63], v[16:19], a[200:207], v1
 s_waitcnt vmcnt(2)
 v_smfmac_f32_16x16x64_bf16 v[56:59], v[20:23], a[208:215], v1
 v_mov_b32 v8, v20
 v_smfmac_f32_16x16x64_bf16 v[60:63], v[20:23], a[216:223], v1
 s_waitcnt vmcnt(1)
 v_smfmac_f32_16x16x64_bf16 v[56:59], v[24:27], a[224:231], v1
 v_max_u32 v8, v8, v24
 v_smfmac_f32_16x16x64_bf16 v[60:63], v[24:27], a[232:239], v1
 s_waitcnt vmcnt(0)
 v_smfmac_f32_16x16x64_bf16 v[56:59], v[28:31], a[240:247], v1
 v_max_u32 v8, v8, v28
 v_cmp_eq_u32 vcc, -1, v8
 v_smfmac_f32_16x16x64_bf16 v[60:63], v[28:31], a[248:255], v1
 s_cbranch_vccnz LlF_bad0
LlF_ok0:
 s_nop 2
 v_cvt_pk_bf16_f32 v64, v56, v57
 v_cvt_pk_bf16_f32 v65, v58, v59
 s_nop 1
 v_cvt_pk_bf16_f32 v66, v60, v61
 v_cvt_pk_bf16_f32 v67, v62, v63
 s_branch LlF_join
LlF_bad0:
 s_sub_u32 s46, s46, 1
 s_cbranch_scc0 LlF_redo
 s_mov_b32 s46, 0
 s_branch LlF_ok0
LlF_got1:
 v_smfmac_f32_16x16x64_bf16 v[56:59], v[20:23], a[208:215], v1
 v_smfmac_f32_16x16x64_bf16 v[60:63], v[20:23], a[216:223], v1
 s_waitcnt vmcnt(2)
 v_smfmac_f32_16x16x64_bf16 v[56:59], v[24:27], a[224:231], v1
 v_mov_b32 v8, v24
 v_smfmac_f32_16x16x64_bf16 v[60:63], v[24:27], a[232:239], v1
 s_waitcnt vmcnt(1)
 v_smfmac_f32_16x16x64_bf16 v[56:59], v[28:31], a[240:247], v1
 v_max_u32 v8, v8, v28
 v_smfmac_f32_16x16x64_bf16 v[60:63], v[28:31], a[248:255], v1
 s_waitcnt vmcnt(0)
 v_smfmac_f32_16x16x64_bf16 v[56:59], v[16:19], a[192:199], v1
 v_max_u32 v8, v8, v16
 v_cmp_eq_u32 vcc, -1, v8
 v_smfmac_f32_16x16x64_bf16 v[60:63], v[16:19], a[200:207], v1
 s_cbranch_vccnz LlF_bad1
LlF_ok1:
 s_nop 2
 v_cvt_pk_bf16_f32 v64, v56, v57
 v_cvt_pk_bf16_f32 v65, v58, v59
 s_nop 1
 v_cvt_pk_bf16_f32 v66, v60, v61
 v_cvt_pk_bf16_f32 v67, v62, v63
 s_branch LlF_join
LlF_bad1:
 s_sub_u32 s46, s46, 1
 s_cbranch_scc0 LlF_redo
 s_mov_b32 s46, 0
 s_branch LlF_ok1
LlF_got2:
 v_smfmac_f32_16x16x64_bf16 v[56:59], v[24:27], a[224:231], v1
 v_smfmac_f32_16x16x64_bf16 v[60:63], v[24:27], a[232:239], v1
 s_waitcnt vmcnt(2)
 v_smfmac_f32_16x16x64_bf16 v[56:59], v[28:31], a[240:247], v1
 v_mov_b32 v8, v28
 v_smfmac_f32_16x16x64_bf16 v[60:63], v[28:31], a[248:255], v1
 s_waitcnt vmcnt(1)
 v_smfmac_f32_16x16x64_bf16 v[56:59], v[16:19], a[192:199], v1
 v_max_u32 v8, v8, v16
 v_smfmac_f32_16x16x64_bf16 v[60:63], v[16:19], a[200:207], v1
 s_waitcnt vmcnt(0)
 v_smfmac_f32_16x16x64_bf16 v[56:59], v[20:23], a[208:215], v1
 v_max_u32 v8, v8, v20
 v_cmp_eq_u32 vcc, -1, v8
 v_smfmac_f32_16x16x64_bf16 v[60:63], v[20:23], a[216:223], v1
 s_cbranch_vccnz LlF_bad2
LlF_ok2:
 s_nop 2
 v_cvt_pk_bf16_f32 v64, v56, v57
 v_cvt_pk_bf16_f32 v65, v58, v59
 s_nop 1
 v_cvt_pk_bf16_f32 v66, v60, v61
 v_cvt_pk_bf16_f32 v67, v62, v63
 s_branch LlF_join
LlF_bad2:
 s_sub_u32 s46, s46, 1
 s_cbranch_scc0 LlF_redo
 s_mov_b32 s46, 0
 s_branch LlF_ok2
LlF_got3:
 v_smfmac_f32_16x16x64_bf16 v[56:59], v[28:31], a[240:247], v1
 v_smfmac_f32_16x16x64_bf16 v[60:63], v[28:31], a[248:255], v1
 s_waitcnt vmcnt(2)
 v_smfmac_f32_16x16x64_bf16 v[56:59], v[16:19], a[192:199], v1
 v_mov_b32 v8, v16
 v_smfmac_f32_16x16x64_bf16 v[60:63], v[16:19], a[200:207], v1
 s_waitcnt vmcnt(1)
 v_smfmac_f32_16x16x64_bf16 v[56:59], v[20:23], a[208:215], v1
 v_max_u32 v8, v8, v20
 v_smfmac_f32_16x16x64_bf16 v[60:63], v[20:23], a[216:223], v1
 s_waitcnt vmcnt(0)
 v_smfmac_f32_16x16x64_bf16 v[56:59], v[24:27], a[224:231], v1
 v_max_u32 v8, v8, v24
 v_cmp_eq_u32 vcc, -1, v8
 v_smfmac_f32_16x16x64_bf16 v[60:63], v[24:27], a[232:239], v1
 s_cbranch_vccnz LlF_bad3
LlF_ok3:
 s_nop 2
 v_cvt_pk_bf16_f32 v64, v56, v57
 v_cvt_pk_bf16_f32 v65, v58, v59
 s_nop 1
 v_cvt_pk_bf16_f32 v66, v60, v61
 v_cvt_pk_bf16_f32 v67, v62, v63
 s_branch LlF_join
LlF_bad3:
 s_sub_u32 s46, s46, 1
 s_cbranch_scc0 LlF_redo
 s_mov_b32 s46, 0
 s_branch LlF_ok3
LlF_join:
 s_nop 0
 v_mfma_f32_16x16x32_bf16 v[224:227], v[64:67], v[80:83], 0
 s_barrier
 ds_read_b128 v[96:99], v2 offset:13312
 ds_read_b128 v[100:103], v2 offset:14336
 ds_read_b128 v[104:107], v2 offset:15360
 buffer_store_dwordx4 v[120:123], v2, s[48:51], s77 offen sc1
 s_waitcnt lgkmcnt(2)
 v_mfma_f32_16x16x32_bf16 v[224:227], v[96:99], v[80:83], v[224:227]
 s_waitcnt lgkmcnt(1)
 v_mfma_f32_16x16x32_bf16 v[224:227], v[100:103], v[80:83], v[224:227]
 s_waitcnt lgkmcnt(0)
 v_mfma_f32_16x16x32_bf16 v[224:227], v[104:107], v[80:83], v[224:227]
 s_nop 7
 v_cvt_pk_bf16_f32 v216, v224, v225
 v_cvt_pk_bf16_f32 v217, v226, v227
 buffer_store_dwordx2 v[216:217], v233, s[48:51], s72 offen offset:0 sc1
 buffer_store_dwordx2 v[216:217], v233, s[48:51], s72 offen offset:512 sc1
 s_xor_b32 s66, s66, 0x4000
 s_xor_b32 s79, s64, 0x4000
 buffer_store_dwordx2 v[92:93], v4, s[48:51], s66 offen
 buffer_store_dwordx2 v[92:93], v4, s[48:51], s79 offen
 buffer_store_dwordx4 v[92:95], v2, s[48:51], s67 offen
 buffer_store_dwordx4 v[92:95], v2, s[48:51], s67 offen offset:1024
 v_mov_b32 v10, v10
 v_mov_b32 v10, v10
 v_mov_b32 v10, v10
 v_mov_b32 v10, v10
 v_mov_b32 v10, v10
 v_mov_b32 v10, v10
 v_mov_b32 v10, v10
 v_mov_b32 v10, v10
 v_mov_b32 v10, v10
 v_mov_b32 v10, v10
 v_mov_b32 v10, v10
 v_mov_b32 v10, v10
 v_mov_b32 v10, v10
 v_mov_b32 v10, v10
 v_mov_b32 v10, v10
 v_mov_b32 v10, v10
 v_mov_b32 v10, v10
 v_mov_b32 v10, v10
 v_mov_b32 v10, v10
 v_mov_b32 v10, v10
 v_mov_b32 v10, v10
 v_mov_b32 v10, v10
 v_mov_b32 v10, v10
 v_mov_b32 v10, v10
 v_mov_b32 v10, v10
 v_mov_b32 v10, v10
 v_mov_b32 v10, v10
 v_mov_b32 v10, v10
 v_mov_b32 v10, v10
 v_mov_b32 v10, v10
 v_mov_b32 v10, v10
 v_mov_b32 v10, v10
 v_mov_b32 v10, v10
 v_mov_b32 v10, v10
 v_mov_b32 v10, v10
 v_mov_b32 v10, v10
 v_mov_b32 v10, v10
 v_mov_b32 v10, v10
 v_mov_b32 v10, v10
 v_mov_b32 v10, v10
 v_mov_b32 v10, v10
 v_mov_b32 v10, v10
 v_mov_b32 v10, v10
 v_mov_b32 v10, v10
 v_mov_b32 v10, v10
 v_mov_b32 v10, v10
 v_mov_b32 v10, v10
 v_mov_b32 v10, v10
 v_mov_b32 v10, v10
 v_mov_b32 v10, v10
 v_mov_b32 v10, v10
 v_mov_b32 v10, v10
 v_mov_b32 v10, v10
 v_mov_b32 v10, v10
 v_mov_b32 v10, v10
 buffer_load_dwordx2 v[152:153], v233, s[48:51], s73 offen offset:0 sc1
 buffer_load_dwordx2 v[154:155], v233, s[48:51], s74 offen offset:0 sc1
 buffer_load_dwordx2 v[156:157], v233, s[48:51], s75 offen offset:0 sc1
 v_mov_b32 v10, v10
 v_mov_b32 v10, v10
 v_mov_b32 v10, v10
 v_mov_b32 v10, v10
 v_mov_b32 v10, v10
 v_mov_b32 v10, v10
 v_mov_b32 v10, v10
 v_mov_b32 v10, v10
 v_mov_b32 v10, v10
 v_mov_b32 v10, v10
 v_mov_b32 v10, v10
 v_mov_b32 v10, v10
 v_mov_b32 v10, v10
 v_mov_b32 v10, v10
 v_mov_b32 v10, v10
 v_mov_b32 v10, v10
 v_mov_b32 v10, v10
 v_mov_b32 v10, v10
 v_mov_b32 v10, v10
 v_mov_b32 v10, v10
 v_mov_b32 v10, v10
 v_mov_b32 v10, v10
 v_mov_b32 v10, v10
 v_mov_b32 v10, v10
 v_mov_b32 v10, v10
 v_mov_b32 v10, v10
 v_mov_b32 v10, v10
 v_mov_b32 v10, v10
 v_mov_b32 v10, v10
 v_mov_b32 v10, v10
 v_mov_b32 v10, v10
 v_mov_b32 v10, v10
 v_mov_b32 v10, v10
 v_mov_b32 v10, v10
 v_mov_b32 v10, v10
 v_mov_b32 v10, v10
 v_mov_b32 v10, v10
 v_mov_b32 v10, v10
 v_mov_b32 v10, v10
 v_mov_b32 v10, v10
 v_mov_b32 v10, v10
 v_mov_b32 v10, v10
 v_mov_b32 v10, v10
 v_mov_b32 v10, v10
 v_mov_b32 v10, v10
 buffer_load_dwordx2 v[158:159], v233, s[48:51], s73 offen offset:512 sc1
 buffer_load_dwordx2 v[160:161], v233, s[48:51], s74 offen offset:512 sc1
 buffer_load_dwordx2 v[162:163], v233, s[48:51], s75 offen offset:512 sc1
 s_waitcnt vmcnt(5)
 v_lshlrev_b32 v216, 16, v152
 v_and_b32 v217, 0xffff0000, v152
 v_lshlrev_b32 v218, 16, v153
 v_and_b32 v219, 0xffff0000, v153
 v_pk_add_f32 v[228:229], v[224:225], v[216:217]
 v_pk_add_f32 v[230:231], v[226:227], v[218:219]
 s_waitcnt vmcnt(4)
 v_lshlrev_b32 v216, 16, v154
 v_and_b32 v217, 0xffff0000, v154
 v_lshlrev_b32 v218, 16, v155
 v_and_b32 v219, 0xffff0000, v155
 v_pk_add_f32 v[228:229], v[228:229], v[216:217]
 v_pk_add_f32 v[230:231], v[230:231], v[218:219]
 s_waitcnt vmcnt(3)
 v_max3_u32 v8, v152, v154, v156
 v_cmp_eq_u32 vcc, -1, v8
 v_lshlrev_b32 v216, 16, v156
 v_and_b32 v217, 0xffff0000, v156
 v_lshlrev_b32 v218, 16, v157
 v_and_b32 v219, 0xffff0000, v157
 v_pk_add_f32 v[228:229], v[228:229], v[216:217]
 v_pk_add_f32 v[230:231], v[230:231], v[218:219]
 v_cvt_pk_bf16_f32 v220, v228, v229
 v_cvt_pk_bf16_f32 v221, v230, v231
 s_cbranch_vccnz Ll_redoH
Ll_okH:
 buffer_store_dwordx2 v[220:221], v4, s[48:51], s64 offen
 s_add_u32 s60, s60, 1
 s_xor_b32 s64, s64, 0x4000
 s_xor_b32 s63, s63, 0x4000
 s_xor_b32 s65, s65, 0x4000
 s_lshl_b32 s79, s60, 18
 s_and_b32 s80, s60, 8
 s_lshl_b32 s80, s80, 10
 s_add_u32 s72, s71, s79
 s_xor_b32 s72, s72, s80
 s_add_u32 s77, s87, s79
 s_xor_b32 s77, s77, s80
 s_xor_b32 s73, s72, 1024
 s_xor_b32 s74, s72, 2048
 s_xor_b32 s75, s72, 3072
 s_branch Ll_step
Ll_redoD:
 s_waitcnt vmcnt(13)
 v_pk_add_f32 v[228:229], v[140:141], v[168:169]
 v_pk_add_f32 v[230:231], v[142:143], v[170:171]
 s_waitcnt vmcnt(11)
 v_pk_add_f32 v[216:217], v[172:173], v[176:177]
 v_pk_add_f32 v[218:219], v[174:175], v[178:179]
 v_max3_u32 v8, v168, v172, v176
 v_pk_add_f32 v[228:229], v[228:229], v[216:217]
 v_pk_add_f32 v[230:231], v[230:231], v[218:219]
 s_waitcnt vmcnt(7)
 v_max3_u32 v8, v8, v180, v181
 v_max3_u32 v8, v8, v182, v183
 v_cmp_eq_u32 vcc, -1, v8
 v_add_f32 v216, v180, v181
 v_add_f32 v217, v182, v183
 v_max3_f32 v236, v228, v229, v230
 v_add_f32 v232, v216, v217
 v_max3_f32 v236, v236, v231, v232
 s_cbranch_vccz Ll_okD
 buffer_load_dwordx4 v[152:155], v2, s[48:51], s68 offen sc1
 buffer_load_dwordx4 v[156:159], v2, s[48:51], s69 offen sc1
 buffer_load_dwordx4 v[160:163], v2, s[48:51], s70 offen sc1
 buffer_load_dword v164, v6, s[48:51], s67 offen sc1
 buffer_load_dword v165, v6, s[48:51], s68 offen sc1
 buffer_load_dword v166, v6, s[48:51], s69 offen sc1
 buffer_load_dword v167, v6, s[48:51], s70 offen sc1
 s_waitcnt vmcnt(13)
 v_pk_add_f32 v[228:229], v[140:141], v[16:17]
 v_pk_add_f32 v[230:231], v[142:143], v[18:19]
 s_waitcnt vmcnt(11)
 v_pk_add_f32 v[216:217], v[20:21], v[24:25]
 v_pk_add_f32 v[218:219], v[22:23], v[26:27]
 v_max3_u32 v8, v16, v20, v24
 v_pk_add_f32 v[228:229], v[228:229], v[216:217]
 v_pk_add_f32 v[230:231], v[230:231], v[218:219]
 s_waitcnt vmcnt(7)
 v_max3_u32 v8, v8, v28, v29
 v_max3_u32 v8, v8, v30, v31
 v_cmp_eq_u32 vcc, -1, v8
 v_add_f32 v216, v28, v29
 v_add_f32 v217, v30, v31
 v_max3_f32 v236, v228, v229, v230
 v_add_f32 v232, v216, v217
 v_max3_f32 v236, v236, v231, v232
 s_cbranch_vccz Ll_okD
top_10:
 buffer_load_dwordx4 v[168:171], v2, s[48:51], s68 offen sc1
 buffer_load_dwordx4 v[172:175], v2, s[48:51], s69 offen sc1
 buffer_load_dwordx4 v[176:179], v2, s[48:51], s70 offen sc1
 buffer_load_dword v180, v6, s[48:51], s67 offen sc1
 buffer_load_dword v181, v6, s[48:51], s68 offen sc1
 buffer_load_dword v182, v6, s[48:51], s69 offen sc1
 buffer_load_dword v183, v6, s[48:51], s70 offen sc1
 s_waitcnt vmcnt(13)
 v_pk_add_f32 v[228:229], v[140:141], v[152:153]
 v_pk_add_f32 v[230:231], v[142:143], v[154:155]
 s_waitcnt vmcnt(11)
 v_pk_add_f32 v[216:217], v[156:157], v[160:161]
 v_pk_add_f32 v[218:219], v[158:159], v[162:163]
 v_max3_u32 v8, v152, v156, v160
 v_pk_add_f32 v[228:229], v[228:229], v[216:217]
 v_pk_add_f32 v[230:231], v[230:231], v[218:219]
 s_waitcnt vmcnt(7)
 v_max3_u32 v8, v8, v164, v165
 v_max3_u32 v8, v8, v166, v167
 v_cmp_eq_u32 vcc, -1, v8
 v_add_f32 v216, v164, v165
 v_add_f32 v217, v166, v167
 v_max3_f32 v236, v228, v229, v230
 v_add_f32 v232, v216, v217
 v_max3_f32 v236, v236, v231, v232
 s_cbranch_vccz Ll_okD
 buffer_load_dwordx4 v[152:155], v2, s[48:51], s68 offen sc1
 buffer_load_dwordx4 v[156:159], v2, s[48:51], s69 offen sc1
 buffer_load_dwordx4 v[160:163], v2, s[48:51], s70 offen sc1
 buffer_load_dword v164, v6, s[48:51], s67 offen sc1
 buffer_load_dword v165, v6, s[48:51], s68 offen sc1
 buffer_load_dword v166, v6, s[48:51], s69 offen sc1
 buffer_load_dword v167, v6, s[48:51], s70 offen sc1
 s_waitcnt vmcnt(13)
 v_pk_add_f32 v[228:229], v[140:141], v[168:169]
 v_pk_add_f32 v[230:231], v[142:143], v[170:171]
 s_waitcnt vmcnt(11)
 v_pk_add_f32 v[216:217], v[172:173], v[176:177]
 v_pk_add_f32 v[218:219], v[174:175], v[178:179]
 v_max3_u32 v8, v168, v172, v176
 v_pk_add_f32 v[228:229], v[228:229], v[216:217]
 v_pk_add_f32 v[230:231], v[230:231], v[218:219]
 s_waitcnt vmcnt(7)
 v_max3_u32 v8, v8, v180, v181
 v_max3_u32 v8, v8, v182, v183
 v_cmp_eq_u32 vcc, -1, v8
 v_add_f32 v216, v180, v181
 v_add_f32 v217, v182, v183
 v_max3_f32 v236, v228, v229, v230
 v_add_f32 v232, v216, v217
 v_max3_f32 v236, v236, v231, v232
 s_cbranch_vccz Ll_okD
 s_sub_u32 s46, s46, 1
 s_cbranch_scc0 top_10
 s_mov_b32 s46, 0
 s_branch Ll_okD
Ll_redoH:
top_11:
 buffer_load_dwordx2 v[152:153], v233, s[48:51], s73 offen offset:0 sc1
 buffer_load_dwordx2 v[154:155], v233, s[48:51], s74 offen offset:0 sc1
 buffer_load_dwordx2 v[156:157], v233, s[48:51], s75 offen offset:0 sc1
 s_waitcnt vmcnt(3)
 v_max3_u32 v8, v158, v160, v162
 v_cmp_eq_u32 vcc, -1, v8
 s_cbranch_vccz Ll_sumH1
 buffer_load_dwordx2 v[158:159], v233, s[48:51], s73 offen offset:512 sc1
 buffer_load_dwordx2 v[160:161], v233, s[48:51], s74 offen offset:512 sc1
 buffer_load_dwordx2 v[162:163], v233, s[48:51], s75 offen offset:512 sc1
 s_waitcnt vmcnt(3)
 v_max3_u32 v8, v152, v154, v156
 v_cmp_eq_u32 vcc, -1, v8
 s_cbranch_vccz Ll_sumH0
 s_sub_u32 s46, s46, 1
 s_cbranch_scc0 top_11
 s_mov_b32 s46, 0
 s_branch Ll_okH
Ll_sumH0:
 v_lshlrev_b32 v216, 16, v152
 v_and_b32 v217, 0xffff0000, v152
 v_lshlrev_b32 v218, 16, v153
 v_and_b32 v219, 0xffff0000, v153
 v_pk_add_f32 v[228:229], v[224:225], v[216:217]
 v_pk_add_f32 v[230:231], v[226:227], v[218:219]
 v_lshlrev_b32 v216, 16, v154
 v_and_b32 v217, 0xffff0000, v154
 v_lshlrev_b32 v218, 16, v155
 v_and_b32 v219, 0xffff0000, v155
 v_pk_add_f32 v[228:229], v[228:229], v[216:217]
 v_pk_add_f32 v[230:231], v[230:231], v[218:219]
 v_lshlrev_b32 v216, 16, v156
 v_and_b32 v217, 0xffff0000, v156
 v_lshlrev_b32 v218, 16, v157
 v_and_b32 v219, 0xffff0000, v157
 v_pk_add_f32 v[228:229], v[228:229], v[216:217]
 v_pk_add_f32 v[230:231], v[230:231], v[218:219]
 v_cvt_pk_bf16_f32 v220, v228, v229
 v_cvt_pk_bf16_f32 v221, v230, v231
 s_branch Ll_okH
Ll_sumH1:
 v_lshlrev_b32 v216, 16, v158
 v_and_b32 v217, 0xffff0000, v158
 v_lshlrev_b32 v218, 16, v159
 v_and_b32 v219, 0xffff0000, v159
 v_pk_add_f32 v[228:229], v[224:225], v[216:217]
 v_pk_add_f32 v[230:231], v[226:227], v[218:219]
 v_lshlrev_b32 v216, 16, v160
 v_and_b32 v217, 0xffff0000, v160
 v_lshlrev_b32 v218, 16, v161
 v_and_b32 v219, 0xffff0000, v161
 v_pk_add_f32 v[228:229], v[228:229], v[216:217]
 v_pk_add_f32 v[230:231], v[230:231], v[218:219]
 v_lshlrev_b32 v216, 16, v162
 v_and_b32 v217, 0xffff0000, v162
 v_lshlrev_b32 v218, 16, v163
 v_and_b32 v219, 0xffff0000, v163
 v_pk_add_f32 v[228:229], v[228:229], v[216:217]
 v_pk_add_f32 v[230:231], v[230:231], v[218:219]
 v_cvt_pk_bf16_f32 v220, v228, v229
 v_cvt_pk_bf16_f32 v221, v230, v231
 s_branch Ll_okH
Ll_last:
 v_smfmac_f32_16x16x64_bf16 v[52:55], v[24:27], a[168:175], v1
 v_smfmac_f32_16x16x64_bf16 v[48:51], v[28:31], a[176:183], v1
 v_smfmac_f32_16x16x64_bf16 v[52:55], v[28:31], a[184:191], v1
 s_barrier
 ds_read_b128 v[96:99], v2 offset:1024
 ds_read_b128 v[100:103], v2 offset:2048
 ds_read_b128 v[104:107], v2 offset:3072
 ds_read_b128 v[108:111], v2 offset:5120
 ds_read_b128 v[112:115], v2 offset:6144
 ds_read_b128 v[116:119], v2 offset:7168
 s_waitcnt lgkmcnt(5)
 v_pk_fma_f32 v[72:73], v[96:97], v[12:13], v[72:73]
 v_pk_fma_f32 v[74:75], v[98:99], v[12:13], v[74:75]
 s_waitcnt lgkmcnt(3)
 v_pk_fma_f32 v[72:73], v[100:101], v[12:13], v[72:73]
 v_pk_fma_f32 v[74:75], v[102:103], v[12:13], v[74:75]
 v_pk_fma_f32 v[72:73], v[104:105], v[12:13], v[72:73]
 v_pk_fma_f32 v[74:75], v[106:107], v[12:13], v[74:75]
 v_cvt_pk_bf16_f32 v120, v72, v73
 v_cvt_pk_bf16_f32 v121, v74, v75
 s_waitcnt lgkmcnt(0)
 v_pk_fma_f32 v[76:77], v[108:109], v[12:13], v[76:77]
 v_pk_fma_f32 v[78:79], v[110:111], v[12:13], v[78:79]
 v_pk_fma_f32 v[76:77], v[112:113], v[12:13], v[76:77]
 v_pk_fma_f32 v[78:79], v[114:115], v[12:13], v[78:79]
 v_pk_fma_f32 v[76:77], v[116:117], v[12:13], v[76:77]
 v_pk_fma_f32 v[78:79], v[118:119], v[12:13], v[78:79]
 v_cvt_pk_bf16_f32 v122, v76, v77
 v_cvt_pk_bf16_f32 v123, v78, v79
 v_mov_b32 v10, s60
 v_mov_b32 v11, 4096
 s_mov_b64 exec, 1
 buffer_store_dword v10, v11, s[48:51], s78 offen sc1
 s_mov_b64 exec, -1
 v_cvt_pk_bf16_f32 v64, v48, v49
 v_cvt_pk_bf16_f32 v65, v50, v51
 v_cvt_pk_bf16_f32 v66, v52, v53
 v_cvt_pk_bf16_f32 v67, v54, v55
 s_barrier
 ds_read_b128 v[96:99], v2 offset:9216
 ds_read_b128 v[100:103], v2 offset:10240
 ds_read_b128 v[104:107], v2 offset:11264
 v_mfma_f32_16x16x32_bf16 v[184:187], v[84:87], v[64:67], 0
 s_waitcnt lgkmcnt(2)
 v_mfma_f32_16x16x32_bf16 v[184:187], v[84:87], v[96:99], v[184:187]
 s_waitcnt lgkmcnt(1)
 v_mfma_f32_16x16x32_bf16 v[184:187], v[84:87], v[100:103], v[184:187]
 s_waitcnt lgkmcnt(0)
 v_mfma_f32_16x16x32_bf16 v[184:187], v[84:87], v[104:107], v[184:187]
 s_nop 7
 v_cvt_pk_bf16_f32 v188, v184, v185
 v_cvt_pk_bf16_f32 v192, v186, v187
 s_nop 0
 v_mov_b32_dpp v120, v188 quad_perm:[0,1,2,3] row_mask:0xf bank_mask:0x3
 v_mov_b32_dpp v121, v192 quad_perm:[0,1,2,3] row_mask:0xf bank_mask:0x3
 v_mov_b32_dpp v122, v188 row_ror:8 row_mask:0xf bank_mask:0x3
 v_mov_b32_dpp v123, v192 row_ror:8 row_mask:0xf bank_mask:0x3
 buffer_store_dwordx4 v[120:123], v2, s[48:51], s77 offen sc1
 s_waitcnt vmcnt(0)
 v_mov_b32 v10, 64
 v_mov_b32 v11, 4096
 s_mov_b64 exec, 1
 buffer_store_dword v10, v11, s[48:51], s78 offen sc1
 s_mov_b64 exec, -1
 s_branch L_chain_done
L_chain_done:
 s_endpgm
L_worker:
 s_lshr_b32 s60, s6, 3
 s_and_b32 s61, s6, 7
 s_lshl_b32 s62, s47, 3
 s_add_u32 s62, s62, s61
 v_lshlrev_b32 v1, 4, v0
 s_mov_b32 s63, 0
 s_mov_b32 s64, 0
 s_mov_b32 s65, 8388608
 s_lshl_b32 s68, s62, 7
 s_lshl_b32 s69, s4, 4
 s_add_u32 s68, s68, s69
 s_lshl_b32 s69, s60, 2
 s_add_u32 s68, s68, s69
 s_add_u32 s68, s68, 3145728
 s_lshl_b32 s69, s47, 2
 s_add_u32 s69, s69, s4
 s_lshl_b32 s69, s69, 7
 s_lshl_b32 s70, s61, 2
 s_add_u32 s69, s69, s70
 s_add_u32 s69, s69, 3153920
 s_cmp_eq_u32 s60, 2
 s_cselect_b32 s68, s69, s68
 s_add_u32 s69, s70, s4
 s_lshl_b32 s69, s69, 7
 s_lshl_b32 s70, s47, 2
 s_add_u32 s69, s69, s70
 s_add_u32 s69, s69, 3162112
 s_cmp_eq_u32 s60, 3
 s_cselect_b32 s68, s69, s68
 s_mov_b32 s70, 0
 v_mov_b32 v3, s70
 v_mov_b32 v4, 0
 s_mov_b64 exec, 1
 buffer_store_dword v3, v4, s[48:51], s68 offen sc1
 s_mov_b64 exec, -1
Lw_noclr:
 s_cmp_eq_u32 s60, 3
 s_cbranch_scc0 Lw_nopoi
 s_mov_b32 s56, s8
 s_and_b32 s57, s9, 0xffff
 s_mov_b32 s58, 4194304
 s_mov_b32 s59, 0x20000
 s_add_u32 s70, s61, 0
 s_lshl_b32 s70, s70, 2
 s_add_u32 s70, s70, s47
 s_lshl_b32 s70, s70, 16
 v_lshrrev_b32 v3, 3, v0
 s_lshl_b32 s69, s4, 3
 v_add_u32 v3, s69, v3
 v_bfe_u32 v4, v3, 1, 3
 v_and_b32 v208, 7, v0
 v_xor_b32 v208, v208, v4
 v_lshlrev_b32 v208, 4, v208
 v_lshl_add_u32 v208, v3, 11, v208
 s_lshl_b32 s71, s4, 10
 s_add_u32 m0, s71, 0
 s_nop 0
 buffer_load_dwordx4 v208, s[56:59], s70 offen offset:0 nt lds
 s_add_u32 m0, s71, 3968
 s_nop 0
 buffer_load_dwordx4 v208, s[56:59], s70 offen offset:128 nt lds
 s_add_u32 m0, s71, 7936
 s_nop 0
 buffer_load_dwordx4 v208, s[56:59], s70 offen offset:256 nt lds
 s_add_u32 m0, s71, 11904
 s_nop 0
 buffer_load_dwordx4 v208, s[56:59], s70 offen offset:384 nt lds
 s_add_u32 m0, s71, 15872
 s_nop 0
 buffer_load_dwordx4 v208, s[56:59], s70 offen offset:512 nt lds
 s_add_u32 m0, s71, 19840
 s_nop 0
 buffer_load_dwordx4 v208, s[56:59], s70 offen offset:640 nt lds
 s_add_u32 m0, s71, 23808
 s_nop 0
 buffer_load_dwordx4 v208, s[56:59], s70 offen offset:768 nt lds
 s_add_u32 m0, s71, 27776
 s_nop 0
 buffer_load_dwordx4 v208, s[56:59], s70 offen offset:896 nt lds
 s_add_u32 m0, s71, 31744
 s_nop 0
 buffer_load_dwordx4 v208, s[56:59], s70 offen offset:1024 nt lds
 s_add_u32 m0, s71, 35712
 s_nop 0
 buffer_load_dwordx4 v208, s[56:59], s70 offen offset:1152 nt lds
 s_add_u32 m0, s71, 39680
 s_nop 0
 buffer_load_dwordx4 v208, s[56:59], s70 offen offset:1280 nt lds
 s_add_u32 m0, s71, 43648
 s_nop 0
 buffer_load_dwordx4 v208, s[56:59], s70 offen offset:1408 nt lds
 s_add_u32 m0, s71, 47616
 s_nop 0
 buffer_load_dwordx4 v208, s[56:59], s70 offen offset:1536 nt lds
 s_add_u32 m0, s71, 51584
 s_nop 0
 buffer_load_dwordx4 v208, s[56:59], s70 offen offset:1664 nt lds
 s_add_u32 m0, s71, 55552
 s_nop 0
 buffer_load_dwordx4 v208, s[56:59], s70 offen offset:1792 nt lds
 s_add_u32 m0, s71, 59520
 s_nop 0
 buffer_load_dwordx4 v208, s[56:59], s70 offen offset:1920 nt lds
 v_and_b32 v3, 31, v0
 s_lshl_b32 s69, s4, 14
 v_lshl_add_u32 v224, v3, 7, s69
 v_bfe_u32 v4, v3, 1, 3
 v_lshrrev_b32 v3, 5, v0
 s_add_u32 s70, s70, s69
 v_add_u32 v225, 0, v3
 v_xor_b32 v225, v225, v4
 v_lshl_add_u32 v209, v225, 4, v224
 v_add_u32 v225, 2, v3
 v_xor_b32 v225, v225, v4
 v_lshl_add_u32 v210, v225, 4, v224
 v_add_u32 v225, 4, v3
 v_xor_b32 v225, v225, v4
 v_lshl_add_u32 v211, v225, 4, v224
 v_add_u32 v225, 6, v3
 v_xor_b32 v225, v225, v4
 v_lshl_add_u32 v212, v225, 4, v224
 s_waitcnt vmcnt(0)
 s_barrier
 ds_read_b128 v[16:19], v209 offset:0
 ds_read_b128 v[20:23], v210 offset:0
 ds_read_b128 v[24:27], v211 offset:0
 ds_read_b128 v[28:31], v212 offset:0
 ds_read_b128 v[32:35], v209 offset:4096
 ds_read_b128 v[36:39], v210 offset:4096
 ds_read_b128 v[40:43], v211 offset:4096
 ds_read_b128 v[44:47], v212 offset:4096
 s_add_u32 s71, s70, 8388608
 s_waitcnt lgkmcnt(7)
 buffer_store_dwordx4 v[16:19], v1, s[48:51], s71 offen offset:0 sc1
 s_waitcnt lgkmcnt(6)
 buffer_store_dwordx4 v[20:23], v1, s[48:51], s71 offen offset:1024 sc1
 s_waitcnt lgkmcnt(5)
 buffer_store_dwordx4 v[24:27], v1, s[48:51], s71 offen offset:2048 sc1
 s_waitcnt lgkmcnt(4)
 buffer_store_dwordx4 v[28:31], v1, s[48:51], s71 offen offset:3072 sc1
 s_add_u32 s71, s70, 8392704
 s_waitcnt lgkmcnt(3)
 buffer_store_dwordx4 v[32:35], v1, s[48:51], s71 offen offset:0 sc1
 s_waitcnt lgkmcnt(2)
 buffer_store_dwordx4 v[36:39], v1, s[48:51], s71 offen offset:1024 sc1
 s_waitcnt lgkmcnt(1)
 buffer_store_dwordx4 v[40:43], v1, s[48:51], s71 offen offset:2048 sc1
 s_waitcnt lgkmcnt(0)
 buffer_store_dwordx4 v[44:47], v1, s[48:51], s71 offen offset:3072 sc1
 ds_read_b128 v[48:51], v209 offset:8192
 ds_read_b128 v[52:55], v210 offset:8192
 ds_read_b128 v[56:59], v211 offset:8192
 ds_read_b128 v[60:63], v212 offset:8192
 ds_read_b128 v[64:67], v209 offset:12288
 ds_read_b128 v[68:71], v210 offset:12288
 ds_read_b128 v[72:75], v211 offset:12288
 ds_read_b128 v[76:79], v212 offset:12288
 s_add_u32 s71, s70, 8396800
 s_waitcnt lgkmcnt(7)
 buffer_store_dwordx4 v[48:51], v1, s[48:51], s71 offen offset:0 sc1
 s_waitcnt lgkmcnt(6)
 buffer_store_dwordx4 v[52:55], v1, s[48:51], s71 offen offset:1024 sc1
 s_waitcnt lgkmcnt(5)
 buffer_store_dwordx4 v[56:59], v1, s[48:51], s71 offen offset:2048 sc1
 s_waitcnt lgkmcnt(4)
 buffer_store_dwordx4 v[60:63], v1, s[48:51], s71 offen offset:3072 sc1
 s_add_u32 s71, s70, 8400896
 s_waitcnt lgkmcnt(3)
 buffer_store_dwordx4 v[64:67], v1, s[48:51], s71 offen offset:0 sc1
 s_waitcnt lgkmcnt(2)
 buffer_store_dwordx4 v[68:71], v1, s[48:51], s71 offen offset:1024 sc1
 s_waitcnt lgkmcnt(1)
 buffer_store_dwordx4 v[72:75], v1, s[48:51], s71 offen offset:2048 sc1
 s_waitcnt lgkmcnt(0)
 buffer_store_dwordx4 v[76:79], v1, s[48:51], s71 offen offset:3072 sc1
 s_waitcnt vmcnt(0)
 s_barrier
 s_cmp_eq_u32 s4, 0
 s_cbranch_scc0 chore_12
 v_mov_b32 v3, 0
 v_mov_b32 v4, 1
 s_mov_b64 exec, 1
 global_atomic_add v4, v3, v4, s[42:43] offset:36 sc0 sc1
 s_waitcnt vmcnt(0)
 v_readfirstlane_b32 s7, v4
 s_nop 0
 s_cmp_eq_u32 s7, 31
 s_cbranch_scc0 arr_13
 v_mov_b32 v4, 4
 global_atomic_or v3, v4, s[42:43] offset:132 sc1
arr_13:
 s_mov_b64 exec, -1
 v_mov_b32 v3, 0
 v_mov_b32 v4, 1
 s_mov_b64 exec, 1
 global_atomic_add v4, v3, v4, s[42:43] offset:68 sc0 sc1
 s_waitcnt vmcnt(0)
 v_readfirstlane_b32 s7, v4
 s_nop 0
 s_cmp_eq_u32 s7, 127
 s_cbranch_scc0 arr_14
 v_mov_b32 v4, 2
 global_atomic_or v3, v4, s[42:43] offset:132 sc1
arr_14:
 s_mov_b64 exec, -1
 s_waitcnt vmcnt(0)
 s_lshl_b32 s69, s47, 4
 s_add_u32 s69, s69, s61
 s_lshl_b32 s69, s69, 7
 v_mov_b32 v3, s69
 s_mov_b32 s74, -1
 s_mov_b32 s75, -1
 s_mov_b32 s76, 0
 s_mov_b64 exec, 1
Lp_loop:
 s_mov_b32 s77, 171966464
 s_memtime s[78:79]
 s_waitcnt lgkmcnt(0)
 buffer_store_dword v3, v3, s[48:51], s77 offen sc1
 s_waitcnt vmcnt(0)
 s_memtime s[80:81]
 s_waitcnt lgkmcnt(0)
 s_sub_u32 s80, s80, s78
 s_min_u32 s74, s74, s80
 s_mov_b32 s77, 171974656
 s_memtime s[78:79]
 s_waitcnt lgkmcnt(0)
 buffer_store_dword v3, v3, s[48:51], s77 offen sc1
 s_waitcnt vmcnt(0)
 s_memtime s[80:81]
 s_waitcnt lgkmcnt(0)
 s_sub_u32 s80, s80, s78
 s_min_u32 s75, s75, s80
 s_add_u32 s76, s76, 1
 s_cmp_lt_u32 s76, 2
 s_cbranch_scc1 Lp_loop
 s_sub_i32 s76, s75, s74
 s_min_i32 s76, s76, 400
 s_max_i32 s76, s76, -400
 s_add_i32 s76, s76, 1024
 s_mov_b64 exec, -1
 v_mov_b32 v3, 0
 s_add_u32 s76, s76, 16777216
 v_mov_b32 v4, s76
 s_mov_b64 exec, 1
 global_atomic_add v4, v3, v4, s[42:43] offset:100 sc0 sc1
 s_waitcnt vmcnt(0)
 v_readfirstlane_b32 s7, v4
 s_nop 0
 s_add_u32 s7, s7, s76
 s_lshr_b32 s76, s7, 24
 s_cmp_eq_u32 s76, 32
 s_cbranch_scc0 arr_15
 s_and_b32 s7, s7, 0xffffff
 s_cmp_gt_u32 s7, 32768
 s_cselect_b32 s7, 48, 16
 v_mov_b32 v4, s7
 global_atomic_or v3, v4, s[42:43] offset:132 sc1
arr_15:
 s_mov_b64 exec, -1
chore_12:
 s_barrier
 s_mov_b32 s56, s8
 s_and_b32 s57, s9, 0xffff
 s_mov_b32 s58, 4194304
 s_mov_b32 s59, 0x20000
 s_add_u32 s70, s61, 8
 s_lshl_b32 s70, s70, 2
 s_add_u32 s70, s70, s47
 s_lshl_b32 s70, s70, 16
 v_lshrrev_b32 v3, 3, v0
 s_lshl_b32 s69, s4, 3
 v_add_u32 v3, s69, v3
 v_bfe_u32 v4, v3, 1, 3
 v_and_b32 v208, 7, v0
 v_xor_b32 v208, v208, v4
 v_lshlrev_b32 v208, 4, v208
 v_lshl_add_u32 v208, v3, 11, v208
 s_lshl_b32 s71, s4, 10
 s_add_u32 m0, s71, 0
 s_nop 0
 buffer_load_dwordx4 v208, s[56:59], s70 offen offset:0 nt lds
 s_add_u32 m0, s71, 3968
 s_nop 0
 buffer_load_dwordx4 v208, s[56:59], s70 offen offset:128 nt lds
 s_add_u32 m0, s71, 7936
 s_nop 0
 buffer_load_dwordx4 v208, s[56:59], s70 offen offset:256 nt lds
 s_add_u32 m0, s71, 11904
 s_nop 0
 buffer_load_dwordx4 v208, s[56:59], s70 offen offset:384 nt lds
 s_add_u32 m0, s71, 15872
 s_nop 0
 buffer_load_dwordx4 v208, s[56:59], s70 offen offset:512 nt lds
 s_add_u32 m0, s71, 19840
 s_nop 0
 buffer_load_dwordx4 v208, s[56:59], s70 offen offset:640 nt lds
 s_add_u32 m0, s71, 23808
 s_nop 0
 buffer_load_dwordx4 v208, s[56:59], s70 offen offset:768 nt lds
 s_add_u32 m0, s71, 27776
 s_nop 0
 buffer_load_dwordx4 v208, s[56:59], s70 offen offset:896 nt lds
 s_add_u32 m0, s71, 31744
 s_nop 0
 buffer_load_dwordx4 v208, s[56:59], s70 offen offset:1024 nt lds
 s_add_u32 m0, s71, 35712
 s_nop 0
 buffer_load_dwordx4 v208, s[56:59], s70 offen offset:1152 nt lds
 s_add_u32 m0, s71, 39680
 s_nop 0
 buffer_load_dwordx4 v208, s[56:59], s70 offen offset:1280 nt lds
 s_add_u32 m0, s71, 43648
 s_nop 0
 buffer_load_dwordx4 v208, s[56:59], s70 offen offset:1408 nt lds
 s_add_u32 m0, s71, 47616
 s_nop 0
 buffer_load_dwordx4 v208, s[56:59], s70 offen offset:1536 nt lds
 s_add_u32 m0, s71, 51584
 s_nop 0
 buffer_load_dwordx4 v208, s[56:59], s70 offen offset:1664 nt lds
 s_add_u32 m0, s71, 55552
 s_nop 0
 buffer_load_dwordx4 v208, s[56:59], s70 offen offset:1792 nt lds
 s_add_u32 m0, s71, 59520
 s_nop 0
 buffer_load_dwordx4 v208, s[56:59], s70 offen offset:1920 nt lds
 v_and_b32 v3, 31, v0
 s_lshl_b32 s69, s4, 14
 v_lshl_add_u32 v224, v3, 7, s69
 v_bfe_u32 v4, v3, 1, 3
 v_lshrrev_b32 v3, 5, v0
 s_add_u32 s70, s70, s69
 v_add_u32 v225, 0, v3
 v_xor_b32 v225, v225, v4
 v_lshl_add_u32 v209, v225, 4, v224
 v_add_u32 v225, 2, v3
 v_xor_b32 v225, v225, v4
 v_lshl_add_u32 v210, v225, 4, v224
 v_add_u32 v225, 4, v3
 v_xor_b32 v225, v225, v4
 v_lshl_add_u32 v211, v225, 4, v224
 v_add_u32 v225, 6, v3
 v_xor_b32 v225, v225, v4
 v_lshl_add_u32 v212, v225, 4, v224
 s_waitcnt vmcnt(0)
 s_barrier
 ds_read_b128 v[16:19], v209 offset:0
 ds_read_b128 v[20:23], v210 offset:0
 ds_read_b128 v[24:27], v211 offset:0
 ds_read_b128 v[28:31], v212 offset:0
 ds_read_b128 v[32:35], v209 offset:4096
 ds_read_b128 v[36:39], v210 offset:4096
 ds_read_b128 v[40:43], v211 offset:4096
 ds_read_b128 v[44:47], v212 offset:4096
 s_add_u32 s71, s70, 8388608
 s_waitcnt lgkmcnt(7)
 buffer_store_dwordx4 v[16:19], v1, s[48:51], s71 offen offset:0 sc1
 s_waitcnt lgkmcnt(6)
 buffer_store_dwordx4 v[20:23], v1, s[48:51], s71 offen offset:1024 sc1
 s_waitcnt lgkmcnt(5)
 buffer_store_dwordx4 v[24:27], v1, s[48:51], s71 offen offset:2048 sc1
 s_waitcnt lgkmcnt(4)
 buffer_store_dwordx4 v[28:31], v1, s[48:51], s71 offen offset:3072 sc1
 s_add_u32 s71, s70, 8392704
 s_waitcnt lgkmcnt(3)
 buffer_store_dwordx4 v[32:35], v1, s[48:51], s71 offen offset:0 sc1
 s_waitcnt lgkmcnt(2)
 buffer_store_dwordx4 v[36:39], v1, s[48:51], s71 offen offset:1024 sc1
 s_waitcnt lgkmcnt(1)
 buffer_store_dwordx4 v[40:43], v1, s[48:51], s71 offen offset:2048 sc1
 s_waitcnt lgkmcnt(0)
 buffer_store_dwordx4 v[44:47], v1, s[48:51], s71 offen offset:3072 sc1
 ds_read_b128 v[48:51], v209 offset:8192
 ds_read_b128 v[52:55], v210 offset:8192
 ds_read_b128 v[56:59], v211 offset:8192
 ds_read_b128 v[60:63], v212 offset:8192
 ds_read_b128 v[64:67], v209 offset:12288
 ds_read_b128 v[68:71], v210 offset:12288
 ds_read_b128 v[72:75], v211 offset:12288
 ds_read_b128 v[76:79], v212 offset:12288
 s_add_u32 s71, s70, 8396800
 s_waitcnt lgkmcnt(7)
 buffer_store_dwordx4 v[48:51], v1, s[48:51], s71 offen offset:0 sc1
 s_waitcnt lgkmcnt(6)
 buffer_store_dwordx4 v[52:55], v1, s[48:51], s71 offen offset:1024 sc1
 s_waitcnt lgkmcnt(5)
 buffer_store_dwordx4 v[56:59], v1, s[48:51], s71 offen offset:2048 sc1
 s_waitcnt lgkmcnt(4)
 buffer_store_dwordx4 v[60:63], v1, s[48:51], s71 offen offset:3072 sc1
 s_add_u32 s71, s70, 8400896
 s_waitcnt lgkmcnt(3)
 buffer_store_dwordx4 v[64:67], v1, s[48:51], s71 offen offset:0 sc1
 s_waitcnt lgkmcnt(2)
 buffer_store_dwordx4 v[68:71], v1, s[48:51], s71 offen offset:1024 sc1
 s_waitcnt lgkmcnt(1)
 buffer_store_dwordx4 v[72:75], v1, s[48:51], s71 offen offset:2048 sc1
 s_waitcnt lgkmcnt(0)
 buffer_store_dwordx4 v[76:79], v1, s[48:51], s71 offen offset:3072 sc1
 s_waitcnt vmcnt(0)
 s_barrier
 s_cmp_eq_u32 s4, 0
 s_cbranch_scc0 chore_16
 v_mov_b32 v3, 0
 v_mov_b32 v4, 1
 s_mov_b64 exec, 1
 global_atomic_add v4, v3, v4, s[42:43] offset:40 sc0 sc1
 s_waitcnt vmcnt(0)
 v_readfirstlane_b32 s7, v4
 s_nop 0
 s_cmp_eq_u32 s7, 31
 s_cbranch_scc0 arr_17
 v_mov_b32 v4, 8
 global_atomic_or v3, v4, s[42:43] offset:132 sc1
arr_17:
 s_mov_b64 exec, -1
chore_16:
 s_barrier
Lw_nopoi:
 v_and_b32 v3, 15, v0
 v_lshrrev_b32 v4, 4, v0
 v_lshlrev_b32 v6, 4, v3
 v_lshl_add_u32 v6, v4, 9, v6
 v_and_b32 v2, 8, v0
 s_cmp_eq_u32 s60, 1
 s_cselect_b32 s69, 16, 0
 v_mul_u32_u24 v2, s69, v2
 s_lshl_b32 s69, s4, 14
 v_add3_u32 v2, v2, v6, s69
 s_mul_i32 s69, s4, 12288
 v_add_u32 v10, s69, v1
 s_xor_b32 s69, s4, 1
 s_mul_i32 s69, s69, 12288
 s_add_u32 s69, s69, 0
 v_add_u32 v7, s69, v1
 s_xor_b32 s69, s4, 2
 s_mul_i32 s69, s69, 12288
 s_add_u32 s69, s69, 4096
 v_add_u32 v8, s69, v1
 s_xor_b32 s69, s4, 3
 s_mul_i32 s69, s69, 12288
 s_add_u32 s69, s69, 8192
 v_add_u32 v9, s69, v1
 s_lshl_b32 s69, s6, 2
 s_add_u32 s69, s69, s4
 s_lshl_b32 s69, s69, 10
 s_lshl_b32 s70, s69, 1
 s_and_b32 s70, s70, 0xffff
 s_cmp_lt_u32 s60, 2
 s_cselect_b32 s69, s69, s70
 v_add_u32 v11, s69, v1
 s_cmp_eq_u32 s60, 0
 s_cselect_b64 s[74:75], s[14:15], s[16:17]
 s_cmp_eq_u32 s60, 2
 s_cselect_b64 s[74:75], s[12:13], s[74:75]
 s_lshl_b32 s70, s62, 8
 s_lshl_b32 s69, s47, 21
 s_lshl_b32 s71, s61, 8
 s_add_u32 s69, s69, s71
 s_cmp_eq_u32 s60, 3
 s_cselect_b64 s[74:75], s[18:19], s[74:75]
 s_cselect_b32 s70, s69, s70
 s_cselect_b32 s71, 11, 13
 s_mov_b32 s52, s74
 s_and_b32 s53, s75, 0xffff
 s_mov_b32 s54, 8388608
 s_mov_b32 s55, 0x20000
 v_lshrrev_b32 v3, 4, v0
 v_lshlrev_b32 v4, 2, v3
 v_xor_b32 v4, v4, v0
 v_and_b32 v4, 15, v4
 v_lshlrev_b32 v208, s71, v3
 v_lshl_add_u32 v208, v4, 4, v208
 s_mul_i32 s66, s4, 40960
 v_bfe_u32 v4, v0, 2, 2
 v_lshl_add_u32 v3, v3, 3, v4
 v_lshl_add_u32 v3, v3, 8, s66
 s_cmp_eq_u32 s60, 1
 s_cselect_b32 s67, 3, 5
 s_cselect_b32 s69, 32, 8
 s_cmp_eq_u32 s60, 3
 s_cselect_b32 s67, 4, s67
 s_cselect_b32 s69, 32, s69
 s_cselect_b32 s72, 3, 4
 s_cselect_b32 s73, s47, s4
 s_cselect_b32 s82, s4, 0
 s_and_b32 s82, s82, 1
 s_lshl_b32 s82, s82, 5
 v_xor_b32 v4, s73, v4
 v_add_u32 v3, s82, v3
 v_and_b32 v224, 1, v0
 v_lshl_add_u32 v3, v224, s72, v3
 v_bfe_u32 v224, v0, 1, 1
 v_lshl_add_u32 v3, v224, s67, v3
 v_xor_b32 v224, 0, v4
 v_lshl_add_u32 v209, v224, 6, v3
 v_xor_b32 v210, s69, v209
 v_xor_b32 v224, 1, v4
 v_lshl_add_u32 v211, v224, 6, v3
 v_xor_b32 v212, s69, v211
 v_xor_b32 v224, 2, v4
 v_lshl_add_u32 v213, v224, 6, v3
 v_xor_b32 v214, s69, v213
 v_xor_b32 v224, 3, v4
 v_lshl_add_u32 v215, v224, 6, v3
 v_xor_b32 v216, s69, v215
 s_lshl_b32 s67, s4, 8
 s_lshl_b32 s67, s67, s71
 s_add_u32 s70, s70, s67
 s_lshl_b32 s67, 4, s71
 s_add_u32 m0, s66, 0
 s_nop 0
 buffer_load_dwordx4 v208, s[52:55], s70 offen nt lds
 s_add_u32 s70, s70, s67
 s_add_u32 m0, s66, 1024
 s_nop 0
 buffer_load_dwordx4 v208, s[52:55], s70 offen nt lds
 s_add_u32 s70, s70, s67
 s_add_u32 m0, s66, 2048
 s_nop 0
 buffer_load_dwordx4 v208, s[52:55], s70 offen nt lds
 s_add_u32 s70, s70, s67
 s_add_u32 m0, s66, 3072
 s_nop 0
 buffer_load_dwordx4 v208, s[52:55], s70 offen nt lds
 s_add_u32 s70, s70, s67
 s_add_u32 m0, s66, 4096
 s_nop 0
 buffer_load_dwordx4 v208, s[52:55], s70 offen nt lds
 s_add_u32 s70, s70, s67
 s_add_u32 m0, s66, 5120
 s_nop 0
 buffer_load_dwordx4 v208, s[52:55], s70 offen nt lds
 s_add_u32 s70, s70, s67
 s_add_u32 m0, s66, 6144
 s_nop 0
 buffer_load_dwordx4 v208, s[52:55], s70 offen nt lds
 s_add_u32 s70, s70, s67
 s_add_u32 m0, s66, 7168
 s_nop 0
 buffer_load_dwordx4 v208, s[52:55], s70 offen nt lds
 s_add_u32 s70, s70, s67
 s_waitcnt vmcnt(4)
 s_add_u32 m0, s66, 8192
 s_nop 0
 buffer_load_dwordx4 v208, s[52:55], s70 offen nt lds
 s_add_u32 s70, s70, s67
 s_add_u32 m0, s66, 9216
 s_nop 0
 buffer_load_dwordx4 v208, s[52:55], s70 offen nt lds
 s_add_u32 s70, s70, s67
 s_add_u32 m0, s66, 10240
 s_nop 0
 buffer_load_dwordx4 v208, s[52:55], s70 offen nt lds
 s_add_u32 s70, s70, s67
 s_add_u32 m0, s66, 11264
 s_nop 0
 buffer_load_dwordx4 v208, s[52:55], s70 offen nt lds
 s_add_u32 s70, s70, s67
 s_cmp_eq_u32 s60, 3
 s_cbranch_scc1 Lw_nordy
 s_barrier
 s_cmp_eq_u32 s4, 0
 s_cbranch_scc0 Lw_nordy
 v_mov_b32 v3, 0
 v_mov_b32 v4, 1
 s_mov_b64 exec, 1
 global_atomic_add v4, v3, v4, s[42:43] offset:68 sc0 sc1
 s_waitcnt vmcnt(0)
 v_readfirstlane_b32 s7, v4
 s_nop 0
 s_cmp_eq_u32 s7, 127
 s_cbranch_scc0 arr_18
 v_mov_b32 v4, 2
 global_atomic_or v3, v4, s[42:43] offset:132 sc1
arr_18:
 s_mov_b64 exec, -1
Lw_nordy:
 s_waitcnt vmcnt(4)
 s_add_u32 m0, s66, 12288
 s_nop 0
 buffer_load_dwordx4 v208, s[52:55], s70 offen nt lds
 s_add_u32 s70, s70, s67
 s_add_u32 m0, s66, 13312
 s_nop 0
 buffer_load_dwordx4 v208, s[52:55], s70 offen nt lds
 s_add_u32 s70, s70, s67
 s_add_u32 m0, s66, 14336
 s_nop 0
 buffer_load_dwordx4 v208, s[52:55], s70 offen nt lds
 s_add_u32 s70, s70, s67
 s_add_u32 m0, s66, 15360
 s_nop 0
 buffer_load_dwordx4 v208, s[52:55], s70 offen nt lds
 s_add_u32 s70, s70, s67
 ds_read_b64_tr_b16 a[0:1], v209 offset:0
 ds_read_b64_tr_b16 a[2:3], v209 offset:1024
 ds_read_b64_tr_b16 a[4:5], v210 offset:0
 ds_read_b64_tr_b16 a[6:7], v210 offset:1024
 ds_read_b64_tr_b16 a[8:9], v211 offset:0
 ds_read_b64_tr_b16 a[10:11], v211 offset:1024
 ds_read_b64_tr_b16 a[12:13], v212 offset:0
 ds_read_b64_tr_b16 a[14:15], v212 offset:1024
 s_waitcnt lgkmcnt(0)
 ds_read_b64_tr_b16 a[16:17], v213 offset:0
 ds_read_b64_tr_b16 a[18:19], v213 offset:1024
 ds_read_b64_tr_b16 a[20:21], v214 offset:0
 ds_read_b64_tr_b16 a[22:23], v214 offset:1024
 ds_read_b64_tr_b16 a[24:25], v215 offset:0
 ds_read_b64_tr_b16 a[26:27], v215 offset:1024
 ds_read_b64_tr_b16 a[28:29], v216 offset:0
 ds_read_b64_tr_b16 a[30:31], v216 offset:1024
 s_waitcnt lgkmcnt(0)
 s_waitcnt vmcnt(4)
 s_add_u32 m0, s66, 16384
 s_nop 0
 buffer_load_dwordx4 v208, s[52:55], s70 offen nt lds
 s_add_u32 s70, s70, s67
 s_add_u32 m0, s66, 17408
 s_nop 0
 buffer_load_dwordx4 v208, s[52:55], s70 offen nt lds
 s_add_u32 s70, s70, s67
 s_add_u32 m0, s66, 18432
 s_nop 0
 buffer_load_dwordx4 v208, s[52:55], s70 offen nt lds
 s_add_u32 s70, s70, s67
 s_add_u32 m0, s66, 19456
 s_nop 0
 buffer_load_dwordx4 v208, s[52:55], s70 offen nt lds
 s_add_u32 s70, s70, s67
 s_waitcnt vmcnt(4)
 s_add_u32 m0, s66, 20480
 s_nop 0
 buffer_load_dwordx4 v208, s[52:55], s70 offen nt lds
 s_add_u32 s70, s70, s67
 s_add_u32 m0, s66, 21504
 s_nop 0
 buffer_load_dwordx4 v208, s[52:55], s70 offen nt lds
 s_add_u32 s70, s70, s67
 s_add_u32 m0, s66, 22528
 s_nop 0
 buffer_load_dwordx4 v208, s[52:55], s70 offen nt lds
 s_add_u32 s70, s70, s67
 s_add_u32 m0, s66, 23552
 s_nop 0
 buffer_load_dwordx4 v208, s[52:55], s70 offen nt lds
 s_add_u32 s70, s70, s67
 ds_read_b64_tr_b16 a[32:33], v209 offset:8192
 ds_read_b64_tr_b16 a[34:35], v209 offset:9216
 ds_read_b64_tr_b16 a[36:37], v210 offset:8192
 ds_read_b64_tr_b16 a[38:39], v210 offset:9216
 ds_read_b64_tr_b16 a[40:41], v211 offset:8192
 ds_read_b64_tr_b16 a[42:43], v211 offset:9216
 ds_read_b64_tr_b16 a[44:45], v212 offset:8192
 ds_read_b64_tr_b16 a[46:47], v212 offset:9216
 s_waitcnt lgkmcnt(0)
 ds_read_b64_tr_b16 a[48:49], v213 offset:8192
 ds_read_b64_tr_b16 a[50:51], v213 offset:9216
 ds_read_b64_tr_b16 a[52:53], v214 offset:8192
 ds_read_b64_tr_b16 a[54:55], v214 offset:9216
 ds_read_b64_tr_b16 a[56:57], v215 offset:8192
 ds_read_b64_tr_b16 a[58:59], v215 offset:9216
 ds_read_b64_tr_b16 a[60:61], v216 offset:8192
 ds_read_b64_tr_b16 a[62:63], v216 offset:9216
 s_waitcnt lgkmcnt(0)
 s_waitcnt vmcnt(4)
 s_add_u32 m0, s66, 24576
 s_nop 0
 buffer_load_dwordx4 v208, s[52:55], s70 offen nt lds
 s_add_u32 s70, s70, s67
 s_add_u32 m0, s66, 25600
 s_nop 0
 buffer_load_dwordx4 v208, s[52:55], s70 offen nt lds
 s_add_u32 s70, s70, s67
 s_add_u32 m0, s66, 26624
 s_nop 0
 buffer_load_dwordx4 v208, s[52:55], s70 offen nt lds
 s_add_u32 s70, s70, s67
 s_add_u32 m0, s66, 27648
 s_nop 0
 buffer_load_dwordx4 v208, s[52:55], s70 offen nt lds
 s_add_u32 s70, s70, s67
 s_waitcnt vmcnt(4)
 s_add_u32 m0, s66, 28672
 s_nop 0
 buffer_load_dwordx4 v208, s[52:55], s70 offen nt lds
 s_add_u32 s70, s70, s67
 s_add_u32 m0, s66, 29696
 s_nop 0
 buffer_load_dwordx4 v208, s[52:55], s70 offen nt lds
 s_add_u32 s70, s70, s67
 s_add_u32 m0, s66, 30720
 s_nop 0
 buffer_load_dwordx4 v208, s[52:55], s70 offen nt lds
 s_add_u32 s70, s70, s67
 s_add_u32 m0, s66, 31744
 s_nop 0
 buffer_load_dwordx4 v208, s[52:55], s70 offen nt lds
 s_add_u32 s70, s70, s67
 ds_read_b64_tr_b16 a[64:65], v209 offset:16384
 ds_read_b64_tr_b16 a[66:67], v209 offset:17408
 ds_read_b64_tr_b16 a[68:69], v210 offset:16384
 ds_read_b64_tr_b16 a[70:71], v210 offset:17408
 ds_read_b64_tr_b16 a[72:73], v211 offset:16384
 ds_read_b64_tr_b16 a[74:75], v211 offset:17408
 ds_read_b64_tr_b16 a[76:77], v212 offset:16384
 ds_read_b64_tr_b16 a[78:79], v212 offset:17408
 s_waitcnt lgkmcnt(0)
 ds_read_b64_tr_b16 a[80:81], v213 offset:16384
 ds_read_b64_tr_b16 a[82:83], v213 offset:17408
 ds_read_b64_tr_b16 a[84:85], v214 offset:16384
 ds_read_b64_tr_b16 a[86:87], v214 offset:17408
 ds_read_b64_tr_b16 a[88:89], v215 offset:16384
 ds_read_b64_tr_b16 a[90:91], v215 offset:17408
 ds_read_b64_tr_b16 a[92:93], v216 offset:16384
 ds_read_b64_tr_b16 a[94:95], v216 offset:17408
 s_waitcnt lgkmcnt(0)
 s_waitcnt vmcnt(4)
 s_add_u32 m0, s66, 0
 s_nop 0
 buffer_load_dwordx4 v208, s[52:55], s70 offen nt lds
 s_add_u32 s70, s70, s67
 s_add_u32 m0, s66, 1024
 s_nop 0
 buffer_load_dwordx4 v208, s[52:55], s70 offen nt lds
 s_add_u32 s70, s70, s67
 s_add_u32 m0, s66, 2048
 s_nop 0
 buffer_load_dwordx4 v208, s[52:55], s70 offen nt lds
 s_add_u32 s70, s70, s67
 s_add_u32 m0, s66, 3072
 s_nop 0
 buffer_load_dwordx4 v208, s[52:55], s70 offen nt lds
 s_add_u32 s70, s70, s67
 s_waitcnt vmcnt(4)
 s_add_u32 m0, s66, 4096
 s_nop 0
 buffer_load_dwordx4 v208, s[52:55], s70 offen nt lds
 s_add_u32 s70, s70, s67
 s_add_u32 m0, s66, 5120
 s_nop 0
 buffer_load_dwordx4 v208, s[52:55], s70 offen nt lds
 s_add_u32 s70, s70, s67
 s_add_u32 m0, s66, 6144
 s_nop 0
 buffer_load_dwordx4 v208, s[52:55], s70 offen nt lds
 s_add_u32 s70, s70, s67
 s_add_u32 m0, s66, 7168
 s_nop 0
 buffer_load_dwordx4 v208, s[52:55], s70 offen nt lds
 s_add_u32 s70, s70, s67
 ds_read_b64_tr_b16 a[96:97], v209 offset:24576
 ds_read_b64_tr_b16 a[98:99], v209 offset:25600
 ds_read_b64_tr_b16 a[100:101], v210 offset:24576
 ds_read_b64_tr_b16 a[102:103], v210 offset:25600
 ds_read_b64_tr_b16 a[104:105], v211 offset:24576
 ds_read_b64_tr_b16 a[106:107], v211 offset:25600
 ds_read_b64_tr_b16 a[108:109], v212 offset:24576
 ds_read_b64_tr_b16 a[110:111], v212 offset:25600
 s_waitcnt lgkmcnt(0)
 ds_read_b64_tr_b16 a[112:113], v213 offset:24576
 ds_read_b64_tr_b16 a[114:115], v213 offset:25600
 ds_read_b64_tr_b16 a[116:117], v214 offset:24576
 ds_read_b64_tr_b16 a[118:119], v214 offset:25600
 ds_read_b64_tr_b16 a[120:121], v215 offset:24576
 ds_read_b64_tr_b16 a[122:123], v215 offset:25600
 ds_read_b64_tr_b16 a[124:125], v216 offset:24576
 ds_read_b64_tr_b16 a[126:127], v216 offset:25600
 s_waitcnt lgkmcnt(0)
 s_waitcnt vmcnt(4)
 s_add_u32 m0, s66, 8192
 s_nop 0
 buffer_load_dwordx4 v208, s[52:55], s70 offen nt lds
 s_add_u32 s70, s70, s67
 s_add_u32 m0, s66, 9216
 s_nop 0
 buffer_load_dwordx4 v208, s[52:55], s70 offen nt lds
 s_add_u32 s70, s70, s67
 s_add_u32 m0, s66, 10240
 s_nop 0
 buffer_load_dwordx4 v208, s[52:55], s70 offen nt lds
 s_add_u32 s70, s70, s67
 s_add_u32 m0, s66, 11264
 s_nop 0
 buffer_load_dwordx4 v208, s[52:55], s70 offen nt lds
 s_add_u32 s70, s70, s67
 s_waitcnt vmcnt(4)
 s_add_u32 m0, s66, 12288
 s_nop 0
 buffer_load_dwordx4 v208, s[52:55], s70 offen nt lds
 s_add_u32 s70, s70, s67
 s_add_u32 m0, s66, 13312
 s_nop 0
 buffer_load_dwordx4 v208, s[52:55], s70 offen nt lds
 s_add_u32 s70, s70, s67
 s_add_u32 m0, s66, 14336
 s_nop 0
 buffer_load_dwordx4 v208, s[52:55], s70 offen nt lds
 s_add_u32 s70, s70, s67
 s_add_u32 m0, s66, 15360
 s_nop 0
 buffer_load_dwordx4 v208, s[52:55], s70 offen nt lds
 s_add_u32 s70, s70, s67
 ds_read_b64_tr_b16 a[128:129], v209 offset:0
 ds_read_b64_tr_b16 a[130:131], v209 offset:1024
 ds_read_b64_tr_b16 a[132:133], v210 offset:0
 ds_read_b64_tr_b16 a[134:135], v210 offset:1024
 ds_read_b64_tr_b16 a[136:137], v211 offset:0
 ds_read_b64_tr_b16 a[138:139], v211 offset:1024
 ds_read_b64_tr_b16 a[140:141], v212 offset:0
 ds_read_b64_tr_b16 a[142:143], v212 offset:1024
 s_waitcnt lgkmcnt(0)
 ds_read_b64_tr_b16 a[144:145], v213 offset:0
 ds_read_b64_tr_b16 a[146:147], v213 offset:1024
 ds_read_b64_tr_b16 a[148:149], v214 offset:0
 ds_read_b64_tr_b16 a[150:151], v214 offset:1024
 ds_read_b64_tr_b16 a[152:153], v215 offset:0
 ds_read_b64_tr_b16 a[154:155], v215 offset:1024
 ds_read_b64_tr_b16 a[156:157], v216 offset:0
 ds_read_b64_tr_b16 a[158:159], v216 offset:1024
 s_waitcnt lgkmcnt(0)
 s_waitcnt vmcnt(4)
 s_add_u32 m0, s66, 16384
 s_nop 0
 buffer_load_dwordx4 v208, s[52:55], s70 offen nt lds
 s_add_u32 s70, s70, s67
 s_add_u32 m0, s66, 17408
 s_nop 0
 buffer_load_dwordx4 v208, s[52:55], s70 offen nt lds
 s_add_u32 s70, s70, s67
 s_add_u32 m0, s66, 18432
 s_nop 0
 buffer_load_dwordx4 v208, s[52:55], s70 offen nt lds
 s_add_u32 s70, s70, s67
 s_add_u32 m0, s66, 19456
 s_nop 0
 buffer_load_dwordx4 v208, s[52:55], s70 offen nt lds
 s_add_u32 s70, s70, s67
 s_waitcnt vmcnt(4)
 s_add_u32 m0, s66, 20480
 s_nop 0
 buffer_load_dwordx4 v208, s[52:55], s70 offen nt lds
 s_add_u32 s70, s70, s67
 s_add_u32 m0, s66, 21504
 s_nop 0
 buffer_load_dwordx4 v208, s[52:55], s70 offen nt lds
 s_add_u32 s70, s70, s67
 s_add_u32 m0, s66, 22528
 s_nop 0
 buffer_load_dwordx4 v208, s[52:55], s70 offen nt lds
 s_add_u32 s70, s70, s67
 s_add_u32 m0, s66, 23552
 s_nop 0
 buffer_load_dwordx4 v208, s[52:55], s70 offen nt lds
 s_add_u32 s70, s70, s67
 ds_read_b64_tr_b16 a[160:161], v209 offset:8192
 ds_read_b64_tr_b16 a[162:163], v209 offset:9216
 ds_read_b64_tr_b16 a[164:165], v210 offset:8192
 ds_read_b64_tr_b16 a[166:167], v210 offset:9216
 ds_read_b64_tr_b16 a[168:169], v211 offset:8192
 ds_read_b64_tr_b16 a[170:171], v211 offset:9216
 ds_read_b64_tr_b16 a[172:173], v212 offset:8192
 ds_read_b64_tr_b16 a[174:175], v212 offset:9216
 s_waitcnt lgkmcnt(0)
 ds_read_b64_tr_b16 a[176:177], v213 offset:8192
 ds_read_b64_tr_b16 a[178:179], v213 offset:9216
 ds_read_b64_tr_b16 a[180:181], v214 offset:8192
 ds_read_b64_tr_b16 a[182:183], v214 offset:9216
 ds_read_b64_tr_b16 a[184:185], v215 offset:8192
 ds_read_b64_tr_b16 a[186:187], v215 offset:9216
 ds_read_b64_tr_b16 a[188:189], v216 offset:8192
 ds_read_b64_tr_b16 a[190:191], v216 offset:9216
 s_waitcnt lgkmcnt(0)
 s_waitcnt vmcnt(4)
 s_add_u32 m0, s66, 24576
 s_nop 0
 buffer_load_dwordx4 v208, s[52:55], s70 offen nt lds
 s_add_u32 s70, s70, s67
 s_add_u32 m0, s66, 25600
 s_nop 0
 buffer_load_dwordx4 v208, s[52:55], s70 offen nt lds
 s_add_u32 s70, s70, s67
 s_add_u32 m0, s66, 26624
 s_nop 0
 buffer_load_dwordx4 v208, s[52:55], s70 offen nt lds
 s_add_u32 s70, s70, s67
 s_add_u32 m0, s66, 27648
 s_nop 0
 buffer_load_dwordx4 v208, s[52:55], s70 offen nt lds
 s_add_u32 s70, s70, s67
 s_waitcnt vmcnt(4)
 s_add_u32 m0, s66, 28672
 s_nop 0
 buffer_load_dwordx4 v208, s[52:55], s70 offen nt lds
 s_add_u32 s70, s70, s67
 s_add_u32 m0, s66, 29696
 s_nop 0
 buffer_load_dwordx4 v208, s[52:55], s70 offen nt lds
 s_add_u32 s70, s70, s67
 s_add_u32 m0, s66, 30720
 s_nop 0
 buffer_load_dwordx4 v208, s[52:55], s70 offen nt lds
 s_add_u32 s70, s70, s67
 s_add_u32 m0, s66, 31744
 s_nop 0
 buffer_load_dwordx4 v208, s[52:55], s70 offen nt lds
 s_add_u32 s70, s70, s67
 ds_read_b64_tr_b16 a[192:193], v209 offset:16384
 ds_read_b64_tr_b16 a[194:195], v209 offset:17408
 ds_read_b64_tr_b16 a[196:197], v210 offset:16384
 ds_read_b64_tr_b16 a[198:199], v210 offset:17408
 ds_read_b64_tr_b16 a[200:201], v211 offset:16384
 ds_read_b64_tr_b16 a[202:203], v211 offset:17408
 ds_read_b64_tr_b16 a[204:205], v212 offset:16384
 ds_read_b64_tr_b16 a[206:207], v212 offset:17408
 s_waitcnt lgkmcnt(0)
 ds_read_b64_tr_b16 a[208:209], v213 offset:16384
 ds_read_b64_tr_b16 a[210:211], v213 offset:17408
 ds_read_b64_tr_b16 a[212:213], v214 offset:16384
 ds_read_b64_tr_b16 a[214:215], v214 offset:17408
 ds_read_b64_tr_b16 a[216:217], v215 offset:16384
 ds_read_b64_tr_b16 a[218:219], v215 offset:17408
 ds_read_b64_tr_b16 a[220:221], v216 offset:16384
 ds_read_b64_tr_b16 a[222:223], v216 offset:17408
 s_waitcnt lgkmcnt(0)
 s_waitcnt vmcnt(4)
 s_cmp_eq_u32 s60, 3
 s_cbranch_scc1 Lw_onews
 v_mov_b32 v3, 0
news_19:
 global_load_dword v4, v3, s[42:43] offset:132 sc1
 s_waitcnt vmcnt(0)
 v_readfirstlane_b32 s7, v4
 s_nop 0
 s_and_b32 s7, s7, 4
 s_cmp_eq_u32 s7, 4
 s_cbranch_scc1 newsok_20
 s_sleep 2
 s_sub_u32 s46, s46, 1
 s_cbranch_scc0 news_19
 s_mov_b32 s46, 0
 s_branch newsok_20
newsok_20:
 s_cmp_lt_u32 s60, 2
 s_cbranch_scc0 Lw_nox
 s_add_u32 s70, s65, 0
 buffer_load_dwordx4 v[12:15], v11, s[48:51], s70 offen offset:0 sc1
 s_add_u32 s70, s65, 65536
 buffer_load_dwordx4 v[12:15], v11, s[48:51], s70 offen offset:0 sc1
 s_add_u32 s70, s65, 131072
 buffer_load_dwordx4 v[12:15], v11, s[48:51], s70 offen offset:0 sc1
 s_branch Lw_nox
Lw_onews:
 v_mov_b32 v3, 0
news_21:
 global_load_dword v4, v3, s[42:43] offset:132 sc1
 s_waitcnt vmcnt(0)
 v_readfirstlane_b32 s7, v4
 s_nop 0
 s_bfe_u32 s64, s7, 0x10005
 s_and_b32 s7, s7, 18
 s_cmp_eq_u32 s7, 18
 s_cbranch_scc1 newsok_22
 s_sleep 2
 s_sub_u32 s46, s46, 1
 s_cbranch_scc0 news_21
 s_mov_b32 s46, 0
 s_branch newsok_22
newsok_22:
Lw_nox:
 s_waitcnt vmcnt(0)
 ds_read_b64_tr_b16 a[224:225], v209 offset:24576
 ds_read_b64_tr_b16 a[226:227], v209 offset:25600
 ds_read_b64_tr_b16 a[228:229], v210 offset:24576
 ds_read_b64_tr_b16 a[230:231], v210 offset:25600
 ds_read_b64_tr_b16 a[232:233], v211 offset:24576
 ds_read_b64_tr_b16 a[234:235], v211 offset:25600
 ds_read_b64_tr_b16 a[236:237], v212 offset:24576
 ds_read_b64_tr_b16 a[238:239], v212 offset:25600
 s_waitcnt lgkmcnt(0)
 ds_read_b64_tr_b16 a[240:241], v213 offset:24576
 ds_read_b64_tr_b16 a[242:243], v213 offset:25600
 ds_read_b64_tr_b16 a[244:245], v214 offset:24576
 ds_read_b64_tr_b16 a[246:247], v214 offset:25600
 ds_read_b64_tr_b16 a[248:249], v215 offset:24576
 ds_read_b64_tr_b16 a[250:251], v215 offset:25600
 ds_read_b64_tr_b16 a[252:253], v216 offset:24576
 ds_read_b64_tr_b16 a[254:255], v216 offset:25600
 s_waitcnt lgkmcnt(0)
 s_waitcnt vmcnt(0)
Lw_go:
 s_barrier
 s_cmp_eq_u32 s60, 0
 s_cbranch_scc1 Lw_K
 s_cmp_eq_u32 s60, 1
 s_cbranch_scc1 Lw_V
 s_cmp_eq_u32 s60, 2
 s_cbranch_scc1 Lw_Q
 s_mov_b32 s56, s40
 s_and_b32 s57, s41, 0xffff
 s_mov_b32 s58, 8388608
 s_mov_b32 s59, 0x20000
 v_lshlrev_b32 v11, 2, v0
 s_lshr_b32 s69, s4, 1
 s_lshl_b32 s70, s69, 8
 v_add_u32 v2, s70, v2
 v_xor_b32 v5, 0x100, v2
 v_and_b32 v3, 15, v0
 v_lshrrev_b32 v4, 4, v0
 v_lshlrev_b32 v4, 3, v4
 v_lshl_add_u32 v250, v3, 12, v4
 s_lshl_b32 s67, s69, 16
 s_lshl_b32 s69, s61, 2
 s_add_u32 s70, s69, s47
 s_lshl_b32 s70, s70, 1
 s_and_b32 s71, s4, 1
 s_add_u32 s70, s70, s71
 s_lshl_b32 s70, s70, 5
 s_add_u32 s67, s67, s70
 s_lshl_b32 s74, s47, 9
 s_add_u32 s74, s74, 3153920
 s_add_u32 s69, s69, s4
 s_lshl_b32 s75, s69, 7
 s_add_u32 s75, s75, 3162112
 s_lshl_b32 s76, s69, 15
 s_xor_b32 s69, s64, 1
 s_lshl_b32 s69, s69, 13
 s_add_u32 s76, s76, s69
 s_add_u32 s76, s76, 100663296
 s_lshl_b32 s65, s47, 16
 s_add_u32 s65, s65, 33554432
 s_xor_b32 s71, s47, 1
 s_and_b32 s69, s71, 2
 s_add_u32 s69, s69, s71
 s_lshl_b32 s69, s69, 2
 s_add_u32 s69, s69, s47
 s_lshl_b32 s69, s69, 10
 v_add_u32 v244, s69, v1
 s_xor_b32 s71, s47, 1
 s_and_b32 s69, s47, 2
 s_add_u32 s69, s69, s47
 s_lshl_b32 s69, s69, 2
 s_add_u32 s69, s69, s71
 s_lshl_b32 s69, s69, 10
 v_add_u32 v247, s69, v1
 s_xor_b32 s71, s47, 2
 s_and_b32 s69, s71, 2
 s_add_u32 s69, s69, s71
 s_lshl_b32 s69, s69, 2
 s_add_u32 s69, s69, s47
 s_lshl_b32 s69, s69, 10
 v_add_u32 v245, s69, v1
 s_xor_b32 s71, s47, 2
 s_and_b32 s69, s47, 2
 s_add_u32 s69, s69, s47
 s_lshl_b32 s69, s69, 2
 s_add_u32 s69, s69, s71
 s_lshl_b32 s69, s69, 10
 v_add_u32 v248, s69, v1
 s_xor_b32 s71, s47, 3
 s_and_b32 s69, s71, 2
 s_add_u32 s69, s69, s71
 s_lshl_b32 s69, s69, 2
 s_add_u32 s69, s69, s47
 s_lshl_b32 s69, s69, 10
 v_add_u32 v246, s69, v1
 s_xor_b32 s71, s47, 3
 s_and_b32 s69, s47, 2
 s_add_u32 s69, s69, s47
 s_lshl_b32 s69, s69, 2
 s_add_u32 s69, s69, s71
 s_lshl_b32 s69, s69, 10
 v_add_u32 v249, s69, v1
 s_mov_b32 s73, 0
Lw_Oloop:
 s_cmp_eq_u32 s73, 1
 s_cbranch_scc1 have_23
 s_and_b32 s69, s63, 3
 s_lshl_b32 s69, s69, 7
 s_add_u32 s71, s69, s74
 s_lshr_b32 s70, s63, 2
 s_add_u32 s70, s70, 1
 s_mov_b64 exec, 255
w_25:
 buffer_load_dword v4, v11, s[48:51], s71 offen sc1
 s_waitcnt vmcnt(0)
 v_cmp_gt_u32 vcc, s70, v4
 s_cbranch_vccz wok_26
 s_sleep 2
 s_sub_u32 s46, s46, 1
 s_cbranch_scc0 w_25
 s_mov_b32 s46, 0
 s_branch wok_26
wok_26:
 s_mov_b64 exec, -1
 s_add_u32 s77, s63, 1
 s_and_b32 s69, s77, 3
 s_lshl_b32 s69, s69, 7
 s_add_u32 s71, s69, s74
 s_lshr_b32 s70, s77, 2
 s_add_u32 s70, s70, 1
 s_mov_b32 s72, s70
 s_mov_b64 exec, 0xff
 buffer_load_dword v12, v11, s[48:51], s71 offen sc1
 buffer_load_dword v13, v11, s[48:51], s75 offen sc1
 s_mov_b64 exec, -1
 s_add_u32 s82, s65, 0
 buffer_load_dwordx4 v[16:19], v2, s[48:51], s82 offen offset:0 sc1
 buffer_load_dwordx4 v[20:23], v5, s[48:51], s82 offen offset:0 sc1
 buffer_load_dwordx4 v[24:27], v2, s[48:51], s82 offen offset:2048 sc1
 buffer_load_dwordx4 v[28:31], v5, s[48:51], s82 offen offset:2048 sc1
 s_add_u32 s82, s65, 4096
 buffer_load_dwordx4 v[32:35], v2, s[48:51], s82 offen offset:0 sc1
 buffer_load_dwordx4 v[36:39], v5, s[48:51], s82 offen offset:0 sc1
 buffer_load_dwordx4 v[40:43], v2, s[48:51], s82 offen offset:2048 sc1
 buffer_load_dwordx4 v[44:47], v5, s[48:51], s82 offen offset:2048 sc1
 s_add_u32 s82, s65, 8192
 buffer_load_dwordx4 v[48:51], v2, s[48:51], s82 offen offset:0 sc1
 buffer_load_dwordx4 v[52:55], v5, s[48:51], s82 offen offset:0 sc1
 buffer_load_dwordx4 v[56:59], v2, s[48:51], s82 offen offset:2048 sc1
 buffer_load_dwordx4 v[60:63], v5, s[48:51], s82 offen offset:2048 sc1
 s_add_u32 s82, s65, 12288
 buffer_load_dwordx4 v[64:67], v2, s[48:51], s82 offen offset:0 sc1
 buffer_load_dwordx4 v[68:71], v5, s[48:51], s82 offen offset:0 sc1
 buffer_load_dwordx4 v[72:75], v2, s[48:51], s82 offen offset:2048 sc1
 buffer_load_dwordx4 v[76:79], v5, s[48:51], s82 offen offset:2048 sc1
 s_add_u32 s65, s65, 0x40000
 s_waitcnt vmcnt(16)
 s_mov_b64 exec, 0xff
 v_cmp_gt_u32 vcc, s72, v12
 s_mov_b64 exec, -1
 s_cbranch_vccnz dry_27
 s_waitcnt vmcnt(14)
 v_mfma_f32_16x16x32_bf16 v[80:83], a[0:3], v[16:19], 0
 v_mfma_f32_16x16x32_bf16 v[96:99], a[4:7], v[16:19], 0
 v_mfma_f32_16x16x32_bf16 v[128:131], a[4:7], v[20:23], 0
 ds_write_b128 v7, v[160:163] offset:49152
 v_mfma_f32_16x16x32_bf16 v[112:115], a[0:3], v[20:23], 0
 v_mfma_f32_16x16x32_bf16 v[84:87], a[8:11], v[16:19], 0
 s_sub_u32 s70, s63, 6
 s_mov_b64 exec, 0xf
 v_cmp_gt_i32 vcc, s70, v13
 s_mov_b64 exec, -1
 s_cbranch_vccz finok_28
 s_mov_b64 exec, 15
w_29:
 buffer_load_dword v4, v11, s[48:51], s75 offen sc1
 s_waitcnt vmcnt(0)
 v_cmp_gt_u32 vcc, s70, v4
 s_cbranch_vccz wok_30
 s_sleep 2
 s_sub_u32 s46, s46, 1
 s_cbranch_scc0 w_29
 s_mov_b32 s46, 0
 s_branch wok_30
wok_30:
 s_mov_b64 exec, -1
finok_28:
 s_sub_u32 s77, s63, 7
 s_and_b32 s69, s77, 2
 s_lshl_b32 s69, s69, 12
 s_xor_b32 s69, s69, s76
 s_and_b32 s78, s77, 15
 s_lshl_b32 s78, s78, 20
 s_add_u32 s78, s78, s69
 buffer_load_dwordx4 v[232:235], v247, s[48:51], s78 offen sc1
 buffer_load_dwordx4 v[236:239], v248, s[48:51], s78 offen sc1
 buffer_load_dwordx4 v[240:243], v249, s[48:51], s78 offen sc1
 v_mfma_f32_16x16x32_bf16 v[100:103], a[12:15], v[16:19], 0
 v_mfma_f32_16x16x32_bf16 v[132:135], a[12:15], v[20:23], 0
 ds_write_b128 v7, v[164:167] offset:50176
 v_mfma_f32_16x16x32_bf16 v[116:119], a[8:11], v[20:23], 0
 v_mfma_f32_16x16x32_bf16 v[88:91], a[16:19], v[16:19], 0
 v_mfma_f32_16x16x32_bf16 v[104:107], a[20:23], v[16:19], 0
 ds_write_b128 v7, v[168:171] offset:51200
 v_mfma_f32_16x16x32_bf16 v[136:139], a[20:23], v[20:23], 0
 v_mfma_f32_16x16x32_bf16 v[120:123], a[16:19], v[20:23], 0
 v_mfma_f32_16x16x32_bf16 v[92:95], a[24:27], v[16:19], 0
 ds_write_b128 v7, v[172:175] offset:52224
 v_mfma_f32_16x16x32_bf16 v[108:111], a[28:31], v[16:19], 0
 v_mfma_f32_16x16x32_bf16 v[140:143], a[28:31], v[20:23], 0
 v_mfma_f32_16x16x32_bf16 v[124:127], a[24:27], v[20:23], 0
 ds_write_b128 v8, v[176:179] offset:49152
 s_waitcnt vmcnt(15)
 v_mfma_f32_16x16x32_bf16 v[80:83], a[32:35], v[24:27], v[80:83]
 s_add_u32 s82, s65, 0
 buffer_load_dwordx4 v[16:19], v2, s[48:51], s82 offen offset:0 sc1
 v_mfma_f32_16x16x32_bf16 v[96:99], a[36:39], v[24:27], v[96:99]
 v_mfma_f32_16x16x32_bf16 v[128:131], a[36:39], v[28:31], v[128:131]
 buffer_load_dwordx4 v[20:23], v5, s[48:51], s82 offen offset:0 sc1
 v_mfma_f32_16x16x32_bf16 v[112:115], a[32:35], v[28:31], v[112:115]
 v_mfma_f32_16x16x32_bf16 v[84:87], a[40:43], v[24:27], v[84:87]
 ds_write_b128 v8, v[180:183] offset:50176
 v_mfma_f32_16x16x32_bf16 v[100:103], a[44:47], v[24:27], v[100:103]
 v_mfma_f32_16x16x32_bf16 v[132:135], a[44:47], v[28:31], v[132:135]
 v_mfma_f32_16x16x32_bf16 v[116:119], a[40:43], v[28:31], v[116:119]
 ds_write_b128 v8, v[184:187] offset:51200
 v_mfma_f32_16x16x32_bf16 v[88:91], a[48:51], v[24:27], v[88:91]
 v_mfma_f32_16x16x32_bf16 v[104:107], a[52:55], v[24:27], v[104:107]
 v_mfma_f32_16x16x32_bf16 v[136:139], a[52:55], v[28:31], v[136:139]
 ds_write_b128 v8, v[188:191] offset:52224
 v_mfma_f32_16x16x32_bf16 v[120:123], a[48:51], v[28:31], v[120:123]
 v_mfma_f32_16x16x32_bf16 v[92:95], a[56:59], v[24:27], v[92:95]
 v_mfma_f32_16x16x32_bf16 v[108:111], a[60:63], v[24:27], v[108:111]
 ds_write_b128 v9, v[192:195] offset:49152
 v_mfma_f32_16x16x32_bf16 v[140:143], a[60:63], v[28:31], v[140:143]
 v_mfma_f32_16x16x32_bf16 v[124:127], a[56:59], v[28:31], v[124:127]
 s_waitcnt vmcnt(15)
 v_mfma_f32_16x16x32_bf16 v[80:83], a[64:67], v[32:35], v[80:83]
 buffer_load_dwordx4 v[24:27], v2, s[48:51], s82 offen offset:2048 sc1
 v_mfma_f32_16x16x32_bf16 v[96:99], a[68:71], v[32:35], v[96:99]
 ds_write_b128 v9, v[196:199] offset:50176
 v_mfma_f32_16x16x32_bf16 v[128:131], a[68:71], v[36:39], v[128:131]
 buffer_load_dwordx4 v[28:31], v5, s[48:51], s82 offen offset:2048 sc1
 v_mfma_f32_16x16x32_bf16 v[112:115], a[64:67], v[36:39], v[112:115]
 v_mfma_f32_16x16x32_bf16 v[84:87], a[72:75], v[32:35], v[84:87]
 v_mfma_f32_16x16x32_bf16 v[100:103], a[76:79], v[32:35], v[100:103]
 ds_write_b128 v9, v[200:203] offset:51200
 v_mfma_f32_16x16x32_bf16 v[132:135], a[76:79], v[36:39], v[132:135]
 v_mfma_f32_16x16x32_bf16 v[116:119], a[72:75], v[36:39], v[116:119]
 v_mfma_f32_16x16x32_bf16 v[88:91], a[80:83], v[32:35], v[88:91]
 ds_write_b128 v9, v[204:207] offset:52224
 v_mfma_f32_16x16x32_bf16 v[104:107], a[84:87], v[32:35], v[104:107]
 v_mfma_f32_16x16x32_bf16 v[136:139], a[84:87], v[36:39], v[136:139]
 v_mfma_f32_16x16x32_bf16 v[120:123], a[80:83], v[36:39], v[120:123]
 s_waitcnt lgkmcnt(0)
 s_barrier
 v_mfma_f32_16x16x32_bf16 v[92:95], a[88:91], v[32:35], v[92:95]
 ds_read_b128 v[160:163], v10 offset:49152
 v_mfma_f32_16x16x32_bf16 v[108:111], a[92:95], v[32:35], v[108:111]
 s_add_u32 s77, s63, 2
 s_and_b32 s69, s77, 3
 s_lshl_b32 s69, s69, 7
 s_add_u32 s71, s69, s74
 s_lshr_b32 s70, s77, 2
 s_add_u32 s70, s70, 1
 s_mov_b32 s72, s70
 s_mov_b64 exec, 0xff
 buffer_load_dword v12, v11, s[48:51], s71 offen sc1
 buffer_load_dword v13, v11, s[48:51], s75 offen sc1
 s_mov_b64 exec, -1
 v_mfma_f32_16x16x32_bf16 v[140:143], a[92:95], v[36:39], v[140:143]
 ds_read_b128 v[164:167], v10 offset:50176
 v_mfma_f32_16x16x32_bf16 v[124:127], a[88:91], v[36:39], v[124:127]
 ds_read_b128 v[168:171], v10 offset:51200
 s_waitcnt vmcnt(17)
 v_mfma_f32_16x16x32_bf16 v[80:83], a[96:99], v[40:43], v[80:83]
 s_add_u32 s82, s65, 4096
 buffer_load_dwordx4 v[32:35], v2, s[48:51], s82 offen offset:0 sc1
 v_mfma_f32_16x16x32_bf16 v[96:99], a[100:103], v[40:43], v[96:99]
 ds_read_b128 v[172:175], v10 offset:52224
 v_mfma_f32_16x16x32_bf16 v[128:131], a[100:103], v[44:47], v[128:131]
 buffer_load_dwordx4 v[36:39], v5, s[48:51], s82 offen offset:0 sc1
 v_mfma_f32_16x16x32_bf16 v[112:115], a[96:99], v[44:47], v[112:115]
 ds_read_b128 v[176:179], v10 offset:53248
 v_mfma_f32_16x16x32_bf16 v[84:87], a[104:107], v[40:43], v[84:87]
 ds_read_b128 v[180:183], v10 offset:54272
 v_mfma_f32_16x16x32_bf16 v[100:103], a[108:111], v[40:43], v[100:103]
 ds_read_b128 v[184:187], v10 offset:55296
 v_mfma_f32_16x16x32_bf16 v[132:135], a[108:111], v[44:47], v[132:135]
 ds_read_b128 v[188:191], v10 offset:56320
 v_mfma_f32_16x16x32_bf16 v[116:119], a[104:107], v[44:47], v[116:119]
 ds_read_b128 v[192:195], v10 offset:57344
 v_mfma_f32_16x16x32_bf16 v[88:91], a[112:115], v[40:43], v[88:91]
 ds_read_b128 v[196:199], v10 offset:58368
 v_mfma_f32_16x16x32_bf16 v[104:107], a[116:119], v[40:43], v[104:107]
 ds_read_b128 v[200:203], v10 offset:59392
 v_mfma_f32_16x16x32_bf16 v[136:139], a[116:119], v[44:47], v[136:139]
 ds_read_b128 v[204:207], v10 offset:60416
 v_mfma_f32_16x16x32_bf16 v[120:123], a[112:115], v[44:47], v[120:123]
 s_waitcnt lgkmcnt(8)
 v_mfma_f32_16x16x32_bf16 v[92:95], a[120:123], v[40:43], v[92:95]
 v_add_f32 v144, v144, v160
 v_add_f32 v145, v145, v161
 v_mfma_f32_16x16x32_bf16 v[108:111], a[124:127], v[40:43], v[108:111]
 v_add_f32 v146, v146, v162
 v_add_f32 v147, v147, v163
 v_mfma_f32_16x16x32_bf16 v[140:143], a[124:127], v[44:47], v[140:143]
 v_add_f32 v148, v148, v164
 v_add_f32 v149, v149, v165
 v_mfma_f32_16x16x32_bf16 v[124:127], a[120:123], v[44:47], v[124:127]
 v_add_f32 v150, v150, v166
 v_add_f32 v151, v151, v167
 s_waitcnt vmcnt(17)
 v_mfma_f32_16x16x32_bf16 v[80:83], a[128:131], v[48:51], v[80:83]
 buffer_load_dwordx4 v[40:43], v2, s[48:51], s82 offen offset:2048 sc1
 v_mfma_f32_16x16x32_bf16 v[96:99], a[132:135], v[48:51], v[96:99]
 v_add_f32 v152, v152, v168
 v_add_f32 v153, v153, v169
 v_mfma_f32_16x16x32_bf16 v[128:131], a[132:135], v[52:55], v[128:131]
 buffer_load_dwordx4 v[44:47], v5, s[48:51], s82 offen offset:2048 sc1
 v_mfma_f32_16x16x32_bf16 v[112:115], a[128:131], v[52:55], v[112:115]
 v_add_f32 v154, v154, v170
 v_add_f32 v155, v155, v171
 v_mfma_f32_16x16x32_bf16 v[84:87], a[136:139], v[48:51], v[84:87]
 v_add_f32 v156, v156, v172
 v_add_f32 v157, v157, v173
 v_mfma_f32_16x16x32_bf16 v[100:103], a[140:143], v[48:51], v[100:103]
 s_sub_u32 s69, s63, 1
 s_max_i32 s69, s69, 0
 v_mov_b32 v3, s69
 v_mov_b32 v4, 0
 s_mov_b64 exec, 1
 buffer_store_dword v3, v4, s[48:51], s68 offen sc1
 s_mov_b64 exec, -1
 v_mfma_f32_16x16x32_bf16 v[132:135], a[140:143], v[52:55], v[132:135]
 v_add_f32 v158, v158, v174
 v_add_f32 v159, v159, v175
 v_mfma_f32_16x16x32_bf16 v[116:119], a[136:139], v[52:55], v[116:119]
 s_waitcnt lgkmcnt(4)
 v_mfma_f32_16x16x32_bf16 v[88:91], a[144:147], v[48:51], v[88:91]
 v_add_f32 v144, v144, v176
 v_add_f32 v145, v145, v177
 v_mfma_f32_16x16x32_bf16 v[104:107], a[148:151], v[48:51], v[104:107]
 v_add_f32 v146, v146, v178
 v_add_f32 v147, v147, v179
 v_mfma_f32_16x16x32_bf16 v[136:139], a[148:151], v[52:55], v[136:139]
 v_add_f32 v148, v148, v180
 v_add_f32 v149, v149, v181
 v_mfma_f32_16x16x32_bf16 v[120:123], a[144:147], v[52:55], v[120:123]
 v_add_f32 v150, v150, v182
 v_add_f32 v151, v151, v183
 v_mfma_f32_16x16x32_bf16 v[92:95], a[152:155], v[48:51], v[92:95]
 v_add_f32 v152, v152, v184
 v_add_f32 v153, v153, v185
 v_mfma_f32_16x16x32_bf16 v[108:111], a[156:159], v[48:51], v[108:111]
 v_add_f32 v154, v154, v186
 v_add_f32 v155, v155, v187
 v_mfma_f32_16x16x32_bf16 v[140:143], a[156:159], v[52:55], v[140:143]
 v_add_f32 v156, v156, v188
 v_add_f32 v157, v157, v189
 v_mfma_f32_16x16x32_bf16 v[124:127], a[152:155], v[52:55], v[124:127]
 v_add_f32 v158, v158, v190
 v_add_f32 v159, v159, v191
 s_waitcnt vmcnt(18)
 v_mfma_f32_16x16x32_bf16 v[80:83], a[160:163], v[56:59], v[80:83]
 s_add_u32 s82, s65, 8192
 buffer_load_dwordx4 v[48:51], v2, s[48:51], s82 offen offset:0 sc1
 v_mfma_f32_16x16x32_bf16 v[96:99], a[164:167], v[56:59], v[96:99]
 s_waitcnt lgkmcnt(0)
 v_mfma_f32_16x16x32_bf16 v[128:131], a[164:167], v[60:63], v[128:131]
 buffer_load_dwordx4 v[52:55], v5, s[48:51], s82 offen offset:0 sc1
 v_mfma_f32_16x16x32_bf16 v[112:115], a[160:163], v[60:63], v[112:115]
 v_add_f32 v144, v144, v192
 v_add_f32 v145, v145, v193
 v_mfma_f32_16x16x32_bf16 v[84:87], a[168:171], v[56:59], v[84:87]
 v_add_f32 v146, v146, v194
 v_add_f32 v147, v147, v195
 v_mfma_f32_16x16x32_bf16 v[100:103], a[172:175], v[56:59], v[100:103]
 v_add_f32 v148, v148, v196
 v_add_f32 v149, v149, v197
 v_mfma_f32_16x16x32_bf16 v[132:135], a[172:175], v[60:63], v[132:135]
 v_add_f32 v150, v150, v198
 v_add_f32 v151, v151, v199
 v_mfma_f32_16x16x32_bf16 v[116:119], a[168:171], v[60:63], v[116:119]
 v_add_f32 v152, v152, v200
 v_add_f32 v153, v153, v201
 v_mfma_f32_16x16x32_bf16 v[88:91], a[176:179], v[56:59], v[88:91]
 v_add_f32 v154, v154, v202
 v_add_f32 v155, v155, v203
 v_mfma_f32_16x16x32_bf16 v[104:107], a[180:183], v[56:59], v[104:107]
 v_add_f32 v156, v156, v204
 v_add_f32 v157, v157, v205
 v_mfma_f32_16x16x32_bf16 v[136:139], a[180:183], v[60:63], v[136:139]
 v_add_f32 v158, v158, v206
 v_add_f32 v159, v159, v207
 v_mfma_f32_16x16x32_bf16 v[120:123], a[176:179], v[60:63], v[120:123]
 s_sub_u32 s77, s63, 1
 s_and_b32 s69, s77, 2
 v_mfma_f32_16x16x32_bf16 v[92:95], a[184:187], v[56:59], v[92:95]
 s_lshl_b32 s69, s69, 12
 s_xor_b32 s69, s69, s76
 v_mfma_f32_16x16x32_bf16 v[108:111], a[188:191], v[56:59], v[108:111]
 s_and_b32 s78, s77, 15
 s_lshl_b32 s78, s78, 20
 v_mfma_f32_16x16x32_bf16 v[140:143], a[188:191], v[60:63], v[140:143]
 s_add_u32 s78, s78, s69
 v_mfma_f32_16x16x32_bf16 v[124:127], a[184:187], v[60:63], v[124:127]
 buffer_store_dwordx4 v[148:151], v244, s[48:51], s78 offen sc1
 s_waitcnt vmcnt(19)
 v_mfma_f32_16x16x32_bf16 v[80:83], a[192:195], v[64:67], v[80:83]
 buffer_load_dwordx4 v[56:59], v2, s[48:51], s82 offen offset:2048 sc1
 v_mfma_f32_16x16x32_bf16 v[96:99], a[196:199], v[64:67], v[96:99]
 buffer_store_dwordx4 v[152:155], v245, s[48:51], s78 offen sc1
 v_mfma_f32_16x16x32_bf16 v[128:131], a[196:199], v[68:71], v[128:131]
 buffer_load_dwordx4 v[60:63], v5, s[48:51], s82 offen offset:2048 sc1
 v_mfma_f32_16x16x32_bf16 v[112:115], a[192:195], v[68:71], v[112:115]
 buffer_store_dwordx4 v[156:159], v246, s[48:51], s78 offen sc1
 v_mfma_f32_16x16x32_bf16 v[84:87], a[200:203], v[64:67], v[84:87]
 s_waitcnt vmcnt(18)
 v_mfma_f32_16x16x32_bf16 v[100:103], a[204:207], v[64:67], v[100:103]
 v_add_f32 v224, v224, v232
 v_add_f32 v225, v225, v233
 v_mfma_f32_16x16x32_bf16 v[132:135], a[204:207], v[68:71], v[132:135]
 v_add_f32 v226, v226, v234
 v_add_f32 v227, v227, v235
 v_mfma_f32_16x16x32_bf16 v[116:119], a[200:203], v[68:71], v[116:119]
 v_add_f32 v224, v224, v236
 v_add_f32 v225, v225, v237
 v_mfma_f32_16x16x32_bf16 v[88:91], a[208:211], v[64:67], v[88:91]
 v_add_f32 v226, v226, v238
 v_add_f32 v227, v227, v239
 v_mfma_f32_16x16x32_bf16 v[104:107], a[212:215], v[64:67], v[104:107]
 v_add_f32 v224, v224, v240
 v_add_f32 v225, v225, v241
 v_mfma_f32_16x16x32_bf16 v[136:139], a[212:215], v[68:71], v[136:139]
 v_add_f32 v226, v226, v242
 v_add_f32 v227, v227, v243
 v_mfma_f32_16x16x32_bf16 v[120:123], a[208:211], v[68:71], v[120:123]
 s_sub_u32 s77, s63, 7
 s_cselect_b32 s77, 64, s77
 s_lshl_b32 s69, s77, 17
 v_mfma_f32_16x16x32_bf16 v[92:95], a[216:219], v[64:67], v[92:95]
 s_add_u32 s69, s69, s67
 v_cvt_pk_bf16_f32 v14, v224, v225
 v_mfma_f32_16x16x32_bf16 v[108:111], a[220:223], v[64:67], v[108:111]
 v_cvt_pk_bf16_f32 v15, v226, v227
 v_mfma_f32_16x16x32_bf16 v[140:143], a[220:223], v[68:71], v[140:143]
 buffer_store_dwordx2 v[14:15], v250, s[56:59], s69 offen
 v_mfma_f32_16x16x32_bf16 v[124:127], a[216:219], v[68:71], v[124:127]
 v_mov_b64 v[224:225], v[216:217]
 v_mov_b64 v[226:227], v[218:219]
 v_mfma_f32_16x16x32_bf16 v[80:83], a[224:227], v[72:75], v[80:83]
 s_add_u32 s82, s65, 12288
 buffer_load_dwordx4 v[64:67], v2, s[48:51], s82 offen offset:0 sc1
 v_mfma_f32_16x16x32_bf16 v[96:99], a[228:231], v[72:75], v[96:99]
 v_mov_b64 v[216:217], v[208:209]
 v_mov_b64 v[218:219], v[210:211]
 v_mfma_f32_16x16x32_bf16 v[128:131], a[228:231], v[76:79], v[128:131]
 buffer_load_dwordx4 v[68:71], v5, s[48:51], s82 offen offset:0 sc1
 v_mfma_f32_16x16x32_bf16 v[112:115], a[224:227], v[76:79], v[112:115]
 v_mov_b64 v[208:209], v[144:145]
 v_mov_b64 v[210:211], v[146:147]
 v_mfma_f32_16x16x32_bf16 v[84:87], a[232:235], v[72:75], v[84:87]
 v_mfma_f32_16x16x32_bf16 v[100:103], a[236:239], v[72:75], v[100:103]
 v_mfma_f32_16x16x32_bf16 v[132:135], a[236:239], v[76:79], v[132:135]
 v_mfma_f32_16x16x32_bf16 v[116:119], a[232:235], v[76:79], v[116:119]
 v_mfma_f32_16x16x32_bf16 v[88:91], a[240:243], v[72:75], v[88:91]
 v_mfma_f32_16x16x32_bf16 v[104:107], a[244:247], v[72:75], v[104:107]
 v_mfma_f32_16x16x32_bf16 v[136:139], a[244:247], v[76:79], v[136:139]
 v_mfma_f32_16x16x32_bf16 v[120:123], a[240:243], v[76:79], v[120:123]
 v_mfma_f32_16x16x32_bf16 v[92:95], a[248:251], v[72:75], v[92:95]
 v_mfma_f32_16x16x32_bf16 v[108:111], a[252:255], v[72:75], v[108:111]
 v_mfma_f32_16x16x32_bf16 v[140:143], a[252:255], v[76:79], v[140:143]
 v_mfma_f32_16x16x32_bf16 v[124:127], a[248:251], v[76:79], v[124:127]
 buffer_load_dwordx4 v[72:75], v2, s[48:51], s82 offen offset:2048 sc1
 buffer_load_dwordx4 v[76:79], v5, s[48:51], s82 offen offset:2048 sc1
 s_waitcnt vmcnt(17)
 s_mov_b32 s73, 1
 s_add_u32 s65, s65, 0x40000
 s_branch nxt_24
dry_27:
 s_waitcnt vmcnt(14)
 v_mfma_f32_16x16x32_bf16 v[80:83], a[0:3], v[16:19], 0
 v_mfma_f32_16x16x32_bf16 v[96:99], a[4:7], v[16:19], 0
 v_mfma_f32_16x16x32_bf16 v[128:131], a[4:7], v[20:23], 0
 ds_write_b128 v7, v[160:163] offset:49152
 v_mfma_f32_16x16x32_bf16 v[112:115], a[0:3], v[20:23], 0
 v_mfma_f32_16x16x32_bf16 v[84:87], a[8:11], v[16:19], 0
 s_sub_u32 s70, s63, 6
 s_mov_b64 exec, 0xf
 v_cmp_gt_i32 vcc, s70, v13
 s_mov_b64 exec, -1
 s_cbranch_vccz finok_31
 s_mov_b64 exec, 15
w_32:
 buffer_load_dword v4, v11, s[48:51], s75 offen sc1
 s_waitcnt vmcnt(0)
 v_cmp_gt_u32 vcc, s70, v4
 s_cbranch_vccz wok_33
 s_sleep 2
 s_sub_u32 s46, s46, 1
 s_cbranch_scc0 w_32
 s_mov_b32 s46, 0
 s_branch wok_33
wok_33:
 s_mov_b64 exec, -1
finok_31:
 s_sub_u32 s77, s63, 7
 s_and_b32 s69, s77, 2
 s_lshl_b32 s69, s69, 12
 s_xor_b32 s69, s69, s76
 s_and_b32 s78, s77, 15
 s_lshl_b32 s78, s78, 20
 s_add_u32 s78, s78, s69
 buffer_load_dwordx4 v[232:235], v247, s[48:51], s78 offen sc1
 buffer_load_dwordx4 v[236:239], v248, s[48:51], s78 offen sc1
 buffer_load_dwordx4 v[240:243], v249, s[48:51], s78 offen sc1
 v_mfma_f32_16x16x32_bf16 v[100:103], a[12:15], v[16:19], 0
 v_mfma_f32_16x16x32_bf16 v[132:135], a[12:15], v[20:23], 0
 ds_write_b128 v7, v[164:167] offset:50176
 v_mfma_f32_16x16x32_bf16 v[116:119], a[8:11], v[20:23], 0
 v_mfma_f32_16x16x32_bf16 v[88:91], a[16:19], v[16:19], 0
 v_mfma_f32_16x16x32_bf16 v[104:107], a[20:23], v[16:19], 0
 ds_write_b128 v7, v[168:171] offset:51200
 v_mfma_f32_16x16x32_bf16 v[136:139], a[20:23], v[20:23], 0
 v_mfma_f32_16x16x32_bf16 v[120:123], a[16:19], v[20:23], 0
 v_mfma_f32_16x16x32_bf16 v[92:95], a[24:27], v[16:19], 0
 ds_write_b128 v7, v[172:175] offset:52224
 v_mfma_f32_16x16x32_bf16 v[108:111], a[28:31], v[16:19], 0
 v_mfma_f32_16x16x32_bf16 v[140:143], a[28:31], v[20:23], 0
 v_mfma_f32_16x16x32_bf16 v[124:127], a[24:27], v[20:23], 0
 ds_write_b128 v8, v[176:179] offset:49152
 s_waitcnt vmcnt(15)
 v_mfma_f32_16x16x32_bf16 v[80:83], a[32:35], v[24:27], v[80:83]
 v_mfma_f32_16x16x32_bf16 v[96:99], a[36:39], v[24:27], v[96:99]
 v_mfma_f32_16x16x32_bf16 v[128:131], a[36:39], v[28:31], v[128:131]
 ds_write_b128 v8, v[180:183] offset:50176
 v_mfma_f32_16x16x32_bf16 v[112:115], a[32:35], v[28:31], v[112:115]
 v_mfma_f32_16x16x32_bf16 v[84:87], a[40:43], v[24:27], v[84:87]
 v_mfma_f32_16x16x32_bf16 v[100:103], a[44:47], v[24:27], v[100:103]
 ds_write_b128 v8, v[184:187] offset:51200
 v_mfma_f32_16x16x32_bf16 v[132:135], a[44:47], v[28:31], v[132:135]
 v_mfma_f32_16x16x32_bf16 v[116:119], a[40:43], v[28:31], v[116:119]
 v_mfma_f32_16x16x32_bf16 v[88:91], a[48:51], v[24:27], v[88:91]
 ds_write_b128 v8, v[188:191] offset:52224
 v_mfma_f32_16x16x32_bf16 v[104:107], a[52:55], v[24:27], v[104:107]
 v_mfma_f32_16x16x32_bf16 v[136:139], a[52:55], v[28:31], v[136:139]
 v_mfma_f32_16x16x32_bf16 v[120:123], a[48:51], v[28:31], v[120:123]
 ds_write_b128 v9, v[192:195] offset:49152
 v_mfma_f32_16x16x32_bf16 v[92:95], a[56:59], v[24:27], v[92:95]
 v_mfma_f32_16x16x32_bf16 v[108:111], a[60:63], v[24:27], v[108:111]
 v_mfma_f32_16x16x32_bf16 v[140:143], a[60:63], v[28:31], v[140:143]
 ds_write_b128 v9, v[196:199] offset:50176
 v_mfma_f32_16x16x32_bf16 v[124:127], a[56:59], v[28:31], v[124:127]
 s_waitcnt vmcnt(13)
 v_mfma_f32_16x16x32_bf16 v[80:83], a[64:67], v[32:35], v[80:83]
 v_mfma_f32_16x16x32_bf16 v[96:99], a[68:71], v[32:35], v[96:99]
 ds_write_b128 v9, v[200:203] offset:51200
 v_mfma_f32_16x16x32_bf16 v[128:131], a[68:71], v[36:39], v[128:131]
 v_mfma_f32_16x16x32_bf16 v[112:115], a[64:67], v[36:39], v[112:115]
 v_mfma_f32_16x16x32_bf16 v[84:87], a[72:75], v[32:35], v[84:87]
 ds_write_b128 v9, v[204:207] offset:52224
 v_mfma_f32_16x16x32_bf16 v[100:103], a[76:79], v[32:35], v[100:103]
 v_mfma_f32_16x16x32_bf16 v[132:135], a[76:79], v[36:39], v[132:135]
 v_mfma_f32_16x16x32_bf16 v[116:119], a[72:75], v[36:39], v[116:119]
 s_waitcnt lgkmcnt(0)
 s_barrier
 v_mfma_f32_16x16x32_bf16 v[88:91], a[80:83], v[32:35], v[88:91]
 ds_read_b128 v[160:163], v10 offset:49152
 v_mfma_f32_16x16x32_bf16 v[104:107], a[84:87], v[32:35], v[104:107]
 ds_read_b128 v[164:167], v10 offset:50176
 v_mfma_f32_16x16x32_bf16 v[136:139], a[84:87], v[36:39], v[136:139]
 ds_read_b128 v[168:171], v10 offset:51200
 v_mfma_f32_16x16x32_bf16 v[120:123], a[80:83], v[36:39], v[120:123]
 ds_read_b128 v[172:175], v10 offset:52224
 v_mfma_f32_16x16x32_bf16 v[92:95], a[88:91], v[32:35], v[92:95]
 ds_read_b128 v[176:179], v10 offset:53248
 v_mfma_f32_16x16x32_bf16 v[108:111], a[92:95], v[32:35], v[108:111]
 s_add_u32 s77, s63, 2
 s_and_b32 s69, s77, 3
 s_lshl_b32 s69, s69, 7
 s_add_u32 s71, s69, s74
 s_lshr_b32 s70, s77, 2
 s_add_u32 s70, s70, 1
 s_mov_b32 s72, s70
 s_mov_b64 exec, 0xff
 buffer_load_dword v12, v11, s[48:51], s71 offen sc1
 buffer_load_dword v13, v11, s[48:51], s75 offen sc1
 s_mov_b64 exec, -1
 v_mfma_f32_16x16x32_bf16 v[140:143], a[92:95], v[36:39], v[140:143]
 ds_read_b128 v[180:183], v10 offset:54272
 v_mfma_f32_16x16x32_bf16 v[124:127], a[88:91], v[36:39], v[124:127]
 ds_read_b128 v[184:187], v10 offset:55296
 s_waitcnt vmcnt(13)
 v_mfma_f32_16x16x32_bf16 v[80:83], a[96:99], v[40:43], v[80:83]
 ds_read_b128 v[188:191], v10 offset:56320
 v_mfma_f32_16x16x32_bf16 v[96:99], a[100:103], v[40:43], v[96:99]
 ds_read_b128 v[192:195], v10 offset:57344
 v_mfma_f32_16x16x32_bf16 v[128:131], a[100:103], v[44:47], v[128:131]
 ds_read_b128 v[196:199], v10 offset:58368
 v_mfma_f32_16x16x32_bf16 v[112:115], a[96:99], v[44:47], v[112:115]
 ds_read_b128 v[200:203], v10 offset:59392
 v_mfma_f32_16x16x32_bf16 v[84:87], a[104:107], v[40:43], v[84:87]
 ds_read_b128 v[204:207], v10 offset:60416
 v_mfma_f32_16x16x32_bf16 v[100:103], a[108:111], v[40:43], v[100:103]
 s_waitcnt lgkmcnt(8)
 v_mfma_f32_16x16x32_bf16 v[132:135], a[108:111], v[44:47], v[132:135]
 v_add_f32 v144, v144, v160
 v_add_f32 v145, v145, v161
 v_mfma_f32_16x16x32_bf16 v[116:119], a[104:107], v[44:47], v[116:119]
 v_add_f32 v146, v146, v162
 v_add_f32 v147, v147, v163
 v_mfma_f32_16x16x32_bf16 v[88:91], a[112:115], v[40:43], v[88:91]
 v_add_f32 v148, v148, v164
 v_add_f32 v149, v149, v165
 v_mfma_f32_16x16x32_bf16 v[104:107], a[116:119], v[40:43], v[104:107]
 v_add_f32 v150, v150, v166
 v_add_f32 v151, v151, v167
 v_mfma_f32_16x16x32_bf16 v[136:139], a[116:119], v[44:47], v[136:139]
 v_add_f32 v152, v152, v168
 v_add_f32 v153, v153, v169
 v_mfma_f32_16x16x32_bf16 v[120:123], a[112:115], v[44:47], v[120:123]
 v_add_f32 v154, v154, v170
 v_add_f32 v155, v155, v171
 v_mfma_f32_16x16x32_bf16 v[92:95], a[120:123], v[40:43], v[92:95]
 v_add_f32 v156, v156, v172
 v_add_f32 v157, v157, v173
 v_mfma_f32_16x16x32_bf16 v[108:111], a[124:127], v[40:43], v[108:111]
 v_add_f32 v158, v158, v174
 v_add_f32 v159, v159, v175
 v_mfma_f32_16x16x32_bf16 v[140:143], a[124:127], v[44:47], v[140:143]
 s_waitcnt lgkmcnt(4)
 v_mfma_f32_16x16x32_bf16 v[124:127], a[120:123], v[44:47], v[124:127]
 v_add_f32 v144, v144, v176
 v_add_f32 v145, v145, v177
 s_waitcnt vmcnt(11)
 v_mfma_f32_16x16x32_bf16 v[80:83], a[128:131], v[48:51], v[80:83]
 v_add_f32 v146, v146, v178
 v_add_f32 v147, v147, v179
 v_mfma_f32_16x16x32_bf16 v[96:99], a[132:135], v[48:51], v[96:99]
 v_add_f32 v148, v148, v180
 v_add_f32 v149, v149, v181
 v_mfma_f32_16x16x32_bf16 v[128:131], a[132:135], v[52:55], v[128:131]
 v_add_f32 v150, v150, v182
 v_add_f32 v151, v151, v183
 v_mfma_f32_16x16x32_bf16 v[112:115], a[128:131], v[52:55], v[112:115]
 v_add_f32 v152, v152, v184
 v_add_f32 v153, v153, v185
 v_mfma_f32_16x16x32_bf16 v[84:87], a[136:139], v[48:51], v[84:87]
 v_add_f32 v154, v154, v186
 v_add_f32 v155, v155, v187
 v_mfma_f32_16x16x32_bf16 v[100:103], a[140:143], v[48:51], v[100:103]
 s_sub_u32 s69, s63, 1
 s_max_i32 s69, s69, 0
 v_mov_b32 v3, s69
 v_mov_b32 v4, 0
 s_mov_b64 exec, 1
 buffer_store_dword v3, v4, s[48:51], s68 offen sc1
 s_mov_b64 exec, -1
 v_mfma_f32_16x16x32_bf16 v[132:135], a[140:143], v[52:55], v[132:135]
 v_add_f32 v156, v156, v188
 v_add_f32 v157, v157, v189
 v_mfma_f32_16x16x32_bf16 v[116:119], a[136:139], v[52:55], v[116:119]
 v_add_f32 v158, v158, v190
 v_add_f32 v159, v159, v191
 v_mfma_f32_16x16x32_bf16 v[88:91], a[144:147], v[48:51], v[88:91]
 s_waitcnt lgkmcnt(0)
 v_mfma_f32_16x16x32_bf16 v[104:107], a[148:151], v[48:51], v[104:107]
 v_add_f32 v144, v144, v192
 v_add_f32 v145, v145, v193
 v_mfma_f32_16x16x32_bf16 v[136:139], a[148:151], v[52:55], v[136:139]
 v_add_f32 v146, v146, v194
 v_add_f32 v147, v147, v195
 v_mfma_f32_16x16x32_bf16 v[120:123], a[144:147], v[52:55], v[120:123]
 v_add_f32 v148, v148, v196
 v_add_f32 v149, v149, v197
 v_mfma_f32_16x16x32_bf16 v[92:95], a[152:155], v[48:51], v[92:95]
 v_add_f32 v150, v150, v198
 v_add_f32 v151, v151, v199
 v_mfma_f32_16x16x32_bf16 v[108:111], a[156:159], v[48:51], v[108:111]
 v_add_f32 v152, v152, v200
 v_add_f32 v153, v153, v201
 v_mfma_f32_16x16x32_bf16 v[140:143], a[156:159], v[52:55], v[140:143]
 v_add_f32 v154, v154, v202
 v_add_f32 v155, v155, v203
 v_mfma_f32_16x16x32_bf16 v[124:127], a[152:155], v[52:55], v[124:127]
 v_add_f32 v156, v156, v204
 v_add_f32 v157, v157, v205
 s_waitcnt vmcnt(10)
 v_mfma_f32_16x16x32_bf16 v[80:83], a[160:163], v[56:59], v[80:83]
 v_add_f32 v158, v158, v206
 v_add_f32 v159, v159, v207
 v_mfma_f32_16x16x32_bf16 v[96:99], a[164:167], v[56:59], v[96:99]
 s_sub_u32 s77, s63, 1
 s_and_b32 s69, s77, 2
 v_mfma_f32_16x16x32_bf16 v[128:131], a[164:167], v[60:63], v[128:131]
 s_lshl_b32 s69, s69, 12
 s_xor_b32 s69, s69, s76
 v_mfma_f32_16x16x32_bf16 v[112:115], a[160:163], v[60:63], v[112:115]
 s_and_b32 s78, s77, 15
 s_lshl_b32 s78, s78, 20
 v_mfma_f32_16x16x32_bf16 v[84:87], a[168:171], v[56:59], v[84:87]
 s_add_u32 s78, s78, s69
 v_mfma_f32_16x16x32_bf16 v[100:103], a[172:175], v[56:59], v[100:103]
 buffer_store_dwordx4 v[148:151], v244, s[48:51], s78 offen sc1
 v_mfma_f32_16x16x32_bf16 v[132:135], a[172:175], v[60:63], v[132:135]
 buffer_store_dwordx4 v[152:155], v245, s[48:51], s78 offen sc1
 v_mfma_f32_16x16x32_bf16 v[116:119], a[168:171], v[60:63], v[116:119]
 buffer_store_dwordx4 v[156:159], v246, s[48:51], s78 offen sc1
 v_mfma_f32_16x16x32_bf16 v[88:91], a[176:179], v[56:59], v[88:91]
 s_waitcnt vmcnt(6)
 v_mfma_f32_16x16x32_bf16 v[104:107], a[180:183], v[56:59], v[104:107]
 v_add_f32 v224, v224, v232
 v_add_f32 v225, v225, v233
 v_mfma_f32_16x16x32_bf16 v[136:139], a[180:183], v[60:63], v[136:139]
 v_add_f32 v226, v226, v234
 v_add_f32 v227, v227, v235
 v_mfma_f32_16x16x32_bf16 v[120:123], a[176:179], v[60:63], v[120:123]
 v_add_f32 v224, v224, v236
 v_add_f32 v225, v225, v237
 v_mfma_f32_16x16x32_bf16 v[92:95], a[184:187], v[56:59], v[92:95]
 v_add_f32 v226, v226, v238
 v_add_f32 v227, v227, v239
 v_mfma_f32_16x16x32_bf16 v[108:111], a[188:191], v[56:59], v[108:111]
 v_add_f32 v224, v224, v240
 v_add_f32 v225, v225, v241
 v_mfma_f32_16x16x32_bf16 v[140:143], a[188:191], v[60:63], v[140:143]
 v_add_f32 v226, v226, v242
 v_add_f32 v227, v227, v243
 v_mfma_f32_16x16x32_bf16 v[124:127], a[184:187], v[60:63], v[124:127]
 s_sub_u32 s77, s63, 7
 s_cselect_b32 s77, 64, s77
 s_lshl_b32 s69, s77, 17
 v_mfma_f32_16x16x32_bf16 v[80:83], a[192:195], v[64:67], v[80:83]
 s_add_u32 s69, s69, s67
 v_cvt_pk_bf16_f32 v14, v224, v225
 v_mfma_f32_16x16x32_bf16 v[96:99], a[196:199], v[64:67], v[96:99]
 v_cvt_pk_bf16_f32 v15, v226, v227
 v_mfma_f32_16x16x32_bf16 v[128:131], a[196:199], v[68:71], v[128:131]
 buffer_store_dwordx2 v[14:15], v250, s[56:59], s69 offen
 v_mfma_f32_16x16x32_bf16 v[112:115], a[192:195], v[68:71], v[112:115]
 v_mov_b64 v[224:225], v[216:217]
 v_mov_b64 v[226:227], v[218:219]
 v_mfma_f32_16x16x32_bf16 v[84:87], a[200:203], v[64:67], v[84:87]
 v_mov_b64 v[216:217], v[208:209]
 v_mov_b64 v[218:219], v[210:211]
 v_mfma_f32_16x16x32_bf16 v[100:103], a[204:207], v[64:67], v[100:103]
 v_mov_b64 v[208:209], v[144:145]
 v_mov_b64 v[210:211], v[146:147]
 v_mfma_f32_16x16x32_bf16 v[132:135], a[204:207], v[68:71], v[132:135]
 v_mfma_f32_16x16x32_bf16 v[116:119], a[200:203], v[68:71], v[116:119]
 v_mfma_f32_16x16x32_bf16 v[88:91], a[208:211], v[64:67], v[88:91]
 v_mfma_f32_16x16x32_bf16 v[104:107], a[212:215], v[64:67], v[104:107]
 v_mfma_f32_16x16x32_bf16 v[136:139], a[212:215], v[68:71], v[136:139]
 v_mfma_f32_16x16x32_bf16 v[120:123], a[208:211], v[68:71], v[120:123]
 v_mfma_f32_16x16x32_bf16 v[92:95], a[216:219], v[64:67], v[92:95]
 v_mfma_f32_16x16x32_bf16 v[108:111], a[220:223], v[64:67], v[108:111]
 v_mfma_f32_16x16x32_bf16 v[140:143], a[220:223], v[68:71], v[140:143]
 v_mfma_f32_16x16x32_bf16 v[124:127], a[216:219], v[68:71], v[124:127]
 v_mfma_f32_16x16x32_bf16 v[80:83], a[224:227], v[72:75], v[80:83]
 v_mfma_f32_16x16x32_bf16 v[96:99], a[228:231], v[72:75], v[96:99]
 v_mfma_f32_16x16x32_bf16 v[128:131], a[228:231], v[76:79], v[128:131]
 v_mfma_f32_16x16x32_bf16 v[112:115], a[224:227], v[76:79], v[112:115]
 v_mfma_f32_16x16x32_bf16 v[84:87], a[232:235], v[72:75], v[84:87]
 v_mfma_f32_16x16x32_bf16 v[100:103], a[236:239], v[72:75], v[100:103]
 v_mfma_f32_16x16x32_bf16 v[132:135], a[236:239], v[76:79], v[132:135]
 v_mfma_f32_16x16x32_bf16 v[116:119], a[232:235], v[76:79], v[116:119]
 v_mfma_f32_16x16x32_bf16 v[88:91], a[240:243], v[72:75], v[88:91]
 v_mfma_f32_16x16x32_bf16 v[104:107], a[244:247], v[72:75], v[104:107]
 v_mfma_f32_16x16x32_bf16 v[136:139], a[244:247], v[76:79], v[136:139]
 v_mfma_f32_16x16x32_bf16 v[120:123], a[240:243], v[76:79], v[120:123]
 v_mfma_f32_16x16x32_bf16 v[92:95], a[248:251], v[72:75], v[92:95]
 v_mfma_f32_16x16x32_bf16 v[108:111], a[252:255], v[72:75], v[108:111]
 v_mfma_f32_16x16x32_bf16 v[140:143], a[252:255], v[76:79], v[140:143]
 v_mfma_f32_16x16x32_bf16 v[124:127], a[248:251], v[76:79], v[124:127]
 s_waitcnt vmcnt(5)
 s_mov_b32 s73, 0
 s_branch nxt_24
have_23:
 s_mov_b64 exec, 0xff
 v_cmp_gt_u32 vcc, s72, v12
 s_mov_b64 exec, -1
 s_cbranch_vccnz dry_34
 v_mfma_f32_16x16x32_bf16 v[80:83], a[0:3], v[16:19], 0
 v_mfma_f32_16x16x32_bf16 v[96:99], a[4:7], v[16:19], 0
 v_mfma_f32_16x16x32_bf16 v[128:131], a[4:7], v[20:23], 0
 ds_write_b128 v7, v[160:163] offset:49152
 v_mfma_f32_16x16x32_bf16 v[112:115], a[0:3], v[20:23], 0
 v_mfma_f32_16x16x32_bf16 v[84:87], a[8:11], v[16:19], 0
 s_sub_u32 s70, s63, 6
 s_mov_b64 exec, 0xf
 v_cmp_gt_i32 vcc, s70, v13
 s_mov_b64 exec, -1
 s_cbranch_vccz finok_35
 s_mov_b64 exec, 15
w_36:
 buffer_load_dword v4, v11, s[48:51], s75 offen sc1
 s_waitcnt vmcnt(0)
 v_cmp_gt_u32 vcc, s70, v4
 s_cbranch_vccz wok_37
 s_sleep 2
 s_sub_u32 s46, s46, 1
 s_cbranch_scc0 w_36
 s_mov_b32 s46, 0
 s_branch wok_37
wok_37:
 s_mov_b64 exec, -1
finok_35:
 s_sub_u32 s77, s63, 7
 s_and_b32 s69, s77, 2
 s_lshl_b32 s69, s69, 12
 s_xor_b32 s69, s69, s76
 s_and_b32 s78, s77, 15
 s_lshl_b32 s78, s78, 20
 s_add_u32 s78, s78, s69
 buffer_load_dwordx4 v[232:235], v247, s[48:51], s78 offen sc1
 buffer_load_dwordx4 v[236:239], v248, s[48:51], s78 offen sc1
 buffer_load_dwordx4 v[240:243], v249, s[48:51], s78 offen sc1
 v_mfma_f32_16x16x32_bf16 v[100:103], a[12:15], v[16:19], 0
 v_mfma_f32_16x16x32_bf16 v[132:135], a[12:15], v[20:23], 0
 ds_write_b128 v7, v[164:167] offset:50176
 v_mfma_f32_16x16x32_bf16 v[116:119], a[8:11], v[20:23], 0
 v_mfma_f32_16x16x32_bf16 v[88:91], a[16:19], v[16:19], 0
 v_mfma_f32_16x16x32_bf16 v[104:107], a[20:23], v[16:19], 0
 ds_write_b128 v7, v[168:171] offset:51200
 v_mfma_f32_16x16x32_bf16 v[136:139], a[20:23], v[20:23], 0
 v_mfma_f32_16x16x32_bf16 v[120:123], a[16:19], v[20:23], 0
 v_mfma_f32_16x16x32_bf16 v[92:95], a[24:27], v[16:19], 0
 ds_write_b128 v7, v[172:175] offset:52224
 v_mfma_f32_16x16x32_bf16 v[108:111], a[28:31], v[16:19], 0
 v_mfma_f32_16x16x32_bf16 v[140:143], a[28:31], v[20:23], 0
 v_mfma_f32_16x16x32_bf16 v[124:127], a[24:27], v[20:23], 0
 ds_write_b128 v8, v[176:179] offset:49152
 v_mfma_f32_16x16x32_bf16 v[80:83], a[32:35], v[24:27], v[80:83]
 s_add_u32 s82, s65, 0
 buffer_load_dwordx4 v[16:19], v2, s[48:51], s82 offen offset:0 sc1
 v_mfma_f32_16x16x32_bf16 v[96:99], a[36:39], v[24:27], v[96:99]
 v_mfma_f32_16x16x32_bf16 v[128:131], a[36:39], v[28:31], v[128:131]
 buffer_load_dwordx4 v[20:23], v5, s[48:51], s82 offen offset:0 sc1
 v_mfma_f32_16x16x32_bf16 v[112:115], a[32:35], v[28:31], v[112:115]
 v_mfma_f32_16x16x32_bf16 v[84:87], a[40:43], v[24:27], v[84:87]
 ds_write_b128 v8, v[180:183] offset:50176
 v_mfma_f32_16x16x32_bf16 v[100:103], a[44:47], v[24:27], v[100:103]
 v_mfma_f32_16x16x32_bf16 v[132:135], a[44:47], v[28:31], v[132:135]
 v_mfma_f32_16x16x32_bf16 v[116:119], a[40:43], v[28:31], v[116:119]
 ds_write_b128 v8, v[184:187] offset:51200
 v_mfma_f32_16x16x32_bf16 v[88:91], a[48:51], v[24:27], v[88:91]
 v_mfma_f32_16x16x32_bf16 v[104:107], a[52:55], v[24:27], v[104:107]
 v_mfma_f32_16x16x32_bf16 v[136:139], a[52:55], v[28:31], v[136:139]
 ds_write_b128 v8, v[188:191] offset:52224
 v_mfma_f32_16x16x32_bf16 v[120:123], a[48:51], v[28:31], v[120:123]
 v_mfma_f32_16x16x32_bf16 v[92:95], a[56:59], v[24:27], v[92:95]
 v_mfma_f32_16x16x32_bf16 v[108:111], a[60:63], v[24:27], v[108:111]
 ds_write_b128 v9, v[192:195] offset:49152
 v_mfma_f32_16x16x32_bf16 v[140:143], a[60:63], v[28:31], v[140:143]
 v_mfma_f32_16x16x32_bf16 v[124:127], a[56:59], v[28:31], v[124:127]
 s_waitcnt vmcnt(20)
 v_mfma_f32_16x16x32_bf16 v[80:83], a[64:67], v[32:35], v[80:83]
 buffer_load_dwordx4 v[24:27], v2, s[48:51], s82 offen offset:2048 sc1
 v_mfma_f32_16x16x32_bf16 v[96:99], a[68:71], v[32:35], v[96:99]
 ds_write_b128 v9, v[196:199] offset:50176
 v_mfma_f32_16x16x32_bf16 v[128:131], a[68:71], v[36:39], v[128:131]
 buffer_load_dwordx4 v[28:31], v5, s[48:51], s82 offen offset:2048 sc1
 v_mfma_f32_16x16x32_bf16 v[112:115], a[64:67], v[36:39], v[112:115]
 v_mfma_f32_16x16x32_bf16 v[84:87], a[72:75], v[32:35], v[84:87]
 v_mfma_f32_16x16x32_bf16 v[100:103], a[76:79], v[32:35], v[100:103]
 ds_write_b128 v9, v[200:203] offset:51200
 v_mfma_f32_16x16x32_bf16 v[132:135], a[76:79], v[36:39], v[132:135]
 v_mfma_f32_16x16x32_bf16 v[116:119], a[72:75], v[36:39], v[116:119]
 v_mfma_f32_16x16x32_bf16 v[88:91], a[80:83], v[32:35], v[88:91]
 ds_write_b128 v9, v[204:207] offset:52224
 v_mfma_f32_16x16x32_bf16 v[104:107], a[84:87], v[32:35], v[104:107]
 v_mfma_f32_16x16x32_bf16 v[136:139], a[84:87], v[36:39], v[136:139]
 v_mfma_f32_16x16x32_bf16 v[120:123], a[80:83], v[36:39], v[120:123]
 s_waitcnt lgkmcnt(0)
 s_barrier
 v_mfma_f32_16x16x32_bf16 v[92:95], a[88:91], v[32:35], v[92:95]
 ds_read_b128 v[160:163], v10 offset:49152
 v_mfma_f32_16x16x32_bf16 v[108:111], a[92:95], v[32:35], v[108:111]
 s_add_u32 s77, s63, 2
 s_and_b32 s69, s77, 3
 s_lshl_b32 s69, s69, 7
 s_add_u32 s71, s69, s74
 s_lshr_b32 s70, s77, 2
 s_add_u32 s70, s70, 1
 s_mov_b32 s72, s70
 s_mov_b64 exec, 0xff
 buffer_load_dword v12, v11, s[48:51], s71 offen sc1
 buffer_load_dword v13, v11, s[48:51], s75 offen sc1
 s_mov_b64 exec, -1
 v_mfma_f32_16x16x32_bf16 v[140:143], a[92:95], v[36:39], v[140:143]
 ds_read_b128 v[164:167], v10 offset:50176
 v_mfma_f32_16x16x32_bf16 v[124:127], a[88:91], v[36:39], v[124:127]
 ds_read_b128 v[168:171], v10 offset:51200
 s_waitcnt vmcnt(22)
 v_mfma_f32_16x16x32_bf16 v[80:83], a[96:99], v[40:43], v[80:83]
 s_add_u32 s82, s65, 4096
 buffer_load_dwordx4 v[32:35], v2, s[48:51], s82 offen offset:0 sc1
 v_mfma_f32_16x16x32_bf16 v[96:99], a[100:103], v[40:43], v[96:99]
 ds_read_b128 v[172:175], v10 offset:52224
 v_mfma_f32_16x16x32_bf16 v[128:131], a[100:103], v[44:47], v[128:131]
 buffer_load_dwordx4 v[36:39], v5, s[48:51], s82 offen offset:0 sc1
 v_mfma_f32_16x16x32_bf16 v[112:115], a[96:99], v[44:47], v[112:115]
 ds_read_b128 v[176:179], v10 offset:53248
 v_mfma_f32_16x16x32_bf16 v[84:87], a[104:107], v[40:43], v[84:87]
 ds_read_b128 v[180:183], v10 offset:54272
 v_mfma_f32_16x16x32_bf16 v[100:103], a[108:111], v[40:43], v[100:103]
 ds_read_b128 v[184:187], v10 offset:55296
 v_mfma_f32_16x16x32_bf16 v[132:135], a[108:111], v[44:47], v[132:135]
 ds_read_b128 v[188:191], v10 offset:56320
 v_mfma_f32_16x16x32_bf16 v[116:119], a[104:107], v[44:47], v[116:119]
 ds_read_b128 v[192:195], v10 offset:57344
 v_mfma_f32_16x16x32_bf16 v[88:91], a[112:115], v[40:43], v[88:91]
 ds_read_b128 v[196:199], v10 offset:58368
 v_mfma_f32_16x16x32_bf16 v[104:107], a[116:119], v[40:43], v[104:107]
 ds_read_b128 v[200:203], v10 offset:59392
 v_mfma_f32_16x16x32_bf16 v[136:139], a[116:119], v[44:47], v[136:139]
 ds_read_b128 v[204:207], v10 offset:60416
 v_mfma_f32_16x16x32_bf16 v[120:123], a[112:115], v[44:47], v[120:123]
 s_waitcnt lgkmcnt(8)
 v_mfma_f32_16x16x32_bf16 v[92:95], a[120:123], v[40:43], v[92:95]
 v_add_f32 v144, v144, v160
 v_add_f32 v145, v145, v161
 v_mfma_f32_16x16x32_bf16 v[108:111], a[124:127], v[40:43], v[108:111]
 v_add_f32 v146, v146, v162
 v_add_f32 v147, v147, v163
 v_mfma_f32_16x16x32_bf16 v[140:143], a[124:127], v[44:47], v[140:143]
 v_add_f32 v148, v148, v164
 v_add_f32 v149, v149, v165
 v_mfma_f32_16x16x32_bf16 v[124:127], a[120:123], v[44:47], v[124:127]
 v_add_f32 v150, v150, v166
 v_add_f32 v151, v151, v167
 s_waitcnt vmcnt(21)
 v_mfma_f32_16x16x32_bf16 v[80:83], a[128:131], v[48:51], v[80:83]
 buffer_load_dwordx4 v[40:43], v2, s[48:51], s82 offen offset:2048 sc1
 v_mfma_f32_16x16x32_bf16 v[96:99], a[132:135], v[48:51], v[96:99]
 v_add_f32 v152, v152, v168
 v_add_f32 v153, v153, v169
 v_mfma_f32_16x16x32_bf16 v[128:131], a[132:135], v[52:55], v[128:131]
 buffer_load_dwordx4 v[44:47], v5, s[48:51], s82 offen offset:2048 sc1
 v_mfma_f32_16x16x32_bf16 v[112:115], a[128:131], v[52:55], v[112:115]
 v_add_f32 v154, v154, v170
 v_add_f32 v155, v155, v171
 v_mfma_f32_16x16x32_bf16 v[84:87], a[136:139], v[48:51], v[84:87]
 v_add_f32 v156, v156, v172
 v_add_f32 v157, v157, v173
 v_mfma_f32_16x16x32_bf16 v[100:103], a[140:143], v[48:51], v[100:103]
 s_waitcnt vmcnt(17)
 s_sub_u32 s69, s63, 1
 s_max_i32 s69, s69, 0
 v_mov_b32 v3, s69
 v_mov_b32 v4, 0
 s_mov_b64 exec, 1
 buffer_store_dword v3, v4, s[48:51], s68 offen sc1
 s_mov_b64 exec, -1
 v_mfma_f32_16x16x32_bf16 v[132:135], a[140:143], v[52:55], v[132:135]
 v_add_f32 v158, v158, v174
 v_add_f32 v159, v159, v175
 v_mfma_f32_16x16x32_bf16 v[116:119], a[136:139], v[52:55], v[116:119]
 s_waitcnt lgkmcnt(4)
 v_mfma_f32_16x16x32_bf16 v[88:91], a[144:147], v[48:51], v[88:91]
 v_add_f32 v144, v144, v176
 v_add_f32 v145, v145, v177
 v_mfma_f32_16x16x32_bf16 v[104:107], a[148:151], v[48:51], v[104:107]
 v_add_f32 v146, v146, v178
 v_add_f32 v147, v147, v179
 v_mfma_f32_16x16x32_bf16 v[136:139], a[148:151], v[52:55], v[136:139]
 v_add_f32 v148, v148, v180
 v_add_f32 v149, v149, v181
 v_mfma_f32_16x16x32_bf16 v[120:123], a[144:147], v[52:55], v[120:123]
 v_add_f32 v150, v150, v182
 v_add_f32 v151, v151, v183
 v_mfma_f32_16x16x32_bf16 v[92:95], a[152:155], v[48:51], v[92:95]
 v_add_f32 v152, v152, v184
 v_add_f32 v153, v153, v185
 v_mfma_f32_16x16x32_bf16 v[108:111], a[156:159], v[48:51], v[108:111]
 v_add_f32 v154, v154, v186
 v_add_f32 v155, v155, v187
 v_mfma_f32_16x16x32_bf16 v[140:143], a[156:159], v[52:55], v[140:143]
 v_add_f32 v156, v156, v188
 v_add_f32 v157, v157, v189
 v_mfma_f32_16x16x32_bf16 v[124:127], a[152:155], v[52:55], v[124:127]
 v_add_f32 v158, v158, v190
 v_add_f32 v159, v159, v191
 v_mfma_f32_16x16x32_bf16 v[80:83], a[160:163], v[56:59], v[80:83]
 s_add_u32 s82, s65, 8192
 buffer_load_dwordx4 v[48:51], v2, s[48:51], s82 offen offset:0 sc1
 v_mfma_f32_16x16x32_bf16 v[96:99], a[164:167], v[56:59], v[96:99]
 s_waitcnt lgkmcnt(0)
 v_mfma_f32_16x16x32_bf16 v[128:131], a[164:167], v[60:63], v[128:131]
 buffer_load_dwordx4 v[52:55], v5, s[48:51], s82 offen offset:0 sc1
 v_mfma_f32_16x16x32_bf16 v[112:115], a[160:163], v[60:63], v[112:115]
 v_add_f32 v144, v144, v192
 v_add_f32 v145, v145, v193
 v_mfma_f32_16x16x32_bf16 v[84:87], a[168:171], v[56:59], v[84:87]
 v_add_f32 v146, v146, v194
 v_add_f32 v147, v147, v195
 v_mfma_f32_16x16x32_bf16 v[100:103], a[172:175], v[56:59], v[100:103]
 v_add_f32 v148, v148, v196
 v_add_f32 v149, v149, v197
 v_mfma_f32_16x16x32_bf16 v[132:135], a[172:175], v[60:63], v[132:135]
 v_add_f32 v150, v150, v198
 v_add_f32 v151, v151, v199
 v_mfma_f32_16x16x32_bf16 v[116:119], a[168:171], v[60:63], v[116:119]
 v_add_f32 v152, v152, v200
 v_add_f32 v153, v153, v201
 v_mfma_f32_16x16x32_bf16 v[88:91], a[176:179], v[56:59], v[88:91]
 v_add_f32 v154, v154, v202
 v_add_f32 v155, v155, v203
 v_mfma_f32_16x16x32_bf16 v[104:107], a[180:183], v[56:59], v[104:107]
 v_add_f32 v156, v156, v204
 v_add_f32 v157, v157, v205
 v_mfma_f32_16x16x32_bf16 v[136:139], a[180:183], v[60:63], v[136:139]
 v_add_f32 v158, v158, v206
 v_add_f32 v159, v159, v207
 v_mfma_f32_16x16x32_bf16 v[120:123], a[176:179], v[60:63], v[120:123]
 s_sub_u32 s77, s63, 1
 s_and_b32 s69, s77, 2
 v_mfma_f32_16x16x32_bf16 v[92:95], a[184:187], v[56:59], v[92:95]
 s_lshl_b32 s69, s69, 12
 s_xor_b32 s69, s69, s76
 v_mfma_f32_16x16x32_bf16 v[108:111], a[188:191], v[56:59], v[108:111]
 s_and_b32 s78, s77, 15
 s_lshl_b32 s78, s78, 20
 v_mfma_f32_16x16x32_bf16 v[140:143], a[188:191], v[60:63], v[140:143]
 s_add_u32 s78, s78, s69
 v_mfma_f32_16x16x32_bf16 v[124:127], a[184:187], v[60:63], v[124:127]
 buffer_store_dwordx4 v[148:151], v244, s[48:51], s78 offen sc1
 s_waitcnt vmcnt(19)
 v_mfma_f32_16x16x32_bf16 v[80:83], a[192:195], v[64:67], v[80:83]
 buffer_load_dwordx4 v[56:59], v2, s[48:51], s82 offen offset:2048 sc1
 v_mfma_f32_16x16x32_bf16 v[96:99], a[196:199], v[64:67], v[96:99]
 buffer_store_dwordx4 v[152:155], v245, s[48:51], s78 offen sc1
 v_mfma_f32_16x16x32_bf16 v[128:131], a[196:199], v[68:71], v[128:131]
 buffer_load_dwordx4 v[60:63], v5, s[48:51], s82 offen offset:2048 sc1
 v_mfma_f32_16x16x32_bf16 v[112:115], a[192:195], v[68:71], v[112:115]
 buffer_store_dwordx4 v[156:159], v246, s[48:51], s78 offen sc1
 v_mfma_f32_16x16x32_bf16 v[84:87], a[200:203], v[64:67], v[84:87]
 s_waitcnt vmcnt(18)
 v_mfma_f32_16x16x32_bf16 v[100:103], a[204:207], v[64:67], v[100:103]
 v_add_f32 v224, v224, v232
 v_add_f32 v225, v225, v233
 v_mfma_f32_16x16x32_bf16 v[132:135], a[204:207], v[68:71], v[132:135]
 v_add_f32 v226, v226, v234
 v_add_f32 v227, v227, v235
 v_mfma_f32_16x16x32_bf16 v[116:119], a[200:203], v[68:71], v[116:119]
 v_add_f32 v224, v224, v236
 v_add_f32 v225, v225, v237
 v_mfma_f32_16x16x32_bf16 v[88:91], a[208:211], v[64:67], v[88:91]
 v_add_f32 v226, v226, v238
 v_add_f32 v227, v227, v239
 v_mfma_f32_16x16x32_bf16 v[104:107], a[212:215], v[64:67], v[104:107]
 v_add_f32 v224, v224, v240
 v_add_f32 v225, v225, v241
 v_mfma_f32_16x16x32_bf16 v[136:139], a[212:215], v[68:71], v[136:139]
 v_add_f32 v226, v226, v242
 v_add_f32 v227, v227, v243
 v_mfma_f32_16x16x32_bf16 v[120:123], a[208:211], v[68:71], v[120:123]
 s_sub_u32 s77, s63, 7
 s_cselect_b32 s77, 64, s77
 s_lshl_b32 s69, s77, 17
 v_mfma_f32_16x16x32_bf16 v[92:95], a[216:219], v[64:67], v[92:95]
 s_add_u32 s69, s69, s67
 v_cvt_pk_bf16_f32 v14, v224, v225
 v_mfma_f32_16x16x32_bf16 v[108:111], a[220:223], v[64:67], v[108:111]
 v_cvt_pk_bf16_f32 v15, v226, v227
 v_mfma_f32_16x16x32_bf16 v[140:143], a[220:223], v[68:71], v[140:143]
 buffer_store_dwordx2 v[14:15], v250, s[56:59], s69 offen
 v_mfma_f32_16x16x32_bf16 v[124:127], a[216:219], v[68:71], v[124:127]
 v_mov_b64 v[224:225], v[216:217]
 v_mov_b64 v[226:227], v[218:219]
 v_mfma_f32_16x16x32_bf16 v[80:83], a[224:227], v[72:75], v[80:83]
 s_add_u32 s82, s65, 12288
 buffer_load_dwordx4 v[64:67], v2, s[48:51], s82 offen offset:0 sc1
 v_mfma_f32_16x16x32_bf16 v[96:99], a[228:231], v[72:75], v[96:99]
 v_mov_b64 v[216:217], v[208:209]
 v_mov_b64 v[218:219], v[210:211]
 v_mfma_f32_16x16x32_bf16 v[128:131], a[228:231], v[76:79], v[128:131]
 buffer_load_dwordx4 v[68:71], v5, s[48:51], s82 offen offset:0 sc1
 v_mfma_f32_16x16x32_bf16 v[112:115], a[224:227], v[76:79], v[112:115]
 v_mov_b64 v[208:209], v[144:145]
 v_mov_b64 v[210:211], v[146:147]
 v_mfma_f32_16x16x32_bf16 v[84:87], a[232:235], v[72:75], v[84:87]
 v_mfma_f32_16x16x32_bf16 v[100:103], a[236:239], v[72:75], v[100:103]
 v_mfma_f32_16x16x32_bf16 v[132:135], a[236:239], v[76:79], v[132:135]
 v_mfma_f32_16x16x32_bf16 v[116:119], a[232:235], v[76:79], v[116:119]
 v_mfma_f32_16x16x32_bf16 v[88:91], a[240:243], v[72:75], v[88:91]
 v_mfma_f32_16x16x32_bf16 v[104:107], a[244:247], v[72:75], v[104:107]
 v_mfma_f32_16x16x32_bf16 v[136:139], a[244:247], v[76:79], v[136:139]
 v_mfma_f32_16x16x32_bf16 v[120:123], a[240:243], v[76:79], v[120:123]
 v_mfma_f32_16x16x32_bf16 v[92:95], a[248:251], v[72:75], v[92:95]
 v_mfma_f32_16x16x32_bf16 v[108:111], a[252:255], v[72:75], v[108:111]
 v_mfma_f32_16x16x32_bf16 v[140:143], a[252:255], v[76:79], v[140:143]
 v_mfma_f32_16x16x32_bf16 v[124:127], a[248:251], v[76:79], v[124:127]
 buffer_load_dwordx4 v[72:75], v2, s[48:51], s82 offen offset:2048 sc1
 buffer_load_dwordx4 v[76:79], v5, s[48:51], s82 offen offset:2048 sc1
 s_waitcnt vmcnt(17)
 s_mov_b32 s73, 1
 s_add_u32 s65, s65, 0x40000
 s_branch nxt_24
dry_34:
 v_mfma_f32_16x16x32_bf16 v[80:83], a[0:3], v[16:19], 0
 v_mfma_f32_16x16x32_bf16 v[96:99], a[4:7], v[16:19], 0
 v_mfma_f32_16x16x32_bf16 v[128:131], a[4:7], v[20:23], 0
 ds_write_b128 v7, v[160:163] offset:49152
 v_mfma_f32_16x16x32_bf16 v[112:115], a[0:3], v[20:23], 0
 v_mfma_f32_16x16x32_bf16 v[84:87], a[8:11], v[16:19], 0
 s_sub_u32 s70, s63, 6
 s_mov_b64 exec, 0xf
 v_cmp_gt_i32 vcc, s70, v13
 s_mov_b64 exec, -1
 s_cbranch_vccz finok_38
 s_mov_b64 exec, 15
w_39:
 buffer_load_dword v4, v11, s[48:51], s75 offen sc1
 s_waitcnt vmcnt(0)
 v_cmp_gt_u32 vcc, s70, v4
 s_cbranch_vccz wok_40
 s_sleep 2
 s_sub_u32 s46, s46, 1
 s_cbranch_scc0 w_39
 s_mov_b32 s46, 0
 s_branch wok_40
wok_40:
 s_mov_b64 exec, -1
finok_38:
 s_sub_u32 s77, s63, 7
 s_and_b32 s69, s77, 2
 s_lshl_b32 s69, s69, 12
 s_xor_b32 s69, s69, s76
 s_and_b32 s78, s77, 15
 s_lshl_b32 s78, s78, 20
 s_add_u32 s78, s78, s69
 buffer_load_dwordx4 v[232:235], v247, s[48:51], s78 offen sc1
 buffer_load_dwordx4 v[236:239], v248, s[48:51], s78 offen sc1
 buffer_load_dwordx4 v[240:243], v249, s[48:51], s78 offen sc1
 v_mfma_f32_16x16x32_bf16 v[100:103], a[12:15], v[16:19], 0
 v_mfma_f32_16x16x32_bf16 v[132:135], a[12:15], v[20:23], 0
 ds_write_b128 v7, v[164:167] offset:50176
 v_mfma_f32_16x16x32_bf16 v[116:119], a[8:11], v[20:23], 0
 v_mfma_f32_16x16x32_bf16 v[88:91], a[16:19], v[16:19], 0
 v_mfma_f32_16x16x32_bf16 v[104:107], a[20:23], v[16:19], 0
 ds_write_b128 v7, v[168:171] offset:51200
 v_mfma_f32_16x16x32_bf16 v[136:139], a[20:23], v[20:23], 0
 v_mfma_f32_16x16x32_bf16 v[120:123], a[16:19], v[20:23], 0
 v_mfma_f32_16x16x32_bf16 v[92:95], a[24:27], v[16:19], 0
 ds_write_b128 v7, v[172:175] offset:52224
 v_mfma_f32_16x16x32_bf16 v[108:111], a[28:31], v[16:19], 0
 v_mfma_f32_16x16x32_bf16 v[140:143], a[28:31], v[20:23], 0
 v_mfma_f32_16x16x32_bf16 v[124:127], a[24:27], v[20:23], 0
 ds_write_b128 v8, v[176:179] offset:49152
 v_mfma_f32_16x16x32_bf16 v[80:83], a[32:35], v[24:27], v[80:83]
 v_mfma_f32_16x16x32_bf16 v[96:99], a[36:39], v[24:27], v[96:99]
 v_mfma_f32_16x16x32_bf16 v[128:131], a[36:39], v[28:31], v[128:131]
 ds_write_b128 v8, v[180:183] offset:50176
 v_mfma_f32_16x16x32_bf16 v[112:115], a[32:35], v[28:31], v[112:115]
 v_mfma_f32_16x16x32_bf16 v[84:87], a[40:43], v[24:27], v[84:87]
 v_mfma_f32_16x16x32_bf16 v[100:103], a[44:47], v[24:27], v[100:103]
 ds_write_b128 v8, v[184:187] offset:51200
 v_mfma_f32_16x16x32_bf16 v[132:135], a[44:47], v[28:31], v[132:135]
 v_mfma_f32_16x16x32_bf16 v[116:119], a[40:43], v[28:31], v[116:119]
 v_mfma_f32_16x16x32_bf16 v[88:91], a[48:51], v[24:27], v[88:91]
 ds_write_b128 v8, v[188:191] offset:52224
 v_mfma_f32_16x16x32_bf16 v[104:107], a[52:55], v[24:27], v[104:107]
 v_mfma_f32_16x16x32_bf16 v[136:139], a[52:55], v[28:31], v[136:139]
 v_mfma_f32_16x16x32_bf16 v[120:123], a[48:51], v[28:31], v[120:123]
 ds_write_b128 v9, v[192:195] offset:49152
 v_mfma_f32_16x16x32_bf16 v[92:95], a[56:59], v[24:27], v[92:95]
 v_mfma_f32_16x16x32_bf16 v[108:111], a[60:63], v[24:27], v[108:111]
 v_mfma_f32_16x16x32_bf16 v[140:143], a[60:63], v[28:31], v[140:143]
 ds_write_b128 v9, v[196:199] offset:50176
 v_mfma_f32_16x16x32_bf16 v[124:127], a[56:59], v[28:31], v[124:127]
 s_waitcnt vmcnt(18)
 v_mfma_f32_16x16x32_bf16 v[80:83], a[64:67], v[32:35], v[80:83]
 v_mfma_f32_16x16x32_bf16 v[96:99], a[68:71], v[32:35], v[96:99]
 ds_write_b128 v9, v[200:203] offset:51200
 v_mfma_f32_16x16x32_bf16 v[128:131], a[68:71], v[36:39], v[128:131]
 v_mfma_f32_16x16x32_bf16 v[112:115], a[64:67], v[36:39], v[112:115]
 v_mfma_f32_16x16x32_bf16 v[84:87], a[72:75], v[32:35], v[84:87]
 ds_write_b128 v9, v[204:207] offset:52224
 v_mfma_f32_16x16x32_bf16 v[100:103], a[76:79], v[32:35], v[100:103]
 v_mfma_f32_16x16x32_bf16 v[132:135], a[76:79], v[36:39], v[132:135]
 v_mfma_f32_16x16x32_bf16 v[116:119], a[72:75], v[36:39], v[116:119]
 s_waitcnt lgkmcnt(0)
 s_barrier
 v_mfma_f32_16x16x32_bf16 v[88:91], a[80:83], v[32:35], v[88:91]
 ds_read_b128 v[160:163], v10 offset:49152
 v_mfma_f32_16x16x32_bf16 v[104:107], a[84:87], v[32:35], v[104:107]
 ds_read_b128 v[164:167], v10 offset:50176
 v_mfma_f32_16x16x32_bf16 v[136:139], a[84:87], v[36:39], v[136:139]
 ds_read_b128 v[168:171], v10 offset:51200
 v_mfma_f32_16x16x32_bf16 v[120:123], a[80:83], v[36:39], v[120:123]
 ds_read_b128 v[172:175], v10 offset:52224
 v_mfma_f32_16x16x32_bf16 v[92:95], a[88:91], v[32:35], v[92:95]
 ds_read_b128 v[176:179], v10 offset:53248
 v_mfma_f32_16x16x32_bf16 v[108:111], a[92:95], v[32:35], v[108:111]
 s_add_u32 s77, s63, 2
 s_and_b32 s69, s77, 3
 s_lshl_b32 s69, s69, 7
 s_add_u32 s71, s69, s74
 s_lshr_b32 s70, s77, 2
 s_add_u32 s70, s70, 1
 s_mov_b32 s72, s70
 s_mov_b64 exec, 0xff
 buffer_load_dword v12, v11, s[48:51], s71 offen sc1
 buffer_load_dword v13, v11, s[48:51], s75 offen sc1
 s_mov_b64 exec, -1
 v_mfma_f32_16x16x32_bf16 v[140:143], a[92:95], v[36:39], v[140:143]
 ds_read_b128 v[180:183], v10 offset:54272
 v_mfma_f32_16x16x32_bf16 v[124:127], a[88:91], v[36:39], v[124:127]
 ds_read_b128 v[184:187], v10 offset:55296
 s_waitcnt vmcnt(18)
 v_mfma_f32_16x16x32_bf16 v[80:83], a[96:99], v[40:43], v[80:83]
 ds_read_b128 v[188:191], v10 offset:56320
 v_mfma_f32_16x16x32_bf16 v[96:99], a[100:103], v[40:43], v[96:99]
 ds_read_b128 v[192:195], v10 offset:57344
 v_mfma_f32_16x16x32_bf16 v[128:131], a[100:103], v[44:47], v[128:131]
 ds_read_b128 v[196:199], v10 offset:58368
 v_mfma_f32_16x16x32_bf16 v[112:115], a[96:99], v[44:47], v[112:115]
 ds_read_b128 v[200:203], v10 offset:59392
 v_mfma_f32_16x16x32_bf16 v[84:87], a[104:107], v[40:43], v[84:87]
 ds_read_b128 v[204:207], v10 offset:60416
 v_mfma_f32_16x16x32_bf16 v[100:103], a[108:111], v[40:43], v[100:103]
 s_waitcnt lgkmcnt(8)
 v_mfma_f32_16x16x32_bf16 v[132:135], a[108:111], v[44:47], v[132:135]
 v_add_f32 v144, v144, v160
 v_add_f32 v145, v145, v161
 v_mfma_f32_16x16x32_bf16 v[116:119], a[104:107], v[44:47], v[116:119]
 v_add_f32 v146, v146, v162
 v_add_f32 v147, v147, v163
 v_mfma_f32_16x16x32_bf16 v[88:91], a[112:115], v[40:43], v[88:91]
 v_add_f32 v148, v148, v164
 v_add_f32 v149, v149, v165
 v_mfma_f32_16x16x32_bf16 v[104:107], a[116:119], v[40:43], v[104:107]
 v_add_f32 v150, v150, v166
 v_add_f32 v151, v151, v167
 v_mfma_f32_16x16x32_bf16 v[136:139], a[116:119], v[44:47], v[136:139]
 v_add_f32 v152, v152, v168
 v_add_f32 v153, v153, v169
 v_mfma_f32_16x16x32_bf16 v[120:123], a[112:115], v[44:47], v[120:123]
 v_add_f32 v154, v154, v170
 v_add_f32 v155, v155, v171
 v_mfma_f32_16x16x32_bf16 v[92:95], a[120:123], v[40:43], v[92:95]
 v_add_f32 v156, v156, v172
 v_add_f32 v157, v157, v173
 v_mfma_f32_16x16x32_bf16 v[108:111], a[124:127], v[40:43], v[108:111]
 v_add_f32 v158, v158, v174
 v_add_f32 v159, v159, v175
 v_mfma_f32_16x16x32_bf16 v[140:143], a[124:127], v[44:47], v[140:143]
 s_waitcnt lgkmcnt(4)
 v_mfma_f32_16x16x32_bf16 v[124:127], a[120:123], v[44:47], v[124:127]
 v_add_f32 v144, v144, v176
 v_add_f32 v145, v145, v177
 s_waitcnt vmcnt(15)
 v_mfma_f32_16x16x32_bf16 v[80:83], a[128:131], v[48:51], v[80:83]
 v_add_f32 v146, v146, v178
 v_add_f32 v147, v147, v179
 v_mfma_f32_16x16x32_bf16 v[96:99], a[132:135], v[48:51], v[96:99]
 v_add_f32 v148, v148, v180
 v_add_f32 v149, v149, v181
 v_mfma_f32_16x16x32_bf16 v[128:131], a[132:135], v[52:55], v[128:131]
 v_add_f32 v150, v150, v182
 v_add_f32 v151, v151, v183
 v_mfma_f32_16x16x32_bf16 v[112:115], a[128:131], v[52:55], v[112:115]
 v_add_f32 v152, v152, v184
 v_add_f32 v153, v153, v185
 v_mfma_f32_16x16x32_bf16 v[84:87], a[136:139], v[48:51], v[84:87]
 v_add_f32 v154, v154, v186
 v_add_f32 v155, v155, v187
 v_mfma_f32_16x16x32_bf16 v[100:103], a[140:143], v[48:51], v[100:103]
 s_waitcnt vmcnt(9)
 s_sub_u32 s69, s63, 1
 s_max_i32 s69, s69, 0
 v_mov_b32 v3, s69
 v_mov_b32 v4, 0
 s_mov_b64 exec, 1
 buffer_store_dword v3, v4, s[48:51], s68 offen sc1
 s_mov_b64 exec, -1
 v_mfma_f32_16x16x32_bf16 v[132:135], a[140:143], v[52:55], v[132:135]
 v_add_f32 v156, v156, v188
 v_add_f32 v157, v157, v189
 v_mfma_f32_16x16x32_bf16 v[116:119], a[136:139], v[52:55], v[116:119]
 v_add_f32 v158, v158, v190
 v_add_f32 v159, v159, v191
 v_mfma_f32_16x16x32_bf16 v[88:91], a[144:147], v[48:51], v[88:91]
 s_waitcnt lgkmcnt(0)
 v_mfma_f32_16x16x32_bf16 v[104:107], a[148:151], v[48:51], v[104:107]
 v_add_f32 v144, v144, v192
 v_add_f32 v145, v145, v193
 v_mfma_f32_16x16x32_bf16 v[136:139], a[148:151], v[52:55], v[136:139]
 v_add_f32 v146, v146, v194
 v_add_f32 v147, v147, v195
 v_mfma_f32_16x16x32_bf16 v[120:123], a[144:147], v[52:55], v[120:123]
 v_add_f32 v148, v148, v196
 v_add_f32 v149, v149, v197
 v_mfma_f32_16x16x32_bf16 v[92:95], a[152:155], v[48:51], v[92:95]
 v_add_f32 v150, v150, v198
 v_add_f32 v151, v151, v199
 v_mfma_f32_16x16x32_bf16 v[108:111], a[156:159], v[48:51], v[108:111]
 v_add_f32 v152, v152, v200
 v_add_f32 v153, v153, v201
 v_mfma_f32_16x16x32_bf16 v[140:143], a[156:159], v[52:55], v[140:143]
 v_add_f32 v154, v154, v202
 v_add_f32 v155, v155, v203
 v_mfma_f32_16x16x32_bf16 v[124:127], a[152:155], v[52:55], v[124:127]
 v_add_f32 v156, v156, v204
 v_add_f32 v157, v157, v205
 v_mfma_f32_16x16x32_bf16 v[80:83], a[160:163], v[56:59], v[80:83]
 v_add_f32 v158, v158, v206
 v_add_f32 v159, v159, v207
 v_mfma_f32_16x16x32_bf16 v[96:99], a[164:167], v[56:59], v[96:99]
 s_sub_u32 s77, s63, 1
 s_and_b32 s69, s77, 2
 v_mfma_f32_16x16x32_bf16 v[128:131], a[164:167], v[60:63], v[128:131]
 s_lshl_b32 s69, s69, 12
 s_xor_b32 s69, s69, s76
 v_mfma_f32_16x16x32_bf16 v[112:115], a[160:163], v[60:63], v[112:115]
 s_and_b32 s78, s77, 15
 s_lshl_b32 s78, s78, 20
 v_mfma_f32_16x16x32_bf16 v[84:87], a[168:171], v[56:59], v[84:87]
 s_add_u32 s78, s78, s69
 v_mfma_f32_16x16x32_bf16 v[100:103], a[172:175], v[56:59], v[100:103]
 buffer_store_dwordx4 v[148:151], v244, s[48:51], s78 offen sc1
 v_mfma_f32_16x16x32_bf16 v[132:135], a[172:175], v[60:63], v[132:135]
 buffer_store_dwordx4 v[152:155], v245, s[48:51], s78 offen sc1
 v_mfma_f32_16x16x32_bf16 v[116:119], a[168:171], v[60:63], v[116:119]
 buffer_store_dwordx4 v[156:159], v246, s[48:51], s78 offen sc1
 v_mfma_f32_16x16x32_bf16 v[88:91], a[176:179], v[56:59], v[88:91]
 s_waitcnt vmcnt(6)
 v_mfma_f32_16x16x32_bf16 v[104:107], a[180:183], v[56:59], v[104:107]
 v_add_f32 v224, v224, v232
 v_add_f32 v225, v225, v233
 v_mfma_f32_16x16x32_bf16 v[136:139], a[180:183], v[60:63], v[136:139]
 v_add_f32 v226, v226, v234
 v_add_f32 v227, v227, v235
 v_mfma_f32_16x16x32_bf16 v[120:123], a[176:179], v[60:63], v[120:123]
 v_add_f32 v224, v224, v236
 v_add_f32 v225, v225, v237
 v_mfma_f32_16x16x32_bf16 v[92:95], a[184:187], v[56:59], v[92:95]
 v_add_f32 v226, v226, v238
 v_add_f32 v227, v227, v239
 v_mfma_f32_16x16x32_bf16 v[108:111], a[188:191], v[56:59], v[108:111]
 v_add_f32 v224, v224, v240
 v_add_f32 v225, v225, v241
 v_mfma_f32_16x16x32_bf16 v[140:143], a[188:191], v[60:63], v[140:143]
 v_add_f32 v226, v226, v242
 v_add_f32 v227, v227, v243
 v_mfma_f32_16x16x32_bf16 v[124:127], a[184:187], v[60:63], v[124:127]
 s_sub_u32 s77, s63, 7
 s_cselect_b32 s77, 64, s77
 s_lshl_b32 s69, s77, 17
 v_mfma_f32_16x16x32_bf16 v[80:83], a[192:195], v[64:67], v[80:83]
 s_add_u32 s69, s69, s67
 v_cvt_pk_bf16_f32 v14, v224, v225
 v_mfma_f32_16x16x32_bf16 v[96:99], a[196:199], v[64:67], v[96:99]
 v_cvt_pk_bf16_f32 v15, v226, v227
 v_mfma_f32_16x16x32_bf16 v[128:131], a[196:199], v[68:71], v[128:131]
 buffer_store_dwordx2 v[14:15], v250, s[56:59], s69 offen
 v_mfma_f32_16x16x32_bf16 v[112:115], a[192:195], v[68:71], v[112:115]
 v_mov_b64 v[224:225], v[216:217]
 v_mov_b64 v[226:227], v[218:219]
 v_mfma_f32_16x16x32_bf16 v[84:87], a[200:203], v[64:67], v[84:87]
 v_mov_b64 v[216:217], v[208:209]
 v_mov_b64 v[218:219], v[210:211]
 v_mfma_f32_16x16x32_bf16 v[100:103], a[204:207], v[64:67], v[100:103]
 v_mov_b64 v[208:209], v[144:145]
 v_mov_b64 v[210:211], v[146:147]
 v_mfma_f32_16x16x32_bf16 v[132:135], a[204:207], v[68:71], v[132:135]
 v_mfma_f32_16x16x32_bf16 v[116:119], a[200:203], v[68:71], v[116:119]
 v_mfma_f32_16x16x32_bf16 v[88:91], a[208:211], v[64:67], v[88:91]
 v_mfma_f32_16x16x32_bf16 v[104:107], a[212:215], v[64:67], v[104:107]
 v_mfma_f32_16x16x32_bf16 v[136:139], a[212:215], v[68:71], v[136:139]
 v_mfma_f32_16x16x32_bf16 v[120:123], a[208:211], v[68:71], v[120:123]
 v_mfma_f32_16x16x32_bf16 v[92:95], a[216:219], v[64:67], v[92:95]
 v_mfma_f32_16x16x32_bf16 v[108:111], a[220:223], v[64:67], v[108:111]
 v_mfma_f32_16x16x32_bf16 v[140:143], a[220:223], v[68:71], v[140:143]
 v_mfma_f32_16x16x32_bf16 v[124:127], a[216:219], v[68:71], v[124:127]
 v_mfma_f32_16x16x32_bf16 v[80:83], a[224:227], v[72:75], v[80:83]
 v_mfma_f32_16x16x32_bf16 v[96:99], a[228:231], v[72:75], v[96:99]
 v_mfma_f32_16x16x32_bf16 v[128:131], a[228:231], v[76:79], v[128:131]
 v_mfma_f32_16x16x32_bf16 v[112:115], a[224:227], v[76:79], v[112:115]
 v_mfma_f32_16x16x32_bf16 v[84:87], a[232:235], v[72:75], v[84:87]
 v_mfma_f32_16x16x32_bf16 v[100:103], a[236:239], v[72:75], v[100:103]
 v_mfma_f32_16x16x32_bf16 v[132:135], a[236:239], v[76:79], v[132:135]
 v_mfma_f32_16x16x32_bf16 v[116:119], a[232:235], v[76:79], v[116:119]
 v_mfma_f32_16x16x32_bf16 v[88:91], a[240:243], v[72:75], v[88:91]
 v_mfma_f32_16x16x32_bf16 v[104:107], a[244:247], v[72:75], v[104:107]
 v_mfma_f32_16x16x32_bf16 v[136:139], a[244:247], v[76:79], v[136:139]
 v_mfma_f32_16x16x32_bf16 v[120:123], a[240:243], v[76:79], v[120:123]
 v_mfma_f32_16x16x32_bf16 v[92:95], a[248:251], v[72:75], v[92:95]
 v_mfma_f32_16x16x32_bf16 v[108:111], a[252:255], v[72:75], v[108:111]
 v_mfma_f32_16x16x32_bf16 v[140:143], a[252:255], v[76:79], v[140:143]
 v_mfma_f32_16x16x32_bf16 v[124:127], a[248:251], v[76:79], v[124:127]
 s_waitcnt vmcnt(5)
 s_mov_b32 s73, 0
nxt_24:
 s_add_u32 s63, s63, 1
 s_cmp_eq_u32 s73, 1
 s_cbranch_scc1 have_41
 s_and_b32 s69, s63, 3
 s_lshl_b32 s69, s69, 7
 s_add_u32 s71, s69, s74
 s_lshr_b32 s70, s63, 2
 s_add_u32 s70, s70, 1
 s_mov_b64 exec, 255
w_43:
 buffer_load_dword v4, v11, s[48:51], s71 offen sc1
 s_waitcnt vmcnt(0)
 v_cmp_gt_u32 vcc, s70, v4
 s_cbranch_vccz wok_44
 s_sleep 2
 s_sub_u32 s46, s46, 1
 s_cbranch_scc0 w_43
 s_mov_b32 s46, 0
 s_branch wok_44
wok_44:
 s_mov_b64 exec, -1
 s_add_u32 s77, s63, 1
 s_and_b32 s69, s77, 3
 s_lshl_b32 s69, s69, 7
 s_add_u32 s71, s69, s74
 s_lshr_b32 s70, s77, 2
 s_add_u32 s70, s70, 1
 s_mov_b32 s72, s70
 s_mov_b64 exec, 0xff
 buffer_load_dword v12, v11, s[48:51], s71 offen sc1
 buffer_load_dword v13, v11, s[48:51], s75 offen sc1
 s_mov_b64 exec, -1
 s_add_u32 s82, s65, 0
 buffer_load_dwordx4 v[16:19], v2, s[48:51], s82 offen offset:0 sc1
 buffer_load_dwordx4 v[20:23], v5, s[48:51], s82 offen offset:0 sc1
 buffer_load_dwordx4 v[24:27], v2, s[48:51], s82 offen offset:2048 sc1
 buffer_load_dwordx4 v[28:31], v5, s[48:51], s82 offen offset:2048 sc1
 s_add_u32 s82, s65, 4096
 buffer_load_dwordx4 v[32:35], v2, s[48:51], s82 offen offset:0 sc1
 buffer_load_dwordx4 v[36:39], v5, s[48:51], s82 offen offset:0 sc1
 buffer_load_dwordx4 v[40:43], v2, s[48:51], s82 offen offset:2048 sc1
 buffer_load_dwordx4 v[44:47], v5, s[48:51], s82 offen offset:2048 sc1
 s_add_u32 s82, s65, 8192
 buffer_load_dwordx4 v[48:51], v2, s[48:51], s82 offen offset:0 sc1
 buffer_load_dwordx4 v[52:55], v5, s[48:51], s82 offen offset:0 sc1
 buffer_load_dwordx4 v[56:59], v2, s[48:51], s82 offen offset:2048 sc1
 buffer_load_dwordx4 v[60:63], v5, s[48:51], s82 offen offset:2048 sc1
 s_add_u32 s82, s65, 12288
 buffer_load_dwordx4 v[64:67], v2, s[48:51], s82 offen offset:0 sc1
 buffer_load_dwordx4 v[68:71], v5, s[48:51], s82 offen offset:0 sc1
 buffer_load_dwordx4 v[72:75], v2, s[48:51], s82 offen offset:2048 sc1
 buffer_load_dwordx4 v[76:79], v5, s[48:51], s82 offen offset:2048 sc1
 s_add_u32 s65, s65, 0x40000
 s_waitcnt vmcnt(16)
 s_mov_b64 exec, 0xff
 v_cmp_gt_u32 vcc, s72, v12
 s_mov_b64 exec, -1
 s_cbranch_vccnz dry_45
 s_waitcnt vmcnt(14)
 v_mfma_f32_16x16x32_bf16 v[144:147], a[0:3], v[16:19], 0
 v_mfma_f32_16x16x32_bf16 v[160:163], a[4:7], v[16:19], 0
 v_mfma_f32_16x16x32_bf16 v[192:195], a[4:7], v[20:23], 0
 ds_write_b128 v7, v[96:99] offset:0
 v_mfma_f32_16x16x32_bf16 v[176:179], a[0:3], v[20:23], 0
 v_mfma_f32_16x16x32_bf16 v[148:151], a[8:11], v[16:19], 0
 s_sub_u32 s70, s63, 6
 s_mov_b64 exec, 0xf
 v_cmp_gt_i32 vcc, s70, v13
 s_mov_b64 exec, -1
 s_cbranch_vccz finok_46
 s_mov_b64 exec, 15
w_47:
 buffer_load_dword v4, v11, s[48:51], s75 offen sc1
 s_waitcnt vmcnt(0)
 v_cmp_gt_u32 vcc, s70, v4
 s_cbranch_vccz wok_48
 s_sleep 2
 s_sub_u32 s46, s46, 1
 s_cbranch_scc0 w_47
 s_mov_b32 s46, 0
 s_branch wok_48
wok_48:
 s_mov_b64 exec, -1
finok_46:
 s_sub_u32 s77, s63, 7
 s_and_b32 s69, s77, 2
 s_lshl_b32 s69, s69, 12
 s_xor_b32 s69, s69, s76
 s_and_b32 s78, s77, 15
 s_lshl_b32 s78, s78, 20
 s_add_u32 s78, s78, s69
 buffer_load_dwordx4 v[232:235], v247, s[48:51], s78 offen sc1
 buffer_load_dwordx4 v[236:239], v248, s[48:51], s78 offen sc1
 buffer_load_dwordx4 v[240:243], v249, s[48:51], s78 offen sc1
 v_mfma_f32_16x16x32_bf16 v[164:167], a[12:15], v[16:19], 0
 v_mfma_f32_16x16x32_bf16 v[196:199], a[12:15], v[20:23], 0
 ds_write_b128 v7, v[100:103] offset:1024
 v_mfma_f32_16x16x32_bf16 v[180:183], a[8:11], v[20:23], 0
 v_mfma_f32_16x16x32_bf16 v[152:155], a[16:19], v[16:19], 0
 v_mfma_f32_16x16x32_bf16 v[168:171], a[20:23], v[16:19], 0
 ds_write_b128 v7, v[104:107] offset:2048
 v_mfma_f32_16x16x32_bf16 v[200:203], a[20:23], v[20:23], 0
 v_mfma_f32_16x16x32_bf16 v[184:187], a[16:19], v[20:23], 0
 v_mfma_f32_16x16x32_bf16 v[156:159], a[24:27], v[16:19], 0
 ds_write_b128 v7, v[108:111] offset:3072
 v_mfma_f32_16x16x32_bf16 v[172:175], a[28:31], v[16:19], 0
 v_mfma_f32_16x16x32_bf16 v[204:207], a[28:31], v[20:23], 0
 v_mfma_f32_16x16x32_bf16 v[188:191], a[24:27], v[20:23], 0
 ds_write_b128 v8, v[112:115] offset:0
 s_waitcnt vmcnt(15)
 v_mfma_f32_16x16x32_bf16 v[144:147], a[32:35], v[24:27], v[144:147]
 s_add_u32 s82, s65, 0
 buffer_load_dwordx4 v[16:19], v2, s[48:51], s82 offen offset:0 sc1
 v_mfma_f32_16x16x32_bf16 v[160:163], a[36:39], v[24:27], v[160:163]
 v_mfma_f32_16x16x32_bf16 v[192:195], a[36:39], v[28:31], v[192:195]
 buffer_load_dwordx4 v[20:23], v5, s[48:51], s82 offen offset:0 sc1
 v_mfma_f32_16x16x32_bf16 v[176:179], a[32:35], v[28:31], v[176:179]
 v_mfma_f32_16x16x32_bf16 v[148:151], a[40:43], v[24:27], v[148:151]
 ds_write_b128 v8, v[116:119] offset:1024
 v_mfma_f32_16x16x32_bf16 v[164:167], a[44:47], v[24:27], v[164:167]
 v_mfma_f32_16x16x32_bf16 v[196:199], a[44:47], v[28:31], v[196:199]
 v_mfma_f32_16x16x32_bf16 v[180:183], a[40:43], v[28:31], v[180:183]
 ds_write_b128 v8, v[120:123] offset:2048
 v_mfma_f32_16x16x32_bf16 v[152:155], a[48:51], v[24:27], v[152:155]
 v_mfma_f32_16x16x32_bf16 v[168:171], a[52:55], v[24:27], v[168:171]
 v_mfma_f32_16x16x32_bf16 v[200:203], a[52:55], v[28:31], v[200:203]
 ds_write_b128 v8, v[124:127] offset:3072
 v_mfma_f32_16x16x32_bf16 v[184:187], a[48:51], v[28:31], v[184:187]
 v_mfma_f32_16x16x32_bf16 v[156:159], a[56:59], v[24:27], v[156:159]
 v_mfma_f32_16x16x32_bf16 v[172:175], a[60:63], v[24:27], v[172:175]
 ds_write_b128 v9, v[128:131] offset:0
 v_mfma_f32_16x16x32_bf16 v[204:207], a[60:63], v[28:31], v[204:207]
 v_mfma_f32_16x16x32_bf16 v[188:191], a[56:59], v[28:31], v[188:191]
 s_waitcnt vmcnt(15)
 v_mfma_f32_16x16x32_bf16 v[144:147], a[64:67], v[32:35], v[144:147]
 buffer_load_dwordx4 v[24:27], v2, s[48:51], s82 offen offset:2048 sc1
 v_mfma_f32_16x16x32_bf16 v[160:163], a[68:71], v[32:35], v[160:163]
 ds_write_b128 v9, v[132:135] offset:1024
 v_mfma_f32_16x16x32_bf16 v[192:195], a[68:71], v[36:39], v[192:195]
 buffer_load_dwordx4 v[28:31], v5, s[48:51], s82 offen offset:2048 sc1
 v_mfma_f32_16x16x32_bf16 v[176:179], a[64:67], v[36:39], v[176:179]
 v_mfma_f32_16x16x32_bf16 v[148:151], a[72:75], v[32:35], v[148:151]
 v_mfma_f32_16x16x32_bf16 v[164:167], a[76:79], v[32:35], v[164:167]
 ds_write_b128 v9, v[136:139] offset:2048
 v_mfma_f32_16x16x32_bf16 v[196:199], a[76:79], v[36:39], v[196:199]
 v_mfma_f32_16x16x32_bf16 v[180:183], a[72:75], v[36:39], v[180:183]
 v_mfma_f32_16x16x32_bf16 v[152:155], a[80:83], v[32:35], v[152:155]
 ds_write_b128 v9, v[140:143] offset:3072
 v_mfma_f32_16x16x32_bf16 v[168:171], a[84:87], v[32:35], v[168:171]
 v_mfma_f32_16x16x32_bf16 v[200:203], a[84:87], v[36:39], v[200:203]
 v_mfma_f32_16x16x32_bf16 v[184:187], a[80:83], v[36:39], v[184:187]
 s_waitcnt lgkmcnt(0)
 s_barrier
 v_mfma_f32_16x16x32_bf16 v[156:159], a[88:91], v[32:35], v[156:159]
 ds_read_b128 v[96:99], v10 offset:0
 v_mfma_f32_16x16x32_bf16 v[172:175], a[92:95], v[32:35], v[172:175]
 s_add_u32 s77, s63, 2
 s_and_b32 s69, s77, 3
 s_lshl_b32 s69, s69, 7
 s_add_u32 s71, s69, s74
 s_lshr_b32 s70, s77, 2
 s_add_u32 s70, s70, 1
 s_mov_b32 s72, s70
 s_mov_b64 exec, 0xff
 buffer_load_dword v12, v11, s[48:51], s71 offen sc1
 buffer_load_dword v13, v11, s[48:51], s75 offen sc1
 s_mov_b64 exec, -1
 v_mfma_f32_16x16x32_bf16 v[204:207], a[92:95], v[36:39], v[204:207]
 ds_read_b128 v[100:103], v10 offset:1024
 v_mfma_f32_16x16x32_bf16 v[188:191], a[88:91], v[36:39], v[188:191]
 ds_read_b128 v[104:107], v10 offset:2048
 s_waitcnt vmcnt(17)
 v_mfma_f32_16x16x32_bf16 v[144:147], a[96:99], v[40:43], v[144:147]
 s_add_u32 s82, s65, 4096
 buffer_load_dwordx4 v[32:35], v2, s[48:51], s82 offen offset:0 sc1
 v_mfma_f32_16x16x32_bf16 v[160:163], a[100:103], v[40:43], v[160:163]
 ds_read_b128 v[108:111], v10 offset:3072
 v_mfma_f32_16x16x32_bf16 v[192:195], a[100:103], v[44:47], v[192:195]
 buffer_load_dwordx4 v[36:39], v5, s[48:51], s82 offen offset:0 sc1
 v_mfma_f32_16x16x32_bf16 v[176:179], a[96:99], v[44:47], v[176:179]
 ds_read_b128 v[112:115], v10 offset:4096
 v_mfma_f32_16x16x32_bf16 v[148:151], a[104:107], v[40:43], v[148:151]
 ds_read_b128 v[116:119], v10 offset:5120
 v_mfma_f32_16x16x32_bf16 v[164:167], a[108:111], v[40:43], v[164:167]
 ds_read_b128 v[120:123], v10 offset:6144
 v_mfma_f32_16x16x32_bf16 v[196:199], a[108:111], v[44:47], v[196:199]
 ds_read_b128 v[124:127], v10 offset:7168
 v_mfma_f32_16x16x32_bf16 v[180:183], a[104:107], v[44:47], v[180:183]
 ds_read_b128 v[128:131], v10 offset:8192
 v_mfma_f32_16x16x32_bf16 v[152:155], a[112:115], v[40:43], v[152:155]
 ds_read_b128 v[132:135], v10 offset:9216
 v_mfma_f32_16x16x32_bf16 v[168:171], a[116:119], v[40:43], v[168:171]
 ds_read_b128 v[136:139], v10 offset:10240
 v_mfma_f32_16x16x32_bf16 v[200:203], a[116:119], v[44:47], v[200:203]
 ds_read_b128 v[140:143], v10 offset:11264
 v_mfma_f32_16x16x32_bf16 v[184:187], a[112:115], v[44:47], v[184:187]
 s_waitcnt lgkmcnt(8)
 v_mfma_f32_16x16x32_bf16 v[156:159], a[120:123], v[40:43], v[156:159]
 v_add_f32 v80, v80, v96
 v_add_f32 v81, v81, v97
 v_mfma_f32_16x16x32_bf16 v[172:175], a[124:127], v[40:43], v[172:175]
 v_add_f32 v82, v82, v98
 v_add_f32 v83, v83, v99
 v_mfma_f32_16x16x32_bf16 v[204:207], a[124:127], v[44:47], v[204:207]
 v_add_f32 v84, v84, v100
 v_add_f32 v85, v85, v101
 v_mfma_f32_16x16x32_bf16 v[188:191], a[120:123], v[44:47], v[188:191]
 v_add_f32 v86, v86, v102
 v_add_f32 v87, v87, v103
 s_waitcnt vmcnt(17)
 v_mfma_f32_16x16x32_bf16 v[144:147], a[128:131], v[48:51], v[144:147]
 buffer_load_dwordx4 v[40:43], v2, s[48:51], s82 offen offset:2048 sc1
 v_mfma_f32_16x16x32_bf16 v[160:163], a[132:135], v[48:51], v[160:163]
 v_add_f32 v88, v88, v104
 v_add_f32 v89, v89, v105
 v_mfma_f32_16x16x32_bf16 v[192:195], a[132:135], v[52:55], v[192:195]
 buffer_load_dwordx4 v[44:47], v5, s[48:51], s82 offen offset:2048 sc1
 v_mfma_f32_16x16x32_bf16 v[176:179], a[128:131], v[52:55], v[176:179]
 v_add_f32 v90, v90, v106
 v_add_f32 v91, v91, v107
 v_mfma_f32_16x16x32_bf16 v[148:151], a[136:139], v[48:51], v[148:151]
 v_add_f32 v92, v92, v108
 v_add_f32 v93, v93, v109
 v_mfma_f32_16x16x32_bf16 v[164:167], a[140:143], v[48:51], v[164:167]
 s_sub_u32 s69, s63, 1
 s_max_i32 s69, s69, 0
 v_mov_b32 v3, s69
 v_mov_b32 v4, 0
 s_mov_b64 exec, 1
 buffer_store_dword v3, v4, s[48:51], s68 offen sc1
 s_mov_b64 exec, -1
 v_mfma_f32_16x16x32_bf16 v[196:199], a[140:143], v[52:55], v[196:199]
 v_add_f32 v94, v94, v110
 v_add_f32 v95, v95, v111
 v_mfma_f32_16x16x32_bf16 v[180:183], a[136:139], v[52:55], v[180:183]
 s_waitcnt lgkmcnt(4)
 v_mfma_f32_16x16x32_bf16 v[152:155], a[144:147], v[48:51], v[152:155]
 v_add_f32 v80, v80, v112
 v_add_f32 v81, v81, v113
 v_mfma_f32_16x16x32_bf16 v[168:171], a[148:151], v[48:51], v[168:171]
 v_add_f32 v82, v82, v114
 v_add_f32 v83, v83, v115
 v_mfma_f32_16x16x32_bf16 v[200:203], a[148:151], v[52:55], v[200:203]
 v_add_f32 v84, v84, v116
 v_add_f32 v85, v85, v117
 v_mfma_f32_16x16x32_bf16 v[184:187], a[144:147], v[52:55], v[184:187]
 v_add_f32 v86, v86, v118
 v_add_f32 v87, v87, v119
 v_mfma_f32_16x16x32_bf16 v[156:159], a[152:155], v[48:51], v[156:159]
 v_add_f32 v88, v88, v120
 v_add_f32 v89, v89, v121
 v_mfma_f32_16x16x32_bf16 v[172:175], a[156:159], v[48:51], v[172:175]
 v_add_f32 v90, v90, v122
 v_add_f32 v91, v91, v123
 v_mfma_f32_16x16x32_bf16 v[204:207], a[156:159], v[52:55], v[204:207]
 v_add_f32 v92, v92, v124
 v_add_f32 v93, v93, v125
 v_mfma_f32_16x16x32_bf16 v[188:191], a[152:155], v[52:55], v[188:191]
 v_add_f32 v94, v94, v126
 v_add_f32 v95, v95, v127
 s_waitcnt vmcnt(18)
 v_mfma_f32_16x16x32_bf16 v[144:147], a[160:163], v[56:59], v[144:147]
 s_add_u32 s82, s65, 8192
 buffer_load_dwordx4 v[48:51], v2, s[48:51], s82 offen offset:0 sc1
 v_mfma_f32_16x16x32_bf16 v[160:163], a[164:167], v[56:59], v[160:163]
 s_waitcnt lgkmcnt(0)
 v_mfma_f32_16x16x32_bf16 v[192:195], a[164:167], v[60:63], v[192:195]
 buffer_load_dwordx4 v[52:55], v5, s[48:51], s82 offen offset:0 sc1
 v_mfma_f32_16x16x32_bf16 v[176:179], a[160:163], v[60:63], v[176:179]
 v_add_f32 v80, v80, v128
 v_add_f32 v81, v81, v129
 v_mfma_f32_16x16x32_bf16 v[148:151], a[168:171], v[56:59], v[148:151]
 v_add_f32 v82, v82, v130
 v_add_f32 v83, v83, v131
 v_mfma_f32_16x16x32_bf16 v[164:167], a[172:175], v[56:59], v[164:167]
 v_add_f32 v84, v84, v132
 v_add_f32 v85, v85, v133
 v_mfma_f32_16x16x32_bf16 v[196:199], a[172:175], v[60:63], v[196:199]
 v_add_f32 v86, v86, v134
 v_add_f32 v87, v87, v135
 v_mfma_f32_16x16x32_bf16 v[180:183], a[168:171], v[60:63], v[180:183]
 v_add_f32 v88, v88, v136
 v_add_f32 v89, v89, v137
 v_mfma_f32_16x16x32_bf16 v[152:155], a[176:179], v[56:59], v[152:155]
 v_add_f32 v90, v90, v138
 v_add_f32 v91, v91, v139
 v_mfma_f32_16x16x32_bf16 v[168:171], a[180:183], v[56:59], v[168:171]
 v_add_f32 v92, v92, v140
 v_add_f32 v93, v93, v141
 v_mfma_f32_16x16x32_bf16 v[200:203], a[180:183], v[60:63], v[200:203]
 v_add_f32 v94, v94, v142
 v_add_f32 v95, v95, v143
 v_mfma_f32_16x16x32_bf16 v[184:187], a[176:179], v[60:63], v[184:187]
 s_sub_u32 s77, s63, 1
 s_and_b32 s69, s77, 2
 v_mfma_f32_16x16x32_bf16 v[156:159], a[184:187], v[56:59], v[156:159]
 s_lshl_b32 s69, s69, 12
 s_xor_b32 s69, s69, s76
 v_mfma_f32_16x16x32_bf16 v[172:175], a[188:191], v[56:59], v[172:175]
 s_and_b32 s78, s77, 15
 s_lshl_b32 s78, s78, 20
 v_mfma_f32_16x16x32_bf16 v[204:207], a[188:191], v[60:63], v[204:207]
 s_add_u32 s78, s78, s69
 v_mfma_f32_16x16x32_bf16 v[188:191], a[184:187], v[60:63], v[188:191]
 buffer_store_dwordx4 v[84:87], v244, s[48:51], s78 offen sc1
 s_waitcnt vmcnt(19)
 v_mfma_f32_16x16x32_bf16 v[144:147], a[192:195], v[64:67], v[144:147]
 buffer_load_dwordx4 v[56:59], v2, s[48:51], s82 offen offset:2048 sc1
 v_mfma_f32_16x16x32_bf16 v[160:163], a[196:199], v[64:67], v[160:163]
 buffer_store_dwordx4 v[88:91], v245, s[48:51], s78 offen sc1
 v_mfma_f32_16x16x32_bf16 v[192:195], a[196:199], v[68:71], v[192:195]
 buffer_load_dwordx4 v[60:63], v5, s[48:51], s82 offen offset:2048 sc1
 v_mfma_f32_16x16x32_bf16 v[176:179], a[192:195], v[68:71], v[176:179]
 buffer_store_dwordx4 v[92:95], v246, s[48:51], s78 offen sc1
 v_mfma_f32_16x16x32_bf16 v[148:151], a[200:203], v[64:67], v[148:151]
 s_waitcnt vmcnt(18)
 v_mfma_f32_16x16x32_bf16 v[164:167], a[204:207], v[64:67], v[164:167]
 v_add_f32 v228, v228, v232
 v_add_f32 v229, v229, v233
 v_mfma_f32_16x16x32_bf16 v[196:199], a[204:207], v[68:71], v[196:199]
 v_add_f32 v230, v230, v234
 v_add_f32 v231, v231, v235
 v_mfma_f32_16x16x32_bf16 v[180:183], a[200:203], v[68:71], v[180:183]
 v_add_f32 v228, v228, v236
 v_add_f32 v229, v229, v237
 v_mfma_f32_16x16x32_bf16 v[152:155], a[208:211], v[64:67], v[152:155]
 v_add_f32 v230, v230, v238
 v_add_f32 v231, v231, v239
 v_mfma_f32_16x16x32_bf16 v[168:171], a[212:215], v[64:67], v[168:171]
 v_add_f32 v228, v228, v240
 v_add_f32 v229, v229, v241
 v_mfma_f32_16x16x32_bf16 v[200:203], a[212:215], v[68:71], v[200:203]
 v_add_f32 v230, v230, v242
 v_add_f32 v231, v231, v243
 v_mfma_f32_16x16x32_bf16 v[184:187], a[208:211], v[68:71], v[184:187]
 s_sub_u32 s77, s63, 7
 s_cselect_b32 s77, 64, s77
 s_lshl_b32 s69, s77, 17
 v_mfma_f32_16x16x32_bf16 v[156:159], a[216:219], v[64:67], v[156:159]
 s_add_u32 s69, s69, s67
 v_cvt_pk_bf16_f32 v14, v228, v229
 v_mfma_f32_16x16x32_bf16 v[172:175], a[220:223], v[64:67], v[172:175]
 v_cvt_pk_bf16_f32 v15, v230, v231
 v_mfma_f32_16x16x32_bf16 v[204:207], a[220:223], v[68:71], v[204:207]
 buffer_store_dwordx2 v[14:15], v250, s[56:59], s69 offen
 v_mfma_f32_16x16x32_bf16 v[188:191], a[216:219], v[68:71], v[188:191]
 v_mov_b64 v[228:229], v[220:221]
 v_mov_b64 v[230:231], v[222:223]
 v_mfma_f32_16x16x32_bf16 v[144:147], a[224:227], v[72:75], v[144:147]
 s_add_u32 s82, s65, 12288
 buffer_load_dwordx4 v[64:67], v2, s[48:51], s82 offen offset:0 sc1
 v_mfma_f32_16x16x32_bf16 v[160:163], a[228:231], v[72:75], v[160:163]
 v_mov_b64 v[220:221], v[212:213]
 v_mov_b64 v[222:223], v[214:215]
 v_mfma_f32_16x16x32_bf16 v[192:195], a[228:231], v[76:79], v[192:195]
 buffer_load_dwordx4 v[68:71], v5, s[48:51], s82 offen offset:0 sc1
 v_mfma_f32_16x16x32_bf16 v[176:179], a[224:227], v[76:79], v[176:179]
 v_mov_b64 v[212:213], v[80:81]
 v_mov_b64 v[214:215], v[82:83]
 v_mfma_f32_16x16x32_bf16 v[148:151], a[232:235], v[72:75], v[148:151]
 v_mfma_f32_16x16x32_bf16 v[164:167], a[236:239], v[72:75], v[164:167]
 v_mfma_f32_16x16x32_bf16 v[196:199], a[236:239], v[76:79], v[196:199]
 v_mfma_f32_16x16x32_bf16 v[180:183], a[232:235], v[76:79], v[180:183]
 v_mfma_f32_16x16x32_bf16 v[152:155], a[240:243], v[72:75], v[152:155]
 v_mfma_f32_16x16x32_bf16 v[168:171], a[244:247], v[72:75], v[168:171]
 v_mfma_f32_16x16x32_bf16 v[200:203], a[244:247], v[76:79], v[200:203]
 v_mfma_f32_16x16x32_bf16 v[184:187], a[240:243], v[76:79], v[184:187]
 v_mfma_f32_16x16x32_bf16 v[156:159], a[248:251], v[72:75], v[156:159]
 v_mfma_f32_16x16x32_bf16 v[172:175], a[252:255], v[72:75], v[172:175]
 v_mfma_f32_16x16x32_bf16 v[204:207], a[252:255], v[76:79], v[204:207]
 v_mfma_f32_16x16x32_bf16 v[188:191], a[248:251], v[76:79], v[188:191]
 buffer_load_dwordx4 v[72:75], v2, s[48:51], s82 offen offset:2048 sc1
 buffer_load_dwordx4 v[76:79], v5, s[48:51], s82 offen offset:2048 sc1
 s_waitcnt vmcnt(17)
 s_mov_b32 s73, 1
 s_add_u32 s65, s65, 0x40000
 s_branch nxt_42
dry_45:
 s_waitcnt vmcnt(14)
 v_mfma_f32_16x16x32_bf16 v[144:147], a[0:3], v[16:19], 0
 v_mfma_f32_16x16x32_bf16 v[160:163], a[4:7], v[16:19], 0
 v_mfma_f32_16x16x32_bf16 v[192:195], a[4:7], v[20:23], 0
 ds_write_b128 v7, v[96:99] offset:0
 v_mfma_f32_16x16x32_bf16 v[176:179], a[0:3], v[20:23], 0
 v_mfma_f32_16x16x32_bf16 v[148:151], a[8:11], v[16:19], 0
 s_sub_u32 s70, s63, 6
 s_mov_b64 exec, 0xf
 v_cmp_gt_i32 vcc, s70, v13
 s_mov_b64 exec, -1
 s_cbranch_vccz finok_49
 s_mov_b64 exec, 15
w_50:
 buffer_load_dword v4, v11, s[48:51], s75 offen sc1
 s_waitcnt vmcnt(0)
 v_cmp_gt_u32 vcc, s70, v4
 s_cbranch_vccz wok_51
 s_sleep 2
 s_sub_u32 s46, s46, 1
 s_cbranch_scc0 w_50
 s_mov_b32 s46, 0
 s_branch wok_51
wok_51:
 s_mov_b64 exec, -1
finok_49:
 s_sub_u32 s77, s63, 7
 s_and_b32 s69, s77, 2
 s_lshl_b32 s69, s69, 12
 s_xor_b32 s69, s69, s76
 s_and_b32 s78, s77, 15
 s_lshl_b32 s78, s78, 20
 s_add_u32 s78, s78, s69
 buffer_load_dwordx4 v[232:235], v247, s[48:51], s78 offen sc1
 buffer_load_dwordx4 v[236:239], v248, s[48:51], s78 offen sc1
 buffer_load_dwordx4 v[240:243], v249, s[48:51], s78 offen sc1
 v_mfma_f32_16x16x32_bf16 v[164:167], a[12:15], v[16:19], 0
 v_mfma_f32_16x16x32_bf16 v[196:199], a[12:15], v[20:23], 0
 ds_write_b128 v7, v[100:103] offset:1024
 v_mfma_f32_16x16x32_bf16 v[180:183], a[8:11], v[20:23], 0
 v_mfma_f32_16x16x32_bf16 v[152:155], a[16:19], v[16:19], 0
 v_mfma_f32_16x16x32_bf16 v[168:171], a[20:23], v[16:19], 0
 ds_write_b128 v7, v[104:107] offset:2048
 v_mfma_f32_16x16x32_bf16 v[200:203], a[20:23], v[20:23], 0
 v_mfma_f32_16x16x32_bf16 v[184:187], a[16:19], v[20:23], 0
 v_mfma_f32_16x16x32_bf16 v[156:159], a[24:27], v[16:19], 0
 ds_write_b128 v7, v[108:111] offset:3072
 v_mfma_f32_16x16x32_bf16 v[172:175], a[28:31], v[16:19], 0
 v_mfma_f32_16x16x32_bf16 v[204:207], a[28:31], v[20:23], 0
 v_mfma_f32_16x16x32_bf16 v[188:191], a[24:27], v[20:23], 0
 ds_write_b128 v8, v[112:115] offset:0
 s_waitcnt vmcnt(15)
 v_mfma_f32_16x16x32_bf16 v[144:147], a[32:35], v[24:27], v[144:147]
 v_mfma_f32_16x16x32_bf16 v[160:163], a[36:39], v[24:27], v[160:163]
 v_mfma_f32_16x16x32_bf16 v[192:195], a[36:39], v[28:31], v[192:195]
 ds_write_b128 v8, v[116:119] offset:1024
 v_mfma_f32_16x16x32_bf16 v[176:179], a[32:35], v[28:31], v[176:179]
 v_mfma_f32_16x16x32_bf16 v[148:151], a[40:43], v[24:27], v[148:151]
 v_mfma_f32_16x16x32_bf16 v[164:167], a[44:47], v[24:27], v[164:167]
 ds_write_b128 v8, v[120:123] offset:2048
 v_mfma_f32_16x16x32_bf16 v[196:199], a[44:47], v[28:31], v[196:199]
 v_mfma_f32_16x16x32_bf16 v[180:183], a[40:43], v[28:31], v[180:183]
 v_mfma_f32_16x16x32_bf16 v[152:155], a[48:51], v[24:27], v[152:155]
 ds_write_b128 v8, v[124:127] offset:3072
 v_mfma_f32_16x16x32_bf16 v[168:171], a[52:55], v[24:27], v[168:171]
 v_mfma_f32_16x16x32_bf16 v[200:203], a[52:55], v[28:31], v[200:203]
 v_mfma_f32_16x16x32_bf16 v[184:187], a[48:51], v[28:31], v[184:187]
 ds_write_b128 v9, v[128:131] offset:0
 v_mfma_f32_16x16x32_bf16 v[156:159], a[56:59], v[24:27], v[156:159]
 v_mfma_f32_16x16x32_bf16 v[172:175], a[60:63], v[24:27], v[172:175]
 v_mfma_f32_16x16x32_bf16 v[204:207], a[60:63], v[28:31], v[204:207]
 ds_write_b128 v9, v[132:135] offset:1024
 v_mfma_f32_16x16x32_bf16 v[188:191], a[56:59], v[28:31], v[188:191]
 s_waitcnt vmcnt(13)
 v_mfma_f32_16x16x32_bf16 v[144:147], a[64:67], v[32:35], v[144:147]
 v_mfma_f32_16x16x32_bf16 v[160:163], a[68:71], v[32:35], v[160:163]
 ds_write_b128 v9, v[136:139] offset:2048
 v_mfma_f32_16x16x32_bf16 v[192:195], a[68:71], v[36:39], v[192:195]
 v_mfma_f32_16x16x32_bf16 v[176:179], a[64:67], v[36:39], v[176:179]
 v_mfma_f32_16x16x32_bf16 v[148:151], a[72:75], v[32:35], v[148:151]
 ds_write_b128 v9, v[140:143] offset:3072
 v_mfma_f32_16x16x32_bf16 v[164:167], a[76:79], v[32:35], v[164:167]
 v_mfma_f32_16x16x32_bf16 v[196:199], a[76:79], v[36:39], v[196:199]
 v_mfma_f32_16x16x32_bf16 v[180:183], a[72:75], v[36:39], v[180:183]
 s_waitcnt lgkmcnt(0)
 s_barrier
 v_mfma_f32_16x16x32_bf16 v[152:155], a[80:83], v[32:35], v[152:155]
 ds_read_b128 v[96:99], v10 offset:0
 v_mfma_f32_16x16x32_bf16 v[168:171], a[84:87], v[32:35], v[168:171]
 ds_read_b128 v[100:103], v10 offset:1024
 v_mfma_f32_16x16x32_bf16 v[200:203], a[84:87], v[36:39], v[200:203]
 ds_read_b128 v[104:107], v10 offset:2048
 v_mfma_f32_16x16x32_bf16 v[184:187], a[80:83], v[36:39], v[184:187]
 ds_read_b128 v[108:111], v10 offset:3072
 v_mfma_f32_16x16x32_bf16 v[156:159], a[88:91], v[32:35], v[156:159]
 ds_read_b128 v[112:115], v10 offset:4096
 v_mfma_f32_16x16x32_bf16 v[172:175], a[92:95], v[32:35], v[172:175]
 s_add_u32 s77, s63, 2
 s_and_b32 s69, s77, 3
 s_lshl_b32 s69, s69, 7
 s_add_u32 s71, s69, s74
 s_lshr_b32 s70, s77, 2
 s_add_u32 s70, s70, 1
 s_mov_b32 s72, s70
 s_mov_b64 exec, 0xff
 buffer_load_dword v12, v11, s[48:51], s71 offen sc1
 buffer_load_dword v13, v11, s[48:51], s75 offen sc1
 s_mov_b64 exec, -1
 v_mfma_f32_16x16x32_bf16 v[204:207], a[92:95], v[36:39], v[204:207]
 ds_read_b128 v[116:119], v10 offset:5120
 v_mfma_f32_16x16x32_bf16 v[188:191], a[88:91], v[36:39], v[188:191]
 ds_read_b128 v[120:123], v10 offset:6144
 s_waitcnt vmcnt(13)
 v_mfma_f32_16x16x32_bf16 v[144:147], a[96:99], v[40:43], v[144:147]
 ds_read_b128 v[124:127], v10 offset:7168
 v_mfma_f32_16x16x32_bf16 v[160:163], a[100:103], v[40:43], v[160:163]
 ds_read_b128 v[128:131], v10 offset:8192
 v_mfma_f32_16x16x32_bf16 v[192:195], a[100:103], v[44:47], v[192:195]
 ds_read_b128 v[132:135], v10 offset:9216
 v_mfma_f32_16x16x32_bf16 v[176:179], a[96:99], v[44:47], v[176:179]
 ds_read_b128 v[136:139], v10 offset:10240
 v_mfma_f32_16x16x32_bf16 v[148:151], a[104:107], v[40:43], v[148:151]
 ds_read_b128 v[140:143], v10 offset:11264
 v_mfma_f32_16x16x32_bf16 v[164:167], a[108:111], v[40:43], v[164:167]
 s_waitcnt lgkmcnt(8)
 v_mfma_f32_16x16x32_bf16 v[196:199], a[108:111], v[44:47], v[196:199]
 v_add_f32 v80, v80, v96
 v_add_f32 v81, v81, v97
 v_mfma_f32_16x16x32_bf16 v[180:183], a[104:107], v[44:47], v[180:183]
 v_add_f32 v82, v82, v98
 v_add_f32 v83, v83, v99
 v_mfma_f32_16x16x32_bf16 v[152:155], a[112:115], v[40:43], v[152:155]
 v_add_f32 v84, v84, v100
 v_add_f32 v85, v85, v101
 v_mfma_f32_16x16x32_bf16 v[168:171], a[116:119], v[40:43], v[168:171]
 v_add_f32 v86, v86, v102
 v_add_f32 v87, v87, v103
 v_mfma_f32_16x16x32_bf16 v[200:203], a[116:119], v[44:47], v[200:203]
 v_add_f32 v88, v88, v104
 v_add_f32 v89, v89, v105
 v_mfma_f32_16x16x32_bf16 v[184:187], a[112:115], v[44:47], v[184:187]
 v_add_f32 v90, v90, v106
 v_add_f32 v91, v91, v107
 v_mfma_f32_16x16x32_bf16 v[156:159], a[120:123], v[40:43], v[156:159]
 v_add_f32 v92, v92, v108
 v_add_f32 v93, v93, v109
 v_mfma_f32_16x16x32_bf16 v[172:175], a[124:127], v[40:43], v[172:175]
 v_add_f32 v94, v94, v110
 v_add_f32 v95, v95, v111
 v_mfma_f32_16x16x32_bf16 v[204:207], a[124:127], v[44:47], v[204:207]
 s_waitcnt lgkmcnt(4)
 v_mfma_f32_16x16x32_bf16 v[188:191], a[120:123], v[44:47], v[188:191]
 v_add_f32 v80, v80, v112
 v_add_f32 v81, v81, v113
 s_waitcnt vmcnt(11)
 v_mfma_f32_16x16x32_bf16 v[144:147], a[128:131], v[48:51], v[144:147]
 v_add_f32 v82, v82, v114
 v_add_f32 v83, v83, v115
 v_mfma_f32_16x16x32_bf16 v[160:163], a[132:135], v[48:51], v[160:163]
 v_add_f32 v84, v84, v116
 v_add_f32 v85, v85, v117
 v_mfma_f32_16x16x32_bf16 v[192:195], a[132:135], v[52:55], v[192:195]
 v_add_f32 v86, v86, v118
 v_add_f32 v87, v87, v119
 v_mfma_f32_16x16x32_bf16 v[176:179], a[128:131], v[52:55], v[176:179]
 v_add_f32 v88, v88, v120
 v_add_f32 v89, v89, v121
 v_mfma_f32_16x16x32_bf16 v[148:151], a[136:139], v[48:51], v[148:151]
 v_add_f32 v90, v90, v122
 v_add_f32 v91, v91, v123
 v_mfma_f32_16x16x32_bf16 v[164:167], a[140:143], v[48:51], v[164:167]
 s_sub_u32 s69, s63, 1
 s_max_i32 s69, s69, 0
 v_mov_b32 v3, s69
 v_mov_b32 v4, 0
 s_mov_b64 exec, 1
 buffer_store_dword v3, v4, s[48:51], s68 offen sc1
 s_mov_b64 exec, -1
 v_mfma_f32_16x16x32_bf16 v[196:199], a[140:143], v[52:55], v[196:199]
 v_add_f32 v92, v92, v124
 v_add_f32 v93, v93, v125
 v_mfma_f32_16x16x32_bf16 v[180:183], a[136:139], v[52:55], v[180:183]
 v_add_f32 v94, v94, v126
 v_add_f32 v95, v95, v127
 v_mfma_f32_16x16x32_bf16 v[152:155], a[144:147], v[48:51], v[152:155]
 s_waitcnt lgkmcnt(0)
 v_mfma_f32_16x16x32_bf16 v[168:171], a[148:151], v[48:51], v[168:171]
 v_add_f32 v80, v80, v128
 v_add_f32 v81, v81, v129
 v_mfma_f32_16x16x32_bf16 v[200:203], a[148:151], v[52:55], v[200:203]
 v_add_f32 v82, v82, v130
 v_add_f32 v83, v83, v131
 v_mfma_f32_16x16x32_bf16 v[184:187], a[144:147], v[52:55], v[184:187]
 v_add_f32 v84, v84, v132
 v_add_f32 v85, v85, v133
 v_mfma_f32_16x16x32_bf16 v[156:159], a[152:155], v[48:51], v[156:159]
 v_add_f32 v86, v86, v134
 v_add_f32 v87, v87, v135
 v_mfma_f32_16x16x32_bf16 v[172:175], a[156:159], v[48:51], v[172:175]
 v_add_f32 v88, v88, v136
 v_add_f32 v89, v89, v137
 v_mfma_f32_16x16x32_bf16 v[204:207], a[156:159], v[52:55], v[204:207]
 v_add_f32 v90, v90, v138
 v_add_f32 v91, v91, v139
 v_mfma_f32_16x16x32_bf16 v[188:191], a[152:155], v[52:55], v[188:191]
 v_add_f32 v92, v92, v140
 v_add_f32 v93, v93, v141
 s_waitcnt vmcnt(10)
 v_mfma_f32_16x16x32_bf16 v[144:147], a[160:163], v[56:59], v[144:147]
 v_add_f32 v94, v94, v142
 v_add_f32 v95, v95, v143
 v_mfma_f32_16x16x32_bf16 v[160:163], a[164:167], v[56:59], v[160:163]
 s_sub_u32 s77, s63, 1
 s_and_b32 s69, s77, 2
 v_mfma_f32_16x16x32_bf16 v[192:195], a[164:167], v[60:63], v[192:195]
 s_lshl_b32 s69, s69, 12
 s_xor_b32 s69, s69, s76
 v_mfma_f32_16x16x32_bf16 v[176:179], a[160:163], v[60:63], v[176:179]
 s_and_b32 s78, s77, 15
 s_lshl_b32 s78, s78, 20
 v_mfma_f32_16x16x32_bf16 v[148:151], a[168:171], v[56:59], v[148:151]
 s_add_u32 s78, s78, s69
 v_mfma_f32_16x16x32_bf16 v[164:167], a[172:175], v[56:59], v[164:167]
 buffer_store_dwordx4 v[84:87], v244, s[48:51], s78 offen sc1
 v_mfma_f32_16x16x32_bf16 v[196:199], a[172:175], v[60:63], v[196:199]
 buffer_store_dwordx4 v[88:91], v245, s[48:51], s78 offen sc1
 v_mfma_f32_16x16x32_bf16 v[180:183], a[168:171], v[60:63], v[180:183]
 buffer_store_dwordx4 v[92:95], v246, s[48:51], s78 offen sc1
 v_mfma_f32_16x16x32_bf16 v[152:155], a[176:179], v[56:59], v[152:155]
 s_waitcnt vmcnt(6)
 v_mfma_f32_16x16x32_bf16 v[168:171], a[180:183], v[56:59], v[168:171]
 v_add_f32 v228, v228, v232
 v_add_f32 v229, v229, v233
 v_mfma_f32_16x16x32_bf16 v[200:203], a[180:183], v[60:63], v[200:203]
 v_add_f32 v230, v230, v234
 v_add_f32 v231, v231, v235
 v_mfma_f32_16x16x32_bf16 v[184:187], a[176:179], v[60:63], v[184:187]
 v_add_f32 v228, v228, v236
 v_add_f32 v229, v229, v237
 v_mfma_f32_16x16x32_bf16 v[156:159], a[184:187], v[56:59], v[156:159]
 v_add_f32 v230, v230, v238
 v_add_f32 v231, v231, v239
 v_mfma_f32_16x16x32_bf16 v[172:175], a[188:191], v[56:59], v[172:175]
 v_add_f32 v228, v228, v240
 v_add_f32 v229, v229, v241
 v_mfma_f32_16x16x32_bf16 v[204:207], a[188:191], v[60:63], v[204:207]
 v_add_f32 v230, v230, v242
 v_add_f32 v231, v231, v243
 v_mfma_f32_16x16x32_bf16 v[188:191], a[184:187], v[60:63], v[188:191]
 s_sub_u32 s77, s63, 7
 s_cselect_b32 s77, 64, s77
 s_lshl_b32 s69, s77, 17
 v_mfma_f32_16x16x32_bf16 v[144:147], a[192:195], v[64:67], v[144:147]
 s_add_u32 s69, s69, s67
 v_cvt_pk_bf16_f32 v14, v228, v229
 v_mfma_f32_16x16x32_bf16 v[160:163], a[196:199], v[64:67], v[160:163]
 v_cvt_pk_bf16_f32 v15, v230, v231
 v_mfma_f32_16x16x32_bf16 v[192:195], a[196:199], v[68:71], v[192:195]
 buffer_store_dwordx2 v[14:15], v250, s[56:59], s69 offen
 v_mfma_f32_16x16x32_bf16 v[176:179], a[192:195], v[68:71], v[176:179]
 v_mov_b64 v[228:229], v[220:221]
 v_mov_b64 v[230:231], v[222:223]
 v_mfma_f32_16x16x32_bf16 v[148:151], a[200:203], v[64:67], v[148:151]
 v_mov_b64 v[220:221], v[212:213]
 v_mov_b64 v[222:223], v[214:215]
 v_mfma_f32_16x16x32_bf16 v[164:167], a[204:207], v[64:67], v[164:167]
 v_mov_b64 v[212:213], v[80:81]
 v_mov_b64 v[214:215], v[82:83]
 v_mfma_f32_16x16x32_bf16 v[196:199], a[204:207], v[68:71], v[196:199]
 v_mfma_f32_16x16x32_bf16 v[180:183], a[200:203], v[68:71], v[180:183]
 v_mfma_f32_16x16x32_bf16 v[152:155], a[208:211], v[64:67], v[152:155]
 v_mfma_f32_16x16x32_bf16 v[168:171], a[212:215], v[64:67], v[168:171]
 v_mfma_f32_16x16x32_bf16 v[200:203], a[212:215], v[68:71], v[200:203]
 v_mfma_f32_16x16x32_bf16 v[184:187], a[208:211], v[68:71], v[184:187]
 v_mfma_f32_16x16x32_bf16 v[156:159], a[216:219], v[64:67], v[156:159]
 v_mfma_f32_16x16x32_bf16 v[172:175], a[220:223], v[64:67], v[172:175]
 v_mfma_f32_16x16x32_bf16 v[204:207], a[220:223], v[68:71], v[204:207]
 v_mfma_f32_16x16x32_bf16 v[188:191], a[216:219], v[68:71], v[188:191]
 v_mfma_f32_16x16x32_bf16 v[144:147], a[224:227], v[72:75], v[144:147]
 v_mfma_f32_16x16x32_bf16 v[160:163], a[228:231], v[72:75], v[160:163]
 v_mfma_f32_16x16x32_bf16 v[192:195], a[228:231], v[76:79], v[192:195]
 v_mfma_f32_16x16x32_bf16 v[176:179], a[224:227], v[76:79], v[176:179]
 v_mfma_f32_16x16x32_bf16 v[148:151], a[232:235], v[72:75], v[148:151]
 v_mfma_f32_16x16x32_bf16 v[164:167], a[236:239], v[72:75], v[164:167]
 v_mfma_f32_16x16x32_bf16 v[196:199], a[236:239], v[76:79], v[196:199]
 v_mfma_f32_16x16x32_bf16 v[180:183], a[232:235], v[76:79], v[180:183]
 v_mfma_f32_16x16x32_bf16 v[152:155], a[240:243], v[72:75], v[152:155]
 v_mfma_f32_16x16x32_bf16 v[168:171], a[244:247], v[72:75], v[168:171]
 v_mfma_f32_16x16x32_bf16 v[200:203], a[244:247], v[76:79], v[200:203]
 v_mfma_f32_16x16x32_bf16 v[184:187], a[240:243], v[76:79], v[184:187]
 v_mfma_f32_16x16x32_bf16 v[156:159], a[248:251], v[72:75], v[156:159]
 v_mfma_f32_16x16x32_bf16 v[172:175], a[252:255], v[72:75], v[172:175]
 v_mfma_f32_16x16x32_bf16 v[204:207], a[252:255], v[76:79], v[204:207]
 v_mfma_f32_16x16x32_bf16 v[188:191], a[248:251], v[76:79], v[188:191]
 s_waitcnt vmcnt(5)
 s_mov_b32 s73, 0
 s_branch nxt_42
have_41:
 s_mov_b64 exec, 0xff
 v_cmp_gt_u32 vcc, s72, v12
 s_mov_b64 exec, -1
 s_cbranch_vccnz dry_52
 v_mfma_f32_16x16x32_bf16 v[144:147], a[0:3], v[16:19], 0
 v_mfma_f32_16x16x32_bf16 v[160:163], a[4:7], v[16:19], 0
 v_mfma_f32_16x16x32_bf16 v[192:195], a[4:7], v[20:23], 0
 ds_write_b128 v7, v[96:99] offset:0
 v_mfma_f32_16x16x32_bf16 v[176:179], a[0:3], v[20:23], 0
 v_mfma_f32_16x16x32_bf16 v[148:151], a[8:11], v[16:19], 0
 s_sub_u32 s70, s63, 6
 s_mov_b64 exec, 0xf
 v_cmp_gt_i32 vcc, s70, v13
 s_mov_b64 exec, -1
 s_cbranch_vccz finok_53
 s_mov_b64 exec, 15
w_54:
 buffer_load_dword v4, v11, s[48:51], s75 offen sc1
 s_waitcnt vmcnt(0)
 v_cmp_gt_u32 vcc, s70, v4
 s_cbranch_vccz wok_55
 s_sleep 2
 s_sub_u32 s46, s46, 1
 s_cbranch_scc0 w_54
 s_mov_b32 s46, 0
 s_branch wok_55
wok_55:
 s_mov_b64 exec, -1
finok_53:
 s_sub_u32 s77, s63, 7
 s_and_b32 s69, s77, 2
 s_lshl_b32 s69, s69, 12
 s_xor_b32 s69, s69, s76
 s_and_b32 s78, s77, 15
 s_lshl_b32 s78, s78, 20
 s_add_u32 s78, s78, s69
 buffer_load_dwordx4 v[232:235], v247, s[48:51], s78 offen sc1
 buffer_load_dwordx4 v[236:239], v248, s[48:51], s78 offen sc1
 buffer_load_dwordx4 v[240:243], v249, s[48:51], s78 offen sc1
 v_mfma_f32_16x16x32_bf16 v[164:167], a[12:15], v[16:19], 0
 v_mfma_f32_16x16x32_bf16 v[196:199], a[12:15], v[20:23], 0
 ds_write_b128 v7, v[100:103] offset:1024
 v_mfma_f32_16x16x32_bf16 v[180:183], a[8:11], v[20:23], 0
 v_mfma_f32_16x16x32_bf16 v[152:155], a[16:19], v[16:19], 0
 v_mfma_f32_16x16x32_bf16 v[168:171], a[20:23], v[16:19], 0
 ds_write_b128 v7, v[104:107] offset:2048
 v_mfma_f32_16x16x32_bf16 v[200:203], a[20:23], v[20:23], 0
 v_mfma_f32_16x16x32_bf16 v[184:187], a[16:19], v[20:23], 0
 v_mfma_f32_16x16x32_bf16 v[156:159], a[24:27], v[16:19], 0
 ds_write_b128 v7, v[108:111] offset:3072
 v_mfma_f32_16x16x32_bf16 v[172:175], a[28:31], v[16:19], 0
 v_mfma_f32_16x16x32_bf16 v[204:207], a[28:31], v[20:23], 0
 v_mfma_f32_16x16x32_bf16 v[188:191], a[24:27], v[20:23], 0
 ds_write_b128 v8, v[112:115] offset:0
 v_mfma_f32_16x16x32_bf16 v[144:147], a[32:35], v[24:27], v[144:147]
 s_add_u32 s82, s65, 0
 buffer_load_dwordx4 v[16:19], v2, s[48:51], s82 offen offset:0 sc1
 v_mfma_f32_16x16x32_bf16 v[160:163], a[36:39], v[24:27], v[160:163]
 v_mfma_f32_16x16x32_bf16 v[192:195], a[36:39], v[28:31], v[192:195]
 buffer_load_dwordx4 v[20:23], v5, s[48:51], s82 offen offset:0 sc1
 v_mfma_f32_16x16x32_bf16 v[176:179], a[32:35], v[28:31], v[176:179]
 v_mfma_f32_16x16x32_bf16 v[148:151], a[40:43], v[24:27], v[148:151]
 ds_write_b128 v8, v[116:119] offset:1024
 v_mfma_f32_16x16x32_bf16 v[164:167], a[44:47], v[24:27], v[164:167]
 v_mfma_f32_16x16x32_bf16 v[196:199], a[44:47], v[28:31], v[196:199]
 v_mfma_f32_16x16x32_bf16 v[180:183], a[40:43], v[28:31], v[180:183]
 ds_write_b128 v8, v[120:123] offset:2048
 v_mfma_f32_16x16x32_bf16 v[152:155], a[48:51], v[24:27], v[152:155]
 v_mfma_f32_16x16x32_bf16 v[168:171], a[52:55], v[24:27], v[168:171]
 v_mfma_f32_16x16x32_bf16 v[200:203], a[52:55], v[28:31], v[200:203]
 ds_write_b128 v8, v[124:127] offset:3072
 v_mfma_f32_16x16x32_bf16 v[184:187], a[48:51], v[28:31], v[184:187]
 v_mfma_f32_16x16x32_bf16 v[156:159], a[56:59], v[24:27], v[156:159]
 v_mfma_f32_16x16x32_bf16 v[172:175], a[60:63], v[24:27], v[172:175]
 ds_write_b128 v9, v[128:131] offset:0
 v_mfma_f32_16x16x32_bf16 v[204:207], a[60:63], v[28:31], v[204:207]
 v_mfma_f32_16x16x32_bf16 v[188:191], a[56:59], v[28:31], v[188:191]
 s_waitcnt vmcnt(20)
 v_mfma_f32_16x16x32_bf16 v[144:147], a[64:67], v[32:35], v[144:147]
 buffer_load_dwordx4 v[24:27], v2, s[48:51], s82 offen offset:2048 sc1
 v_mfma_f32_16x16x32_bf16 v[160:163], a[68:71], v[32:35], v[160:163]
 ds_write_b128 v9, v[132:135] offset:1024
 v_mfma_f32_16x16x32_bf16 v[192:195], a[68:71], v[36:39], v[192:195]
 buffer_load_dwordx4 v[28:31], v5, s[48:51], s82 offen offset:2048 sc1
 v_mfma_f32_16x16x32_bf16 v[176:179], a[64:67], v[36:39], v[176:179]
 v_mfma_f32_16x16x32_bf16 v[148:151], a[72:75], v[32:35], v[148:151]
 v_mfma_f32_16x16x32_bf16 v[164:167], a[76:79], v[32:35], v[164:167]
 ds_write_b128 v9, v[136:139] offset:2048
 v_mfma_f32_16x16x32_bf16 v[196:199], a[76:79], v[36:39], v[196:199]
 v_mfma_f32_16x16x32_bf16 v[180:183], a[72:75], v[36:39], v[180:183]
 v_mfma_f32_16x16x32_bf16 v[152:155], a[80:83], v[32:35], v[152:155]
 ds_write_b128 v9, v[140:143] offset:3072
 v_mfma_f32_16x16x32_bf16 v[168:171], a[84:87], v[32:35], v[168:171]
 v_mfma_f32_16x16x32_bf16 v[200:203], a[84:87], v[36:39], v[200:203]
 v_mfma_f32_16x16x32_bf16 v[184:187], a[80:83], v[36:39], v[184:187]
 s_waitcnt lgkmcnt(0)
 s_barrier
 v_mfma_f32_16x16x32_bf16 v[156:159], a[88:91], v[32:35], v[156:159]
 ds_read_b128 v[96:99], v10 offset:0
 v_mfma_f32_16x16x32_bf16 v[172:175], a[92:95], v[32:35], v[172:175]
 s_add_u32 s77, s63, 2
 s_and_b32 s69, s77, 3
 s_lshl_b32 s69, s69, 7
 s_add_u32 s71, s69, s74
 s_lshr_b32 s70, s77, 2
 s_add_u32 s70, s70, 1
 s_mov_b32 s72, s70
 s_mov_b64 exec, 0xff
 buffer_load_dword v12, v11, s[48:51], s71 offen sc1
 buffer_load_dword v13, v11, s[48:51], s75 offen sc1
 s_mov_b64 exec, -1
 v_mfma_f32_16x16x32_bf16 v[204:207], a[92:95], v[36:39], v[204:207]
 ds_read_b128 v[100:103], v10 offset:1024
 v_mfma_f32_16x16x32_bf16 v[188:191], a[88:91], v[36:39], v[188:191]
 ds_read_b128 v[104:107], v10 offset:2048
 s_waitcnt vmcnt(22)
 v_mfma_f32_16x16x32_bf16 v[144:147], a[96:99], v[40:43], v[144:147]
 s_add_u32 s82, s65, 4096
 buffer_load_dwordx4 v[32:35], v2, s[48:51], s82 offen offset:0 sc1
 v_mfma_f32_16x16x32_bf16 v[160:163], a[100:103], v[40:43], v[160:163]
 ds_read_b128 v[108:111], v10 offset:3072
 v_mfma_f32_16x16x32_bf16 v[192:195], a[100:103], v[44:47], v[192:195]
 buffer_load_dwordx4 v[36:39], v5, s[48:51], s82 offen offset:0 sc1
 v_mfma_f32_16x16x32_bf16 v[176:179], a[96:99], v[44:47], v[176:179]
 ds_read_b128 v[112:115], v10 offset:4096
 v_mfma_f32_16x16x32_bf16 v[148:151], a[104:107], v[40:43], v[148:151]
 ds_read_b128 v[116:119], v10 offset:5120
 v_mfma_f32_16x16x32_bf16 v[164:167], a[108:111], v[40:43], v[164:167]
 ds_read_b128 v[120:123], v10 offset:6144
 v_mfma_f32_16x16x32_bf16 v[196:199], a[108:111], v[44:47], v[196:199]
 ds_read_b128 v[124:127], v10 offset:7168
 v_mfma_f32_16x16x32_bf16 v[180:183], a[104:107], v[44:47], v[180:183]
 ds_read_b128 v[128:131], v10 offset:8192
 v_mfma_f32_16x16x32_bf16 v[152:155], a[112:115], v[40:43], v[152:155]
 ds_read_b128 v[132:135], v10 offset:9216
 v_mfma_f32_16x16x32_bf16 v[168:171], a[116:119], v[40:43], v[168:171]
 ds_read_b128 v[136:139], v10 offset:10240
 v_mfma_f32_16x16x32_bf16 v[200:203], a[116:119], v[44:47], v[200:203]
 ds_read_b128 v[140:143], v10 offset:11264
 v_mfma_f32_16x16x32_bf16 v[184:187], a[112:115], v[44:47], v[184:187]
 s_waitcnt lgkmcnt(8)
 v_mfma_f32_16x16x32_bf16 v[156:159], a[120:123], v[40:43], v[156:159]
 v_add_f32 v80, v80, v96
 v_add_f32 v81, v81, v97
 v_mfma_f32_16x16x32_bf16 v[172:175], a[124:127], v[40:43], v[172:175]
 v_add_f32 v82, v82, v98
 v_add_f32 v83, v83, v99
 v_mfma_f32_16x16x32_bf16 v[204:207], a[124:127], v[44:47], v[204:207]
 v_add_f32 v84, v84, v100
 v_add_f32 v85, v85, v101
 v_mfma_f32_16x16x32_bf16 v[188:191], a[120:123], v[44:47], v[188:191]
 v_add_f32 v86, v86, v102
 v_add_f32 v87, v87, v103
 s_waitcnt vmcnt(21)
 v_mfma_f32_16x16x32_bf16 v[144:147], a[128:131], v[48:51], v[144:147]
 buffer_load_dwordx4 v[40:43], v2, s[48:51], s82 offen offset:2048 sc1
 v_mfma_f32_16x16x32_bf16 v[160:163], a[132:135], v[48:51], v[160:163]
 v_add_f32 v88, v88, v104
 v_add_f32 v89, v89, v105
 v_mfma_f32_16x16x32_bf16 v[192:195], a[132:135], v[52:55], v[192:195]
 buffer_load_dwordx4 v[44:47], v5, s[48:51], s82 offen offset:2048 sc1
 v_mfma_f32_16x16x32_bf16 v[176:179], a[128:131], v[52:55], v[176:179]
 v_add_f32 v90, v90, v106
 v_add_f32 v91, v91, v107
 v_mfma_f32_16x16x32_bf16 v[148:151], a[136:139], v[48:51], v[148:151]
 v_add_f32 v92, v92, v108
 v_add_f32 v93, v93, v109
 v_mfma_f32_16x16x32_bf16 v[164:167], a[140:143], v[48:51], v[164:167]
 s_waitcnt vmcnt(17)
 s_sub_u32 s69, s63, 1
 s_max_i32 s69, s69, 0
 v_mov_b32 v3, s69
 v_mov_b32 v4, 0
 s_mov_b64 exec, 1
 buffer_store_dword v3, v4, s[48:51], s68 offen sc1
 s_mov_b64 exec, -1
 v_mfma_f32_16x16x32_bf16 v[196:199], a[140:143], v[52:55], v[196:199]
 v_add_f32 v94, v94, v110
 v_add_f32 v95, v95, v111
 v_mfma_f32_16x16x32_bf16 v[180:183], a[136:139], v[52:55], v[180:183]
 s_waitcnt lgkmcnt(4)
 v_mfma_f32_16x16x32_bf16 v[152:155], a[144:147], v[48:51], v[152:155]
 v_add_f32 v80, v80, v112
 v_add_f32 v81, v81, v113
 v_mfma_f32_16x16x32_bf16 v[168:171], a[148:151], v[48:51], v[168:171]
 v_add_f32 v82, v82, v114
 v_add_f32 v83, v83, v115
 v_mfma_f32_16x16x32_bf16 v[200:203], a[148:151], v[52:55], v[200:203]
 v_add_f32 v84, v84, v116
 v_add_f32 v85, v85, v117
 v_mfma_f32_16x16x32_bf16 v[184:187], a[144:147], v[52:55], v[184:187]
 v_add_f32 v86, v86, v118
 v_add_f32 v87, v87, v119
 v_mfma_f32_16x16x32_bf16 v[156:159], a[152:155], v[48:51], v[156:159]
 v_add_f32 v88, v88, v120
 v_add_f32 v89, v89, v121
 v_mfma_f32_16x16x32_bf16 v[172:175], a[156:159], v[48:51], v[172:175]
 v_add_f32 v90, v90, v122
 v_add_f32 v91, v91, v123
 v_mfma_f32_16x16x32_bf16 v[204:207], a[156:159], v[52:55], v[204:207]
 v_add_f32 v92, v92, v124
 v_add_f32 v93, v93, v125
 v_mfma_f32_16x16x32_bf16 v[188:191], a[152:155], v[52:55], v[188:191]
 v_add_f32 v94, v94, v126
 v_add_f32 v95, v95, v127
 v_mfma_f32_16x16x32_bf16 v[144:147], a[160:163], v[56:59], v[144:147]
 s_add_u32 s82, s65, 8192
 buffer_load_dwordx4 v[48:51], v2, s[48:51], s82 offen offset:0 sc1
 v_mfma_f32_16x16x32_bf16 v[160:163], a[164:167], v[56:59], v[160:163]
 s_waitcnt lgkmcnt(0)
 v_mfma_f32_16x16x32_bf16 v[192:195], a[164:167], v[60:63], v[192:195]
 buffer_load_dwordx4 v[52:55], v5, s[48:51], s82 offen offset:0 sc1
 v_mfma_f32_16x16x32_bf16 v[176:179], a[160:163], v[60:63], v[176:179]
 v_add_f32 v80, v80, v128
 v_add_f32 v81, v81, v129
 v_mfma_f32_16x16x32_bf16 v[148:151], a[168:171], v[56:59], v[148:151]
 v_add_f32 v82, v82, v130
 v_add_f32 v83, v83, v131
 v_mfma_f32_16x16x32_bf16 v[164:167], a[172:175], v[56:59], v[164:167]
 v_add_f32 v84, v84, v132
 v_add_f32 v85, v85, v133
 v_mfma_f32_16x16x32_bf16 v[196:199], a[172:175], v[60:63], v[196:199]
 v_add_f32 v86, v86, v134
 v_add_f32 v87, v87, v135
 v_mfma_f32_16x16x32_bf16 v[180:183], a[168:171], v[60:63], v[180:183]
 v_add_f32 v88, v88, v136
 v_add_f32 v89, v89, v137
 v_mfma_f32_16x16x32_bf16 v[152:155], a[176:179], v[56:59], v[152:155]
 v_add_f32 v90, v90, v138
 v_add_f32 v91, v91, v139
 v_mfma_f32_16x16x32_bf16 v[168:171], a[180:183], v[56:59], v[168:171]
 v_add_f32 v92, v92, v140
 v_add_f32 v93, v93, v141
 v_mfma_f32_16x16x32_bf16 v[200:203], a[180:183], v[60:63], v[200:203]
 v_add_f32 v94, v94, v142
 v_add_f32 v95, v95, v143
 v_mfma_f32_16x16x32_bf16 v[184:187], a[176:179], v[60:63], v[184:187]
 s_sub_u32 s77, s63, 1
 s_and_b32 s69, s77, 2
 v_mfma_f32_16x16x32_bf16 v[156:159], a[184:187], v[56:59], v[156:159]
 s_lshl_b32 s69, s69, 12
 s_xor_b32 s69, s69, s76
 v_mfma_f32_16x16x32_bf16 v[172:175], a[188:191], v[56:59], v[172:175]
 s_and_b32 s78, s77, 15
 s_lshl_b32 s78, s78, 20
 v_mfma_f32_16x16x32_bf16 v[204:207], a[188:191], v[60:63], v[204:207]
 s_add_u32 s78, s78, s69
 v_mfma_f32_16x16x32_bf16 v[188:191], a[184:187], v[60:63], v[188:191]
 buffer_store_dwordx4 v[84:87], v244, s[48:51], s78 offen sc1
 s_waitcnt vmcnt(19)
 v_mfma_f32_16x16x32_bf16 v[144:147], a[192:195], v[64:67], v[144:147]
 buffer_load_dwordx4 v[56:59], v2, s[48:51], s82 offen offset:2048 sc1
 v_mfma_f32_16x16x32_bf16 v[160:163], a[196:199], v[64:67], v[160:163]
 buffer_store_dwordx4 v[88:91], v245, s[48:51], s78 offen sc1
 v_mfma_f32_16x16x32_bf16 v[192:195], a[196:199], v[68:71], v[192:195]
 buffer_load_dwordx4 v[60:63], v5, s[48:51], s82 offen offset:2048 sc1
 v_mfma_f32_16x16x32_bf16 v[176:179], a[192:195], v[68:71], v[176:179]
 buffer_store_dwordx4 v[92:95], v246, s[48:51], s78 offen sc1
 v_mfma_f32_16x16x32_bf16 v[148:151], a[200:203], v[64:67], v[148:151]
 s_waitcnt vmcnt(18)
 v_mfma_f32_16x16x32_bf16 v[164:167], a[204:207], v[64:67], v[164:167]
 v_add_f32 v228, v228, v232
 v_add_f32 v229, v229, v233
 v_mfma_f32_16x16x32_bf16 v[196:199], a[204:207], v[68:71], v[196:199]
 v_add_f32 v230, v230, v234
 v_add_f32 v231, v231, v235
 v_mfma_f32_16x16x32_bf16 v[180:183], a[200:203], v[68:71], v[180:183]
 v_add_f32 v228, v228, v236
 v_add_f32 v229, v229, v237
 v_mfma_f32_16x16x32_bf16 v[152:155], a[208:211], v[64:67], v[152:155]
 v_add_f32 v230, v230, v238
 v_add_f32 v231, v231, v239
 v_mfma_f32_16x16x32_bf16 v[168:171], a[212:215], v[64:67], v[168:171]
 v_add_f32 v228, v228, v240
 v_add_f32 v229, v229, v241
 v_mfma_f32_16x16x32_bf16 v[200:203], a[212:215], v[68:71], v[200:203]
 v_add_f32 v230, v230, v242
 v_add_f32 v231, v231, v243
 v_mfma_f32_16x16x32_bf16 v[184:187], a[208:211], v[68:71], v[184:187]
 s_sub_u32 s77, s63, 7
 s_cselect_b32 s77, 64, s77
 s_lshl_b32 s69, s77, 17
 v_mfma_f32_16x16x32_bf16 v[156:159], a[216:219], v[64:67], v[156:159]
 s_add_u32 s69, s69, s67
 v_cvt_pk_bf16_f32 v14, v228, v229
 v_mfma_f32_16x16x32_bf16 v[172:175], a[220:223], v[64:67], v[172:175]
 v_cvt_pk_bf16_f32 v15, v230, v231
 v_mfma_f32_16x16x32_bf16 v[204:207], a[220:223], v[68:71], v[204:207]
 buffer_store_dwordx2 v[14:15], v250, s[56:59], s69 offen
 v_mfma_f32_16x16x32_bf16 v[188:191], a[216:219], v[68:71], v[188:191]
 v_mov_b64 v[228:229], v[220:221]
 v_mov_b64 v[230:231], v[222:223]
 v_mfma_f32_16x16x32_bf16 v[144:147], a[224:227], v[72:75], v[144:147]
 s_add_u32 s82, s65, 12288
 buffer_load_dwordx4 v[64:67], v2, s[48:51], s82 offen offset:0 sc1
 v_mfma_f32_16x16x32_bf16 v[160:163], a[228:231], v[72:75], v[160:163]
 v_mov_b64 v[220:221], v[212:213]
 v_mov_b64 v[222:223], v[214:215]
 v_mfma_f32_16x16x32_bf16 v[192:195], a[228:231], v[76:79], v[192:195]
 buffer_load_dwordx4 v[68:71], v5, s[48:51], s82 offen offset:0 sc1
 v_mfma_f32_16x16x32_bf16 v[176:179], a[224:227], v[76:79], v[176:179]
 v_mov_b64 v[212:213], v[80:81]
 v_mov_b64 v[214:215], v[82:83]
 v_mfma_f32_16x16x32_bf16 v[148:151], a[232:235], v[72:75], v[148:151]
 v_mfma_f32_16x16x32_bf16 v[164:167], a[236:239], v[72:75], v[164:167]
 v_mfma_f32_16x16x32_bf16 v[196:199], a[236:239], v[76:79], v[196:199]
 v_mfma_f32_16x16x32_bf16 v[180:183], a[232:235], v[76:79], v[180:183]
 v_mfma_f32_16x16x32_bf16 v[152:155], a[240:243], v[72:75], v[152:155]
 v_mfma_f32_16x16x32_bf16 v[168:171], a[244:247], v[72:75], v[168:171]
 v_mfma_f32_16x16x32_bf16 v[200:203], a[244:247], v[76:79], v[200:203]
 v_mfma_f32_16x16x32_bf16 v[184:187], a[240:243], v[76:79], v[184:187]
 v_mfma_f32_16x16x32_bf16 v[156:159], a[248:251], v[72:75], v[156:159]
 v_mfma_f32_16x16x32_bf16 v[172:175], a[252:255], v[72:75], v[172:175]
 v_mfma_f32_16x16x32_bf16 v[204:207], a[252:255], v[76:79], v[204:207]
 v_mfma_f32_16x16x32_bf16 v[188:191], a[248:251], v[76:79], v[188:191]
 buffer_load_dwordx4 v[72:75], v2, s[48:51], s82 offen offset:2048 sc1
 buffer_load_dwordx4 v[76:79], v5, s[48:51], s82 offen offset:2048 sc1
 s_waitcnt vmcnt(17)
 s_mov_b32 s73, 1
 s_add_u32 s65, s65, 0x40000
 s_branch nxt_42
dry_52:
 v_mfma_f32_16x16x32_bf16 v[144:147], a[0:3], v[16:19], 0
 v_mfma_f32_16x16x32_bf16 v[160:163], a[4:7], v[16:19], 0
 v_mfma_f32_16x16x32_bf16 v[192:195], a[4:7], v[20:23], 0
 ds_write_b128 v7, v[96:99] offset:0
 v_mfma_f32_16x16x32_bf16 v[176:179], a[0:3], v[20:23], 0
 v_mfma_f32_16x16x32_bf16 v[148:151], a[8:11], v[16:19], 0
 s_sub_u32 s70, s63, 6
 s_mov_b64 exec, 0xf
 v_cmp_gt_i32 vcc, s70, v13
 s_mov_b64 exec, -1
 s_cbranch_vccz finok_56
 s_mov_b64 exec, 15
w_57:
 buffer_load_dword v4, v11, s[48:51], s75 offen sc1
 s_waitcnt vmcnt(0)
 v_cmp_gt_u32 vcc, s70, v4
 s_cbranch_vccz wok_58
 s_sleep 2
 s_sub_u32 s46, s46, 1
 s_cbranch_scc0 w_57
 s_mov_b32 s46, 0
 s_branch wok_58
wok_58:
 s_mov_b64 exec, -1
finok_56:
 s_sub_u32 s77, s63, 7
 s_and_b32 s69, s77, 2
 s_lshl_b32 s69, s69, 12
 s_xor_b32 s69, s69, s76
 s_and_b32 s78, s77, 15
 s_lshl_b32 s78, s78, 20
 s_add_u32 s78, s78, s69
 buffer_load_dwordx4 v[232:235], v247, s[48:51], s78 offen sc1
 buffer_load_dwordx4 v[236:239], v248, s[48:51], s78 offen sc1
 buffer_load_dwordx4 v[240:243], v249, s[48:51], s78 offen sc1
 v_mfma_f32_16x16x32_bf16 v[164:167], a[12:15], v[16:19], 0
 v_mfma_f32_16x16x32_bf16 v[196:199], a[12:15], v[20:23], 0
 ds_write_b128 v7, v[100:103] offset:1024
 v_mfma_f32_16x16x32_bf16 v[180:183], a[8:11], v[20:23], 0
 v_mfma_f32_16x16x32_bf16 v[152:155], a[16:19], v[16:19], 0
 v_mfma_f32_16x16x32_bf16 v[168:171], a[20:23], v[16:19], 0
 ds_write_b128 v7, v[104:107] offset:2048
 v_mfma_f32_16x16x32_bf16 v[200:203], a[20:23], v[20:23], 0
 v_mfma_f32_16x16x32_bf16 v[184:187], a[16:19], v[20:23], 0
 v_mfma_f32_16x16x32_bf16 v[156:159], a[24:27], v[16:19], 0
 ds_write_b128 v7, v[108:111] offset:3072
 v_mfma_f32_16x16x32_bf16 v[172:175], a[28:31], v[16:19], 0
 v_mfma_f32_16x16x32_bf16 v[204:207], a[28:31], v[20:23], 0
 v_mfma_f32_16x16x32_bf16 v[188:191], a[24:27], v[20:23], 0
 ds_write_b128 v8, v[112:115] offset:0
 v_mfma_f32_16x16x32_bf16 v[144:147], a[32:35], v[24:27], v[144:147]
 v_mfma_f32_16x16x32_bf16 v[160:163], a[36:39], v[24:27], v[160:163]
 v_mfma_f32_16x16x32_bf16 v[192:195], a[36:39], v[28:31], v[192:195]
 ds_write_b128 v8, v[116:119] offset:1024
 v_mfma_f32_16x16x32_bf16 v[176:179], a[32:35], v[28:31], v[176:179]
 v_mfma_f32_16x16x32_bf16 v[148:151], a[40:43], v[24:27], v[148:151]
 v_mfma_f32_16x16x32_bf16 v[164:167], a[44:47], v[24:27], v[164:167]
 ds_write_b128 v8, v[120:123] offset:2048
 v_mfma_f32_16x16x32_bf16 v[196:199], a[44:47], v[28:31], v[196:199]
 v_mfma_f32_16x16x32_bf16 v[180:183], a[40:43], v[28:31], v[180:183]
 v_mfma_f32_16x16x32_bf16 v[152:155], a[48:51], v[24:27], v[152:155]
 ds_write_b128 v8, v[124:127] offset:3072
 v_mfma_f32_16x16x32_bf16 v[168:171], a[52:55], v[24:27], v[168:171]
 v_mfma_f32_16x16x32_bf16 v[200:203], a[52:55], v[28:31], v[200:203]
 v_mfma_f32_16x16x32_bf16 v[184:187], a[48:51], v[28:31], v[184:187]
 ds_write_b128 v9, v[128:131] offset:0
 v_mfma_f32_16x16x32_bf16 v[156:159], a[56:59], v[24:27], v[156:159]
 v_mfma_f32_16x16x32_bf16 v[172:175], a[60:63], v[24:27], v[172:175]
 v_mfma_f32_16x16x32_bf16 v[204:207], a[60:63], v[28:31], v[204:207]
 ds_write_b128 v9, v[132:135] offset:1024
 v_mfma_f32_16x16x32_bf16 v[188:191], a[56:59], v[28:31], v[188:191]
 s_waitcnt vmcnt(18)
 v_mfma_f32_16x16x32_bf16 v[144:147], a[64:67], v[32:35], v[144:147]
 v_mfma_f32_16x16x32_bf16 v[160:163], a[68:71], v[32:35], v[160:163]
 ds_write_b128 v9, v[136:139] offset:2048
 v_mfma_f32_16x16x32_bf16 v[192:195], a[68:71], v[36:39], v[192:195]
 v_mfma_f32_16x16x32_bf16 v[176:179], a[64:67], v[36:39], v[176:179]
 v_mfma_f32_16x16x32_bf16 v[148:151], a[72:75], v[32:35], v[148:151]
 ds_write_b128 v9, v[140:143] offset:3072
 v_mfma_f32_16x16x32_bf16 v[164:167], a[76:79], v[32:35], v[164:167]
 v_mfma_f32_16x16x32_bf16 v[196:199], a[76:79], v[36:39], v[196:199]
 v_mfma_f32_16x16x32_bf16 v[180:183], a[72:75], v[36:39], v[180:183]
 s_waitcnt lgkmcnt(0)
 s_barrier
 v_mfma_f32_16x16x32_bf16 v[152:155], a[80:83], v[32:35], v[152:155]
 ds_read_b128 v[96:99], v10 offset:0
 v_mfma_f32_16x16x32_bf16 v[168:171], a[84:87], v[32:35], v[168:171]
 ds_read_b128 v[100:103], v10 offset:1024
 v_mfma_f32_16x16x32_bf16 v[200:203], a[84:87], v[36:39], v[200:203]
 ds_read_b128 v[104:107], v10 offset:2048
 v_mfma_f32_16x16x32_bf16 v[184:187], a[80:83], v[36:39], v[184:187]
 ds_read_b128 v[108:111], v10 offset:3072
 v_mfma_f32_16x16x32_bf16 v[156:159], a[88:91], v[32:35], v[156:159]
 ds_read_b128 v[112:115], v10 offset:4096
 v_mfma_f32_16x16x32_bf16 v[172:175], a[92:95], v[32:35], v[172:175]
 s_add_u32 s77, s63, 2
 s_and_b32 s69, s77, 3
 s_lshl_b32 s69, s69, 7
 s_add_u32 s71, s69, s74
 s_lshr_b32 s70, s77, 2
 s_add_u32 s70, s70, 1
 s_mov_b32 s72, s70
 s_mov_b64 exec, 0xff
 buffer_load_dword v12, v11, s[48:51], s71 offen sc1
 buffer_load_dword v13, v11, s[48:51], s75 offen sc1
 s_mov_b64 exec, -1
 v_mfma_f32_16x16x32_bf16 v[204:207], a[92:95], v[36:39], v[204:207]
 ds_read_b128 v[116:119], v10 offset:5120
 v_mfma_f32_16x16x32_bf16 v[188:191], a[88:91], v[36:39], v[188:191]
 ds_read_b128 v[120:123], v10 offset:6144
 s_waitcnt vmcnt(18)
 v_mfma_f32_16x16x32_bf16 v[144:147], a[96:99], v[40:43], v[144:147]
 ds_read_b128 v[124:127], v10 offset:7168
 v_mfma_f32_16x16x32_bf16 v[160:163], a[100:103], v[40:43], v[160:163]
 ds_read_b128 v[128:131], v10 offset:8192
 v_mfma_f32_16x16x32_bf16 v[192:195], a[100:103], v[44:47], v[192:195]
 ds_read_b128 v[132:135], v10 offset:9216
 v_mfma_f32_16x16x32_bf16 v[176:179], a[96:99], v[44:47], v[176:179]
 ds_read_b128 v[136:139], v10 offset:10240
 v_mfma_f32_16x16x32_bf16 v[148:151], a[104:107], v[40:43], v[148:151]
 ds_read_b128 v[140:143], v10 offset:11264
 v_mfma_f32_16x16x32_bf16 v[164:167], a[108:111], v[40:43], v[164:167]
 s_waitcnt lgkmcnt(8)
 v_mfma_f32_16x16x32_bf16 v[196:199], a[108:111], v[44:47], v[196:199]
 v_add_f32 v80, v80, v96
 v_add_f32 v81, v81, v97
 v_mfma_f32_16x16x32_bf16 v[180:183], a[104:107], v[44:47], v[180:183]
 v_add_f32 v82, v82, v98
 v_add_f32 v83, v83, v99
 v_mfma_f32_16x16x32_bf16 v[152:155], a[112:115], v[40:43], v[152:155]
 v_add_f32 v84, v84, v100
 v_add_f32 v85, v85, v101
 v_mfma_f32_16x16x32_bf16 v[168:171], a[116:119], v[40:43], v[168:171]
 v_add_f32 v86, v86, v102
 v_add_f32 v87, v87, v103
 v_mfma_f32_16x16x32_bf16 v[200:203], a[116:119], v[44:47], v[200:203]
 v_add_f32 v88, v88, v104
 v_add_f32 v89, v89, v105
 v_mfma_f32_16x16x32_bf16 v[184:187], a[112:115], v[44:47], v[184:187]
 v_add_f32 v90, v90, v106
 v_add_f32 v91, v91, v107
 v_mfma_f32_16x16x32_bf16 v[156:159], a[120:123], v[40:43], v[156:159]
 v_add_f32 v92, v92, v108
 v_add_f32 v93, v93, v109
 v_mfma_f32_16x16x32_bf16 v[172:175], a[124:127], v[40:43], v[172:175]
 v_add_f32 v94, v94, v110
 v_add_f32 v95, v95, v111
 v_mfma_f32_16x16x32_bf16 v[204:207], a[124:127], v[44:47], v[204:207]
 s_waitcnt lgkmcnt(4)
 v_mfma_f32_16x16x32_bf16 v[188:191], a[120:123], v[44:47], v[188:191]
 v_add_f32 v80, v80, v112
 v_add_f32 v81, v81, v113
 s_waitcnt vmcnt(15)
 v_mfma_f32_16x16x32_bf16 v[144:147], a[128:131], v[48:51], v[144:147]
 v_add_f32 v82, v82, v114
 v_add_f32 v83, v83, v115
 v_mfma_f32_16x16x32_bf16 v[160:163], a[132:135], v[48:51], v[160:163]
 v_add_f32 v84, v84, v116
 v_add_f32 v85, v85, v117
 v_mfma_f32_16x16x32_bf16 v[192:195], a[132:135], v[52:55], v[192:195]
 v_add_f32 v86, v86, v118
 v_add_f32 v87, v87, v119
 v_mfma_f32_16x16x32_bf16 v[176:179], a[128:131], v[52:55], v[176:179]
 v_add_f32 v88, v88, v120
 v_add_f32 v89, v89, v121
 v_mfma_f32_16x16x32_bf16 v[148:151], a[136:139], v[48:51], v[148:151]
 v_add_f32 v90, v90, v122
 v_add_f32 v91, v91, v123
 v_mfma_f32_16x16x32_bf16 v[164:167], a[140:143], v[48:51], v[164:167]
 s_waitcnt vmcnt(9)
 s_sub_u32 s69, s63, 1
 s_max_i32 s69, s69, 0
 v_mov_b32 v3, s69
 v_mov_b32 v4, 0
 s_mov_b64 exec, 1
 buffer_store_dword v3, v4, s[48:51], s68 offen sc1
 s_mov_b64 exec, -1
 v_mfma_f32_16x16x32_bf16 v[196:199], a[140:143], v[52:55], v[196:199]
 v_add_f32 v92, v92, v124
 v_add_f32 v93, v93, v125
 v_mfma_f32_16x16x32_bf16 v[180:183], a[136:139], v[52:55], v[180:183]
 v_add_f32 v94, v94, v126
 v_add_f32 v95, v95, v127
 v_mfma_f32_16x16x32_bf16 v[152:155], a[144:147], v[48:51], v[152:155]
 s_waitcnt lgkmcnt(0)
 v_mfma_f32_16x16x32_bf16 v[168:171], a[148:151], v[48:51], v[168:171]
 v_add_f32 v80, v80, v128
 v_add_f32 v81, v81, v129
 v_mfma_f32_16x16x32_bf16 v[200:203], a[148:151], v[52:55], v[200:203]
 v_add_f32 v82, v82, v130
 v_add_f32 v83, v83, v131
 v_mfma_f32_16x16x32_bf16 v[184:187], a[144:147], v[52:55], v[184:187]
 v_add_f32 v84, v84, v132
 v_add_f32 v85, v85, v133
 v_mfma_f32_16x16x32_bf16 v[156:159], a[152:155], v[48:51], v[156:159]
 v_add_f32 v86, v86, v134
 v_add_f32 v87, v87, v135
 v_mfma_f32_16x16x32_bf16 v[172:175], a[156:159], v[48:51], v[172:175]
 v_add_f32 v88, v88, v136
 v_add_f32 v89, v89, v137
 v_mfma_f32_16x16x32_bf16 v[204:207], a[156:159], v[52:55], v[204:207]
 v_add_f32 v90, v90, v138
 v_add_f32 v91, v91, v139
 v_mfma_f32_16x16x32_bf16 v[188:191], a[152:155], v[52:55], v[188:191]
 v_add_f32 v92, v92, v140
 v_add_f32 v93, v93, v141
 v_mfma_f32_16x16x32_bf16 v[144:147], a[160:163], v[56:59], v[144:147]
 v_add_f32 v94, v94, v142
 v_add_f32 v95, v95, v143
 v_mfma_f32_16x16x32_bf16 v[160:163], a[164:167], v[56:59], v[160:163]
 s_sub_u32 s77, s63, 1
 s_and_b32 s69, s77, 2
 v_mfma_f32_16x16x32_bf16 v[192:195], a[164:167], v[60:63], v[192:195]
 s_lshl_b32 s69, s69, 12
 s_xor_b32 s69, s69, s76
 v_mfma_f32_16x16x32_bf16 v[176:179], a[160:163], v[60:63], v[176:179]
 s_and_b32 s78, s77, 15
 s_lshl_b32 s78, s78, 20
 v_mfma_f32_16x16x32_bf16 v[148:151], a[168:171], v[56:59], v[148:151]
 s_add_u32 s78, s78, s69
 v_mfma_f32_16x16x32_bf16 v[164:167], a[172:175], v[56:59], v[164:167]
 buffer_store_dwordx4 v[84:87], v244, s[48:51], s78 offen sc1
 v_mfma_f32_16x16x32_bf16 v[196:199], a[172:175], v[60:63], v[196:199]
 buffer_store_dwordx4 v[88:91], v245, s[48:51], s78 offen sc1
 v_mfma_f32_16x16x32_bf16 v[180:183], a[168:171], v[60:63], v[180:183]
 buffer_store_dwordx4 v[92:95], v246, s[48:51], s78 offen sc1
 v_mfma_f32_16x16x32_bf16 v[152:155], a[176:179], v[56:59], v[152:155]
 s_waitcnt vmcnt(6)
 v_mfma_f32_16x16x32_bf16 v[168:171], a[180:183], v[56:59], v[168:171]
 v_add_f32 v228, v228, v232
 v_add_f32 v229, v229, v233
 v_mfma_f32_16x16x32_bf16 v[200:203], a[180:183], v[60:63], v[200:203]
 v_add_f32 v230, v230, v234
 v_add_f32 v231, v231, v235
 v_mfma_f32_16x16x32_bf16 v[184:187], a[176:179], v[60:63], v[184:187]
 v_add_f32 v228, v228, v236
 v_add_f32 v229, v229, v237
 v_mfma_f32_16x16x32_bf16 v[156:159], a[184:187], v[56:59], v[156:159]
 v_add_f32 v230, v230, v238
 v_add_f32 v231, v231, v239
 v_mfma_f32_16x16x32_bf16 v[172:175], a[188:191], v[56:59], v[172:175]
 v_add_f32 v228, v228, v240
 v_add_f32 v229, v229, v241
 v_mfma_f32_16x16x32_bf16 v[204:207], a[188:191], v[60:63], v[204:207]
 v_add_f32 v230, v230, v242
 v_add_f32 v231, v231, v243
 v_mfma_f32_16x16x32_bf16 v[188:191], a[184:187], v[60:63], v[188:191]
 s_sub_u32 s77, s63, 7
 s_cselect_b32 s77, 64, s77
 s_lshl_b32 s69, s77, 17
 v_mfma_f32_16x16x32_bf16 v[144:147], a[192:195], v[64:67], v[144:147]
 s_add_u32 s69, s69, s67
 v_cvt_pk_bf16_f32 v14, v228, v229
 v_mfma_f32_16x16x32_bf16 v[160:163], a[196:199], v[64:67], v[160:163]
 v_cvt_pk_bf16_f32 v15, v230, v231
 v_mfma_f32_16x16x32_bf16 v[192:195], a[196:199], v[68:71], v[192:195]
 buffer_store_dwordx2 v[14:15], v250, s[56:59], s69 offen
 v_mfma_f32_16x16x32_bf16 v[176:179], a[192:195], v[68:71], v[176:179]
 v_mov_b64 v[228:229], v[220:221]
 v_mov_b64 v[230:231], v[222:223]
 v_mfma_f32_16x16x32_bf16 v[148:151], a[200:203], v[64:67], v[148:151]
 v_mov_b64 v[220:221], v[212:213]
 v_mov_b64 v[222:223], v[214:215]
 v_mfma_f32_16x16x32_bf16 v[164:167], a[204:207], v[64:67], v[164:167]
 v_mov_b64 v[212:213], v[80:81]
 v_mov_b64 v[214:215], v[82:83]
 v_mfma_f32_16x16x32_bf16 v[196:199], a[204:207], v[68:71], v[196:199]
 v_mfma_f32_16x16x32_bf16 v[180:183], a[200:203], v[68:71], v[180:183]
 v_mfma_f32_16x16x32_bf16 v[152:155], a[208:211], v[64:67], v[152:155]
 v_mfma_f32_16x16x32_bf16 v[168:171], a[212:215], v[64:67], v[168:171]
 v_mfma_f32_16x16x32_bf16 v[200:203], a[212:215], v[68:71], v[200:203]
 v_mfma_f32_16x16x32_bf16 v[184:187], a[208:211], v[68:71], v[184:187]
 v_mfma_f32_16x16x32_bf16 v[156:159], a[216:219], v[64:67], v[156:159]
 v_mfma_f32_16x16x32_bf16 v[172:175], a[220:223], v[64:67], v[172:175]
 v_mfma_f32_16x16x32_bf16 v[204:207], a[220:223], v[68:71], v[204:207]
 v_mfma_f32_16x16x32_bf16 v[188:191], a[216:219], v[68:71], v[188:191]
 v_mfma_f32_16x16x32_bf16 v[144:147], a[224:227], v[72:75], v[144:147]
 v_mfma_f32_16x16x32_bf16 v[160:163], a[228:231], v[72:75], v[160:163]
 v_mfma_f32_16x16x32_bf16 v[192:195], a[228:231], v[76:79], v[192:195]
 v_mfma_f32_16x16x32_bf16 v[176:179], a[224:227], v[76:79], v[176:179]
 v_mfma_f32_16x16x32_bf16 v[148:151], a[232:235], v[72:75], v[148:151]
 v_mfma_f32_16x16x32_bf16 v[164:167], a[236:239], v[72:75], v[164:167]
 v_mfma_f32_16x16x32_bf16 v[196:199], a[236:239], v[76:79], v[196:199]
 v_mfma_f32_16x16x32_bf16 v[180:183], a[232:235], v[76:79], v[180:183]
 v_mfma_f32_16x16x32_bf16 v[152:155], a[240:243], v[72:75], v[152:155]
 v_mfma_f32_16x16x32_bf16 v[168:171], a[244:247], v[72:75], v[168:171]
 v_mfma_f32_16x16x32_bf16 v[200:203], a[244:247], v[76:79], v[200:203]
 v_mfma_f32_16x16x32_bf16 v[184:187], a[240:243], v[76:79], v[184:187]
 v_mfma_f32_16x16x32_bf16 v[156:159], a[248:251], v[72:75], v[156:159]
 v_mfma_f32_16x16x32_bf16 v[172:175], a[252:255], v[72:75], v[172:175]
 v_mfma_f32_16x16x32_bf16 v[204:207], a[252:255], v[76:79], v[204:207]
 v_mfma_f32_16x16x32_bf16 v[188:191], a[248:251], v[76:79], v[188:191]
 s_waitcnt vmcnt(5)
 s_mov_b32 s73, 0
nxt_42:
 s_add_u32 s63, s63, 1
 s_cmp_lt_u32 s63, 64
 s_cbranch_scc1 Lw_Oloop
 ds_write_b128 v7, v[160:163] offset:49152
 ds_write_b128 v7, v[164:167] offset:50176
 ds_write_b128 v7, v[168:171] offset:51200
 ds_write_b128 v7, v[172:175] offset:52224
 ds_write_b128 v8, v[176:179] offset:49152
 ds_write_b128 v8, v[180:183] offset:50176
 ds_write_b128 v8, v[184:187] offset:51200
 ds_write_b128 v8, v[188:191] offset:52224
 ds_write_b128 v9, v[192:195] offset:49152
 ds_write_b128 v9, v[196:199] offset:50176
 ds_write_b128 v9, v[200:203] offset:51200
 ds_write_b128 v9, v[204:207] offset:52224
 s_waitcnt lgkmcnt(0)
 s_barrier
 ds_read_b128 v[160:163], v10 offset:49152
 ds_read_b128 v[164:167], v10 offset:50176
 ds_read_b128 v[168:171], v10 offset:51200
 ds_read_b128 v[172:175], v10 offset:52224
 ds_read_b128 v[176:179], v10 offset:53248
 ds_read_b128 v[180:183], v10 offset:54272
 ds_read_b128 v[184:187], v10 offset:55296
 ds_read_b128 v[188:191], v10 offset:56320
 ds_read_b128 v[192:195], v10 offset:57344
 ds_read_b128 v[196:199], v10 offset:58368
 ds_read_b128 v[200:203], v10 offset:59392
 ds_read_b128 v[204:207], v10 offset:60416
 s_waitcnt lgkmcnt(8)
 v_add_f32 v144, v144, v160
 v_add_f32 v145, v145, v161
 v_add_f32 v146, v146, v162
 v_add_f32 v147, v147, v163
 v_add_f32 v148, v148, v164
 v_add_f32 v149, v149, v165
 v_add_f32 v150, v150, v166
 v_add_f32 v151, v151, v167
 v_add_f32 v152, v152, v168
 v_add_f32 v153, v153, v169
 v_add_f32 v154, v154, v170
 v_add_f32 v155, v155, v171
 v_add_f32 v156, v156, v172
 v_add_f32 v157, v157, v173
 v_add_f32 v158, v158, v174
 v_add_f32 v159, v159, v175
 s_waitcnt lgkmcnt(4)
 v_add_f32 v144, v144, v176
 v_add_f32 v145, v145, v177
 v_add_f32 v146, v146, v178
 v_add_f32 v147, v147, v179
 v_add_f32 v148, v148, v180
 v_add_f32 v149, v149, v181
 v_add_f32 v150, v150, v182
 v_add_f32 v151, v151, v183
 v_add_f32 v152, v152, v184
 v_add_f32 v153, v153, v185
 v_add_f32 v154, v154, v186
 v_add_f32 v155, v155, v187
 v_add_f32 v156, v156, v188
 v_add_f32 v157, v157, v189
 v_add_f32 v158, v158, v190
 v_add_f32 v159, v159, v191
 s_waitcnt lgkmcnt(0)
 v_add_f32 v144, v144, v192
 v_add_f32 v145, v145, v193
 v_add_f32 v146, v146, v194
 v_add_f32 v147, v147, v195
 v_add_f32 v148, v148, v196
 v_add_f32 v149, v149, v197
 v_add_f32 v150, v150, v198
 v_add_f32 v151, v151, v199
 v_add_f32 v152, v152, v200
 v_add_f32 v153, v153, v201
 v_add_f32 v154, v154, v202
 v_add_f32 v155, v155, v203
 v_add_f32 v156, v156, v204
 v_add_f32 v157, v157, v205
 v_add_f32 v158, v158, v206
 v_add_f32 v159, v159, v207
 s_sub_u32 s77, s63, 1
 s_and_b32 s69, s77, 2
 s_lshl_b32 s69, s69, 12
 s_xor_b32 s69, s69, s76
 s_and_b32 s78, s77, 15
 s_lshl_b32 s78, s78, 20
 s_add_u32 s78, s78, s69
 buffer_store_dwordx4 v[148:151], v244, s[48:51], s78 offen sc1
 buffer_store_dwordx4 v[152:155], v245, s[48:51], s78 offen sc1
 buffer_store_dwordx4 v[156:159], v246, s[48:51], s78 offen sc1
 s_waitcnt vmcnt(0)
 v_mov_b32 v3, 64
 v_mov_b32 v4, 0
 s_mov_b64 exec, 1
 buffer_store_dword v3, v4, s[48:51], s68 offen sc1
 s_mov_b64 exec, -1
 s_sub_u32 s70, s63, 0
 s_mov_b64 exec, 15
w_60:
 buffer_load_dword v4, v11, s[48:51], s75 offen sc1
 s_waitcnt vmcnt(0)
 v_cmp_gt_u32 vcc, s70, v4
 s_cbranch_vccz wok_61
 s_sleep 2
 s_sub_u32 s46, s46, 1
 s_cbranch_scc0 w_60
 s_mov_b32 s46, 0
 s_branch wok_61
wok_61:
 s_mov_b64 exec, -1
finok_59:
 s_sub_u32 s77, s63, 1
 s_and_b32 s69, s77, 2
 s_lshl_b32 s69, s69, 12
 s_xor_b32 s69, s69, s76
 s_and_b32 s78, s77, 15
 s_lshl_b32 s78, s78, 20
 s_add_u32 s78, s78, s69
 buffer_load_dwordx4 v[28:31], v247, s[48:51], s78 offen sc1
 buffer_load_dwordx4 v[32:35], v248, s[48:51], s78 offen sc1
 buffer_load_dwordx4 v[36:39], v249, s[48:51], s78 offen sc1
 s_sub_u32 s70, s63, 1
finok_62:
 s_sub_u32 s77, s63, 2
 s_and_b32 s69, s77, 2
 s_lshl_b32 s69, s69, 12
 s_xor_b32 s69, s69, s76
 s_and_b32 s78, s77, 15
 s_lshl_b32 s78, s78, 20
 s_add_u32 s78, s78, s69
 buffer_load_dwordx4 v[40:43], v247, s[48:51], s78 offen sc1
 buffer_load_dwordx4 v[44:47], v248, s[48:51], s78 offen sc1
 buffer_load_dwordx4 v[48:51], v249, s[48:51], s78 offen sc1
 s_sub_u32 s70, s63, 2
finok_63:
 s_sub_u32 s77, s63, 3
 s_and_b32 s69, s77, 2
 s_lshl_b32 s69, s69, 12
 s_xor_b32 s69, s69, s76
 s_and_b32 s78, s77, 15
 s_lshl_b32 s78, s78, 20
 s_add_u32 s78, s78, s69
 buffer_load_dwordx4 v[52:55], v247, s[48:51], s78 offen sc1
 buffer_load_dwordx4 v[56:59], v248, s[48:51], s78 offen sc1
 buffer_load_dwordx4 v[60:63], v249, s[48:51], s78 offen sc1
 s_sub_u32 s70, s63, 3
finok_64:
 s_sub_u32 s77, s63, 4
 s_and_b32 s69, s77, 2
 s_lshl_b32 s69, s69, 12
 s_xor_b32 s69, s69, s76
 s_and_b32 s78, s77, 15
 s_lshl_b32 s78, s78, 20
 s_add_u32 s78, s78, s69
 buffer_load_dwordx4 v[64:67], v247, s[48:51], s78 offen sc1
 buffer_load_dwordx4 v[68:71], v248, s[48:51], s78 offen sc1
 buffer_load_dwordx4 v[72:75], v249, s[48:51], s78 offen sc1
 s_sub_u32 s70, s63, 4
finok_65:
 s_sub_u32 s77, s63, 5
 s_and_b32 s69, s77, 2
 s_lshl_b32 s69, s69, 12
 s_xor_b32 s69, s69, s76
 s_and_b32 s78, s77, 15
 s_lshl_b32 s78, s78, 20
 s_add_u32 s78, s78, s69
 buffer_load_dwordx4 v[76:79], v247, s[48:51], s78 offen sc1
 buffer_load_dwordx4 v[80:83], v248, s[48:51], s78 offen sc1
 buffer_load_dwordx4 v[84:87], v249, s[48:51], s78 offen sc1
 s_sub_u32 s70, s63, 5
finok_66:
 s_sub_u32 s77, s63, 6
 s_and_b32 s69, s77, 2
 s_lshl_b32 s69, s69, 12
 s_xor_b32 s69, s69, s76
 s_and_b32 s78, s77, 15
 s_lshl_b32 s78, s78, 20
 s_add_u32 s78, s78, s69
 buffer_load_dwordx4 v[88:91], v247, s[48:51], s78 offen sc1
 buffer_load_dwordx4 v[92:95], v248, s[48:51], s78 offen sc1
 buffer_load_dwordx4 v[96:99], v249, s[48:51], s78 offen sc1
 s_sub_u32 s70, s63, 6
finok_67:
 s_sub_u32 s77, s63, 7
 s_and_b32 s69, s77, 2
 s_lshl_b32 s69, s69, 12
 s_xor_b32 s69, s69, s76
 s_and_b32 s78, s77, 15
 s_lshl_b32 s78, s78, 20
 s_add_u32 s78, s78, s69
 buffer_load_dwordx4 v[100:103], v247, s[48:51], s78 offen sc1
 buffer_load_dwordx4 v[104:107], v248, s[48:51], s78 offen sc1
 buffer_load_dwordx4 v[108:111], v249, s[48:51], s78 offen sc1
 s_waitcnt vmcnt(18)
 v_add_f32 v144, v144, v28
 v_add_f32 v145, v145, v29
 v_add_f32 v146, v146, v30
 v_add_f32 v147, v147, v31
 v_add_f32 v144, v144, v32
 v_add_f32 v145, v145, v33
 v_add_f32 v146, v146, v34
 v_add_f32 v147, v147, v35
 v_add_f32 v144, v144, v36
 v_add_f32 v145, v145, v37
 v_add_f32 v146, v146, v38
 v_add_f32 v147, v147, v39
 s_sub_u32 s77, s63, 1
 s_cselect_b32 s77, 64, s77
 s_lshl_b32 s69, s77, 17
 s_add_u32 s69, s69, s67
 v_cvt_pk_bf16_f32 v234, v144, v145
 v_cvt_pk_bf16_f32 v235, v146, v147
 buffer_store_dwordx2 v[234:235], v250, s[56:59], s69 offen
 s_waitcnt vmcnt(16)
 v_add_f32 v212, v212, v40
 v_add_f32 v213, v213, v41
 v_add_f32 v214, v214, v42
 v_add_f32 v215, v215, v43
 v_add_f32 v212, v212, v44
 v_add_f32 v213, v213, v45
 v_add_f32 v214, v214, v46
 v_add_f32 v215, v215, v47
 v_add_f32 v212, v212, v48
 v_add_f32 v213, v213, v49
 v_add_f32 v214, v214, v50
 v_add_f32 v215, v215, v51
 s_sub_u32 s77, s63, 2
 s_cselect_b32 s77, 64, s77
 s_lshl_b32 s69, s77, 17
 s_add_u32 s69, s69, s67
 v_cvt_pk_bf16_f32 v236, v212, v213
 v_cvt_pk_bf16_f32 v237, v214, v215
 buffer_store_dwordx2 v[236:237], v250, s[56:59], s69 offen
 s_waitcnt vmcnt(14)
 v_add_f32 v208, v208, v52
 v_add_f32 v209, v209, v53
 v_add_f32 v210, v210, v54
 v_add_f32 v211, v211, v55
 v_add_f32 v208, v208, v56
 v_add_f32 v209, v209, v57
 v_add_f32 v210, v210, v58
 v_add_f32 v211, v211, v59
 v_add_f32 v208, v208, v60
 v_add_f32 v209, v209, v61
 v_add_f32 v210, v210, v62
 v_add_f32 v211, v211, v63
 s_sub_u32 s77, s63, 3
 s_cselect_b32 s77, 64, s77
 s_lshl_b32 s69, s77, 17
 s_add_u32 s69, s69, s67
 v_cvt_pk_bf16_f32 v238, v208, v209
 v_cvt_pk_bf16_f32 v239, v210, v211
 buffer_store_dwordx2 v[238:239], v250, s[56:59], s69 offen
 s_waitcnt vmcnt(12)
 v_add_f32 v220, v220, v64
 v_add_f32 v221, v221, v65
 v_add_f32 v222, v222, v66
 v_add_f32 v223, v223, v67
 v_add_f32 v220, v220, v68
 v_add_f32 v221, v221, v69
 v_add_f32 v222, v222, v70
 v_add_f32 v223, v223, v71
 v_add_f32 v220, v220, v72
 v_add_f32 v221, v221, v73
 v_add_f32 v222, v222, v74
 v_add_f32 v223, v223, v75
 s_sub_u32 s77, s63, 4
 s_cselect_b32 s77, 64, s77
 s_lshl_b32 s69, s77, 17
 s_add_u32 s69, s69, s67
 v_cvt_pk_bf16_f32 v232, v220, v221
 v_cvt_pk_bf16_f32 v233, v222, v223
 buffer_store_dwordx2 v[232:233], v250, s[56:59], s69 offen
 s_waitcnt vmcnt(10)
 v_add_f32 v216, v216, v76
 v_add_f32 v217, v217, v77
 v_add_f32 v218, v218, v78
 v_add_f32 v219, v219, v79
 v_add_f32 v216, v216, v80
 v_add_f32 v217, v217, v81
 v_add_f32 v218, v218, v82
 v_add_f32 v219, v219, v83
 v_add_f32 v216, v216, v84
 v_add_f32 v217, v217, v85
 v_add_f32 v218, v218, v86
 v_add_f32 v219, v219, v87
 s_sub_u32 s77, s63, 5
 s_cselect_b32 s77, 64, s77
 s_lshl_b32 s69, s77, 17
 s_add_u32 s69, s69, s67
 v_cvt_pk_bf16_f32 v234, v216, v217
 v_cvt_pk_bf16_f32 v235, v218, v219
 buffer_store_dwordx2 v[234:235], v250, s[56:59], s69 offen
 s_waitcnt vmcnt(8)
 v_add_f32 v228, v228, v88
 v_add_f32 v229, v229, v89
 v_add_f32 v230, v230, v90
 v_add_f32 v231, v231, v91
 v_add_f32 v228, v228, v92
 v_add_f32 v229, v229, v93
 v_add_f32 v230, v230, v94
 v_add_f32 v231, v231, v95
 v_add_f32 v228, v228, v96
 v_add_f32 v229, v229, v97
 v_add_f32 v230, v230, v98
 v_add_f32 v231, v231, v99
 s_sub_u32 s77, s63, 6
 s_cselect_b32 s77, 64, s77
 s_lshl_b32 s69, s77, 17
 s_add_u32 s69, s69, s67
 v_cvt_pk_bf16_f32 v236, v228, v229
 v_cvt_pk_bf16_f32 v237, v230, v231
 buffer_store_dwordx2 v[236:237], v250, s[56:59], s69 offen
 s_waitcnt vmcnt(6)
 v_add_f32 v224, v224, v100
 v_add_f32 v225, v225, v101
 v_add_f32 v226, v226, v102
 v_add_f32 v227, v227, v103
 v_add_f32 v224, v224, v104
 v_add_f32 v225, v225, v105
 v_add_f32 v226, v226, v106
 v_add_f32 v227, v227, v107
 v_add_f32 v224, v224, v108
 v_add_f32 v225, v225, v109
 v_add_f32 v226, v226, v110
 v_add_f32 v227, v227, v111
 s_sub_u32 s77, s63, 7
 s_cselect_b32 s77, 64, s77
 s_lshl_b32 s69, s77, 17
 s_add_u32 s69, s69, s67
 v_cvt_pk_bf16_f32 v238, v224, v225
 v_cvt_pk_bf16_f32 v239, v226, v227
 buffer_store_dwordx2 v[238:239], v250, s[56:59], s69 offen
 s_branch Lw_end
Lw_Q:
 s_lshl_b32 s69, s4, 11
 s_add_u32 s69, s69, 49152
 v_add_u32 v235, s69, v6
 v_add_u32 v236, 32768, v235
 s_lshl_b32 s69, s4, 13
 s_add_u32 s69, s69, 81920
 v_add_u32 v237, s69, v1
 v_add_u32 v238, 32768, v237
 v_lshrrev_b32 v3, 5, v0
 v_and_b32 v4, 7, v0
 v_lshlrev_b32 v4, 4, v4
 v_lshl_add_u32 v232, v3, 8, v4
 s_lshl_b32 s69, s4, 12
 s_add_u32 s69, s69, 147456
 v_add_u32 v232, 128, v232
 v_add_u32 v232, s69, v232
 v_lshl_add_u32 v233, v3, 9, v4
 v_add_u32 v233, s69, v233
 v_bfe_u32 v4, v0, 3, 2
 v_lshl_add_u32 v233, v4, 2, v233
 v_bfe_u32 v4, v0, 1, 2
 v_and_b32 v234, 1, v0
 v_lshlrev_b32 v234, 2, v234
 v_lshl_add_u32 v234, v4, 4, v234
 v_and_b32 v4, 31, v0
 v_lshlrev_b32 v3, 2, v3
 v_sub_u32 v4, v4, v3
 s_add_u32 s82, s65, 0
 buffer_load_dwordx4 v[16:19], v2, s[48:51], s82 offen offset:0 sc1
 buffer_load_dwordx4 v[20:23], v2, s[48:51], s82 offen offset:256 sc1
 buffer_load_dwordx4 v[24:27], v2, s[48:51], s82 offen offset:2048 sc1
 buffer_load_dwordx4 v[28:31], v2, s[48:51], s82 offen offset:2304 sc1
 s_add_u32 s82, s65, 4096
 buffer_load_dwordx4 v[32:35], v2, s[48:51], s82 offen offset:0 sc1
 buffer_load_dwordx4 v[36:39], v2, s[48:51], s82 offen offset:256 sc1
 buffer_load_dwordx4 v[40:43], v2, s[48:51], s82 offen offset:2048 sc1
 buffer_load_dwordx4 v[44:47], v2, s[48:51], s82 offen offset:2304 sc1
 s_add_u32 s82, s65, 8192
 buffer_load_dwordx4 v[48:51], v2, s[48:51], s82 offen offset:0 sc1
 buffer_load_dwordx4 v[52:55], v2, s[48:51], s82 offen offset:256 sc1
 buffer_load_dwordx4 v[56:59], v2, s[48:51], s82 offen offset:2048 sc1
 buffer_load_dwordx4 v[60:63], v2, s[48:51], s82 offen offset:2304 sc1
 s_add_u32 s82, s65, 12288
 buffer_load_dwordx4 v[64:67], v2, s[48:51], s82 offen offset:0 sc1
 buffer_load_dwordx4 v[68:71], v2, s[48:51], s82 offen offset:256 sc1
 buffer_load_dwordx4 v[72:75], v2, s[48:51], s82 offen offset:2048 sc1
 buffer_load_dwordx4 v[76:79], v2, s[48:51], s82 offen offset:2304 sc1
 v_cmp_le_i32 s[8:9], 0, v4
 v_cmp_le_i32 s[10:11], 1, v4
 v_cmp_le_i32 s[12:13], 2, v4
 v_cmp_le_i32 s[14:15], 3, v4
 v_cmp_le_i32 s[16:17], 8, v4
 v_cmp_le_i32 s[18:19], 9, v4
 v_cmp_le_i32 s[20:21], 10, v4
 v_cmp_le_i32 s[22:23], 11, v4
 v_cmp_le_i32 s[24:25], 16, v4
 v_cmp_le_i32 s[26:27], 17, v4
 v_cmp_le_i32 s[28:29], 18, v4
 v_cmp_le_i32 s[30:31], 19, v4
 v_cmp_le_i32 s[32:33], 24, v4
 v_cmp_le_i32 s[34:35], 25, v4
 v_cmp_le_i32 s[36:37], 26, v4
 v_cmp_le_i32 s[38:39], 27, v4
 s_add_u32 s65, s65, 0x10000
 s_lshl_b32 s77, s62, 7
 s_add_u32 s77, s77, 3145728
 s_sub_u32 s74, s4, 4
 s_mov_b32 s76, 0
 s_mov_b32 s72, -1
 s_mov_b32 s73, 32768
 s_mov_b32 s75, -1
 s_mov_b32 s78, 0
 s_mov_b32 s67, 268435456
 s_waitcnt vmcnt(0)
 s_branch Lw_Qproj
Lw_Qloop:
 s_add_u32 s74, s74, 4
 s_add_u32 s75, s74, 1
 s_lshl_b32 s67, s74, 18
 s_and_b32 s69, s74, 8
 s_lshl_b32 s69, s69, 10
 s_xor_b32 s78, s66, s69
 s_add_u32 s78, s78, s67
 s_lshl_b32 s69, s62, 13
 s_add_u32 s67, s67, s69
 s_cmp_ge_u32 s76, s75
 s_cbranch_scc1 kvok_68
 s_mov_b64 exec, 255
w_69:
 buffer_load_dword v4, v234, s[48:51], s77 offen sc1
 s_waitcnt vmcnt(0)
 v_cmp_gt_u32 vcc, s75, v4
 s_cbranch_vccz wok_70
 s_sleep 2
 s_sub_u32 s46, s46, 1
 s_cbranch_scc0 w_69
 s_mov_b32 s46, 0
 s_branch wok_70
wok_70:
 s_mov_b64 exec, -1
 v_readlane_b32 s76, v4, 0
 v_readlane_b32 s69, v4, 1
 s_nop 0
 s_min_u32 s76, s76, s69
 v_readlane_b32 s69, v4, 2
 s_nop 0
 s_min_u32 s76, s76, s69
 v_readlane_b32 s69, v4, 3
 s_nop 0
 s_min_u32 s76, s76, s69
 v_readlane_b32 s69, v4, 4
 s_nop 0
 s_min_u32 s76, s76, s69
 v_readlane_b32 s69, v4, 5
 s_nop 0
 s_min_u32 s76, s76, s69
 v_readlane_b32 s69, v4, 6
 s_nop 0
 s_min_u32 s76, s76, s69
 v_readlane_b32 s69, v4, 7
 s_nop 0
 s_min_u32 s76, s76, s69
kvok_68:
 s_cmp_eq_u32 s72, 15
 s_cbranch_scc0 Lw_Qproj
 s_waitcnt vmcnt(0)
 v_mov_b32 v3, s72
 v_mov_b32 v4, 0
 s_mov_b64 exec, 1
 buffer_store_dword v3, v4, s[48:51], s68 offen
 s_mov_b64 exec, -1
 s_add_u32 s82, s67, 16777216
 buffer_load_dwordx4 v[16:19], v1, s[48:51], s82 offen offset:0 sc1
 buffer_load_dwordx4 v[20:23], v1, s[48:51], s82 offen offset:1024 sc1
 buffer_load_dwordx4 v[24:27], v1, s[48:51], s82 offen offset:2048 sc1
 buffer_load_dwordx4 v[28:31], v1, s[48:51], s82 offen offset:3072 sc1
 s_add_u32 s82, s67, 16781312
 buffer_load_dwordx4 v[32:35], v1, s[48:51], s82 offen offset:0 sc1
 buffer_load_dwordx4 v[36:39], v1, s[48:51], s82 offen offset:1024 sc1
 buffer_load_dwordx4 v[40:43], v1, s[48:51], s82 offen offset:2048 sc1
 buffer_load_dwordx4 v[44:47], v1, s[48:51], s82 offen offset:3072 sc1
 s_lshl_b32 s69, s4, 13
 s_add_u32 m0, s69, 114688
 s_add_u32 s69, s67, 33554432
 buffer_load_dwordx4 v1, s[48:51], s69 offen offset:0 sc1 lds
 s_lshl_b32 s69, s4, 13
 s_add_u32 m0, s69, 114688
 s_add_u32 s69, s67, 33554432
 buffer_load_dwordx4 v1, s[48:51], s69 offen offset:1024 sc1 lds
 s_lshl_b32 s69, s4, 13
 s_add_u32 m0, s69, 114688
 s_add_u32 s69, s67, 33554432
 buffer_load_dwordx4 v1, s[48:51], s69 offen offset:2048 sc1 lds
 s_lshl_b32 s69, s4, 13
 s_add_u32 m0, s69, 114688
 s_add_u32 s69, s67, 33554432
 buffer_load_dwordx4 v1, s[48:51], s69 offen offset:3072 sc1 lds
 s_lshl_b32 s69, s4, 13
 s_add_u32 m0, s69, 118784
 s_add_u32 s69, s67, 33558528
 buffer_load_dwordx4 v1, s[48:51], s69 offen offset:0 sc1 lds
 s_lshl_b32 s69, s4, 13
 s_add_u32 m0, s69, 118784
 s_add_u32 s69, s67, 33558528
 buffer_load_dwordx4 v1, s[48:51], s69 offen offset:1024 sc1 lds
 s_lshl_b32 s69, s4, 13
 s_add_u32 m0, s69, 118784
 s_add_u32 s69, s67, 33558528
 buffer_load_dwordx4 v1, s[48:51], s69 offen offset:2048 sc1 lds
 s_lshl_b32 s69, s4, 13
 s_add_u32 m0, s69, 118784
 s_add_u32 s69, s67, 33558528
 buffer_load_dwordx4 v1, s[48:51], s69 offen offset:3072 sc1 lds
 ds_write_b128 v7, v[160:163] offset:0
 ds_write_b128 v7, v[164:167] offset:1024
 ds_write_b128 v7, v[168:171] offset:2048
 ds_write_b128 v7, v[172:175] offset:3072
 ds_write_b128 v8, v[176:179] offset:0
 ds_write_b128 v8, v[180:183] offset:1024
 ds_write_b128 v8, v[184:187] offset:2048
 ds_write_b128 v8, v[188:191] offset:3072
 ds_write_b128 v9, v[192:195] offset:0
 ds_write_b128 v9, v[196:199] offset:1024
 ds_write_b128 v9, v[200:203] offset:2048
 ds_write_b128 v9, v[204:207] offset:3072
 s_waitcnt lgkmcnt(0)
 s_barrier
 ds_read_b128 v[160:163], v10 offset:0
 ds_read_b128 v[164:167], v10 offset:1024
 ds_read_b128 v[168:171], v10 offset:2048
 ds_read_b128 v[172:175], v10 offset:3072
 ds_read_b128 v[176:179], v10 offset:4096
 ds_read_b128 v[180:183], v10 offset:5120
 ds_read_b128 v[184:187], v10 offset:6144
 ds_read_b128 v[188:191], v10 offset:7168
 ds_read_b128 v[192:195], v10 offset:8192
 ds_read_b128 v[196:199], v10 offset:9216
 ds_read_b128 v[200:203], v10 offset:10240
 ds_read_b128 v[204:207], v10 offset:11264
 s_waitcnt lgkmcnt(8)
 v_add_f32 v144, v144, v160
 v_add_f32 v145, v145, v161
 v_add_f32 v146, v146, v162
 v_add_f32 v147, v147, v163
 v_add_f32 v148, v148, v164
 v_add_f32 v149, v149, v165
 v_add_f32 v150, v150, v166
 v_add_f32 v151, v151, v167
 v_add_f32 v152, v152, v168
 v_add_f32 v153, v153, v169
 v_add_f32 v154, v154, v170
 v_add_f32 v155, v155, v171
 v_add_f32 v156, v156, v172
 v_add_f32 v157, v157, v173
 v_add_f32 v158, v158, v174
 v_add_f32 v159, v159, v175
 s_waitcnt lgkmcnt(4)
 v_add_f32 v144, v144, v176
 v_add_f32 v145, v145, v177
 v_add_f32 v146, v146, v178
 v_add_f32 v147, v147, v179
 v_add_f32 v148, v148, v180
 v_add_f32 v149, v149, v181
 v_add_f32 v150, v150, v182
 v_add_f32 v151, v151, v183
 v_add_f32 v152, v152, v184
 v_add_f32 v153, v153, v185
 v_add_f32 v154, v154, v186
 v_add_f32 v155, v155, v187
 v_add_f32 v156, v156, v188
 v_add_f32 v157, v157, v189
 v_add_f32 v158, v158, v190
 v_add_f32 v159, v159, v191
 s_waitcnt lgkmcnt(0)
 s_barrier
 v_add_f32 v144, v144, v192
 v_add_f32 v145, v145, v193
 v_add_f32 v146, v146, v194
 v_add_f32 v147, v147, v195
 v_add_f32 v148, v148, v196
 v_add_f32 v149, v149, v197
 v_add_f32 v150, v150, v198
 v_add_f32 v151, v151, v199
 v_add_f32 v152, v152, v200
 v_add_f32 v153, v153, v201
 v_add_f32 v154, v154, v202
 v_add_f32 v155, v155, v203
 v_add_f32 v156, v156, v204
 v_add_f32 v157, v157, v205
 v_add_f32 v158, v158, v206
 v_add_f32 v159, v159, v207
 v_mul_f32 v144, 0x3e0293ee, v144
 v_mul_f32 v145, 0x3e0293ee, v145
 v_cvt_pk_bf16_f32 v224, v144, v145
 v_mul_f32 v146, 0x3e0293ee, v146
 v_mul_f32 v147, 0x3e0293ee, v147
 v_cvt_pk_bf16_f32 v225, v146, v147
 v_mul_f32 v148, 0x3e0293ee, v148
 v_mul_f32 v149, 0x3e0293ee, v149
 v_cvt_pk_bf16_f32 v226, v148, v149
 v_mul_f32 v150, 0x3e0293ee, v150
 v_mul_f32 v151, 0x3e0293ee, v151
 v_cvt_pk_bf16_f32 v227, v150, v151
 ds_write_b128 v236, v[224:227] offset:24576
 v_mul_f32 v152, 0x3e0293ee, v152
 v_mul_f32 v153, 0x3e0293ee, v153
 v_cvt_pk_bf16_f32 v228, v152, v153
 v_mul_f32 v154, 0x3e0293ee, v154
 v_mul_f32 v155, 0x3e0293ee, v155
 v_cvt_pk_bf16_f32 v229, v154, v155
 v_mul_f32 v156, 0x3e0293ee, v156
 v_mul_f32 v157, 0x3e0293ee, v157
 v_cvt_pk_bf16_f32 v230, v156, v157
 v_mul_f32 v158, 0x3e0293ee, v158
 v_mul_f32 v159, 0x3e0293ee, v159
 v_cvt_pk_bf16_f32 v231, v158, v159
 ds_write_b128 v236, v[228:231] offset:24832
 s_mov_b32 s79, 0
 s_waitcnt lgkmcnt(0)
 s_barrier
 s_branch Lw_Qatt
Lw_Qproj:
 s_waitcnt vmcnt(22)
 v_mfma_f32_16x16x32_bf16 v[80:83], a[0:3], v[16:19], 0
 v_mfma_f32_16x16x32_bf16 v[84:87], a[4:7], v[16:19], 0
 v_mfma_f32_16x16x32_bf16 v[92:95], a[4:7], v[20:23], 0
 ds_write_b128 v7, v[160:163] offset:0
 v_mfma_f32_16x16x32_bf16 v[88:91], a[0:3], v[20:23], 0
 v_mfma_f32_16x16x32_bf16 v[96:99], a[8:11], v[16:19], 0
 v_mfma_f32_16x16x32_bf16 v[100:103], a[12:15], v[16:19], 0
 ds_write_b128 v7, v[164:167] offset:1024
 v_mfma_f32_16x16x32_bf16 v[108:111], a[12:15], v[20:23], 0
 v_mfma_f32_16x16x32_bf16 v[104:107], a[8:11], v[20:23], 0
 v_mfma_f32_16x16x32_bf16 v[112:115], a[16:19], v[16:19], 0
 ds_write_b128 v7, v[168:171] offset:2048
 v_mfma_f32_16x16x32_bf16 v[116:119], a[20:23], v[16:19], 0
 v_mfma_f32_16x16x32_bf16 v[124:127], a[20:23], v[20:23], 0
 v_mfma_f32_16x16x32_bf16 v[120:123], a[16:19], v[20:23], 0
 ds_write_b128 v7, v[172:175] offset:3072
 v_mfma_f32_16x16x32_bf16 v[128:131], a[24:27], v[16:19], 0
 v_mfma_f32_16x16x32_bf16 v[132:135], a[28:31], v[16:19], 0
 v_mfma_f32_16x16x32_bf16 v[140:143], a[28:31], v[20:23], 0
 ds_write_b128 v8, v[176:179] offset:0
 v_mfma_f32_16x16x32_bf16 v[136:139], a[24:27], v[20:23], 0
 s_waitcnt vmcnt(20)
 v_mfma_f32_16x16x32_bf16 v[80:83], a[32:35], v[24:27], v[80:83]
 s_add_u32 s82, s65, 0
 buffer_load_dwordx4 v[16:19], v2, s[48:51], s82 offen offset:0 sc1
 v_mfma_f32_16x16x32_bf16 v[84:87], a[36:39], v[24:27], v[84:87]
 v_mfma_f32_16x16x32_bf16 v[92:95], a[36:39], v[28:31], v[92:95]
 buffer_load_dwordx4 v[20:23], v2, s[48:51], s82 offen offset:256 sc1
 v_mfma_f32_16x16x32_bf16 v[88:91], a[32:35], v[28:31], v[88:91]
 ds_write_b128 v8, v[180:183] offset:1024
 v_mfma_f32_16x16x32_bf16 v[96:99], a[40:43], v[24:27], v[96:99]
 v_mfma_f32_16x16x32_bf16 v[100:103], a[44:47], v[24:27], v[100:103]
 s_waitcnt vmcnt(2)
 s_max_i32 s69, s72, 0
 v_mov_b32 v3, s69
 v_mov_b32 v4, 0
 s_mov_b64 exec, 1
 buffer_store_dword v3, v4, s[48:51], s68 offen
 s_mov_b64 exec, -1
 v_mfma_f32_16x16x32_bf16 v[108:111], a[44:47], v[28:31], v[108:111]
 v_mfma_f32_16x16x32_bf16 v[104:107], a[40:43], v[28:31], v[104:107]
 ds_write_b128 v8, v[184:187] offset:2048
 v_mfma_f32_16x16x32_bf16 v[112:115], a[48:51], v[24:27], v[112:115]
 v_mfma_f32_16x16x32_bf16 v[116:119], a[52:55], v[24:27], v[116:119]
 v_mfma_f32_16x16x32_bf16 v[124:127], a[52:55], v[28:31], v[124:127]
 ds_write_b128 v8, v[188:191] offset:3072
 v_mfma_f32_16x16x32_bf16 v[120:123], a[48:51], v[28:31], v[120:123]
 v_mfma_f32_16x16x32_bf16 v[128:131], a[56:59], v[24:27], v[128:131]
 v_mfma_f32_16x16x32_bf16 v[132:135], a[60:63], v[24:27], v[132:135]
 ds_write_b128 v9, v[192:195] offset:0
 v_mfma_f32_16x16x32_bf16 v[140:143], a[60:63], v[28:31], v[140:143]
 v_mfma_f32_16x16x32_bf16 v[136:139], a[56:59], v[28:31], v[136:139]
 v_mfma_f32_16x16x32_bf16 v[80:83], a[64:67], v[32:35], v[80:83]
 buffer_load_dwordx4 v[24:27], v2, s[48:51], s82 offen offset:2048 sc1
 v_mfma_f32_16x16x32_bf16 v[84:87], a[68:71], v[32:35], v[84:87]
 ds_write_b128 v9, v[196:199] offset:1024
 v_mfma_f32_16x16x32_bf16 v[92:95], a[68:71], v[36:39], v[92:95]
 buffer_load_dwordx4 v[28:31], v2, s[48:51], s82 offen offset:2304 sc1
 v_mfma_f32_16x16x32_bf16 v[88:91], a[64:67], v[36:39], v[88:91]
 v_mfma_f32_16x16x32_bf16 v[96:99], a[72:75], v[32:35], v[96:99]
 v_mfma_f32_16x16x32_bf16 v[100:103], a[76:79], v[32:35], v[100:103]
 ds_write_b128 v9, v[200:203] offset:2048
 v_mfma_f32_16x16x32_bf16 v[108:111], a[76:79], v[36:39], v[108:111]
 v_mfma_f32_16x16x32_bf16 v[104:107], a[72:75], v[36:39], v[104:107]
 v_mfma_f32_16x16x32_bf16 v[112:115], a[80:83], v[32:35], v[112:115]
 ds_write_b128 v9, v[204:207] offset:3072
 v_mfma_f32_16x16x32_bf16 v[116:119], a[84:87], v[32:35], v[116:119]
 v_mfma_f32_16x16x32_bf16 v[124:127], a[84:87], v[36:39], v[124:127]
 v_mfma_f32_16x16x32_bf16 v[120:123], a[80:83], v[36:39], v[120:123]
 s_waitcnt lgkmcnt(0)
 s_barrier
 v_mfma_f32_16x16x32_bf16 v[128:131], a[88:91], v[32:35], v[128:131]
 ds_read_b128 v[160:163], v10 offset:0
 v_mfma_f32_16x16x32_bf16 v[132:135], a[92:95], v[32:35], v[132:135]
 ds_read_b128 v[164:167], v10 offset:1024
 v_mfma_f32_16x16x32_bf16 v[140:143], a[92:95], v[36:39], v[140:143]
 ds_read_b128 v[168:171], v10 offset:2048
 v_mfma_f32_16x16x32_bf16 v[136:139], a[88:91], v[36:39], v[136:139]
 ds_read_b128 v[172:175], v10 offset:3072
 v_mfma_f32_16x16x32_bf16 v[80:83], a[96:99], v[40:43], v[80:83]
 s_add_u32 s82, s65, 4096
 buffer_load_dwordx4 v[32:35], v2, s[48:51], s82 offen offset:0 sc1
 v_mfma_f32_16x16x32_bf16 v[84:87], a[100:103], v[40:43], v[84:87]
 ds_read_b128 v[176:179], v10 offset:4096
 v_mfma_f32_16x16x32_bf16 v[92:95], a[100:103], v[44:47], v[92:95]
 buffer_load_dwordx4 v[36:39], v2, s[48:51], s82 offen offset:256 sc1
 v_mfma_f32_16x16x32_bf16 v[88:91], a[96:99], v[44:47], v[88:91]
 ds_read_b128 v[180:183], v10 offset:5120
 v_mfma_f32_16x16x32_bf16 v[96:99], a[104:107], v[40:43], v[96:99]
 ds_read_b128 v[184:187], v10 offset:6144
 v_mfma_f32_16x16x32_bf16 v[100:103], a[108:111], v[40:43], v[100:103]
 ds_read_b128 v[188:191], v10 offset:7168
 v_mfma_f32_16x16x32_bf16 v[108:111], a[108:111], v[44:47], v[108:111]
 ds_read_b128 v[192:195], v10 offset:8192
 v_mfma_f32_16x16x32_bf16 v[104:107], a[104:107], v[44:47], v[104:107]
 ds_read_b128 v[196:199], v10 offset:9216
 v_mfma_f32_16x16x32_bf16 v[112:115], a[112:115], v[40:43], v[112:115]
 ds_read_b128 v[200:203], v10 offset:10240
 v_mfma_f32_16x16x32_bf16 v[116:119], a[116:119], v[40:43], v[116:119]
 ds_read_b128 v[204:207], v10 offset:11264
 v_mfma_f32_16x16x32_bf16 v[124:127], a[116:119], v[44:47], v[124:127]
 s_waitcnt lgkmcnt(8)
 v_mfma_f32_16x16x32_bf16 v[120:123], a[112:115], v[44:47], v[120:123]
 v_add_f32 v144, v144, v160
 v_add_f32 v145, v145, v161
 v_mfma_f32_16x16x32_bf16 v[128:131], a[120:123], v[40:43], v[128:131]
 v_add_f32 v146, v146, v162
 v_add_f32 v147, v147, v163
 v_mfma_f32_16x16x32_bf16 v[132:135], a[124:127], v[40:43], v[132:135]
 v_add_f32 v148, v148, v164
 v_add_f32 v149, v149, v165
 v_mfma_f32_16x16x32_bf16 v[140:143], a[124:127], v[44:47], v[140:143]
 v_add_f32 v150, v150, v166
 v_add_f32 v151, v151, v167
 v_mfma_f32_16x16x32_bf16 v[136:139], a[120:123], v[44:47], v[136:139]
 v_add_f32 v152, v152, v168
 v_add_f32 v153, v153, v169
 v_mfma_f32_16x16x32_bf16 v[80:83], a[128:131], v[48:51], v[80:83]
 buffer_load_dwordx4 v[40:43], v2, s[48:51], s82 offen offset:2048 sc1
 v_mfma_f32_16x16x32_bf16 v[84:87], a[132:135], v[48:51], v[84:87]
 v_add_f32 v154, v154, v170
 v_add_f32 v155, v155, v171
 v_mfma_f32_16x16x32_bf16 v[92:95], a[132:135], v[52:55], v[92:95]
 buffer_load_dwordx4 v[44:47], v2, s[48:51], s82 offen offset:2304 sc1
 v_mfma_f32_16x16x32_bf16 v[88:91], a[128:131], v[52:55], v[88:91]
 v_add_f32 v156, v156, v172
 v_add_f32 v157, v157, v173
 v_mfma_f32_16x16x32_bf16 v[96:99], a[136:139], v[48:51], v[96:99]
 v_add_f32 v158, v158, v174
 v_add_f32 v159, v159, v175
 v_mfma_f32_16x16x32_bf16 v[100:103], a[140:143], v[48:51], v[100:103]
 s_waitcnt lgkmcnt(4)
 v_mfma_f32_16x16x32_bf16 v[108:111], a[140:143], v[52:55], v[108:111]
 v_add_f32 v144, v144, v176
 v_add_f32 v145, v145, v177
 v_mfma_f32_16x16x32_bf16 v[104:107], a[136:139], v[52:55], v[104:107]
 v_add_f32 v146, v146, v178
 v_add_f32 v147, v147, v179
 v_mfma_f32_16x16x32_bf16 v[112:115], a[144:147], v[48:51], v[112:115]
 v_add_f32 v148, v148, v180
 v_add_f32 v149, v149, v181
 v_mfma_f32_16x16x32_bf16 v[116:119], a[148:151], v[48:51], v[116:119]
 v_add_f32 v150, v150, v182
 v_add_f32 v151, v151, v183
 v_mfma_f32_16x16x32_bf16 v[124:127], a[148:151], v[52:55], v[124:127]
 v_add_f32 v152, v152, v184
 v_add_f32 v153, v153, v185
 v_mfma_f32_16x16x32_bf16 v[120:123], a[144:147], v[52:55], v[120:123]
 v_add_f32 v154, v154, v186
 v_add_f32 v155, v155, v187
 v_mfma_f32_16x16x32_bf16 v[128:131], a[152:155], v[48:51], v[128:131]
 v_add_f32 v156, v156, v188
 v_add_f32 v157, v157, v189
 v_mfma_f32_16x16x32_bf16 v[132:135], a[156:159], v[48:51], v[132:135]
 v_add_f32 v158, v158, v190
 v_add_f32 v159, v159, v191
 v_mfma_f32_16x16x32_bf16 v[140:143], a[156:159], v[52:55], v[140:143]
 s_waitcnt lgkmcnt(0)
 v_mfma_f32_16x16x32_bf16 v[136:139], a[152:155], v[52:55], v[136:139]
 s_barrier
 v_mfma_f32_16x16x32_bf16 v[80:83], a[160:163], v[56:59], v[80:83]
 s_add_u32 s82, s65, 8192
 buffer_load_dwordx4 v[48:51], v2, s[48:51], s82 offen offset:0 sc1
 v_mfma_f32_16x16x32_bf16 v[84:87], a[164:167], v[56:59], v[84:87]
 v_add_f32 v144, v144, v192
 v_add_f32 v145, v145, v193
 v_mfma_f32_16x16x32_bf16 v[92:95], a[164:167], v[60:63], v[92:95]
 buffer_load_dwordx4 v[52:55], v2, s[48:51], s82 offen offset:256 sc1
 v_mfma_f32_16x16x32_bf16 v[88:91], a[160:163], v[60:63], v[88:91]
 v_add_f32 v146, v146, v194
 v_add_f32 v147, v147, v195
 v_mfma_f32_16x16x32_bf16 v[96:99], a[168:171], v[56:59], v[96:99]
 v_add_f32 v148, v148, v196
 v_add_f32 v149, v149, v197
 v_mfma_f32_16x16x32_bf16 v[100:103], a[172:175], v[56:59], v[100:103]
 v_add_f32 v150, v150, v198
 v_add_f32 v151, v151, v199
 v_mfma_f32_16x16x32_bf16 v[108:111], a[172:175], v[60:63], v[108:111]
 v_add_f32 v152, v152, v200
 v_add_f32 v153, v153, v201
 v_mfma_f32_16x16x32_bf16 v[104:107], a[168:171], v[60:63], v[104:107]
 v_add_f32 v154, v154, v202
 v_add_f32 v155, v155, v203
 v_mfma_f32_16x16x32_bf16 v[112:115], a[176:179], v[56:59], v[112:115]
 v_add_f32 v156, v156, v204
 v_add_f32 v157, v157, v205
 v_mfma_f32_16x16x32_bf16 v[116:119], a[180:183], v[56:59], v[116:119]
 v_add_f32 v158, v158, v206
 v_add_f32 v159, v159, v207
 v_mfma_f32_16x16x32_bf16 v[124:127], a[180:183], v[60:63], v[124:127]
 v_mul_f32 v144, 0x3e0293ee, v144
 v_mul_f32 v145, 0x3e0293ee, v145
 v_mfma_f32_16x16x32_bf16 v[120:123], a[176:179], v[60:63], v[120:123]
 v_cvt_pk_bf16_f32 v224, v144, v145
 v_mul_f32 v146, 0x3e0293ee, v146
 v_mfma_f32_16x16x32_bf16 v[128:131], a[184:187], v[56:59], v[128:131]
 v_mul_f32 v147, 0x3e0293ee, v147
 v_cvt_pk_bf16_f32 v225, v146, v147
 v_mfma_f32_16x16x32_bf16 v[132:135], a[188:191], v[56:59], v[132:135]
 v_mul_f32 v148, 0x3e0293ee, v148
 v_mul_f32 v149, 0x3e0293ee, v149
 v_mfma_f32_16x16x32_bf16 v[140:143], a[188:191], v[60:63], v[140:143]
 v_cvt_pk_bf16_f32 v226, v148, v149
 v_mul_f32 v150, 0x3e0293ee, v150
 v_mfma_f32_16x16x32_bf16 v[136:139], a[184:187], v[60:63], v[136:139]
 v_mul_f32 v151, 0x3e0293ee, v151
 v_cvt_pk_bf16_f32 v227, v150, v151
 v_mfma_f32_16x16x32_bf16 v[80:83], a[192:195], v[64:67], v[80:83]
 buffer_load_dwordx4 v[56:59], v2, s[48:51], s82 offen offset:2048 sc1
 v_mfma_f32_16x16x32_bf16 v[84:87], a[196:199], v[64:67], v[84:87]
 ds_write_b128 v236, v[224:227] offset:24576
 v_mfma_f32_16x16x32_bf16 v[92:95], a[196:199], v[68:71], v[92:95]
 buffer_load_dwordx4 v[60:63], v2, s[48:51], s82 offen offset:2304 sc1
 v_mfma_f32_16x16x32_bf16 v[88:91], a[192:195], v[68:71], v[88:91]
 v_mfma_f32_16x16x32_bf16 v[96:99], a[200:203], v[64:67], v[96:99]
 v_mfma_f32_16x16x32_bf16 v[100:103], a[204:207], v[64:67], v[100:103]
 v_mul_f32 v152, 0x3e0293ee, v152
 v_mul_f32 v153, 0x3e0293ee, v153
 v_mfma_f32_16x16x32_bf16 v[108:111], a[204:207], v[68:71], v[108:111]
 v_cvt_pk_bf16_f32 v228, v152, v153
 v_mul_f32 v154, 0x3e0293ee, v154
 v_mfma_f32_16x16x32_bf16 v[104:107], a[200:203], v[68:71], v[104:107]
 v_mul_f32 v155, 0x3e0293ee, v155
 v_cvt_pk_bf16_f32 v229, v154, v155
 v_mfma_f32_16x16x32_bf16 v[112:115], a[208:211], v[64:67], v[112:115]
 v_mul_f32 v156, 0x3e0293ee, v156
 v_mul_f32 v157, 0x3e0293ee, v157
 v_mfma_f32_16x16x32_bf16 v[116:119], a[212:215], v[64:67], v[116:119]
 v_cvt_pk_bf16_f32 v230, v156, v157
 v_mul_f32 v158, 0x3e0293ee, v158
 v_mfma_f32_16x16x32_bf16 v[124:127], a[212:215], v[68:71], v[124:127]
 v_mul_f32 v159, 0x3e0293ee, v159
 v_cvt_pk_bf16_f32 v231, v158, v159
 v_mfma_f32_16x16x32_bf16 v[120:123], a[208:211], v[68:71], v[120:123]
 ds_write_b128 v236, v[228:231] offset:24832
 v_mfma_f32_16x16x32_bf16 v[128:131], a[216:219], v[64:67], v[128:131]
 v_mfma_f32_16x16x32_bf16 v[132:135], a[220:223], v[64:67], v[132:135]
 v_mfma_f32_16x16x32_bf16 v[140:143], a[220:223], v[68:71], v[140:143]
 v_mfma_f32_16x16x32_bf16 v[136:139], a[216:219], v[68:71], v[136:139]
 v_mfma_f32_16x16x32_bf16 v[80:83], a[224:227], v[72:75], v[80:83]
 s_add_u32 s82, s65, 12288
 buffer_load_dwordx4 v[64:67], v2, s[48:51], s82 offen offset:0 sc1
 v_mfma_f32_16x16x32_bf16 v[84:87], a[228:231], v[72:75], v[84:87]
 v_mfma_f32_16x16x32_bf16 v[92:95], a[228:231], v[76:79], v[92:95]
 buffer_load_dwordx4 v[68:71], v2, s[48:51], s82 offen offset:256 sc1
 v_mfma_f32_16x16x32_bf16 v[88:91], a[224:227], v[76:79], v[88:91]
 v_mfma_f32_16x16x32_bf16 v[96:99], a[232:235], v[72:75], v[96:99]
 v_mfma_f32_16x16x32_bf16 v[100:103], a[236:239], v[72:75], v[100:103]
 s_add_u32 s70, s65, 131072
 buffer_load_dwordx4 v[12:15], v11, s[48:51], s70 offen offset:0 sc1
 buffer_load_dwordx4 v[12:15], v11, s[48:51], s70 offen offset:1024 sc1
 v_mfma_f32_16x16x32_bf16 v[108:111], a[236:239], v[76:79], v[108:111]
 v_mfma_f32_16x16x32_bf16 v[104:107], a[232:235], v[76:79], v[104:107]
 v_mfma_f32_16x16x32_bf16 v[112:115], a[240:243], v[72:75], v[112:115]
 v_mfma_f32_16x16x32_bf16 v[116:119], a[244:247], v[72:75], v[116:119]
 v_mfma_f32_16x16x32_bf16 v[124:127], a[244:247], v[76:79], v[124:127]
 v_mfma_f32_16x16x32_bf16 v[120:123], a[240:243], v[76:79], v[120:123]
 v_mfma_f32_16x16x32_bf16 v[128:131], a[248:251], v[72:75], v[128:131]
 v_mfma_f32_16x16x32_bf16 v[132:135], a[252:255], v[72:75], v[132:135]
 v_mfma_f32_16x16x32_bf16 v[140:143], a[252:255], v[76:79], v[140:143]
 v_mfma_f32_16x16x32_bf16 v[136:139], a[248:251], v[76:79], v[136:139]
 buffer_load_dwordx4 v[72:75], v2, s[48:51], s82 offen offset:2048 sc1
 buffer_load_dwordx4 v[76:79], v2, s[48:51], s82 offen offset:2304 sc1
 s_add_u32 s65, s65, 0x10000
 s_waitcnt vmcnt(17)
 v_mfma_f32_16x16x32_bf16 v[144:147], a[0:3], v[16:19], 0
 v_mfma_f32_16x16x32_bf16 v[148:151], a[4:7], v[16:19], 0
 v_mfma_f32_16x16x32_bf16 v[156:159], a[4:7], v[20:23], 0
 ds_write_b128 v7, v[96:99] offset:0
 v_mfma_f32_16x16x32_bf16 v[152:155], a[0:3], v[20:23], 0
 v_mfma_f32_16x16x32_bf16 v[160:163], a[8:11], v[16:19], 0
 v_mfma_f32_16x16x32_bf16 v[164:167], a[12:15], v[16:19], 0
 ds_write_b128 v7, v[100:103] offset:1024
 v_mfma_f32_16x16x32_bf16 v[172:175], a[12:15], v[20:23], 0
 v_mfma_f32_16x16x32_bf16 v[168:171], a[8:11], v[20:23], 0
 v_mfma_f32_16x16x32_bf16 v[176:179], a[16:19], v[16:19], 0
 ds_write_b128 v7, v[104:107] offset:2048
 v_mfma_f32_16x16x32_bf16 v[180:183], a[20:23], v[16:19], 0
 v_mfma_f32_16x16x32_bf16 v[188:191], a[20:23], v[20:23], 0
 v_mfma_f32_16x16x32_bf16 v[184:187], a[16:19], v[20:23], 0
 ds_write_b128 v7, v[108:111] offset:3072
 v_mfma_f32_16x16x32_bf16 v[192:195], a[24:27], v[16:19], 0
 v_mfma_f32_16x16x32_bf16 v[196:199], a[28:31], v[16:19], 0
 s_lshl_b32 s69, s4, 13
 s_add_u32 m0, s69, 114688
 s_add_u32 s69, s67, 33554432
 buffer_load_dwordx4 v1, s[48:51], s69 offen offset:0 sc1 lds
 v_mfma_f32_16x16x32_bf16 v[204:207], a[28:31], v[20:23], 0
 v_mfma_f32_16x16x32_bf16 v[200:203], a[24:27], v[20:23], 0
 ds_write_b128 v8, v[112:115] offset:0
 s_waitcnt vmcnt(15)
 v_mfma_f32_16x16x32_bf16 v[144:147], a[32:35], v[24:27], v[144:147]
 s_add_u32 s82, s65, 0
 buffer_load_dwordx4 v[16:19], v2, s[48:51], s82 offen offset:0 sc1
 v_mfma_f32_16x16x32_bf16 v[148:151], a[36:39], v[24:27], v[148:151]
 v_mfma_f32_16x16x32_bf16 v[156:159], a[36:39], v[28:31], v[156:159]
 buffer_load_dwordx4 v[20:23], v2, s[48:51], s82 offen offset:256 sc1
 v_mfma_f32_16x16x32_bf16 v[152:155], a[32:35], v[28:31], v[152:155]
 v_mfma_f32_16x16x32_bf16 v[160:163], a[40:43], v[24:27], v[160:163]
 ds_write_b128 v8, v[116:119] offset:1024
 v_mfma_f32_16x16x32_bf16 v[164:167], a[44:47], v[24:27], v[164:167]
 v_mfma_f32_16x16x32_bf16 v[172:175], a[44:47], v[28:31], v[172:175]
 v_mfma_f32_16x16x32_bf16 v[168:171], a[40:43], v[28:31], v[168:171]
 ds_write_b128 v8, v[120:123] offset:2048
 v_mfma_f32_16x16x32_bf16 v[176:179], a[48:51], v[24:27], v[176:179]
 v_mfma_f32_16x16x32_bf16 v[180:183], a[52:55], v[24:27], v[180:183]
 v_mfma_f32_16x16x32_bf16 v[188:191], a[52:55], v[28:31], v[188:191]
 ds_write_b128 v8, v[124:127] offset:3072
 v_mfma_f32_16x16x32_bf16 v[184:187], a[48:51], v[28:31], v[184:187]
 v_mfma_f32_16x16x32_bf16 v[192:195], a[56:59], v[24:27], v[192:195]
 v_mfma_f32_16x16x32_bf16 v[196:199], a[60:63], v[24:27], v[196:199]
 ds_write_b128 v9, v[128:131] offset:0
 v_mfma_f32_16x16x32_bf16 v[204:207], a[60:63], v[28:31], v[204:207]
 v_mfma_f32_16x16x32_bf16 v[200:203], a[56:59], v[28:31], v[200:203]
 s_waitcnt vmcnt(15)
 v_mfma_f32_16x16x32_bf16 v[144:147], a[64:67], v[32:35], v[144:147]
 buffer_load_dwordx4 v[24:27], v2, s[48:51], s82 offen offset:2048 sc1
 v_mfma_f32_16x16x32_bf16 v[148:151], a[68:71], v[32:35], v[148:151]
 ds_write_b128 v9, v[132:135] offset:1024
 v_mfma_f32_16x16x32_bf16 v[156:159], a[68:71], v[36:39], v[156:159]
 buffer_load_dwordx4 v[28:31], v2, s[48:51], s82 offen offset:2304 sc1
 v_mfma_f32_16x16x32_bf16 v[152:155], a[64:67], v[36:39], v[152:155]
 v_mfma_f32_16x16x32_bf16 v[160:163], a[72:75], v[32:35], v[160:163]
 v_mfma_f32_16x16x32_bf16 v[164:167], a[76:79], v[32:35], v[164:167]
 s_lshl_b32 s69, s4, 13
 s_add_u32 m0, s69, 114688
 s_add_u32 s69, s67, 33554432
 buffer_load_dwordx4 v1, s[48:51], s69 offen offset:1024 sc1 lds
 v_mfma_f32_16x16x32_bf16 v[172:175], a[76:79], v[36:39], v[172:175]
 ds_write_b128 v9, v[136:139] offset:2048
 v_mfma_f32_16x16x32_bf16 v[168:171], a[72:75], v[36:39], v[168:171]
 v_mfma_f32_16x16x32_bf16 v[176:179], a[80:83], v[32:35], v[176:179]
 v_mfma_f32_16x16x32_bf16 v[180:183], a[84:87], v[32:35], v[180:183]
 ds_write_b128 v9, v[140:143] offset:3072
 v_mfma_f32_16x16x32_bf16 v[188:191], a[84:87], v[36:39], v[188:191]
 v_mfma_f32_16x16x32_bf16 v[184:187], a[80:83], v[36:39], v[184:187]
 v_mfma_f32_16x16x32_bf16 v[192:195], a[88:91], v[32:35], v[192:195]
 s_waitcnt lgkmcnt(0)
 s_barrier
 v_mfma_f32_16x16x32_bf16 v[196:199], a[92:95], v[32:35], v[196:199]
 ds_read_b128 v[96:99], v10 offset:0
 v_mfma_f32_16x16x32_bf16 v[204:207], a[92:95], v[36:39], v[204:207]
 ds_read_b128 v[100:103], v10 offset:1024
 v_mfma_f32_16x16x32_bf16 v[200:203], a[88:91], v[36:39], v[200:203]
 ds_read_b128 v[104:107], v10 offset:2048
 s_waitcnt vmcnt(16)
 v_mfma_f32_16x16x32_bf16 v[144:147], a[96:99], v[40:43], v[144:147]
 s_add_u32 s82, s65, 4096
 buffer_load_dwordx4 v[32:35], v2, s[48:51], s82 offen offset:0 sc1
 v_mfma_f32_16x16x32_bf16 v[148:151], a[100:103], v[40:43], v[148:151]
 ds_read_b128 v[108:111], v10 offset:3072
 v_mfma_f32_16x16x32_bf16 v[156:159], a[100:103], v[44:47], v[156:159]
 buffer_load_dwordx4 v[36:39], v2, s[48:51], s82 offen offset:256 sc1
 v_mfma_f32_16x16x32_bf16 v[152:155], a[96:99], v[44:47], v[152:155]
 ds_read_b128 v[112:115], v10 offset:4096
 v_mfma_f32_16x16x32_bf16 v[160:163], a[104:107], v[40:43], v[160:163]
 ds_read_b128 v[116:119], v10 offset:5120
 v_mfma_f32_16x16x32_bf16 v[164:167], a[108:111], v[40:43], v[164:167]
 ds_read_b128 v[120:123], v10 offset:6144
 v_mfma_f32_16x16x32_bf16 v[172:175], a[108:111], v[44:47], v[172:175]
 ds_read_b128 v[124:127], v10 offset:7168
 v_mfma_f32_16x16x32_bf16 v[168:171], a[104:107], v[44:47], v[168:171]
 ds_read_b128 v[128:131], v10 offset:8192
 v_mfma_f32_16x16x32_bf16 v[176:179], a[112:115], v[40:43], v[176:179]
 ds_read_b128 v[132:135], v10 offset:9216
 v_mfma_f32_16x16x32_bf16 v[180:183], a[116:119], v[40:43], v[180:183]
 ds_read_b128 v[136:139], v10 offset:10240
 v_mfma_f32_16x16x32_bf16 v[188:191], a[116:119], v[44:47], v[188:191]
 ds_read_b128 v[140:143], v10 offset:11264
 v_mfma_f32_16x16x32_bf16 v[184:187], a[112:115], v[44:47], v[184:187]
 s_waitcnt lgkmcnt(8)
 v_mfma_f32_16x16x32_bf16 v[192:195], a[120:123], v[40:43], v[192:195]
 v_add_f32 v80, v80, v96
 v_add_f32 v81, v81, v97
 v_mfma_f32_16x16x32_bf16 v[196:199], a[124:127], v[40:43], v[196:199]
 s_lshl_b32 s69, s4, 13
 s_add_u32 m0, s69, 114688
 s_add_u32 s69, s67, 33554432
 buffer_load_dwordx4 v1, s[48:51], s69 offen offset:2048 sc1 lds
 v_mfma_f32_16x16x32_bf16 v[204:207], a[124:127], v[44:47], v[204:207]
 v_add_f32 v82, v82, v98
 v_add_f32 v83, v83, v99
 v_mfma_f32_16x16x32_bf16 v[200:203], a[120:123], v[44:47], v[200:203]
 v_add_f32 v84, v84, v100
 v_add_f32 v85, v85, v101
 s_waitcnt vmcnt(17)
 v_mfma_f32_16x16x32_bf16 v[144:147], a[128:131], v[48:51], v[144:147]
 buffer_load_dwordx4 v[40:43], v2, s[48:51], s82 offen offset:2048 sc1
 v_mfma_f32_16x16x32_bf16 v[148:151], a[132:135], v[48:51], v[148:151]
 v_add_f32 v86, v86, v102
 v_add_f32 v87, v87, v103
 v_mfma_f32_16x16x32_bf16 v[156:159], a[132:135], v[52:55], v[156:159]
 buffer_load_dwordx4 v[44:47], v2, s[48:51], s82 offen offset:2304 sc1
 v_mfma_f32_16x16x32_bf16 v[152:155], a[128:131], v[52:55], v[152:155]
 v_add_f32 v88, v88, v104
 v_add_f32 v89, v89, v105
 v_mfma_f32_16x16x32_bf16 v[160:163], a[136:139], v[48:51], v[160:163]
 v_add_f32 v90, v90, v106
 v_add_f32 v91, v91, v107
 v_mfma_f32_16x16x32_bf16 v[164:167], a[140:143], v[48:51], v[164:167]
 v_add_f32 v92, v92, v108
 v_add_f32 v93, v93, v109
 v_mfma_f32_16x16x32_bf16 v[172:175], a[140:143], v[52:55], v[172:175]
 v_add_f32 v94, v94, v110
 v_add_f32 v95, v95, v111
 v_mfma_f32_16x16x32_bf16 v[168:171], a[136:139], v[52:55], v[168:171]
 s_waitcnt lgkmcnt(4)
 v_mfma_f32_16x16x32_bf16 v[176:179], a[144:147], v[48:51], v[176:179]
 v_add_f32 v80, v80, v112
 v_add_f32 v81, v81, v113
 v_mfma_f32_16x16x32_bf16 v[180:183], a[148:151], v[48:51], v[180:183]
 v_add_f32 v82, v82, v114
 v_add_f32 v83, v83, v115
 v_mfma_f32_16x16x32_bf16 v[188:191], a[148:151], v[52:55], v[188:191]
 v_add_f32 v84, v84, v116
 v_add_f32 v85, v85, v117
 v_mfma_f32_16x16x32_bf16 v[184:187], a[144:147], v[52:55], v[184:187]
 v_add_f32 v86, v86, v118
 v_add_f32 v87, v87, v119
 v_mfma_f32_16x16x32_bf16 v[192:195], a[152:155], v[48:51], v[192:195]
 v_add_f32 v88, v88, v120
 v_add_f32 v89, v89, v121
 v_mfma_f32_16x16x32_bf16 v[196:199], a[156:159], v[48:51], v[196:199]
 v_add_f32 v90, v90, v122
 v_add_f32 v91, v91, v123
 v_mfma_f32_16x16x32_bf16 v[204:207], a[156:159], v[52:55], v[204:207]
 v_add_f32 v92, v92, v124
 v_add_f32 v93, v93, v125
 v_mfma_f32_16x16x32_bf16 v[200:203], a[152:155], v[52:55], v[200:203]
 v_add_f32 v94, v94, v126
 v_add_f32 v95, v95, v127
 s_waitcnt vmcnt(17)
 v_mfma_f32_16x16x32_bf16 v[144:147], a[160:163], v[56:59], v[144:147]
 s_add_u32 s82, s65, 8192
 buffer_load_dwordx4 v[48:51], v2, s[48:51], s82 offen offset:0 sc1
 v_mfma_f32_16x16x32_bf16 v[148:151], a[164:167], v[56:59], v[148:151]
 s_waitcnt lgkmcnt(0)
 v_mfma_f32_16x16x32_bf16 v[156:159], a[164:167], v[60:63], v[156:159]
 buffer_load_dwordx4 v[52:55], v2, s[48:51], s82 offen offset:256 sc1
 v_mfma_f32_16x16x32_bf16 v[152:155], a[160:163], v[60:63], v[152:155]
 s_barrier
 v_mfma_f32_16x16x32_bf16 v[160:163], a[168:171], v[56:59], v[160:163]
 v_add_f32 v80, v80, v128
 v_add_f32 v81, v81, v129
 v_mfma_f32_16x16x32_bf16 v[164:167], a[172:175], v[56:59], v[164:167]
 s_lshl_b32 s69, s4, 13
 s_add_u32 m0, s69, 114688
 s_add_u32 s69, s67, 33554432
 buffer_load_dwordx4 v1, s[48:51], s69 offen offset:3072 sc1 lds
 v_mfma_f32_16x16x32_bf16 v[172:175], a[172:175], v[60:63], v[172:175]
 v_add_f32 v82, v82, v130
 v_add_f32 v83, v83, v131
 v_mfma_f32_16x16x32_bf16 v[168:171], a[168:171], v[60:63], v[168:171]
 v_add_f32 v84, v84, v132
 v_add_f32 v85, v85, v133
 v_mfma_f32_16x16x32_bf16 v[176:179], a[176:179], v[56:59], v[176:179]
 v_add_f32 v86, v86, v134
 v_add_f32 v87, v87, v135
 v_mfma_f32_16x16x32_bf16 v[180:183], a[180:183], v[56:59], v[180:183]
 v_add_f32 v88, v88, v136
 v_add_f32 v89, v89, v137
 v_mfma_f32_16x16x32_bf16 v[188:191], a[180:183], v[60:63], v[188:191]
 v_add_f32 v90, v90, v138
 v_add_f32 v91, v91, v139
 v_mfma_f32_16x16x32_bf16 v[184:187], a[176:179], v[60:63], v[184:187]
 v_add_f32 v92, v92, v140
 v_add_f32 v93, v93, v141
 v_mfma_f32_16x16x32_bf16 v[192:195], a[184:187], v[56:59], v[192:195]
 v_add_f32 v94, v94, v142
 v_add_f32 v95, v95, v143
 v_mfma_f32_16x16x32_bf16 v[196:199], a[188:191], v[56:59], v[196:199]
 v_mul_f32 v80, 0x3e0293ee, v80
 v_mul_f32 v81, 0x3e0293ee, v81
 v_mfma_f32_16x16x32_bf16 v[204:207], a[188:191], v[60:63], v[204:207]
 v_cvt_pk_bf16_f32 v224, v80, v81
 v_mul_f32 v82, 0x3e0293ee, v82
 v_mfma_f32_16x16x32_bf16 v[200:203], a[184:187], v[60:63], v[200:203]
 v_mul_f32 v83, 0x3e0293ee, v83
 v_cvt_pk_bf16_f32 v225, v82, v83
 s_waitcnt vmcnt(18)
 v_mfma_f32_16x16x32_bf16 v[144:147], a[192:195], v[64:67], v[144:147]
 buffer_load_dwordx4 v[56:59], v2, s[48:51], s82 offen offset:2048 sc1
 v_mfma_f32_16x16x32_bf16 v[148:151], a[196:199], v[64:67], v[148:151]
 v_mul_f32 v84, 0x3e0293ee, v84
 v_mul_f32 v85, 0x3e0293ee, v85
 v_mfma_f32_16x16x32_bf16 v[156:159], a[196:199], v[68:71], v[156:159]
 buffer_load_dwordx4 v[60:63], v2, s[48:51], s82 offen offset:2304 sc1
 v_mfma_f32_16x16x32_bf16 v[152:155], a[192:195], v[68:71], v[152:155]
 v_cvt_pk_bf16_f32 v226, v84, v85
 v_mul_f32 v86, 0x3e0293ee, v86
 v_mfma_f32_16x16x32_bf16 v[160:163], a[200:203], v[64:67], v[160:163]
 v_mul_f32 v87, 0x3e0293ee, v87
 v_cvt_pk_bf16_f32 v227, v86, v87
 v_mfma_f32_16x16x32_bf16 v[164:167], a[204:207], v[64:67], v[164:167]
 ds_write_b128 v235, v[224:227] offset:0
 v_mfma_f32_16x16x32_bf16 v[172:175], a[204:207], v[68:71], v[172:175]
 v_mfma_f32_16x16x32_bf16 v[168:171], a[200:203], v[68:71], v[168:171]
 v_mfma_f32_16x16x32_bf16 v[176:179], a[208:211], v[64:67], v[176:179]
 v_mul_f32 v88, 0x3e0293ee, v88
 v_mul_f32 v89, 0x3e0293ee, v89
 v_mfma_f32_16x16x32_bf16 v[180:183], a[212:215], v[64:67], v[180:183]
 v_cvt_pk_bf16_f32 v228, v88, v89
 v_mul_f32 v90, 0x3e0293ee, v90
 v_mfma_f32_16x16x32_bf16 v[188:191], a[212:215], v[68:71], v[188:191]
 v_mul_f32 v91, 0x3e0293ee, v91
 v_cvt_pk_bf16_f32 v229, v90, v91
 v_mfma_f32_16x16x32_bf16 v[184:187], a[208:211], v[68:71], v[184:187]
 v_mul_f32 v92, 0x3e0293ee, v92
 v_mul_f32 v93, 0x3e0293ee, v93
 v_mfma_f32_16x16x32_bf16 v[192:195], a[216:219], v[64:67], v[192:195]
 v_cvt_pk_bf16_f32 v230, v92, v93
 v_mul_f32 v94, 0x3e0293ee, v94
 v_mfma_f32_16x16x32_bf16 v[196:199], a[220:223], v[64:67], v[196:199]
 v_mul_f32 v95, 0x3e0293ee, v95
 v_cvt_pk_bf16_f32 v231, v94, v95
 v_mfma_f32_16x16x32_bf16 v[204:207], a[220:223], v[68:71], v[204:207]
 ds_write_b128 v235, v[228:231] offset:256
 v_mfma_f32_16x16x32_bf16 v[200:203], a[216:219], v[68:71], v[200:203]
 s_waitcnt vmcnt(16)
 v_mfma_f32_16x16x32_bf16 v[144:147], a[224:227], v[72:75], v[144:147]
 s_add_u32 s82, s65, 12288
 buffer_load_dwordx4 v[64:67], v2, s[48:51], s82 offen offset:0 sc1
 v_mfma_f32_16x16x32_bf16 v[148:151], a[228:231], v[72:75], v[148:151]
 v_mfma_f32_16x16x32_bf16 v[156:159], a[228:231], v[76:79], v[156:159]
 buffer_load_dwordx4 v[68:71], v2, s[48:51], s82 offen offset:256 sc1
 v_mfma_f32_16x16x32_bf16 v[152:155], a[224:227], v[76:79], v[152:155]
 v_mfma_f32_16x16x32_bf16 v[160:163], a[232:235], v[72:75], v[160:163]
 v_mfma_f32_16x16x32_bf16 v[164:167], a[236:239], v[72:75], v[164:167]
 s_add_u32 s70, s65, 131072
 buffer_load_dwordx4 v[12:15], v11, s[48:51], s70 offen offset:0 sc1
 buffer_load_dwordx4 v[12:15], v11, s[48:51], s70 offen offset:1024 sc1
 v_mfma_f32_16x16x32_bf16 v[172:175], a[236:239], v[76:79], v[172:175]
 v_mfma_f32_16x16x32_bf16 v[168:171], a[232:235], v[76:79], v[168:171]
 v_mfma_f32_16x16x32_bf16 v[176:179], a[240:243], v[72:75], v[176:179]
 v_mfma_f32_16x16x32_bf16 v[180:183], a[244:247], v[72:75], v[180:183]
 v_mfma_f32_16x16x32_bf16 v[188:191], a[244:247], v[76:79], v[188:191]
 v_mfma_f32_16x16x32_bf16 v[184:187], a[240:243], v[76:79], v[184:187]
 v_mfma_f32_16x16x32_bf16 v[192:195], a[248:251], v[72:75], v[192:195]
 v_mfma_f32_16x16x32_bf16 v[196:199], a[252:255], v[72:75], v[196:199]
 v_mfma_f32_16x16x32_bf16 v[204:207], a[252:255], v[76:79], v[204:207]
 v_mfma_f32_16x16x32_bf16 v[200:203], a[248:251], v[76:79], v[200:203]
 buffer_load_dwordx4 v[72:75], v2, s[48:51], s82 offen offset:2048 sc1
 buffer_load_dwordx4 v[76:79], v2, s[48:51], s82 offen offset:2304 sc1
 s_add_u32 s65, s65, 0x10000
 s_waitcnt vmcnt(19)
 v_mfma_f32_16x16x32_bf16 v[80:83], a[0:3], v[16:19], 0
 v_mfma_f32_16x16x32_bf16 v[84:87], a[4:7], v[16:19], 0
 v_mfma_f32_16x16x32_bf16 v[92:95], a[4:7], v[20:23], 0
 ds_write_b128 v7, v[160:163] offset:0
 v_mfma_f32_16x16x32_bf16 v[88:91], a[0:3], v[20:23], 0
 v_mfma_f32_16x16x32_bf16 v[96:99], a[8:11], v[16:19], 0
 v_mfma_f32_16x16x32_bf16 v[100:103], a[12:15], v[16:19], 0
 ds_write_b128 v7, v[164:167] offset:1024
 v_mfma_f32_16x16x32_bf16 v[108:111], a[12:15], v[20:23], 0
 v_mfma_f32_16x16x32_bf16 v[104:107], a[8:11], v[20:23], 0
 v_mfma_f32_16x16x32_bf16 v[112:115], a[16:19], v[16:19], 0
 ds_write_b128 v7, v[168:171] offset:2048
 v_mfma_f32_16x16x32_bf16 v[116:119], a[20:23], v[16:19], 0
 v_mfma_f32_16x16x32_bf16 v[124:127], a[20:23], v[20:23], 0
 v_mfma_f32_16x16x32_bf16 v[120:123], a[16:19], v[20:23], 0
 ds_write_b128 v7, v[172:175] offset:3072
 v_mfma_f32_16x16x32_bf16 v[128:131], a[24:27], v[16:19], 0
 v_mfma_f32_16x16x32_bf16 v[132:135], a[28:31], v[16:19], 0
 s_lshl_b32 s69, s4, 13
 s_add_u32 m0, s69, 118784
 s_add_u32 s69, s67, 33558528
 buffer_load_dwordx4 v1, s[48:51], s69 offen offset:0 sc1 lds
 v_mfma_f32_16x16x32_bf16 v[140:143], a[28:31], v[20:23], 0
 v_mfma_f32_16x16x32_bf16 v[136:139], a[24:27], v[20:23], 0
 ds_write_b128 v8, v[176:179] offset:0
 s_waitcnt vmcnt(18)
 v_mfma_f32_16x16x32_bf16 v[80:83], a[32:35], v[24:27], v[80:83]
 s_add_u32 s82, s65, 0
 buffer_load_dwordx4 v[16:19], v2, s[48:51], s82 offen offset:0 sc1
 v_mfma_f32_16x16x32_bf16 v[84:87], a[36:39], v[24:27], v[84:87]
 v_mfma_f32_16x16x32_bf16 v[92:95], a[36:39], v[28:31], v[92:95]
 buffer_load_dwordx4 v[20:23], v2, s[48:51], s82 offen offset:256 sc1
 v_mfma_f32_16x16x32_bf16 v[88:91], a[32:35], v[28:31], v[88:91]
 v_mfma_f32_16x16x32_bf16 v[96:99], a[40:43], v[24:27], v[96:99]
 ds_write_b128 v8, v[180:183] offset:1024
 v_mfma_f32_16x16x32_bf16 v[100:103], a[44:47], v[24:27], v[100:103]
 v_mfma_f32_16x16x32_bf16 v[108:111], a[44:47], v[28:31], v[108:111]
 v_mfma_f32_16x16x32_bf16 v[104:107], a[40:43], v[28:31], v[104:107]
 ds_write_b128 v8, v[184:187] offset:2048
 v_mfma_f32_16x16x32_bf16 v[112:115], a[48:51], v[24:27], v[112:115]
 v_mfma_f32_16x16x32_bf16 v[116:119], a[52:55], v[24:27], v[116:119]
 v_mfma_f32_16x16x32_bf16 v[124:127], a[52:55], v[28:31], v[124:127]
 ds_write_b128 v8, v[188:191] offset:3072
 v_mfma_f32_16x16x32_bf16 v[120:123], a[48:51], v[28:31], v[120:123]
 v_mfma_f32_16x16x32_bf16 v[128:131], a[56:59], v[24:27], v[128:131]
 v_mfma_f32_16x16x32_bf16 v[132:135], a[60:63], v[24:27], v[132:135]
 ds_write_b128 v9, v[192:195] offset:0
 v_mfma_f32_16x16x32_bf16 v[140:143], a[60:63], v[28:31], v[140:143]
 v_mfma_f32_16x16x32_bf16 v[136:139], a[56:59], v[28:31], v[136:139]
 s_waitcnt vmcnt(17)
 v_mfma_f32_16x16x32_bf16 v[80:83], a[64:67], v[32:35], v[80:83]
 buffer_load_dwordx4 v[24:27], v2, s[48:51], s82 offen offset:2048 sc1
 v_mfma_f32_16x16x32_bf16 v[84:87], a[68:71], v[32:35], v[84:87]
 ds_write_b128 v9, v[196:199] offset:1024
 v_mfma_f32_16x16x32_bf16 v[92:95], a[68:71], v[36:39], v[92:95]
 buffer_load_dwordx4 v[28:31], v2, s[48:51], s82 offen offset:2304 sc1
 v_mfma_f32_16x16x32_bf16 v[88:91], a[64:67], v[36:39], v[88:91]
 v_mfma_f32_16x16x32_bf16 v[96:99], a[72:75], v[32:35], v[96:99]
 v_mfma_f32_16x16x32_bf16 v[100:103], a[76:79], v[32:35], v[100:103]
 s_lshl_b32 s69, s4, 13
 s_add_u32 m0, s69, 118784
 s_add_u32 s69, s67, 33558528
 buffer_load_dwordx4 v1, s[48:51], s69 offen offset:1024 sc1 lds
 v_mfma_f32_16x16x32_bf16 v[108:111], a[76:79], v[36:39], v[108:111]
 ds_write_b128 v9, v[200:203] offset:2048
 v_mfma_f32_16x16x32_bf16 v[104:107], a[72:75], v[36:39], v[104:107]
 v_mfma_f32_16x16x32_bf16 v[112:115], a[80:83], v[32:35], v[112:115]
 v_mfma_f32_16x16x32_bf16 v[116:119], a[84:87], v[32:35], v[116:119]
 ds_write_b128 v9, v[204:207] offset:3072
 v_mfma_f32_16x16x32_bf16 v[124:127], a[84:87], v[36:39], v[124:127]
 v_mfma_f32_16x16x32_bf16 v[120:123], a[80:83], v[36:39], v[120:123]
 v_mfma_f32_16x16x32_bf16 v[128:131], a[88:91], v[32:35], v[128:131]
 s_waitcnt lgkmcnt(0)
 s_barrier
 v_mfma_f32_16x16x32_bf16 v[132:135], a[92:95], v[32:35], v[132:135]
 ds_read_b128 v[160:163], v10 offset:0
 v_mfma_f32_16x16x32_bf16 v[140:143], a[92:95], v[36:39], v[140:143]
 ds_read_b128 v[164:167], v10 offset:1024
 v_mfma_f32_16x16x32_bf16 v[136:139], a[88:91], v[36:39], v[136:139]
 ds_read_b128 v[168:171], v10 offset:2048
 s_waitcnt vmcnt(17)
 v_mfma_f32_16x16x32_bf16 v[80:83], a[96:99], v[40:43], v[80:83]
 s_add_u32 s82, s65, 4096
 buffer_load_dwordx4 v[32:35], v2, s[48:51], s82 offen offset:0 sc1
 v_mfma_f32_16x16x32_bf16 v[84:87], a[100:103], v[40:43], v[84:87]
 ds_read_b128 v[172:175], v10 offset:3072
 v_mfma_f32_16x16x32_bf16 v[92:95], a[100:103], v[44:47], v[92:95]
 buffer_load_dwordx4 v[36:39], v2, s[48:51], s82 offen offset:256 sc1
 v_mfma_f32_16x16x32_bf16 v[88:91], a[96:99], v[44:47], v[88:91]
 ds_read_b128 v[176:179], v10 offset:4096
 v_mfma_f32_16x16x32_bf16 v[96:99], a[104:107], v[40:43], v[96:99]
 ds_read_b128 v[180:183], v10 offset:5120
 v_mfma_f32_16x16x32_bf16 v[100:103], a[108:111], v[40:43], v[100:103]
 ds_read_b128 v[184:187], v10 offset:6144
 v_mfma_f32_16x16x32_bf16 v[108:111], a[108:111], v[44:47], v[108:111]
 ds_read_b128 v[188:191], v10 offset:7168
 v_mfma_f32_16x16x32_bf16 v[104:107], a[104:107], v[44:47], v[104:107]
 ds_read_b128 v[192:195], v10 offset:8192
 v_mfma_f32_16x16x32_bf16 v[112:115], a[112:115], v[40:43], v[112:115]
 ds_read_b128 v[196:199], v10 offset:9216
 v_mfma_f32_16x16x32_bf16 v[116:119], a[116:119], v[40:43], v[116:119]
 ds_read_b128 v[200:203], v10 offset:10240
 v_mfma_f32_16x16x32_bf16 v[124:127], a[116:119], v[44:47], v[124:127]
 ds_read_b128 v[204:207], v10 offset:11264
 v_mfma_f32_16x16x32_bf16 v[120:123], a[112:115], v[44:47], v[120:123]
 s_waitcnt lgkmcnt(8)
 v_mfma_f32_16x16x32_bf16 v[128:131], a[120:123], v[40:43], v[128:131]
 v_add_f32 v144, v144, v160
 v_add_f32 v145, v145, v161
 v_mfma_f32_16x16x32_bf16 v[132:135], a[124:127], v[40:43], v[132:135]
 s_lshl_b32 s69, s4, 13
 s_add_u32 m0, s69, 118784
 s_add_u32 s69, s67, 33558528
 buffer_load_dwordx4 v1, s[48:51], s69 offen offset:2048 sc1 lds
 v_mfma_f32_16x16x32_bf16 v[140:143], a[124:127], v[44:47], v[140:143]
 v_add_f32 v146, v146, v162
 v_add_f32 v147, v147, v163
 v_mfma_f32_16x16x32_bf16 v[136:139], a[120:123], v[44:47], v[136:139]
 v_add_f32 v148, v148, v164
 v_add_f32 v149, v149, v165
 s_waitcnt vmcnt(18)
 v_mfma_f32_16x16x32_bf16 v[80:83], a[128:131], v[48:51], v[80:83]
 buffer_load_dwordx4 v[40:43], v2, s[48:51], s82 offen offset:2048 sc1
 v_mfma_f32_16x16x32_bf16 v[84:87], a[132:135], v[48:51], v[84:87]
 v_add_f32 v150, v150, v166
 v_add_f32 v151, v151, v167
 v_mfma_f32_16x16x32_bf16 v[92:95], a[132:135], v[52:55], v[92:95]
 buffer_load_dwordx4 v[44:47], v2, s[48:51], s82 offen offset:2304 sc1
 v_mfma_f32_16x16x32_bf16 v[88:91], a[128:131], v[52:55], v[88:91]
 v_add_f32 v152, v152, v168
 v_add_f32 v153, v153, v169
 v_mfma_f32_16x16x32_bf16 v[96:99], a[136:139], v[48:51], v[96:99]
 v_add_f32 v154, v154, v170
 v_add_f32 v155, v155, v171
 v_mfma_f32_16x16x32_bf16 v[100:103], a[140:143], v[48:51], v[100:103]
 v_add_f32 v156, v156, v172
 v_add_f32 v157, v157, v173
 v_mfma_f32_16x16x32_bf16 v[108:111], a[140:143], v[52:55], v[108:111]
 v_add_f32 v158, v158, v174
 v_add_f32 v159, v159, v175
 v_mfma_f32_16x16x32_bf16 v[104:107], a[136:139], v[52:55], v[104:107]
 s_waitcnt lgkmcnt(4)
 v_mfma_f32_16x16x32_bf16 v[112:115], a[144:147], v[48:51], v[112:115]
 v_add_f32 v144, v144, v176
 v_add_f32 v145, v145, v177
 v_mfma_f32_16x16x32_bf16 v[116:119], a[148:151], v[48:51], v[116:119]
 v_add_f32 v146, v146, v178
 v_add_f32 v147, v147, v179
 v_mfma_f32_16x16x32_bf16 v[124:127], a[148:151], v[52:55], v[124:127]
 v_add_f32 v148, v148, v180
 v_add_f32 v149, v149, v181
 v_mfma_f32_16x16x32_bf16 v[120:123], a[144:147], v[52:55], v[120:123]
 v_add_f32 v150, v150, v182
 v_add_f32 v151, v151, v183
 v_mfma_f32_16x16x32_bf16 v[128:131], a[152:155], v[48:51], v[128:131]
 v_add_f32 v152, v152, v184
 v_add_f32 v153, v153, v185
 v_mfma_f32_16x16x32_bf16 v[132:135], a[156:159], v[48:51], v[132:135]
 v_add_f32 v154, v154, v186
 v_add_f32 v155, v155, v187
 v_mfma_f32_16x16x32_bf16 v[140:143], a[156:159], v[52:55], v[140:143]
 v_add_f32 v156, v156, v188
 v_add_f32 v157, v157, v189
 v_mfma_f32_16x16x32_bf16 v[136:139], a[152:155], v[52:55], v[136:139]
 v_add_f32 v158, v158, v190
 v_add_f32 v159, v159, v191
 s_waitcnt vmcnt(17)
 v_mfma_f32_16x16x32_bf16 v[80:83], a[160:163], v[56:59], v[80:83]
 s_add_u32 s82, s65, 8192
 buffer_load_dwordx4 v[48:51], v2, s[48:51], s82 offen offset:0 sc1
 v_mfma_f32_16x16x32_bf16 v[84:87], a[164:167], v[56:59], v[84:87]
 s_waitcnt lgkmcnt(0)
 v_mfma_f32_16x16x32_bf16 v[92:95], a[164:167], v[60:63], v[92:95]
 buffer_load_dwordx4 v[52:55], v2, s[48:51], s82 offen offset:256 sc1
 v_mfma_f32_16x16x32_bf16 v[88:91], a[160:163], v[60:63], v[88:91]
 s_barrier
 v_mfma_f32_16x16x32_bf16 v[96:99], a[168:171], v[56:59], v[96:99]
 v_add_f32 v144, v144, v192
 v_add_f32 v145, v145, v193
 v_mfma_f32_16x16x32_bf16 v[100:103], a[172:175], v[56:59], v[100:103]
 s_lshl_b32 s69, s4, 13
 s_add_u32 m0, s69, 118784
 s_add_u32 s69, s67, 33558528
 buffer_load_dwordx4 v1, s[48:51], s69 offen offset:3072 sc1 lds
 v_mfma_f32_16x16x32_bf16 v[108:111], a[172:175], v[60:63], v[108:111]
 v_add_f32 v146, v146, v194
 v_add_f32 v147, v147, v195
 v_mfma_f32_16x16x32_bf16 v[104:107], a[168:171], v[60:63], v[104:107]
 v_add_f32 v148, v148, v196
 v_add_f32 v149, v149, v197
 v_mfma_f32_16x16x32_bf16 v[112:115], a[176:179], v[56:59], v[112:115]
 v_add_f32 v150, v150, v198
 v_add_f32 v151, v151, v199
 v_mfma_f32_16x16x32_bf16 v[116:119], a[180:183], v[56:59], v[116:119]
 v_add_f32 v152, v152, v200
 v_add_f32 v153, v153, v201
 v_mfma_f32_16x16x32_bf16 v[124:127], a[180:183], v[60:63], v[124:127]
 v_add_f32 v154, v154, v202
 v_add_f32 v155, v155, v203
 v_mfma_f32_16x16x32_bf16 v[120:123], a[176:179], v[60:63], v[120:123]
 v_add_f32 v156, v156, v204
 v_add_f32 v157, v157, v205
 v_mfma_f32_16x16x32_bf16 v[128:131], a[184:187], v[56:59], v[128:131]
 v_add_f32 v158, v158, v206
 v_add_f32 v159, v159, v207
 v_mfma_f32_16x16x32_bf16 v[132:135], a[188:191], v[56:59], v[132:135]
 v_mul_f32 v144, 0x3e0293ee, v144
 v_mul_f32 v145, 0x3e0293ee, v145
 v_mfma_f32_16x16x32_bf16 v[140:143], a[188:191], v[60:63], v[140:143]
 v_cvt_pk_bf16_f32 v224, v144, v145
 v_mul_f32 v146, 0x3e0293ee, v146
 v_mfma_f32_16x16x32_bf16 v[136:139], a[184:187], v[60:63], v[136:139]
 v_mul_f32 v147, 0x3e0293ee, v147
 v_cvt_pk_bf16_f32 v225, v146, v147
 s_waitcnt vmcnt(18)
 v_mfma_f32_16x16x32_bf16 v[80:83], a[192:195], v[64:67], v[80:83]
 buffer_load_dwordx4 v[56:59], v2, s[48:51], s82 offen offset:2048 sc1
 v_mfma_f32_16x16x32_bf16 v[84:87], a[196:199], v[64:67], v[84:87]
 v_mul_f32 v148, 0x3e0293ee, v148
 v_mul_f32 v149, 0x3e0293ee, v149
 v_mfma_f32_16x16x32_bf16 v[92:95], a[196:199], v[68:71], v[92:95]
 buffer_load_dwordx4 v[60:63], v2, s[48:51], s82 offen offset:2304 sc1
 v_mfma_f32_16x16x32_bf16 v[88:91], a[192:195], v[68:71], v[88:91]
 v_cvt_pk_bf16_f32 v226, v148, v149
 v_mul_f32 v150, 0x3e0293ee, v150
 v_mfma_f32_16x16x32_bf16 v[96:99], a[200:203], v[64:67], v[96:99]
 v_mul_f32 v151, 0x3e0293ee, v151
 v_cvt_pk_bf16_f32 v227, v150, v151
 v_mfma_f32_16x16x32_bf16 v[100:103], a[204:207], v[64:67], v[100:103]
 ds_write_b128 v235, v[224:227] offset:8192
 v_mfma_f32_16x16x32_bf16 v[108:111], a[204:207], v[68:71], v[108:111]
 v_mfma_f32_16x16x32_bf16 v[104:107], a[200:203], v[68:71], v[104:107]
 v_mfma_f32_16x16x32_bf16 v[112:115], a[208:211], v[64:67], v[112:115]
 v_mul_f32 v152, 0x3e0293ee, v152
 v_mul_f32 v153, 0x3e0293ee, v153
 v_mfma_f32_16x16x32_bf16 v[116:119], a[212:215], v[64:67], v[116:119]
 v_cvt_pk_bf16_f32 v228, v152, v153
 v_mul_f32 v154, 0x3e0293ee, v154
 v_mfma_f32_16x16x32_bf16 v[124:127], a[212:215], v[68:71], v[124:127]
 v_mul_f32 v155, 0x3e0293ee, v155
 v_cvt_pk_bf16_f32 v229, v154, v155
 v_mfma_f32_16x16x32_bf16 v[120:123], a[208:211], v[68:71], v[120:123]
 v_mul_f32 v156, 0x3e0293ee, v156
 v_mul_f32 v157, 0x3e0293ee, v157
 v_mfma_f32_16x16x32_bf16 v[128:131], a[216:219], v[64:67], v[128:131]
 v_cvt_pk_bf16_f32 v230, v156, v157
 v_mul_f32 v158, 0x3e0293ee, v158
 v_mfma_f32_16x16x32_bf16 v[132:135], a[220:223], v[64:67], v[132:135]
 v_mul_f32 v159, 0x3e0293ee, v159
 v_cvt_pk_bf16_f32 v231, v158, v159
 v_mfma_f32_16x16x32_bf16 v[140:143], a[220:223], v[68:71], v[140:143]
 ds_write_b128 v235, v[228:231] offset:8448
 v_mfma_f32_16x16x32_bf16 v[136:139], a[216:219], v[68:71], v[136:139]
 s_waitcnt vmcnt(16)
 v_mfma_f32_16x16x32_bf16 v[80:83], a[224:227], v[72:75], v[80:83]
 s_add_u32 s82, s65, 12288
 buffer_load_dwordx4 v[64:67], v2, s[48:51], s82 offen offset:0 sc1
 v_mfma_f32_16x16x32_bf16 v[84:87], a[228:231], v[72:75], v[84:87]
 v_mfma_f32_16x16x32_bf16 v[92:95], a[228:231], v[76:79], v[92:95]
 buffer_load_dwordx4 v[68:71], v2, s[48:51], s82 offen offset:256 sc1
 v_mfma_f32_16x16x32_bf16 v[88:91], a[224:227], v[76:79], v[88:91]
 v_mfma_f32_16x16x32_bf16 v[96:99], a[232:235], v[72:75], v[96:99]
 v_mfma_f32_16x16x32_bf16 v[100:103], a[236:239], v[72:75], v[100:103]
 s_add_u32 s70, s65, 131072
 buffer_load_dwordx4 v[12:15], v11, s[48:51], s70 offen offset:0 sc1
 buffer_load_dwordx4 v[12:15], v11, s[48:51], s70 offen offset:1024 sc1
 v_mfma_f32_16x16x32_bf16 v[108:111], a[236:239], v[76:79], v[108:111]
 v_mfma_f32_16x16x32_bf16 v[104:107], a[232:235], v[76:79], v[104:107]
 v_mfma_f32_16x16x32_bf16 v[112:115], a[240:243], v[72:75], v[112:115]
 v_mfma_f32_16x16x32_bf16 v[116:119], a[244:247], v[72:75], v[116:119]
 v_mfma_f32_16x16x32_bf16 v[124:127], a[244:247], v[76:79], v[124:127]
 v_mfma_f32_16x16x32_bf16 v[120:123], a[240:243], v[76:79], v[120:123]
 v_mfma_f32_16x16x32_bf16 v[128:131], a[248:251], v[72:75], v[128:131]
 v_mfma_f32_16x16x32_bf16 v[132:135], a[252:255], v[72:75], v[132:135]
 v_mfma_f32_16x16x32_bf16 v[140:143], a[252:255], v[76:79], v[140:143]
 v_mfma_f32_16x16x32_bf16 v[136:139], a[248:251], v[76:79], v[136:139]
 buffer_load_dwordx4 v[72:75], v2, s[48:51], s82 offen offset:2048 sc1
 buffer_load_dwordx4 v[76:79], v2, s[48:51], s82 offen offset:2304 sc1
 s_add_u32 s65, s65, 0x10000
 s_waitcnt vmcnt(19)
 v_mfma_f32_16x16x32_bf16 v[144:147], a[0:3], v[16:19], 0
 v_mfma_f32_16x16x32_bf16 v[148:151], a[4:7], v[16:19], 0
 v_mfma_f32_16x16x32_bf16 v[156:159], a[4:7], v[20:23], 0
 ds_write_b128 v7, v[96:99] offset:0
 v_mfma_f32_16x16x32_bf16 v[152:155], a[0:3], v[20:23], 0
 v_mfma_f32_16x16x32_bf16 v[160:163], a[8:11], v[16:19], 0
 v_mfma_f32_16x16x32_bf16 v[164:167], a[12:15], v[16:19], 0
 s_add_u32 s70, s65, 131072
 buffer_load_dwordx4 v[12:15], v11, s[48:51], s70 offen offset:0 sc1
 buffer_load_dwordx4 v[12:15], v11, s[48:51], s70 offen offset:1024 sc1
 v_mfma_f32_16x16x32_bf16 v[172:175], a[12:15], v[20:23], 0
 ds_write_b128 v7, v[100:103] offset:1024
 v_mfma_f32_16x16x32_bf16 v[168:171], a[8:11], v[20:23], 0
 s_add_u32 s69, s77, 4096
 s_mov_b64 exec, 0xf
 buffer_load_dword v239, v1, s[48:51], s69 offen sc1
 s_mov_b64 exec, -1
 v_mfma_f32_16x16x32_bf16 v[176:179], a[16:19], v[16:19], 0
 v_mfma_f32_16x16x32_bf16 v[180:183], a[20:23], v[16:19], 0
 v_mfma_f32_16x16x32_bf16 v[188:191], a[20:23], v[20:23], 0
 ds_write_b128 v7, v[104:107] offset:2048
 v_mfma_f32_16x16x32_bf16 v[184:187], a[16:19], v[20:23], 0
 v_mfma_f32_16x16x32_bf16 v[192:195], a[24:27], v[16:19], 0
 v_mfma_f32_16x16x32_bf16 v[196:199], a[28:31], v[16:19], 0
 ds_write_b128 v7, v[108:111] offset:3072
 v_mfma_f32_16x16x32_bf16 v[204:207], a[28:31], v[20:23], 0
 v_mfma_f32_16x16x32_bf16 v[200:203], a[24:27], v[20:23], 0
 s_waitcnt vmcnt(20)
 v_mfma_f32_16x16x32_bf16 v[144:147], a[32:35], v[24:27], v[144:147]
 s_add_u32 s82, s67, 16777216
 buffer_load_dwordx4 v[16:19], v1, s[48:51], s82 offen offset:0 sc1
 v_mfma_f32_16x16x32_bf16 v[148:151], a[36:39], v[24:27], v[148:151]
 ds_write_b128 v8, v[112:115] offset:0
 v_mfma_f32_16x16x32_bf16 v[156:159], a[36:39], v[28:31], v[156:159]
 buffer_load_dwordx4 v[20:23], v1, s[48:51], s82 offen offset:1024 sc1
 v_mfma_f32_16x16x32_bf16 v[152:155], a[32:35], v[28:31], v[152:155]
 v_mfma_f32_16x16x32_bf16 v[160:163], a[40:43], v[24:27], v[160:163]
 v_mfma_f32_16x16x32_bf16 v[164:167], a[44:47], v[24:27], v[164:167]
 ds_write_b128 v8, v[116:119] offset:1024
 v_mfma_f32_16x16x32_bf16 v[172:175], a[44:47], v[28:31], v[172:175]
 v_mfma_f32_16x16x32_bf16 v[168:171], a[40:43], v[28:31], v[168:171]
 v_mfma_f32_16x16x32_bf16 v[176:179], a[48:51], v[24:27], v[176:179]
 ds_write_b128 v8, v[120:123] offset:2048
 v_mfma_f32_16x16x32_bf16 v[180:183], a[52:55], v[24:27], v[180:183]
 v_mfma_f32_16x16x32_bf16 v[188:191], a[52:55], v[28:31], v[188:191]
 v_mfma_f32_16x16x32_bf16 v[184:187], a[48:51], v[28:31], v[184:187]
 ds_write_b128 v8, v[124:127] offset:3072
 v_mfma_f32_16x16x32_bf16 v[192:195], a[56:59], v[24:27], v[192:195]
 v_mfma_f32_16x16x32_bf16 v[196:199], a[60:63], v[24:27], v[196:199]
 v_mfma_f32_16x16x32_bf16 v[204:207], a[60:63], v[28:31], v[204:207]
 ds_write_b128 v9, v[128:131] offset:0
 v_mfma_f32_16x16x32_bf16 v[200:203], a[56:59], v[28:31], v[200:203]
 s_waitcnt vmcnt(19)
 v_mfma_f32_16x16x32_bf16 v[144:147], a[64:67], v[32:35], v[144:147]
 buffer_load_dwordx4 v[24:27], v1, s[48:51], s82 offen offset:2048 sc1
 v_mfma_f32_16x16x32_bf16 v[148:151], a[68:71], v[32:35], v[148:151]
 v_mfma_f32_16x16x32_bf16 v[156:159], a[68:71], v[36:39], v[156:159]
 buffer_load_dwordx4 v[28:31], v1, s[48:51], s82 offen offset:3072 sc1
 v_mfma_f32_16x16x32_bf16 v[152:155], a[64:67], v[36:39], v[152:155]
 ds_write_b128 v9, v[132:135] offset:1024
 v_mfma_f32_16x16x32_bf16 v[160:163], a[72:75], v[32:35], v[160:163]
 v_mfma_f32_16x16x32_bf16 v[164:167], a[76:79], v[32:35], v[164:167]
 v_mfma_f32_16x16x32_bf16 v[172:175], a[76:79], v[36:39], v[172:175]
 ds_write_b128 v9, v[136:139] offset:2048
 v_mfma_f32_16x16x32_bf16 v[168:171], a[72:75], v[36:39], v[168:171]
 v_mfma_f32_16x16x32_bf16 v[176:179], a[80:83], v[32:35], v[176:179]
 v_mfma_f32_16x16x32_bf16 v[180:183], a[84:87], v[32:35], v[180:183]
 ds_write_b128 v9, v[140:143] offset:3072
 v_mfma_f32_16x16x32_bf16 v[188:191], a[84:87], v[36:39], v[188:191]
 v_mfma_f32_16x16x32_bf16 v[184:187], a[80:83], v[36:39], v[184:187]
 v_mfma_f32_16x16x32_bf16 v[192:195], a[88:91], v[32:35], v[192:195]
 s_waitcnt lgkmcnt(0)
 s_barrier
 v_mfma_f32_16x16x32_bf16 v[196:199], a[92:95], v[32:35], v[196:199]
 ds_read_b128 v[96:99], v10 offset:0
 v_mfma_f32_16x16x32_bf16 v[204:207], a[92:95], v[36:39], v[204:207]
 ds_read_b128 v[100:103], v10 offset:1024
 v_mfma_f32_16x16x32_bf16 v[200:203], a[88:91], v[36:39], v[200:203]
 ds_read_b128 v[104:107], v10 offset:2048
 s_waitcnt vmcnt(18)
 v_mfma_f32_16x16x32_bf16 v[144:147], a[96:99], v[40:43], v[144:147]
 s_add_u32 s82, s67, 16781312
 buffer_load_dwordx4 v[32:35], v1, s[48:51], s82 offen offset:0 sc1
 v_mfma_f32_16x16x32_bf16 v[148:151], a[100:103], v[40:43], v[148:151]
 ds_read_b128 v[108:111], v10 offset:3072
 v_mfma_f32_16x16x32_bf16 v[156:159], a[100:103], v[44:47], v[156:159]
 buffer_load_dwordx4 v[36:39], v1, s[48:51], s82 offen offset:1024 sc1
 v_mfma_f32_16x16x32_bf16 v[152:155], a[96:99], v[44:47], v[152:155]
 ds_read_b128 v[112:115], v10 offset:4096
 v_mfma_f32_16x16x32_bf16 v[160:163], a[104:107], v[40:43], v[160:163]
 ds_read_b128 v[116:119], v10 offset:5120
 v_mfma_f32_16x16x32_bf16 v[164:167], a[108:111], v[40:43], v[164:167]
 ds_read_b128 v[120:123], v10 offset:6144
 v_mfma_f32_16x16x32_bf16 v[172:175], a[108:111], v[44:47], v[172:175]
 ds_read_b128 v[124:127], v10 offset:7168
 v_mfma_f32_16x16x32_bf16 v[168:171], a[104:107], v[44:47], v[168:171]
 ds_read_b128 v[128:131], v10 offset:8192
 v_mfma_f32_16x16x32_bf16 v[176:179], a[112:115], v[40:43], v[176:179]
 ds_read_b128 v[132:135], v10 offset:9216
 v_mfma_f32_16x16x32_bf16 v[180:183], a[116:119], v[40:43], v[180:183]
 ds_read_b128 v[136:139], v10 offset:10240
 v_mfma_f32_16x16x32_bf16 v[188:191], a[116:119], v[44:47], v[188:191]
 ds_read_b128 v[140:143], v10 offset:11264
 v_mfma_f32_16x16x32_bf16 v[184:187], a[112:115], v[44:47], v[184:187]
 s_waitcnt lgkmcnt(8)
 v_mfma_f32_16x16x32_bf16 v[192:195], a[120:123], v[40:43], v[192:195]
 v_add_f32 v80, v80, v96
 v_add_f32 v81, v81, v97
 v_mfma_f32_16x16x32_bf16 v[196:199], a[124:127], v[40:43], v[196:199]
 v_add_f32 v82, v82, v98
 v_add_f32 v83, v83, v99
 v_mfma_f32_16x16x32_bf16 v[204:207], a[124:127], v[44:47], v[204:207]
 v_add_f32 v84, v84, v100
 v_add_f32 v85, v85, v101
 v_mfma_f32_16x16x32_bf16 v[200:203], a[120:123], v[44:47], v[200:203]
 v_add_f32 v86, v86, v102
 v_add_f32 v87, v87, v103
 s_waitcnt vmcnt(18)
 v_mfma_f32_16x16x32_bf16 v[144:147], a[128:131], v[48:51], v[144:147]
 buffer_load_dwordx4 v[40:43], v1, s[48:51], s82 offen offset:2048 sc1
 v_mfma_f32_16x16x32_bf16 v[148:151], a[132:135], v[48:51], v[148:151]
 v_add_f32 v88, v88, v104
 v_add_f32 v89, v89, v105
 v_mfma_f32_16x16x32_bf16 v[156:159], a[132:135], v[52:55], v[156:159]
 buffer_load_dwordx4 v[44:47], v1, s[48:51], s82 offen offset:3072 sc1
 v_mfma_f32_16x16x32_bf16 v[152:155], a[128:131], v[52:55], v[152:155]
 v_add_f32 v90, v90, v106
 v_add_f32 v91, v91, v107
 v_mfma_f32_16x16x32_bf16 v[160:163], a[136:139], v[48:51], v[160:163]
 v_add_f32 v92, v92, v108
 v_add_f32 v93, v93, v109
 v_mfma_f32_16x16x32_bf16 v[164:167], a[140:143], v[48:51], v[164:167]
 s_waitcnt vmcnt(8)
 s_mov_b64 exec, 0xf
 v_cmp_gt_u32 vcc, s75, v239
 s_mov_b64 exec, -1
 s_mov_b32 s79, 0
 s_cbranch_vccnz notry_71
 s_mov_b32 s79, 1
 s_lshl_b32 s69, s4, 12
 s_add_u32 m0, s69, 147456
 s_nop 0
 buffer_load_dwordx4 v1, s[48:51], s78 offen offset:0 sc1 lds
 buffer_load_dwordx4 v1, s[48:51], s78 offen offset:1024 sc1 lds
 buffer_load_dwordx4 v1, s[48:51], s78 offen offset:2048 sc1 lds
 buffer_load_dwordx4 v1, s[48:51], s78 offen offset:3072 sc1 lds
notry_71:
 v_mfma_f32_16x16x32_bf16 v[172:175], a[140:143], v[52:55], v[172:175]
 v_add_f32 v94, v94, v110
 v_add_f32 v95, v95, v111
 v_mfma_f32_16x16x32_bf16 v[168:171], a[136:139], v[52:55], v[168:171]
 s_waitcnt lgkmcnt(4)
 v_mfma_f32_16x16x32_bf16 v[176:179], a[144:147], v[48:51], v[176:179]
 v_add_f32 v80, v80, v112
 v_add_f32 v81, v81, v113
 v_mfma_f32_16x16x32_bf16 v[180:183], a[148:151], v[48:51], v[180:183]
 v_add_f32 v82, v82, v114
 v_add_f32 v83, v83, v115
 v_mfma_f32_16x16x32_bf16 v[188:191], a[148:151], v[52:55], v[188:191]
 v_add_f32 v84, v84, v116
 v_add_f32 v85, v85, v117
 v_mfma_f32_16x16x32_bf16 v[184:187], a[144:147], v[52:55], v[184:187]
 v_add_f32 v86, v86, v118
 v_add_f32 v87, v87, v119
 v_mfma_f32_16x16x32_bf16 v[192:195], a[152:155], v[48:51], v[192:195]
 v_add_f32 v88, v88, v120
 v_add_f32 v89, v89, v121
 v_mfma_f32_16x16x32_bf16 v[196:199], a[156:159], v[48:51], v[196:199]
 v_add_f32 v90, v90, v122
 v_add_f32 v91, v91, v123
 v_mfma_f32_16x16x32_bf16 v[204:207], a[156:159], v[52:55], v[204:207]
 v_add_f32 v92, v92, v124
 v_add_f32 v93, v93, v125
 v_mfma_f32_16x16x32_bf16 v[200:203], a[152:155], v[52:55], v[200:203]
 v_add_f32 v94, v94, v126
 v_add_f32 v95, v95, v127
 v_mfma_f32_16x16x32_bf16 v[144:147], a[160:163], v[56:59], v[144:147]
 s_waitcnt lgkmcnt(0)
 v_mfma_f32_16x16x32_bf16 v[148:151], a[164:167], v[56:59], v[148:151]
 s_barrier
 v_mfma_f32_16x16x32_bf16 v[156:159], a[164:167], v[60:63], v[156:159]
 v_add_f32 v80, v80, v128
 v_add_f32 v81, v81, v129
 v_mfma_f32_16x16x32_bf16 v[152:155], a[160:163], v[60:63], v[152:155]
 v_add_f32 v82, v82, v130
 v_add_f32 v83, v83, v131
 v_mfma_f32_16x16x32_bf16 v[160:163], a[168:171], v[56:59], v[160:163]
 v_add_f32 v84, v84, v132
 v_add_f32 v85, v85, v133
 v_mfma_f32_16x16x32_bf16 v[164:167], a[172:175], v[56:59], v[164:167]
 v_add_f32 v86, v86, v134
 v_add_f32 v87, v87, v135
 v_mfma_f32_16x16x32_bf16 v[172:175], a[172:175], v[60:63], v[172:175]
 v_add_f32 v88, v88, v136
 v_add_f32 v89, v89, v137
 v_mfma_f32_16x16x32_bf16 v[168:171], a[168:171], v[60:63], v[168:171]
 v_add_f32 v90, v90, v138
 v_add_f32 v91, v91, v139
 v_mfma_f32_16x16x32_bf16 v[176:179], a[176:179], v[56:59], v[176:179]
 v_add_f32 v92, v92, v140
 v_add_f32 v93, v93, v141
 v_mfma_f32_16x16x32_bf16 v[180:183], a[180:183], v[56:59], v[180:183]
 v_add_f32 v94, v94, v142
 v_add_f32 v95, v95, v143
 v_mfma_f32_16x16x32_bf16 v[188:191], a[180:183], v[60:63], v[188:191]
 v_mul_f32 v80, 0x3e0293ee, v80
 v_mul_f32 v81, 0x3e0293ee, v81
 v_mfma_f32_16x16x32_bf16 v[184:187], a[176:179], v[60:63], v[184:187]
 v_cvt_pk_bf16_f32 v224, v80, v81
 v_mul_f32 v82, 0x3e0293ee, v82
 v_mfma_f32_16x16x32_bf16 v[192:195], a[184:187], v[56:59], v[192:195]
 v_mul_f32 v83, 0x3e0293ee, v83
 v_cvt_pk_bf16_f32 v225, v82, v83
 v_mfma_f32_16x16x32_bf16 v[196:199], a[188:191], v[56:59], v[196:199]
 v_mul_f32 v84, 0x3e0293ee, v84
 v_mul_f32 v85, 0x3e0293ee, v85
 v_mfma_f32_16x16x32_bf16 v[204:207], a[188:191], v[60:63], v[204:207]
 v_cvt_pk_bf16_f32 v226, v84, v85
 v_mul_f32 v86, 0x3e0293ee, v86
 v_mfma_f32_16x16x32_bf16 v[200:203], a[184:187], v[60:63], v[200:203]
 v_mul_f32 v87, 0x3e0293ee, v87
 v_cvt_pk_bf16_f32 v227, v86, v87
 v_mfma_f32_16x16x32_bf16 v[144:147], a[192:195], v[64:67], v[144:147]
 ds_write_b128 v235, v[224:227] offset:16384
 v_mfma_f32_16x16x32_bf16 v[148:151], a[196:199], v[64:67], v[148:151]
 v_mfma_f32_16x16x32_bf16 v[156:159], a[196:199], v[68:71], v[156:159]
 v_mfma_f32_16x16x32_bf16 v[152:155], a[192:195], v[68:71], v[152:155]
 v_mul_f32 v88, 0x3e0293ee, v88
 v_mul_f32 v89, 0x3e0293ee, v89
 v_mfma_f32_16x16x32_bf16 v[160:163], a[200:203], v[64:67], v[160:163]
 v_cvt_pk_bf16_f32 v228, v88, v89
 v_mul_f32 v90, 0x3e0293ee, v90
 v_mfma_f32_16x16x32_bf16 v[164:167], a[204:207], v[64:67], v[164:167]
 v_mul_f32 v91, 0x3e0293ee, v91
 v_cvt_pk_bf16_f32 v229, v90, v91
 v_mfma_f32_16x16x32_bf16 v[172:175], a[204:207], v[68:71], v[172:175]
 v_mul_f32 v92, 0x3e0293ee, v92
 v_mul_f32 v93, 0x3e0293ee, v93
 v_mfma_f32_16x16x32_bf16 v[168:171], a[200:203], v[68:71], v[168:171]
 v_cvt_pk_bf16_f32 v230, v92, v93
 v_mul_f32 v94, 0x3e0293ee, v94
 v_mfma_f32_16x16x32_bf16 v[176:179], a[208:211], v[64:67], v[176:179]
 v_mul_f32 v95, 0x3e0293ee, v95
 v_cvt_pk_bf16_f32 v231, v94, v95
 v_mfma_f32_16x16x32_bf16 v[180:183], a[212:215], v[64:67], v[180:183]
 ds_write_b128 v235, v[228:231] offset:16640
 v_mfma_f32_16x16x32_bf16 v[188:191], a[212:215], v[68:71], v[188:191]
 v_mfma_f32_16x16x32_bf16 v[184:187], a[208:211], v[68:71], v[184:187]
 v_mfma_f32_16x16x32_bf16 v[192:195], a[216:219], v[64:67], v[192:195]
 v_mfma_f32_16x16x32_bf16 v[196:199], a[220:223], v[64:67], v[196:199]
 v_mfma_f32_16x16x32_bf16 v[204:207], a[220:223], v[68:71], v[204:207]
 v_mfma_f32_16x16x32_bf16 v[200:203], a[216:219], v[68:71], v[200:203]
 v_mfma_f32_16x16x32_bf16 v[144:147], a[224:227], v[72:75], v[144:147]
 v_mfma_f32_16x16x32_bf16 v[148:151], a[228:231], v[72:75], v[148:151]
 v_mfma_f32_16x16x32_bf16 v[156:159], a[228:231], v[76:79], v[156:159]
 v_mfma_f32_16x16x32_bf16 v[152:155], a[224:227], v[76:79], v[152:155]
 v_mfma_f32_16x16x32_bf16 v[160:163], a[232:235], v[72:75], v[160:163]
 v_mfma_f32_16x16x32_bf16 v[164:167], a[236:239], v[72:75], v[164:167]
 v_mfma_f32_16x16x32_bf16 v[172:175], a[236:239], v[76:79], v[172:175]
 v_mfma_f32_16x16x32_bf16 v[168:171], a[232:235], v[76:79], v[168:171]
 v_mfma_f32_16x16x32_bf16 v[176:179], a[240:243], v[72:75], v[176:179]
 v_mfma_f32_16x16x32_bf16 v[180:183], a[244:247], v[72:75], v[180:183]
 v_mfma_f32_16x16x32_bf16 v[188:191], a[244:247], v[76:79], v[188:191]
 v_mfma_f32_16x16x32_bf16 v[184:187], a[240:243], v[76:79], v[184:187]
 v_mfma_f32_16x16x32_bf16 v[192:195], a[248:251], v[72:75], v[192:195]
 v_mfma_f32_16x16x32_bf16 v[196:199], a[252:255], v[72:75], v[196:199]
 v_mfma_f32_16x16x32_bf16 v[204:207], a[252:255], v[76:79], v[204:207]
 v_mfma_f32_16x16x32_bf16 v[200:203], a[248:251], v[76:79], v[200:203]
 s_cmp_eq_u32 s72, -1
 s_cbranch_scc0 Lw_Qatt
 v_mov_b32 v3, 0
news_72:
 global_load_dword v4, v3, s[42:43] offset:132 sc1
 s_waitcnt vmcnt(0)
 v_readfirstlane_b32 s7, v4
 s_nop 0
 s_bfe_u32 s64, s7, 0x10005
 s_and_b32 s7, s7, 27
 s_cmp_eq_u32 s7, 27
 s_cbranch_scc1 newsok_73
 s_sleep 2
 s_sub_u32 s46, s46, 1
 s_cbranch_scc0 news_72
 s_mov_b32 s46, 0
 s_branch newsok_73
newsok_73:
 s_add_u32 s82, s65, 0
 buffer_load_dwordx4 v[16:19], v2, s[48:51], s82 offen offset:0 sc1
 buffer_load_dwordx4 v[20:23], v2, s[48:51], s82 offen offset:256 sc1
 buffer_load_dwordx4 v[24:27], v2, s[48:51], s82 offen offset:2048 sc1
 buffer_load_dwordx4 v[28:31], v2, s[48:51], s82 offen offset:2304 sc1
 s_add_u32 s82, s65, 4096
 buffer_load_dwordx4 v[32:35], v2, s[48:51], s82 offen offset:0 sc1
 buffer_load_dwordx4 v[36:39], v2, s[48:51], s82 offen offset:256 sc1
 buffer_load_dwordx4 v[40:43], v2, s[48:51], s82 offen offset:2048 sc1
 buffer_load_dwordx4 v[44:47], v2, s[48:51], s82 offen offset:2304 sc1
 s_add_u32 s82, s65, 8192
 buffer_load_dwordx4 v[48:51], v2, s[48:51], s82 offen offset:0 sc1
 buffer_load_dwordx4 v[52:55], v2, s[48:51], s82 offen offset:256 sc1
 buffer_load_dwordx4 v[56:59], v2, s[48:51], s82 offen offset:2048 sc1
 buffer_load_dwordx4 v[60:63], v2, s[48:51], s82 offen offset:2304 sc1
 s_add_u32 s82, s65, 12288
 buffer_load_dwordx4 v[64:67], v2, s[48:51], s82 offen offset:0 sc1
 buffer_load_dwordx4 v[68:71], v2, s[48:51], s82 offen offset:256 sc1
 buffer_load_dwordx4 v[72:75], v2, s[48:51], s82 offen offset:2048 sc1
 buffer_load_dwordx4 v[76:79], v2, s[48:51], s82 offen offset:2304 sc1
 s_lshr_b32 s66, s62, 1
 s_lshl_b32 s66, s66, 1
 s_add_u32 s66, s66, s64
 s_lshl_b32 s66, s66, 1
 s_and_b32 s69, s62, 1
 s_add_u32 s66, s66, s69
 s_lshl_b32 s66, s66, 12
 s_add_u32 s66, s66, 155189248
 s_waitcnt vmcnt(0)
 s_branch Lw_Qnext
Lw_Qatt:
 ds_read_b128 v[48:51], v237 offset:0
 ds_read_b128 v[52:55], v237 offset:1024
 ds_read_b128 v[56:59], v237 offset:2048
 ds_read_b128 v[60:63], v237 offset:3072
 ds_read_b128 v[64:67], v237 offset:4096
 ds_read_b128 v[68:71], v237 offset:5120
 ds_read_b128 v[72:75], v237 offset:6144
 ds_read_b128 v[76:79], v237 offset:7168
 s_waitcnt vmcnt(0)
 s_waitcnt lgkmcnt(7)
 v_mfma_f32_32x32x16_bf16 v[208:223], v[16:19], v[48:51], 0
 s_waitcnt lgkmcnt(6)
 v_mfma_f32_32x32x16_bf16 v[208:223], v[20:23], v[52:55], v[208:223]
 s_waitcnt lgkmcnt(5)
 v_mfma_f32_32x32x16_bf16 v[208:223], v[24:27], v[56:59], v[208:223]
 s_waitcnt lgkmcnt(4)
 v_mfma_f32_32x32x16_bf16 v[208:223], v[28:31], v[60:63], v[208:223]
 s_waitcnt lgkmcnt(3)
 v_mfma_f32_32x32x16_bf16 v[208:223], v[32:35], v[64:67], v[208:223]
 s_waitcnt lgkmcnt(2)
 v_mfma_f32_32x32x16_bf16 v[208:223], v[36:39], v[68:71], v[208:223]
 s_waitcnt lgkmcnt(1)
 v_mfma_f32_32x32x16_bf16 v[208:223], v[40:43], v[72:75], v[208:223]
 s_waitcnt lgkmcnt(0)
 v_mfma_f32_32x32x16_bf16 v[208:223], v[44:47], v[76:79], v[208:223]
 s_cmp_eq_u32 s79, 1
 s_cbranch_scc1 gotm_74
 s_add_u32 s71, s77, 4096
 s_mov_b64 exec, 15
w_75:
 buffer_load_dword v4, v1, s[48:51], s71 offen sc1
 s_waitcnt vmcnt(0)
 v_cmp_gt_u32 vcc, s75, v4
 s_cbranch_vccz wok_76
 s_sleep 2
 s_sub_u32 s46, s46, 1
 s_cbranch_scc0 w_75
 s_mov_b32 s46, 0
 s_branch wok_76
wok_76:
 s_mov_b64 exec, -1
 s_lshl_b32 s69, s4, 12
 s_add_u32 m0, s69, 147456
 s_nop 0
 buffer_load_dwordx4 v1, s[48:51], s78 offen offset:0 sc1 lds
 buffer_load_dwordx4 v1, s[48:51], s78 offen offset:1024 sc1 lds
 buffer_load_dwordx4 v1, s[48:51], s78 offen offset:2048 sc1 lds
 buffer_load_dwordx4 v1, s[48:51], s78 offen offset:3072 sc1 lds
 s_waitcnt vmcnt(0)
gotm_74:
 ds_read_b128 v[96:99], v232 offset:0
 ds_read_b128 v[100:103], v232 offset:512
 ds_read_b128 v[104:107], v232 offset:1024
 ds_read_b128 v[108:111], v232 offset:1536
 ds_read_b128 v[112:115], v232 offset:2048
 ds_read_b128 v[116:119], v232 offset:2560
 ds_read_b128 v[120:123], v232 offset:3072
 ds_read_b128 v[124:127], v232 offset:3584
 s_waitcnt lgkmcnt(7)
 v_mfma_f32_32x32x16_bf16 v[80:95], v[96:99], v[48:51], 0
 s_add_u32 s82, s65, 0
 buffer_load_dwordx4 v[16:19], v2, s[48:51], s82 offen offset:0 sc1
 v_mov_b32 v240, 0xceabdc6e
 v_cndmask_b32 v208, v240, v208, s[8:9]
 v_cndmask_b32 v209, v240, v209, s[10:11]
 s_waitcnt lgkmcnt(6)
 v_mfma_f32_32x32x16_bf16 v[80:95], v[100:103], v[52:55], v[80:95]
 buffer_load_dwordx4 v[20:23], v2, s[48:51], s82 offen offset:256 sc1
 v_cndmask_b32 v210, v240, v210, s[12:13]
 v_cndmask_b32 v211, v240, v211, s[14:15]
 v_cndmask_b32 v212, v240, v212, s[16:17]
 s_waitcnt lgkmcnt(5)
 v_mfma_f32_32x32x16_bf16 v[80:95], v[104:107], v[56:59], v[80:95]
 buffer_load_dwordx4 v[24:27], v2, s[48:51], s82 offen offset:2048 sc1
 v_cndmask_b32 v213, v240, v213, s[18:19]
 v_cndmask_b32 v214, v240, v214, s[20:21]
 v_cndmask_b32 v215, v240, v215, s[22:23]
 s_waitcnt lgkmcnt(4)
 v_mfma_f32_32x32x16_bf16 v[80:95], v[108:111], v[60:63], v[80:95]
 buffer_load_dwordx4 v[28:31], v2, s[48:51], s82 offen offset:2304 sc1
 v_cndmask_b32 v216, v240, v216, s[24:25]
 v_cndmask_b32 v217, v240, v217, s[26:27]
 v_cndmask_b32 v218, v240, v218, s[28:29]
 s_waitcnt lgkmcnt(3)
 v_mfma_f32_32x32x16_bf16 v[80:95], v[112:115], v[64:67], v[80:95]
 s_add_u32 s82, s65, 4096
 buffer_load_dwordx4 v[32:35], v2, s[48:51], s82 offen offset:0 sc1
 v_cndmask_b32 v219, v240, v219, s[30:31]
 v_cndmask_b32 v220, v240, v220, s[32:33]
 v_cndmask_b32 v221, v240, v221, s[34:35]
 s_waitcnt lgkmcnt(2)
 v_mfma_f32_32x32x16_bf16 v[80:95], v[116:119], v[68:71], v[80:95]
 buffer_load_dwordx4 v[36:39], v2, s[48:51], s82 offen offset:256 sc1
 v_cndmask_b32 v222, v240, v222, s[36:37]
 v_cndmask_b32 v223, v240, v223, s[38:39]
 v_max3_f32 v240, v208, v209, v210
 s_waitcnt lgkmcnt(1)
 v_mfma_f32_32x32x16_bf16 v[80:95], v[120:123], v[72:75], v[80:95]
 buffer_load_dwordx4 v[40:43], v2, s[48:51], s82 offen offset:2048 sc1
 v_max3_f32 v240, v240, v211, v212
 v_max3_f32 v240, v240, v213, v214
 v_max3_f32 v240, v240, v215, v216
 s_waitcnt lgkmcnt(0)
 v_mfma_f32_32x32x16_bf16 v[80:95], v[124:127], v[76:79], v[80:95]
 buffer_load_dwordx4 v[44:47], v2, s[48:51], s82 offen offset:2304 sc1
 v_max3_f32 v240, v240, v217, v218
 v_max3_f32 v240, v240, v219, v220
 v_max3_f32 v240, v240, v221, v222
 v_max_f32 v240, v240, v223
 s_add_u32 s82, s65, 8192
 buffer_load_dwordx4 v[48:51], v2, s[48:51], s82 offen offset:0 sc1
 buffer_load_dwordx4 v[52:55], v2, s[48:51], s82 offen offset:256 sc1
 s_nop 3
 v_max3_f32 v240, v240, v80, v81
 v_max3_f32 v240, v240, v82, v83
 v_mov_b32 v242, v240
 s_nop 1
 v_permlane32_swap_b32 v240, v242
 v_max_f32 v240, v240, v242
 v_pk_add_f32 v[208:209], v[208:209], v[240:241] op_sel_hi:[1,0] neg_lo:[0,1] neg_hi:[0,1]
 v_pk_add_f32 v[210:211], v[210:211], v[240:241] op_sel_hi:[1,0] neg_lo:[0,1] neg_hi:[0,1]
 v_pk_add_f32 v[212:213], v[212:213], v[240:241] op_sel_hi:[1,0] neg_lo:[0,1] neg_hi:[0,1]
 v_pk_add_f32 v[214:215], v[214:215], v[240:241] op_sel_hi:[1,0] neg_lo:[0,1] neg_hi:[0,1]
 v_pk_add_f32 v[216:217], v[216:217], v[240:241] op_sel_hi:[1,0] neg_lo:[0,1] neg_hi:[0,1]
 v_pk_add_f32 v[218:219], v[218:219], v[240:241] op_sel_hi:[1,0] neg_lo:[0,1] neg_hi:[0,1]
 v_pk_add_f32 v[220:221], v[220:221], v[240:241] op_sel_hi:[1,0] neg_lo:[0,1] neg_hi:[0,1]
 v_pk_add_f32 v[222:223], v[222:223], v[240:241] op_sel_hi:[1,0] neg_lo:[0,1] neg_hi:[0,1]
 v_pk_add_f32 v[224:225], v[80:81], v[240:241] op_sel_hi:[1,0] neg_lo:[0,1] neg_hi:[0,1]
 v_pk_add_f32 v[226:227], v[82:83], v[240:241] op_sel_hi:[1,0] neg_lo:[0,1] neg_hi:[0,1]
 ds_read_b128 v[80:83], v238 offset:0
 ds_read_b128 v[84:87], v238 offset:1024
 ds_read_b32 v88, v233 offset:0
 ds_read_b32 v89, v233 offset:256
 ds_read_b128 v[92:95], v238 offset:2048
 ds_read_b128 v[96:99], v238 offset:3072
 ds_read_b32 v100, v233 offset:1024
 ds_read_b32 v101, v233 offset:1280
 v_mov_b64 v[90:91], 0
 v_mov_b64 v[102:103], 0
 v_mov_b64 v[254:255], 0
 v_exp_f32 v208, v208
 v_exp_f32 v209, v209
 v_exp_f32 v210, v210
 v_exp_f32 v211, v211
 buffer_load_dwordx4 v[56:59], v2, s[48:51], s82 offen offset:2048 sc1
 v_exp_f32 v212, v212
 v_exp_f32 v213, v213
 buffer_load_dwordx4 v[60:63], v2, s[48:51], s82 offen offset:2304 sc1
 v_pk_add_f32 v[242:243], v[208:209], v[210:211]
 v_exp_f32 v214, v214
 v_exp_f32 v215, v215
 s_add_u32 s82, s65, 12288
 buffer_load_dwordx4 v[64:67], v2, s[48:51], s82 offen offset:0 sc1
 v_pk_add_f32 v[242:243], v[242:243], v[212:213]
 v_exp_f32 v216, v216
 v_exp_f32 v217, v217
 buffer_load_dwordx4 v[68:71], v2, s[48:51], s82 offen offset:256 sc1
 v_pk_add_f32 v[242:243], v[242:243], v[214:215]
 v_exp_f32 v218, v218
 v_exp_f32 v219, v219
 buffer_load_dwordx4 v[72:75], v2, s[48:51], s82 offen offset:2048 sc1
 v_pk_add_f32 v[242:243], v[242:243], v[216:217]
 v_exp_f32 v220, v220
 v_exp_f32 v221, v221
 buffer_load_dwordx4 v[76:79], v2, s[48:51], s82 offen offset:2304 sc1
 v_pk_add_f32 v[242:243], v[242:243], v[218:219]
 v_exp_f32 v222, v222
 v_exp_f32 v223, v223
 v_pk_add_f32 v[242:243], v[242:243], v[220:221]
 v_exp_f32 v224, v224
 v_exp_f32 v225, v225
 v_pk_add_f32 v[242:243], v[242:243], v[222:223]
 v_exp_f32 v226, v226
 v_exp_f32 v227, v227
 v_pk_add_f32 v[242:243], v[242:243], v[224:225]
 v_pk_add_f32 v[242:243], v[242:243], v[226:227]
 v_add_f32 v242, v242, v243
 v_mov_b32 v243, v242
 s_nop 1
 v_permlane32_swap_b32 v242, v243
 v_add_f32 v242, v242, v243
 v_rcp_f32 v242, v242
 s_nop 0
 v_pk_mul_f32 v[208:209], v[208:209], v[242:243] op_sel_hi:[1,0]
 v_cvt_pk_bf16_f32 v244, v208, v209
 v_pk_mul_f32 v[210:211], v[210:211], v[242:243] op_sel_hi:[1,0]
 v_cvt_pk_bf16_f32 v245, v210, v211
 v_pk_mul_f32 v[212:213], v[212:213], v[242:243] op_sel_hi:[1,0]
 v_cvt_pk_bf16_f32 v246, v212, v213
 v_pk_mul_f32 v[214:215], v[214:215], v[242:243] op_sel_hi:[1,0]
 v_cvt_pk_bf16_f32 v247, v214, v215
 v_pk_mul_f32 v[216:217], v[216:217], v[242:243] op_sel_hi:[1,0]
 v_cvt_pk_bf16_f32 v248, v216, v217
 v_pk_mul_f32 v[218:219], v[218:219], v[242:243] op_sel_hi:[1,0]
 v_cvt_pk_bf16_f32 v249, v218, v219
 v_pk_mul_f32 v[220:221], v[220:221], v[242:243] op_sel_hi:[1,0]
 v_cvt_pk_bf16_f32 v250, v220, v221
 v_pk_mul_f32 v[222:223], v[222:223], v[242:243] op_sel_hi:[1,0]
 v_cvt_pk_bf16_f32 v251, v222, v223
 v_pk_mul_f32 v[224:225], v[224:225], v[242:243] op_sel_hi:[1,0]
 v_cvt_pk_bf16_f32 v252, v224, v225
 v_pk_mul_f32 v[226:227], v[226:227], v[242:243] op_sel_hi:[1,0]
 v_cvt_pk_bf16_f32 v253, v226, v227
 s_waitcnt lgkmcnt(4)
 v_mfma_f32_32x32x16_bf16 v[104:119], v[80:83], v[244:247], 0
 v_mfma_f32_32x32x16_bf16 v[104:119], v[84:87], v[248:251], v[104:119]
 v_mfma_f32_32x32x16_bf16 v[104:119], v[88:91], v[252:255], v[104:119]
 ds_read_b128 v[80:83], v238 offset:4096
 ds_read_b128 v[84:87], v238 offset:5120
 ds_read_b32 v88, v233 offset:2048
 ds_read_b32 v89, v233 offset:2304
 s_waitcnt lgkmcnt(4)
 v_mfma_f32_32x32x16_bf16 v[120:135], v[92:95], v[244:247], 0
 v_mfma_f32_32x32x16_bf16 v[120:135], v[96:99], v[248:251], v[120:135]
 s_add_u32 s69, s67, 33554432
 v_cvt_pk_bf16_f32 v208, v104, v105
 v_cvt_pk_bf16_f32 v209, v106, v107
 v_cvt_pk_bf16_f32 v210, v108, v109
 v_cvt_pk_bf16_f32 v211, v110, v111
 buffer_store_dwordx4 v[208:211], v1, s[48:51], s69 offen offset:0
 v_mfma_f32_32x32x16_bf16 v[120:135], v[100:103], v[252:255], v[120:135]
 v_cvt_pk_bf16_f32 v212, v112, v113
 v_cvt_pk_bf16_f32 v213, v114, v115
 v_cvt_pk_bf16_f32 v214, v116, v117
 v_cvt_pk_bf16_f32 v215, v118, v119
 buffer_store_dwordx4 v[212:215], v1, s[48:51], s69 offen offset:1024
 ds_read_b128 v[92:95], v238 offset:6144
 ds_read_b128 v[96:99], v238 offset:7168
 ds_read_b32 v100, v233 offset:3072
 ds_read_b32 v101, v233 offset:3328
 s_waitcnt lgkmcnt(4)
 v_mfma_f32_32x32x16_bf16 v[104:119], v[80:83], v[244:247], 0
 v_mfma_f32_32x32x16_bf16 v[104:119], v[84:87], v[248:251], v[104:119]
 s_add_u32 s69, s67, 33556480
 v_cvt_pk_bf16_f32 v216, v120, v121
 v_cvt_pk_bf16_f32 v217, v122, v123
 v_cvt_pk_bf16_f32 v218, v124, v125
 v_cvt_pk_bf16_f32 v219, v126, v127
 buffer_store_dwordx4 v[216:219], v1, s[48:51], s69 offen offset:0
 v_mfma_f32_32x32x16_bf16 v[104:119], v[88:91], v[252:255], v[104:119]
 v_cvt_pk_bf16_f32 v220, v128, v129
 v_cvt_pk_bf16_f32 v221, v130, v131
 v_cvt_pk_bf16_f32 v222, v132, v133
 v_cvt_pk_bf16_f32 v223, v134, v135
 buffer_store_dwordx4 v[220:223], v1, s[48:51], s69 offen offset:1024
 s_waitcnt lgkmcnt(0)
 v_mfma_f32_32x32x16_bf16 v[120:135], v[92:95], v[244:247], 0
 v_mfma_f32_32x32x16_bf16 v[120:135], v[96:99], v[248:251], v[120:135]
 s_add_u32 s69, s67, 33558528
 v_cvt_pk_bf16_f32 v208, v104, v105
 v_cvt_pk_bf16_f32 v209, v106, v107
 v_cvt_pk_bf16_f32 v210, v108, v109
 v_cvt_pk_bf16_f32 v211, v110, v111
 buffer_store_dwordx4 v[208:211], v1, s[48:51], s69 offen offset:0
 v_mfma_f32_32x32x16_bf16 v[120:135], v[100:103], v[252:255], v[120:135]
 v_cvt_pk_bf16_f32 v212, v112, v113
 v_cvt_pk_bf16_f32 v213, v114, v115
 v_cvt_pk_bf16_f32 v214, v116, v117
 v_cvt_pk_bf16_f32 v215, v118, v119
 buffer_store_dwordx4 v[212:215], v1, s[48:51], s69 offen offset:1024
 s_add_u32 s69, s67, 33560576
 s_nop 5
 v_cvt_pk_bf16_f32 v216, v120, v121
 v_cvt_pk_bf16_f32 v217, v122, v123
 v_cvt_pk_bf16_f32 v218, v124, v125
 v_cvt_pk_bf16_f32 v219, v126, v127
 buffer_store_dwordx4 v[216:219], v1, s[48:51], s69 offen offset:0
 v_cvt_pk_bf16_f32 v220, v128, v129
 v_cvt_pk_bf16_f32 v221, v130, v131
 v_cvt_pk_bf16_f32 v222, v132, v133
 v_cvt_pk_bf16_f32 v223, v134, v135
 buffer_store_dwordx4 v[220:223], v1, s[48:51], s69 offen offset:1024
 s_cmp_eq_u32 s72, 15
 s_cbranch_scc0 Lw_Qnext
 s_waitcnt vmcnt(0)
 v_mov_b32 v3, 16
 v_mov_b32 v4, 0
 s_mov_b64 exec, 1
 buffer_store_dword v3, v4, s[48:51], s68 offen
 s_mov_b64 exec, -1
 s_branch Lw_end
Lw_Qnext:
 v_swap_b32 v235, v236
 v_subrev_u32 v237, s73, v237
 s_sub_u32 s73, 0, s73
 s_add_u32 s72, s72, 1
 s_add_u32 s65, s65, 0x10000
 s_branch Lw_Qloop
Lw_end:
 s_endpgm
Lw_K:
 s_lshl_b32 s67, s62, 2
 s_add_u32 s67, s67, s4
 s_lshl_b32 s67, s67, 11
 s_add_u32 s67, s67, 16777216
 s_add_u32 s82, s65, 0
 buffer_load_dwordx4 v[16:19], v2, s[48:51], s82 offen offset:0 sc1
 buffer_load_dwordx4 v[20:23], v2, s[48:51], s82 offen offset:256 sc1
 buffer_load_dwordx4 v[24:27], v2, s[48:51], s82 offen offset:2048 sc1
 buffer_load_dwordx4 v[28:31], v2, s[48:51], s82 offen offset:2304 sc1
 s_add_u32 s82, s65, 4096
 buffer_load_dwordx4 v[32:35], v2, s[48:51], s82 offen offset:0 sc1
 buffer_load_dwordx4 v[36:39], v2, s[48:51], s82 offen offset:256 sc1
 buffer_load_dwordx4 v[40:43], v2, s[48:51], s82 offen offset:2048 sc1
 buffer_load_dwordx4 v[44:47], v2, s[48:51], s82 offen offset:2304 sc1
 s_add_u32 s82, s65, 8192
 buffer_load_dwordx4 v[48:51], v2, s[48:51], s82 offen offset:0 sc1
 buffer_load_dwordx4 v[52:55], v2, s[48:51], s82 offen offset:256 sc1
 buffer_load_dwordx4 v[56:59], v2, s[48:51], s82 offen offset:2048 sc1
 buffer_load_dwordx4 v[60:63], v2, s[48:51], s82 offen offset:2304 sc1
 s_add_u32 s82, s65, 12288
 buffer_load_dwordx4 v[64:67], v2, s[48:51], s82 offen offset:0 sc1
 buffer_load_dwordx4 v[68:71], v2, s[48:51], s82 offen offset:256 sc1
 buffer_load_dwordx4 v[72:75], v2, s[48:51], s82 offen offset:2048 sc1
 buffer_load_dwordx4 v[76:79], v2, s[48:51], s82 offen offset:2304 sc1
 s_add_u32 s65, s65, 0x10000
 v_mov_b32 v208, -1
 v_mov_b32 v209, -1
 v_mov_b32 v210, -1
 v_mov_b32 v211, -1
 s_lshl_b32 s69, s61, 1
 s_lshr_b32 s70, s4, 1
 s_add_u32 s69, s69, s70
 s_lshl_b32 s74, s69, 14
 s_and_b32 s69, s4, 1
 s_lshl_b32 s69, s69, 12
 s_add_u32 s74, s74, s69
 s_lshl_b32 s69, s47, 10
 s_add_u32 s74, s74, s69
 s_add_u32 s74, s74, 134217728
 s_waitcnt vmcnt(14)
 v_mfma_f32_16x16x32_bf16 v[80:83], a[0:3], v[16:19], 0
 v_mfma_f32_16x16x32_bf16 v[84:87], a[4:7], v[16:19], 0
 v_mfma_f32_16x16x32_bf16 v[92:95], a[4:7], v[20:23], 0
 v_mfma_f32_16x16x32_bf16 v[88:91], a[0:3], v[20:23], 0
 v_mfma_f32_16x16x32_bf16 v[96:99], a[8:11], v[16:19], 0
 v_mfma_f32_16x16x32_bf16 v[100:103], a[12:15], v[16:19], 0
 v_mfma_f32_16x16x32_bf16 v[108:111], a[12:15], v[20:23], 0
 v_mfma_f32_16x16x32_bf16 v[104:107], a[8:11], v[20:23], 0
 v_mfma_f32_16x16x32_bf16 v[112:115], a[16:19], v[16:19], 0
 v_mfma_f32_16x16x32_bf16 v[116:119], a[20:23], v[16:19], 0
 v_mfma_f32_16x16x32_bf16 v[124:127], a[20:23], v[20:23], 0
 v_mfma_f32_16x16x32_bf16 v[120:123], a[16:19], v[20:23], 0
 v_mfma_f32_16x16x32_bf16 v[128:131], a[24:27], v[16:19], 0
 v_mfma_f32_16x16x32_bf16 v[132:135], a[28:31], v[16:19], 0
 v_mfma_f32_16x16x32_bf16 v[140:143], a[28:31], v[20:23], 0
 v_mfma_f32_16x16x32_bf16 v[136:139], a[24:27], v[20:23], 0
 s_waitcnt vmcnt(12)
 v_mfma_f32_16x16x32_bf16 v[80:83], a[32:35], v[24:27], v[80:83]
 s_add_u32 s82, s65, 0
 buffer_load_dwordx4 v[16:19], v2, s[48:51], s82 offen offset:0 sc1
 v_mfma_f32_16x16x32_bf16 v[84:87], a[36:39], v[24:27], v[84:87]
 v_mfma_f32_16x16x32_bf16 v[92:95], a[36:39], v[28:31], v[92:95]
 buffer_load_dwordx4 v[20:23], v2, s[48:51], s82 offen offset:256 sc1
 v_mfma_f32_16x16x32_bf16 v[88:91], a[32:35], v[28:31], v[88:91]
 v_mfma_f32_16x16x32_bf16 v[96:99], a[40:43], v[24:27], v[96:99]
 v_mfma_f32_16x16x32_bf16 v[100:103], a[44:47], v[24:27], v[100:103]
 v_mfma_f32_16x16x32_bf16 v[108:111], a[44:47], v[28:31], v[108:111]
 v_mfma_f32_16x16x32_bf16 v[104:107], a[40:43], v[28:31], v[104:107]
 v_mfma_f32_16x16x32_bf16 v[112:115], a[48:51], v[24:27], v[112:115]
 v_mfma_f32_16x16x32_bf16 v[116:119], a[52:55], v[24:27], v[116:119]
 v_mfma_f32_16x16x32_bf16 v[124:127], a[52:55], v[28:31], v[124:127]
 v_mfma_f32_16x16x32_bf16 v[120:123], a[48:51], v[28:31], v[120:123]
 v_mfma_f32_16x16x32_bf16 v[128:131], a[56:59], v[24:27], v[128:131]
 v_mfma_f32_16x16x32_bf16 v[132:135], a[60:63], v[24:27], v[132:135]
 v_mfma_f32_16x16x32_bf16 v[140:143], a[60:63], v[28:31], v[140:143]
 v_mfma_f32_16x16x32_bf16 v[136:139], a[56:59], v[28:31], v[136:139]
 s_waitcnt vmcnt(12)
 v_mfma_f32_16x16x32_bf16 v[80:83], a[64:67], v[32:35], v[80:83]
 buffer_load_dwordx4 v[24:27], v2, s[48:51], s82 offen offset:2048 sc1
 v_mfma_f32_16x16x32_bf16 v[84:87], a[68:71], v[32:35], v[84:87]
 v_mfma_f32_16x16x32_bf16 v[92:95], a[68:71], v[36:39], v[92:95]
 buffer_load_dwordx4 v[28:31], v2, s[48:51], s82 offen offset:2304 sc1
 v_mfma_f32_16x16x32_bf16 v[88:91], a[64:67], v[36:39], v[88:91]
 v_mfma_f32_16x16x32_bf16 v[96:99], a[72:75], v[32:35], v[96:99]
 v_mfma_f32_16x16x32_bf16 v[100:103], a[76:79], v[32:35], v[100:103]
 v_mfma_f32_16x16x32_bf16 v[108:111], a[76:79], v[36:39], v[108:111]
 v_mfma_f32_16x16x32_bf16 v[104:107], a[72:75], v[36:39], v[104:107]
 v_mfma_f32_16x16x32_bf16 v[112:115], a[80:83], v[32:35], v[112:115]
 v_mfma_f32_16x16x32_bf16 v[116:119], a[84:87], v[32:35], v[116:119]
 v_mfma_f32_16x16x32_bf16 v[124:127], a[84:87], v[36:39], v[124:127]
 v_mfma_f32_16x16x32_bf16 v[120:123], a[80:83], v[36:39], v[120:123]
 v_mfma_f32_16x16x32_bf16 v[128:131], a[88:91], v[32:35], v[128:131]
 v_mfma_f32_16x16x32_bf16 v[132:135], a[92:95], v[32:35], v[132:135]
 v_mfma_f32_16x16x32_bf16 v[140:143], a[92:95], v[36:39], v[140:143]
 v_mfma_f32_16x16x32_bf16 v[136:139], a[88:91], v[36:39], v[136:139]
 s_waitcnt vmcnt(12)
 v_mfma_f32_16x16x32_bf16 v[80:83], a[96:99], v[40:43], v[80:83]
 s_add_u32 s82, s65, 4096
 buffer_load_dwordx4 v[32:35], v2, s[48:51], s82 offen offset:0 sc1
 v_mfma_f32_16x16x32_bf16 v[84:87], a[100:103], v[40:43], v[84:87]
 v_mfma_f32_16x16x32_bf16 v[92:95], a[100:103], v[44:47], v[92:95]
 buffer_load_dwordx4 v[36:39], v2, s[48:51], s82 offen offset:256 sc1
 v_mfma_f32_16x16x32_bf16 v[88:91], a[96:99], v[44:47], v[88:91]
 v_mfma_f32_16x16x32_bf16 v[96:99], a[104:107], v[40:43], v[96:99]
 v_mfma_f32_16x16x32_bf16 v[100:103], a[108:111], v[40:43], v[100:103]
 v_mfma_f32_16x16x32_bf16 v[108:111], a[108:111], v[44:47], v[108:111]
 v_mfma_f32_16x16x32_bf16 v[104:107], a[104:107], v[44:47], v[104:107]
 v_mfma_f32_16x16x32_bf16 v[112:115], a[112:115], v[40:43], v[112:115]
 v_mfma_f32_16x16x32_bf16 v[116:119], a[116:119], v[40:43], v[116:119]
 v_mfma_f32_16x16x32_bf16 v[124:127], a[116:119], v[44:47], v[124:127]
 v_mfma_f32_16x16x32_bf16 v[120:123], a[112:115], v[44:47], v[120:123]
 v_mfma_f32_16x16x32_bf16 v[128:131], a[120:123], v[40:43], v[128:131]
 v_mfma_f32_16x16x32_bf16 v[132:135], a[124:127], v[40:43], v[132:135]
 v_mfma_f32_16x16x32_bf16 v[140:143], a[124:127], v[44:47], v[140:143]
 v_mfma_f32_16x16x32_bf16 v[136:139], a[120:123], v[44:47], v[136:139]
 s_waitcnt vmcnt(12)
 v_mfma_f32_16x16x32_bf16 v[80:83], a[128:131], v[48:51], v[80:83]
 buffer_load_dwordx4 v[40:43], v2, s[48:51], s82 offen offset:2048 sc1
 v_mfma_f32_16x16x32_bf16 v[84:87], a[132:135], v[48:51], v[84:87]
 v_mfma_f32_16x16x32_bf16 v[92:95], a[132:135], v[52:55], v[92:95]
 buffer_load_dwordx4 v[44:47], v2, s[48:51], s82 offen offset:2304 sc1
 v_mfma_f32_16x16x32_bf16 v[88:91], a[128:131], v[52:55], v[88:91]
 v_mfma_f32_16x16x32_bf16 v[96:99], a[136:139], v[48:51], v[96:99]
 v_mfma_f32_16x16x32_bf16 v[100:103], a[140:143], v[48:51], v[100:103]
 v_mfma_f32_16x16x32_bf16 v[108:111], a[140:143], v[52:55], v[108:111]
 v_mfma_f32_16x16x32_bf16 v[104:107], a[136:139], v[52:55], v[104:107]
 v_mfma_f32_16x16x32_bf16 v[112:115], a[144:147], v[48:51], v[112:115]
 v_mfma_f32_16x16x32_bf16 v[116:119], a[148:151], v[48:51], v[116:119]
 v_mfma_f32_16x16x32_bf16 v[124:127], a[148:151], v[52:55], v[124:127]
 v_mfma_f32_16x16x32_bf16 v[120:123], a[144:147], v[52:55], v[120:123]
 v_mfma_f32_16x16x32_bf16 v[128:131], a[152:155], v[48:51], v[128:131]
 v_mfma_f32_16x16x32_bf16 v[132:135], a[156:159], v[48:51], v[132:135]
 v_mfma_f32_16x16x32_bf16 v[140:143], a[156:159], v[52:55], v[140:143]
 v_mfma_f32_16x16x32_bf16 v[136:139], a[152:155], v[52:55], v[136:139]
 s_waitcnt vmcnt(12)
 v_mfma_f32_16x16x32_bf16 v[80:83], a[160:163], v[56:59], v[80:83]
 s_add_u32 s82, s65, 8192
 buffer_load_dwordx4 v[48:51], v2, s[48:51], s82 offen offset:0 sc1
 v_mfma_f32_16x16x32_bf16 v[84:87], a[164:167], v[56:59], v[84:87]
 v_mfma_f32_16x16x32_bf16 v[92:95], a[164:167], v[60:63], v[92:95]
 buffer_load_dwordx4 v[52:55], v2, s[48:51], s82 offen offset:256 sc1
 v_mfma_f32_16x16x32_bf16 v[88:91], a[160:163], v[60:63], v[88:91]
 v_mfma_f32_16x16x32_bf16 v[96:99], a[168:171], v[56:59], v[96:99]
 v_mfma_f32_16x16x32_bf16 v[100:103], a[172:175], v[56:59], v[100:103]
 v_mfma_f32_16x16x32_bf16 v[108:111], a[172:175], v[60:63], v[108:111]
 v_mfma_f32_16x16x32_bf16 v[104:107], a[168:171], v[60:63], v[104:107]
 v_mfma_f32_16x16x32_bf16 v[112:115], a[176:179], v[56:59], v[112:115]
 v_mfma_f32_16x16x32_bf16 v[116:119], a[180:183], v[56:59], v[116:119]
 v_mfma_f32_16x16x32_bf16 v[124:127], a[180:183], v[60:63], v[124:127]
 v_mfma_f32_16x16x32_bf16 v[120:123], a[176:179], v[60:63], v[120:123]
 v_mfma_f32_16x16x32_bf16 v[128:131], a[184:187], v[56:59], v[128:131]
 v_mfma_f32_16x16x32_bf16 v[132:135], a[188:191], v[56:59], v[132:135]
 v_mfma_f32_16x16x32_bf16 v[140:143], a[188:191], v[60:63], v[140:143]
 v_mfma_f32_16x16x32_bf16 v[136:139], a[184:187], v[60:63], v[136:139]
 s_waitcnt vmcnt(12)
 v_mfma_f32_16x16x32_bf16 v[80:83], a[192:195], v[64:67], v[80:83]
 buffer_load_dwordx4 v[56:59], v2, s[48:51], s82 offen offset:2048 sc1
 v_mfma_f32_16x16x32_bf16 v[84:87], a[196:199], v[64:67], v[84:87]
 v_mfma_f32_16x16x32_bf16 v[92:95], a[196:199], v[68:71], v[92:95]
 buffer_load_dwordx4 v[60:63], v2, s[48:51], s82 offen offset:2304 sc1
 v_mfma_f32_16x16x32_bf16 v[88:91], a[192:195], v[68:71], v[88:91]
 v_mfma_f32_16x16x32_bf16 v[96:99], a[200:203], v[64:67], v[96:99]
 v_mfma_f32_16x16x32_bf16 v[100:103], a[204:207], v[64:67], v[100:103]
 v_mfma_f32_16x16x32_bf16 v[108:111], a[204:207], v[68:71], v[108:111]
 v_mfma_f32_16x16x32_bf16 v[104:107], a[200:203], v[68:71], v[104:107]
 v_mfma_f32_16x16x32_bf16 v[112:115], a[208:211], v[64:67], v[112:115]
 v_mfma_f32_16x16x32_bf16 v[116:119], a[212:215], v[64:67], v[116:119]
 v_mfma_f32_16x16x32_bf16 v[124:127], a[212:215], v[68:71], v[124:127]
 v_mfma_f32_16x16x32_bf16 v[120:123], a[208:211], v[68:71], v[120:123]
 v_mfma_f32_16x16x32_bf16 v[128:131], a[216:219], v[64:67], v[128:131]
 v_mfma_f32_16x16x32_bf16 v[132:135], a[220:223], v[64:67], v[132:135]
 v_mfma_f32_16x16x32_bf16 v[140:143], a[220:223], v[68:71], v[140:143]
 v_mfma_f32_16x16x32_bf16 v[136:139], a[216:219], v[68:71], v[136:139]
 s_waitcnt vmcnt(12)
 v_mfma_f32_16x16x32_bf16 v[80:83], a[224:227], v[72:75], v[80:83]
 s_add_u32 s82, s65, 12288
 buffer_load_dwordx4 v[64:67], v2, s[48:51], s82 offen offset:0 sc1
 v_mfma_f32_16x16x32_bf16 v[84:87], a[228:231], v[72:75], v[84:87]
 v_mfma_f32_16x16x32_bf16 v[92:95], a[228:231], v[76:79], v[92:95]
 buffer_load_dwordx4 v[68:71], v2, s[48:51], s82 offen offset:256 sc1
 v_mfma_f32_16x16x32_bf16 v[88:91], a[224:227], v[76:79], v[88:91]
 v_mfma_f32_16x16x32_bf16 v[96:99], a[232:235], v[72:75], v[96:99]
 v_mfma_f32_16x16x32_bf16 v[100:103], a[236:239], v[72:75], v[100:103]
 s_add_u32 s70, s65, 131072
 buffer_load_dwordx4 v[12:15], v11, s[48:51], s70 offen offset:0 sc1
 v_mfma_f32_16x16x32_bf16 v[108:111], a[236:239], v[76:79], v[108:111]
 v_mfma_f32_16x16x32_bf16 v[104:107], a[232:235], v[76:79], v[104:107]
 v_mfma_f32_16x16x32_bf16 v[112:115], a[240:243], v[72:75], v[112:115]
 v_mfma_f32_16x16x32_bf16 v[116:119], a[244:247], v[72:75], v[116:119]
 v_mfma_f32_16x16x32_bf16 v[124:127], a[244:247], v[76:79], v[124:127]
 v_mfma_f32_16x16x32_bf16 v[120:123], a[240:243], v[76:79], v[120:123]
 v_mfma_f32_16x16x32_bf16 v[128:131], a[248:251], v[72:75], v[128:131]
 v_mfma_f32_16x16x32_bf16 v[132:135], a[252:255], v[72:75], v[132:135]
 v_mfma_f32_16x16x32_bf16 v[140:143], a[252:255], v[76:79], v[140:143]
 v_mfma_f32_16x16x32_bf16 v[136:139], a[248:251], v[76:79], v[136:139]
 buffer_load_dwordx4 v[72:75], v2, s[48:51], s82 offen offset:2048 sc1
 buffer_load_dwordx4 v[76:79], v2, s[48:51], s82 offen offset:2304 sc1
 v_mov_b32 v3, 0
news_77:
 global_load_dword v4, v3, s[42:43] offset:132 sc1
 s_waitcnt vmcnt(0)
 v_readfirstlane_b32 s7, v4
 s_nop 0
 s_bfe_u32 s64, s7, 0x10005
 s_and_b32 s7, s7, 16
 s_cmp_eq_u32 s7, 16
 s_cbranch_scc1 newsok_78
 s_sleep 2
 s_sub_u32 s46, s46, 1
 s_cbranch_scc0 news_77
 s_mov_b32 s46, 0
 s_branch newsok_78
newsok_78:
 s_lshl_b32 s69, s64, 13
 s_add_u32 s74, s74, s69
 ds_write_b128 v7, v[96:99] offset:0
 ds_write_b128 v7, v[100:103] offset:1024
 ds_write_b128 v7, v[104:107] offset:2048
 ds_write_b128 v7, v[108:111] offset:3072
 ds_write_b128 v8, v[112:115] offset:0
 ds_write_b128 v8, v[116:119] offset:1024
 ds_write_b128 v8, v[120:123] offset:2048
 ds_write_b128 v8, v[124:127] offset:3072
 ds_write_b128 v9, v[128:131] offset:0
 ds_write_b128 v9, v[132:135] offset:1024
 ds_write_b128 v9, v[136:139] offset:2048
 ds_write_b128 v9, v[140:143] offset:3072
 s_waitcnt lgkmcnt(0)
 s_barrier
 ds_read_b128 v[96:99], v10 offset:0
 ds_read_b128 v[100:103], v10 offset:1024
 ds_read_b128 v[104:107], v10 offset:2048
 ds_read_b128 v[108:111], v10 offset:3072
 ds_read_b128 v[112:115], v10 offset:4096
 ds_read_b128 v[116:119], v10 offset:5120
 ds_read_b128 v[120:123], v10 offset:6144
 ds_read_b128 v[124:127], v10 offset:7168
 ds_read_b128 v[128:131], v10 offset:8192
 ds_read_b128 v[132:135], v10 offset:9216
 ds_read_b128 v[136:139], v10 offset:10240
 ds_read_b128 v[140:143], v10 offset:11264
 s_waitcnt lgkmcnt(8)
 v_add_f32 v80, v80, v96
 v_add_f32 v81, v81, v97
 v_add_f32 v82, v82, v98
 v_add_f32 v83, v83, v99
 v_add_f32 v84, v84, v100
 v_add_f32 v85, v85, v101
 v_add_f32 v86, v86, v102
 v_add_f32 v87, v87, v103
 v_add_f32 v88, v88, v104
 v_add_f32 v89, v89, v105
 v_add_f32 v90, v90, v106
 v_add_f32 v91, v91, v107
 v_add_f32 v92, v92, v108
 v_add_f32 v93, v93, v109
 v_add_f32 v94, v94, v110
 v_add_f32 v95, v95, v111
 s_waitcnt lgkmcnt(4)
 v_add_f32 v80, v80, v112
 v_add_f32 v81, v81, v113
 v_add_f32 v82, v82, v114
 v_add_f32 v83, v83, v115
 v_add_f32 v84, v84, v116
 v_add_f32 v85, v85, v117
 v_add_f32 v86, v86, v118
 v_add_f32 v87, v87, v119
 v_add_f32 v88, v88, v120
 v_add_f32 v89, v89, v121
 v_add_f32 v90, v90, v122
 v_add_f32 v91, v91, v123
 v_add_f32 v92, v92, v124
 v_add_f32 v93, v93, v125
 v_add_f32 v94, v94, v126
 v_add_f32 v95, v95, v127
 s_waitcnt lgkmcnt(0)
 v_add_f32 v80, v80, v128
 v_add_f32 v81, v81, v129
 v_add_f32 v82, v82, v130
 v_add_f32 v83, v83, v131
 v_add_f32 v84, v84, v132
 v_add_f32 v85, v85, v133
 v_add_f32 v86, v86, v134
 v_add_f32 v87, v87, v135
 v_add_f32 v88, v88, v136
 v_add_f32 v89, v89, v137
 v_add_f32 v90, v90, v138
 v_add_f32 v91, v91, v139
 v_add_f32 v92, v92, v140
 v_add_f32 v93, v93, v141
 v_add_f32 v94, v94, v142
 v_add_f32 v95, v95, v143
 v_cvt_pk_bf16_f32 v224, v80, v81
 v_cvt_pk_bf16_f32 v225, v82, v83
 v_cvt_pk_bf16_f32 v226, v84, v85
 v_cvt_pk_bf16_f32 v227, v86, v87
 buffer_store_dwordx4 v[224:227], v6, s[48:51], s67 offen offset:0 sc1
 v_cvt_pk_bf16_f32 v228, v88, v89
 v_cvt_pk_bf16_f32 v229, v90, v91
 v_cvt_pk_bf16_f32 v230, v92, v93
 v_cvt_pk_bf16_f32 v231, v94, v95
 buffer_store_dwordx4 v[228:231], v6, s[48:51], s67 offen offset:256 sc1
 s_add_u32 s74, s74, 0x40000
 s_and_b32 s69, s74, 0x200000
 s_lshr_b32 s69, s69, 8
 s_xor_b32 s69, s69, s74
 buffer_store_dwordx4 v[208:211], v1, s[48:51], s69 offen sc1
 s_waitcnt vmcnt(0)
 v_mov_b32 v3, 1
 v_mov_b32 v4, 0
 s_mov_b64 exec, 1
 buffer_store_dword v3, v4, s[48:51], s68 offen sc1
 s_mov_b64 exec, -1
 s_add_u32 s63, s63, 1
 s_add_u32 s65, s65, 0x10000
 s_add_u32 s67, s67, 0x40000
 v_mfma_f32_16x16x32_bf16 v[144:147], a[0:3], v[16:19], 0
 v_mfma_f32_16x16x32_bf16 v[148:151], a[4:7], v[16:19], 0
 v_mfma_f32_16x16x32_bf16 v[156:159], a[4:7], v[20:23], 0
 v_mfma_f32_16x16x32_bf16 v[152:155], a[0:3], v[20:23], 0
 v_mfma_f32_16x16x32_bf16 v[160:163], a[8:11], v[16:19], 0
 v_mfma_f32_16x16x32_bf16 v[164:167], a[12:15], v[16:19], 0
 v_mfma_f32_16x16x32_bf16 v[172:175], a[12:15], v[20:23], 0
 v_mfma_f32_16x16x32_bf16 v[168:171], a[8:11], v[20:23], 0
 v_mfma_f32_16x16x32_bf16 v[176:179], a[16:19], v[16:19], 0
 v_mfma_f32_16x16x32_bf16 v[180:183], a[20:23], v[16:19], 0
 v_mfma_f32_16x16x32_bf16 v[188:191], a[20:23], v[20:23], 0
 v_mfma_f32_16x16x32_bf16 v[184:187], a[16:19], v[20:23], 0
 v_mfma_f32_16x16x32_bf16 v[192:195], a[24:27], v[16:19], 0
 v_mfma_f32_16x16x32_bf16 v[196:199], a[28:31], v[16:19], 0
 v_mfma_f32_16x16x32_bf16 v[204:207], a[28:31], v[20:23], 0
 v_mfma_f32_16x16x32_bf16 v[200:203], a[24:27], v[20:23], 0
 v_mfma_f32_16x16x32_bf16 v[144:147], a[32:35], v[24:27], v[144:147]
 s_add_u32 s82, s65, 0
 buffer_load_dwordx4 v[16:19], v2, s[48:51], s82 offen offset:0 sc1
 v_mfma_f32_16x16x32_bf16 v[148:151], a[36:39], v[24:27], v[148:151]
 v_mfma_f32_16x16x32_bf16 v[156:159], a[36:39], v[28:31], v[156:159]
 buffer_load_dwordx4 v[20:23], v2, s[48:51], s82 offen offset:256 sc1
 v_mfma_f32_16x16x32_bf16 v[152:155], a[32:35], v[28:31], v[152:155]
 v_mfma_f32_16x16x32_bf16 v[160:163], a[40:43], v[24:27], v[160:163]
 v_mfma_f32_16x16x32_bf16 v[164:167], a[44:47], v[24:27], v[164:167]
 v_mfma_f32_16x16x32_bf16 v[172:175], a[44:47], v[28:31], v[172:175]
 v_mfma_f32_16x16x32_bf16 v[168:171], a[40:43], v[28:31], v[168:171]
 v_mfma_f32_16x16x32_bf16 v[176:179], a[48:51], v[24:27], v[176:179]
 v_mfma_f32_16x16x32_bf16 v[180:183], a[52:55], v[24:27], v[180:183]
 v_mfma_f32_16x16x32_bf16 v[188:191], a[52:55], v[28:31], v[188:191]
 v_mfma_f32_16x16x32_bf16 v[184:187], a[48:51], v[28:31], v[184:187]
 v_mfma_f32_16x16x32_bf16 v[192:195], a[56:59], v[24:27], v[192:195]
 v_mfma_f32_16x16x32_bf16 v[196:199], a[60:63], v[24:27], v[196:199]
 v_mfma_f32_16x16x32_bf16 v[204:207], a[60:63], v[28:31], v[204:207]
 v_mfma_f32_16x16x32_bf16 v[200:203], a[56:59], v[28:31], v[200:203]
 v_mfma_f32_16x16x32_bf16 v[144:147], a[64:67], v[32:35], v[144:147]
 buffer_load_dwordx4 v[24:27], v2, s[48:51], s82 offen offset:2048 sc1
 v_mfma_f32_16x16x32_bf16 v[148:151], a[68:71], v[32:35], v[148:151]
 v_mfma_f32_16x16x32_bf16 v[156:159], a[68:71], v[36:39], v[156:159]
 buffer_load_dwordx4 v[28:31], v2, s[48:51], s82 offen offset:2304 sc1
 v_mfma_f32_16x16x32_bf16 v[152:155], a[64:67], v[36:39], v[152:155]
 v_mfma_f32_16x16x32_bf16 v[160:163], a[72:75], v[32:35], v[160:163]
 v_mfma_f32_16x16x32_bf16 v[164:167], a[76:79], v[32:35], v[164:167]
 v_mfma_f32_16x16x32_bf16 v[172:175], a[76:79], v[36:39], v[172:175]
 v_mfma_f32_16x16x32_bf16 v[168:171], a[72:75], v[36:39], v[168:171]
 v_mfma_f32_16x16x32_bf16 v[176:179], a[80:83], v[32:35], v[176:179]
 v_mfma_f32_16x16x32_bf16 v[180:183], a[84:87], v[32:35], v[180:183]
 v_mfma_f32_16x16x32_bf16 v[188:191], a[84:87], v[36:39], v[188:191]
 v_mfma_f32_16x16x32_bf16 v[184:187], a[80:83], v[36:39], v[184:187]
 v_mfma_f32_16x16x32_bf16 v[192:195], a[88:91], v[32:35], v[192:195]
 v_mfma_f32_16x16x32_bf16 v[196:199], a[92:95], v[32:35], v[196:199]
 v_mfma_f32_16x16x32_bf16 v[204:207], a[92:95], v[36:39], v[204:207]
 v_mfma_f32_16x16x32_bf16 v[200:203], a[88:91], v[36:39], v[200:203]
 v_mfma_f32_16x16x32_bf16 v[144:147], a[96:99], v[40:43], v[144:147]
 s_add_u32 s82, s65, 4096
 buffer_load_dwordx4 v[32:35], v2, s[48:51], s82 offen offset:0 sc1
 v_mfma_f32_16x16x32_bf16 v[148:151], a[100:103], v[40:43], v[148:151]
 v_mfma_f32_16x16x32_bf16 v[156:159], a[100:103], v[44:47], v[156:159]
 buffer_load_dwordx4 v[36:39], v2, s[48:51], s82 offen offset:256 sc1
 v_mfma_f32_16x16x32_bf16 v[152:155], a[96:99], v[44:47], v[152:155]
 v_mfma_f32_16x16x32_bf16 v[160:163], a[104:107], v[40:43], v[160:163]
 v_mfma_f32_16x16x32_bf16 v[164:167], a[108:111], v[40:43], v[164:167]
 v_mfma_f32_16x16x32_bf16 v[172:175], a[108:111], v[44:47], v[172:175]
 v_mfma_f32_16x16x32_bf16 v[168:171], a[104:107], v[44:47], v[168:171]
 v_mfma_f32_16x16x32_bf16 v[176:179], a[112:115], v[40:43], v[176:179]
 v_mfma_f32_16x16x32_bf16 v[180:183], a[116:119], v[40:43], v[180:183]
 v_mfma_f32_16x16x32_bf16 v[188:191], a[116:119], v[44:47], v[188:191]
 v_mfma_f32_16x16x32_bf16 v[184:187], a[112:115], v[44:47], v[184:187]
 v_mfma_f32_16x16x32_bf16 v[192:195], a[120:123], v[40:43], v[192:195]
 v_mfma_f32_16x16x32_bf16 v[196:199], a[124:127], v[40:43], v[196:199]
 v_mfma_f32_16x16x32_bf16 v[204:207], a[124:127], v[44:47], v[204:207]
 v_mfma_f32_16x16x32_bf16 v[200:203], a[120:123], v[44:47], v[200:203]
 v_mfma_f32_16x16x32_bf16 v[144:147], a[128:131], v[48:51], v[144:147]
 buffer_load_dwordx4 v[40:43], v2, s[48:51], s82 offen offset:2048 sc1
 v_mfma_f32_16x16x32_bf16 v[148:151], a[132:135], v[48:51], v[148:151]
 v_mfma_f32_16x16x32_bf16 v[156:159], a[132:135], v[52:55], v[156:159]
 buffer_load_dwordx4 v[44:47], v2, s[48:51], s82 offen offset:2304 sc1
 v_mfma_f32_16x16x32_bf16 v[152:155], a[128:131], v[52:55], v[152:155]
 v_mfma_f32_16x16x32_bf16 v[160:163], a[136:139], v[48:51], v[160:163]
 v_mfma_f32_16x16x32_bf16 v[164:167], a[140:143], v[48:51], v[164:167]
 v_mfma_f32_16x16x32_bf16 v[172:175], a[140:143], v[52:55], v[172:175]
 v_mfma_f32_16x16x32_bf16 v[168:171], a[136:139], v[52:55], v[168:171]
 v_mfma_f32_16x16x32_bf16 v[176:179], a[144:147], v[48:51], v[176:179]
 v_mfma_f32_16x16x32_bf16 v[180:183], a[148:151], v[48:51], v[180:183]
 v_mfma_f32_16x16x32_bf16 v[188:191], a[148:151], v[52:55], v[188:191]
 v_mfma_f32_16x16x32_bf16 v[184:187], a[144:147], v[52:55], v[184:187]
 v_mfma_f32_16x16x32_bf16 v[192:195], a[152:155], v[48:51], v[192:195]
 v_mfma_f32_16x16x32_bf16 v[196:199], a[156:159], v[48:51], v[196:199]
 v_mfma_f32_16x16x32_bf16 v[204:207], a[156:159], v[52:55], v[204:207]
 v_mfma_f32_16x16x32_bf16 v[200:203], a[152:155], v[52:55], v[200:203]
 v_mfma_f32_16x16x32_bf16 v[144:147], a[160:163], v[56:59], v[144:147]
 s_add_u32 s82, s65, 8192
 buffer_load_dwordx4 v[48:51], v2, s[48:51], s82 offen offset:0 sc1
 v_mfma_f32_16x16x32_bf16 v[148:151], a[164:167], v[56:59], v[148:151]
 v_mfma_f32_16x16x32_bf16 v[156:159], a[164:167], v[60:63], v[156:159]
 buffer_load_dwordx4 v[52:55], v2, s[48:51], s82 offen offset:256 sc1
 v_mfma_f32_16x16x32_bf16 v[152:155], a[160:163], v[60:63], v[152:155]
 v_mfma_f32_16x16x32_bf16 v[160:163], a[168:171], v[56:59], v[160:163]
 v_mfma_f32_16x16x32_bf16 v[164:167], a[172:175], v[56:59], v[164:167]
 v_mfma_f32_16x16x32_bf16 v[172:175], a[172:175], v[60:63], v[172:175]
 v_mfma_f32_16x16x32_bf16 v[168:171], a[168:171], v[60:63], v[168:171]
 v_mfma_f32_16x16x32_bf16 v[176:179], a[176:179], v[56:59], v[176:179]
 v_mfma_f32_16x16x32_bf16 v[180:183], a[180:183], v[56:59], v[180:183]
 v_mfma_f32_16x16x32_bf16 v[188:191], a[180:183], v[60:63], v[188:191]
 v_mfma_f32_16x16x32_bf16 v[184:187], a[176:179], v[60:63], v[184:187]
 v_mfma_f32_16x16x32_bf16 v[192:195], a[184:187], v[56:59], v[192:195]
 v_mfma_f32_16x16x32_bf16 v[196:199], a[188:191], v[56:59], v[196:199]
 v_mfma_f32_16x16x32_bf16 v[204:207], a[188:191], v[60:63], v[204:207]
 v_mfma_f32_16x16x32_bf16 v[200:203], a[184:187], v[60:63], v[200:203]
 v_mfma_f32_16x16x32_bf16 v[144:147], a[192:195], v[64:67], v[144:147]
 buffer_load_dwordx4 v[56:59], v2, s[48:51], s82 offen offset:2048 sc1
 v_mfma_f32_16x16x32_bf16 v[148:151], a[196:199], v[64:67], v[148:151]
 v_mfma_f32_16x16x32_bf16 v[156:159], a[196:199], v[68:71], v[156:159]
 buffer_load_dwordx4 v[60:63], v2, s[48:51], s82 offen offset:2304 sc1
 v_mfma_f32_16x16x32_bf16 v[152:155], a[192:195], v[68:71], v[152:155]
 v_mfma_f32_16x16x32_bf16 v[160:163], a[200:203], v[64:67], v[160:163]
 v_mfma_f32_16x16x32_bf16 v[164:167], a[204:207], v[64:67], v[164:167]
 v_mfma_f32_16x16x32_bf16 v[172:175], a[204:207], v[68:71], v[172:175]
 v_mfma_f32_16x16x32_bf16 v[168:171], a[200:203], v[68:71], v[168:171]
 v_mfma_f32_16x16x32_bf16 v[176:179], a[208:211], v[64:67], v[176:179]
 v_mfma_f32_16x16x32_bf16 v[180:183], a[212:215], v[64:67], v[180:183]
 v_mfma_f32_16x16x32_bf16 v[188:191], a[212:215], v[68:71], v[188:191]
 v_mfma_f32_16x16x32_bf16 v[184:187], a[208:211], v[68:71], v[184:187]
 v_mfma_f32_16x16x32_bf16 v[192:195], a[216:219], v[64:67], v[192:195]
 v_mfma_f32_16x16x32_bf16 v[196:199], a[220:223], v[64:67], v[196:199]
 v_mfma_f32_16x16x32_bf16 v[204:207], a[220:223], v[68:71], v[204:207]
 v_mfma_f32_16x16x32_bf16 v[200:203], a[216:219], v[68:71], v[200:203]
 v_mfma_f32_16x16x32_bf16 v[144:147], a[224:227], v[72:75], v[144:147]
 s_add_u32 s82, s65, 12288
 buffer_load_dwordx4 v[64:67], v2, s[48:51], s82 offen offset:0 sc1
 v_mfma_f32_16x16x32_bf16 v[148:151], a[228:231], v[72:75], v[148:151]
 v_mfma_f32_16x16x32_bf16 v[156:159], a[228:231], v[76:79], v[156:159]
 buffer_load_dwordx4 v[68:71], v2, s[48:51], s82 offen offset:256 sc1
 v_mfma_f32_16x16x32_bf16 v[152:155], a[224:227], v[76:79], v[152:155]
 v_mfma_f32_16x16x32_bf16 v[160:163], a[232:235], v[72:75], v[160:163]
 v_mfma_f32_16x16x32_bf16 v[164:167], a[236:239], v[72:75], v[164:167]
 s_add_u32 s70, s65, 131072
 buffer_load_dwordx4 v[12:15], v11, s[48:51], s70 offen offset:0 sc1
 v_mfma_f32_16x16x32_bf16 v[172:175], a[236:239], v[76:79], v[172:175]
 v_mfma_f32_16x16x32_bf16 v[168:171], a[232:235], v[76:79], v[168:171]
 v_mfma_f32_16x16x32_bf16 v[176:179], a[240:243], v[72:75], v[176:179]
 v_mfma_f32_16x16x32_bf16 v[180:183], a[244:247], v[72:75], v[180:183]
 v_mfma_f32_16x16x32_bf16 v[188:191], a[244:247], v[76:79], v[188:191]
 v_mfma_f32_16x16x32_bf16 v[184:187], a[240:243], v[76:79], v[184:187]
 v_mfma_f32_16x16x32_bf16 v[192:195], a[248:251], v[72:75], v[192:195]
 v_mfma_f32_16x16x32_bf16 v[196:199], a[252:255], v[72:75], v[196:199]
 v_mfma_f32_16x16x32_bf16 v[204:207], a[252:255], v[76:79], v[204:207]
 v_mfma_f32_16x16x32_bf16 v[200:203], a[248:251], v[76:79], v[200:203]
 buffer_load_dwordx4 v[72:75], v2, s[48:51], s82 offen offset:2048 sc1
 buffer_load_dwordx4 v[76:79], v2, s[48:51], s82 offen offset:2304 sc1
 ds_write_b128 v7, v[160:163] offset:49152
 ds_write_b128 v7, v[164:167] offset:50176
 ds_write_b128 v7, v[168:171] offset:51200
 ds_write_b128 v7, v[172:175] offset:52224
 ds_write_b128 v8, v[176:179] offset:49152
 ds_write_b128 v8, v[180:183] offset:50176
 ds_write_b128 v8, v[184:187] offset:51200
 ds_write_b128 v8, v[188:191] offset:52224
 ds_write_b128 v9, v[192:195] offset:49152
 ds_write_b128 v9, v[196:199] offset:50176
 ds_write_b128 v9, v[200:203] offset:51200
 ds_write_b128 v9, v[204:207] offset:52224
 s_waitcnt lgkmcnt(0)
 s_barrier
 ds_read_b128 v[160:163], v10 offset:49152
 ds_read_b128 v[164:167], v10 offset:50176
 ds_read_b128 v[168:171], v10 offset:51200
 ds_read_b128 v[172:175], v10 offset:52224
 ds_read_b128 v[176:179], v10 offset:53248
 ds_read_b128 v[180:183], v10 offset:54272
 ds_read_b128 v[184:187], v10 offset:55296
 ds_read_b128 v[188:191], v10 offset:56320
 ds_read_b128 v[192:195], v10 offset:57344
 ds_read_b128 v[196:199], v10 offset:58368
 ds_read_b128 v[200:203], v10 offset:59392
 ds_read_b128 v[204:207], v10 offset:60416
 s_waitcnt lgkmcnt(8)
 v_add_f32 v144, v144, v160
 v_add_f32 v145, v145, v161
 v_add_f32 v146, v146, v162
 v_add_f32 v147, v147, v163
 v_add_f32 v148, v148, v164
 v_add_f32 v149, v149, v165
 v_add_f32 v150, v150, v166
 v_add_f32 v151, v151, v167
 v_add_f32 v152, v152, v168
 v_add_f32 v153, v153, v169
 v_add_f32 v154, v154, v170
 v_add_f32 v155, v155, v171
 v_add_f32 v156, v156, v172
 v_add_f32 v157, v157, v173
 v_add_f32 v158, v158, v174
 v_add_f32 v159, v159, v175
 s_waitcnt lgkmcnt(4)
 v_add_f32 v144, v144, v176
 v_add_f32 v145, v145, v177
 v_add_f32 v146, v146, v178
 v_add_f32 v147, v147, v179
 v_add_f32 v148, v148, v180
 v_add_f32 v149, v149, v181
 v_add_f32 v150, v150, v182
 v_add_f32 v151, v151, v183
 v_add_f32 v152, v152, v184
 v_add_f32 v153, v153, v185
 v_add_f32 v154, v154, v186
 v_add_f32 v155, v155, v187
 v_add_f32 v156, v156, v188
 v_add_f32 v157, v157, v189
 v_add_f32 v158, v158, v190
 v_add_f32 v159, v159, v191
 s_waitcnt lgkmcnt(0)
 v_add_f32 v144, v144, v192
 v_add_f32 v145, v145, v193
 v_add_f32 v146, v146, v194
 v_add_f32 v147, v147, v195
 v_add_f32 v148, v148, v196
 v_add_f32 v149, v149, v197
 v_add_f32 v150, v150, v198
 v_add_f32 v151, v151, v199
 v_add_f32 v152, v152, v200
 v_add_f32 v153, v153, v201
 v_add_f32 v154, v154, v202
 v_add_f32 v155, v155, v203
 v_add_f32 v156, v156, v204
 v_add_f32 v157, v157, v205
 v_add_f32 v158, v158, v206
 v_add_f32 v159, v159, v207
 v_cvt_pk_bf16_f32 v224, v144, v145
 v_cvt_pk_bf16_f32 v225, v146, v147
 v_cvt_pk_bf16_f32 v226, v148, v149
 v_cvt_pk_bf16_f32 v227, v150, v151
 buffer_store_dwordx4 v[224:227], v6, s[48:51], s67 offen offset:0 sc1
 v_cvt_pk_bf16_f32 v228, v152, v153
 v_cvt_pk_bf16_f32 v229, v154, v155
 v_cvt_pk_bf16_f32 v230, v156, v157
 v_cvt_pk_bf16_f32 v231, v158, v159
 buffer_store_dwordx4 v[228:231], v6, s[48:51], s67 offen offset:256 sc1
 s_add_u32 s74, s74, 0x40000
 s_and_b32 s69, s74, 0x200000
 s_lshr_b32 s69, s69, 8
 s_xor_b32 s69, s69, s74
 buffer_store_dwordx4 v[208:211], v1, s[48:51], s69 offen sc1
 s_waitcnt vmcnt(0)
 v_mov_b32 v3, 2
 v_mov_b32 v4, 0
 s_mov_b64 exec, 1
 buffer_store_dword v3, v4, s[48:51], s68 offen sc1
 s_mov_b64 exec, -1
 s_add_u32 s63, s63, 1
 s_add_u32 s65, s65, 0x10000
 s_add_u32 s67, s67, 0x40000
 v_mfma_f32_16x16x32_bf16 v[80:83], a[0:3], v[16:19], 0
 v_mfma_f32_16x16x32_bf16 v[84:87], a[4:7], v[16:19], 0
 v_mfma_f32_16x16x32_bf16 v[92:95], a[4:7], v[20:23], 0
 v_mfma_f32_16x16x32_bf16 v[88:91], a[0:3], v[20:23], 0
 v_mfma_f32_16x16x32_bf16 v[96:99], a[8:11], v[16:19], 0
 v_mfma_f32_16x16x32_bf16 v[100:103], a[12:15], v[16:19], 0
 v_mfma_f32_16x16x32_bf16 v[108:111], a[12:15], v[20:23], 0
 v_mfma_f32_16x16x32_bf16 v[104:107], a[8:11], v[20:23], 0
 v_mfma_f32_16x16x32_bf16 v[112:115], a[16:19], v[16:19], 0
 v_mfma_f32_16x16x32_bf16 v[116:119], a[20:23], v[16:19], 0
 v_mfma_f32_16x16x32_bf16 v[124:127], a[20:23], v[20:23], 0
 v_mfma_f32_16x16x32_bf16 v[120:123], a[16:19], v[20:23], 0
 v_mfma_f32_16x16x32_bf16 v[128:131], a[24:27], v[16:19], 0
 v_mfma_f32_16x16x32_bf16 v[132:135], a[28:31], v[16:19], 0
 v_mfma_f32_16x16x32_bf16 v[140:143], a[28:31], v[20:23], 0
 v_mfma_f32_16x16x32_bf16 v[136:139], a[24:27], v[20:23], 0
 v_mfma_f32_16x16x32_bf16 v[80:83], a[32:35], v[24:27], v[80:83]
 s_add_u32 s82, s65, 0
 buffer_load_dwordx4 v[16:19], v2, s[48:51], s82 offen offset:0 sc1
 v_mfma_f32_16x16x32_bf16 v[84:87], a[36:39], v[24:27], v[84:87]
 v_mfma_f32_16x16x32_bf16 v[92:95], a[36:39], v[28:31], v[92:95]
 buffer_load_dwordx4 v[20:23], v2, s[48:51], s82 offen offset:256 sc1
 v_mfma_f32_16x16x32_bf16 v[88:91], a[32:35], v[28:31], v[88:91]
 v_mfma_f32_16x16x32_bf16 v[96:99], a[40:43], v[24:27], v[96:99]
 v_mfma_f32_16x16x32_bf16 v[100:103], a[44:47], v[24:27], v[100:103]
 v_mfma_f32_16x16x32_bf16 v[108:111], a[44:47], v[28:31], v[108:111]
 v_mfma_f32_16x16x32_bf16 v[104:107], a[40:43], v[28:31], v[104:107]
 v_mfma_f32_16x16x32_bf16 v[112:115], a[48:51], v[24:27], v[112:115]
 v_mfma_f32_16x16x32_bf16 v[116:119], a[52:55], v[24:27], v[116:119]
 v_mfma_f32_16x16x32_bf16 v[124:127], a[52:55], v[28:31], v[124:127]
 v_mfma_f32_16x16x32_bf16 v[120:123], a[48:51], v[28:31], v[120:123]
 v_mfma_f32_16x16x32_bf16 v[128:131], a[56:59], v[24:27], v[128:131]
 v_mfma_f32_16x16x32_bf16 v[132:135], a[60:63], v[24:27], v[132:135]
 v_mfma_f32_16x16x32_bf16 v[140:143], a[60:63], v[28:31], v[140:143]
 v_mfma_f32_16x16x32_bf16 v[136:139], a[56:59], v[28:31], v[136:139]
 v_mfma_f32_16x16x32_bf16 v[80:83], a[64:67], v[32:35], v[80:83]
 buffer_load_dwordx4 v[24:27], v2, s[48:51], s82 offen offset:2048 sc1
 v_mfma_f32_16x16x32_bf16 v[84:87], a[68:71], v[32:35], v[84:87]
 v_mfma_f32_16x16x32_bf16 v[92:95], a[68:71], v[36:39], v[92:95]
 buffer_load_dwordx4 v[28:31], v2, s[48:51], s82 offen offset:2304 sc1
 v_mfma_f32_16x16x32_bf16 v[88:91], a[64:67], v[36:39], v[88:91]
 v_mfma_f32_16x16x32_bf16 v[96:99], a[72:75], v[32:35], v[96:99]
 v_mfma_f32_16x16x32_bf16 v[100:103], a[76:79], v[32:35], v[100:103]
 v_mfma_f32_16x16x32_bf16 v[108:111], a[76:79], v[36:39], v[108:111]
 v_mfma_f32_16x16x32_bf16 v[104:107], a[72:75], v[36:39], v[104:107]
 v_mfma_f32_16x16x32_bf16 v[112:115], a[80:83], v[32:35], v[112:115]
 v_mfma_f32_16x16x32_bf16 v[116:119], a[84:87], v[32:35], v[116:119]
 v_mfma_f32_16x16x32_bf16 v[124:127], a[84:87], v[36:39], v[124:127]
 v_mfma_f32_16x16x32_bf16 v[120:123], a[80:83], v[36:39], v[120:123]
 v_mfma_f32_16x16x32_bf16 v[128:131], a[88:91], v[32:35], v[128:131]
 v_mfma_f32_16x16x32_bf16 v[132:135], a[92:95], v[32:35], v[132:135]
 v_mfma_f32_16x16x32_bf16 v[140:143], a[92:95], v[36:39], v[140:143]
 v_mfma_f32_16x16x32_bf16 v[136:139], a[88:91], v[36:39], v[136:139]
 v_mfma_f32_16x16x32_bf16 v[80:83], a[96:99], v[40:43], v[80:83]
 s_add_u32 s82, s65, 4096
 buffer_load_dwordx4 v[32:35], v2, s[48:51], s82 offen offset:0 sc1
 v_mfma_f32_16x16x32_bf16 v[84:87], a[100:103], v[40:43], v[84:87]
 v_mfma_f32_16x16x32_bf16 v[92:95], a[100:103], v[44:47], v[92:95]
 buffer_load_dwordx4 v[36:39], v2, s[48:51], s82 offen offset:256 sc1
 v_mfma_f32_16x16x32_bf16 v[88:91], a[96:99], v[44:47], v[88:91]
 v_mfma_f32_16x16x32_bf16 v[96:99], a[104:107], v[40:43], v[96:99]
 v_mfma_f32_16x16x32_bf16 v[100:103], a[108:111], v[40:43], v[100:103]
 v_mfma_f32_16x16x32_bf16 v[108:111], a[108:111], v[44:47], v[108:111]
 v_mfma_f32_16x16x32_bf16 v[104:107], a[104:107], v[44:47], v[104:107]
 v_mfma_f32_16x16x32_bf16 v[112:115], a[112:115], v[40:43], v[112:115]
 v_mfma_f32_16x16x32_bf16 v[116:119], a[116:119], v[40:43], v[116:119]
 v_mfma_f32_16x16x32_bf16 v[124:127], a[116:119], v[44:47], v[124:127]
 v_mfma_f32_16x16x32_bf16 v[120:123], a[112:115], v[44:47], v[120:123]
 v_mfma_f32_16x16x32_bf16 v[128:131], a[120:123], v[40:43], v[128:131]
 v_mfma_f32_16x16x32_bf16 v[132:135], a[124:127], v[40:43], v[132:135]
 v_mfma_f32_16x16x32_bf16 v[140:143], a[124:127], v[44:47], v[140:143]
 v_mfma_f32_16x16x32_bf16 v[136:139], a[120:123], v[44:47], v[136:139]
 v_mfma_f32_16x16x32_bf16 v[80:83], a[128:131], v[48:51], v[80:83]
 buffer_load_dwordx4 v[40:43], v2, s[48:51], s82 offen offset:2048 sc1
 v_mfma_f32_16x16x32_bf16 v[84:87], a[132:135], v[48:51], v[84:87]
 v_mfma_f32_16x16x32_bf16 v[92:95], a[132:135], v[52:55], v[92:95]
 buffer_load_dwordx4 v[44:47], v2, s[48:51], s82 offen offset:2304 sc1
 v_mfma_f32_16x16x32_bf16 v[88:91], a[128:131], v[52:55], v[88:91]
 v_mfma_f32_16x16x32_bf16 v[96:99], a[136:139], v[48:51], v[96:99]
 v_mfma_f32_16x16x32_bf16 v[100:103], a[140:143], v[48:51], v[100:103]
 v_mfma_f32_16x16x32_bf16 v[108:111], a[140:143], v[52:55], v[108:111]
 v_mfma_f32_16x16x32_bf16 v[104:107], a[136:139], v[52:55], v[104:107]
 v_mfma_f32_16x16x32_bf16 v[112:115], a[144:147], v[48:51], v[112:115]
 v_mfma_f32_16x16x32_bf16 v[116:119], a[148:151], v[48:51], v[116:119]
 v_mfma_f32_16x16x32_bf16 v[124:127], a[148:151], v[52:55], v[124:127]
 v_mfma_f32_16x16x32_bf16 v[120:123], a[144:147], v[52:55], v[120:123]
 v_mfma_f32_16x16x32_bf16 v[128:131], a[152:155], v[48:51], v[128:131]
 v_mfma_f32_16x16x32_bf16 v[132:135], a[156:159], v[48:51], v[132:135]
 v_mfma_f32_16x16x32_bf16 v[140:143], a[156:159], v[52:55], v[140:143]
 v_mfma_f32_16x16x32_bf16 v[136:139], a[152:155], v[52:55], v[136:139]
 v_mfma_f32_16x16x32_bf16 v[80:83], a[160:163], v[56:59], v[80:83]
 s_add_u32 s82, s65, 8192
 buffer_load_dwordx4 v[48:51], v2, s[48:51], s82 offen offset:0 sc1
 v_mfma_f32_16x16x32_bf16 v[84:87], a[164:167], v[56:59], v[84:87]
 v_mfma_f32_16x16x32_bf16 v[92:95], a[164:167], v[60:63], v[92:95]
 buffer_load_dwordx4 v[52:55], v2, s[48:51], s82 offen offset:256 sc1
 v_mfma_f32_16x16x32_bf16 v[88:91], a[160:163], v[60:63], v[88:91]
 v_mfma_f32_16x16x32_bf16 v[96:99], a[168:171], v[56:59], v[96:99]
 v_mfma_f32_16x16x32_bf16 v[100:103], a[172:175], v[56:59], v[100:103]
 v_mfma_f32_16x16x32_bf16 v[108:111], a[172:175], v[60:63], v[108:111]
 v_mfma_f32_16x16x32_bf16 v[104:107], a[168:171], v[60:63], v[104:107]
 v_mfma_f32_16x16x32_bf16 v[112:115], a[176:179], v[56:59], v[112:115]
 v_mfma_f32_16x16x32_bf16 v[116:119], a[180:183], v[56:59], v[116:119]
 v_mfma_f32_16x16x32_bf16 v[124:127], a[180:183], v[60:63], v[124:127]
 v_mfma_f32_16x16x32_bf16 v[120:123], a[176:179], v[60:63], v[120:123]
 v_mfma_f32_16x16x32_bf16 v[128:131], a[184:187], v[56:59], v[128:131]
 v_mfma_f32_16x16x32_bf16 v[132:135], a[188:191], v[56:59], v[132:135]
 v_mfma_f32_16x16x32_bf16 v[140:143], a[188:191], v[60:63], v[140:143]
 v_mfma_f32_16x16x32_bf16 v[136:139], a[184:187], v[60:63], v[136:139]
 v_mfma_f32_16x16x32_bf16 v[80:83], a[192:195], v[64:67], v[80:83]
 buffer_load_dwordx4 v[56:59], v2, s[48:51], s82 offen offset:2048 sc1
 v_mfma_f32_16x16x32_bf16 v[84:87], a[196:199], v[64:67], v[84:87]
 v_mfma_f32_16x16x32_bf16 v[92:95], a[196:199], v[68:71], v[92:95]
 buffer_load_dwordx4 v[60:63], v2, s[48:51], s82 offen offset:2304 sc1
 v_mfma_f32_16x16x32_bf16 v[88:91], a[192:195], v[68:71], v[88:91]
 v_mfma_f32_16x16x32_bf16 v[96:99], a[200:203], v[64:67], v[96:99]
 v_mfma_f32_16x16x32_bf16 v[100:103], a[204:207], v[64:67], v[100:103]
 v_mfma_f32_16x16x32_bf16 v[108:111], a[204:207], v[68:71], v[108:111]
 v_mfma_f32_16x16x32_bf16 v[104:107], a[200:203], v[68:71], v[104:107]
 v_mfma_f32_16x16x32_bf16 v[112:115], a[208:211], v[64:67], v[112:115]
 v_mfma_f32_16x16x32_bf16 v[116:119], a[212:215], v[64:67], v[116:119]
 v_mfma_f32_16x16x32_bf16 v[124:127], a[212:215], v[68:71], v[124:127]
 v_mfma_f32_16x16x32_bf16 v[120:123], a[208:211], v[68:71], v[120:123]
 v_mfma_f32_16x16x32_bf16 v[128:131], a[216:219], v[64:67], v[128:131]
 v_mfma_f32_16x16x32_bf16 v[132:135], a[220:223], v[64:67], v[132:135]
 v_mfma_f32_16x16x32_bf16 v[140:143], a[220:223], v[68:71], v[140:143]
 v_mfma_f32_16x16x32_bf16 v[136:139], a[216:219], v[68:71], v[136:139]
 v_mfma_f32_16x16x32_bf16 v[80:83], a[224:227], v[72:75], v[80:83]
 s_add_u32 s82, s65, 12288
 buffer_load_dwordx4 v[64:67], v2, s[48:51], s82 offen offset:0 sc1
 v_mfma_f32_16x16x32_bf16 v[84:87], a[228:231], v[72:75], v[84:87]
 v_mfma_f32_16x16x32_bf16 v[92:95], a[228:231], v[76:79], v[92:95]
 buffer_load_dwordx4 v[68:71], v2, s[48:51], s82 offen offset:256 sc1
 v_mfma_f32_16x16x32_bf16 v[88:91], a[224:227], v[76:79], v[88:91]
 v_mfma_f32_16x16x32_bf16 v[96:99], a[232:235], v[72:75], v[96:99]
 v_mfma_f32_16x16x32_bf16 v[100:103], a[236:239], v[72:75], v[100:103]
 s_add_u32 s70, s65, 131072
 buffer_load_dwordx4 v[12:15], v11, s[48:51], s70 offen offset:0 sc1
 v_mfma_f32_16x16x32_bf16 v[108:111], a[236:239], v[76:79], v[108:111]
 v_mfma_f32_16x16x32_bf16 v[104:107], a[232:235], v[76:79], v[104:107]
 v_mfma_f32_16x16x32_bf16 v[112:115], a[240:243], v[72:75], v[112:115]
 v_mfma_f32_16x16x32_bf16 v[116:119], a[244:247], v[72:75], v[116:119]
 v_mfma_f32_16x16x32_bf16 v[124:127], a[244:247], v[76:79], v[124:127]
 v_mfma_f32_16x16x32_bf16 v[120:123], a[240:243], v[76:79], v[120:123]
 v_mfma_f32_16x16x32_bf16 v[128:131], a[248:251], v[72:75], v[128:131]
 v_mfma_f32_16x16x32_bf16 v[132:135], a[252:255], v[72:75], v[132:135]
 v_mfma_f32_16x16x32_bf16 v[140:143], a[252:255], v[76:79], v[140:143]
 v_mfma_f32_16x16x32_bf16 v[136:139], a[248:251], v[76:79], v[136:139]
 buffer_load_dwordx4 v[72:75], v2, s[48:51], s82 offen offset:2048 sc1
 buffer_load_dwordx4 v[76:79], v2, s[48:51], s82 offen offset:2304 sc1
 s_add_u32 s63, s63, 1
 s_add_u32 s65, s65, 0x10000
 s_waitcnt vmcnt(0)
Lw_Kloop:
 s_cmp_eq_u32 s63, 27
 s_cbranch_scc0 Lw_Kxf
 v_mov_b32 v3, 0
news_79:
 global_load_dword v4, v3, s[42:43] offset:132 sc1
 s_waitcnt vmcnt(0)
 v_readfirstlane_b32 s7, v4
 s_nop 0
 s_and_b32 s7, s7, 8
 s_cmp_eq_u32 s7, 8
 s_cbranch_scc1 newsok_80
 s_sleep 2
 s_sub_u32 s46, s46, 1
 s_cbranch_scc0 news_79
 s_mov_b32 s46, 0
 s_branch newsok_80
newsok_80:
Lw_Kxf:
 s_waitcnt vmcnt(19)
 v_mfma_f32_16x16x32_bf16 v[144:147], a[0:3], v[16:19], 0
 v_mfma_f32_16x16x32_bf16 v[148:151], a[4:7], v[16:19], 0
 v_mfma_f32_16x16x32_bf16 v[156:159], a[4:7], v[20:23], 0
 ds_write_b128 v7, v[96:99] offset:0
 v_mfma_f32_16x16x32_bf16 v[152:155], a[0:3], v[20:23], 0
 v_mfma_f32_16x16x32_bf16 v[160:163], a[8:11], v[16:19], 0
 v_mfma_f32_16x16x32_bf16 v[164:167], a[12:15], v[16:19], 0
 ds_write_b128 v7, v[100:103] offset:1024
 v_mfma_f32_16x16x32_bf16 v[172:175], a[12:15], v[20:23], 0
 v_mfma_f32_16x16x32_bf16 v[168:171], a[8:11], v[20:23], 0
 v_mfma_f32_16x16x32_bf16 v[176:179], a[16:19], v[16:19], 0
 ds_write_b128 v7, v[104:107] offset:2048
 v_mfma_f32_16x16x32_bf16 v[180:183], a[20:23], v[16:19], 0
 v_mfma_f32_16x16x32_bf16 v[188:191], a[20:23], v[20:23], 0
 v_mfma_f32_16x16x32_bf16 v[184:187], a[16:19], v[20:23], 0
 ds_write_b128 v7, v[108:111] offset:3072
 v_mfma_f32_16x16x32_bf16 v[192:195], a[24:27], v[16:19], 0
 v_mfma_f32_16x16x32_bf16 v[196:199], a[28:31], v[16:19], 0
 v_mfma_f32_16x16x32_bf16 v[204:207], a[28:31], v[20:23], 0
 ds_write_b128 v8, v[112:115] offset:0
 v_mfma_f32_16x16x32_bf16 v[200:203], a[24:27], v[20:23], 0
 s_waitcnt vmcnt(17)
 v_mfma_f32_16x16x32_bf16 v[144:147], a[32:35], v[24:27], v[144:147]
 s_add_u32 s82, s65, 0
 buffer_load_dwordx4 v[16:19], v2, s[48:51], s82 offen offset:0 sc1
 v_mfma_f32_16x16x32_bf16 v[148:151], a[36:39], v[24:27], v[148:151]
 v_mfma_f32_16x16x32_bf16 v[156:159], a[36:39], v[28:31], v[156:159]
 buffer_load_dwordx4 v[20:23], v2, s[48:51], s82 offen offset:256 sc1
 v_mfma_f32_16x16x32_bf16 v[152:155], a[32:35], v[28:31], v[152:155]
 ds_write_b128 v8, v[116:119] offset:1024
 v_mfma_f32_16x16x32_bf16 v[160:163], a[40:43], v[24:27], v[160:163]
 v_mfma_f32_16x16x32_bf16 v[164:167], a[44:47], v[24:27], v[164:167]
 v_mfma_f32_16x16x32_bf16 v[172:175], a[44:47], v[28:31], v[172:175]
 ds_write_b128 v8, v[120:123] offset:2048
 v_mfma_f32_16x16x32_bf16 v[168:171], a[40:43], v[28:31], v[168:171]
 v_mfma_f32_16x16x32_bf16 v[176:179], a[48:51], v[24:27], v[176:179]
 v_mfma_f32_16x16x32_bf16 v[180:183], a[52:55], v[24:27], v[180:183]
 ds_write_b128 v8, v[124:127] offset:3072
 v_mfma_f32_16x16x32_bf16 v[188:191], a[52:55], v[28:31], v[188:191]
 v_mfma_f32_16x16x32_bf16 v[184:187], a[48:51], v[28:31], v[184:187]
 v_mfma_f32_16x16x32_bf16 v[192:195], a[56:59], v[24:27], v[192:195]
 ds_write_b128 v9, v[128:131] offset:0
 v_mfma_f32_16x16x32_bf16 v[196:199], a[60:63], v[24:27], v[196:199]
 v_mfma_f32_16x16x32_bf16 v[204:207], a[60:63], v[28:31], v[204:207]
 v_mfma_f32_16x16x32_bf16 v[200:203], a[56:59], v[28:31], v[200:203]
 ds_write_b128 v9, v[132:135] offset:1024
 s_waitcnt vmcnt(17)
 v_mfma_f32_16x16x32_bf16 v[144:147], a[64:67], v[32:35], v[144:147]
 buffer_load_dwordx4 v[24:27], v2, s[48:51], s82 offen offset:2048 sc1
 v_mfma_f32_16x16x32_bf16 v[148:151], a[68:71], v[32:35], v[148:151]
 v_mfma_f32_16x16x32_bf16 v[156:159], a[68:71], v[36:39], v[156:159]
 buffer_load_dwordx4 v[28:31], v2, s[48:51], s82 offen offset:2304 sc1
 v_mfma_f32_16x16x32_bf16 v[152:155], a[64:67], v[36:39], v[152:155]
 v_mfma_f32_16x16x32_bf16 v[160:163], a[72:75], v[32:35], v[160:163]
 ds_write_b128 v9, v[136:139] offset:2048
 v_mfma_f32_16x16x32_bf16 v[164:167], a[76:79], v[32:35], v[164:167]
 v_mfma_f32_16x16x32_bf16 v[172:175], a[76:79], v[36:39], v[172:175]
 v_mfma_f32_16x16x32_bf16 v[168:171], a[72:75], v[36:39], v[168:171]
 ds_write_b128 v9, v[140:143] offset:3072
 v_mfma_f32_16x16x32_bf16 v[176:179], a[80:83], v[32:35], v[176:179]
 v_mfma_f32_16x16x32_bf16 v[180:183], a[84:87], v[32:35], v[180:183]
 v_mfma_f32_16x16x32_bf16 v[188:191], a[84:87], v[36:39], v[188:191]
 s_waitcnt lgkmcnt(0)
 s_barrier
 v_mfma_f32_16x16x32_bf16 v[184:187], a[80:83], v[36:39], v[184:187]
 ds_read_b128 v[96:99], v10 offset:0
 v_mfma_f32_16x16x32_bf16 v[192:195], a[88:91], v[32:35], v[192:195]
 ds_read_b128 v[100:103], v10 offset:1024
 v_mfma_f32_16x16x32_bf16 v[196:199], a[92:95], v[32:35], v[196:199]
 ds_read_b128 v[104:107], v10 offset:2048
 v_mfma_f32_16x16x32_bf16 v[204:207], a[92:95], v[36:39], v[204:207]
 ds_read_b128 v[108:111], v10 offset:3072
 v_mfma_f32_16x16x32_bf16 v[200:203], a[88:91], v[36:39], v[200:203]
 ds_read_b128 v[112:115], v10 offset:4096
 s_waitcnt vmcnt(16)
 v_mfma_f32_16x16x32_bf16 v[144:147], a[96:99], v[40:43], v[144:147]
 s_add_u32 s82, s65, 4096
 buffer_load_dwordx4 v[32:35], v2, s[48:51], s82 offen offset:0 sc1
 v_mfma_f32_16x16x32_bf16 v[148:151], a[100:103], v[40:43], v[148:151]
 ds_read_b128 v[116:119], v10 offset:5120
 v_mfma_f32_16x16x32_bf16 v[156:159], a[100:103], v[44:47], v[156:159]
 buffer_load_dwordx4 v[36:39], v2, s[48:51], s82 offen offset:256 sc1
 v_mfma_f32_16x16x32_bf16 v[152:155], a[96:99], v[44:47], v[152:155]
 ds_read_b128 v[120:123], v10 offset:6144
 v_mfma_f32_16x16x32_bf16 v[160:163], a[104:107], v[40:43], v[160:163]
 ds_read_b128 v[124:127], v10 offset:7168
 v_mfma_f32_16x16x32_bf16 v[164:167], a[108:111], v[40:43], v[164:167]
 s_waitcnt vmcnt(11)
 s_sub_u32 s69, s63, 1
 s_max_u32 s69, s69, 2
 v_mov_b32 v3, s69
 v_mov_b32 v4, 0
 s_mov_b64 exec, 1
 buffer_store_dword v3, v4, s[48:51], s68 offen sc1
 s_mov_b64 exec, -1
 v_mfma_f32_16x16x32_bf16 v[172:175], a[108:111], v[44:47], v[172:175]
 ds_read_b128 v[128:131], v10 offset:8192
 v_mfma_f32_16x16x32_bf16 v[168:171], a[104:107], v[44:47], v[168:171]
 ds_read_b128 v[132:135], v10 offset:9216
 v_mfma_f32_16x16x32_bf16 v[176:179], a[112:115], v[40:43], v[176:179]
 ds_read_b128 v[136:139], v10 offset:10240
 v_mfma_f32_16x16x32_bf16 v[180:183], a[116:119], v[40:43], v[180:183]
 ds_read_b128 v[140:143], v10 offset:11264
 v_mfma_f32_16x16x32_bf16 v[188:191], a[116:119], v[44:47], v[188:191]
 s_waitcnt lgkmcnt(8)
 v_mfma_f32_16x16x32_bf16 v[184:187], a[112:115], v[44:47], v[184:187]
 v_add_f32 v80, v80, v96
 v_add_f32 v81, v81, v97
 v_mfma_f32_16x16x32_bf16 v[192:195], a[120:123], v[40:43], v[192:195]
 v_add_f32 v82, v82, v98
 v_add_f32 v83, v83, v99
 v_mfma_f32_16x16x32_bf16 v[196:199], a[124:127], v[40:43], v[196:199]
 v_add_f32 v84, v84, v100
 v_add_f32 v85, v85, v101
 v_mfma_f32_16x16x32_bf16 v[204:207], a[124:127], v[44:47], v[204:207]
 v_add_f32 v86, v86, v102
 v_add_f32 v87, v87, v103
 v_mfma_f32_16x16x32_bf16 v[200:203], a[120:123], v[44:47], v[200:203]
 v_add_f32 v88, v88, v104
 v_add_f32 v89, v89, v105
 v_mfma_f32_16x16x32_bf16 v[144:147], a[128:131], v[48:51], v[144:147]
 buffer_load_dwordx4 v[40:43], v2, s[48:51], s82 offen offset:2048 sc1
 v_mfma_f32_16x16x32_bf16 v[148:151], a[132:135], v[48:51], v[148:151]
 v_add_f32 v90, v90, v106
 v_add_f32 v91, v91, v107
 v_mfma_f32_16x16x32_bf16 v[156:159], a[132:135], v[52:55], v[156:159]
 buffer_load_dwordx4 v[44:47], v2, s[48:51], s82 offen offset:2304 sc1
 v_mfma_f32_16x16x32_bf16 v[152:155], a[128:131], v[52:55], v[152:155]
 v_add_f32 v92, v92, v108
 v_add_f32 v93, v93, v109
 v_mfma_f32_16x16x32_bf16 v[160:163], a[136:139], v[48:51], v[160:163]
 v_add_f32 v94, v94, v110
 v_add_f32 v95, v95, v111
 v_mfma_f32_16x16x32_bf16 v[164:167], a[140:143], v[48:51], v[164:167]
 s_waitcnt lgkmcnt(4)
 v_mfma_f32_16x16x32_bf16 v[172:175], a[140:143], v[52:55], v[172:175]
 v_add_f32 v80, v80, v112
 v_add_f32 v81, v81, v113
 v_mfma_f32_16x16x32_bf16 v[168:171], a[136:139], v[52:55], v[168:171]
 v_add_f32 v82, v82, v114
 v_add_f32 v83, v83, v115
 v_mfma_f32_16x16x32_bf16 v[176:179], a[144:147], v[48:51], v[176:179]
 v_add_f32 v84, v84, v116
 v_add_f32 v85, v85, v117
 v_mfma_f32_16x16x32_bf16 v[180:183], a[148:151], v[48:51], v[180:183]
 v_add_f32 v86, v86, v118
 v_add_f32 v87, v87, v119
 v_mfma_f32_16x16x32_bf16 v[188:191], a[148:151], v[52:55], v[188:191]
 v_add_f32 v88, v88, v120
 v_add_f32 v89, v89, v121
 v_mfma_f32_16x16x32_bf16 v[184:187], a[144:147], v[52:55], v[184:187]
 v_add_f32 v90, v90, v122
 v_add_f32 v91, v91, v123
 v_mfma_f32_16x16x32_bf16 v[192:195], a[152:155], v[48:51], v[192:195]
 v_add_f32 v92, v92, v124
 v_add_f32 v93, v93, v125
 v_mfma_f32_16x16x32_bf16 v[196:199], a[156:159], v[48:51], v[196:199]
 v_add_f32 v94, v94, v126
 v_add_f32 v95, v95, v127
 v_mfma_f32_16x16x32_bf16 v[204:207], a[156:159], v[52:55], v[204:207]
 s_waitcnt lgkmcnt(0)
 v_mfma_f32_16x16x32_bf16 v[200:203], a[152:155], v[52:55], v[200:203]
 v_add_f32 v80, v80, v128
 v_add_f32 v81, v81, v129
 v_mfma_f32_16x16x32_bf16 v[144:147], a[160:163], v[56:59], v[144:147]
 s_add_u32 s82, s65, 8192
 buffer_load_dwordx4 v[48:51], v2, s[48:51], s82 offen offset:0 sc1
 v_mfma_f32_16x16x32_bf16 v[148:151], a[164:167], v[56:59], v[148:151]
 v_add_f32 v82, v82, v130
 v_add_f32 v83, v83, v131
 v_mfma_f32_16x16x32_bf16 v[156:159], a[164:167], v[60:63], v[156:159]
 buffer_load_dwordx4 v[52:55], v2, s[48:51], s82 offen offset:256 sc1
 v_mfma_f32_16x16x32_bf16 v[152:155], a[160:163], v[60:63], v[152:155]
 v_add_f32 v84, v84, v132
 v_add_f32 v85, v85, v133
 v_mfma_f32_16x16x32_bf16 v[160:163], a[168:171], v[56:59], v[160:163]
 v_add_f32 v86, v86, v134
 v_add_f32 v87, v87, v135
 v_mfma_f32_16x16x32_bf16 v[164:167], a[172:175], v[56:59], v[164:167]
 v_add_f32 v88, v88, v136
 v_add_f32 v89, v89, v137
 v_mfma_f32_16x16x32_bf16 v[172:175], a[172:175], v[60:63], v[172:175]
 v_add_f32 v90, v90, v138
 v_add_f32 v91, v91, v139
 v_mfma_f32_16x16x32_bf16 v[168:171], a[168:171], v[60:63], v[168:171]
 v_add_f32 v92, v92, v140
 v_add_f32 v93, v93, v141
 v_mfma_f32_16x16x32_bf16 v[176:179], a[176:179], v[56:59], v[176:179]
 v_add_f32 v94, v94, v142
 v_add_f32 v95, v95, v143
 v_mfma_f32_16x16x32_bf16 v[180:183], a[180:183], v[56:59], v[180:183]
 v_cvt_pk_bf16_f32 v224, v80, v81
 v_cvt_pk_bf16_f32 v225, v82, v83
 v_mfma_f32_16x16x32_bf16 v[188:191], a[180:183], v[60:63], v[188:191]
 v_cvt_pk_bf16_f32 v226, v84, v85
 v_cvt_pk_bf16_f32 v227, v86, v87
 v_mfma_f32_16x16x32_bf16 v[184:187], a[176:179], v[60:63], v[184:187]
 buffer_store_dwordx4 v[224:227], v6, s[48:51], s67 offen offset:0 sc1
 v_mfma_f32_16x16x32_bf16 v[192:195], a[184:187], v[56:59], v[192:195]
 v_cvt_pk_bf16_f32 v228, v88, v89
 v_cvt_pk_bf16_f32 v229, v90, v91
 v_mfma_f32_16x16x32_bf16 v[196:199], a[188:191], v[56:59], v[196:199]
 v_cvt_pk_bf16_f32 v230, v92, v93
 v_cvt_pk_bf16_f32 v231, v94, v95
 v_mfma_f32_16x16x32_bf16 v[204:207], a[188:191], v[60:63], v[204:207]
 buffer_store_dwordx4 v[228:231], v6, s[48:51], s67 offen offset:256 sc1
 v_mfma_f32_16x16x32_bf16 v[200:203], a[184:187], v[60:63], v[200:203]
 s_add_u32 s74, s74, 0x40000
 s_and_b32 s69, s74, 0x200000
 s_waitcnt vmcnt(16)
 v_mfma_f32_16x16x32_bf16 v[144:147], a[192:195], v[64:67], v[144:147]
 buffer_load_dwordx4 v[56:59], v2, s[48:51], s82 offen offset:2048 sc1
 v_mfma_f32_16x16x32_bf16 v[148:151], a[196:199], v[64:67], v[148:151]
 s_lshr_b32 s69, s69, 8
 s_xor_b32 s69, s69, s74
 v_mfma_f32_16x16x32_bf16 v[156:159], a[196:199], v[68:71], v[156:159]
 buffer_load_dwordx4 v[60:63], v2, s[48:51], s82 offen offset:2304 sc1
 v_mfma_f32_16x16x32_bf16 v[152:155], a[192:195], v[68:71], v[152:155]
 buffer_store_dwordx4 v[208:211], v1, s[48:51], s69 offen sc1
 v_mfma_f32_16x16x32_bf16 v[160:163], a[200:203], v[64:67], v[160:163]
 v_mfma_f32_16x16x32_bf16 v[164:167], a[204:207], v[64:67], v[164:167]
 v_mfma_f32_16x16x32_bf16 v[172:175], a[204:207], v[68:71], v[172:175]
 v_mfma_f32_16x16x32_bf16 v[168:171], a[200:203], v[68:71], v[168:171]
 v_mfma_f32_16x16x32_bf16 v[176:179], a[208:211], v[64:67], v[176:179]
 v_mfma_f32_16x16x32_bf16 v[180:183], a[212:215], v[64:67], v[180:183]
 v_mfma_f32_16x16x32_bf16 v[188:191], a[212:215], v[68:71], v[188:191]
 v_mfma_f32_16x16x32_bf16 v[184:187], a[208:211], v[68:71], v[184:187]
 v_mfma_f32_16x16x32_bf16 v[192:195], a[216:219], v[64:67], v[192:195]
 v_mfma_f32_16x16x32_bf16 v[196:199], a[220:223], v[64:67], v[196:199]
 v_mfma_f32_16x16x32_bf16 v[204:207], a[220:223], v[68:71], v[204:207]
 v_mfma_f32_16x16x32_bf16 v[200:203], a[216:219], v[68:71], v[200:203]
 s_waitcnt vmcnt(16)
 v_mfma_f32_16x16x32_bf16 v[144:147], a[224:227], v[72:75], v[144:147]
 s_add_u32 s82, s65, 12288
 buffer_load_dwordx4 v[64:67], v2, s[48:51], s82 offen offset:0 sc1
 v_mfma_f32_16x16x32_bf16 v[148:151], a[228:231], v[72:75], v[148:151]
 v_mfma_f32_16x16x32_bf16 v[156:159], a[228:231], v[76:79], v[156:159]
 buffer_load_dwordx4 v[68:71], v2, s[48:51], s82 offen offset:256 sc1
 v_mfma_f32_16x16x32_bf16 v[152:155], a[224:227], v[76:79], v[152:155]
 v_mfma_f32_16x16x32_bf16 v[160:163], a[232:235], v[72:75], v[160:163]
 v_mfma_f32_16x16x32_bf16 v[164:167], a[236:239], v[72:75], v[164:167]
 s_add_u32 s70, s65, 131072
 buffer_load_dwordx4 v[12:15], v11, s[48:51], s70 offen offset:0 sc1
 v_mfma_f32_16x16x32_bf16 v[172:175], a[236:239], v[76:79], v[172:175]
 v_mfma_f32_16x16x32_bf16 v[168:171], a[232:235], v[76:79], v[168:171]
 v_mfma_f32_16x16x32_bf16 v[176:179], a[240:243], v[72:75], v[176:179]
 v_mfma_f32_16x16x32_bf16 v[180:183], a[244:247], v[72:75], v[180:183]
 v_mfma_f32_16x16x32_bf16 v[188:191], a[244:247], v[76:79], v[188:191]
 v_mfma_f32_16x16x32_bf16 v[184:187], a[240:243], v[76:79], v[184:187]
 v_mfma_f32_16x16x32_bf16 v[192:195], a[248:251], v[72:75], v[192:195]
 v_mfma_f32_16x16x32_bf16 v[196:199], a[252:255], v[72:75], v[196:199]
 v_mfma_f32_16x16x32_bf16 v[204:207], a[252:255], v[76:79], v[204:207]
 v_mfma_f32_16x16x32_bf16 v[200:203], a[248:251], v[76:79], v[200:203]
 buffer_load_dwordx4 v[72:75], v2, s[48:51], s82 offen offset:2048 sc1
 buffer_load_dwordx4 v[76:79], v2, s[48:51], s82 offen offset:2304 sc1
 s_add_u32 s63, s63, 1
 s_add_u32 s65, s65, 0x10000
 s_add_u32 s67, s67, 0x40000
 s_cmp_eq_u32 s63, 64
 s_cbranch_scc1 Lw_Kend
 s_waitcnt vmcnt(19)
 v_mfma_f32_16x16x32_bf16 v[80:83], a[0:3], v[16:19], 0
 v_mfma_f32_16x16x32_bf16 v[84:87], a[4:7], v[16:19], 0
 v_mfma_f32_16x16x32_bf16 v[92:95], a[4:7], v[20:23], 0
 ds_write_b128 v7, v[160:163] offset:49152
 v_mfma_f32_16x16x32_bf16 v[88:91], a[0:3], v[20:23], 0
 v_mfma_f32_16x16x32_bf16 v[96:99], a[8:11], v[16:19], 0
 v_mfma_f32_16x16x32_bf16 v[100:103], a[12:15], v[16:19], 0
 ds_write_b128 v7, v[164:167] offset:50176
 v_mfma_f32_16x16x32_bf16 v[108:111], a[12:15], v[20:23], 0
 v_mfma_f32_16x16x32_bf16 v[104:107], a[8:11], v[20:23], 0
 v_mfma_f32_16x16x32_bf16 v[112:115], a[16:19], v[16:19], 0
 ds_write_b128 v7, v[168:171] offset:51200
 v_mfma_f32_16x16x32_bf16 v[116:119], a[20:23], v[16:19], 0
 v_mfma_f32_16x16x32_bf16 v[124:127], a[20:23], v[20:23], 0
 v_mfma_f32_16x16x32_bf16 v[120:123], a[16:19], v[20:23], 0
 ds_write_b128 v7, v[172:175] offset:52224
 v_mfma_f32_16x16x32_bf16 v[128:131], a[24:27], v[16:19], 0
 v_mfma_f32_16x16x32_bf16 v[132:135], a[28:31], v[16:19], 0
 v_mfma_f32_16x16x32_bf16 v[140:143], a[28:31], v[20:23], 0
 ds_write_b128 v8, v[176:179] offset:49152
 v_mfma_f32_16x16x32_bf16 v[136:139], a[24:27], v[20:23], 0
 s_waitcnt vmcnt(17)
 v_mfma_f32_16x16x32_bf16 v[80:83], a[32:35], v[24:27], v[80:83]
 s_add_u32 s82, s65, 0
 buffer_load_dwordx4 v[16:19], v2, s[48:51], s82 offen offset:0 sc1
 v_mfma_f32_16x16x32_bf16 v[84:87], a[36:39], v[24:27], v[84:87]
 v_mfma_f32_16x16x32_bf16 v[92:95], a[36:39], v[28:31], v[92:95]
 buffer_load_dwordx4 v[20:23], v2, s[48:51], s82 offen offset:256 sc1
 v_mfma_f32_16x16x32_bf16 v[88:91], a[32:35], v[28:31], v[88:91]
 ds_write_b128 v8, v[180:183] offset:50176
 v_mfma_f32_16x16x32_bf16 v[96:99], a[40:43], v[24:27], v[96:99]
 v_mfma_f32_16x16x32_bf16 v[100:103], a[44:47], v[24:27], v[100:103]
 v_mfma_f32_16x16x32_bf16 v[108:111], a[44:47], v[28:31], v[108:111]
 ds_write_b128 v8, v[184:187] offset:51200
 v_mfma_f32_16x16x32_bf16 v[104:107], a[40:43], v[28:31], v[104:107]
 v_mfma_f32_16x16x32_bf16 v[112:115], a[48:51], v[24:27], v[112:115]
 v_mfma_f32_16x16x32_bf16 v[116:119], a[52:55], v[24:27], v[116:119]
 ds_write_b128 v8, v[188:191] offset:52224
 v_mfma_f32_16x16x32_bf16 v[124:127], a[52:55], v[28:31], v[124:127]
 v_mfma_f32_16x16x32_bf16 v[120:123], a[48:51], v[28:31], v[120:123]
 v_mfma_f32_16x16x32_bf16 v[128:131], a[56:59], v[24:27], v[128:131]
 ds_write_b128 v9, v[192:195] offset:49152
 v_mfma_f32_16x16x32_bf16 v[132:135], a[60:63], v[24:27], v[132:135]
 v_mfma_f32_16x16x32_bf16 v[140:143], a[60:63], v[28:31], v[140:143]
 v_mfma_f32_16x16x32_bf16 v[136:139], a[56:59], v[28:31], v[136:139]
 ds_write_b128 v9, v[196:199] offset:50176
 s_waitcnt vmcnt(17)
 v_mfma_f32_16x16x32_bf16 v[80:83], a[64:67], v[32:35], v[80:83]
 buffer_load_dwordx4 v[24:27], v2, s[48:51], s82 offen offset:2048 sc1
 v_mfma_f32_16x16x32_bf16 v[84:87], a[68:71], v[32:35], v[84:87]
 v_mfma_f32_16x16x32_bf16 v[92:95], a[68:71], v[36:39], v[92:95]
 buffer_load_dwordx4 v[28:31], v2, s[48:51], s82 offen offset:2304 sc1
 v_mfma_f32_16x16x32_bf16 v[88:91], a[64:67], v[36:39], v[88:91]
 v_mfma_f32_16x16x32_bf16 v[96:99], a[72:75], v[32:35], v[96:99]
 ds_write_b128 v9, v[200:203] offset:51200
 v_mfma_f32_16x16x32_bf16 v[100:103], a[76:79], v[32:35], v[100:103]
 v_mfma_f32_16x16x32_bf16 v[108:111], a[76:79], v[36:39], v[108:111]
 v_mfma_f32_16x16x32_bf16 v[104:107], a[72:75], v[36:39], v[104:107]
 ds_write_b128 v9, v[204:207] offset:52224
 v_mfma_f32_16x16x32_bf16 v[112:115], a[80:83], v[32:35], v[112:115]
 v_mfma_f32_16x16x32_bf16 v[116:119], a[84:87], v[32:35], v[116:119]
 v_mfma_f32_16x16x32_bf16 v[124:127], a[84:87], v[36:39], v[124:127]
 s_waitcnt lgkmcnt(0)
 s_barrier
 v_mfma_f32_16x16x32_bf16 v[120:123], a[80:83], v[36:39], v[120:123]
 ds_read_b128 v[160:163], v10 offset:49152
 v_mfma_f32_16x16x32_bf16 v[128:131], a[88:91], v[32:35], v[128:131]
 ds_read_b128 v[164:167], v10 offset:50176
 v_mfma_f32_16x16x32_bf16 v[132:135], a[92:95], v[32:35], v[132:135]
 ds_read_b128 v[168:171], v10 offset:51200
 v_mfma_f32_16x16x32_bf16 v[140:143], a[92:95], v[36:39], v[140:143]
 ds_read_b128 v[172:175], v10 offset:52224
 v_mfma_f32_16x16x32_bf16 v[136:139], a[88:91], v[36:39], v[136:139]
 ds_read_b128 v[176:179], v10 offset:53248
 s_waitcnt vmcnt(16)
 v_mfma_f32_16x16x32_bf16 v[80:83], a[96:99], v[40:43], v[80:83]
 s_add_u32 s82, s65, 4096
 buffer_load_dwordx4 v[32:35], v2, s[48:51], s82 offen offset:0 sc1
 v_mfma_f32_16x16x32_bf16 v[84:87], a[100:103], v[40:43], v[84:87]
 ds_read_b128 v[180:183], v10 offset:54272
 v_mfma_f32_16x16x32_bf16 v[92:95], a[100:103], v[44:47], v[92:95]
 buffer_load_dwordx4 v[36:39], v2, s[48:51], s82 offen offset:256 sc1
 v_mfma_f32_16x16x32_bf16 v[88:91], a[96:99], v[44:47], v[88:91]
 ds_read_b128 v[184:187], v10 offset:55296
 v_mfma_f32_16x16x32_bf16 v[96:99], a[104:107], v[40:43], v[96:99]
 ds_read_b128 v[188:191], v10 offset:56320
 v_mfma_f32_16x16x32_bf16 v[100:103], a[108:111], v[40:43], v[100:103]
 s_waitcnt vmcnt(11)
 s_sub_u32 s69, s63, 1
 s_max_u32 s69, s69, 2
 v_mov_b32 v3, s69
 v_mov_b32 v4, 0
 s_mov_b64 exec, 1
 buffer_store_dword v3, v4, s[48:51], s68 offen sc1
 s_mov_b64 exec, -1
 v_mfma_f32_16x16x32_bf16 v[108:111], a[108:111], v[44:47], v[108:111]
 ds_read_b128 v[192:195], v10 offset:57344
 v_mfma_f32_16x16x32_bf16 v[104:107], a[104:107], v[44:47], v[104:107]
 ds_read_b128 v[196:199], v10 offset:58368
 v_mfma_f32_16x16x32_bf16 v[112:115], a[112:115], v[40:43], v[112:115]
 ds_read_b128 v[200:203], v10 offset:59392
 v_mfma_f32_16x16x32_bf16 v[116:119], a[116:119], v[40:43], v[116:119]
 ds_read_b128 v[204:207], v10 offset:60416
 v_mfma_f32_16x16x32_bf16 v[124:127], a[116:119], v[44:47], v[124:127]
 s_waitcnt lgkmcnt(8)
 v_mfma_f32_16x16x32_bf16 v[120:123], a[112:115], v[44:47], v[120:123]
 v_add_f32 v144, v144, v160
 v_add_f32 v145, v145, v161
 v_mfma_f32_16x16x32_bf16 v[128:131], a[120:123], v[40:43], v[128:131]
 v_add_f32 v146, v146, v162
 v_add_f32 v147, v147, v163
 v_mfma_f32_16x16x32_bf16 v[132:135], a[124:127], v[40:43], v[132:135]
 v_add_f32 v148, v148, v164
 v_add_f32 v149, v149, v165
 v_mfma_f32_16x16x32_bf16 v[140:143], a[124:127], v[44:47], v[140:143]
 v_add_f32 v150, v150, v166
 v_add_f32 v151, v151, v167
 v_mfma_f32_16x16x32_bf16 v[136:139], a[120:123], v[44:47], v[136:139]
 v_add_f32 v152, v152, v168
 v_add_f32 v153, v153, v169
 v_mfma_f32_16x16x32_bf16 v[80:83], a[128:131], v[48:51], v[80:83]
 buffer_load_dwordx4 v[40:43], v2, s[48:51], s82 offen offset:2048 sc1
 v_mfma_f32_16x16x32_bf16 v[84:87], a[132:135], v[48:51], v[84:87]
 v_add_f32 v154, v154, v170
 v_add_f32 v155, v155, v171
 v_mfma_f32_16x16x32_bf16 v[92:95], a[132:135], v[52:55], v[92:95]
 buffer_load_dwordx4 v[44:47], v2, s[48:51], s82 offen offset:2304 sc1
 v_mfma_f32_16x16x32_bf16 v[88:91], a[128:131], v[52:55], v[88:91]
 v_add_f32 v156, v156, v172
 v_add_f32 v157, v157, v173
 v_mfma_f32_16x16x32_bf16 v[96:99], a[136:139], v[48:51], v[96:99]
 v_add_f32 v158, v158, v174
 v_add_f32 v159, v159, v175
 v_mfma_f32_16x16x32_bf16 v[100:103], a[140:143], v[48:51], v[100:103]
 s_waitcnt lgkmcnt(4)
 v_mfma_f32_16x16x32_bf16 v[108:111], a[140:143], v[52:55], v[108:111]
 v_add_f32 v144, v144, v176
 v_add_f32 v145, v145, v177
 v_mfma_f32_16x16x32_bf16 v[104:107], a[136:139], v[52:55], v[104:107]
 v_add_f32 v146, v146, v178
 v_add_f32 v147, v147, v179
 v_mfma_f32_16x16x32_bf16 v[112:115], a[144:147], v[48:51], v[112:115]
 v_add_f32 v148, v148, v180
 v_add_f32 v149, v149, v181
 v_mfma_f32_16x16x32_bf16 v[116:119], a[148:151], v[48:51], v[116:119]
 v_add_f32 v150, v150, v182
 v_add_f32 v151, v151, v183
 v_mfma_f32_16x16x32_bf16 v[124:127], a[148:151], v[52:55], v[124:127]
 v_add_f32 v152, v152, v184
 v_add_f32 v153, v153, v185
 v_mfma_f32_16x16x32_bf16 v[120:123], a[144:147], v[52:55], v[120:123]
 v_add_f32 v154, v154, v186
 v_add_f32 v155, v155, v187
 v_mfma_f32_16x16x32_bf16 v[128:131], a[152:155], v[48:51], v[128:131]
 v_add_f32 v156, v156, v188
 v_add_f32 v157, v157, v189
 v_mfma_f32_16x16x32_bf16 v[132:135], a[156:159], v[48:51], v[132:135]
 v_add_f32 v158, v158, v190
 v_add_f32 v159, v159, v191
 v_mfma_f32_16x16x32_bf16 v[140:143], a[156:159], v[52:55], v[140:143]
 s_waitcnt lgkmcnt(0)
 v_mfma_f32_16x16x32_bf16 v[136:139], a[152:155], v[52:55], v[136:139]
 v_add_f32 v144, v144, v192
 v_add_f32 v145, v145, v193
 v_mfma_f32_16x16x32_bf16 v[80:83], a[160:163], v[56:59], v[80:83]
 s_add_u32 s82, s65, 8192
 buffer_load_dwordx4 v[48:51], v2, s[48:51], s82 offen offset:0 sc1
 v_mfma_f32_16x16x32_bf16 v[84:87], a[164:167], v[56:59], v[84:87]
 v_add_f32 v146, v146, v194
 v_add_f32 v147, v147, v195
 v_mfma_f32_16x16x32_bf16 v[92:95], a[164:167], v[60:63], v[92:95]
 buffer_load_dwordx4 v[52:55], v2, s[48:51], s82 offen offset:256 sc1
 v_mfma_f32_16x16x32_bf16 v[88:91], a[160:163], v[60:63], v[88:91]
 v_add_f32 v148, v148, v196
 v_add_f32 v149, v149, v197
 v_mfma_f32_16x16x32_bf16 v[96:99], a[168:171], v[56:59], v[96:99]
 v_add_f32 v150, v150, v198
 v_add_f32 v151, v151, v199
 v_mfma_f32_16x16x32_bf16 v[100:103], a[172:175], v[56:59], v[100:103]
 v_add_f32 v152, v152, v200
 v_add_f32 v153, v153, v201
 v_mfma_f32_16x16x32_bf16 v[108:111], a[172:175], v[60:63], v[108:111]
 v_add_f32 v154, v154, v202
 v_add_f32 v155, v155, v203
 v_mfma_f32_16x16x32_bf16 v[104:107], a[168:171], v[60:63], v[104:107]
 v_add_f32 v156, v156, v204
 v_add_f32 v157, v157, v205
 v_mfma_f32_16x16x32_bf16 v[112:115], a[176:179], v[56:59], v[112:115]
 v_add_f32 v158, v158, v206
 v_add_f32 v159, v159, v207
 v_mfma_f32_16x16x32_bf16 v[116:119], a[180:183], v[56:59], v[116:119]
 v_cvt_pk_bf16_f32 v224, v144, v145
 v_cvt_pk_bf16_f32 v225, v146, v147
 v_mfma_f32_16x16x32_bf16 v[124:127], a[180:183], v[60:63], v[124:127]
 v_cvt_pk_bf16_f32 v226, v148, v149
 v_cvt_pk_bf16_f32 v227, v150, v151
 v_mfma_f32_16x16x32_bf16 v[120:123], a[176:179], v[60:63], v[120:123]
 buffer_store_dwordx4 v[224:227], v6, s[48:51], s67 offen offset:0 sc1
 v_mfma_f32_16x16x32_bf16 v[128:131], a[184:187], v[56:59], v[128:131]
 v_cvt_pk_bf16_f32 v228, v152, v153
 v_cvt_pk_bf16_f32 v229, v154, v155
 v_mfma_f32_16x16x32_bf16 v[132:135], a[188:191], v[56:59], v[132:135]
 v_cvt_pk_bf16_f32 v230, v156, v157
 v_cvt_pk_bf16_f32 v231, v158, v159
 v_mfma_f32_16x16x32_bf16 v[140:143], a[188:191], v[60:63], v[140:143]
 buffer_store_dwordx4 v[228:231], v6, s[48:51], s67 offen offset:256 sc1
 v_mfma_f32_16x16x32_bf16 v[136:139], a[184:187], v[60:63], v[136:139]
 s_add_u32 s74, s74, 0x40000
 s_and_b32 s69, s74, 0x200000
 s_waitcnt vmcnt(16)
 v_mfma_f32_16x16x32_bf16 v[80:83], a[192:195], v[64:67], v[80:83]
 buffer_load_dwordx4 v[56:59], v2, s[48:51], s82 offen offset:2048 sc1
 v_mfma_f32_16x16x32_bf16 v[84:87], a[196:199], v[64:67], v[84:87]
 s_lshr_b32 s69, s69, 8
 s_xor_b32 s69, s69, s74
 v_mfma_f32_16x16x32_bf16 v[92:95], a[196:199], v[68:71], v[92:95]
 buffer_load_dwordx4 v[60:63], v2, s[48:51], s82 offen offset:2304 sc1
 v_mfma_f32_16x16x32_bf16 v[88:91], a[192:195], v[68:71], v[88:91]
 buffer_store_dwordx4 v[208:211], v1, s[48:51], s69 offen sc1
 v_mfma_f32_16x16x32_bf16 v[96:99], a[200:203], v[64:67], v[96:99]
 v_mfma_f32_16x16x32_bf16 v[100:103], a[204:207], v[64:67], v[100:103]
 v_mfma_f32_16x16x32_bf16 v[108:111], a[204:207], v[68:71], v[108:111]
 v_mfma_f32_16x16x32_bf16 v[104:107], a[200:203], v[68:71], v[104:107]
 v_mfma_f32_16x16x32_bf16 v[112:115], a[208:211], v[64:67], v[112:115]
 v_mfma_f32_16x16x32_bf16 v[116:119], a[212:215], v[64:67], v[116:119]
 v_mfma_f32_16x16x32_bf16 v[124:127], a[212:215], v[68:71], v[124:127]
 v_mfma_f32_16x16x32_bf16 v[120:123], a[208:211], v[68:71], v[120:123]
 v_mfma_f32_16x16x32_bf16 v[128:131], a[216:219], v[64:67], v[128:131]
 v_mfma_f32_16x16x32_bf16 v[132:135], a[220:223], v[64:67], v[132:135]
 v_mfma_f32_16x16x32_bf16 v[140:143], a[220:223], v[68:71], v[140:143]
 v_mfma_f32_16x16x32_bf16 v[136:139], a[216:219], v[68:71], v[136:139]
 s_waitcnt vmcnt(16)
 v_mfma_f32_16x16x32_bf16 v[80:83], a[224:227], v[72:75], v[80:83]
 s_add_u32 s82, s65, 12288
 buffer_load_dwordx4 v[64:67], v2, s[48:51], s82 offen offset:0 sc1
 v_mfma_f32_16x16x32_bf16 v[84:87], a[228:231], v[72:75], v[84:87]
 v_mfma_f32_16x16x32_bf16 v[92:95], a[228:231], v[76:79], v[92:95]
 buffer_load_dwordx4 v[68:71], v2, s[48:51], s82 offen offset:256 sc1
 v_mfma_f32_16x16x32_bf16 v[88:91], a[224:227], v[76:79], v[88:91]
 v_mfma_f32_16x16x32_bf16 v[96:99], a[232:235], v[72:75], v[96:99]
 v_mfma_f32_16x16x32_bf16 v[100:103], a[236:239], v[72:75], v[100:103]
 s_add_u32 s70, s65, 131072
 buffer_load_dwordx4 v[12:15], v11, s[48:51], s70 offen offset:0 sc1
 v_mfma_f32_16x16x32_bf16 v[108:111], a[236:239], v[76:79], v[108:111]
 v_mfma_f32_16x16x32_bf16 v[104:107], a[232:235], v[76:79], v[104:107]
 v_mfma_f32_16x16x32_bf16 v[112:115], a[240:243], v[72:75], v[112:115]
 v_mfma_f32_16x16x32_bf16 v[116:119], a[244:247], v[72:75], v[116:119]
 v_mfma_f32_16x16x32_bf16 v[124:127], a[244:247], v[76:79], v[124:127]
 v_mfma_f32_16x16x32_bf16 v[120:123], a[240:243], v[76:79], v[120:123]
 v_mfma_f32_16x16x32_bf16 v[128:131], a[248:251], v[72:75], v[128:131]
 v_mfma_f32_16x16x32_bf16 v[132:135], a[252:255], v[72:75], v[132:135]
 v_mfma_f32_16x16x32_bf16 v[140:143], a[252:255], v[76:79], v[140:143]
 v_mfma_f32_16x16x32_bf16 v[136:139], a[248:251], v[76:79], v[136:139]
 buffer_load_dwordx4 v[72:75], v2, s[48:51], s82 offen offset:2048 sc1
 buffer_load_dwordx4 v[76:79], v2, s[48:51], s82 offen offset:2304 sc1
 s_add_u32 s63, s63, 1
 s_add_u32 s65, s65, 0x10000
 s_add_u32 s67, s67, 0x40000
 s_branch Lw_Kloop
Lw_Kend:
 ds_write_b128 v7, v[160:163] offset:49152
 ds_write_b128 v7, v[164:167] offset:50176
 ds_write_b128 v7, v[168:171] offset:51200
 ds_write_b128 v7, v[172:175] offset:52224
 ds_write_b128 v8, v[176:179] offset:49152
 ds_write_b128 v8, v[180:183] offset:50176
 ds_write_b128 v8, v[184:187] offset:51200
 ds_write_b128 v8, v[188:191] offset:52224
 ds_write_b128 v9, v[192:195] offset:49152
 ds_write_b128 v9, v[196:199] offset:50176
 ds_write_b128 v9, v[200:203] offset:51200
 ds_write_b128 v9, v[204:207] offset:52224
 s_waitcnt lgkmcnt(0)
 s_barrier
 ds_read_b128 v[160:163], v10 offset:49152
 ds_read_b128 v[164:167], v10 offset:50176
 ds_read_b128 v[168:171], v10 offset:51200
 ds_read_b128 v[172:175], v10 offset:52224
 ds_read_b128 v[176:179], v10 offset:53248
 ds_read_b128 v[180:183], v10 offset:54272
 ds_read_b128 v[184:187], v10 offset:55296
 ds_read_b128 v[188:191], v10 offset:56320
 ds_read_b128 v[192:195], v10 offset:57344
 ds_read_b128 v[196:199], v10 offset:58368
 ds_read_b128 v[200:203], v10 offset:59392
 ds_read_b128 v[204:207], v10 offset:60416
 s_waitcnt lgkmcnt(8)
 v_add_f32 v144, v144, v160
 v_add_f32 v145, v145, v161
 v_add_f32 v146, v146, v162
 v_add_f32 v147, v147, v163
 v_add_f32 v148, v148, v164
 v_add_f32 v149, v149, v165
 v_add_f32 v150, v150, v166
 v_add_f32 v151, v151, v167
 v_add_f32 v152, v152, v168
 v_add_f32 v153, v153, v169
 v_add_f32 v154, v154, v170
 v_add_f32 v155, v155, v171
 v_add_f32 v156, v156, v172
 v_add_f32 v157, v157, v173
 v_add_f32 v158, v158, v174
 v_add_f32 v159, v159, v175
 s_waitcnt lgkmcnt(4)
 v_add_f32 v144, v144, v176
 v_add_f32 v145, v145, v177
 v_add_f32 v146, v146, v178
 v_add_f32 v147, v147, v179
 v_add_f32 v148, v148, v180
 v_add_f32 v149, v149, v181
 v_add_f32 v150, v150, v182
 v_add_f32 v151, v151, v183
 v_add_f32 v152, v152, v184
 v_add_f32 v153, v153, v185
 v_add_f32 v154, v154, v186
 v_add_f32 v155, v155, v187
 v_add_f32 v156, v156, v188
 v_add_f32 v157, v157, v189
 v_add_f32 v158, v158, v190
 v_add_f32 v159, v159, v191
 s_waitcnt lgkmcnt(0)
 v_add_f32 v144, v144, v192
 v_add_f32 v145, v145, v193
 v_add_f32 v146, v146, v194
 v_add_f32 v147, v147, v195
 v_add_f32 v148, v148, v196
 v_add_f32 v149, v149, v197
 v_add_f32 v150, v150, v198
 v_add_f32 v151, v151, v199
 v_add_f32 v152, v152, v200
 v_add_f32 v153, v153, v201
 v_add_f32 v154, v154, v202
 v_add_f32 v155, v155, v203
 v_add_f32 v156, v156, v204
 v_add_f32 v157, v157, v205
 v_add_f32 v158, v158, v206
 v_add_f32 v159, v159, v207
 v_cvt_pk_bf16_f32 v224, v144, v145
 v_cvt_pk_bf16_f32 v225, v146, v147
 v_cvt_pk_bf16_f32 v226, v148, v149
 v_cvt_pk_bf16_f32 v227, v150, v151
 buffer_store_dwordx4 v[224:227], v6, s[48:51], s67 offen offset:0 sc1
 v_cvt_pk_bf16_f32 v228, v152, v153
 v_cvt_pk_bf16_f32 v229, v154, v155
 v_cvt_pk_bf16_f32 v230, v156, v157
 v_cvt_pk_bf16_f32 v231, v158, v159
 buffer_store_dwordx4 v[228:231], v6, s[48:51], s67 offen offset:256 sc1
 s_add_u32 s74, s74, 0x40000
 s_and_b32 s69, s74, 0x200000
 s_lshr_b32 s69, s69, 8
 s_xor_b32 s69, s69, s74
 buffer_store_dwordx4 v[208:211], v1, s[48:51], s69 offen sc1
 s_waitcnt vmcnt(0)
 v_mov_b32 v3, 64
 v_mov_b32 v4, 0
 s_mov_b64 exec, 1
 buffer_store_dword v3, v4, s[48:51], s68 offen sc1
 s_mov_b64 exec, -1
 s_waitcnt vmcnt(0) lgkmcnt(0)
 s_branch L_ssm
Lw_V:
 s_lshl_b32 s67, s62, 2
 s_add_u32 s67, s67, s4
 s_lshl_b32 s67, s67, 11
 s_add_u32 s67, s67, 33554432
 s_add_u32 s82, s65, 0
 buffer_load_dwordx4 v[16:19], v2, s[48:51], s82 offen offset:0 sc1
 buffer_load_dwordx4 v[20:23], v2, s[48:51], s82 offen offset:128 sc1
 buffer_load_dwordx4 v[24:27], v2, s[48:51], s82 offen offset:2048 sc1
 buffer_load_dwordx4 v[28:31], v2, s[48:51], s82 offen offset:2176 sc1
 s_add_u32 s82, s65, 4096
 buffer_load_dwordx4 v[32:35], v2, s[48:51], s82 offen offset:0 sc1
 buffer_load_dwordx4 v[36:39], v2, s[48:51], s82 offen offset:128 sc1
 buffer_load_dwordx4 v[40:43], v2, s[48:51], s82 offen offset:2048 sc1
 buffer_load_dwordx4 v[44:47], v2, s[48:51], s82 offen offset:2176 sc1
 s_add_u32 s82, s65, 8192
 buffer_load_dwordx4 v[48:51], v2, s[48:51], s82 offen offset:0 sc1
 buffer_load_dwordx4 v[52:55], v2, s[48:51], s82 offen offset:128 sc1
 buffer_load_dwordx4 v[56:59], v2, s[48:51], s82 offen offset:2048 sc1
 buffer_load_dwordx4 v[60:63], v2, s[48:51], s82 offen offset:2176 sc1
 s_add_u32 s82, s65, 12288
 buffer_load_dwordx4 v[64:67], v2, s[48:51], s82 offen offset:0 sc1
 buffer_load_dwordx4 v[68:71], v2, s[48:51], s82 offen offset:128 sc1
 buffer_load_dwordx4 v[72:75], v2, s[48:51], s82 offen offset:2048 sc1
 buffer_load_dwordx4 v[76:79], v2, s[48:51], s82 offen offset:2176 sc1
 s_add_u32 s65, s65, 0x10000
 s_waitcnt vmcnt(14)
 v_mfma_f32_16x16x32_bf16 v[80:83], v[16:19], a[0:3], 0
 v_mfma_f32_16x16x32_bf16 v[84:87], v[16:19], a[4:7], 0
 v_mfma_f32_16x16x32_bf16 v[92:95], v[20:23], a[4:7], 0
 v_mfma_f32_16x16x32_bf16 v[88:91], v[20:23], a[0:3], 0
 v_mfma_f32_16x16x32_bf16 v[96:99], v[16:19], a[8:11], 0
 v_mfma_f32_16x16x32_bf16 v[100:103], v[16:19], a[12:15], 0
 v_mfma_f32_16x16x32_bf16 v[108:111], v[20:23], a[12:15], 0
 v_mfma_f32_16x16x32_bf16 v[104:107], v[20:23], a[8:11], 0
 v_mfma_f32_16x16x32_bf16 v[112:115], v[16:19], a[16:19], 0
 v_mfma_f32_16x16x32_bf16 v[116:119], v[16:19], a[20:23], 0
 v_mfma_f32_16x16x32_bf16 v[124:127], v[20:23], a[20:23], 0
 v_mfma_f32_16x16x32_bf16 v[120:123], v[20:23], a[16:19], 0
 v_mfma_f32_16x16x32_bf16 v[128:131], v[16:19], a[24:27], 0
 v_mfma_f32_16x16x32_bf16 v[132:135], v[16:19], a[28:31], 0
 v_mfma_f32_16x16x32_bf16 v[140:143], v[20:23], a[28:31], 0
 v_mfma_f32_16x16x32_bf16 v[136:139], v[20:23], a[24:27], 0
 s_waitcnt vmcnt(12)
 v_mfma_f32_16x16x32_bf16 v[80:83], v[24:27], a[32:35], v[80:83]
 s_add_u32 s82, s65, 0
 buffer_load_dwordx4 v[16:19], v2, s[48:51], s82 offen offset:0 sc1
 v_mfma_f32_16x16x32_bf16 v[84:87], v[24:27], a[36:39], v[84:87]
 v_mfma_f32_16x16x32_bf16 v[92:95], v[28:31], a[36:39], v[92:95]
 buffer_load_dwordx4 v[20:23], v2, s[48:51], s82 offen offset:128 sc1
 v_mfma_f32_16x16x32_bf16 v[88:91], v[28:31], a[32:35], v[88:91]
 v_mfma_f32_16x16x32_bf16 v[96:99], v[24:27], a[40:43], v[96:99]
 v_mfma_f32_16x16x32_bf16 v[100:103], v[24:27], a[44:47], v[100:103]
 v_mfma_f32_16x16x32_bf16 v[108:111], v[28:31], a[44:47], v[108:111]
 v_mfma_f32_16x16x32_bf16 v[104:107], v[28:31], a[40:43], v[104:107]
 v_mfma_f32_16x16x32_bf16 v[112:115], v[24:27], a[48:51], v[112:115]
 v_mfma_f32_16x16x32_bf16 v[116:119], v[24:27], a[52:55], v[116:119]
 v_mfma_f32_16x16x32_bf16 v[124:127], v[28:31], a[52:55], v[124:127]
 v_mfma_f32_16x16x32_bf16 v[120:123], v[28:31], a[48:51], v[120:123]
 v_mfma_f32_16x16x32_bf16 v[128:131], v[24:27], a[56:59], v[128:131]
 v_mfma_f32_16x16x32_bf16 v[132:135], v[24:27], a[60:63], v[132:135]
 v_mfma_f32_16x16x32_bf16 v[140:143], v[28:31], a[60:63], v[140:143]
 v_mfma_f32_16x16x32_bf16 v[136:139], v[28:31], a[56:59], v[136:139]
 s_waitcnt vmcnt(12)
 v_mfma_f32_16x16x32_bf16 v[80:83], v[32:35], a[64:67], v[80:83]
 buffer_load_dwordx4 v[24:27], v2, s[48:51], s82 offen offset:2048 sc1
 v_mfma_f32_16x16x32_bf16 v[84:87], v[32:35], a[68:71], v[84:87]
 v_mfma_f32_16x16x32_bf16 v[92:95], v[36:39], a[68:71], v[92:95]
 buffer_load_dwordx4 v[28:31], v2, s[48:51], s82 offen offset:2176 sc1
 v_mfma_f32_16x16x32_bf16 v[88:91], v[36:39], a[64:67], v[88:91]
 v_mfma_f32_16x16x32_bf16 v[96:99], v[32:35], a[72:75], v[96:99]
 v_mfma_f32_16x16x32_bf16 v[100:103], v[32:35], a[76:79], v[100:103]
 v_mfma_f32_16x16x32_bf16 v[108:111], v[36:39], a[76:79], v[108:111]
 v_mfma_f32_16x16x32_bf16 v[104:107], v[36:39], a[72:75], v[104:107]
 v_mfma_f32_16x16x32_bf16 v[112:115], v[32:35], a[80:83], v[112:115]
 v_mfma_f32_16x16x32_bf16 v[116:119], v[32:35], a[84:87], v[116:119]
 v_mfma_f32_16x16x32_bf16 v[124:127], v[36:39], a[84:87], v[124:127]
 v_mfma_f32_16x16x32_bf16 v[120:123], v[36:39], a[80:83], v[120:123]
 v_mfma_f32_16x16x32_bf16 v[128:131], v[32:35], a[88:91], v[128:131]
 v_mfma_f32_16x16x32_bf16 v[132:135], v[32:35], a[92:95], v[132:135]
 v_mfma_f32_16x16x32_bf16 v[140:143], v[36:39], a[92:95], v[140:143]
 v_mfma_f32_16x16x32_bf16 v[136:139], v[36:39], a[88:91], v[136:139]
 s_waitcnt vmcnt(12)
 v_mfma_f32_16x16x32_bf16 v[80:83], v[40:43], a[96:99], v[80:83]
 s_add_u32 s82, s65, 4096
 buffer_load_dwordx4 v[32:35], v2, s[48:51], s82 offen offset:0 sc1
 v_mfma_f32_16x16x32_bf16 v[84:87], v[40:43], a[100:103], v[84:87]
 v_mfma_f32_16x16x32_bf16 v[92:95], v[44:47], a[100:103], v[92:95]
 buffer_load_dwordx4 v[36:39], v2, s[48:51], s82 offen offset:128 sc1
 v_mfma_f32_16x16x32_bf16 v[88:91], v[44:47], a[96:99], v[88:91]
 v_mfma_f32_16x16x32_bf16 v[96:99], v[40:43], a[104:107], v[96:99]
 v_mfma_f32_16x16x32_bf16 v[100:103], v[40:43], a[108:111], v[100:103]
 v_mfma_f32_16x16x32_bf16 v[108:111], v[44:47], a[108:111], v[108:111]
 v_mfma_f32_16x16x32_bf16 v[104:107], v[44:47], a[104:107], v[104:107]
 v_mfma_f32_16x16x32_bf16 v[112:115], v[40:43], a[112:115], v[112:115]
 v_mfma_f32_16x16x32_bf16 v[116:119], v[40:43], a[116:119], v[116:119]
 v_mfma_f32_16x16x32_bf16 v[124:127], v[44:47], a[116:119], v[124:127]
 v_mfma_f32_16x16x32_bf16 v[120:123], v[44:47], a[112:115], v[120:123]
 v_mfma_f32_16x16x32_bf16 v[128:131], v[40:43], a[120:123], v[128:131]
 v_mfma_f32_16x16x32_bf16 v[132:135], v[40:43], a[124:127], v[132:135]
 v_mfma_f32_16x16x32_bf16 v[140:143], v[44:47], a[124:127], v[140:143]
 v_mfma_f32_16x16x32_bf16 v[136:139], v[44:47], a[120:123], v[136:139]
 s_waitcnt vmcnt(12)
 v_mfma_f32_16x16x32_bf16 v[80:83], v[48:51], a[128:131], v[80:83]
 buffer_load_dwordx4 v[40:43], v2, s[48:51], s82 offen offset:2048 sc1
 v_mfma_f32_16x16x32_bf16 v[84:87], v[48:51], a[132:135], v[84:87]
 v_mfma_f32_16x16x32_bf16 v[92:95], v[52:55], a[132:135], v[92:95]
 buffer_load_dwordx4 v[44:47], v2, s[48:51], s82 offen offset:2176 sc1
 v_mfma_f32_16x16x32_bf16 v[88:91], v[52:55], a[128:131], v[88:91]
 v_mfma_f32_16x16x32_bf16 v[96:99], v[48:51], a[136:139], v[96:99]
 v_mfma_f32_16x16x32_bf16 v[100:103], v[48:51], a[140:143], v[100:103]
 v_mfma_f32_16x16x32_bf16 v[108:111], v[52:55], a[140:143], v[108:111]
 v_mfma_f32_16x16x32_bf16 v[104:107], v[52:55], a[136:139], v[104:107]
 v_mfma_f32_16x16x32_bf16 v[112:115], v[48:51], a[144:147], v[112:115]
 v_mfma_f32_16x16x32_bf16 v[116:119], v[48:51], a[148:151], v[116:119]
 v_mfma_f32_16x16x32_bf16 v[124:127], v[52:55], a[148:151], v[124:127]
 v_mfma_f32_16x16x32_bf16 v[120:123], v[52:55], a[144:147], v[120:123]
 v_mfma_f32_16x16x32_bf16 v[128:131], v[48:51], a[152:155], v[128:131]
 v_mfma_f32_16x16x32_bf16 v[132:135], v[48:51], a[156:159], v[132:135]
 v_mfma_f32_16x16x32_bf16 v[140:143], v[52:55], a[156:159], v[140:143]
 v_mfma_f32_16x16x32_bf16 v[136:139], v[52:55], a[152:155], v[136:139]
 s_waitcnt vmcnt(12)
 v_mfma_f32_16x16x32_bf16 v[80:83], v[56:59], a[160:163], v[80:83]
 s_add_u32 s82, s65, 8192
 buffer_load_dwordx4 v[48:51], v2, s[48:51], s82 offen offset:0 sc1
 v_mfma_f32_16x16x32_bf16 v[84:87], v[56:59], a[164:167], v[84:87]
 v_mfma_f32_16x16x32_bf16 v[92:95], v[60:63], a[164:167], v[92:95]
 buffer_load_dwordx4 v[52:55], v2, s[48:51], s82 offen offset:128 sc1
 v_mfma_f32_16x16x32_bf16 v[88:91], v[60:63], a[160:163], v[88:91]
 v_mfma_f32_16x16x32_bf16 v[96:99], v[56:59], a[168:171], v[96:99]
 v_mfma_f32_16x16x32_bf16 v[100:103], v[56:59], a[172:175], v[100:103]
 v_mfma_f32_16x16x32_bf16 v[108:111], v[60:63], a[172:175], v[108:111]
 v_mfma_f32_16x16x32_bf16 v[104:107], v[60:63], a[168:171], v[104:107]
 v_mfma_f32_16x16x32_bf16 v[112:115], v[56:59], a[176:179], v[112:115]
 v_mfma_f32_16x16x32_bf16 v[116:119], v[56:59], a[180:183], v[116:119]
 v_mfma_f32_16x16x32_bf16 v[124:127], v[60:63], a[180:183], v[124:127]
 v_mfma_f32_16x16x32_bf16 v[120:123], v[60:63], a[176:179], v[120:123]
 v_mfma_f32_16x16x32_bf16 v[128:131], v[56:59], a[184:187], v[128:131]
 v_mfma_f32_16x16x32_bf16 v[132:135], v[56:59], a[188:191], v[132:135]
 v_mfma_f32_16x16x32_bf16 v[140:143], v[60:63], a[188:191], v[140:143]
 v_mfma_f32_16x16x32_bf16 v[136:139], v[60:63], a[184:187], v[136:139]
 s_waitcnt vmcnt(12)
 v_mfma_f32_16x16x32_bf16 v[80:83], v[64:67], a[192:195], v[80:83]
 buffer_load_dwordx4 v[56:59], v2, s[48:51], s82 offen offset:2048 sc1
 v_mfma_f32_16x16x32_bf16 v[84:87], v[64:67], a[196:199], v[84:87]
 v_mfma_f32_16x16x32_bf16 v[92:95], v[68:71], a[196:199], v[92:95]
 buffer_load_dwordx4 v[60:63], v2, s[48:51], s82 offen offset:2176 sc1
 v_mfma_f32_16x16x32_bf16 v[88:91], v[68:71], a[192:195], v[88:91]
 v_mfma_f32_16x16x32_bf16 v[96:99], v[64:67], a[200:203], v[96:99]
 v_mfma_f32_16x16x32_bf16 v[100:103], v[64:67], a[204:207], v[100:103]
 v_mfma_f32_16x16x32_bf16 v[108:111], v[68:71], a[204:207], v[108:111]
 v_mfma_f32_16x16x32_bf16 v[104:107], v[68:71], a[200:203], v[104:107]
 v_mfma_f32_16x16x32_bf16 v[112:115], v[64:67], a[208:211], v[112:115]
 v_mfma_f32_16x16x32_bf16 v[116:119], v[64:67], a[212:215], v[116:119]
 v_mfma_f32_16x16x32_bf16 v[124:127], v[68:71], a[212:215], v[124:127]
 v_mfma_f32_16x16x32_bf16 v[120:123], v[68:71], a[208:211], v[120:123]
 v_mfma_f32_16x16x32_bf16 v[128:131], v[64:67], a[216:219], v[128:131]
 v_mfma_f32_16x16x32_bf16 v[132:135], v[64:67], a[220:223], v[132:135]
 v_mfma_f32_16x16x32_bf16 v[140:143], v[68:71], a[220:223], v[140:143]
 v_mfma_f32_16x16x32_bf16 v[136:139], v[68:71], a[216:219], v[136:139]
 s_waitcnt vmcnt(12)
 v_mfma_f32_16x16x32_bf16 v[80:83], v[72:75], a[224:227], v[80:83]
 s_add_u32 s82, s65, 12288
 buffer_load_dwordx4 v[64:67], v2, s[48:51], s82 offen offset:0 sc1
 v_mfma_f32_16x16x32_bf16 v[84:87], v[72:75], a[228:231], v[84:87]
 v_mfma_f32_16x16x32_bf16 v[92:95], v[76:79], a[228:231], v[92:95]
 buffer_load_dwordx4 v[68:71], v2, s[48:51], s82 offen offset:128 sc1
 v_mfma_f32_16x16x32_bf16 v[88:91], v[76:79], a[224:227], v[88:91]
 v_mfma_f32_16x16x32_bf16 v[96:99], v[72:75], a[232:235], v[96:99]
 v_mfma_f32_16x16x32_bf16 v[100:103], v[72:75], a[236:239], v[100:103]
 s_add_u32 s70, s65, 131072
 buffer_load_dwordx4 v[12:15], v11, s[48:51], s70 offen offset:0 sc1
 v_mfma_f32_16x16x32_bf16 v[108:111], v[76:79], a[236:239], v[108:111]
 v_mfma_f32_16x16x32_bf16 v[104:107], v[76:79], a[232:235], v[104:107]
 v_mfma_f32_16x16x32_bf16 v[112:115], v[72:75], a[240:243], v[112:115]
 v_mfma_f32_16x16x32_bf16 v[116:119], v[72:75], a[244:247], v[116:119]
 v_mfma_f32_16x16x32_bf16 v[124:127], v[76:79], a[244:247], v[124:127]
 v_mfma_f32_16x16x32_bf16 v[120:123], v[76:79], a[240:243], v[120:123]
 v_mfma_f32_16x16x32_bf16 v[128:131], v[72:75], a[248:251], v[128:131]
 v_mfma_f32_16x16x32_bf16 v[132:135], v[72:75], a[252:255], v[132:135]
 v_mfma_f32_16x16x32_bf16 v[140:143], v[76:79], a[252:255], v[140:143]
 v_mfma_f32_16x16x32_bf16 v[136:139], v[76:79], a[248:251], v[136:139]
 buffer_load_dwordx4 v[72:75], v2, s[48:51], s82 offen offset:2048 sc1
 buffer_load_dwordx4 v[76:79], v2, s[48:51], s82 offen offset:2176 sc1
 ds_write_b128 v7, v[96:99] offset:0
 ds_write_b128 v7, v[100:103] offset:1024
 ds_write_b128 v7, v[104:107] offset:2048
 ds_write_b128 v7, v[108:111] offset:3072
 ds_write_b128 v8, v[112:115] offset:0
 ds_write_b128 v8, v[116:119] offset:1024
 ds_write_b128 v8, v[120:123] offset:2048
 ds_write_b128 v8, v[124:127] offset:3072
 ds_write_b128 v9, v[128:131] offset:0
 ds_write_b128 v9, v[132:135] offset:1024
 ds_write_b128 v9, v[136:139] offset:2048
 ds_write_b128 v9, v[140:143] offset:3072
 s_waitcnt lgkmcnt(0)
 s_barrier
 ds_read_b128 v[96:99], v10 offset:0
 ds_read_b128 v[100:103], v10 offset:1024
 ds_read_b128 v[104:107], v10 offset:2048
 ds_read_b128 v[108:111], v10 offset:3072
 ds_read_b128 v[112:115], v10 offset:4096
 ds_read_b128 v[116:119], v10 offset:5120
 ds_read_b128 v[120:123], v10 offset:6144
 ds_read_b128 v[124:127], v10 offset:7168
 ds_read_b128 v[128:131], v10 offset:8192
 ds_read_b128 v[132:135], v10 offset:9216
 ds_read_b128 v[136:139], v10 offset:10240
 ds_read_b128 v[140:143], v10 offset:11264
 s_waitcnt lgkmcnt(8)
 v_add_f32 v80, v80, v96
 v_add_f32 v81, v81, v97
 v_add_f32 v82, v82, v98
 v_add_f32 v83, v83, v99
 v_add_f32 v84, v84, v100
 v_add_f32 v85, v85, v101
 v_add_f32 v86, v86, v102
 v_add_f32 v87, v87, v103
 v_add_f32 v88, v88, v104
 v_add_f32 v89, v89, v105
 v_add_f32 v90, v90, v106
 v_add_f32 v91, v91, v107
 v_add_f32 v92, v92, v108
 v_add_f32 v93, v93, v109
 v_add_f32 v94, v94, v110
 v_add_f32 v95, v95, v111
 s_waitcnt lgkmcnt(4)
 v_add_f32 v80, v80, v112
 v_add_f32 v81, v81, v113
 v_add_f32 v82, v82, v114
 v_add_f32 v83, v83, v115
 v_add_f32 v84, v84, v116
 v_add_f32 v85, v85, v117
 v_add_f32 v86, v86, v118
 v_add_f32 v87, v87, v119
 v_add_f32 v88, v88, v120
 v_add_f32 v89, v89, v121
 v_add_f32 v90, v90, v122
 v_add_f32 v91, v91, v123
 v_add_f32 v92, v92, v124
 v_add_f32 v93, v93, v125
 v_add_f32 v94, v94, v126
 v_add_f32 v95, v95, v127
 s_waitcnt lgkmcnt(0)
 v_add_f32 v80, v80, v128
 v_add_f32 v81, v81, v129
 v_add_f32 v82, v82, v130
 v_add_f32 v83, v83, v131
 v_add_f32 v84, v84, v132
 v_add_f32 v85, v85, v133
 v_add_f32 v86, v86, v134
 v_add_f32 v87, v87, v135
 v_add_f32 v88, v88, v136
 v_add_f32 v89, v89, v137
 v_add_f32 v90, v90, v138
 v_add_f32 v91, v91, v139
 v_add_f32 v92, v92, v140
 v_add_f32 v93, v93, v141
 v_add_f32 v94, v94, v142
 v_add_f32 v95, v95, v143
 v_cvt_pk_bf16_f32 v224, v80, v81
 v_cvt_pk_bf16_f32 v225, v82, v83
 v_cvt_pk_bf16_f32 v226, v88, v89
 v_cvt_pk_bf16_f32 v227, v90, v91
 buffer_store_dwordx4 v[224:227], v6, s[48:51], s67 offen offset:0 sc1
 v_cvt_pk_bf16_f32 v228, v84, v85
 v_cvt_pk_bf16_f32 v229, v86, v87
 v_cvt_pk_bf16_f32 v230, v92, v93
 v_cvt_pk_bf16_f32 v231, v94, v95
 buffer_store_dwordx4 v[228:231], v6, s[48:51], s67 offen offset:256 sc1
 s_waitcnt vmcnt(0)
 v_mov_b32 v3, 1
 v_mov_b32 v4, 0
 s_mov_b64 exec, 1
 buffer_store_dword v3, v4, s[48:51], s68 offen sc1
 s_mov_b64 exec, -1
 s_add_u32 s63, s63, 1
 s_add_u32 s65, s65, 0x10000
 s_add_u32 s67, s67, 0x40000
 v_mfma_f32_16x16x32_bf16 v[144:147], v[16:19], a[0:3], 0
 v_mfma_f32_16x16x32_bf16 v[148:151], v[16:19], a[4:7], 0
 v_mfma_f32_16x16x32_bf16 v[156:159], v[20:23], a[4:7], 0
 v_mfma_f32_16x16x32_bf16 v[152:155], v[20:23], a[0:3], 0
 v_mfma_f32_16x16x32_bf16 v[160:163], v[16:19], a[8:11], 0
 v_mfma_f32_16x16x32_bf16 v[164:167], v[16:19], a[12:15], 0
 v_mfma_f32_16x16x32_bf16 v[172:175], v[20:23], a[12:15], 0
 v_mfma_f32_16x16x32_bf16 v[168:171], v[20:23], a[8:11], 0
 v_mfma_f32_16x16x32_bf16 v[176:179], v[16:19], a[16:19], 0
 v_mfma_f32_16x16x32_bf16 v[180:183], v[16:19], a[20:23], 0
 v_mfma_f32_16x16x32_bf16 v[188:191], v[20:23], a[20:23], 0
 v_mfma_f32_16x16x32_bf16 v[184:187], v[20:23], a[16:19], 0
 v_mfma_f32_16x16x32_bf16 v[192:195], v[16:19], a[24:27], 0
 v_mfma_f32_16x16x32_bf16 v[196:199], v[16:19], a[28:31], 0
 v_mfma_f32_16x16x32_bf16 v[204:207], v[20:23], a[28:31], 0
 v_mfma_f32_16x16x32_bf16 v[200:203], v[20:23], a[24:27], 0
 v_mfma_f32_16x16x32_bf16 v[144:147], v[24:27], a[32:35], v[144:147]
 s_add_u32 s82, s65, 0
 buffer_load_dwordx4 v[16:19], v2, s[48:51], s82 offen offset:0 sc1
 v_mfma_f32_16x16x32_bf16 v[148:151], v[24:27], a[36:39], v[148:151]
 v_mfma_f32_16x16x32_bf16 v[156:159], v[28:31], a[36:39], v[156:159]
 buffer_load_dwordx4 v[20:23], v2, s[48:51], s82 offen offset:128 sc1
 v_mfma_f32_16x16x32_bf16 v[152:155], v[28:31], a[32:35], v[152:155]
 v_mfma_f32_16x16x32_bf16 v[160:163], v[24:27], a[40:43], v[160:163]
 v_mfma_f32_16x16x32_bf16 v[164:167], v[24:27], a[44:47], v[164:167]
 v_mfma_f32_16x16x32_bf16 v[172:175], v[28:31], a[44:47], v[172:175]
 v_mfma_f32_16x16x32_bf16 v[168:171], v[28:31], a[40:43], v[168:171]
 v_mfma_f32_16x16x32_bf16 v[176:179], v[24:27], a[48:51], v[176:179]
 v_mfma_f32_16x16x32_bf16 v[180:183], v[24:27], a[52:55], v[180:183]
 v_mfma_f32_16x16x32_bf16 v[188:191], v[28:31], a[52:55], v[188:191]
 v_mfma_f32_16x16x32_bf16 v[184:187], v[28:31], a[48:51], v[184:187]
 v_mfma_f32_16x16x32_bf16 v[192:195], v[24:27], a[56:59], v[192:195]
 v_mfma_f32_16x16x32_bf16 v[196:199], v[24:27], a[60:63], v[196:199]
 v_mfma_f32_16x16x32_bf16 v[204:207], v[28:31], a[60:63], v[204:207]
 v_mfma_f32_16x16x32_bf16 v[200:203], v[28:31], a[56:59], v[200:203]
 v_mfma_f32_16x16x32_bf16 v[144:147], v[32:35], a[64:67], v[144:147]
 buffer_load_dwordx4 v[24:27], v2, s[48:51], s82 offen offset:2048 sc1
 v_mfma_f32_16x16x32_bf16 v[148:151], v[32:35], a[68:71], v[148:151]
 v_mfma_f32_16x16x32_bf16 v[156:159], v[36:39], a[68:71], v[156:159]
 buffer_load_dwordx4 v[28:31], v2, s[48:51], s82 offen offset:2176 sc1
 v_mfma_f32_16x16x32_bf16 v[152:155], v[36:39], a[64:67], v[152:155]
 v_mfma_f32_16x16x32_bf16 v[160:163], v[32:35], a[72:75], v[160:163]
 v_mfma_f32_16x16x32_bf16 v[164:167], v[32:35], a[76:79], v[164:167]
 v_mfma_f32_16x16x32_bf16 v[172:175], v[36:39], a[76:79], v[172:175]
 v_mfma_f32_16x16x32_bf16 v[168:171], v[36:39], a[72:75], v[168:171]
 v_mfma_f32_16x16x32_bf16 v[176:179], v[32:35], a[80:83], v[176:179]
 v_mfma_f32_16x16x32_bf16 v[180:183], v[32:35], a[84:87], v[180:183]
 v_mfma_f32_16x16x32_bf16 v[188:191], v[36:39], a[84:87], v[188:191]
 v_mfma_f32_16x16x32_bf16 v[184:187], v[36:39], a[80:83], v[184:187]
 v_mfma_f32_16x16x32_bf16 v[192:195], v[32:35], a[88:91], v[192:195]
 v_mfma_f32_16x16x32_bf16 v[196:199], v[32:35], a[92:95], v[196:199]
 v_mfma_f32_16x16x32_bf16 v[204:207], v[36:39], a[92:95], v[204:207]
 v_mfma_f32_16x16x32_bf16 v[200:203], v[36:39], a[88:91], v[200:203]
 v_mfma_f32_16x16x32_bf16 v[144:147], v[40:43], a[96:99], v[144:147]
 s_add_u32 s82, s65, 4096
 buffer_load_dwordx4 v[32:35], v2, s[48:51], s82 offen offset:0 sc1
 v_mfma_f32_16x16x32_bf16 v[148:151], v[40:43], a[100:103], v[148:151]
 v_mfma_f32_16x16x32_bf16 v[156:159], v[44:47], a[100:103], v[156:159]
 buffer_load_dwordx4 v[36:39], v2, s[48:51], s82 offen offset:128 sc1
 v_mfma_f32_16x16x32_bf16 v[152:155], v[44:47], a[96:99], v[152:155]
 v_mfma_f32_16x16x32_bf16 v[160:163], v[40:43], a[104:107], v[160:163]
 v_mfma_f32_16x16x32_bf16 v[164:167], v[40:43], a[108:111], v[164:167]
 v_mfma_f32_16x16x32_bf16 v[172:175], v[44:47], a[108:111], v[172:175]
 v_mfma_f32_16x16x32_bf16 v[168:171], v[44:47], a[104:107], v[168:171]
 v_mfma_f32_16x16x32_bf16 v[176:179], v[40:43], a[112:115], v[176:179]
 v_mfma_f32_16x16x32_bf16 v[180:183], v[40:43], a[116:119], v[180:183]
 v_mfma_f32_16x16x32_bf16 v[188:191], v[44:47], a[116:119], v[188:191]
 v_mfma_f32_16x16x32_bf16 v[184:187], v[44:47], a[112:115], v[184:187]
 v_mfma_f32_16x16x32_bf16 v[192:195], v[40:43], a[120:123], v[192:195]
 v_mfma_f32_16x16x32_bf16 v[196:199], v[40:43], a[124:127], v[196:199]
 v_mfma_f32_16x16x32_bf16 v[204:207], v[44:47], a[124:127], v[204:207]
 v_mfma_f32_16x16x32_bf16 v[200:203], v[44:47], a[120:123], v[200:203]
 v_mfma_f32_16x16x32_bf16 v[144:147], v[48:51], a[128:131], v[144:147]
 buffer_load_dwordx4 v[40:43], v2, s[48:51], s82 offen offset:2048 sc1
 v_mfma_f32_16x16x32_bf16 v[148:151], v[48:51], a[132:135], v[148:151]
 v_mfma_f32_16x16x32_bf16 v[156:159], v[52:55], a[132:135], v[156:159]
 buffer_load_dwordx4 v[44:47], v2, s[48:51], s82 offen offset:2176 sc1
 v_mfma_f32_16x16x32_bf16 v[152:155], v[52:55], a[128:131], v[152:155]
 v_mfma_f32_16x16x32_bf16 v[160:163], v[48:51], a[136:139], v[160:163]
 v_mfma_f32_16x16x32_bf16 v[164:167], v[48:51], a[140:143], v[164:167]
 v_mfma_f32_16x16x32_bf16 v[172:175], v[52:55], a[140:143], v[172:175]
 v_mfma_f32_16x16x32_bf16 v[168:171], v[52:55], a[136:139], v[168:171]
 v_mfma_f32_16x16x32_bf16 v[176:179], v[48:51], a[144:147], v[176:179]
 v_mfma_f32_16x16x32_bf16 v[180:183], v[48:51], a[148:151], v[180:183]
 v_mfma_f32_16x16x32_bf16 v[188:191], v[52:55], a[148:151], v[188:191]
 v_mfma_f32_16x16x32_bf16 v[184:187], v[52:55], a[144:147], v[184:187]
 v_mfma_f32_16x16x32_bf16 v[192:195], v[48:51], a[152:155], v[192:195]
 v_mfma_f32_16x16x32_bf16 v[196:199], v[48:51], a[156:159], v[196:199]
 v_mfma_f32_16x16x32_bf16 v[204:207], v[52:55], a[156:159], v[204:207]
 v_mfma_f32_16x16x32_bf16 v[200:203], v[52:55], a[152:155], v[200:203]
 v_mfma_f32_16x16x32_bf16 v[144:147], v[56:59], a[160:163], v[144:147]
 s_add_u32 s82, s65, 8192
 buffer_load_dwordx4 v[48:51], v2, s[48:51], s82 offen offset:0 sc1
 v_mfma_f32_16x16x32_bf16 v[148:151], v[56:59], a[164:167], v[148:151]
 v_mfma_f32_16x16x32_bf16 v[156:159], v[60:63], a[164:167], v[156:159]
 buffer_load_dwordx4 v[52:55], v2, s[48:51], s82 offen offset:128 sc1
 v_mfma_f32_16x16x32_bf16 v[152:155], v[60:63], a[160:163], v[152:155]
 v_mfma_f32_16x16x32_bf16 v[160:163], v[56:59], a[168:171], v[160:163]
 v_mfma_f32_16x16x32_bf16 v[164:167], v[56:59], a[172:175], v[164:167]
 v_mfma_f32_16x16x32_bf16 v[172:175], v[60:63], a[172:175], v[172:175]
 v_mfma_f32_16x16x32_bf16 v[168:171], v[60:63], a[168:171], v[168:171]
 v_mfma_f32_16x16x32_bf16 v[176:179], v[56:59], a[176:179], v[176:179]
 v_mfma_f32_16x16x32_bf16 v[180:183], v[56:59], a[180:183], v[180:183]
 v_mfma_f32_16x16x32_bf16 v[188:191], v[60:63], a[180:183], v[188:191]
 v_mfma_f32_16x16x32_bf16 v[184:187], v[60:63], a[176:179], v[184:187]
 v_mfma_f32_16x16x32_bf16 v[192:195], v[56:59], a[184:187], v[192:195]
 v_mfma_f32_16x16x32_bf16 v[196:199], v[56:59], a[188:191], v[196:199]
 v_mfma_f32_16x16x32_bf16 v[204:207], v[60:63], a[188:191], v[204:207]
 v_mfma_f32_16x16x32_bf16 v[200:203], v[60:63], a[184:187], v[200:203]
 v_mfma_f32_16x16x32_bf16 v[144:147], v[64:67], a[192:195], v[144:147]
 buffer_load_dwordx4 v[56:59], v2, s[48:51], s82 offen offset:2048 sc1
 v_mfma_f32_16x16x32_bf16 v[148:151], v[64:67], a[196:199], v[148:151]
 v_mfma_f32_16x16x32_bf16 v[156:159], v[68:71], a[196:199], v[156:159]
 buffer_load_dwordx4 v[60:63], v2, s[48:51], s82 offen offset:2176 sc1
 v_mfma_f32_16x16x32_bf16 v[152:155], v[68:71], a[192:195], v[152:155]
 v_mfma_f32_16x16x32_bf16 v[160:163], v[64:67], a[200:203], v[160:163]
 v_mfma_f32_16x16x32_bf16 v[164:167], v[64:67], a[204:207], v[164:167]
 v_mfma_f32_16x16x32_bf16 v[172:175], v[68:71], a[204:207], v[172:175]
 v_mfma_f32_16x16x32_bf16 v[168:171], v[68:71], a[200:203], v[168:171]
 v_mfma_f32_16x16x32_bf16 v[176:179], v[64:67], a[208:211], v[176:179]
 v_mfma_f32_16x16x32_bf16 v[180:183], v[64:67], a[212:215], v[180:183]
 v_mfma_f32_16x16x32_bf16 v[188:191], v[68:71], a[212:215], v[188:191]
 v_mfma_f32_16x16x32_bf16 v[184:187], v[68:71], a[208:211], v[184:187]
 v_mfma_f32_16x16x32_bf16 v[192:195], v[64:67], a[216:219], v[192:195]
 v_mfma_f32_16x16x32_bf16 v[196:199], v[64:67], a[220:223], v[196:199]
 v_mfma_f32_16x16x32_bf16 v[204:207], v[68:71], a[220:223], v[204:207]
 v_mfma_f32_16x16x32_bf16 v[200:203], v[68:71], a[216:219], v[200:203]
 v_mfma_f32_16x16x32_bf16 v[144:147], v[72:75], a[224:227], v[144:147]
 s_add_u32 s82, s65, 12288
 buffer_load_dwordx4 v[64:67], v2, s[48:51], s82 offen offset:0 sc1
 v_mfma_f32_16x16x32_bf16 v[148:151], v[72:75], a[228:231], v[148:151]
 v_mfma_f32_16x16x32_bf16 v[156:159], v[76:79], a[228:231], v[156:159]
 buffer_load_dwordx4 v[68:71], v2, s[48:51], s82 offen offset:128 sc1
 v_mfma_f32_16x16x32_bf16 v[152:155], v[76:79], a[224:227], v[152:155]
 v_mfma_f32_16x16x32_bf16 v[160:163], v[72:75], a[232:235], v[160:163]
 v_mfma_f32_16x16x32_bf16 v[164:167], v[72:75], a[236:239], v[164:167]
 s_add_u32 s70, s65, 131072
 buffer_load_dwordx4 v[12:15], v11, s[48:51], s70 offen offset:0 sc1
 v_mfma_f32_16x16x32_bf16 v[172:175], v[76:79], a[236:239], v[172:175]
 v_mfma_f32_16x16x32_bf16 v[168:171], v[76:79], a[232:235], v[168:171]
 v_mfma_f32_16x16x32_bf16 v[176:179], v[72:75], a[240:243], v[176:179]
 v_mfma_f32_16x16x32_bf16 v[180:183], v[72:75], a[244:247], v[180:183]
 v_mfma_f32_16x16x32_bf16 v[188:191], v[76:79], a[244:247], v[188:191]
 v_mfma_f32_16x16x32_bf16 v[184:187], v[76:79], a[240:243], v[184:187]
 v_mfma_f32_16x16x32_bf16 v[192:195], v[72:75], a[248:251], v[192:195]
 v_mfma_f32_16x16x32_bf16 v[196:199], v[72:75], a[252:255], v[196:199]
 v_mfma_f32_16x16x32_bf16 v[204:207], v[76:79], a[252:255], v[204:207]
 v_mfma_f32_16x16x32_bf16 v[200:203], v[76:79], a[248:251], v[200:203]
 buffer_load_dwordx4 v[72:75], v2, s[48:51], s82 offen offset:2048 sc1
 buffer_load_dwordx4 v[76:79], v2, s[48:51], s82 offen offset:2176 sc1
 ds_write_b128 v7, v[160:163] offset:49152
 ds_write_b128 v7, v[164:167] offset:50176
 ds_write_b128 v7, v[168:171] offset:51200
 ds_write_b128 v7, v[172:175] offset:52224
 ds_write_b128 v8, v[176:179] offset:49152
 ds_write_b128 v8, v[180:183] offset:50176
 ds_write_b128 v8, v[184:187] offset:51200
 ds_write_b128 v8, v[188:191] offset:52224
 ds_write_b128 v9, v[192:195] offset:49152
 ds_write_b128 v9, v[196:199] offset:50176
 ds_write_b128 v9, v[200:203] offset:51200
 ds_write_b128 v9, v[204:207] offset:52224
 s_waitcnt lgkmcnt(0)
 s_barrier
 ds_read_b128 v[160:163], v10 offset:49152
 ds_read_b128 v[164:167], v10 offset:50176
 ds_read_b128 v[168:171], v10 offset:51200
 ds_read_b128 v[172:175], v10 offset:52224
 ds_read_b128 v[176:179], v10 offset:53248
 ds_read_b128 v[180:183], v10 offset:54272
 ds_read_b128 v[184:187], v10 offset:55296
 ds_read_b128 v[188:191], v10 offset:56320
 ds_read_b128 v[192:195], v10 offset:57344
 ds_read_b128 v[196:199], v10 offset:58368
 ds_read_b128 v[200:203], v10 offset:59392
 ds_read_b128 v[204:207], v10 offset:60416
 s_waitcnt lgkmcnt(8)
 v_add_f32 v144, v144, v160
 v_add_f32 v145, v145, v161
 v_add_f32 v146, v146, v162
 v_add_f32 v147, v147, v163
 v_add_f32 v148, v148, v164
 v_add_f32 v149, v149, v165
 v_add_f32 v150, v150, v166
 v_add_f32 v151, v151, v167
 v_add_f32 v152, v152, v168
 v_add_f32 v153, v153, v169
 v_add_f32 v154, v154, v170
 v_add_f32 v155, v155, v171
 v_add_f32 v156, v156, v172
 v_add_f32 v157, v157, v173
 v_add_f32 v158, v158, v174
 v_add_f32 v159, v159, v175
 s_waitcnt lgkmcnt(4)
 v_add_f32 v144, v144, v176
 v_add_f32 v145, v145, v177
 v_add_f32 v146, v146, v178
 v_add_f32 v147, v147, v179
 v_add_f32 v148, v148, v180
 v_add_f32 v149, v149, v181
 v_add_f32 v150, v150, v182
 v_add_f32 v151, v151, v183
 v_add_f32 v152, v152, v184
 v_add_f32 v153, v153, v185
 v_add_f32 v154, v154, v186
 v_add_f32 v155, v155, v187
 v_add_f32 v156, v156, v188
 v_add_f32 v157, v157, v189
 v_add_f32 v158, v158, v190
 v_add_f32 v159, v159, v191
 s_waitcnt lgkmcnt(0)
 v_add_f32 v144, v144, v192
 v_add_f32 v145, v145, v193
 v_add_f32 v146, v146, v194
 v_add_f32 v147, v147, v195
 v_add_f32 v148, v148, v196
 v_add_f32 v149, v149, v197
 v_add_f32 v150, v150, v198
 v_add_f32 v151, v151, v199
 v_add_f32 v152, v152, v200
 v_add_f32 v153, v153, v201
 v_add_f32 v154, v154, v202
 v_add_f32 v155, v155, v203
 v_add_f32 v156, v156, v204
 v_add_f32 v157, v157, v205
 v_add_f32 v158, v158, v206
 v_add_f32 v159, v159, v207
 v_cvt_pk_bf16_f32 v224, v144, v145
 v_cvt_pk_bf16_f32 v225, v146, v147
 v_cvt_pk_bf16_f32 v226, v152, v153
 v_cvt_pk_bf16_f32 v227, v154, v155
 buffer_store_dwordx4 v[224:227], v6, s[48:51], s67 offen offset:0 sc1
 v_cvt_pk_bf16_f32 v228, v148, v149
 v_cvt_pk_bf16_f32 v229, v150, v151
 v_cvt_pk_bf16_f32 v230, v156, v157
 v_cvt_pk_bf16_f32 v231, v158, v159
 buffer_store_dwordx4 v[228:231], v6, s[48:51], s67 offen offset:256 sc1
 s_waitcnt vmcnt(0)
 v_mov_b32 v3, 2
 v_mov_b32 v4, 0
 s_mov_b64 exec, 1
 buffer_store_dword v3, v4, s[48:51], s68 offen sc1
 s_mov_b64 exec, -1
 s_add_u32 s63, s63, 1
 s_add_u32 s65, s65, 0x10000
 s_add_u32 s67, s67, 0x40000
 v_mfma_f32_16x16x32_bf16 v[80:83], v[16:19], a[0:3], 0
 v_mfma_f32_16x16x32_bf16 v[84:87], v[16:19], a[4:7], 0
 v_mfma_f32_16x16x32_bf16 v[92:95], v[20:23], a[4:7], 0
 v_mfma_f32_16x16x32_bf16 v[88:91], v[20:23], a[0:3], 0
 v_mfma_f32_16x16x32_bf16 v[96:99], v[16:19], a[8:11], 0
 v_mfma_f32_16x16x32_bf16 v[100:103], v[16:19], a[12:15], 0
 v_mfma_f32_16x16x32_bf16 v[108:111], v[20:23], a[12:15], 0
 v_mfma_f32_16x16x32_bf16 v[104:107], v[20:23], a[8:11], 0
 v_mfma_f32_16x16x32_bf16 v[112:115], v[16:19], a[16:19], 0
 v_mfma_f32_16x16x32_bf16 v[116:119], v[16:19], a[20:23], 0
 v_mfma_f32_16x16x32_bf16 v[124:127], v[20:23], a[20:23], 0
 v_mfma_f32_16x16x32_bf16 v[120:123], v[20:23], a[16:19], 0
 v_mfma_f32_16x16x32_bf16 v[128:131], v[16:19], a[24:27], 0
 v_mfma_f32_16x16x32_bf16 v[132:135], v[16:19], a[28:31], 0
 v_mfma_f32_16x16x32_bf16 v[140:143], v[20:23], a[28:31], 0
 v_mfma_f32_16x16x32_bf16 v[136:139], v[20:23], a[24:27], 0
 v_mfma_f32_16x16x32_bf16 v[80:83], v[24:27], a[32:35], v[80:83]
 s_add_u32 s82, s65, 0
 buffer_load_dwordx4 v[16:19], v2, s[48:51], s82 offen offset:0 sc1
 v_mfma_f32_16x16x32_bf16 v[84:87], v[24:27], a[36:39], v[84:87]
 v_mfma_f32_16x16x32_bf16 v[92:95], v[28:31], a[36:39], v[92:95]
 buffer_load_dwordx4 v[20:23], v2, s[48:51], s82 offen offset:128 sc1
 v_mfma_f32_16x16x32_bf16 v[88:91], v[28:31], a[32:35], v[88:91]
 v_mfma_f32_16x16x32_bf16 v[96:99], v[24:27], a[40:43], v[96:99]
 v_mfma_f32_16x16x32_bf16 v[100:103], v[24:27], a[44:47], v[100:103]
 v_mfma_f32_16x16x32_bf16 v[108:111], v[28:31], a[44:47], v[108:111]
 v_mfma_f32_16x16x32_bf16 v[104:107], v[28:31], a[40:43], v[104:107]
 v_mfma_f32_16x16x32_bf16 v[112:115], v[24:27], a[48:51], v[112:115]
 v_mfma_f32_16x16x32_bf16 v[116:119], v[24:27], a[52:55], v[116:119]
 v_mfma_f32_16x16x32_bf16 v[124:127], v[28:31], a[52:55], v[124:127]
 v_mfma_f32_16x16x32_bf16 v[120:123], v[28:31], a[48:51], v[120:123]
 v_mfma_f32_16x16x32_bf16 v[128:131], v[24:27], a[56:59], v[128:131]
 v_mfma_f32_16x16x32_bf16 v[132:135], v[24:27], a[60:63], v[132:135]
 v_mfma_f32_16x16x32_bf16 v[140:143], v[28:31], a[60:63], v[140:143]
 v_mfma_f32_16x16x32_bf16 v[136:139], v[28:31], a[56:59], v[136:139]
 v_mfma_f32_16x16x32_bf16 v[80:83], v[32:35], a[64:67], v[80:83]
 buffer_load_dwordx4 v[24:27], v2, s[48:51], s82 offen offset:2048 sc1
 v_mfma_f32_16x16x32_bf16 v[84:87], v[32:35], a[68:71], v[84:87]
 v_mfma_f32_16x16x32_bf16 v[92:95], v[36:39], a[68:71], v[92:95]
 buffer_load_dwordx4 v[28:31], v2, s[48:51], s82 offen offset:2176 sc1
 v_mfma_f32_16x16x32_bf16 v[88:91], v[36:39], a[64:67], v[88:91]
 v_mfma_f32_16x16x32_bf16 v[96:99], v[32:35], a[72:75], v[96:99]
 v_mfma_f32_16x16x32_bf16 v[100:103], v[32:35], a[76:79], v[100:103]
 v_mfma_f32_16x16x32_bf16 v[108:111], v[36:39], a[76:79], v[108:111]
 v_mfma_f32_16x16x32_bf16 v[104:107], v[36:39], a[72:75], v[104:107]
 v_mfma_f32_16x16x32_bf16 v[112:115], v[32:35], a[80:83], v[112:115]
 v_mfma_f32_16x16x32_bf16 v[116:119], v[32:35], a[84:87], v[116:119]
 v_mfma_f32_16x16x32_bf16 v[124:127], v[36:39], a[84:87], v[124:127]
 v_mfma_f32_16x16x32_bf16 v[120:123], v[36:39], a[80:83], v[120:123]
 v_mfma_f32_16x16x32_bf16 v[128:131], v[32:35], a[88:91], v[128:131]
 v_mfma_f32_16x16x32_bf16 v[132:135], v[32:35], a[92:95], v[132:135]
 v_mfma_f32_16x16x32_bf16 v[140:143], v[36:39], a[92:95], v[140:143]
 v_mfma_f32_16x16x32_bf16 v[136:139], v[36:39], a[88:91], v[136:139]
 v_mfma_f32_16x16x32_bf16 v[80:83], v[40:43], a[96:99], v[80:83]
 s_add_u32 s82, s65, 4096
 buffer_load_dwordx4 v[32:35], v2, s[48:51], s82 offen offset:0 sc1
 v_mfma_f32_16x16x32_bf16 v[84:87], v[40:43], a[100:103], v[84:87]
 v_mfma_f32_16x16x32_bf16 v[92:95], v[44:47], a[100:103], v[92:95]
 buffer_load_dwordx4 v[36:39], v2, s[48:51], s82 offen offset:128 sc1
 v_mfma_f32_16x16x32_bf16 v[88:91], v[44:47], a[96:99], v[88:91]
 v_mfma_f32_16x16x32_bf16 v[96:99], v[40:43], a[104:107], v[96:99]
 v_mfma_f32_16x16x32_bf16 v[100:103], v[40:43], a[108:111], v[100:103]
 v_mfma_f32_16x16x32_bf16 v[108:111], v[44:47], a[108:111], v[108:111]
 v_mfma_f32_16x16x32_bf16 v[104:107], v[44:47], a[104:107], v[104:107]
 v_mfma_f32_16x16x32_bf16 v[112:115], v[40:43], a[112:115], v[112:115]
 v_mfma_f32_16x16x32_bf16 v[116:119], v[40:43], a[116:119], v[116:119]
 v_mfma_f32_16x16x32_bf16 v[124:127], v[44:47], a[116:119], v[124:127]
 v_mfma_f32_16x16x32_bf16 v[120:123], v[44:47], a[112:115], v[120:123]
 v_mfma_f32_16x16x32_bf16 v[128:131], v[40:43], a[120:123], v[128:131]
 v_mfma_f32_16x16x32_bf16 v[132:135], v[40:43], a[124:127], v[132:135]
 v_mfma_f32_16x16x32_bf16 v[140:143], v[44:47], a[124:127], v[140:143]
 v_mfma_f32_16x16x32_bf16 v[136:139], v[44:47], a[120:123], v[136:139]
 v_mfma_f32_16x16x32_bf16 v[80:83], v[48:51], a[128:131], v[80:83]
 buffer_load_dwordx4 v[40:43], v2, s[48:51], s82 offen offset:2048 sc1
 v_mfma_f32_16x16x32_bf16 v[84:87], v[48:51], a[132:135], v[84:87]
 v_mfma_f32_16x16x32_bf16 v[92:95], v[52:55], a[132:135], v[92:95]
 buffer_load_dwordx4 v[44:47], v2, s[48:51], s82 offen offset:2176 sc1
 v_mfma_f32_16x16x32_bf16 v[88:91], v[52:55], a[128:131], v[88:91]
 v_mfma_f32_16x16x32_bf16 v[96:99], v[48:51], a[136:139], v[96:99]
 v_mfma_f32_16x16x32_bf16 v[100:103], v[48:51], a[140:143], v[100:103]
 v_mfma_f32_16x16x32_bf16 v[108:111], v[52:55], a[140:143], v[108:111]
 v_mfma_f32_16x16x32_bf16 v[104:107], v[52:55], a[136:139], v[104:107]
 v_mfma_f32_16x16x32_bf16 v[112:115], v[48:51], a[144:147], v[112:115]
 v_mfma_f32_16x16x32_bf16 v[116:119], v[48:51], a[148:151], v[116:119]
 v_mfma_f32_16x16x32_bf16 v[124:127], v[52:55], a[148:151], v[124:127]
 v_mfma_f32_16x16x32_bf16 v[120:123], v[52:55], a[144:147], v[120:123]
 v_mfma_f32_16x16x32_bf16 v[128:131], v[48:51], a[152:155], v[128:131]
 v_mfma_f32_16x16x32_bf16 v[132:135], v[48:51], a[156:159], v[132:135]
 v_mfma_f32_16x16x32_bf16 v[140:143], v[52:55], a[156:159], v[140:143]
 v_mfma_f32_16x16x32_bf16 v[136:139], v[52:55], a[152:155], v[136:139]
 v_mfma_f32_16x16x32_bf16 v[80:83], v[56:59], a[160:163], v[80:83]
 s_add_u32 s82, s65, 8192
 buffer_load_dwordx4 v[48:51], v2, s[48:51], s82 offen offset:0 sc1
 v_mfma_f32_16x16x32_bf16 v[84:87], v[56:59], a[164:167], v[84:87]
 v_mfma_f32_16x16x32_bf16 v[92:95], v[60:63], a[164:167], v[92:95]
 buffer_load_dwordx4 v[52:55], v2, s[48:51], s82 offen offset:128 sc1
 v_mfma_f32_16x16x32_bf16 v[88:91], v[60:63], a[160:163], v[88:91]
 v_mfma_f32_16x16x32_bf16 v[96:99], v[56:59], a[168:171], v[96:99]
 v_mfma_f32_16x16x32_bf16 v[100:103], v[56:59], a[172:175], v[100:103]
 v_mfma_f32_16x16x32_bf16 v[108:111], v[60:63], a[172:175], v[108:111]
 v_mfma_f32_16x16x32_bf16 v[104:107], v[60:63], a[168:171], v[104:107]
 v_mfma_f32_16x16x32_bf16 v[112:115], v[56:59], a[176:179], v[112:115]
 v_mfma_f32_16x16x32_bf16 v[116:119], v[56:59], a[180:183], v[116:119]
 v_mfma_f32_16x16x32_bf16 v[124:127], v[60:63], a[180:183], v[124:127]
 v_mfma_f32_16x16x32_bf16 v[120:123], v[60:63], a[176:179], v[120:123]
 v_mfma_f32_16x16x32_bf16 v[128:131], v[56:59], a[184:187], v[128:131]
 v_mfma_f32_16x16x32_bf16 v[132:135], v[56:59], a[188:191], v[132:135]
 v_mfma_f32_16x16x32_bf16 v[140:143], v[60:63], a[188:191], v[140:143]
 v_mfma_f32_16x16x32_bf16 v[136:139], v[60:63], a[184:187], v[136:139]
 v_mfma_f32_16x16x32_bf16 v[80:83], v[64:67], a[192:195], v[80:83]
 buffer_load_dwordx4 v[56:59], v2, s[48:51], s82 offen offset:2048 sc1
 v_mfma_f32_16x16x32_bf16 v[84:87], v[64:67], a[196:199], v[84:87]
 v_mfma_f32_16x16x32_bf16 v[92:95], v[68:71], a[196:199], v[92:95]
 buffer_load_dwordx4 v[60:63], v2, s[48:51], s82 offen offset:2176 sc1
 v_mfma_f32_16x16x32_bf16 v[88:91], v[68:71], a[192:195], v[88:91]
 v_mfma_f32_16x16x32_bf16 v[96:99], v[64:67], a[200:203], v[96:99]
 v_mfma_f32_16x16x32_bf16 v[100:103], v[64:67], a[204:207], v[100:103]
 v_mfma_f32_16x16x32_bf16 v[108:111], v[68:71], a[204:207], v[108:111]
 v_mfma_f32_16x16x32_bf16 v[104:107], v[68:71], a[200:203], v[104:107]
 v_mfma_f32_16x16x32_bf16 v[112:115], v[64:67], a[208:211], v[112:115]
 v_mfma_f32_16x16x32_bf16 v[116:119], v[64:67], a[212:215], v[116:119]
 v_mfma_f32_16x16x32_bf16 v[124:127], v[68:71], a[212:215], v[124:127]
 v_mfma_f32_16x16x32_bf16 v[120:123], v[68:71], a[208:211], v[120:123]
 v_mfma_f32_16x16x32_bf16 v[128:131], v[64:67], a[216:219], v[128:131]
 v_mfma_f32_16x16x32_bf16 v[132:135], v[64:67], a[220:223], v[132:135]
 v_mfma_f32_16x16x32_bf16 v[140:143], v[68:71], a[220:223], v[140:143]
 v_mfma_f32_16x16x32_bf16 v[136:139], v[68:71], a[216:219], v[136:139]
 v_mfma_f32_16x16x32_bf16 v[80:83], v[72:75], a[224:227], v[80:83]
 s_add_u32 s82, s65, 12288
 buffer_load_dwordx4 v[64:67], v2, s[48:51], s82 offen offset:0 sc1
 v_mfma_f32_16x16x32_bf16 v[84:87], v[72:75], a[228:231], v[84:87]
 v_mfma_f32_16x16x32_bf16 v[92:95], v[76:79], a[228:231], v[92:95]
 buffer_load_dwordx4 v[68:71], v2, s[48:51], s82 offen offset:128 sc1
 v_mfma_f32_16x16x32_bf16 v[88:91], v[76:79], a[224:227], v[88:91]
 v_mfma_f32_16x16x32_bf16 v[96:99], v[72:75], a[232:235], v[96:99]
 v_mfma_f32_16x16x32_bf16 v[100:103], v[72:75], a[236:239], v[100:103]
 s_add_u32 s70, s65, 131072
 buffer_load_dwordx4 v[12:15], v11, s[48:51], s70 offen offset:0 sc1
 v_mfma_f32_16x16x32_bf16 v[108:111], v[76:79], a[236:239], v[108:111]
 v_mfma_f32_16x16x32_bf16 v[104:107], v[76:79], a[232:235], v[104:107]
 v_mfma_f32_16x16x32_bf16 v[112:115], v[72:75], a[240:243], v[112:115]
 v_mfma_f32_16x16x32_bf16 v[116:119], v[72:75], a[244:247], v[116:119]
 v_mfma_f32_16x16x32_bf16 v[124:127], v[76:79], a[244:247], v[124:127]
 v_mfma_f32_16x16x32_bf16 v[120:123], v[76:79], a[240:243], v[120:123]
 v_mfma_f32_16x16x32_bf16 v[128:131], v[72:75], a[248:251], v[128:131]
 v_mfma_f32_16x16x32_bf16 v[132:135], v[72:75], a[252:255], v[132:135]
 v_mfma_f32_16x16x32_bf16 v[140:143], v[76:79], a[252:255], v[140:143]
 v_mfma_f32_16x16x32_bf16 v[136:139], v[76:79], a[248:251], v[136:139]
 buffer_load_dwordx4 v[72:75], v2, s[48:51], s82 offen offset:2048 sc1
 buffer_load_dwordx4 v[76:79], v2, s[48:51], s82 offen offset:2176 sc1
 s_add_u32 s63, s63, 1
 s_add_u32 s65, s65, 0x10000
 s_waitcnt vmcnt(0)
Lw_Vloop:
 s_cmp_eq_u32 s63, 27
 s_cbranch_scc0 Lw_Vxf
 v_mov_b32 v3, 0
news_81:
 global_load_dword v4, v3, s[42:43] offset:132 sc1
 s_waitcnt vmcnt(0)
 v_readfirstlane_b32 s7, v4
 s_nop 0
 s_and_b32 s7, s7, 8
 s_cmp_eq_u32 s7, 8
 s_cbranch_scc1 newsok_82
 s_sleep 2
 s_sub_u32 s46, s46, 1
 s_cbranch_scc0 news_81
 s_mov_b32 s46, 0
 s_branch newsok_82
newsok_82:
Lw_Vxf:
 s_waitcnt vmcnt(18)
 v_mfma_f32_16x16x32_bf16 v[144:147], v[16:19], a[0:3], 0
 v_mfma_f32_16x16x32_bf16 v[148:151], v[16:19], a[4:7], 0
 v_mfma_f32_16x16x32_bf16 v[156:159], v[20:23], a[4:7], 0
 ds_write_b128 v7, v[96:99] offset:0
 v_mfma_f32_16x16x32_bf16 v[152:155], v[20:23], a[0:3], 0
 v_mfma_f32_16x16x32_bf16 v[160:163], v[16:19], a[8:11], 0
 v_mfma_f32_16x16x32_bf16 v[164:167], v[16:19], a[12:15], 0
 ds_write_b128 v7, v[100:103] offset:1024
 v_mfma_f32_16x16x32_bf16 v[172:175], v[20:23], a[12:15], 0
 v_mfma_f32_16x16x32_bf16 v[168:171], v[20:23], a[8:11], 0
 v_mfma_f32_16x16x32_bf16 v[176:179], v[16:19], a[16:19], 0
 ds_write_b128 v7, v[104:107] offset:2048
 v_mfma_f32_16x16x32_bf16 v[180:183], v[16:19], a[20:23], 0
 v_mfma_f32_16x16x32_bf16 v[188:191], v[20:23], a[20:23], 0
 v_mfma_f32_16x16x32_bf16 v[184:187], v[20:23], a[16:19], 0
 ds_write_b128 v7, v[108:111] offset:3072
 v_mfma_f32_16x16x32_bf16 v[192:195], v[16:19], a[24:27], 0
 v_mfma_f32_16x16x32_bf16 v[196:199], v[16:19], a[28:31], 0
 v_mfma_f32_16x16x32_bf16 v[204:207], v[20:23], a[28:31], 0
 ds_write_b128 v8, v[112:115] offset:0
 v_mfma_f32_16x16x32_bf16 v[200:203], v[20:23], a[24:27], 0
 s_waitcnt vmcnt(16)
 v_mfma_f32_16x16x32_bf16 v[144:147], v[24:27], a[32:35], v[144:147]
 s_add_u32 s82, s65, 0
 buffer_load_dwordx4 v[16:19], v2, s[48:51], s82 offen offset:0 sc1
 v_mfma_f32_16x16x32_bf16 v[148:151], v[24:27], a[36:39], v[148:151]
 v_mfma_f32_16x16x32_bf16 v[156:159], v[28:31], a[36:39], v[156:159]
 buffer_load_dwordx4 v[20:23], v2, s[48:51], s82 offen offset:128 sc1
 v_mfma_f32_16x16x32_bf16 v[152:155], v[28:31], a[32:35], v[152:155]
 ds_write_b128 v8, v[116:119] offset:1024
 v_mfma_f32_16x16x32_bf16 v[160:163], v[24:27], a[40:43], v[160:163]
 v_mfma_f32_16x16x32_bf16 v[164:167], v[24:27], a[44:47], v[164:167]
 v_mfma_f32_16x16x32_bf16 v[172:175], v[28:31], a[44:47], v[172:175]
 ds_write_b128 v8, v[120:123] offset:2048
 v_mfma_f32_16x16x32_bf16 v[168:171], v[28:31], a[40:43], v[168:171]
 v_mfma_f32_16x16x32_bf16 v[176:179], v[24:27], a[48:51], v[176:179]
 v_mfma_f32_16x16x32_bf16 v[180:183], v[24:27], a[52:55], v[180:183]
 ds_write_b128 v8, v[124:127] offset:3072
 v_mfma_f32_16x16x32_bf16 v[188:191], v[28:31], a[52:55], v[188:191]
 v_mfma_f32_16x16x32_bf16 v[184:187], v[28:31], a[48:51], v[184:187]
 v_mfma_f32_16x16x32_bf16 v[192:195], v[24:27], a[56:59], v[192:195]
 ds_write_b128 v9, v[128:131] offset:0
 v_mfma_f32_16x16x32_bf16 v[196:199], v[24:27], a[60:63], v[196:199]
 v_mfma_f32_16x16x32_bf16 v[204:207], v[28:31], a[60:63], v[204:207]
 v_mfma_f32_16x16x32_bf16 v[200:203], v[28:31], a[56:59], v[200:203]
 ds_write_b128 v9, v[132:135] offset:1024
 s_waitcnt vmcnt(16)
 v_mfma_f32_16x16x32_bf16 v[144:147], v[32:35], a[64:67], v[144:147]
 buffer_load_dwordx4 v[24:27], v2, s[48:51], s82 offen offset:2048 sc1
 v_mfma_f32_16x16x32_bf16 v[148:151], v[32:35], a[68:71], v[148:151]
 v_mfma_f32_16x16x32_bf16 v[156:159], v[36:39], a[68:71], v[156:159]
 buffer_load_dwordx4 v[28:31], v2, s[48:51], s82 offen offset:2176 sc1
 v_mfma_f32_16x16x32_bf16 v[152:155], v[36:39], a[64:67], v[152:155]
 v_mfma_f32_16x16x32_bf16 v[160:163], v[32:35], a[72:75], v[160:163]
 ds_write_b128 v9, v[136:139] offset:2048
 v_mfma_f32_16x16x32_bf16 v[164:167], v[32:35], a[76:79], v[164:167]
 v_mfma_f32_16x16x32_bf16 v[172:175], v[36:39], a[76:79], v[172:175]
 v_mfma_f32_16x16x32_bf16 v[168:171], v[36:39], a[72:75], v[168:171]
 ds_write_b128 v9, v[140:143] offset:3072
 v_mfma_f32_16x16x32_bf16 v[176:179], v[32:35], a[80:83], v[176:179]
 v_mfma_f32_16x16x32_bf16 v[180:183], v[32:35], a[84:87], v[180:183]
 v_mfma_f32_16x16x32_bf16 v[188:191], v[36:39], a[84:87], v[188:191]
 s_waitcnt lgkmcnt(0)
 s_barrier
 v_mfma_f32_16x16x32_bf16 v[184:187], v[36:39], a[80:83], v[184:187]
 ds_read_b128 v[96:99], v10 offset:0
 v_mfma_f32_16x16x32_bf16 v[192:195], v[32:35], a[88:91], v[192:195]
 ds_read_b128 v[100:103], v10 offset:1024
 v_mfma_f32_16x16x32_bf16 v[196:199], v[32:35], a[92:95], v[196:199]
 ds_read_b128 v[104:107], v10 offset:2048
 v_mfma_f32_16x16x32_bf16 v[204:207], v[36:39], a[92:95], v[204:207]
 ds_read_b128 v[108:111], v10 offset:3072
 v_mfma_f32_16x16x32_bf16 v[200:203], v[36:39], a[88:91], v[200:203]
 ds_read_b128 v[112:115], v10 offset:4096
 s_waitcnt vmcnt(15)
 v_mfma_f32_16x16x32_bf16 v[144:147], v[40:43], a[96:99], v[144:147]
 s_add_u32 s82, s65, 4096
 buffer_load_dwordx4 v[32:35], v2, s[48:51], s82 offen offset:0 sc1
 v_mfma_f32_16x16x32_bf16 v[148:151], v[40:43], a[100:103], v[148:151]
 ds_read_b128 v[116:119], v10 offset:5120
 v_mfma_f32_16x16x32_bf16 v[156:159], v[44:47], a[100:103], v[156:159]
 buffer_load_dwordx4 v[36:39], v2, s[48:51], s82 offen offset:128 sc1
 v_mfma_f32_16x16x32_bf16 v[152:155], v[44:47], a[96:99], v[152:155]
 ds_read_b128 v[120:123], v10 offset:6144
 v_mfma_f32_16x16x32_bf16 v[160:163], v[40:43], a[104:107], v[160:163]
 ds_read_b128 v[124:127], v10 offset:7168
 v_mfma_f32_16x16x32_bf16 v[164:167], v[40:43], a[108:111], v[164:167]
 s_waitcnt vmcnt(13)
 s_sub_u32 s69, s63, 1
 s_max_u32 s69, s69, 2
 v_mov_b32 v3, s69
 v_mov_b32 v4, 0
 s_mov_b64 exec, 1
 buffer_store_dword v3, v4, s[48:51], s68 offen sc1
 s_mov_b64 exec, -1
 v_mfma_f32_16x16x32_bf16 v[172:175], v[44:47], a[108:111], v[172:175]
 ds_read_b128 v[128:131], v10 offset:8192
 v_mfma_f32_16x16x32_bf16 v[168:171], v[44:47], a[104:107], v[168:171]
 ds_read_b128 v[132:135], v10 offset:9216
 v_mfma_f32_16x16x32_bf16 v[176:179], v[40:43], a[112:115], v[176:179]
 ds_read_b128 v[136:139], v10 offset:10240
 v_mfma_f32_16x16x32_bf16 v[180:183], v[40:43], a[116:119], v[180:183]
 ds_read_b128 v[140:143], v10 offset:11264
 v_mfma_f32_16x16x32_bf16 v[188:191], v[44:47], a[116:119], v[188:191]
 s_waitcnt lgkmcnt(8)
 v_mfma_f32_16x16x32_bf16 v[184:187], v[44:47], a[112:115], v[184:187]
 v_add_f32 v80, v80, v96
 v_add_f32 v81, v81, v97
 v_mfma_f32_16x16x32_bf16 v[192:195], v[40:43], a[120:123], v[192:195]
 v_add_f32 v82, v82, v98
 v_add_f32 v83, v83, v99
 v_mfma_f32_16x16x32_bf16 v[196:199], v[40:43], a[124:127], v[196:199]
 v_add_f32 v84, v84, v100
 v_add_f32 v85, v85, v101
 v_mfma_f32_16x16x32_bf16 v[204:207], v[44:47], a[124:127], v[204:207]
 v_add_f32 v86, v86, v102
 v_add_f32 v87, v87, v103
 v_mfma_f32_16x16x32_bf16 v[200:203], v[44:47], a[120:123], v[200:203]
 v_add_f32 v88, v88, v104
 v_add_f32 v89, v89, v105
 v_mfma_f32_16x16x32_bf16 v[144:147], v[48:51], a[128:131], v[144:147]
 buffer_load_dwordx4 v[40:43], v2, s[48:51], s82 offen offset:2048 sc1
 v_mfma_f32_16x16x32_bf16 v[148:151], v[48:51], a[132:135], v[148:151]
 v_add_f32 v90, v90, v106
 v_add_f32 v91, v91, v107
 v_mfma_f32_16x16x32_bf16 v[156:159], v[52:55], a[132:135], v[156:159]
 buffer_load_dwordx4 v[44:47], v2, s[48:51], s82 offen offset:2176 sc1
 v_mfma_f32_16x16x32_bf16 v[152:155], v[52:55], a[128:131], v[152:155]
 v_add_f32 v92, v92, v108
 v_add_f32 v93, v93, v109
 v_mfma_f32_16x16x32_bf16 v[160:163], v[48:51], a[136:139], v[160:163]
 v_add_f32 v94, v94, v110
 v_add_f32 v95, v95, v111
 v_mfma_f32_16x16x32_bf16 v[164:167], v[48:51], a[140:143], v[164:167]
 s_waitcnt lgkmcnt(4)
 v_mfma_f32_16x16x32_bf16 v[172:175], v[52:55], a[140:143], v[172:175]
 v_add_f32 v80, v80, v112
 v_add_f32 v81, v81, v113
 v_mfma_f32_16x16x32_bf16 v[168:171], v[52:55], a[136:139], v[168:171]
 v_add_f32 v82, v82, v114
 v_add_f32 v83, v83, v115
 v_mfma_f32_16x16x32_bf16 v[176:179], v[48:51], a[144:147], v[176:179]
 v_add_f32 v84, v84, v116
 v_add_f32 v85, v85, v117
 v_mfma_f32_16x16x32_bf16 v[180:183], v[48:51], a[148:151], v[180:183]
 v_add_f32 v86, v86, v118
 v_add_f32 v87, v87, v119
 v_mfma_f32_16x16x32_bf16 v[188:191], v[52:55], a[148:151], v[188:191]
 v_add_f32 v88, v88, v120
 v_add_f32 v89, v89, v121
 v_mfma_f32_16x16x32_bf16 v[184:187], v[52:55], a[144:147], v[184:187]
 v_add_f32 v90, v90, v122
 v_add_f32 v91, v91, v123
 v_mfma_f32_16x16x32_bf16 v[192:195], v[48:51], a[152:155], v[192:195]
 v_add_f32 v92, v92, v124
 v_add_f32 v93, v93, v125
 v_mfma_f32_16x16x32_bf16 v[196:199], v[48:51], a[156:159], v[196:199]
 v_add_f32 v94, v94, v126
 v_add_f32 v95, v95, v127
 v_mfma_f32_16x16x32_bf16 v[204:207], v[52:55], a[156:159], v[204:207]
 s_waitcnt lgkmcnt(0)
 v_mfma_f32_16x16x32_bf16 v[200:203], v[52:55], a[152:155], v[200:203]
 v_add_f32 v80, v80, v128
 v_add_f32 v81, v81, v129
 s_waitcnt vmcnt(14)
 v_mfma_f32_16x16x32_bf16 v[144:147], v[56:59], a[160:163], v[144:147]
 s_add_u32 s82, s65, 8192
 buffer_load_dwordx4 v[48:51], v2, s[48:51], s82 offen offset:0 sc1
 v_mfma_f32_16x16x32_bf16 v[148:151], v[56:59], a[164:167], v[148:151]
 v_add_f32 v82, v82, v130
 v_add_f32 v83, v83, v131
 v_mfma_f32_16x16x32_bf16 v[156:159], v[60:63], a[164:167], v[156:159]
 buffer_load_dwordx4 v[52:55], v2, s[48:51], s82 offen offset:128 sc1
 v_mfma_f32_16x16x32_bf16 v[152:155], v[60:63], a[160:163], v[152:155]
 v_add_f32 v84, v84, v132
 v_add_f32 v85, v85, v133
 v_mfma_f32_16x16x32_bf16 v[160:163], v[56:59], a[168:171], v[160:163]
 v_add_f32 v86, v86, v134
 v_add_f32 v87, v87, v135
 v_mfma_f32_16x16x32_bf16 v[164:167], v[56:59], a[172:175], v[164:167]
 v_add_f32 v88, v88, v136
 v_add_f32 v89, v89, v137
 v_mfma_f32_16x16x32_bf16 v[172:175], v[60:63], a[172:175], v[172:175]
 v_add_f32 v90, v90, v138
 v_add_f32 v91, v91, v139
 v_mfma_f32_16x16x32_bf16 v[168:171], v[60:63], a[168:171], v[168:171]
 v_add_f32 v92, v92, v140
 v_add_f32 v93, v93, v141
 v_mfma_f32_16x16x32_bf16 v[176:179], v[56:59], a[176:179], v[176:179]
 v_add_f32 v94, v94, v142
 v_add_f32 v95, v95, v143
 v_mfma_f32_16x16x32_bf16 v[180:183], v[56:59], a[180:183], v[180:183]
 v_cvt_pk_bf16_f32 v224, v80, v81
 v_cvt_pk_bf16_f32 v225, v82, v83
 v_mfma_f32_16x16x32_bf16 v[188:191], v[60:63], a[180:183], v[188:191]
 v_cvt_pk_bf16_f32 v226, v88, v89
 v_cvt_pk_bf16_f32 v227, v90, v91
 v_mfma_f32_16x16x32_bf16 v[184:187], v[60:63], a[176:179], v[184:187]
 buffer_store_dwordx4 v[224:227], v6, s[48:51], s67 offen offset:0 sc1
 v_mfma_f32_16x16x32_bf16 v[192:195], v[56:59], a[184:187], v[192:195]
 v_cvt_pk_bf16_f32 v228, v84, v85
 v_cvt_pk_bf16_f32 v229, v86, v87
 v_mfma_f32_16x16x32_bf16 v[196:199], v[56:59], a[188:191], v[196:199]
 v_cvt_pk_bf16_f32 v230, v92, v93
 v_cvt_pk_bf16_f32 v231, v94, v95
 v_mfma_f32_16x16x32_bf16 v[204:207], v[60:63], a[188:191], v[204:207]
 buffer_store_dwordx4 v[228:231], v6, s[48:51], s67 offen offset:256 sc1
 v_mfma_f32_16x16x32_bf16 v[200:203], v[60:63], a[184:187], v[200:203]
 s_waitcnt vmcnt(16)
 v_mfma_f32_16x16x32_bf16 v[144:147], v[64:67], a[192:195], v[144:147]
 buffer_load_dwordx4 v[56:59], v2, s[48:51], s82 offen offset:2048 sc1
 v_mfma_f32_16x16x32_bf16 v[148:151], v[64:67], a[196:199], v[148:151]
 v_mfma_f32_16x16x32_bf16 v[156:159], v[68:71], a[196:199], v[156:159]
 buffer_load_dwordx4 v[60:63], v2, s[48:51], s82 offen offset:2176 sc1
 v_mfma_f32_16x16x32_bf16 v[152:155], v[68:71], a[192:195], v[152:155]
 v_mfma_f32_16x16x32_bf16 v[160:163], v[64:67], a[200:203], v[160:163]
 v_mfma_f32_16x16x32_bf16 v[164:167], v[64:67], a[204:207], v[164:167]
 v_mfma_f32_16x16x32_bf16 v[172:175], v[68:71], a[204:207], v[172:175]
 v_mfma_f32_16x16x32_bf16 v[168:171], v[68:71], a[200:203], v[168:171]
 v_mfma_f32_16x16x32_bf16 v[176:179], v[64:67], a[208:211], v[176:179]
 v_mfma_f32_16x16x32_bf16 v[180:183], v[64:67], a[212:215], v[180:183]
 v_mfma_f32_16x16x32_bf16 v[188:191], v[68:71], a[212:215], v[188:191]
 v_mfma_f32_16x16x32_bf16 v[184:187], v[68:71], a[208:211], v[184:187]
 v_mfma_f32_16x16x32_bf16 v[192:195], v[64:67], a[216:219], v[192:195]
 v_mfma_f32_16x16x32_bf16 v[196:199], v[64:67], a[220:223], v[196:199]
 v_mfma_f32_16x16x32_bf16 v[204:207], v[68:71], a[220:223], v[204:207]
 v_mfma_f32_16x16x32_bf16 v[200:203], v[68:71], a[216:219], v[200:203]
 s_waitcnt vmcnt(15)
 v_mfma_f32_16x16x32_bf16 v[144:147], v[72:75], a[224:227], v[144:147]
 s_add_u32 s82, s65, 12288
 buffer_load_dwordx4 v[64:67], v2, s[48:51], s82 offen offset:0 sc1
 v_mfma_f32_16x16x32_bf16 v[148:151], v[72:75], a[228:231], v[148:151]
 v_mfma_f32_16x16x32_bf16 v[156:159], v[76:79], a[228:231], v[156:159]
 buffer_load_dwordx4 v[68:71], v2, s[48:51], s82 offen offset:128 sc1
 v_mfma_f32_16x16x32_bf16 v[152:155], v[76:79], a[224:227], v[152:155]
 v_mfma_f32_16x16x32_bf16 v[160:163], v[72:75], a[232:235], v[160:163]
 v_mfma_f32_16x16x32_bf16 v[164:167], v[72:75], a[236:239], v[164:167]
 s_add_u32 s70, s65, 131072
 buffer_load_dwordx4 v[12:15], v11, s[48:51], s70 offen offset:0 sc1
 v_mfma_f32_16x16x32_bf16 v[172:175], v[76:79], a[236:239], v[172:175]
 v_mfma_f32_16x16x32_bf16 v[168:171], v[76:79], a[232:235], v[168:171]
 v_mfma_f32_16x16x32_bf16 v[176:179], v[72:75], a[240:243], v[176:179]
 v_mfma_f32_16x16x32_bf16 v[180:183], v[72:75], a[244:247], v[180:183]
 v_mfma_f32_16x16x32_bf16 v[188:191], v[76:79], a[244:247], v[188:191]
 v_mfma_f32_16x16x32_bf16 v[184:187], v[76:79], a[240:243], v[184:187]
 v_mfma_f32_16x16x32_bf16 v[192:195], v[72:75], a[248:251], v[192:195]
 v_mfma_f32_16x16x32_bf16 v[196:199], v[72:75], a[252:255], v[196:199]
 v_mfma_f32_16x16x32_bf16 v[204:207], v[76:79], a[252:255], v[204:207]
 v_mfma_f32_16x16x32_bf16 v[200:203], v[76:79], a[248:251], v[200:203]
 buffer_load_dwordx4 v[72:75], v2, s[48:51], s82 offen offset:2048 sc1
 buffer_load_dwordx4 v[76:79], v2, s[48:51], s82 offen offset:2176 sc1
 s_add_u32 s63, s63, 1
 s_add_u32 s65, s65, 0x10000
 s_add_u32 s67, s67, 0x40000
 s_cmp_eq_u32 s63, 64
 s_cbranch_scc1 Lw_Vend
 s_waitcnt vmcnt(18)
 v_mfma_f32_16x16x32_bf16 v[80:83], v[16:19], a[0:3], 0
 v_mfma_f32_16x16x32_bf16 v[84:87], v[16:19], a[4:7], 0
 v_mfma_f32_16x16x32_bf16 v[92:95], v[20:23], a[4:7], 0
 ds_write_b128 v7, v[160:163] offset:49152
 v_mfma_f32_16x16x32_bf16 v[88:91], v[20:23], a[0:3], 0
 v_mfma_f32_16x16x32_bf16 v[96:99], v[16:19], a[8:11], 0
 v_mfma_f32_16x16x32_bf16 v[100:103], v[16:19], a[12:15], 0
 ds_write_b128 v7, v[164:167] offset:50176
 v_mfma_f32_16x16x32_bf16 v[108:111], v[20:23], a[12:15], 0
 v_mfma_f32_16x16x32_bf16 v[104:107], v[20:23], a[8:11], 0
 v_mfma_f32_16x16x32_bf16 v[112:115], v[16:19], a[16:19], 0
 ds_write_b128 v7, v[168:171] offset:51200
 v_mfma_f32_16x16x32_bf16 v[116:119], v[16:19], a[20:23], 0
 v_mfma_f32_16x16x32_bf16 v[124:127], v[20:23], a[20:23], 0
 v_mfma_f32_16x16x32_bf16 v[120:123], v[20:23], a[16:19], 0
 ds_write_b128 v7, v[172:175] offset:52224
 v_mfma_f32_16x16x32_bf16 v[128:131], v[16:19], a[24:27], 0
 v_mfma_f32_16x16x32_bf16 v[132:135], v[16:19], a[28:31], 0
 v_mfma_f32_16x16x32_bf16 v[140:143], v[20:23], a[28:31], 0
 ds_write_b128 v8, v[176:179] offset:49152
 v_mfma_f32_16x16x32_bf16 v[136:139], v[20:23], a[24:27], 0
 s_waitcnt vmcnt(16)
 v_mfma_f32_16x16x32_bf16 v[80:83], v[24:27], a[32:35], v[80:83]
 s_add_u32 s82, s65, 0
 buffer_load_dwordx4 v[16:19], v2, s[48:51], s82 offen offset:0 sc1
 v_mfma_f32_16x16x32_bf16 v[84:87], v[24:27], a[36:39], v[84:87]
 v_mfma_f32_16x16x32_bf16 v[92:95], v[28:31], a[36:39], v[92:95]
 buffer_load_dwordx4 v[20:23], v2, s[48:51], s82 offen offset:128 sc1
 v_mfma_f32_16x16x32_bf16 v[88:91], v[28:31], a[32:35], v[88:91]
 ds_write_b128 v8, v[180:183] offset:50176
 v_mfma_f32_16x16x32_bf16 v[96:99], v[24:27], a[40:43], v[96:99]
 v_mfma_f32_16x16x32_bf16 v[100:103], v[24:27], a[44:47], v[100:103]
 v_mfma_f32_16x16x32_bf16 v[108:111], v[28:31], a[44:47], v[108:111]
 ds_write_b128 v8, v[184:187] offset:51200
 v_mfma_f32_16x16x32_bf16 v[104:107], v[28:31], a[40:43], v[104:107]
 v_mfma_f32_16x16x32_bf16 v[112:115], v[24:27], a[48:51], v[112:115]
 v_mfma_f32_16x16x32_bf16 v[116:119], v[24:27], a[52:55], v[116:119]
 ds_write_b128 v8, v[188:191] offset:52224
 v_mfma_f32_16x16x32_bf16 v[124:127], v[28:31], a[52:55], v[124:127]
 v_mfma_f32_16x16x32_bf16 v[120:123], v[28:31], a[48:51], v[120:123]
 v_mfma_f32_16x16x32_bf16 v[128:131], v[24:27], a[56:59], v[128:131]
 ds_write_b128 v9, v[192:195] offset:49152
 v_mfma_f32_16x16x32_bf16 v[132:135], v[24:27], a[60:63], v[132:135]
 v_mfma_f32_16x16x32_bf16 v[140:143], v[28:31], a[60:63], v[140:143]
 v_mfma_f32_16x16x32_bf16 v[136:139], v[28:31], a[56:59], v[136:139]
 ds_write_b128 v9, v[196:199] offset:50176
 s_waitcnt vmcnt(16)
 v_mfma_f32_16x16x32_bf16 v[80:83], v[32:35], a[64:67], v[80:83]
 buffer_load_dwordx4 v[24:27], v2, s[48:51], s82 offen offset:2048 sc1
 v_mfma_f32_16x16x32_bf16 v[84:87], v[32:35], a[68:71], v[84:87]
 v_mfma_f32_16x16x32_bf16 v[92:95], v[36:39], a[68:71], v[92:95]
 buffer_load_dwordx4 v[28:31], v2, s[48:51], s82 offen offset:2176 sc1
 v_mfma_f32_16x16x32_bf16 v[88:91], v[36:39], a[64:67], v[88:91]
 v_mfma_f32_16x16x32_bf16 v[96:99], v[32:35], a[72:75], v[96:99]
 ds_write_b128 v9, v[200:203] offset:51200
 v_mfma_f32_16x16x32_bf16 v[100:103], v[32:35], a[76:79], v[100:103]
 v_mfma_f32_16x16x32_bf16 v[108:111], v[36:39], a[76:79], v[108:111]
 v_mfma_f32_16x16x32_bf16 v[104:107], v[36:39], a[72:75], v[104:107]
 ds_write_b128 v9, v[204:207] offset:52224
 v_mfma_f32_16x16x32_bf16 v[112:115], v[32:35], a[80:83], v[112:115]
 v_mfma_f32_16x16x32_bf16 v[116:119], v[32:35], a[84:87], v[116:119]
 v_mfma_f32_16x16x32_bf16 v[124:127], v[36:39], a[84:87], v[124:127]
 s_waitcnt lgkmcnt(0)
 s_barrier
 v_mfma_f32_16x16x32_bf16 v[120:123], v[36:39], a[80:83], v[120:123]
 ds_read_b128 v[160:163], v10 offset:49152
 v_mfma_f32_16x16x32_bf16 v[128:131], v[32:35], a[88:91], v[128:131]
 ds_read_b128 v[164:167], v10 offset:50176
 v_mfma_f32_16x16x32_bf16 v[132:135], v[32:35], a[92:95], v[132:135]
 ds_read_b128 v[168:171], v10 offset:51200
 v_mfma_f32_16x16x32_bf16 v[140:143], v[36:39], a[92:95], v[140:143]
 ds_read_b128 v[172:175], v10 offset:52224
 v_mfma_f32_16x16x32_bf16 v[136:139], v[36:39], a[88:91], v[136:139]
 ds_read_b128 v[176:179], v10 offset:53248
 s_waitcnt vmcnt(15)
 v_mfma_f32_16x16x32_bf16 v[80:83], v[40:43], a[96:99], v[80:83]
 s_add_u32 s82, s65, 4096
 buffer_load_dwordx4 v[32:35], v2, s[48:51], s82 offen offset:0 sc1
 v_mfma_f32_16x16x32_bf16 v[84:87], v[40:43], a[100:103], v[84:87]
 ds_read_b128 v[180:183], v10 offset:54272
 v_mfma_f32_16x16x32_bf16 v[92:95], v[44:47], a[100:103], v[92:95]
 buffer_load_dwordx4 v[36:39], v2, s[48:51], s82 offen offset:128 sc1
 v_mfma_f32_16x16x32_bf16 v[88:91], v[44:47], a[96:99], v[88:91]
 ds_read_b128 v[184:187], v10 offset:55296
 v_mfma_f32_16x16x32_bf16 v[96:99], v[40:43], a[104:107], v[96:99]
 ds_read_b128 v[188:191], v10 offset:56320
 v_mfma_f32_16x16x32_bf16 v[100:103], v[40:43], a[108:111], v[100:103]
 s_waitcnt vmcnt(13)
 s_sub_u32 s69, s63, 1
 s_max_u32 s69, s69, 2
 v_mov_b32 v3, s69
 v_mov_b32 v4, 0
 s_mov_b64 exec, 1
 buffer_store_dword v3, v4, s[48:51], s68 offen sc1
 s_mov_b64 exec, -1
 v_mfma_f32_16x16x32_bf16 v[108:111], v[44:47], a[108:111], v[108:111]
 ds_read_b128 v[192:195], v10 offset:57344
 v_mfma_f32_16x16x32_bf16 v[104:107], v[44:47], a[104:107], v[104:107]
 ds_read_b128 v[196:199], v10 offset:58368
 v_mfma_f32_16x16x32_bf16 v[112:115], v[40:43], a[112:115], v[112:115]
 ds_read_b128 v[200:203], v10 offset:59392
 v_mfma_f32_16x16x32_bf16 v[116:119], v[40:43], a[116:119], v[116:119]
 ds_read_b128 v[204:207], v10 offset:60416
 v_mfma_f32_16x16x32_bf16 v[124:127], v[44:47], a[116:119], v[124:127]
 s_waitcnt lgkmcnt(8)
 v_mfma_f32_16x16x32_bf16 v[120:123], v[44:47], a[112:115], v[120:123]
 v_add_f32 v144, v144, v160
 v_add_f32 v145, v145, v161
 v_mfma_f32_16x16x32_bf16 v[128:131], v[40:43], a[120:123], v[128:131]
 v_add_f32 v146, v146, v162
 v_add_f32 v147, v147, v163
 v_mfma_f32_16x16x32_bf16 v[132:135], v[40:43], a[124:127], v[132:135]
 v_add_f32 v148, v148, v164
 v_add_f32 v149, v149, v165
 v_mfma_f32_16x16x32_bf16 v[140:143], v[44:47], a[124:127], v[140:143]
 v_add_f32 v150, v150, v166
 v_add_f32 v151, v151, v167
 v_mfma_f32_16x16x32_bf16 v[136:139], v[44:47], a[120:123], v[136:139]
 v_add_f32 v152, v152, v168
 v_add_f32 v153, v153, v169
 v_mfma_f32_16x16x32_bf16 v[80:83], v[48:51], a[128:131], v[80:83]
 buffer_load_dwordx4 v[40:43], v2, s[48:51], s82 offen offset:2048 sc1
 v_mfma_f32_16x16x32_bf16 v[84:87], v[48:51], a[132:135], v[84:87]
 v_add_f32 v154, v154, v170
 v_add_f32 v155, v155, v171
 v_mfma_f32_16x16x32_bf16 v[92:95], v[52:55], a[132:135], v[92:95]
 buffer_load_dwordx4 v[44:47], v2, s[48:51], s82 offen offset:2176 sc1
 v_mfma_f32_16x16x32_bf16 v[88:91], v[52:55], a[128:131], v[88:91]
 v_add_f32 v156, v156, v172
 v_add_f32 v157, v157, v173
 v_mfma_f32_16x16x32_bf16 v[96:99], v[48:51], a[136:139], v[96:99]
 v_add_f32 v158, v158, v174
 v_add_f32 v159, v159, v175
 v_mfma_f32_16x16x32_bf16 v[100:103], v[48:51], a[140:143], v[100:103]
 s_waitcnt lgkmcnt(4)
 v_mfma_f32_16x16x32_bf16 v[108:111], v[52:55], a[140:143], v[108:111]
 v_add_f32 v144, v144, v176
 v_add_f32 v145, v145, v177
 v_mfma_f32_16x16x32_bf16 v[104:107], v[52:55], a[136:139], v[104:107]
 v_add_f32 v146, v146, v178
 v_add_f32 v147, v147, v179
 v_mfma_f32_16x16x32_bf16 v[112:115], v[48:51], a[144:147], v[112:115]
 v_add_f32 v148, v148, v180
 v_add_f32 v149, v149, v181
 v_mfma_f32_16x16x32_bf16 v[116:119], v[48:51], a[148:151], v[116:119]
 v_add_f32 v150, v150, v182
 v_add_f32 v151, v151, v183
 v_mfma_f32_16x16x32_bf16 v[124:127], v[52:55], a[148:151], v[124:127]
 v_add_f32 v152, v152, v184
 v_add_f32 v153, v153, v185
 v_mfma_f32_16x16x32_bf16 v[120:123], v[52:55], a[144:147], v[120:123]
 v_add_f32 v154, v154, v186
 v_add_f32 v155, v155, v187
 v_mfma_f32_16x16x32_bf16 v[128:131], v[48:51], a[152:155], v[128:131]
 v_add_f32 v156, v156, v188
 v_add_f32 v157, v157, v189
 v_mfma_f32_16x16x32_bf16 v[132:135], v[48:51], a[156:159], v[132:135]
 v_add_f32 v158, v158, v190
 v_add_f32 v159, v159, v191
 v_mfma_f32_16x16x32_bf16 v[140:143], v[52:55], a[156:159], v[140:143]
 s_waitcnt lgkmcnt(0)
 v_mfma_f32_16x16x32_bf16 v[136:139], v[52:55], a[152:155], v[136:139]
 v_add_f32 v144, v144, v192
 v_add_f32 v145, v145, v193
 s_waitcnt vmcnt(14)
 v_mfma_f32_16x16x32_bf16 v[80:83], v[56:59], a[160:163], v[80:83]
 s_add_u32 s82, s65, 8192
 buffer_load_dwordx4 v[48:51], v2, s[48:51], s82 offen offset:0 sc1
 v_mfma_f32_16x16x32_bf16 v[84:87], v[56:59], a[164:167], v[84:87]
 v_add_f32 v146, v146, v194
 v_add_f32 v147, v147, v195
 v_mfma_f32_16x16x32_bf16 v[92:95], v[60:63], a[164:167], v[92:95]
 buffer_load_dwordx4 v[52:55], v2, s[48:51], s82 offen offset:128 sc1
 v_mfma_f32_16x16x32_bf16 v[88:91], v[60:63], a[160:163], v[88:91]
 v_add_f32 v148, v148, v196
 v_add_f32 v149, v149, v197
 v_mfma_f32_16x16x32_bf16 v[96:99], v[56:59], a[168:171], v[96:99]
 v_add_f32 v150, v150, v198
 v_add_f32 v151, v151, v199
 v_mfma_f32_16x16x32_bf16 v[100:103], v[56:59], a[172:175], v[100:103]
 v_add_f32 v152, v152, v200
 v_add_f32 v153, v153, v201
 v_mfma_f32_16x16x32_bf16 v[108:111], v[60:63], a[172:175], v[108:111]
 v_add_f32 v154, v154, v202
 v_add_f32 v155, v155, v203
 v_mfma_f32_16x16x32_bf16 v[104:107], v[60:63], a[168:171], v[104:107]
 v_add_f32 v156, v156, v204
 v_add_f32 v157, v157, v205
 v_mfma_f32_16x16x32_bf16 v[112:115], v[56:59], a[176:179], v[112:115]
 v_add_f32 v158, v158, v206
 v_add_f32 v159, v159, v207
 v_mfma_f32_16x16x32_bf16 v[116:119], v[56:59], a[180:183], v[116:119]
 v_cvt_pk_bf16_f32 v224, v144, v145
 v_cvt_pk_bf16_f32 v225, v146, v147
 v_mfma_f32_16x16x32_bf16 v[124:127], v[60:63], a[180:183], v[124:127]
 v_cvt_pk_bf16_f32 v226, v152, v153
 v_cvt_pk_bf16_f32 v227, v154, v155
 v_mfma_f32_16x16x32_bf16 v[120:123], v[60:63], a[176:179], v[120:123]
 buffer_store_dwordx4 v[224:227], v6, s[48:51], s67 offen offset:0 sc1
 v_mfma_f32_16x16x32_bf16 v[128:131], v[56:59], a[184:187], v[128:131]
 v_cvt_pk_bf16_f32 v228, v148, v149
 v_cvt_pk_bf16_f32 v229, v150, v151
 v_mfma_f32_16x16x32_bf16 v[132:135], v[56:59], a[188:191], v[132:135]
 v_cvt_pk_bf16_f32 v230, v156, v157
 v_cvt_pk_bf16_f32 v231, v158, v159
 v_mfma_f32_16x16x32_bf16 v[140:143], v[60:63], a[188:191], v[140:143]
 buffer_store_dwordx4 v[228:231], v6, s[48:51], s67 offen offset:256 sc1
 v_mfma_f32_16x16x32_bf16 v[136:139], v[60:63], a[184:187], v[136:139]
 s_waitcnt vmcnt(16)
 v_mfma_f32_16x16x32_bf16 v[80:83], v[64:67], a[192:195], v[80:83]
 buffer_load_dwordx4 v[56:59], v2, s[48:51], s82 offen offset:2048 sc1
 v_mfma_f32_16x16x32_bf16 v[84:87], v[64:67], a[196:199], v[84:87]
 v_mfma_f32_16x16x32_bf16 v[92:95], v[68:71], a[196:199], v[92:95]
 buffer_load_dwordx4 v[60:63], v2, s[48:51], s82 offen offset:2176 sc1
 v_mfma_f32_16x16x32_bf16 v[88:91], v[68:71], a[192:195], v[88:91]
 v_mfma_f32_16x16x32_bf16 v[96:99], v[64:67], a[200:203], v[96:99]
 v_mfma_f32_16x16x32_bf16 v[100:103], v[64:67], a[204:207], v[100:103]
 v_mfma_f32_16x16x32_bf16 v[108:111], v[68:71], a[204:207], v[108:111]
 v_mfma_f32_16x16x32_bf16 v[104:107], v[68:71], a[200:203], v[104:107]
 v_mfma_f32_16x16x32_bf16 v[112:115], v[64:67], a[208:211], v[112:115]
 v_mfma_f32_16x16x32_bf16 v[116:119], v[64:67], a[212:215], v[116:119]
 v_mfma_f32_16x16x32_bf16 v[124:127], v[68:71], a[212:215], v[124:127]
 v_mfma_f32_16x16x32_bf16 v[120:123], v[68:71], a[208:211], v[120:123]
 v_mfma_f32_16x16x32_bf16 v[128:131], v[64:67], a[216:219], v[128:131]
 v_mfma_f32_16x16x32_bf16 v[132:135], v[64:67], a[220:223], v[132:135]
 v_mfma_f32_16x16x32_bf16 v[140:143], v[68:71], a[220:223], v[140:143]
 v_mfma_f32_16x16x32_bf16 v[136:139], v[68:71], a[216:219], v[136:139]
 s_waitcnt vmcnt(15)
 v_mfma_f32_16x16x32_bf16 v[80:83], v[72:75], a[224:227], v[80:83]
 s_add_u32 s82, s65, 12288
 buffer_load_dwordx4 v[64:67], v2, s[48:51], s82 offen offset:0 sc1
 v_mfma_f32_16x16x32_bf16 v[84:87], v[72:75], a[228:231], v[84:87]
 v_mfma_f32_16x16x32_bf16 v[92:95], v[76:79], a[228:231], v[92:95]
 buffer_load_dwordx4 v[68:71], v2, s[48:51], s82 offen offset:128 sc1
 v_mfma_f32_16x16x32_bf16 v[88:91], v[76:79], a[224:227], v[88:91]
 v_mfma_f32_16x16x32_bf16 v[96:99], v[72:75], a[232:235], v[96:99]
 v_mfma_f32_16x16x32_bf16 v[100:103], v[72:75], a[236:239], v[100:103]
 s_add_u32 s70, s65, 131072
 buffer_load_dwordx4 v[12:15], v11, s[48:51], s70 offen offset:0 sc1
 v_mfma_f32_16x16x32_bf16 v[108:111], v[76:79], a[236:239], v[108:111]
 v_mfma_f32_16x16x32_bf16 v[104:107], v[76:79], a[232:235], v[104:107]
 v_mfma_f32_16x16x32_bf16 v[112:115], v[72:75], a[240:243], v[112:115]
 v_mfma_f32_16x16x32_bf16 v[116:119], v[72:75], a[244:247], v[116:119]
 v_mfma_f32_16x16x32_bf16 v[124:127], v[76:79], a[244:247], v[124:127]
 v_mfma_f32_16x16x32_bf16 v[120:123], v[76:79], a[240:243], v[120:123]
 v_mfma_f32_16x16x32_bf16 v[128:131], v[72:75], a[248:251], v[128:131]
 v_mfma_f32_16x16x32_bf16 v[132:135], v[72:75], a[252:255], v[132:135]
 v_mfma_f32_16x16x32_bf16 v[140:143], v[76:79], a[252:255], v[140:143]
 v_mfma_f32_16x16x32_bf16 v[136:139], v[76:79], a[248:251], v[136:139]
 buffer_load_dwordx4 v[72:75], v2, s[48:51], s82 offen offset:2048 sc1
 buffer_load_dwordx4 v[76:79], v2, s[48:51], s82 offen offset:2176 sc1
 s_add_u32 s63, s63, 1
 s_add_u32 s65, s65, 0x10000
 s_add_u32 s67, s67, 0x40000
 s_branch Lw_Vloop
Lw_Vend:
 ds_write_b128 v7, v[160:163] offset:49152
 ds_write_b128 v7, v[164:167] offset:50176
 ds_write_b128 v7, v[168:171] offset:51200
 ds_write_b128 v7, v[172:175] offset:52224
 ds_write_b128 v8, v[176:179] offset:49152
 ds_write_b128 v8, v[180:183] offset:50176
 ds_write_b128 v8, v[184:187] offset:51200
 ds_write_b128 v8, v[188:191] offset:52224
 ds_write_b128 v9, v[192:195] offset:49152
 ds_write_b128 v9, v[196:199] offset:50176
 ds_write_b128 v9, v[200:203] offset:51200
 ds_write_b128 v9, v[204:207] offset:52224
 s_waitcnt lgkmcnt(0)
 s_barrier
 ds_read_b128 v[160:163], v10 offset:49152
 ds_read_b128 v[164:167], v10 offset:50176
 ds_read_b128 v[168:171], v10 offset:51200
 ds_read_b128 v[172:175], v10 offset:52224
 ds_read_b128 v[176:179], v10 offset:53248
 ds_read_b128 v[180:183], v10 offset:54272
 ds_read_b128 v[184:187], v10 offset:55296
 ds_read_b128 v[188:191], v10 offset:56320
 ds_read_b128 v[192:195], v10 offset:57344
 ds_read_b128 v[196:199], v10 offset:58368
 ds_read_b128 v[200:203], v10 offset:59392
 ds_read_b128 v[204:207], v10 offset:60416
 s_waitcnt lgkmcnt(8)
 v_add_f32 v144, v144, v160
 v_add_f32 v145, v145, v161
 v_add_f32 v146, v146, v162
 v_add_f32 v147, v147, v163
 v_add_f32 v148, v148, v164
 v_add_f32 v149, v149, v165
 v_add_f32 v150, v150, v166
 v_add_f32 v151, v151, v167
 v_add_f32 v152, v152, v168
 v_add_f32 v153, v153, v169
 v_add_f32 v154, v154, v170
 v_add_f32 v155, v155, v171
 v_add_f32 v156, v156, v172
 v_add_f32 v157, v157, v173
 v_add_f32 v158, v158, v174
 v_add_f32 v159, v159, v175
 s_waitcnt lgkmcnt(4)
 v_add_f32 v144, v144, v176
 v_add_f32 v145, v145, v177
 v_add_f32 v146, v146, v178
 v_add_f32 v147, v147, v179
 v_add_f32 v148, v148, v180
 v_add_f32 v149, v149, v181
 v_add_f32 v150, v150, v182
 v_add_f32 v151, v151, v183
 v_add_f32 v152, v152, v184
 v_add_f32 v153, v153, v185
 v_add_f32 v154, v154, v186
 v_add_f32 v155, v155, v187
 v_add_f32 v156, v156, v188
 v_add_f32 v157, v157, v189
 v_add_f32 v158, v158, v190
 v_add_f32 v159, v159, v191
 s_waitcnt lgkmcnt(0)
 v_add_f32 v144, v144, v192
 v_add_f32 v145, v145, v193
 v_add_f32 v146, v146, v194
 v_add_f32 v147, v147, v195
 v_add_f32 v148, v148, v196
 v_add_f32 v149, v149, v197
 v_add_f32 v150, v150, v198
 v_add_f32 v151, v151, v199
 v_add_f32 v152, v152, v200
 v_add_f32 v153, v153, v201
 v_add_f32 v154, v154, v202
 v_add_f32 v155, v155, v203
 v_add_f32 v156, v156, v204
 v_add_f32 v157, v157, v205
 v_add_f32 v158, v158, v206
 v_add_f32 v159, v159, v207
 v_cvt_pk_bf16_f32 v224, v144, v145
 v_cvt_pk_bf16_f32 v225, v146, v147
 v_cvt_pk_bf16_f32 v226, v152, v153
 v_cvt_pk_bf16_f32 v227, v154, v155
 buffer_store_dwordx4 v[224:227], v6, s[48:51], s67 offen offset:0 sc1
 v_cvt_pk_bf16_f32 v228, v148, v149
 v_cvt_pk_bf16_f32 v229, v150, v151
 v_cvt_pk_bf16_f32 v230, v156, v157
 v_cvt_pk_bf16_f32 v231, v158, v159
 buffer_store_dwordx4 v[228:231], v6, s[48:51], s67 offen offset:256 sc1
 s_waitcnt vmcnt(0)
 v_mov_b32 v3, 64
 v_mov_b32 v4, 0
 s_mov_b64 exec, 1
 buffer_store_dword v3, v4, s[48:51], s68 offen sc1
 s_mov_b64 exec, -1
 s_waitcnt vmcnt(0) lgkmcnt(0)
 s_branch L_ssm
L_ssm:
 s_barrier
 s_lshl_b32 s60, s47, 4
 s_add_u32 s60, s60, s6
 s_lshl_b32 s60, s60, 2
 s_add_u32 s60, s60, s4
 s_lshl_b32 s61, s60, 3
 s_load_dwordx2 s[64:65], s[36:37], s61
 s_load_dwordx2 s[66:67], s[38:39], s61
 s_lshl_b32 s62, s60, 10
 v_lshl_add_u32 v2, v0, 2, s62
 global_load_dword v16, v2, s[24:25] offset:0
 global_load_dword v17, v2, s[26:27] offset:0
 global_load_dword v18, v2, s[28:29] offset:0
 global_load_dword v19, v2, s[30:31] offset:0
 global_load_dword v20, v2, s[32:33] offset:0
 global_load_dword v21, v2, s[34:35] offset:0
 global_load_dword v22, v2, s[24:25] offset:256
 global_load_dword v23, v2, s[26:27] offset:256
 global_load_dword v24, v2, s[28:29] offset:256
 global_load_dword v25, v2, s[30:31] offset:256
 global_load_dword v26, v2, s[32:33] offset:256
 global_load_dword v27, v2, s[34:35] offset:256
 global_load_dword v28, v2, s[24:25] offset:512
 global_load_dword v29, v2, s[26:27] offset:512
 global_load_dword v30, v2, s[28:29] offset:512
 global_load_dword v31, v2, s[30:31] offset:512
 global_load_dword v32, v2, s[32:33] offset:512
 global_load_dword v33, v2, s[34:35] offset:512
 global_load_dword v34, v2, s[24:25] offset:768
 global_load_dword v35, v2, s[26:27] offset:768
 global_load_dword v36, v2, s[28:29] offset:768
 global_load_dword v37, v2, s[30:31] offset:768
 global_load_dword v38, v2, s[32:33] offset:768
 global_load_dword v39, v2, s[34:35] offset:768
 s_mov_b32 s52, s22
 s_and_b32 s53, s23, 0xffff
 s_mov_b32 s54, 4194304
 s_mov_b32 s55, 0x20000
 s_mov_b32 s56, s40
 s_and_b32 s57, s41, 0xffff
 s_mov_b32 s58, 8388608
 s_mov_b32 s59, 0x20000
 v_and_b32 v4, 31, v0
 v_lshrrev_b32 v5, 5, v0
 v_lshrrev_b32 v3, 1, v0
 v_and_b32 v15, 1, v0
 v_lshlrev_b32 v15, 4, v15
 v_lshl_add_u32 v3, v3, 11, v15
 s_lshr_b32 s61, s60, 2
 s_lshl_b32 s61, s61, 5
 s_lshl_b32 s62, s4, 20
 s_add_u32 s61, s61, s62
 s_mul_i32 s63, s4, 16640
 s_and_b32 s68, s6, 3
 s_lshl_b32 s68, s68, 2
 s_add_u32 s69, s68, 0
 s_and_b32 s69, s69, 15
 s_mul_i32 s62, s69, 1040
 s_add_u32 m0, s62, s63
 s_lshl_b32 s62, s69, 16
 s_add_u32 s62, s62, s61
 buffer_load_dwordx4 v3, s[52:55], s62 offen lds
 s_add_u32 s69, s68, 1
 s_and_b32 s69, s69, 15
 s_mul_i32 s62, s69, 1040
 s_add_u32 m0, s62, s63
 s_lshl_b32 s62, s69, 16
 s_add_u32 s62, s62, s61
 buffer_load_dwordx4 v3, s[52:55], s62 offen lds
 s_add_u32 s69, s68, 2
 s_and_b32 s69, s69, 15
 s_mul_i32 s62, s69, 1040
 s_add_u32 m0, s62, s63
 s_lshl_b32 s62, s69, 16
 s_add_u32 s62, s62, s61
 buffer_load_dwordx4 v3, s[52:55], s62 offen lds
 s_add_u32 s69, s68, 3
 s_and_b32 s69, s69, 15
 s_mul_i32 s62, s69, 1040
 s_add_u32 m0, s62, s63
 s_lshl_b32 s62, s69, 16
 s_add_u32 s62, s62, s61
 buffer_load_dwordx4 v3, s[52:55], s62 offen lds
 s_add_u32 s69, s68, 4
 s_and_b32 s69, s69, 15
 s_mul_i32 s62, s69, 1040
 s_add_u32 m0, s62, s63
 s_lshl_b32 s62, s69, 16
 s_add_u32 s62, s62, s61
 buffer_load_dwordx4 v3, s[52:55], s62 offen lds
 s_add_u32 s69, s68, 5
 s_and_b32 s69, s69, 15
 s_mul_i32 s62, s69, 1040
 s_add_u32 m0, s62, s63
 s_lshl_b32 s62, s69, 16
 s_add_u32 s62, s62, s61
 buffer_load_dwordx4 v3, s[52:55], s62 offen lds
 s_add_u32 s69, s68, 6
 s_and_b32 s69, s69, 15
 s_mul_i32 s62, s69, 1040
 s_add_u32 m0, s62, s63
 s_lshl_b32 s62, s69, 16
 s_add_u32 s62, s62, s61
 buffer_load_dwordx4 v3, s[52:55], s62 offen lds
 s_add_u32 s69, s68, 7
 s_and_b32 s69, s69, 15
 s_mul_i32 s62, s69, 1040
 s_add_u32 m0, s62, s63
 s_lshl_b32 s62, s69, 16
 s_add_u32 s62, s62, s61
 buffer_load_dwordx4 v3, s[52:55], s62 offen lds
 s_add_u32 s69, s68, 8
 s_and_b32 s69, s69, 15
 s_mul_i32 s62, s69, 1040
 s_add_u32 m0, s62, s63
 s_lshl_b32 s62, s69, 16
 s_add_u32 s62, s62, s61
 buffer_load_dwordx4 v3, s[52:55], s62 offen lds
 s_add_u32 s69, s68, 9
 s_and_b32 s69, s69, 15
 s_mul_i32 s62, s69, 1040
 s_add_u32 m0, s62, s63
 s_lshl_b32 s62, s69, 16
 s_add_u32 s62, s62, s61
 buffer_load_dwordx4 v3, s[52:55], s62 offen lds
 s_add_u32 s69, s68, 10
 s_and_b32 s69, s69, 15
 s_mul_i32 s62, s69, 1040
 s_add_u32 m0, s62, s63
 s_lshl_b32 s62, s69, 16
 s_add_u32 s62, s62, s61
 buffer_load_dwordx4 v3, s[52:55], s62 offen lds
 s_add_u32 s69, s68, 11
 s_and_b32 s69, s69, 15
 s_mul_i32 s62, s69, 1040
 s_add_u32 m0, s62, s63
 s_lshl_b32 s62, s69, 16
 s_add_u32 s62, s62, s61
 buffer_load_dwordx4 v3, s[52:55], s62 offen lds
 s_add_u32 s69, s68, 12
 s_and_b32 s69, s69, 15
 s_mul_i32 s62, s69, 1040
 s_add_u32 m0, s62, s63
 s_lshl_b32 s62, s69, 16
 s_add_u32 s62, s62, s61
 buffer_load_dwordx4 v3, s[52:55], s62 offen lds
 s_add_u32 s69, s68, 13
 s_and_b32 s69, s69, 15
 s_mul_i32 s62, s69, 1040
 s_add_u32 m0, s62, s63
 s_lshl_b32 s62, s69, 16
 s_add_u32 s62, s62, s61
 buffer_load_dwordx4 v3, s[52:55], s62 offen lds
 s_add_u32 s69, s68, 14
 s_and_b32 s69, s69, 15
 s_mul_i32 s62, s69, 1040
 s_add_u32 m0, s62, s63
 s_lshl_b32 s62, s69, 16
 s_add_u32 s62, s62, s61
 buffer_load_dwordx4 v3, s[52:55], s62 offen lds
 s_add_u32 s69, s68, 15
 s_and_b32 s69, s69, 15
 s_mul_i32 s62, s69, 1040
 s_add_u32 m0, s62, s63
 s_lshl_b32 s62, s69, 16
 s_add_u32 s62, s62, s61
 buffer_load_dwordx4 v3, s[52:55], s62 offen lds
 s_mul_i32 s62, s4, 40960
 v_lshl_add_u32 v6, v0, 2, s62
 v_mul_u32_u24 v7, 272, v4
 v_lshl_add_u32 v7, v5, 4, v7
 v_add_u32 v7, s62, v7
 v_lshlrev_b32 v8, 5, v4
 v_lshl_add_u32 v8, v5, 4, v8
 v_add_u32 v8, s62, v8
 v_sub_u32 v2, 4, v5
 v_lshlrev_b32 v9, v2, v4
 v_add_u32 v9, s62, v9
 v_lshl_add_u32 v10, v4, 2, s62
 v_lshl_add_u32 v11, v0, 6, s62
 v_and_b32 v2, 3, v0
 v_mul_u32_u24 v12, 4160, v2
 v_lshrrev_b32 v2, 2, v4
 v_sub_u32 v2, 7, v2
 v_lshl_add_u32 v12, v2, 3, v12
 v_lshl_add_u32 v12, v5, 4, v12
 v_add_u32 v12, s62, v12
 v_mul_u32_u24 v14, 80, v4
 v_add_u32 v14, s62, v14
 v_lshl_add_u32 v13, v5, 4, v14
 v_add_u32 v13, 80, v13
 v_lshl_add_u32 v14, v5, 3, v14
 s_add_u32 s62, s62, 24320
 v_lshlrev_b32 v2, 5, v0
 v_sub_u32 v3, 2047, v2
 v_cvt_f32_i32 v76, v3
 v_cvt_pk_bf16_f32 v76, v76, v76
 v_and_b32 v76, 0xffff, v76
 v_subrev_u32 v76, 17024, v76
 v_cmp_gt_i32 vcc, 0x100, v3
 s_nop 1
 v_cndmask_b32 v76, v76, v3, vcc
 v_lshl_add_u32 v40, v76, 2, s62
 v_sub_u32 v3, 2046, v2
 v_cvt_f32_i32 v76, v3
 v_cvt_pk_bf16_f32 v76, v76, v76
 v_and_b32 v76, 0xffff, v76
 v_subrev_u32 v76, 17024, v76
 v_cmp_gt_i32 vcc, 0x100, v3
 s_nop 1
 v_cndmask_b32 v76, v76, v3, vcc
 v_lshl_add_u32 v41, v76, 2, s62
 v_sub_u32 v3, 2045, v2
 v_cvt_f32_i32 v76, v3
 v_cvt_pk_bf16_f32 v76, v76, v76
 v_and_b32 v76, 0xffff, v76
 v_subrev_u32 v76, 17024, v76
 v_cmp_gt_i32 vcc, 0x100, v3
 s_nop 1
 v_cndmask_b32 v76, v76, v3, vcc
 v_lshl_add_u32 v42, v76, 2, s62
 v_sub_u32 v3, 2044, v2
 v_cvt_f32_i32 v76, v3
 v_cvt_pk_bf16_f32 v76, v76, v76
 v_and_b32 v76, 0xffff, v76
 v_subrev_u32 v76, 17024, v76
 v_cmp_gt_i32 vcc, 0x100, v3
 s_nop 1
 v_cndmask_b32 v76, v76, v3, vcc
 v_lshl_add_u32 v43, v76, 2, s62
 v_sub_u32 v3, 2043, v2
 v_cvt_f32_i32 v76, v3
 v_cvt_pk_bf16_f32 v76, v76, v76
 v_and_b32 v76, 0xffff, v76
 v_subrev_u32 v76, 17024, v76
 v_cmp_gt_i32 vcc, 0x100, v3
 s_nop 1
 v_cndmask_b32 v76, v76, v3, vcc
 v_lshl_add_u32 v44, v76, 2, s62
 v_sub_u32 v3, 2042, v2
 v_cvt_f32_i32 v76, v3
 v_cvt_pk_bf16_f32 v76, v76, v76
 v_and_b32 v76, 0xffff, v76
 v_subrev_u32 v76, 17024, v76
 v_cmp_gt_i32 vcc, 0x100, v3
 s_nop 1
 v_cndmask_b32 v76, v76, v3, vcc
 v_lshl_add_u32 v45, v76, 2, s62
 v_sub_u32 v3, 2041, v2
 v_cvt_f32_i32 v76, v3
 v_cvt_pk_bf16_f32 v76, v76, v76
 v_and_b32 v76, 0xffff, v76
 v_subrev_u32 v76, 17024, v76
 v_cmp_gt_i32 vcc, 0x100, v3
 s_nop 1
 v_cndmask_b32 v76, v76, v3, vcc
 v_lshl_add_u32 v46, v76, 2, s62
 v_sub_u32 v3, 2040, v2
 v_cvt_f32_i32 v76, v3
 v_cvt_pk_bf16_f32 v76, v76, v76
 v_and_b32 v76, 0xffff, v76
 v_subrev_u32 v76, 17024, v76
 v_cmp_gt_i32 vcc, 0x100, v3
 s_nop 1
 v_cndmask_b32 v76, v76, v3, vcc
 v_lshl_add_u32 v47, v76, 2, s62
 v_sub_u32 v3, 2039, v2
 v_cvt_f32_i32 v76, v3
 v_cvt_pk_bf16_f32 v76, v76, v76
 v_and_b32 v76, 0xffff, v76
 v_subrev_u32 v76, 17024, v76
 v_cmp_gt_i32 vcc, 0x100, v3
 s_nop 1
 v_cndmask_b32 v76, v76, v3, vcc
 v_lshl_add_u32 v48, v76, 2, s62
 v_sub_u32 v3, 2038, v2
 v_cvt_f32_i32 v76, v3
 v_cvt_pk_bf16_f32 v76, v76, v76
 v_and_b32 v76, 0xffff, v76
 v_subrev_u32 v76, 17024, v76
 v_cmp_gt_i32 vcc, 0x100, v3
 s_nop 1
 v_cndmask_b32 v76, v76, v3, vcc
 v_lshl_add_u32 v49, v76, 2, s62
 v_sub_u32 v3, 2037, v2
 v_cvt_f32_i32 v76, v3
 v_cvt_pk_bf16_f32 v76, v76, v76
 v_and_b32 v76, 0xffff, v76
 v_subrev_u32 v76, 17024, v76
 v_cmp_gt_i32 vcc, 0x100, v3
 s_nop 1
 v_cndmask_b32 v76, v76, v3, vcc
 v_lshl_add_u32 v50, v76, 2, s62
 v_sub_u32 v3, 2036, v2
 v_cvt_f32_i32 v76, v3
 v_cvt_pk_bf16_f32 v76, v76, v76
 v_and_b32 v76, 0xffff, v76
 v_subrev_u32 v76, 17024, v76
 v_cmp_gt_i32 vcc, 0x100, v3
 s_nop 1
 v_cndmask_b32 v76, v76, v3, vcc
 v_lshl_add_u32 v51, v76, 2, s62
 v_sub_u32 v3, 2035, v2
 v_cvt_f32_i32 v76, v3
 v_cvt_pk_bf16_f32 v76, v76, v76
 v_and_b32 v76, 0xffff, v76
 v_subrev_u32 v76, 17024, v76
 v_cmp_gt_i32 vcc, 0x100, v3
 s_nop 1
 v_cndmask_b32 v76, v76, v3, vcc
 v_lshl_add_u32 v52, v76, 2, s62
 v_sub_u32 v3, 2034, v2
 v_cvt_f32_i32 v76, v3
 v_cvt_pk_bf16_f32 v76, v76, v76
 v_and_b32 v76, 0xffff, v76
 v_subrev_u32 v76, 17024, v76
 v_cmp_gt_i32 vcc, 0x100, v3
 s_nop 1
 v_cndmask_b32 v76, v76, v3, vcc
 v_lshl_add_u32 v53, v76, 2, s62
 v_sub_u32 v3, 2033, v2
 v_cvt_f32_i32 v76, v3
 v_cvt_pk_bf16_f32 v76, v76, v76
 v_and_b32 v76, 0xffff, v76
 v_subrev_u32 v76, 17024, v76
 v_cmp_gt_i32 vcc, 0x100, v3
 s_nop 1
 v_cndmask_b32 v76, v76, v3, vcc
 v_lshl_add_u32 v54, v76, 2, s62
 v_sub_u32 v3, 2032, v2
 v_cvt_f32_i32 v76, v3
 v_cvt_pk_bf16_f32 v76, v76, v76
 v_and_b32 v76, 0xffff, v76
 v_subrev_u32 v76, 17024, v76
 v_cmp_gt_i32 vcc, 0x100, v3
 s_nop 1
 v_cndmask_b32 v76, v76, v3, vcc
 v_lshl_add_u32 v55, v76, 2, s62
 v_sub_u32 v3, 2031, v2
 v_cvt_f32_i32 v76, v3
 v_cvt_pk_bf16_f32 v76, v76, v76
 v_and_b32 v76, 0xffff, v76
 v_subrev_u32 v76, 17024, v76
 v_cmp_gt_i32 vcc, 0x100, v3
 s_nop 1
 v_cndmask_b32 v76, v76, v3, vcc
 v_lshl_add_u32 v56, v76, 2, s62
 v_sub_u32 v3, 2030, v2
 v_cvt_f32_i32 v76, v3
 v_cvt_pk_bf16_f32 v76, v76, v76
 v_and_b32 v76, 0xffff, v76
 v_subrev_u32 v76, 17024, v76
 v_cmp_gt_i32 vcc, 0x100, v3
 s_nop 1
 v_cndmask_b32 v76, v76, v3, vcc
 v_lshl_add_u32 v57, v76, 2, s62
 v_sub_u32 v3, 2029, v2
 v_cvt_f32_i32 v76, v3
 v_cvt_pk_bf16_f32 v76, v76, v76
 v_and_b32 v76, 0xffff, v76
 v_subrev_u32 v76, 17024, v76
 v_cmp_gt_i32 vcc, 0x100, v3
 s_nop 1
 v_cndmask_b32 v76, v76, v3, vcc
 v_lshl_add_u32 v58, v76, 2, s62
 v_sub_u32 v3, 2028, v2
 v_cvt_f32_i32 v76, v3
 v_cvt_pk_bf16_f32 v76, v76, v76
 v_and_b32 v76, 0xffff, v76
 v_subrev_u32 v76, 17024, v76
 v_cmp_gt_i32 vcc, 0x100, v3
 s_nop 1
 v_cndmask_b32 v76, v76, v3, vcc
 v_lshl_add_u32 v59, v76, 2, s62
 v_sub_u32 v3, 2027, v2
 v_cvt_f32_i32 v76, v3
 v_cvt_pk_bf16_f32 v76, v76, v76
 v_and_b32 v76, 0xffff, v76
 v_subrev_u32 v76, 17024, v76
 v_cmp_gt_i32 vcc, 0x100, v3
 s_nop 1
 v_cndmask_b32 v76, v76, v3, vcc
 v_lshl_add_u32 v60, v76, 2, s62
 v_sub_u32 v3, 2026, v2
 v_cvt_f32_i32 v76, v3
 v_cvt_pk_bf16_f32 v76, v76, v76
 v_and_b32 v76, 0xffff, v76
 v_subrev_u32 v76, 17024, v76
 v_cmp_gt_i32 vcc, 0x100, v3
 s_nop 1
 v_cndmask_b32 v76, v76, v3, vcc
 v_lshl_add_u32 v61, v76, 2, s62
 v_sub_u32 v3, 2025, v2
 v_cvt_f32_i32 v76, v3
 v_cvt_pk_bf16_f32 v76, v76, v76
 v_and_b32 v76, 0xffff, v76
 v_subrev_u32 v76, 17024, v76
 v_cmp_gt_i32 vcc, 0x100, v3
 s_nop 1
 v_cndmask_b32 v76, v76, v3, vcc
 v_lshl_add_u32 v62, v76, 2, s62
 v_sub_u32 v3, 2024, v2
 v_cvt_f32_i32 v76, v3
 v_cvt_pk_bf16_f32 v76, v76, v76
 v_and_b32 v76, 0xffff, v76
 v_subrev_u32 v76, 17024, v76
 v_cmp_gt_i32 vcc, 0x100, v3
 s_nop 1
 v_cndmask_b32 v76, v76, v3, vcc
 v_lshl_add_u32 v63, v76, 2, s62
 v_sub_u32 v3, 2023, v2
 v_cvt_f32_i32 v76, v3
 v_cvt_pk_bf16_f32 v76, v76, v76
 v_and_b32 v76, 0xffff, v76
 v_subrev_u32 v76, 17024, v76
 v_cmp_gt_i32 vcc, 0x100, v3
 s_nop 1
 v_cndmask_b32 v76, v76, v3, vcc
 v_lshl_add_u32 v64, v76, 2, s62
 v_sub_u32 v3, 2022, v2
 v_cvt_f32_i32 v76, v3
 v_cvt_pk_bf16_f32 v76, v76, v76
 v_and_b32 v76, 0xffff, v76
 v_subrev_u32 v76, 17024, v76
 v_cmp_gt_i32 vcc, 0x100, v3
 s_nop 1
 v_cndmask_b32 v76, v76, v3, vcc
 v_lshl_add_u32 v65, v76, 2, s62
 v_sub_u32 v3, 2021, v2
 v_cvt_f32_i32 v76, v3
 v_cvt_pk_bf16_f32 v76, v76, v76
 v_and_b32 v76, 0xffff, v76
 v_subrev_u32 v76, 17024, v76
 v_cmp_gt_i32 vcc, 0x100, v3
 s_nop 1
 v_cndmask_b32 v76, v76, v3, vcc
 v_lshl_add_u32 v66, v76, 2, s62
 v_sub_u32 v3, 2020, v2
 v_cvt_f32_i32 v76, v3
 v_cvt_pk_bf16_f32 v76, v76, v76
 v_and_b32 v76, 0xffff, v76
 v_subrev_u32 v76, 17024, v76
 v_cmp_gt_i32 vcc, 0x100, v3
 s_nop 1
 v_cndmask_b32 v76, v76, v3, vcc
 v_lshl_add_u32 v67, v76, 2, s62
 v_sub_u32 v3, 2019, v2
 v_cvt_f32_i32 v76, v3
 v_cvt_pk_bf16_f32 v76, v76, v76
 v_and_b32 v76, 0xffff, v76
 v_subrev_u32 v76, 17024, v76
 v_cmp_gt_i32 vcc, 0x100, v3
 s_nop 1
 v_cndmask_b32 v76, v76, v3, vcc
 v_lshl_add_u32 v68, v76, 2, s62
 v_sub_u32 v3, 2018, v2
 v_cvt_f32_i32 v76, v3
 v_cvt_pk_bf16_f32 v76, v76, v76
 v_and_b32 v76, 0xffff, v76
 v_subrev_u32 v76, 17024, v76
 v_cmp_gt_i32 vcc, 0x100, v3
 s_nop 1
 v_cndmask_b32 v76, v76, v3, vcc
 v_lshl_add_u32 v69, v76, 2, s62
 v_sub_u32 v3, 2017, v2
 v_cvt_f32_i32 v76, v3
 v_cvt_pk_bf16_f32 v76, v76, v76
 v_and_b32 v76, 0xffff, v76
 v_subrev_u32 v76, 17024, v76
 v_cmp_gt_i32 vcc, 0x100, v3
 s_nop 1
 v_cndmask_b32 v76, v76, v3, vcc
 v_lshl_add_u32 v70, v76, 2, s62
 v_sub_u32 v3, 2016, v2
 v_cvt_f32_i32 v76, v3
 v_cvt_pk_bf16_f32 v76, v76, v76
 v_and_b32 v76, 0xffff, v76
 v_subrev_u32 v76, 17024, v76
 v_cmp_gt_i32 vcc, 0x100, v3
 s_nop 1
 v_cndmask_b32 v76, v76, v3, vcc
 v_lshl_add_u32 v71, v76, 2, s62
 v_sub_u32 v3, 2015, v2
 v_cvt_f32_i32 v76, v3
 v_cvt_pk_bf16_f32 v76, v76, v76
 v_and_b32 v76, 0xffff, v76
 v_subrev_u32 v76, 17024, v76
 v_cmp_gt_i32 vcc, 0x100, v3
 s_nop 1
 v_cndmask_b32 v76, v76, v3, vcc
 v_mov_b32 v77, 672
 v_cmp_gt_i32 vcc, 0, v3
 s_nop 1
 v_cndmask_b32 v76, v76, v77, vcc
 v_lshl_add_u32 v72, v76, 2, s62
 v_sub_u32 v3, 2014, v2
 v_cvt_f32_i32 v76, v3
 v_cvt_pk_bf16_f32 v76, v76, v76
 v_and_b32 v76, 0xffff, v76
 v_subrev_u32 v76, 17024, v76
 v_cmp_gt_i32 vcc, 0x100, v3
 s_nop 1
 v_cndmask_b32 v76, v76, v3, vcc
 v_mov_b32 v77, 672
 v_cmp_gt_i32 vcc, 0, v3
 s_nop 1
 v_cndmask_b32 v76, v76, v77, vcc
 v_lshl_add_u32 v73, v76, 2, s62
 v_sub_u32 v3, 2013, v2
 v_cvt_f32_i32 v76, v3
 v_cvt_pk_bf16_f32 v76, v76, v76
 v_and_b32 v76, 0xffff, v76
 v_subrev_u32 v76, 17024, v76
 v_cmp_gt_i32 vcc, 0x100, v3
 s_nop 1
 v_cndmask_b32 v76, v76, v3, vcc
 v_mov_b32 v77, 672
 v_cmp_gt_i32 vcc, 0, v3
 s_nop 1
 v_cndmask_b32 v76, v76, v77, vcc
 v_lshl_add_u32 v74, v76, 2, s62
 v_mul_u32_u24 v75, 1040, v4
 v_lshl_add_u32 v75, v5, 7, v75
 s_lshl_b32 s61, s4, 3
 v_add_u32 v75, s61, v75
 s_waitcnt vmcnt(0)
 s_barrier
 ds_read_b64 v[192:193], v75 offset:0
 ds_read_b64 v[194:195], v75 offset:32
 ds_read_b64 v[196:197], v75 offset:64
 ds_read_b64 v[198:199], v75 offset:96
 ds_read_b64 v[200:201], v75 offset:256
 ds_read_b64 v[202:203], v75 offset:288
 ds_read_b64 v[204:205], v75 offset:320
 ds_read_b64 v[206:207], v75 offset:352
 s_waitcnt lgkmcnt(0)
 ds_read_b64 v[208:209], v75 offset:512
 ds_read_b64 v[210:211], v75 offset:544
 ds_read_b64 v[212:213], v75 offset:576
 ds_read_b64 v[214:215], v75 offset:608
 ds_read_b64 v[216:217], v75 offset:768
 ds_read_b64 v[218:219], v75 offset:800
 ds_read_b64 v[220:221], v75 offset:832
 ds_read_b64 v[222:223], v75 offset:864
 s_waitcnt lgkmcnt(0)
 ds_read_b64 v[224:225], v75 offset:33280
 ds_read_b64 v[226:227], v75 offset:33312
 ds_read_b64 v[228:229], v75 offset:33344
 ds_read_b64 v[230:231], v75 offset:33376
 ds_read_b64 v[232:233], v75 offset:33536
 ds_read_b64 v[234:235], v75 offset:33568
 ds_read_b64 v[236:237], v75 offset:33600
 ds_read_b64 v[238:239], v75 offset:33632
 s_waitcnt lgkmcnt(0)
 ds_read_b64 v[240:241], v75 offset:33792
 ds_read_b64 v[242:243], v75 offset:33824
 ds_read_b64 v[244:245], v75 offset:33856
 ds_read_b64 v[246:247], v75 offset:33888
 ds_read_b64 v[248:249], v75 offset:34048
 ds_read_b64 v[250:251], v75 offset:34080
 ds_read_b64 v[252:253], v75 offset:34112
 ds_read_b64 v[254:255], v75 offset:34144
 s_waitcnt lgkmcnt(0)
 s_barrier
 v_mov_b32 v2, 0
 ds_write_b32 v6, v2 offset:27008
 ds_write_b32 v6, v2 offset:16640
 ds_write_b32 v6, v2 offset:16896
 ds_write_b32 v6, v2 offset:17152
 ds_write_b32 v6, v2 offset:17408
 ds_write_b32 v6, v2 offset:17664
 ds_write_b32 v6, v2 offset:17920
 ds_write_b32 v6, v2 offset:18176
 ds_write_b32 v6, v2 offset:18432
 ds_write_b32 v6, v2 offset:18688
 ds_write_b32 v6, v2 offset:18944
 s_mov_b32 s63, 0
 s_waitcnt lgkmcnt(0)
Ls_chan:
 s_lshl_b32 s61, s64, 16
 v_mov_b32 v15, 0x3fb8aa3b
 v_mul_f32 v15, s61, v15
 v_exp_f32 v15, v15
 s_bitcmp1_b32 s63, 0
 s_mov_b32 s68, 0x01000c0c
 s_mov_b32 s69, 0x05040100
 s_mov_b32 s70, 0x03020504
 s_mov_b32 s71, 0x03020706
 s_cmov_b32 s68, 0x03020c0c
 s_cmov_b32 s69, 0x07060302
 s_cmov_b32 s70, 0x05040100
 s_cmov_b32 s71, 0x07060100
 v_cvt_pk_bf16_f32 v15, v15, v15
 v_lshlrev_b32 v15, 16, v15
 v_lshlrev_b32 v76, 16, v16
 v_lshlrev_b32 v77, 16, v17
 v_lshlrev_b32 v90, 16, v18
 v_lshlrev_b32 v91, 16, v19
 v_lshlrev_b32 v92, 16, v20
 v_lshlrev_b32 v93, 16, v21
 v_mul_f32 v76, v15, v76
 v_mul_f32 v77, v15, v77
 v_mul_f32 v90, v15, v90
 v_mul_f32 v91, v15, v91
 v_mul_f32 v76, 0x3fb8aa3b, v76
 v_mul_f32 v77, 0.15915494, v77
 v_pk_mul_f32 v[94:95], v[92:93], v[90:91] op_sel_hi:[1,0]
 v_pk_fma_f32 v[94:95], v[92:93], v[90:91], v[94:95] op_sel:[1,1,0] op_sel_hi:[0,1,1] neg_lo:[1,0,0]
 v_mul_f32 v2, 0x3f800000, v76
 v_mul_f32 v3, 0x3f800000, v77
 v_exp_f32 v2, v2
 v_fract_f32 v3, v3
 v_cos_f32 v80, v3
 v_sin_f32 v81, v3
 s_nop 0
 v_pk_mul_f32 v[80:81], v[80:81], v[2:3] op_sel_hi:[1,0]
 v_mul_f32 v2, 0x41000000, v76
 v_mul_f32 v3, 0x41000000, v77
 v_exp_f32 v2, v2
 v_fract_f32 v3, v3
 v_cos_f32 v82, v3
 v_sin_f32 v83, v3
 s_nop 0
 v_pk_mul_f32 v[82:83], v[82:83], v[2:3] op_sel_hi:[1,0]
 v_mul_f32 v2, 0x43800000, v76
 v_mul_f32 v3, 0x43800000, v77
 v_exp_f32 v2, v2
 v_fract_f32 v3, v3
 v_cos_f32 v84, v3
 v_sin_f32 v85, v3
 s_nop 0
 v_pk_mul_f32 v[84:85], v[84:85], v[2:3] op_sel_hi:[1,0]
 v_mov_b32 v117, 0x3f80
 ds_write_b32 v6, v117 offset:5712
 v_cvt_pk_bf16_f32 v114, v82, v83
 ds_write_b32 v6, v114 offset:5984
 v_pk_mul_f32 v[110:111], v[82:83], v[82:83] op_sel_hi:[1,0]
 v_pk_fma_f32 v[110:111], v[82:83], v[82:83], v[110:111] op_sel:[1,1,0] op_sel_hi:[0,1,1] neg_lo:[1,0,0]
 v_cvt_pk_bf16_f32 v115, v110, v111
 ds_write_b32 v6, v115 offset:6256
 v_pk_mul_f32 v[112:113], v[110:111], v[82:83] op_sel_hi:[1,0]
 v_pk_fma_f32 v[112:113], v[110:111], v[82:83], v[112:113] op_sel:[1,1,0] op_sel_hi:[0,1,1] neg_lo:[1,0,0]
 v_cvt_pk_bf16_f32 v116, v112, v113
 ds_write_b32 v6, v116 offset:6528
 v_pk_mul_f32 v[110:111], v[112:113], v[82:83] op_sel_hi:[1,0]
 v_pk_fma_f32 v[110:111], v[112:113], v[82:83], v[110:111] op_sel:[1,1,0] op_sel_hi:[0,1,1] neg_lo:[1,0,0]
 v_cvt_pk_bf16_f32 v117, v110, v111
 ds_write_b32 v6, v117 offset:6800
 v_pk_mul_f32 v[112:113], v[110:111], v[82:83] op_sel_hi:[1,0]
 v_pk_fma_f32 v[112:113], v[110:111], v[82:83], v[112:113] op_sel:[1,1,0] op_sel_hi:[0,1,1] neg_lo:[1,0,0]
 v_cvt_pk_bf16_f32 v114, v112, v113
 ds_write_b32 v6, v114 offset:7072
 v_pk_mul_f32 v[110:111], v[112:113], v[82:83] op_sel_hi:[1,0]
 v_pk_fma_f32 v[110:111], v[112:113], v[82:83], v[110:111] op_sel:[1,1,0] op_sel_hi:[0,1,1] neg_lo:[1,0,0]
 v_cvt_pk_bf16_f32 v115, v110, v111
 ds_write_b32 v6, v115 offset:7344
 v_pk_mul_f32 v[112:113], v[110:111], v[82:83] op_sel_hi:[1,0]
 v_pk_fma_f32 v[112:113], v[110:111], v[82:83], v[112:113] op_sel:[1,1,0] op_sel_hi:[0,1,1] neg_lo:[1,0,0]
 v_cvt_pk_bf16_f32 v116, v112, v113
 ds_write_b32 v6, v116 offset:7616
 v_pk_mul_f32 v[110:111], v[112:113], v[82:83] op_sel_hi:[1,0]
 v_pk_fma_f32 v[110:111], v[112:113], v[82:83], v[110:111] op_sel:[1,1,0] op_sel_hi:[0,1,1] neg_lo:[1,0,0]
 v_cvt_pk_bf16_f32 v117, v110, v111
 ds_write_b32 v6, v117 offset:7888
 v_pk_mul_f32 v[112:113], v[110:111], v[82:83] op_sel_hi:[1,0]
 v_pk_fma_f32 v[112:113], v[110:111], v[82:83], v[112:113] op_sel:[1,1,0] op_sel_hi:[0,1,1] neg_lo:[1,0,0]
 v_cvt_pk_bf16_f32 v114, v112, v113
 ds_write_b32 v6, v114 offset:8160
 v_pk_mul_f32 v[110:111], v[112:113], v[82:83] op_sel_hi:[1,0]
 v_pk_fma_f32 v[110:111], v[112:113], v[82:83], v[110:111] op_sel:[1,1,0] op_sel_hi:[0,1,1] neg_lo:[1,0,0]
 v_cvt_pk_bf16_f32 v115, v110, v111
 ds_write_b32 v6, v115 offset:8432
 v_pk_mul_f32 v[112:113], v[110:111], v[82:83] op_sel_hi:[1,0]
 v_pk_fma_f32 v[112:113], v[110:111], v[82:83], v[112:113] op_sel:[1,1,0] op_sel_hi:[0,1,1] neg_lo:[1,0,0]
 v_cvt_pk_bf16_f32 v116, v112, v113
 ds_write_b32 v6, v116 offset:8704
 v_pk_mul_f32 v[110:111], v[112:113], v[82:83] op_sel_hi:[1,0]
 v_pk_fma_f32 v[110:111], v[112:113], v[82:83], v[110:111] op_sel:[1,1,0] op_sel_hi:[0,1,1] neg_lo:[1,0,0]
 v_cvt_pk_bf16_f32 v117, v110, v111
 ds_write_b32 v6, v117 offset:8976
 v_pk_mul_f32 v[112:113], v[110:111], v[82:83] op_sel_hi:[1,0]
 v_pk_fma_f32 v[112:113], v[110:111], v[82:83], v[112:113] op_sel:[1,1,0] op_sel_hi:[0,1,1] neg_lo:[1,0,0]
 v_cvt_pk_bf16_f32 v114, v112, v113
 ds_write_b32 v6, v114 offset:9248
 v_pk_mul_f32 v[110:111], v[112:113], v[82:83] op_sel_hi:[1,0]
 v_pk_fma_f32 v[110:111], v[112:113], v[82:83], v[110:111] op_sel:[1,1,0] op_sel_hi:[0,1,1] neg_lo:[1,0,0]
 v_cvt_pk_bf16_f32 v115, v110, v111
 ds_write_b32 v6, v115 offset:9520
 v_pk_mul_f32 v[112:113], v[110:111], v[82:83] op_sel_hi:[1,0]
 v_pk_fma_f32 v[112:113], v[110:111], v[82:83], v[112:113] op_sel:[1,1,0] op_sel_hi:[0,1,1] neg_lo:[1,0,0]
 v_cvt_pk_bf16_f32 v116, v112, v113
 ds_write_b32 v6, v116 offset:9792
 v_pk_mul_f32 v[110:111], v[112:113], v[82:83] op_sel_hi:[1,0]
 v_pk_fma_f32 v[110:111], v[112:113], v[82:83], v[110:111] op_sel:[1,1,0] op_sel_hi:[0,1,1] neg_lo:[1,0,0]
 v_cvt_pk_bf16_f32 v117, v110, v111
 ds_write_b32 v6, v117 offset:10064
 v_pk_mul_f32 v[112:113], v[110:111], v[82:83] op_sel_hi:[1,0]
 v_pk_fma_f32 v[112:113], v[110:111], v[82:83], v[112:113] op_sel:[1,1,0] op_sel_hi:[0,1,1] neg_lo:[1,0,0]
 v_cvt_pk_bf16_f32 v114, v112, v113
 ds_write_b32 v6, v114 offset:10336
 v_pk_mul_f32 v[110:111], v[112:113], v[82:83] op_sel_hi:[1,0]
 v_pk_fma_f32 v[110:111], v[112:113], v[82:83], v[110:111] op_sel:[1,1,0] op_sel_hi:[0,1,1] neg_lo:[1,0,0]
 v_cvt_pk_bf16_f32 v115, v110, v111
 ds_write_b32 v6, v115 offset:10608
 v_pk_mul_f32 v[112:113], v[110:111], v[82:83] op_sel_hi:[1,0]
 v_pk_fma_f32 v[112:113], v[110:111], v[82:83], v[112:113] op_sel:[1,1,0] op_sel_hi:[0,1,1] neg_lo:[1,0,0]
 v_cvt_pk_bf16_f32 v116, v112, v113
 ds_write_b32 v6, v116 offset:10880
 v_pk_mul_f32 v[110:111], v[112:113], v[82:83] op_sel_hi:[1,0]
 v_pk_fma_f32 v[110:111], v[112:113], v[82:83], v[110:111] op_sel:[1,1,0] op_sel_hi:[0,1,1] neg_lo:[1,0,0]
 v_cvt_pk_bf16_f32 v117, v110, v111
 ds_write_b32 v6, v117 offset:11152
 v_pk_mul_f32 v[112:113], v[110:111], v[82:83] op_sel_hi:[1,0]
 v_pk_fma_f32 v[112:113], v[110:111], v[82:83], v[112:113] op_sel:[1,1,0] op_sel_hi:[0,1,1] neg_lo:[1,0,0]
 v_cvt_pk_bf16_f32 v114, v112, v113
 ds_write_b32 v6, v114 offset:11424
 v_pk_mul_f32 v[110:111], v[112:113], v[82:83] op_sel_hi:[1,0]
 v_pk_fma_f32 v[110:111], v[112:113], v[82:83], v[110:111] op_sel:[1,1,0] op_sel_hi:[0,1,1] neg_lo:[1,0,0]
 v_cvt_pk_bf16_f32 v115, v110, v111
 ds_write_b32 v6, v115 offset:11696
 v_pk_mul_f32 v[112:113], v[110:111], v[82:83] op_sel_hi:[1,0]
 v_pk_fma_f32 v[112:113], v[110:111], v[82:83], v[112:113] op_sel:[1,1,0] op_sel_hi:[0,1,1] neg_lo:[1,0,0]
 v_cvt_pk_bf16_f32 v116, v112, v113
 ds_write_b32 v6, v116 offset:11968
 v_pk_mul_f32 v[110:111], v[112:113], v[82:83] op_sel_hi:[1,0]
 v_pk_fma_f32 v[110:111], v[112:113], v[82:83], v[110:111] op_sel:[1,1,0] op_sel_hi:[0,1,1] neg_lo:[1,0,0]
 v_cvt_pk_bf16_f32 v117, v110, v111
 ds_write_b32 v6, v117 offset:12240
 v_pk_mul_f32 v[112:113], v[110:111], v[82:83] op_sel_hi:[1,0]
 v_pk_fma_f32 v[112:113], v[110:111], v[82:83], v[112:113] op_sel:[1,1,0] op_sel_hi:[0,1,1] neg_lo:[1,0,0]
 v_cvt_pk_bf16_f32 v114, v112, v113
 ds_write_b32 v6, v114 offset:12512
 v_pk_mul_f32 v[110:111], v[112:113], v[82:83] op_sel_hi:[1,0]
 v_pk_fma_f32 v[110:111], v[112:113], v[82:83], v[110:111] op_sel:[1,1,0] op_sel_hi:[0,1,1] neg_lo:[1,0,0]
 v_cvt_pk_bf16_f32 v115, v110, v111
 ds_write_b32 v6, v115 offset:12784
 v_pk_mul_f32 v[112:113], v[110:111], v[82:83] op_sel_hi:[1,0]
 v_pk_fma_f32 v[112:113], v[110:111], v[82:83], v[112:113] op_sel:[1,1,0] op_sel_hi:[0,1,1] neg_lo:[1,0,0]
 v_cvt_pk_bf16_f32 v116, v112, v113
 ds_write_b32 v6, v116 offset:13056
 v_pk_mul_f32 v[110:111], v[112:113], v[82:83] op_sel_hi:[1,0]
 v_pk_fma_f32 v[110:111], v[112:113], v[82:83], v[110:111] op_sel:[1,1,0] op_sel_hi:[0,1,1] neg_lo:[1,0,0]
 v_cvt_pk_bf16_f32 v117, v110, v111
 ds_write_b32 v6, v117 offset:13328
 v_pk_mul_f32 v[112:113], v[110:111], v[82:83] op_sel_hi:[1,0]
 v_pk_fma_f32 v[112:113], v[110:111], v[82:83], v[112:113] op_sel:[1,1,0] op_sel_hi:[0,1,1] neg_lo:[1,0,0]
 v_cvt_pk_bf16_f32 v114, v112, v113
 ds_write_b32 v6, v114 offset:13600
 v_pk_mul_f32 v[110:111], v[112:113], v[82:83] op_sel_hi:[1,0]
 v_pk_fma_f32 v[110:111], v[112:113], v[82:83], v[110:111] op_sel:[1,1,0] op_sel_hi:[0,1,1] neg_lo:[1,0,0]
 v_cvt_pk_bf16_f32 v115, v110, v111
 ds_write_b32 v6, v115 offset:13872
 v_pk_mul_f32 v[112:113], v[110:111], v[82:83] op_sel_hi:[1,0]
 v_pk_fma_f32 v[112:113], v[110:111], v[82:83], v[112:113] op_sel:[1,1,0] op_sel_hi:[0,1,1] neg_lo:[1,0,0]
 v_cvt_pk_bf16_f32 v116, v112, v113
 ds_write_b32 v6, v116 offset:14144
 v_cvt_pk_bf16_f32 v117, v94, -v95
 ds_write_b32 v6, v117 offset:0
 v_pk_mul_f32 v[96:97], v[94:95], v[80:81] op_sel_hi:[1,0]
 v_pk_fma_f32 v[96:97], v[94:95], v[80:81], v[96:97] op_sel:[1,1,0] op_sel_hi:[0,1,1] neg_lo:[1,0,0]
 v_cvt_pk_bf16_f32 v114, v96, -v97
 ds_write_b32 v6, v114 offset:272
 v_pk_mul_f32 v[98:99], v[96:97], v[80:81] op_sel_hi:[1,0]
 v_pk_fma_f32 v[98:99], v[96:97], v[80:81], v[98:99] op_sel:[1,1,0] op_sel_hi:[0,1,1] neg_lo:[1,0,0]
 v_cvt_pk_bf16_f32 v115, v98, -v99
 ds_write_b32 v6, v115 offset:544
 v_pk_mul_f32 v[100:101], v[98:99], v[80:81] op_sel_hi:[1,0]
 v_pk_fma_f32 v[100:101], v[98:99], v[80:81], v[100:101] op_sel:[1,1,0] op_sel_hi:[0,1,1] neg_lo:[1,0,0]
 v_cvt_pk_bf16_f32 v116, v100, -v101
 ds_write_b32 v6, v116 offset:816
 v_pk_mul_f32 v[102:103], v[100:101], v[80:81] op_sel_hi:[1,0]
 v_pk_fma_f32 v[102:103], v[100:101], v[80:81], v[102:103] op_sel:[1,1,0] op_sel_hi:[0,1,1] neg_lo:[1,0,0]
 v_cvt_pk_bf16_f32 v117, v102, -v103
 ds_write_b32 v6, v117 offset:1088
 v_pk_mul_f32 v[104:105], v[102:103], v[80:81] op_sel_hi:[1,0]
 v_pk_fma_f32 v[104:105], v[102:103], v[80:81], v[104:105] op_sel:[1,1,0] op_sel_hi:[0,1,1] neg_lo:[1,0,0]
 v_cvt_pk_bf16_f32 v114, v104, -v105
 ds_write_b32 v6, v114 offset:1360
 v_pk_mul_f32 v[106:107], v[104:105], v[80:81] op_sel_hi:[1,0]
 v_pk_fma_f32 v[106:107], v[104:105], v[80:81], v[106:107] op_sel:[1,1,0] op_sel_hi:[0,1,1] neg_lo:[1,0,0]
 v_cvt_pk_bf16_f32 v115, v106, -v107
 ds_write_b32 v6, v115 offset:1632
 v_pk_mul_f32 v[108:109], v[106:107], v[80:81] op_sel_hi:[1,0]
 v_pk_fma_f32 v[108:109], v[106:107], v[80:81], v[108:109] op_sel:[1,1,0] op_sel_hi:[0,1,1] neg_lo:[1,0,0]
 v_cvt_pk_bf16_f32 v116, v108, -v109
 ds_write_b32 v6, v116 offset:1904
 v_pk_mul_f32 v[110:111], v[94:95], v[84:85] op_sel_hi:[1,0]
 v_pk_fma_f32 v[110:111], v[94:95], v[84:85], v[110:111] op_sel:[1,1,0] op_sel_hi:[0,1,1] neg_lo:[1,0,0]
 v_cvt_pk_bf16_f32 v117, v110, -v111
 ds_write_b32 v6, v117 offset:2176
 v_pk_mul_f32 v[112:113], v[98:99], v[84:85] op_sel_hi:[1,0]
 v_pk_fma_f32 v[112:113], v[98:99], v[84:85], v[112:113] op_sel:[1,1,0] op_sel_hi:[0,1,1] neg_lo:[1,0,0]
 v_cvt_pk_bf16_f32 v114, v112, -v113
 ds_write_b32 v6, v114 offset:2448
 v_pk_mul_f32 v[110:111], v[102:103], v[84:85] op_sel_hi:[1,0]
 v_pk_fma_f32 v[110:111], v[102:103], v[84:85], v[110:111] op_sel:[1,1,0] op_sel_hi:[0,1,1] neg_lo:[1,0,0]
 v_cvt_pk_bf16_f32 v115, v110, -v111
 ds_write_b32 v6, v115 offset:2720
 v_pk_mul_f32 v[112:113], v[106:107], v[84:85] op_sel_hi:[1,0]
 v_pk_fma_f32 v[112:113], v[106:107], v[84:85], v[112:113] op_sel:[1,1,0] op_sel_hi:[0,1,1] neg_lo:[1,0,0]
 v_cvt_pk_bf16_f32 v116, v112, -v113
 ds_write_b32 v6, v116 offset:2992
 v_pk_mul_f32 v[86:87], v[84:85], v[84:85] op_sel_hi:[1,0]
 v_pk_fma_f32 v[86:87], v[84:85], v[84:85], v[86:87] op_sel:[1,1,0] op_sel_hi:[0,1,1] neg_lo:[1,0,0]
 v_pk_mul_f32 v[110:111], v[94:95], v[86:87] op_sel_hi:[1,0]
 v_pk_fma_f32 v[110:111], v[94:95], v[86:87], v[110:111] op_sel:[1,1,0] op_sel_hi:[0,1,1] neg_lo:[1,0,0]
 v_cvt_pk_bf16_f32 v117, v110, -v111
 ds_write_b32 v6, v117 offset:3264
 v_pk_mul_f32 v[112:113], v[102:103], v[86:87] op_sel_hi:[1,0]
 v_pk_fma_f32 v[112:113], v[102:103], v[86:87], v[112:113] op_sel:[1,1,0] op_sel_hi:[0,1,1] neg_lo:[1,0,0]
 v_cvt_pk_bf16_f32 v114, v112, -v113
 ds_write_b32 v6, v114 offset:3536
 v_pk_mul_f32 v[88:89], v[86:87], v[84:85] op_sel_hi:[1,0]
 v_pk_fma_f32 v[88:89], v[86:87], v[84:85], v[88:89] op_sel:[1,1,0] op_sel_hi:[0,1,1] neg_lo:[1,0,0]
 v_pk_mul_f32 v[110:111], v[94:95], v[88:89] op_sel_hi:[1,0]
 v_pk_fma_f32 v[110:111], v[94:95], v[88:89], v[110:111] op_sel:[1,1,0] op_sel_hi:[0,1,1] neg_lo:[1,0,0]
 v_cvt_pk_bf16_f32 v115, v110, -v111
 ds_write_b32 v6, v115 offset:3808
 v_pk_mul_f32 v[112:113], v[102:103], v[88:89] op_sel_hi:[1,0]
 v_pk_fma_f32 v[112:113], v[102:103], v[88:89], v[112:113] op_sel:[1,1,0] op_sel_hi:[0,1,1] neg_lo:[1,0,0]
 v_cvt_pk_bf16_f32 v116, v112, -v113
 ds_write_b32 v6, v116 offset:4080
 v_pk_mul_f32 v[86:87], v[88:89], v[84:85] op_sel_hi:[1,0]
 v_pk_fma_f32 v[86:87], v[88:89], v[84:85], v[86:87] op_sel:[1,1,0] op_sel_hi:[0,1,1] neg_lo:[1,0,0]
 v_pk_mul_f32 v[110:111], v[94:95], v[86:87] op_sel_hi:[1,0]
 v_pk_fma_f32 v[110:111], v[94:95], v[86:87], v[110:111] op_sel:[1,1,0] op_sel_hi:[0,1,1] neg_lo:[1,0,0]
 v_cvt_pk_bf16_f32 v117, v110, -v111
 ds_write_b32 v6, v117 offset:4352
 v_pk_mul_f32 v[88:89], v[86:87], v[84:85] op_sel_hi:[1,0]
 v_pk_fma_f32 v[88:89], v[86:87], v[84:85], v[88:89] op_sel:[1,1,0] op_sel_hi:[0,1,1] neg_lo:[1,0,0]
 v_pk_mul_f32 v[110:111], v[94:95], v[88:89] op_sel_hi:[1,0]
 v_pk_fma_f32 v[110:111], v[94:95], v[88:89], v[110:111] op_sel:[1,1,0] op_sel_hi:[0,1,1] neg_lo:[1,0,0]
 v_cvt_pk_bf16_f32 v114, v110, -v111
 ds_write_b32 v6, v114 offset:4624
 v_pk_mul_f32 v[86:87], v[88:89], v[84:85] op_sel_hi:[1,0]
 v_pk_fma_f32 v[86:87], v[88:89], v[84:85], v[86:87] op_sel:[1,1,0] op_sel_hi:[0,1,1] neg_lo:[1,0,0]
 v_pk_mul_f32 v[110:111], v[94:95], v[86:87] op_sel_hi:[1,0]
 v_pk_fma_f32 v[110:111], v[94:95], v[86:87], v[110:111] op_sel:[1,1,0] op_sel_hi:[0,1,1] neg_lo:[1,0,0]
 v_cvt_pk_bf16_f32 v115, v110, -v111
 ds_write_b32 v6, v115 offset:4896
 v_pk_mul_f32 v[88:89], v[86:87], v[84:85] op_sel_hi:[1,0]
 v_pk_fma_f32 v[88:89], v[86:87], v[84:85], v[88:89] op_sel:[1,1,0] op_sel_hi:[0,1,1] neg_lo:[1,0,0]
 v_pk_mul_f32 v[110:111], v[94:95], v[88:89] op_sel_hi:[1,0]
 v_pk_fma_f32 v[110:111], v[94:95], v[88:89], v[110:111] op_sel:[1,1,0] op_sel_hi:[0,1,1] neg_lo:[1,0,0]
 v_cvt_pk_bf16_f32 v116, v110, -v111
 ds_write_b32 v6, v116 offset:5168
 v_pk_mul_f32 v[86:87], v[88:89], v[84:85] op_sel_hi:[1,0]
 v_pk_fma_f32 v[86:87], v[88:89], v[84:85], v[86:87] op_sel:[1,1,0] op_sel_hi:[0,1,1] neg_lo:[1,0,0]
 v_pk_mul_f32 v[110:111], v[94:95], v[86:87] op_sel_hi:[1,0]
 v_pk_fma_f32 v[110:111], v[94:95], v[86:87], v[110:111] op_sel:[1,1,0] op_sel_hi:[0,1,1] neg_lo:[1,0,0]
 v_cvt_pk_bf16_f32 v117, v110, -v111
 ds_write_b32 v6, v117 offset:5440
 s_waitcnt lgkmcnt(0)
 ds_read_b128 v[176:179], v7 offset:0
 ds_read_b128 v[160:163], v7 offset:5712
 ds_read_b128 v[180:183], v7 offset:32
 ds_read_b128 v[164:167], v7 offset:5744
 ds_read_b128 v[184:187], v7 offset:64
 ds_read_b128 v[168:171], v7 offset:5776
 ds_read_b128 v[188:191], v7 offset:96
 ds_read_b128 v[172:175], v7 offset:5808
 s_waitcnt lgkmcnt(6)
 v_mfma_f32_32x32x16_bf16 v[128:143], v[176:179], v[160:163], 0
 s_waitcnt lgkmcnt(4)
 v_mfma_f32_32x32x16_bf16 v[128:143], v[180:183], v[164:167], v[128:143]
 s_waitcnt lgkmcnt(2)
 v_mfma_f32_32x32x16_bf16 v[128:143], v[184:187], v[168:171], v[128:143]
 s_waitcnt lgkmcnt(0)
 v_mfma_f32_32x32x16_bf16 v[128:143], v[188:191], v[172:175], v[128:143]
 ds_read_b128 v[176:179], v7 offset:128
 ds_read_b128 v[160:163], v7 offset:5840
 ds_read_b128 v[180:183], v7 offset:160
 ds_read_b128 v[164:167], v7 offset:5872
 ds_read_b128 v[184:187], v7 offset:192
 ds_read_b128 v[168:171], v7 offset:5904
 ds_read_b128 v[188:191], v7 offset:224
 ds_read_b128 v[172:175], v7 offset:5936
 s_waitcnt lgkmcnt(6)
 v_mfma_f32_32x32x16_bf16 v[128:143], v[176:179], v[160:163], v[128:143]
 s_waitcnt lgkmcnt(4)
 v_mfma_f32_32x32x16_bf16 v[128:143], v[180:183], v[164:167], v[128:143]
 s_waitcnt lgkmcnt(2)
 v_mfma_f32_32x32x16_bf16 v[128:143], v[184:187], v[168:171], v[128:143]
 s_waitcnt lgkmcnt(0)
 v_mfma_f32_32x32x16_bf16 v[128:143], v[188:191], v[172:175], v[128:143]
 v_and_b32 v76, 0xffff0000, v16
 v_and_b32 v77, 0xffff0000, v17
 v_and_b32 v90, 0xffff0000, v18
 v_and_b32 v91, 0xffff0000, v19
 v_and_b32 v92, 0xffff0000, v20
 v_and_b32 v93, 0xffff0000, v21
 v_mul_f32 v76, v15, v76
 v_mul_f32 v77, v15, v77
 v_mul_f32 v90, v15, v90
 v_mul_f32 v91, v15, v91
 v_mul_f32 v76, 0x3fb8aa3b, v76
 v_mul_f32 v77, 0.15915494, v77
 v_pk_mul_f32 v[94:95], v[92:93], v[90:91] op_sel_hi:[1,0]
 v_pk_fma_f32 v[94:95], v[92:93], v[90:91], v[94:95] op_sel:[1,1,0] op_sel_hi:[0,1,1] neg_lo:[1,0,0]
 v_mul_f32 v2, 0x3f800000, v76
 v_mul_f32 v3, 0x3f800000, v77
 v_exp_f32 v2, v2
 v_fract_f32 v3, v3
 v_cos_f32 v80, v3
 v_sin_f32 v81, v3
 s_nop 0
 v_pk_mul_f32 v[80:81], v[80:81], v[2:3] op_sel_hi:[1,0]
 v_mul_f32 v2, 0x41000000, v76
 v_mul_f32 v3, 0x41000000, v77
 v_exp_f32 v2, v2
 v_fract_f32 v3, v3
 v_cos_f32 v82, v3
 v_sin_f32 v83, v3
 s_nop 0
 v_pk_mul_f32 v[82:83], v[82:83], v[2:3] op_sel_hi:[1,0]
 v_mul_f32 v2, 0x43800000, v76
 v_mul_f32 v3, 0x43800000, v77
 v_exp_f32 v2, v2
 v_fract_f32 v3, v3
 v_cos_f32 v84, v3
 v_sin_f32 v85, v3
 s_nop 0
 v_pk_mul_f32 v[84:85], v[84:85], v[2:3] op_sel_hi:[1,0]
 v_mov_b32 v117, 0x3f80
 ds_write_b32 v6, v117 offset:5712
 v_cvt_pk_bf16_f32 v114, v82, v83
 ds_write_b32 v6, v114 offset:5984
 v_pk_mul_f32 v[110:111], v[82:83], v[82:83] op_sel_hi:[1,0]
 v_pk_fma_f32 v[110:111], v[82:83], v[82:83], v[110:111] op_sel:[1,1,0] op_sel_hi:[0,1,1] neg_lo:[1,0,0]
 v_cvt_pk_bf16_f32 v115, v110, v111
 ds_write_b32 v6, v115 offset:6256
 v_pk_mul_f32 v[112:113], v[110:111], v[82:83] op_sel_hi:[1,0]
 v_pk_fma_f32 v[112:113], v[110:111], v[82:83], v[112:113] op_sel:[1,1,0] op_sel_hi:[0,1,1] neg_lo:[1,0,0]
 v_cvt_pk_bf16_f32 v116, v112, v113
 ds_write_b32 v6, v116 offset:6528
 v_pk_mul_f32 v[110:111], v[112:113], v[82:83] op_sel_hi:[1,0]
 v_pk_fma_f32 v[110:111], v[112:113], v[82:83], v[110:111] op_sel:[1,1,0] op_sel_hi:[0,1,1] neg_lo:[1,0,0]
 v_cvt_pk_bf16_f32 v117, v110, v111
 ds_write_b32 v6, v117 offset:6800
 v_pk_mul_f32 v[112:113], v[110:111], v[82:83] op_sel_hi:[1,0]
 v_pk_fma_f32 v[112:113], v[110:111], v[82:83], v[112:113] op_sel:[1,1,0] op_sel_hi:[0,1,1] neg_lo:[1,0,0]
 v_cvt_pk_bf16_f32 v114, v112, v113
 ds_write_b32 v6, v114 offset:7072
 v_pk_mul_f32 v[110:111], v[112:113], v[82:83] op_sel_hi:[1,0]
 v_pk_fma_f32 v[110:111], v[112:113], v[82:83], v[110:111] op_sel:[1,1,0] op_sel_hi:[0,1,1] neg_lo:[1,0,0]
 v_cvt_pk_bf16_f32 v115, v110, v111
 ds_write_b32 v6, v115 offset:7344
 v_pk_mul_f32 v[112:113], v[110:111], v[82:83] op_sel_hi:[1,0]
 v_pk_fma_f32 v[112:113], v[110:111], v[82:83], v[112:113] op_sel:[1,1,0] op_sel_hi:[0,1,1] neg_lo:[1,0,0]
 v_cvt_pk_bf16_f32 v116, v112, v113
 ds_write_b32 v6, v116 offset:7616
 v_pk_mul_f32 v[110:111], v[112:113], v[82:83] op_sel_hi:[1,0]
 v_pk_fma_f32 v[110:111], v[112:113], v[82:83], v[110:111] op_sel:[1,1,0] op_sel_hi:[0,1,1] neg_lo:[1,0,0]
 v_cvt_pk_bf16_f32 v117, v110, v111
 ds_write_b32 v6, v117 offset:7888
 v_pk_mul_f32 v[112:113], v[110:111], v[82:83] op_sel_hi:[1,0]
 v_pk_fma_f32 v[112:113], v[110:111], v[82:83], v[112:113] op_sel:[1,1,0] op_sel_hi:[0,1,1] neg_lo:[1,0,0]
 v_cvt_pk_bf16_f32 v114, v112, v113
 ds_write_b32 v6, v114 offset:8160
 v_pk_mul_f32 v[110:111], v[112:113], v[82:83] op_sel_hi:[1,0]
 v_pk_fma_f32 v[110:111], v[112:113], v[82:83], v[110:111] op_sel:[1,1,0] op_sel_hi:[0,1,1] neg_lo:[1,0,0]
 v_cvt_pk_bf16_f32 v115, v110, v111
 ds_write_b32 v6, v115 offset:8432
 v_pk_mul_f32 v[112:113], v[110:111], v[82:83] op_sel_hi:[1,0]
 v_pk_fma_f32 v[112:113], v[110:111], v[82:83], v[112:113] op_sel:[1,1,0] op_sel_hi:[0,1,1] neg_lo:[1,0,0]
 v_cvt_pk_bf16_f32 v116, v112, v113
 ds_write_b32 v6, v116 offset:8704
 v_pk_mul_f32 v[110:111], v[112:113], v[82:83] op_sel_hi:[1,0]
 v_pk_fma_f32 v[110:111], v[112:113], v[82:83], v[110:111] op_sel:[1,1,0] op_sel_hi:[0,1,1] neg_lo:[1,0,0]
 v_cvt_pk_bf16_f32 v117, v110, v111
 ds_write_b32 v6, v117 offset:8976
 v_pk_mul_f32 v[112:113], v[110:111], v[82:83] op_sel_hi:[1,0]
 v_pk_fma_f32 v[112:113], v[110:111], v[82:83], v[112:113] op_sel:[1,1,0] op_sel_hi:[0,1,1] neg_lo:[1,0,0]
 v_cvt_pk_bf16_f32 v114, v112, v113
 ds_write_b32 v6, v114 offset:9248
 v_pk_mul_f32 v[110:111], v[112:113], v[82:83] op_sel_hi:[1,0]
 v_pk_fma_f32 v[110:111], v[112:113], v[82:83], v[110:111] op_sel:[1,1,0] op_sel_hi:[0,1,1] neg_lo:[1,0,0]
 v_cvt_pk_bf16_f32 v115, v110, v111
 ds_write_b32 v6, v115 offset:9520
 v_pk_mul_f32 v[112:113], v[110:111], v[82:83] op_sel_hi:[1,0]
 v_pk_fma_f32 v[112:113], v[110:111], v[82:83], v[112:113] op_sel:[1,1,0] op_sel_hi:[0,1,1] neg_lo:[1,0,0]
 v_cvt_pk_bf16_f32 v116, v112, v113
 ds_write_b32 v6, v116 offset:9792
 v_pk_mul_f32 v[110:111], v[112:113], v[82:83] op_sel_hi:[1,0]
 v_pk_fma_f32 v[110:111], v[112:113], v[82:83], v[110:111] op_sel:[1,1,0] op_sel_hi:[0,1,1] neg_lo:[1,0,0]
 v_cvt_pk_bf16_f32 v117, v110, v111
 ds_write_b32 v6, v117 offset:10064
 v_pk_mul_f32 v[112:113], v[110:111], v[82:83] op_sel_hi:[1,0]
 v_pk_fma_f32 v[112:113], v[110:111], v[82:83], v[112:113] op_sel:[1,1,0] op_sel_hi:[0,1,1] neg_lo:[1,0,0]
 v_cvt_pk_bf16_f32 v114, v112, v113
 ds_write_b32 v6, v114 offset:10336
 v_pk_mul_f32 v[110:111], v[112:113], v[82:83] op_sel_hi:[1,0]
 v_pk_fma_f32 v[110:111], v[112:113], v[82:83], v[110:111] op_sel:[1,1,0] op_sel_hi:[0,1,1] neg_lo:[1,0,0]
 v_cvt_pk_bf16_f32 v115, v110, v111
 ds_write_b32 v6, v115 offset:10608
 v_pk_mul_f32 v[112:113], v[110:111], v[82:83] op_sel_hi:[1,0]
 v_pk_fma_f32 v[112:113], v[110:111], v[82:83], v[112:113] op_sel:[1,1,0] op_sel_hi:[0,1,1] neg_lo:[1,0,0]
 v_cvt_pk_bf16_f32 v116, v112, v113
 ds_write_b32 v6, v116 offset:10880
 v_pk_mul_f32 v[110:111], v[112:113], v[82:83] op_sel_hi:[1,0]
 v_pk_fma_f32 v[110:111], v[112:113], v[82:83], v[110:111] op_sel:[1,1,0] op_sel_hi:[0,1,1] neg_lo:[1,0,0]
 v_cvt_pk_bf16_f32 v117, v110, v111
 ds_write_b32 v6, v117 offset:11152
 v_pk_mul_f32 v[112:113], v[110:111], v[82:83] op_sel_hi:[1,0]
 v_pk_fma_f32 v[112:113], v[110:111], v[82:83], v[112:113] op_sel:[1,1,0] op_sel_hi:[0,1,1] neg_lo:[1,0,0]
 v_cvt_pk_bf16_f32 v114, v112, v113
 ds_write_b32 v6, v114 offset:11424
 v_pk_mul_f32 v[110:111], v[112:113], v[82:83] op_sel_hi:[1,0]
 v_pk_fma_f32 v[110:111], v[112:113], v[82:83], v[110:111] op_sel:[1,1,0] op_sel_hi:[0,1,1] neg_lo:[1,0,0]
 v_cvt_pk_bf16_f32 v115, v110, v111
 ds_write_b32 v6, v115 offset:11696
 v_pk_mul_f32 v[112:113], v[110:111], v[82:83] op_sel_hi:[1,0]
 v_pk_fma_f32 v[112:113], v[110:111], v[82:83], v[112:113] op_sel:[1,1,0] op_sel_hi:[0,1,1] neg_lo:[1,0,0]
 v_cvt_pk_bf16_f32 v116, v112, v113
 ds_write_b32 v6, v116 offset:11968
 v_pk_mul_f32 v[110:111], v[112:113], v[82:83] op_sel_hi:[1,0]
 v_pk_fma_f32 v[110:111], v[112:113], v[82:83], v[110:111] op_sel:[1,1,0] op_sel_hi:[0,1,1] neg_lo:[1,0,0]
 v_cvt_pk_bf16_f32 v117, v110, v111
 ds_write_b32 v6, v117 offset:12240
 v_pk_mul_f32 v[112:113], v[110:111], v[82:83] op_sel_hi:[1,0]
 v_pk_fma_f32 v[112:113], v[110:111], v[82:83], v[112:113] op_sel:[1,1,0] op_sel_hi:[0,1,1] neg_lo:[1,0,0]
 v_cvt_pk_bf16_f32 v114, v112, v113
 ds_write_b32 v6, v114 offset:12512
 v_pk_mul_f32 v[110:111], v[112:113], v[82:83] op_sel_hi:[1,0]
 v_pk_fma_f32 v[110:111], v[112:113], v[82:83], v[110:111] op_sel:[1,1,0] op_sel_hi:[0,1,1] neg_lo:[1,0,0]
 v_cvt_pk_bf16_f32 v115, v110, v111
 ds_write_b32 v6, v115 offset:12784
 v_pk_mul_f32 v[112:113], v[110:111], v[82:83] op_sel_hi:[1,0]
 v_pk_fma_f32 v[112:113], v[110:111], v[82:83], v[112:113] op_sel:[1,1,0] op_sel_hi:[0,1,1] neg_lo:[1,0,0]
 v_cvt_pk_bf16_f32 v116, v112, v113
 ds_write_b32 v6, v116 offset:13056
 v_pk_mul_f32 v[110:111], v[112:113], v[82:83] op_sel_hi:[1,0]
 v_pk_fma_f32 v[110:111], v[112:113], v[82:83], v[110:111] op_sel:[1,1,0] op_sel_hi:[0,1,1] neg_lo:[1,0,0]
 v_cvt_pk_bf16_f32 v117, v110, v111
 ds_write_b32 v6, v117 offset:13328
 v_pk_mul_f32 v[112:113], v[110:111], v[82:83] op_sel_hi:[1,0]
 v_pk_fma_f32 v[112:113], v[110:111], v[82:83], v[112:113] op_sel:[1,1,0] op_sel_hi:[0,1,1] neg_lo:[1,0,0]
 v_cvt_pk_bf16_f32 v114, v112, v113
 ds_write_b32 v6, v114 offset:13600
 v_pk_mul_f32 v[110:111], v[112:113], v[82:83] op_sel_hi:[1,0]
 v_pk_fma_f32 v[110:111], v[112:113], v[82:83], v[110:111] op_sel:[1,1,0] op_sel_hi:[0,1,1] neg_lo:[1,0,0]
 v_cvt_pk_bf16_f32 v115, v110, v111
 ds_write_b32 v6, v115 offset:13872
 v_pk_mul_f32 v[112:113], v[110:111], v[82:83] op_sel_hi:[1,0]
 v_pk_fma_f32 v[112:113], v[110:111], v[82:83], v[112:113] op_sel:[1,1,0] op_sel_hi:[0,1,1] neg_lo:[1,0,0]
 v_cvt_pk_bf16_f32 v116, v112, v113
 ds_write_b32 v6, v116 offset:14144
 v_cvt_pk_bf16_f32 v117, v94, -v95
 ds_write_b32 v6, v117 offset:0
 v_pk_mul_f32 v[96:97], v[94:95], v[80:81] op_sel_hi:[1,0]
 v_pk_fma_f32 v[96:97], v[94:95], v[80:81], v[96:97] op_sel:[1,1,0] op_sel_hi:[0,1,1] neg_lo:[1,0,0]
 v_cvt_pk_bf16_f32 v114, v96, -v97
 ds_write_b32 v6, v114 offset:272
 v_pk_mul_f32 v[98:99], v[96:97], v[80:81] op_sel_hi:[1,0]
 v_pk_fma_f32 v[98:99], v[96:97], v[80:81], v[98:99] op_sel:[1,1,0] op_sel_hi:[0,1,1] neg_lo:[1,0,0]
 v_cvt_pk_bf16_f32 v115, v98, -v99
 ds_write_b32 v6, v115 offset:544
 v_pk_mul_f32 v[100:101], v[98:99], v[80:81] op_sel_hi:[1,0]
 v_pk_fma_f32 v[100:101], v[98:99], v[80:81], v[100:101] op_sel:[1,1,0] op_sel_hi:[0,1,1] neg_lo:[1,0,0]
 v_cvt_pk_bf16_f32 v116, v100, -v101
 ds_write_b32 v6, v116 offset:816
 v_pk_mul_f32 v[102:103], v[100:101], v[80:81] op_sel_hi:[1,0]
 v_pk_fma_f32 v[102:103], v[100:101], v[80:81], v[102:103] op_sel:[1,1,0] op_sel_hi:[0,1,1] neg_lo:[1,0,0]
 v_cvt_pk_bf16_f32 v117, v102, -v103
 ds_write_b32 v6, v117 offset:1088
 v_pk_mul_f32 v[104:105], v[102:103], v[80:81] op_sel_hi:[1,0]
 v_pk_fma_f32 v[104:105], v[102:103], v[80:81], v[104:105] op_sel:[1,1,0] op_sel_hi:[0,1,1] neg_lo:[1,0,0]
 v_cvt_pk_bf16_f32 v114, v104, -v105
 ds_write_b32 v6, v114 offset:1360
 v_pk_mul_f32 v[106:107], v[104:105], v[80:81] op_sel_hi:[1,0]
 v_pk_fma_f32 v[106:107], v[104:105], v[80:81], v[106:107] op_sel:[1,1,0] op_sel_hi:[0,1,1] neg_lo:[1,0,0]
 v_cvt_pk_bf16_f32 v115, v106, -v107
 ds_write_b32 v6, v115 offset:1632
 v_pk_mul_f32 v[108:109], v[106:107], v[80:81] op_sel_hi:[1,0]
 v_pk_fma_f32 v[108:109], v[106:107], v[80:81], v[108:109] op_sel:[1,1,0] op_sel_hi:[0,1,1] neg_lo:[1,0,0]
 v_cvt_pk_bf16_f32 v116, v108, -v109
 ds_write_b32 v6, v116 offset:1904
 v_pk_mul_f32 v[110:111], v[94:95], v[84:85] op_sel_hi:[1,0]
 v_pk_fma_f32 v[110:111], v[94:95], v[84:85], v[110:111] op_sel:[1,1,0] op_sel_hi:[0,1,1] neg_lo:[1,0,0]
 v_cvt_pk_bf16_f32 v117, v110, -v111
 ds_write_b32 v6, v117 offset:2176
 v_pk_mul_f32 v[112:113], v[98:99], v[84:85] op_sel_hi:[1,0]
 v_pk_fma_f32 v[112:113], v[98:99], v[84:85], v[112:113] op_sel:[1,1,0] op_sel_hi:[0,1,1] neg_lo:[1,0,0]
 v_cvt_pk_bf16_f32 v114, v112, -v113
 ds_write_b32 v6, v114 offset:2448
 v_pk_mul_f32 v[110:111], v[102:103], v[84:85] op_sel_hi:[1,0]
 v_pk_fma_f32 v[110:111], v[102:103], v[84:85], v[110:111] op_sel:[1,1,0] op_sel_hi:[0,1,1] neg_lo:[1,0,0]
 v_cvt_pk_bf16_f32 v115, v110, -v111
 ds_write_b32 v6, v115 offset:2720
 v_pk_mul_f32 v[112:113], v[106:107], v[84:85] op_sel_hi:[1,0]
 v_pk_fma_f32 v[112:113], v[106:107], v[84:85], v[112:113] op_sel:[1,1,0] op_sel_hi:[0,1,1] neg_lo:[1,0,0]
 v_cvt_pk_bf16_f32 v116, v112, -v113
 ds_write_b32 v6, v116 offset:2992
 v_pk_mul_f32 v[86:87], v[84:85], v[84:85] op_sel_hi:[1,0]
 v_pk_fma_f32 v[86:87], v[84:85], v[84:85], v[86:87] op_sel:[1,1,0] op_sel_hi:[0,1,1] neg_lo:[1,0,0]
 v_pk_mul_f32 v[110:111], v[94:95], v[86:87] op_sel_hi:[1,0]
 v_pk_fma_f32 v[110:111], v[94:95], v[86:87], v[110:111] op_sel:[1,1,0] op_sel_hi:[0,1,1] neg_lo:[1,0,0]
 v_cvt_pk_bf16_f32 v117, v110, -v111
 ds_write_b32 v6, v117 offset:3264
 v_pk_mul_f32 v[112:113], v[102:103], v[86:87] op_sel_hi:[1,0]
 v_pk_fma_f32 v[112:113], v[102:103], v[86:87], v[112:113] op_sel:[1,1,0] op_sel_hi:[0,1,1] neg_lo:[1,0,0]
 v_cvt_pk_bf16_f32 v114, v112, -v113
 ds_write_b32 v6, v114 offset:3536
 v_pk_mul_f32 v[88:89], v[86:87], v[84:85] op_sel_hi:[1,0]
 v_pk_fma_f32 v[88:89], v[86:87], v[84:85], v[88:89] op_sel:[1,1,0] op_sel_hi:[0,1,1] neg_lo:[1,0,0]
 v_pk_mul_f32 v[110:111], v[94:95], v[88:89] op_sel_hi:[1,0]
 v_pk_fma_f32 v[110:111], v[94:95], v[88:89], v[110:111] op_sel:[1,1,0] op_sel_hi:[0,1,1] neg_lo:[1,0,0]
 v_cvt_pk_bf16_f32 v115, v110, -v111
 ds_write_b32 v6, v115 offset:3808
 v_pk_mul_f32 v[112:113], v[102:103], v[88:89] op_sel_hi:[1,0]
 v_pk_fma_f32 v[112:113], v[102:103], v[88:89], v[112:113] op_sel:[1,1,0] op_sel_hi:[0,1,1] neg_lo:[1,0,0]
 v_cvt_pk_bf16_f32 v116, v112, -v113
 ds_write_b32 v6, v116 offset:4080
 v_pk_mul_f32 v[86:87], v[88:89], v[84:85] op_sel_hi:[1,0]
 v_pk_fma_f32 v[86:87], v[88:89], v[84:85], v[86:87] op_sel:[1,1,0] op_sel_hi:[0,1,1] neg_lo:[1,0,0]
 v_pk_mul_f32 v[110:111], v[94:95], v[86:87] op_sel_hi:[1,0]
 v_pk_fma_f32 v[110:111], v[94:95], v[86:87], v[110:111] op_sel:[1,1,0] op_sel_hi:[0,1,1] neg_lo:[1,0,0]
 v_cvt_pk_bf16_f32 v117, v110, -v111
 ds_write_b32 v6, v117 offset:4352
 v_pk_mul_f32 v[88:89], v[86:87], v[84:85] op_sel_hi:[1,0]
 v_pk_fma_f32 v[88:89], v[86:87], v[84:85], v[88:89] op_sel:[1,1,0] op_sel_hi:[0,1,1] neg_lo:[1,0,0]
 v_pk_mul_f32 v[110:111], v[94:95], v[88:89] op_sel_hi:[1,0]
 v_pk_fma_f32 v[110:111], v[94:95], v[88:89], v[110:111] op_sel:[1,1,0] op_sel_hi:[0,1,1] neg_lo:[1,0,0]
 v_cvt_pk_bf16_f32 v114, v110, -v111
 ds_write_b32 v6, v114 offset:4624
 v_pk_mul_f32 v[86:87], v[88:89], v[84:85] op_sel_hi:[1,0]
 v_pk_fma_f32 v[86:87], v[88:89], v[84:85], v[86:87] op_sel:[1,1,0] op_sel_hi:[0,1,1] neg_lo:[1,0,0]
 v_pk_mul_f32 v[110:111], v[94:95], v[86:87] op_sel_hi:[1,0]
 v_pk_fma_f32 v[110:111], v[94:95], v[86:87], v[110:111] op_sel:[1,1,0] op_sel_hi:[0,1,1] neg_lo:[1,0,0]
 v_cvt_pk_bf16_f32 v115, v110, -v111
 ds_write_b32 v6, v115 offset:4896
 v_pk_mul_f32 v[88:89], v[86:87], v[84:85] op_sel_hi:[1,0]
 v_pk_fma_f32 v[88:89], v[86:87], v[84:85], v[88:89] op_sel:[1,1,0] op_sel_hi:[0,1,1] neg_lo:[1,0,0]
 v_pk_mul_f32 v[110:111], v[94:95], v[88:89] op_sel_hi:[1,0]
 v_pk_fma_f32 v[110:111], v[94:95], v[88:89], v[110:111] op_sel:[1,1,0] op_sel_hi:[0,1,1] neg_lo:[1,0,0]
 v_cvt_pk_bf16_f32 v116, v110, -v111
 ds_write_b32 v6, v116 offset:5168
 v_pk_mul_f32 v[86:87], v[88:89], v[84:85] op_sel_hi:[1,0]
 v_pk_fma_f32 v[86:87], v[88:89], v[84:85], v[86:87] op_sel:[1,1,0] op_sel_hi:[0,1,1] neg_lo:[1,0,0]
 v_pk_mul_f32 v[110:111], v[94:95], v[86:87] op_sel_hi:[1,0]
 v_pk_fma_f32 v[110:111], v[94:95], v[86:87], v[110:111] op_sel:[1,1,0] op_sel_hi:[0,1,1] neg_lo:[1,0,0]
 v_cvt_pk_bf16_f32 v117, v110, -v111
 ds_write_b32 v6, v117 offset:5440
 s_waitcnt lgkmcnt(0)
 ds_read_b128 v[176:179], v7 offset:0
 ds_read_b128 v[160:163], v7 offset:5712
 ds_read_b128 v[180:183], v7 offset:32
 ds_read_b128 v[164:167], v7 offset:5744
 ds_read_b128 v[184:187], v7 offset:64
 ds_read_b128 v[168:171], v7 offset:5776
 ds_read_b128 v[188:191], v7 offset:96
 ds_read_b128 v[172:175], v7 offset:5808
 s_waitcnt lgkmcnt(6)
 v_mfma_f32_32x32x16_bf16 v[128:143], v[176:179], v[160:163], v[128:143]
 s_waitcnt lgkmcnt(4)
 v_mfma_f32_32x32x16_bf16 v[128:143], v[180:183], v[164:167], v[128:143]
 s_waitcnt lgkmcnt(2)
 v_mfma_f32_32x32x16_bf16 v[128:143], v[184:187], v[168:171], v[128:143]
 s_waitcnt lgkmcnt(0)
 v_mfma_f32_32x32x16_bf16 v[128:143], v[188:191], v[172:175], v[128:143]
 ds_read_b128 v[176:179], v7 offset:128
 ds_read_b128 v[160:163], v7 offset:5840
 ds_read_b128 v[180:183], v7 offset:160
 ds_read_b128 v[164:167], v7 offset:5872
 ds_read_b128 v[184:187], v7 offset:192
 ds_read_b128 v[168:171], v7 offset:5904
 ds_read_b128 v[188:191], v7 offset:224
 ds_read_b128 v[172:175], v7 offset:5936
 s_waitcnt lgkmcnt(6)
 v_mfma_f32_32x32x16_bf16 v[128:143], v[176:179], v[160:163], v[128:143]
 s_waitcnt lgkmcnt(4)
 v_mfma_f32_32x32x16_bf16 v[128:143], v[180:183], v[164:167], v[128:143]
 s_waitcnt lgkmcnt(2)
 v_mfma_f32_32x32x16_bf16 v[128:143], v[184:187], v[168:171], v[128:143]
 s_waitcnt lgkmcnt(0)
 v_mfma_f32_32x32x16_bf16 v[128:143], v[188:191], v[172:175], v[128:143]
 v_perm_b32 v176, v194, v192, s69
 v_perm_b32 v177, v198, v196, s69
 ds_write_b64 v14, v[176:177] offset:19200
 v_perm_b32 v178, v202, v200, s69
 v_perm_b32 v179, v206, v204, s69
 ds_write_b64 v14, v[178:179] offset:19216
 v_perm_b32 v180, v210, v208, s69
 v_perm_b32 v181, v214, v212, s69
 ds_write_b64 v14, v[180:181] offset:19232
 v_perm_b32 v182, v218, v216, s69
 v_perm_b32 v183, v222, v220, s69
 ds_write_b64 v14, v[182:183] offset:19248
 v_perm_b32 v184, v226, v224, s69
 v_perm_b32 v185, v230, v228, s69
 ds_write_b64 v14, v[184:185] offset:21760
 v_perm_b32 v186, v234, v232, s69
 v_perm_b32 v187, v238, v236, s69
 ds_write_b64 v14, v[186:187] offset:21776
 v_perm_b32 v188, v242, v240, s69
 v_perm_b32 v189, v246, v244, s69
 ds_write_b64 v14, v[188:189] offset:21792
 v_perm_b32 v190, v250, v248, s69
 v_perm_b32 v191, v254, v252, s69
 ds_write_b64 v14, v[190:191] offset:21808
 ds_write_b32 v8, v128 offset:24320
 ds_write_b32 v8, v129 offset:24324
 ds_write_b32 v8, v130 offset:24328
 ds_write_b32 v8, v131 offset:24332
 s_mov_b64 exec, 0xffffffff
 ds_write_b32 v9, v132 offset:25344
 ds_write_b32 v10, v136 offset:26368
 ds_write_b32 v9, v133 offset:25348
 ds_write_b32 v10, v137 offset:26496
 ds_write_b32 v9, v134 offset:25352
 ds_write_b32 v10, v138 offset:26624
 ds_write_b32 v9, v135 offset:25356
 ds_write_b32 v10, v139 offset:26752
 s_not_b64 exec, exec
 ds_write_b32 v9, v132 offset:25856
 ds_write_b32 v9, v133 offset:25860
 ds_write_b32 v9, v134 offset:26112
 ds_write_b32 v9, v135 offset:26116
 ds_write_b32 v10, v136 offset:26880
 s_mov_b64 exec, -1
 s_waitcnt lgkmcnt(0)
 ds_read_b32 v76, v40
 ds_read_b32 v77, v41
 ds_read_b32 v78, v42
 ds_read_b32 v79, v43
 ds_read_b32 v80, v44
 ds_read_b32 v81, v45
 ds_read_b32 v82, v46
 ds_read_b32 v83, v47
 ds_read_b32 v84, v48
 ds_read_b32 v85, v49
 ds_read_b32 v86, v50
 ds_read_b32 v87, v51
 s_waitcnt lgkmcnt(0)
 ds_read_b32 v88, v52
 ds_read_b32 v89, v53
 ds_read_b32 v90, v54
 ds_read_b32 v91, v55
 ds_read_b32 v92, v56
 ds_read_b32 v93, v57
 ds_read_b32 v94, v58
 ds_read_b32 v95, v59
 ds_read_b32 v96, v60
 ds_read_b32 v97, v61
 ds_read_b32 v98, v62
 ds_read_b32 v99, v63
 s_waitcnt lgkmcnt(0)
 ds_read_b32 v100, v64
 ds_read_b32 v101, v65
 ds_read_b32 v102, v66
 ds_read_b32 v103, v67
 ds_read_b32 v104, v68
 ds_read_b32 v105, v69
 ds_read_b32 v106, v70
 ds_read_b32 v107, v71
 ds_read_b32 v108, v72
 ds_read_b32 v109, v73
 ds_read_b32 v110, v74
 s_waitcnt lgkmcnt(0)
 v_cvt_pk_bf16_f32 v160, v79, v80
 v_cvt_pk_bf16_f32 v161, v81, v82
 v_cvt_pk_bf16_f32 v162, v83, v84
 v_cvt_pk_bf16_f32 v163, v85, v86
 ds_write_b128 v11, v[160:163] offset:0
 v_cvt_pk_bf16_f32 v164, v87, v88
 v_cvt_pk_bf16_f32 v165, v89, v90
 v_cvt_pk_bf16_f32 v166, v91, v92
 v_cvt_pk_bf16_f32 v167, v93, v94
 ds_write_b128 v11, v[164:167] offset:16
 v_cvt_pk_bf16_f32 v168, v95, v96
 v_cvt_pk_bf16_f32 v169, v97, v98
 v_cvt_pk_bf16_f32 v170, v99, v100
 v_cvt_pk_bf16_f32 v171, v101, v102
 ds_write_b128 v11, v[168:171] offset:32
 v_cvt_pk_bf16_f32 v172, v103, v104
 v_cvt_pk_bf16_f32 v173, v105, v106
 v_cvt_pk_bf16_f32 v174, v107, v108
 v_cvt_pk_bf16_f32 v175, v109, v110
 ds_write_b128 v11, v[172:175] offset:48
 v_cvt_pk_bf16_f32 v176, v78, v79
 v_cvt_pk_bf16_f32 v177, v80, v81
 v_cvt_pk_bf16_f32 v178, v82, v83
 v_cvt_pk_bf16_f32 v179, v84, v85
 ds_write_b128 v11, v[176:179] offset:4160
 v_cvt_pk_bf16_f32 v180, v86, v87
 v_cvt_pk_bf16_f32 v181, v88, v89
 v_cvt_pk_bf16_f32 v182, v90, v91
 v_cvt_pk_bf16_f32 v183, v92, v93
 ds_write_b128 v11, v[180:183] offset:4176
 v_cvt_pk_bf16_f32 v184, v94, v95
 v_cvt_pk_bf16_f32 v185, v96, v97
 v_cvt_pk_bf16_f32 v186, v98, v99
 v_cvt_pk_bf16_f32 v187, v100, v101
 ds_write_b128 v11, v[184:187] offset:4192
 v_cvt_pk_bf16_f32 v188, v102, v103
 v_cvt_pk_bf16_f32 v189, v104, v105
 v_cvt_pk_bf16_f32 v190, v106, v107
 v_cvt_pk_bf16_f32 v191, v108, v109
 ds_write_b128 v11, v[188:191] offset:4208
 v_cvt_pk_bf16_f32 v160, v77, v78
 v_cvt_pk_bf16_f32 v161, v79, v80
 v_cvt_pk_bf16_f32 v162, v81, v82
 v_cvt_pk_bf16_f32 v163, v83, v84
 ds_write_b128 v11, v[160:163] offset:8320
 v_cvt_pk_bf16_f32 v164, v85, v86
 v_cvt_pk_bf16_f32 v165, v87, v88
 v_cvt_pk_bf16_f32 v166, v89, v90
 v_cvt_pk_bf16_f32 v167, v91, v92
 ds_write_b128 v11, v[164:167] offset:8336
 v_cvt_pk_bf16_f32 v168, v93, v94
 v_cvt_pk_bf16_f32 v169, v95, v96
 v_cvt_pk_bf16_f32 v170, v97, v98
 v_cvt_pk_bf16_f32 v171, v99, v100
 ds_write_b128 v11, v[168:171] offset:8352
 v_cvt_pk_bf16_f32 v172, v101, v102
 v_cvt_pk_bf16_f32 v173, v103, v104
 v_cvt_pk_bf16_f32 v174, v105, v106
 v_cvt_pk_bf16_f32 v175, v107, v108
 ds_write_b128 v11, v[172:175] offset:8368
 v_cvt_pk_bf16_f32 v176, v76, v77
 v_cvt_pk_bf16_f32 v177, v78, v79
 v_cvt_pk_bf16_f32 v178, v80, v81
 v_cvt_pk_bf16_f32 v179, v82, v83
 ds_write_b128 v11, v[176:179] offset:12480
 v_cvt_pk_bf16_f32 v180, v84, v85
 v_cvt_pk_bf16_f32 v181, v86, v87
 v_cvt_pk_bf16_f32 v182, v88, v89
 v_cvt_pk_bf16_f32 v183, v90, v91
 ds_write_b128 v11, v[180:183] offset:12496
 v_cvt_pk_bf16_f32 v184, v92, v93
 v_cvt_pk_bf16_f32 v185, v94, v95
 v_cvt_pk_bf16_f32 v186, v96, v97
 v_cvt_pk_bf16_f32 v187, v98, v99
 ds_write_b128 v11, v[184:187] offset:12512
 v_cvt_pk_bf16_f32 v188, v100, v101
 v_cvt_pk_bf16_f32 v189, v102, v103
 v_cvt_pk_bf16_f32 v190, v104, v105
 v_cvt_pk_bf16_f32 v191, v106, v107
 ds_write_b128 v11, v[188:191] offset:12528
 v_mov_b32 v2, 0
 v_lshrrev_b32 v3, 4, v0
 v_mul_u32_u24 v3, 4096, v3
 v_add_u32 v3, v3, v6
 ds_write_b32 v3, v2 offset:4096
 s_lshl_b32 s61, s66, 16
 v_perm_b32 v128, v192, v192, s68
 v_mul_f32 v128, s61, v128
 v_perm_b32 v129, v194, v194, s68
 v_mul_f32 v129, s61, v129
 v_perm_b32 v130, v196, v196, s68
 v_mul_f32 v130, s61, v130
 v_perm_b32 v131, v198, v198, s68
 v_mul_f32 v131, s61, v131
 v_perm_b32 v132, v200, v200, s68
 v_mul_f32 v132, s61, v132
 v_perm_b32 v133, v202, v202, s68
 v_mul_f32 v133, s61, v133
 v_perm_b32 v134, v204, v204, s68
 v_mul_f32 v134, s61, v134
 v_perm_b32 v135, v206, v206, s68
 v_mul_f32 v135, s61, v135
 v_perm_b32 v136, v208, v208, s68
 v_mul_f32 v136, s61, v136
 v_perm_b32 v137, v210, v210, s68
 v_mul_f32 v137, s61, v137
 v_perm_b32 v138, v212, v212, s68
 v_mul_f32 v138, s61, v138
 v_perm_b32 v139, v214, v214, s68
 v_mul_f32 v139, s61, v139
 v_perm_b32 v140, v216, v216, s68
 v_mul_f32 v140, s61, v140
 v_perm_b32 v141, v218, v218, s68
 v_mul_f32 v141, s61, v141
 v_perm_b32 v142, v220, v220, s68
 v_mul_f32 v142, s61, v142
 v_perm_b32 v143, v222, v222, s68
 v_mul_f32 v143, s61, v143
 v_perm_b32 v144, v224, v224, s68
 v_mul_f32 v144, s61, v144
 v_perm_b32 v145, v226, v226, s68
 v_mul_f32 v145, s61, v145
 v_perm_b32 v146, v228, v228, s68
 v_mul_f32 v146, s61, v146
 v_perm_b32 v147, v230, v230, s68
 v_mul_f32 v147, s61, v147
 v_perm_b32 v148, v232, v232, s68
 v_mul_f32 v148, s61, v148
 v_perm_b32 v149, v234, v234, s68
 v_mul_f32 v149, s61, v149
 v_perm_b32 v150, v236, v236, s68
 v_mul_f32 v150, s61, v150
 v_perm_b32 v151, v238, v238, s68
 v_mul_f32 v151, s61, v151
 v_perm_b32 v152, v240, v240, s68
 v_mul_f32 v152, s61, v152
 v_perm_b32 v153, v242, v242, s68
 v_mul_f32 v153, s61, v153
 v_perm_b32 v154, v244, v244, s68
 v_mul_f32 v154, s61, v154
 v_perm_b32 v155, v246, v246, s68
 v_mul_f32 v155, s61, v155
 v_perm_b32 v156, v248, v248, s68
 v_mul_f32 v156, s61, v156
 v_perm_b32 v157, v250, v250, s68
 v_mul_f32 v157, s61, v157
 v_perm_b32 v158, v252, v252, s68
 v_mul_f32 v158, s61, v158
 v_perm_b32 v159, v254, v254, s68
 v_mul_f32 v159, s61, v159
 s_waitcnt lgkmcnt(0)
 ds_read_b128 v[160:163], v13 offset:21680
 ds_read_b64 v[176:177], v12 offset:4032
 ds_read_b64 v[178:179], v12 offset:4040
 ds_read_b128 v[164:167], v13 offset:21712
 ds_read_b64 v[180:181], v12 offset:4064
 ds_read_b64 v[182:183], v12 offset:4072
 ds_read_b128 v[168:171], v13 offset:21600
 ds_read_b64 v[184:185], v12 offset:3968
 ds_read_b64 v[186:187], v12 offset:3976
 ds_read_b128 v[172:175], v13 offset:21632
 ds_read_b64 v[188:189], v12 offset:4000
 ds_read_b64 v[190:191], v12 offset:4008
 s_waitcnt lgkmcnt(9)
 v_mfma_f32_32x32x16_bf16 v[144:159], v[176:179], v[160:163], v[144:159]
 ds_read_b128 v[160:163], v13 offset:21520
 ds_read_b64 v[176:177], v12 offset:3904
 ds_read_b64 v[178:179], v12 offset:3912
 s_waitcnt lgkmcnt(9)
 v_mfma_f32_32x32x16_bf16 v[144:159], v[180:183], v[164:167], v[144:159]
 ds_read_b128 v[164:167], v13 offset:21552
 ds_read_b64 v[180:181], v12 offset:3936
 ds_read_b64 v[182:183], v12 offset:3944
 s_waitcnt lgkmcnt(9)
 v_mfma_f32_32x32x16_bf16 v[144:159], v[184:187], v[168:171], v[144:159]
 ds_read_b128 v[168:171], v13 offset:21440
 ds_read_b64 v[184:185], v12 offset:3840
 ds_read_b64 v[186:187], v12 offset:3848
 s_waitcnt lgkmcnt(9)
 v_mfma_f32_32x32x16_bf16 v[144:159], v[188:191], v[172:175], v[144:159]
 ds_read_b128 v[172:175], v13 offset:21472
 ds_read_b64 v[188:189], v12 offset:3872
 ds_read_b64 v[190:191], v12 offset:3880
 s_waitcnt lgkmcnt(9)
 v_mfma_f32_32x32x16_bf16 v[144:159], v[176:179], v[160:163], v[144:159]
 ds_read_b128 v[160:163], v13 offset:21360
 ds_read_b64 v[176:177], v12 offset:3776
 ds_read_b64 v[178:179], v12 offset:3784
 s_waitcnt lgkmcnt(9)
 v_mfma_f32_32x32x16_bf16 v[144:159], v[180:183], v[164:167], v[144:159]
 ds_read_b128 v[164:167], v13 offset:21392
 ds_read_b64 v[180:181], v12 offset:3808
 ds_read_b64 v[182:183], v12 offset:3816
 s_waitcnt lgkmcnt(9)
 v_mfma_f32_32x32x16_bf16 v[144:159], v[184:187], v[168:171], v[144:159]
 ds_read_b128 v[168:171], v13 offset:21280
 ds_read_b64 v[184:185], v12 offset:3712
 ds_read_b64 v[186:187], v12 offset:3720
 s_waitcnt lgkmcnt(9)
 v_mfma_f32_32x32x16_bf16 v[144:159], v[188:191], v[172:175], v[144:159]
 ds_read_b128 v[172:175], v13 offset:21312
 ds_read_b64 v[188:189], v12 offset:3744
 ds_read_b64 v[190:191], v12 offset:3752
 s_waitcnt lgkmcnt(9)
 v_mfma_f32_32x32x16_bf16 v[144:159], v[176:179], v[160:163], v[144:159]
 ds_read_b128 v[160:163], v13 offset:21200
 ds_read_b64 v[176:177], v12 offset:3648
 ds_read_b64 v[178:179], v12 offset:3656
 s_waitcnt lgkmcnt(9)
 v_mfma_f32_32x32x16_bf16 v[144:159], v[180:183], v[164:167], v[144:159]
 ds_read_b128 v[164:167], v13 offset:21232
 ds_read_b64 v[180:181], v12 offset:3680
 ds_read_b64 v[182:183], v12 offset:3688
 s_waitcnt lgkmcnt(9)
 v_mfma_f32_32x32x16_bf16 v[144:159], v[184:187], v[168:171], v[144:159]
 ds_read_b128 v[168:171], v13 offset:21120
 ds_read_b64 v[184:185], v12 offset:3584
 ds_read_b64 v[186:187], v12 offset:3592
 s_waitcnt lgkmcnt(9)
 v_mfma_f32_32x32x16_bf16 v[144:159], v[188:191], v[172:175], v[144:159]
 ds_read_b128 v[172:175], v13 offset:21152
 ds_read_b64 v[188:189], v12 offset:3616
 ds_read_b64 v[190:191], v12 offset:3624
 s_waitcnt lgkmcnt(9)
 v_mfma_f32_32x32x16_bf16 v[144:159], v[176:179], v[160:163], v[144:159]
 ds_read_b128 v[160:163], v13 offset:21040
 ds_read_b64 v[176:177], v12 offset:3520
 ds_read_b64 v[178:179], v12 offset:3528
 s_waitcnt lgkmcnt(9)
 v_mfma_f32_32x32x16_bf16 v[144:159], v[180:183], v[164:167], v[144:159]
 ds_read_b128 v[164:167], v13 offset:21072
 ds_read_b64 v[180:181], v12 offset:3552
 ds_read_b64 v[182:183], v12 offset:3560
 s_waitcnt lgkmcnt(9)
 v_mfma_f32_32x32x16_bf16 v[144:159], v[184:187], v[168:171], v[144:159]
 ds_read_b128 v[168:171], v13 offset:20960
 ds_read_b64 v[184:185], v12 offset:3456
 ds_read_b64 v[186:187], v12 offset:3464
 s_waitcnt lgkmcnt(9)
 v_mfma_f32_32x32x16_bf16 v[144:159], v[188:191], v[172:175], v[144:159]
 ds_read_b128 v[172:175], v13 offset:20992
 ds_read_b64 v[188:189], v12 offset:3488
 ds_read_b64 v[190:191], v12 offset:3496
 s_waitcnt lgkmcnt(9)
 v_mfma_f32_32x32x16_bf16 v[144:159], v[176:179], v[160:163], v[144:159]
 ds_read_b128 v[160:163], v13 offset:20880
 ds_read_b64 v[176:177], v12 offset:3392
 ds_read_b64 v[178:179], v12 offset:3400
 s_waitcnt lgkmcnt(9)
 v_mfma_f32_32x32x16_bf16 v[144:159], v[180:183], v[164:167], v[144:159]
 ds_read_b128 v[164:167], v13 offset:20912
 ds_read_b64 v[180:181], v12 offset:3424
 ds_read_b64 v[182:183], v12 offset:3432
 s_waitcnt lgkmcnt(9)
 v_mfma_f32_32x32x16_bf16 v[144:159], v[184:187], v[168:171], v[144:159]
 ds_read_b128 v[168:171], v13 offset:20800
 ds_read_b64 v[184:185], v12 offset:3328
 ds_read_b64 v[186:187], v12 offset:3336
 s_waitcnt lgkmcnt(9)
 v_mfma_f32_32x32x16_bf16 v[144:159], v[188:191], v[172:175], v[144:159]
 ds_read_b128 v[172:175], v13 offset:20832
 ds_read_b64 v[188:189], v12 offset:3360
 ds_read_b64 v[190:191], v12 offset:3368
 s_waitcnt lgkmcnt(9)
 v_mfma_f32_32x32x16_bf16 v[144:159], v[176:179], v[160:163], v[144:159]
 ds_read_b128 v[160:163], v13 offset:20720
 ds_read_b64 v[176:177], v12 offset:3264
 ds_read_b64 v[178:179], v12 offset:3272
 s_waitcnt lgkmcnt(9)
 v_mfma_f32_32x32x16_bf16 v[144:159], v[180:183], v[164:167], v[144:159]
 ds_read_b128 v[164:167], v13 offset:20752
 ds_read_b64 v[180:181], v12 offset:3296
 ds_read_b64 v[182:183], v12 offset:3304
 s_waitcnt lgkmcnt(9)
 v_mfma_f32_32x32x16_bf16 v[144:159], v[184:187], v[168:171], v[144:159]
 ds_read_b128 v[168:171], v13 offset:20640
 ds_read_b64 v[184:185], v12 offset:3200
 ds_read_b64 v[186:187], v12 offset:3208
 s_waitcnt lgkmcnt(9)
 v_mfma_f32_32x32x16_bf16 v[144:159], v[188:191], v[172:175], v[144:159]
 ds_read_b128 v[172:175], v13 offset:20672
 ds_read_b64 v[188:189], v12 offset:3232
 ds_read_b64 v[190:191], v12 offset:3240
 s_waitcnt lgkmcnt(9)
 v_mfma_f32_32x32x16_bf16 v[144:159], v[176:179], v[160:163], v[144:159]
 ds_read_b128 v[160:163], v13 offset:20560
 ds_read_b64 v[176:177], v12 offset:3136
 ds_read_b64 v[178:179], v12 offset:3144
 s_waitcnt lgkmcnt(9)
 v_mfma_f32_32x32x16_bf16 v[144:159], v[180:183], v[164:167], v[144:159]
 ds_read_b128 v[164:167], v13 offset:20592
 ds_read_b64 v[180:181], v12 offset:3168
 ds_read_b64 v[182:183], v12 offset:3176
 s_waitcnt lgkmcnt(9)
 v_mfma_f32_32x32x16_bf16 v[144:159], v[184:187], v[168:171], v[144:159]
 ds_read_b128 v[168:171], v13 offset:20480
 ds_read_b64 v[184:185], v12 offset:3072
 ds_read_b64 v[186:187], v12 offset:3080
 s_waitcnt lgkmcnt(9)
 v_mfma_f32_32x32x16_bf16 v[144:159], v[188:191], v[172:175], v[144:159]
 ds_read_b128 v[172:175], v13 offset:20512
 ds_read_b64 v[188:189], v12 offset:3104
 ds_read_b64 v[190:191], v12 offset:3112
 s_waitcnt lgkmcnt(9)
 v_mfma_f32_32x32x16_bf16 v[144:159], v[176:179], v[160:163], v[144:159]
 ds_read_b128 v[160:163], v13 offset:20400
 ds_read_b64 v[176:177], v12 offset:3008
 ds_read_b64 v[178:179], v12 offset:3016
 s_waitcnt lgkmcnt(9)
 v_mfma_f32_32x32x16_bf16 v[144:159], v[180:183], v[164:167], v[144:159]
 ds_read_b128 v[164:167], v13 offset:20432
 ds_read_b64 v[180:181], v12 offset:3040
 ds_read_b64 v[182:183], v12 offset:3048
 s_waitcnt lgkmcnt(9)
 v_mfma_f32_32x32x16_bf16 v[144:159], v[184:187], v[168:171], v[144:159]
 ds_read_b128 v[168:171], v13 offset:20320
 ds_read_b64 v[184:185], v12 offset:2944
 ds_read_b64 v[186:187], v12 offset:2952
 s_waitcnt lgkmcnt(9)
 v_mfma_f32_32x32x16_bf16 v[144:159], v[188:191], v[172:175], v[144:159]
 ds_read_b128 v[172:175], v13 offset:20352
 ds_read_b64 v[188:189], v12 offset:2976
 ds_read_b64 v[190:191], v12 offset:2984
 s_waitcnt lgkmcnt(9)
 v_mfma_f32_32x32x16_bf16 v[144:159], v[176:179], v[160:163], v[144:159]
 ds_read_b128 v[160:163], v13 offset:20240
 ds_read_b64 v[176:177], v12 offset:2880
 ds_read_b64 v[178:179], v12 offset:2888
 s_waitcnt lgkmcnt(9)
 v_mfma_f32_32x32x16_bf16 v[144:159], v[180:183], v[164:167], v[144:159]
 ds_read_b128 v[164:167], v13 offset:20272
 ds_read_b64 v[180:181], v12 offset:2912
 ds_read_b64 v[182:183], v12 offset:2920
 s_waitcnt lgkmcnt(9)
 v_mfma_f32_32x32x16_bf16 v[144:159], v[184:187], v[168:171], v[144:159]
 ds_read_b128 v[168:171], v13 offset:20160
 ds_read_b64 v[184:185], v12 offset:2816
 ds_read_b64 v[186:187], v12 offset:2824
 s_waitcnt lgkmcnt(9)
 v_mfma_f32_32x32x16_bf16 v[144:159], v[188:191], v[172:175], v[144:159]
 ds_read_b128 v[172:175], v13 offset:20192
 ds_read_b64 v[188:189], v12 offset:2848
 ds_read_b64 v[190:191], v12 offset:2856
 s_waitcnt lgkmcnt(9)
 v_mfma_f32_32x32x16_bf16 v[144:159], v[176:179], v[160:163], v[144:159]
 ds_read_b128 v[160:163], v13 offset:20080
 ds_read_b64 v[176:177], v12 offset:2752
 ds_read_b64 v[178:179], v12 offset:2760
 s_waitcnt lgkmcnt(9)
 v_mfma_f32_32x32x16_bf16 v[144:159], v[180:183], v[164:167], v[144:159]
 ds_read_b128 v[164:167], v13 offset:20112
 ds_read_b64 v[180:181], v12 offset:2784
 ds_read_b64 v[182:183], v12 offset:2792
 s_waitcnt lgkmcnt(9)
 v_mfma_f32_32x32x16_bf16 v[144:159], v[184:187], v[168:171], v[144:159]
 ds_read_b128 v[168:171], v13 offset:20000
 ds_read_b64 v[184:185], v12 offset:2688
 ds_read_b64 v[186:187], v12 offset:2696
 s_waitcnt lgkmcnt(9)
 v_mfma_f32_32x32x16_bf16 v[144:159], v[188:191], v[172:175], v[144:159]
 ds_read_b128 v[172:175], v13 offset:20032
 ds_read_b64 v[188:189], v12 offset:2720
 ds_read_b64 v[190:191], v12 offset:2728
 s_waitcnt lgkmcnt(9)
 v_mfma_f32_32x32x16_bf16 v[144:159], v[176:179], v[160:163], v[144:159]
 ds_read_b128 v[160:163], v13 offset:19920
 ds_read_b64 v[176:177], v12 offset:2624
 ds_read_b64 v[178:179], v12 offset:2632
 s_waitcnt lgkmcnt(9)
 v_mfma_f32_32x32x16_bf16 v[144:159], v[180:183], v[164:167], v[144:159]
 ds_read_b128 v[164:167], v13 offset:19952
 ds_read_b64 v[180:181], v12 offset:2656
 ds_read_b64 v[182:183], v12 offset:2664
 s_waitcnt lgkmcnt(9)
 v_mfma_f32_32x32x16_bf16 v[144:159], v[184:187], v[168:171], v[144:159]
 ds_read_b128 v[168:171], v13 offset:19840
 ds_read_b64 v[184:185], v12 offset:2560
 ds_read_b64 v[186:187], v12 offset:2568
 s_waitcnt lgkmcnt(9)
 v_mfma_f32_32x32x16_bf16 v[144:159], v[188:191], v[172:175], v[144:159]
 ds_read_b128 v[172:175], v13 offset:19872
 ds_read_b64 v[188:189], v12 offset:2592
 ds_read_b64 v[190:191], v12 offset:2600
 s_waitcnt lgkmcnt(9)
 v_mfma_f32_32x32x16_bf16 v[144:159], v[176:179], v[160:163], v[144:159]
 ds_read_b128 v[160:163], v13 offset:19760
 ds_read_b64 v[176:177], v12 offset:2496
 ds_read_b64 v[178:179], v12 offset:2504
 s_waitcnt lgkmcnt(9)
 v_mfma_f32_32x32x16_bf16 v[144:159], v[180:183], v[164:167], v[144:159]
 ds_read_b128 v[164:167], v13 offset:19792
 ds_read_b64 v[180:181], v12 offset:2528
 ds_read_b64 v[182:183], v12 offset:2536
 s_waitcnt lgkmcnt(9)
 v_mfma_f32_32x32x16_bf16 v[144:159], v[184:187], v[168:171], v[144:159]
 ds_read_b128 v[168:171], v13 offset:19680
 ds_read_b64 v[184:185], v12 offset:2432
 ds_read_b64 v[186:187], v12 offset:2440
 s_waitcnt lgkmcnt(9)
 v_mfma_f32_32x32x16_bf16 v[144:159], v[188:191], v[172:175], v[144:159]
 ds_read_b128 v[172:175], v13 offset:19712
 ds_read_b64 v[188:189], v12 offset:2464
 ds_read_b64 v[190:191], v12 offset:2472
 s_waitcnt lgkmcnt(9)
 v_mfma_f32_32x32x16_bf16 v[144:159], v[176:179], v[160:163], v[144:159]
 ds_read_b128 v[160:163], v13 offset:19600
 ds_read_b64 v[176:177], v12 offset:2368
 ds_read_b64 v[178:179], v12 offset:2376
 s_waitcnt lgkmcnt(9)
 v_mfma_f32_32x32x16_bf16 v[144:159], v[180:183], v[164:167], v[144:159]
 ds_read_b128 v[164:167], v13 offset:19632
 ds_read_b64 v[180:181], v12 offset:2400
 ds_read_b64 v[182:183], v12 offset:2408
 s_waitcnt lgkmcnt(9)
 v_mfma_f32_32x32x16_bf16 v[144:159], v[184:187], v[168:171], v[144:159]
 ds_read_b128 v[168:171], v13 offset:19520
 ds_read_b64 v[184:185], v12 offset:2304
 ds_read_b64 v[186:187], v12 offset:2312
 s_waitcnt lgkmcnt(9)
 v_mfma_f32_32x32x16_bf16 v[144:159], v[188:191], v[172:175], v[144:159]
 ds_read_b128 v[172:175], v13 offset:19552
 ds_read_b64 v[188:189], v12 offset:2336
 ds_read_b64 v[190:191], v12 offset:2344
 s_waitcnt lgkmcnt(9)
 v_mfma_f32_32x32x16_bf16 v[144:159], v[176:179], v[160:163], v[144:159]
 ds_read_b128 v[160:163], v13 offset:19440
 ds_read_b64 v[176:177], v12 offset:2240
 ds_read_b64 v[178:179], v12 offset:2248
 s_waitcnt lgkmcnt(9)
 v_mfma_f32_32x32x16_bf16 v[144:159], v[180:183], v[164:167], v[144:159]
 ds_read_b128 v[164:167], v13 offset:19472
 ds_read_b64 v[180:181], v12 offset:2272
 ds_read_b64 v[182:183], v12 offset:2280
 s_waitcnt lgkmcnt(9)
 v_mfma_f32_32x32x16_bf16 v[144:159], v[184:187], v[168:171], v[144:159]
 ds_read_b128 v[168:171], v13 offset:19360
 ds_read_b64 v[184:185], v12 offset:2176
 ds_read_b64 v[186:187], v12 offset:2184
 s_waitcnt lgkmcnt(9)
 v_mfma_f32_32x32x16_bf16 v[144:159], v[188:191], v[172:175], v[144:159]
 ds_read_b128 v[172:175], v13 offset:19392
 ds_read_b64 v[188:189], v12 offset:2208
 ds_read_b64 v[190:191], v12 offset:2216
 s_waitcnt lgkmcnt(9)
 v_mfma_f32_32x32x16_bf16 v[144:159], v[176:179], v[160:163], v[144:159]
 ds_read_b128 v[160:163], v13 offset:19280
 ds_read_b64 v[176:177], v12 offset:2112
 ds_read_b64 v[178:179], v12 offset:2120
 s_waitcnt lgkmcnt(9)
 v_mfma_f32_32x32x16_bf16 v[144:159], v[180:183], v[164:167], v[144:159]
 ds_read_b128 v[164:167], v13 offset:19312
 ds_read_b64 v[180:181], v12 offset:2144
 ds_read_b64 v[182:183], v12 offset:2152
 s_waitcnt lgkmcnt(9)
 v_mfma_f32_32x32x16_bf16 v[144:159], v[184:187], v[168:171], v[144:159]
 ds_read_b128 v[168:171], v13 offset:19200
 ds_read_b64 v[184:185], v12 offset:2048
 ds_read_b64 v[186:187], v12 offset:2056
 s_waitcnt lgkmcnt(9)
 v_mfma_f32_32x32x16_bf16 v[144:159], v[188:191], v[172:175], v[144:159]
 ds_read_b128 v[172:175], v13 offset:19232
 ds_read_b64 v[188:189], v12 offset:2080
 ds_read_b64 v[190:191], v12 offset:2088
 s_waitcnt lgkmcnt(9)
 v_mfma_f32_32x32x16_bf16 v[144:159], v[176:179], v[160:163], v[144:159]
 ds_read_b128 v[160:163], v13 offset:19120
 ds_read_b64 v[176:177], v12 offset:1984
 ds_read_b64 v[178:179], v12 offset:1992
 s_waitcnt lgkmcnt(9)
 v_mfma_f32_32x32x16_bf16 v[144:159], v[180:183], v[164:167], v[144:159]
 ds_read_b64 v[180:181], v12 offset:4032
 ds_read_b64 v[182:183], v12 offset:4040
 s_waitcnt lgkmcnt(8)
 v_mfma_f32_32x32x16_bf16 v[144:159], v[184:187], v[168:171], v[144:159]
 ds_read_b128 v[164:167], v13 offset:19152
 ds_read_b64 v[184:185], v12 offset:2016
 ds_read_b64 v[186:187], v12 offset:2024
 s_waitcnt lgkmcnt(8)
 v_mfma_f32_32x32x16_bf16 v[144:159], v[188:191], v[172:175], v[144:159]
 ds_read_b64 v[188:189], v12 offset:4064
 ds_read_b64 v[190:191], v12 offset:4072
 s_waitcnt lgkmcnt(7)
 v_mfma_f32_32x32x16_bf16 v[144:159], v[176:179], v[160:163], v[144:159]
 ds_read_b128 v[168:171], v13 offset:19040
 ds_read_b64 v[176:177], v12 offset:1920
 ds_read_b64 v[178:179], v12 offset:1928
 s_waitcnt lgkmcnt(8)
 v_mfma_f32_32x32x16_bf16 v[128:143], v[180:183], v[160:163], v[128:143]
 ds_read_b64 v[180:181], v12 offset:3968
 ds_read_b64 v[182:183], v12 offset:3976
 s_waitcnt lgkmcnt(7)
 v_mfma_f32_32x32x16_bf16 v[144:159], v[184:187], v[164:167], v[144:159]
 ds_read_b128 v[172:175], v13 offset:19072
 ds_read_b64 v[184:185], v12 offset:1952
 ds_read_b64 v[186:187], v12 offset:1960
 s_waitcnt lgkmcnt(8)
 v_mfma_f32_32x32x16_bf16 v[128:143], v[188:191], v[164:167], v[128:143]
 ds_read_b64 v[188:189], v12 offset:4000
 ds_read_b64 v[190:191], v12 offset:4008
 s_waitcnt lgkmcnt(7)
 v_mfma_f32_32x32x16_bf16 v[144:159], v[176:179], v[168:171], v[144:159]
 ds_read_b128 v[160:163], v13 offset:18960
 ds_read_b64 v[176:177], v12 offset:1856
 ds_read_b64 v[178:179], v12 offset:1864
 s_waitcnt lgkmcnt(8)
 v_mfma_f32_32x32x16_bf16 v[128:143], v[180:183], v[168:171], v[128:143]
 ds_read_b64 v[180:181], v12 offset:3904
 ds_read_b64 v[182:183], v12 offset:3912
 s_waitcnt lgkmcnt(7)
 v_mfma_f32_32x32x16_bf16 v[144:159], v[184:187], v[172:175], v[144:159]
 ds_read_b128 v[164:167], v13 offset:18992
 ds_read_b64 v[184:185], v12 offset:1888
 ds_read_b64 v[186:187], v12 offset:1896
 s_waitcnt lgkmcnt(8)
 v_mfma_f32_32x32x16_bf16 v[128:143], v[188:191], v[172:175], v[128:143]
 ds_read_b64 v[188:189], v12 offset:3936
 ds_read_b64 v[190:191], v12 offset:3944
 s_waitcnt lgkmcnt(7)
 v_mfma_f32_32x32x16_bf16 v[144:159], v[176:179], v[160:163], v[144:159]
 ds_read_b128 v[168:171], v13 offset:18880
 ds_read_b64 v[176:177], v12 offset:1792
 ds_read_b64 v[178:179], v12 offset:1800
 s_waitcnt lgkmcnt(8)
 v_mfma_f32_32x32x16_bf16 v[128:143], v[180:183], v[160:163], v[128:143]
 ds_read_b64 v[180:181], v12 offset:3840
 ds_read_b64 v[182:183], v12 offset:3848
 s_waitcnt lgkmcnt(7)
 v_mfma_f32_32x32x16_bf16 v[144:159], v[184:187], v[164:167], v[144:159]
 ds_read_b128 v[172:175], v13 offset:18912
 ds_read_b64 v[184:185], v12 offset:1824
 ds_read_b64 v[186:187], v12 offset:1832
 s_waitcnt lgkmcnt(8)
 v_mfma_f32_32x32x16_bf16 v[128:143], v[188:191], v[164:167], v[128:143]
 ds_read_b64 v[188:189], v12 offset:3872
 ds_read_b64 v[190:191], v12 offset:3880
 s_waitcnt lgkmcnt(7)
 v_mfma_f32_32x32x16_bf16 v[144:159], v[176:179], v[168:171], v[144:159]
 ds_read_b128 v[160:163], v13 offset:18800
 ds_read_b64 v[176:177], v12 offset:1728
 ds_read_b64 v[178:179], v12 offset:1736
 s_waitcnt lgkmcnt(8)
 v_mfma_f32_32x32x16_bf16 v[128:143], v[180:183], v[168:171], v[128:143]
 ds_read_b64 v[180:181], v12 offset:3776
 ds_read_b64 v[182:183], v12 offset:3784
 s_waitcnt lgkmcnt(7)
 v_mfma_f32_32x32x16_bf16 v[144:159], v[184:187], v[172:175], v[144:159]
 ds_read_b128 v[164:167], v13 offset:18832
 ds_read_b64 v[184:185], v12 offset:1760
 ds_read_b64 v[186:187], v12 offset:1768
 s_waitcnt lgkmcnt(8)
 v_mfma_f32_32x32x16_bf16 v[128:143], v[188:191], v[172:175], v[128:143]
 ds_read_b64 v[188:189], v12 offset:3808
 ds_read_b64 v[190:191], v12 offset:3816
 s_waitcnt lgkmcnt(7)
 v_mfma_f32_32x32x16_bf16 v[144:159], v[176:179], v[160:163], v[144:159]
 ds_read_b128 v[168:171], v13 offset:18720
 ds_read_b64 v[176:177], v12 offset:1664
 ds_read_b64 v[178:179], v12 offset:1672
 s_waitcnt lgkmcnt(8)
 v_mfma_f32_32x32x16_bf16 v[128:143], v[180:183], v[160:163], v[128:143]
 ds_read_b64 v[180:181], v12 offset:3712
 ds_read_b64 v[182:183], v12 offset:3720
 s_waitcnt lgkmcnt(7)
 v_mfma_f32_32x32x16_bf16 v[144:159], v[184:187], v[164:167], v[144:159]
 ds_read_b128 v[172:175], v13 offset:18752
 ds_read_b64 v[184:185], v12 offset:1696
 ds_read_b64 v[186:187], v12 offset:1704
 s_waitcnt lgkmcnt(8)
 v_mfma_f32_32x32x16_bf16 v[128:143], v[188:191], v[164:167], v[128:143]
 ds_read_b64 v[188:189], v12 offset:3744
 ds_read_b64 v[190:191], v12 offset:3752
 s_waitcnt lgkmcnt(7)
 v_mfma_f32_32x32x16_bf16 v[144:159], v[176:179], v[168:171], v[144:159]
 ds_read_b128 v[160:163], v13 offset:18640
 ds_read_b64 v[176:177], v12 offset:1600
 ds_read_b64 v[178:179], v12 offset:1608
 s_waitcnt lgkmcnt(8)
 v_mfma_f32_32x32x16_bf16 v[128:143], v[180:183], v[168:171], v[128:143]
 ds_read_b64 v[180:181], v12 offset:3648
 ds_read_b64 v[182:183], v12 offset:3656
 s_waitcnt lgkmcnt(7)
 v_mfma_f32_32x32x16_bf16 v[144:159], v[184:187], v[172:175], v[144:159]
 ds_read_b128 v[164:167], v13 offset:18672
 ds_read_b64 v[184:185], v12 offset:1632
 ds_read_b64 v[186:187], v12 offset:1640
 s_waitcnt lgkmcnt(8)
 v_mfma_f32_32x32x16_bf16 v[128:143], v[188:191], v[172:175], v[128:143]
 ds_read_b64 v[188:189], v12 offset:3680
 ds_read_b64 v[190:191], v12 offset:3688
 s_waitcnt lgkmcnt(7)
 v_mfma_f32_32x32x16_bf16 v[144:159], v[176:179], v[160:163], v[144:159]
 ds_read_b128 v[168:171], v13 offset:18560
 ds_read_b64 v[176:177], v12 offset:1536
 ds_read_b64 v[178:179], v12 offset:1544
 s_waitcnt lgkmcnt(8)
 v_mfma_f32_32x32x16_bf16 v[128:143], v[180:183], v[160:163], v[128:143]
 ds_read_b64 v[180:181], v12 offset:3584
 ds_read_b64 v[182:183], v12 offset:3592
 s_waitcnt lgkmcnt(7)
 v_mfma_f32_32x32x16_bf16 v[144:159], v[184:187], v[164:167], v[144:159]
 ds_read_b128 v[172:175], v13 offset:18592
 ds_read_b64 v[184:185], v12 offset:1568
 ds_read_b64 v[186:187], v12 offset:1576
 s_waitcnt lgkmcnt(8)
 v_mfma_f32_32x32x16_bf16 v[128:143], v[188:191], v[164:167], v[128:143]
 ds_read_b64 v[188:189], v12 offset:3616
 ds_read_b64 v[190:191], v12 offset:3624
 s_waitcnt lgkmcnt(7)
 v_mfma_f32_32x32x16_bf16 v[144:159], v[176:179], v[168:171], v[144:159]
 ds_read_b128 v[160:163], v13 offset:18480
 ds_read_b64 v[176:177], v12 offset:1472
 ds_read_b64 v[178:179], v12 offset:1480
 s_waitcnt lgkmcnt(8)
 v_mfma_f32_32x32x16_bf16 v[128:143], v[180:183], v[168:171], v[128:143]
 ds_read_b64 v[180:181], v12 offset:3520
 ds_read_b64 v[182:183], v12 offset:3528
 s_waitcnt lgkmcnt(7)
 v_mfma_f32_32x32x16_bf16 v[144:159], v[184:187], v[172:175], v[144:159]
 ds_read_b128 v[164:167], v13 offset:18512
 ds_read_b64 v[184:185], v12 offset:1504
 ds_read_b64 v[186:187], v12 offset:1512
 s_waitcnt lgkmcnt(8)
 v_mfma_f32_32x32x16_bf16 v[128:143], v[188:191], v[172:175], v[128:143]
 ds_read_b64 v[188:189], v12 offset:3552
 ds_read_b64 v[190:191], v12 offset:3560
 s_waitcnt lgkmcnt(7)
 v_mfma_f32_32x32x16_bf16 v[144:159], v[176:179], v[160:163], v[144:159]
 ds_read_b128 v[168:171], v13 offset:18400
 ds_read_b64 v[176:177], v12 offset:1408
 ds_read_b64 v[178:179], v12 offset:1416
 s_waitcnt lgkmcnt(8)
 v_mfma_f32_32x32x16_bf16 v[128:143], v[180:183], v[160:163], v[128:143]
 ds_read_b64 v[180:181], v12 offset:3456
 ds_read_b64 v[182:183], v12 offset:3464
 s_waitcnt lgkmcnt(7)
 v_mfma_f32_32x32x16_bf16 v[144:159], v[184:187], v[164:167], v[144:159]
 ds_read_b128 v[172:175], v13 offset:18432
 ds_read_b64 v[184:185], v12 offset:1440
 ds_read_b64 v[186:187], v12 offset:1448
 s_waitcnt lgkmcnt(8)
 v_mfma_f32_32x32x16_bf16 v[128:143], v[188:191], v[164:167], v[128:143]
 ds_read_b64 v[188:189], v12 offset:3488
 ds_read_b64 v[190:191], v12 offset:3496
 s_waitcnt lgkmcnt(7)
 v_mfma_f32_32x32x16_bf16 v[144:159], v[176:179], v[168:171], v[144:159]
 ds_read_b128 v[160:163], v13 offset:18320
 ds_read_b64 v[176:177], v12 offset:1344
 ds_read_b64 v[178:179], v12 offset:1352
 s_waitcnt lgkmcnt(8)
 v_mfma_f32_32x32x16_bf16 v[128:143], v[180:183], v[168:171], v[128:143]
 ds_read_b64 v[180:181], v12 offset:3392
 ds_read_b64 v[182:183], v12 offset:3400
 s_waitcnt lgkmcnt(7)
 v_mfma_f32_32x32x16_bf16 v[144:159], v[184:187], v[172:175], v[144:159]
 ds_read_b128 v[164:167], v13 offset:18352
 ds_read_b64 v[184:185], v12 offset:1376
 ds_read_b64 v[186:187], v12 offset:1384
 s_waitcnt lgkmcnt(8)
 v_mfma_f32_32x32x16_bf16 v[128:143], v[188:191], v[172:175], v[128:143]
 ds_read_b64 v[188:189], v12 offset:3424
 ds_read_b64 v[190:191], v12 offset:3432
 s_waitcnt lgkmcnt(7)
 v_mfma_f32_32x32x16_bf16 v[144:159], v[176:179], v[160:163], v[144:159]
 ds_read_b128 v[168:171], v13 offset:18240
 ds_read_b64 v[176:177], v12 offset:1280
 ds_read_b64 v[178:179], v12 offset:1288
 s_waitcnt lgkmcnt(8)
 v_mfma_f32_32x32x16_bf16 v[128:143], v[180:183], v[160:163], v[128:143]
 ds_read_b64 v[180:181], v12 offset:3328
 ds_read_b64 v[182:183], v12 offset:3336
 s_waitcnt lgkmcnt(7)
 v_mfma_f32_32x32x16_bf16 v[144:159], v[184:187], v[164:167], v[144:159]
 ds_read_b128 v[172:175], v13 offset:18272
 ds_read_b64 v[184:185], v12 offset:1312
 ds_read_b64 v[186:187], v12 offset:1320
 s_waitcnt lgkmcnt(8)
 v_mfma_f32_32x32x16_bf16 v[128:143], v[188:191], v[164:167], v[128:143]
 ds_read_b64 v[188:189], v12 offset:3360
 ds_read_b64 v[190:191], v12 offset:3368
 s_waitcnt lgkmcnt(7)
 v_mfma_f32_32x32x16_bf16 v[144:159], v[176:179], v[168:171], v[144:159]
 ds_read_b128 v[160:163], v13 offset:18160
 ds_read_b64 v[176:177], v12 offset:1216
 ds_read_b64 v[178:179], v12 offset:1224
 s_waitcnt lgkmcnt(8)
 v_mfma_f32_32x32x16_bf16 v[128:143], v[180:183], v[168:171], v[128:143]
 ds_read_b64 v[180:181], v12 offset:3264
 ds_read_b64 v[182:183], v12 offset:3272
 s_waitcnt lgkmcnt(7)
 v_mfma_f32_32x32x16_bf16 v[144:159], v[184:187], v[172:175], v[144:159]
 ds_read_b128 v[164:167], v13 offset:18192
 ds_read_b64 v[184:185], v12 offset:1248
 ds_read_b64 v[186:187], v12 offset:1256
 s_waitcnt lgkmcnt(8)
 v_mfma_f32_32x32x16_bf16 v[128:143], v[188:191], v[172:175], v[128:143]
 ds_read_b64 v[188:189], v12 offset:3296
 ds_read_b64 v[190:191], v12 offset:3304
 s_waitcnt lgkmcnt(7)
 v_mfma_f32_32x32x16_bf16 v[144:159], v[176:179], v[160:163], v[144:159]
 ds_read_b128 v[168:171], v13 offset:18080
 ds_read_b64 v[176:177], v12 offset:1152
 ds_read_b64 v[178:179], v12 offset:1160
 s_waitcnt lgkmcnt(8)
 v_mfma_f32_32x32x16_bf16 v[128:143], v[180:183], v[160:163], v[128:143]
 ds_read_b64 v[180:181], v12 offset:3200
 ds_read_b64 v[182:183], v12 offset:3208
 s_waitcnt lgkmcnt(7)
 v_mfma_f32_32x32x16_bf16 v[144:159], v[184:187], v[164:167], v[144:159]
 ds_read_b128 v[172:175], v13 offset:18112
 ds_read_b64 v[184:185], v12 offset:1184
 ds_read_b64 v[186:187], v12 offset:1192
 s_waitcnt lgkmcnt(8)
 v_mfma_f32_32x32x16_bf16 v[128:143], v[188:191], v[164:167], v[128:143]
 ds_read_b64 v[188:189], v12 offset:3232
 ds_read_b64 v[190:191], v12 offset:3240
 s_waitcnt lgkmcnt(7)
 v_mfma_f32_32x32x16_bf16 v[144:159], v[176:179], v[168:171], v[144:159]
 ds_read_b128 v[160:163], v13 offset:18000
 ds_read_b64 v[176:177], v12 offset:1088
 ds_read_b64 v[178:179], v12 offset:1096
 s_waitcnt lgkmcnt(8)
 v_mfma_f32_32x32x16_bf16 v[128:143], v[180:183], v[168:171], v[128:143]
 ds_read_b64 v[180:181], v12 offset:3136
 ds_read_b64 v[182:183], v12 offset:3144
 s_waitcnt lgkmcnt(7)
 v_mfma_f32_32x32x16_bf16 v[144:159], v[184:187], v[172:175], v[144:159]
 ds_read_b128 v[164:167], v13 offset:18032
 ds_read_b64 v[184:185], v12 offset:1120
 ds_read_b64 v[186:187], v12 offset:1128
 s_waitcnt lgkmcnt(8)
 v_mfma_f32_32x32x16_bf16 v[128:143], v[188:191], v[172:175], v[128:143]
 ds_read_b64 v[188:189], v12 offset:3168
 ds_read_b64 v[190:191], v12 offset:3176
 s_waitcnt lgkmcnt(7)
 v_mfma_f32_32x32x16_bf16 v[144:159], v[176:179], v[160:163], v[144:159]
 ds_read_b128 v[168:171], v13 offset:17920
 ds_read_b64 v[176:177], v12 offset:1024
 ds_read_b64 v[178:179], v12 offset:1032
 s_waitcnt lgkmcnt(8)
 v_mfma_f32_32x32x16_bf16 v[128:143], v[180:183], v[160:163], v[128:143]
 ds_read_b64 v[180:181], v12 offset:3072
 ds_read_b64 v[182:183], v12 offset:3080
 s_waitcnt lgkmcnt(7)
 v_mfma_f32_32x32x16_bf16 v[144:159], v[184:187], v[164:167], v[144:159]
 ds_read_b128 v[172:175], v13 offset:17952
 ds_read_b64 v[184:185], v12 offset:1056
 ds_read_b64 v[186:187], v12 offset:1064
 s_waitcnt lgkmcnt(8)
 v_mfma_f32_32x32x16_bf16 v[128:143], v[188:191], v[164:167], v[128:143]
 ds_read_b64 v[188:189], v12 offset:3104
 ds_read_b64 v[190:191], v12 offset:3112
 s_waitcnt lgkmcnt(7)
 v_mfma_f32_32x32x16_bf16 v[144:159], v[176:179], v[168:171], v[144:159]
 ds_read_b128 v[160:163], v13 offset:17840
 ds_read_b64 v[176:177], v12 offset:960
 ds_read_b64 v[178:179], v12 offset:968
 s_waitcnt lgkmcnt(8)
 v_mfma_f32_32x32x16_bf16 v[128:143], v[180:183], v[168:171], v[128:143]
 ds_read_b64 v[180:181], v12 offset:3008
 ds_read_b64 v[182:183], v12 offset:3016
 s_waitcnt lgkmcnt(7)
 v_mfma_f32_32x32x16_bf16 v[144:159], v[184:187], v[172:175], v[144:159]
 ds_read_b128 v[164:167], v13 offset:17872
 ds_read_b64 v[184:185], v12 offset:992
 ds_read_b64 v[186:187], v12 offset:1000
 s_waitcnt lgkmcnt(8)
 v_mfma_f32_32x32x16_bf16 v[128:143], v[188:191], v[172:175], v[128:143]
 ds_read_b64 v[188:189], v12 offset:3040
 ds_read_b64 v[190:191], v12 offset:3048
 s_waitcnt lgkmcnt(7)
 v_mfma_f32_32x32x16_bf16 v[144:159], v[176:179], v[160:163], v[144:159]
 ds_read_b128 v[168:171], v13 offset:17760
 ds_read_b64 v[176:177], v12 offset:896
 ds_read_b64 v[178:179], v12 offset:904
 s_waitcnt lgkmcnt(8)
 v_mfma_f32_32x32x16_bf16 v[128:143], v[180:183], v[160:163], v[128:143]
 ds_read_b64 v[180:181], v12 offset:2944
 ds_read_b64 v[182:183], v12 offset:2952
 s_waitcnt lgkmcnt(7)
 v_mfma_f32_32x32x16_bf16 v[144:159], v[184:187], v[164:167], v[144:159]
 ds_read_b128 v[172:175], v13 offset:17792
 ds_read_b64 v[184:185], v12 offset:928
 ds_read_b64 v[186:187], v12 offset:936
 s_waitcnt lgkmcnt(8)
 v_mfma_f32_32x32x16_bf16 v[128:143], v[188:191], v[164:167], v[128:143]
 ds_read_b64 v[188:189], v12 offset:2976
 ds_read_b64 v[190:191], v12 offset:2984
 s_waitcnt lgkmcnt(7)
 v_mfma_f32_32x32x16_bf16 v[144:159], v[176:179], v[168:171], v[144:159]
 ds_read_b128 v[160:163], v13 offset:17680
 ds_read_b64 v[176:177], v12 offset:832
 ds_read_b64 v[178:179], v12 offset:840
 s_waitcnt lgkmcnt(8)
 v_mfma_f32_32x32x16_bf16 v[128:143], v[180:183], v[168:171], v[128:143]
 ds_read_b64 v[180:181], v12 offset:2880
 ds_read_b64 v[182:183], v12 offset:2888
 s_waitcnt lgkmcnt(7)
 v_mfma_f32_32x32x16_bf16 v[144:159], v[184:187], v[172:175], v[144:159]
 ds_read_b128 v[164:167], v13 offset:17712
 ds_read_b64 v[184:185], v12 offset:864
 ds_read_b64 v[186:187], v12 offset:872
 s_waitcnt lgkmcnt(8)
 v_mfma_f32_32x32x16_bf16 v[128:143], v[188:191], v[172:175], v[128:143]
 ds_read_b64 v[188:189], v12 offset:2912
 ds_read_b64 v[190:191], v12 offset:2920
 s_waitcnt lgkmcnt(7)
 v_mfma_f32_32x32x16_bf16 v[144:159], v[176:179], v[160:163], v[144:159]
 ds_read_b128 v[168:171], v13 offset:17600
 ds_read_b64 v[176:177], v12 offset:768
 ds_read_b64 v[178:179], v12 offset:776
 s_waitcnt lgkmcnt(8)
 v_mfma_f32_32x32x16_bf16 v[128:143], v[180:183], v[160:163], v[128:143]
 ds_read_b64 v[180:181], v12 offset:2816
 ds_read_b64 v[182:183], v12 offset:2824
 s_waitcnt lgkmcnt(7)
 v_mfma_f32_32x32x16_bf16 v[144:159], v[184:187], v[164:167], v[144:159]
 ds_read_b128 v[172:175], v13 offset:17632
 ds_read_b64 v[184:185], v12 offset:800
 ds_read_b64 v[186:187], v12 offset:808
 s_waitcnt lgkmcnt(8)
 v_mfma_f32_32x32x16_bf16 v[128:143], v[188:191], v[164:167], v[128:143]
 ds_read_b64 v[188:189], v12 offset:2848
 ds_read_b64 v[190:191], v12 offset:2856
 s_waitcnt lgkmcnt(7)
 v_mfma_f32_32x32x16_bf16 v[144:159], v[176:179], v[168:171], v[144:159]
 ds_read_b128 v[160:163], v13 offset:17520
 ds_read_b64 v[176:177], v12 offset:704
 ds_read_b64 v[178:179], v12 offset:712
 s_waitcnt lgkmcnt(8)
 v_mfma_f32_32x32x16_bf16 v[128:143], v[180:183], v[168:171], v[128:143]
 ds_read_b64 v[180:181], v12 offset:2752
 ds_read_b64 v[182:183], v12 offset:2760
 s_waitcnt lgkmcnt(7)
 v_mfma_f32_32x32x16_bf16 v[144:159], v[184:187], v[172:175], v[144:159]
 ds_read_b128 v[164:167], v13 offset:17552
 ds_read_b64 v[184:185], v12 offset:736
 ds_read_b64 v[186:187], v12 offset:744
 s_waitcnt lgkmcnt(8)
 v_mfma_f32_32x32x16_bf16 v[128:143], v[188:191], v[172:175], v[128:143]
 ds_read_b64 v[188:189], v12 offset:2784
 ds_read_b64 v[190:191], v12 offset:2792
 s_waitcnt lgkmcnt(7)
 v_mfma_f32_32x32x16_bf16 v[144:159], v[176:179], v[160:163], v[144:159]
 ds_read_b128 v[168:171], v13 offset:17440
 ds_read_b64 v[176:177], v12 offset:640
 ds_read_b64 v[178:179], v12 offset:648
 s_waitcnt lgkmcnt(8)
 v_mfma_f32_32x32x16_bf16 v[128:143], v[180:183], v[160:163], v[128:143]
 ds_read_b64 v[180:181], v12 offset:2688
 ds_read_b64 v[182:183], v12 offset:2696
 s_waitcnt lgkmcnt(7)
 v_mfma_f32_32x32x16_bf16 v[144:159], v[184:187], v[164:167], v[144:159]
 ds_read_b128 v[172:175], v13 offset:17472
 ds_read_b64 v[184:185], v12 offset:672
 ds_read_b64 v[186:187], v12 offset:680
 s_waitcnt lgkmcnt(8)
 v_mfma_f32_32x32x16_bf16 v[128:143], v[188:191], v[164:167], v[128:143]
 ds_read_b64 v[188:189], v12 offset:2720
 ds_read_b64 v[190:191], v12 offset:2728
 s_waitcnt lgkmcnt(7)
 v_mfma_f32_32x32x16_bf16 v[144:159], v[176:179], v[168:171], v[144:159]
 ds_read_b128 v[160:163], v13 offset:17360
 ds_read_b64 v[176:177], v12 offset:576
 ds_read_b64 v[178:179], v12 offset:584
 s_waitcnt lgkmcnt(8)
 v_mfma_f32_32x32x16_bf16 v[128:143], v[180:183], v[168:171], v[128:143]
 ds_read_b64 v[180:181], v12 offset:2624
 ds_read_b64 v[182:183], v12 offset:2632
 s_waitcnt lgkmcnt(7)
 v_mfma_f32_32x32x16_bf16 v[144:159], v[184:187], v[172:175], v[144:159]
 ds_read_b128 v[164:167], v13 offset:17392
 ds_read_b64 v[184:185], v12 offset:608
 ds_read_b64 v[186:187], v12 offset:616
 s_waitcnt lgkmcnt(8)
 v_mfma_f32_32x32x16_bf16 v[128:143], v[188:191], v[172:175], v[128:143]
 ds_read_b64 v[188:189], v12 offset:2656
 ds_read_b64 v[190:191], v12 offset:2664
 s_waitcnt lgkmcnt(7)
 v_mfma_f32_32x32x16_bf16 v[144:159], v[176:179], v[160:163], v[144:159]
 ds_read_b128 v[168:171], v13 offset:17280
 ds_read_b64 v[176:177], v12 offset:512
 ds_read_b64 v[178:179], v12 offset:520
 s_waitcnt lgkmcnt(8)
 v_mfma_f32_32x32x16_bf16 v[128:143], v[180:183], v[160:163], v[128:143]
 ds_read_b64 v[180:181], v12 offset:2560
 ds_read_b64 v[182:183], v12 offset:2568
 s_waitcnt lgkmcnt(7)
 v_mfma_f32_32x32x16_bf16 v[144:159], v[184:187], v[164:167], v[144:159]
 ds_read_b128 v[172:175], v13 offset:17312
 ds_read_b64 v[184:185], v12 offset:544
 ds_read_b64 v[186:187], v12 offset:552
 s_waitcnt lgkmcnt(8)
 v_mfma_f32_32x32x16_bf16 v[128:143], v[188:191], v[164:167], v[128:143]
 ds_read_b64 v[188:189], v12 offset:2592
 ds_read_b64 v[190:191], v12 offset:2600
 s_waitcnt lgkmcnt(7)
 v_mfma_f32_32x32x16_bf16 v[144:159], v[176:179], v[168:171], v[144:159]
 ds_read_b128 v[160:163], v13 offset:17200
 ds_read_b64 v[176:177], v12 offset:448
 ds_read_b64 v[178:179], v12 offset:456
 s_waitcnt lgkmcnt(8)
 v_mfma_f32_32x32x16_bf16 v[128:143], v[180:183], v[168:171], v[128:143]
 ds_read_b64 v[180:181], v12 offset:2496
 ds_read_b64 v[182:183], v12 offset:2504
 s_waitcnt lgkmcnt(7)
 v_mfma_f32_32x32x16_bf16 v[144:159], v[184:187], v[172:175], v[144:159]
 ds_read_b128 v[164:167], v13 offset:17232
 ds_read_b64 v[184:185], v12 offset:480
 ds_read_b64 v[186:187], v12 offset:488
 s_waitcnt lgkmcnt(8)
 v_mfma_f32_32x32x16_bf16 v[128:143], v[188:191], v[172:175], v[128:143]
 ds_read_b64 v[188:189], v12 offset:2528
 ds_read_b64 v[190:191], v12 offset:2536
 s_waitcnt lgkmcnt(7)
 v_mfma_f32_32x32x16_bf16 v[144:159], v[176:179], v[160:163], v[144:159]
 ds_read_b128 v[168:171], v13 offset:17120
 ds_read_b64 v[176:177], v12 offset:384
 ds_read_b64 v[178:179], v12 offset:392
 s_waitcnt lgkmcnt(8)
 v_mfma_f32_32x32x16_bf16 v[128:143], v[180:183], v[160:163], v[128:143]
 ds_read_b64 v[180:181], v12 offset:2432
 ds_read_b64 v[182:183], v12 offset:2440
 s_waitcnt lgkmcnt(7)
 v_mfma_f32_32x32x16_bf16 v[144:159], v[184:187], v[164:167], v[144:159]
 ds_read_b128 v[172:175], v13 offset:17152
 ds_read_b64 v[184:185], v12 offset:416
 ds_read_b64 v[186:187], v12 offset:424
 s_waitcnt lgkmcnt(8)
 v_mfma_f32_32x32x16_bf16 v[128:143], v[188:191], v[164:167], v[128:143]
 ds_read_b64 v[188:189], v12 offset:2464
 ds_read_b64 v[190:191], v12 offset:2472
 s_waitcnt lgkmcnt(7)
 v_mfma_f32_32x32x16_bf16 v[144:159], v[176:179], v[168:171], v[144:159]
 ds_read_b128 v[160:163], v13 offset:17040
 ds_read_b64 v[176:177], v12 offset:320
 ds_read_b64 v[178:179], v12 offset:328
 s_waitcnt lgkmcnt(8)
 v_mfma_f32_32x32x16_bf16 v[128:143], v[180:183], v[168:171], v[128:143]
 ds_read_b64 v[180:181], v12 offset:2368
 ds_read_b64 v[182:183], v12 offset:2376
 s_waitcnt lgkmcnt(7)
 v_mfma_f32_32x32x16_bf16 v[144:159], v[184:187], v[172:175], v[144:159]
 ds_read_b128 v[164:167], v13 offset:17072
 ds_read_b64 v[184:185], v12 offset:352
 ds_read_b64 v[186:187], v12 offset:360
 s_waitcnt lgkmcnt(8)
 v_mfma_f32_32x32x16_bf16 v[128:143], v[188:191], v[172:175], v[128:143]
 ds_read_b64 v[188:189], v12 offset:2400
 ds_read_b64 v[190:191], v12 offset:2408
 s_waitcnt lgkmcnt(7)
 v_mfma_f32_32x32x16_bf16 v[144:159], v[176:179], v[160:163], v[144:159]
 ds_read_b128 v[168:171], v13 offset:16960
 ds_read_b64 v[176:177], v12 offset:256
 ds_read_b64 v[178:179], v12 offset:264
 s_waitcnt lgkmcnt(8)
 v_mfma_f32_32x32x16_bf16 v[128:143], v[180:183], v[160:163], v[128:143]
 ds_read_b64 v[180:181], v12 offset:2304
 ds_read_b64 v[182:183], v12 offset:2312
 s_waitcnt lgkmcnt(7)
 v_mfma_f32_32x32x16_bf16 v[144:159], v[184:187], v[164:167], v[144:159]
 ds_read_b128 v[172:175], v13 offset:16992
 ds_read_b64 v[184:185], v12 offset:288
 ds_read_b64 v[186:187], v12 offset:296
 s_waitcnt lgkmcnt(8)
 v_mfma_f32_32x32x16_bf16 v[128:143], v[188:191], v[164:167], v[128:143]
 ds_read_b64 v[188:189], v12 offset:2336
 ds_read_b64 v[190:191], v12 offset:2344
 s_waitcnt lgkmcnt(7)
 v_mfma_f32_32x32x16_bf16 v[144:159], v[176:179], v[168:171], v[144:159]
 ds_read_b128 v[160:163], v13 offset:16880
 ds_read_b64 v[176:177], v12 offset:192
 ds_read_b64 v[178:179], v12 offset:200
 s_waitcnt lgkmcnt(8)
 v_mfma_f32_32x32x16_bf16 v[128:143], v[180:183], v[168:171], v[128:143]
 ds_read_b64 v[180:181], v12 offset:2240
 ds_read_b64 v[182:183], v12 offset:2248
 s_waitcnt lgkmcnt(7)
 v_mfma_f32_32x32x16_bf16 v[144:159], v[184:187], v[172:175], v[144:159]
 ds_read_b128 v[164:167], v13 offset:16912
 ds_read_b64 v[184:185], v12 offset:224
 ds_read_b64 v[186:187], v12 offset:232
 s_waitcnt lgkmcnt(8)
 v_mfma_f32_32x32x16_bf16 v[128:143], v[188:191], v[172:175], v[128:143]
 ds_read_b64 v[188:189], v12 offset:2272
 ds_read_b64 v[190:191], v12 offset:2280
 s_waitcnt lgkmcnt(7)
 v_mfma_f32_32x32x16_bf16 v[144:159], v[176:179], v[160:163], v[144:159]
 ds_read_b128 v[168:171], v13 offset:16800
 ds_read_b64 v[176:177], v12 offset:128
 ds_read_b64 v[178:179], v12 offset:136
 s_waitcnt lgkmcnt(8)
 v_mfma_f32_32x32x16_bf16 v[128:143], v[180:183], v[160:163], v[128:143]
 ds_read_b64 v[180:181], v12 offset:2176
 ds_read_b64 v[182:183], v12 offset:2184
 s_waitcnt lgkmcnt(7)
 v_mfma_f32_32x32x16_bf16 v[144:159], v[184:187], v[164:167], v[144:159]
 ds_read_b128 v[172:175], v13 offset:16832
 ds_read_b64 v[184:185], v12 offset:160
 ds_read_b64 v[186:187], v12 offset:168
 s_waitcnt lgkmcnt(8)
 v_mfma_f32_32x32x16_bf16 v[128:143], v[188:191], v[164:167], v[128:143]
 ds_read_b64 v[188:189], v12 offset:2208
 ds_read_b64 v[190:191], v12 offset:2216
 s_waitcnt lgkmcnt(7)
 v_mfma_f32_32x32x16_bf16 v[144:159], v[176:179], v[168:171], v[144:159]
 ds_read_b128 v[160:163], v13 offset:16720
 ds_read_b64 v[176:177], v12 offset:64
 ds_read_b64 v[178:179], v12 offset:72
 s_waitcnt lgkmcnt(8)
 v_mfma_f32_32x32x16_bf16 v[128:143], v[180:183], v[168:171], v[128:143]
 ds_read_b64 v[180:181], v12 offset:2112
 ds_read_b64 v[182:183], v12 offset:2120
 s_waitcnt lgkmcnt(7)
 v_mfma_f32_32x32x16_bf16 v[144:159], v[184:187], v[172:175], v[144:159]
 ds_read_b128 v[164:167], v13 offset:16752
 ds_read_b64 v[184:185], v12 offset:96
 ds_read_b64 v[186:187], v12 offset:104
 s_waitcnt lgkmcnt(8)
 v_mfma_f32_32x32x16_bf16 v[128:143], v[188:191], v[172:175], v[128:143]
 ds_read_b64 v[188:189], v12 offset:2144
 ds_read_b64 v[190:191], v12 offset:2152
 s_waitcnt lgkmcnt(7)
 v_mfma_f32_32x32x16_bf16 v[144:159], v[176:179], v[160:163], v[144:159]
 ds_read_b128 v[168:171], v13 offset:16640
 ds_read_b64 v[176:177], v12 offset:0
 ds_read_b64 v[178:179], v12 offset:8
 s_waitcnt lgkmcnt(8)
 v_mfma_f32_32x32x16_bf16 v[128:143], v[180:183], v[160:163], v[128:143]
 ds_read_b64 v[180:181], v12 offset:2048
 ds_read_b64 v[182:183], v12 offset:2056
 s_waitcnt lgkmcnt(7)
 v_mfma_f32_32x32x16_bf16 v[144:159], v[184:187], v[164:167], v[144:159]
 ds_read_b128 v[172:175], v13 offset:16672
 ds_read_b64 v[184:185], v12 offset:32
 ds_read_b64 v[186:187], v12 offset:40
 s_waitcnt lgkmcnt(8)
 v_mfma_f32_32x32x16_bf16 v[128:143], v[188:191], v[164:167], v[128:143]
 ds_read_b64 v[188:189], v12 offset:2080
 ds_read_b64 v[190:191], v12 offset:2088
 s_waitcnt lgkmcnt(7)
 v_mfma_f32_32x32x16_bf16 v[144:159], v[176:179], v[168:171], v[144:159]
 s_waitcnt lgkmcnt(5)
 v_mfma_f32_32x32x16_bf16 v[128:143], v[180:183], v[168:171], v[128:143]
 s_waitcnt lgkmcnt(2)
 v_mfma_f32_32x32x16_bf16 v[144:159], v[184:187], v[172:175], v[144:159]
 s_waitcnt lgkmcnt(0)
 v_mfma_f32_32x32x16_bf16 v[128:143], v[188:191], v[172:175], v[128:143]
 v_mov_b32 v16, v22
 v_mov_b32 v17, v23
 v_mov_b32 v18, v24
 v_mov_b32 v19, v25
 v_mov_b32 v20, v26
 v_mov_b32 v21, v27
 v_mov_b32 v22, v28
 v_mov_b32 v23, v29
 v_mov_b32 v24, v30
 v_mov_b32 v25, v31
 v_mov_b32 v26, v32
 v_mov_b32 v27, v33
 v_mov_b32 v28, v34
 v_mov_b32 v29, v35
 v_mov_b32 v30, v36
 v_mov_b32 v31, v37
 v_mov_b32 v32, v38
 v_mov_b32 v33, v39
 v_cvt_pk_bf16_f32 v2, v128, v129
 v_perm_b32 v192, v2, v192, s70
 v_perm_b32 v194, v2, v194, s71
 v_cvt_pk_bf16_f32 v2, v130, v131
 v_perm_b32 v196, v2, v196, s70
 v_perm_b32 v198, v2, v198, s71
 v_cvt_pk_bf16_f32 v2, v132, v133
 v_perm_b32 v200, v2, v200, s70
 v_perm_b32 v202, v2, v202, s71
 v_cvt_pk_bf16_f32 v2, v134, v135
 v_perm_b32 v204, v2, v204, s70
 v_perm_b32 v206, v2, v206, s71
 v_cvt_pk_bf16_f32 v2, v136, v137
 v_perm_b32 v208, v2, v208, s70
 v_perm_b32 v210, v2, v210, s71
 v_cvt_pk_bf16_f32 v2, v138, v139
 v_perm_b32 v212, v2, v212, s70
 v_perm_b32 v214, v2, v214, s71
 v_cvt_pk_bf16_f32 v2, v140, v141
 v_perm_b32 v216, v2, v216, s70
 v_perm_b32 v218, v2, v218, s71
 v_cvt_pk_bf16_f32 v2, v142, v143
 v_perm_b32 v220, v2, v220, s70
 v_perm_b32 v222, v2, v222, s71
 v_cvt_pk_bf16_f32 v2, v144, v145
 v_perm_b32 v224, v2, v224, s70
 v_perm_b32 v226, v2, v226, s71
 v_cvt_pk_bf16_f32 v2, v146, v147
 v_perm_b32 v228, v2, v228, s70
 v_perm_b32 v230, v2, v230, s71
 v_cvt_pk_bf16_f32 v2, v148, v149
 v_perm_b32 v232, v2, v232, s70
 v_perm_b32 v234, v2, v234, s71
 v_cvt_pk_bf16_f32 v2, v150, v151
 v_perm_b32 v236, v2, v236, s70
 v_perm_b32 v238, v2, v238, s71
 v_cvt_pk_bf16_f32 v2, v152, v153
 v_perm_b32 v240, v2, v240, s70
 v_perm_b32 v242, v2, v242, s71
 v_cvt_pk_bf16_f32 v2, v154, v155
 v_perm_b32 v244, v2, v244, s70
 v_perm_b32 v246, v2, v246, s71
 v_cvt_pk_bf16_f32 v2, v156, v157
 v_perm_b32 v248, v2, v248, s70
 v_perm_b32 v250, v2, v250, s71
 v_cvt_pk_bf16_f32 v2, v158, v159
 v_perm_b32 v252, v2, v252, s70
 v_perm_b32 v254, v2, v254, s71
 s_lshr_b64 s[64:65], s[64:65], 16
 s_lshr_b64 s[66:67], s[66:67], 16
 s_bitcmp1_b32 s63, 0
 s_cbranch_scc0 Ls_noswap
 v_swap_b32 v192, v193
 v_swap_b32 v194, v195
 v_swap_b32 v196, v197
 v_swap_b32 v198, v199
 v_swap_b32 v200, v201
 v_swap_b32 v202, v203
 v_swap_b32 v204, v205
 v_swap_b32 v206, v207
 v_swap_b32 v208, v209
 v_swap_b32 v210, v211
 v_swap_b32 v212, v213
 v_swap_b32 v214, v215
 v_swap_b32 v216, v217
 v_swap_b32 v218, v219
 v_swap_b32 v220, v221
 v_swap_b32 v222, v223
 v_swap_b32 v224, v225
 v_swap_b32 v226, v227
 v_swap_b32 v228, v229
 v_swap_b32 v230, v231
 v_swap_b32 v232, v233
 v_swap_b32 v234, v235
 v_swap_b32 v236, v237
 v_swap_b32 v238, v239
 v_swap_b32 v240, v241
 v_swap_b32 v242, v243
 v_swap_b32 v244, v245
 v_swap_b32 v246, v247
 v_swap_b32 v248, v249
 v_swap_b32 v250, v251
 v_swap_b32 v252, v253
 v_swap_b32 v254, v255
Ls_noswap:
 s_add_u32 s63, s63, 1
 s_cmp_lt_u32 s63, 4
 s_cbranch_scc1 Ls_chan
 s_barrier
 ds_write_b64 v75, v[192:193] offset:0
 ds_write_b64 v75, v[194:195] offset:32
 ds_write_b64 v75, v[196:197] offset:64
 ds_write_b64 v75, v[198:199] offset:96
 ds_write_b64 v75, v[200:201] offset:256
 ds_write_b64 v75, v[202:203] offset:288
 ds_write_b64 v75, v[204:205] offset:320
 ds_write_b64 v75, v[206:207] offset:352
 ds_write_b64 v75, v[208:209] offset:512
 ds_write_b64 v75, v[210:211] offset:544
 ds_write_b64 v75, v[212:213] offset:576
 ds_write_b64 v75, v[214:215] offset:608
 ds_write_b64 v75, v[216:217] offset:768
 ds_write_b64 v75, v[218:219] offset:800
 ds_write_b64 v75, v[220:221] offset:832
 ds_write_b64 v75, v[222:223] offset:864
 ds_write_b64 v75, v[224:225] offset:33280
 ds_write_b64 v75, v[226:227] offset:33312
 ds_write_b64 v75, v[228:229] offset:33344
 ds_write_b64 v75, v[230:231] offset:33376
 ds_write_b64 v75, v[232:233] offset:33536
 ds_write_b64 v75, v[234:235] offset:33568
 ds_write_b64 v75, v[236:237] offset:33600
 ds_write_b64 v75, v[238:239] offset:33632
 ds_write_b64 v75, v[240:241] offset:33792
 ds_write_b64 v75, v[242:243] offset:33824
 ds_write_b64 v75, v[244:245] offset:33856
 ds_write_b64 v75, v[246:247] offset:33888
 ds_write_b64 v75, v[248:249] offset:34048
 ds_write_b64 v75, v[250:251] offset:34080
 ds_write_b64 v75, v[252:253] offset:34112
 ds_write_b64 v75, v[254:255] offset:34144
 s_mul_i32 s61, s4, 16640
 v_lshl_add_u32 v3, v0, 4, s61
 v_lshrrev_b32 v4, 1, v0
 v_and_b32 v5, 1, v0
 v_lshlrev_b32 v5, 4, v5
 v_lshl_add_u32 v4, v4, 12, v5
 s_lshr_b32 s61, s60, 2
 s_lshl_b32 s61, s61, 5
 s_lshl_b32 s62, s4, 21
 s_add_u32 s61, s61, s62
 s_add_u32 s61, s61, 2048
 s_waitcnt lgkmcnt(0)
 s_barrier
 ds_read_b128 v[76:79], v3 offset:0
 ds_read_b128 v[80:83], v3 offset:1040
 ds_read_b128 v[84:87], v3 offset:2080
 ds_read_b128 v[88:91], v3 offset:3120
 ds_read_b128 v[92:95], v3 offset:4160
 ds_read_b128 v[96:99], v3 offset:5200
 ds_read_b128 v[100:103], v3 offset:6240
 ds_read_b128 v[104:107], v3 offset:7280
 s_waitcnt lgkmcnt(7)
 s_add_u32 s62, s61, 0
 buffer_store_dwordx4 v[76:79], v4, s[56:59], s62 offen
 s_waitcnt lgkmcnt(6)
 s_add_u32 s62, s61, 131072
 buffer_store_dwordx4 v[80:83], v4, s[56:59], s62 offen
 s_waitcnt lgkmcnt(5)
 s_add_u32 s62, s61, 262144
 buffer_store_dwordx4 v[84:87], v4, s[56:59], s62 offen
 s_waitcnt lgkmcnt(4)
 s_add_u32 s62, s61, 393216
 buffer_store_dwordx4 v[88:91], v4, s[56:59], s62 offen
 s_waitcnt lgkmcnt(3)
 s_add_u32 s62, s61, 524288
 buffer_store_dwordx4 v[92:95], v4, s[56:59], s62 offen
 s_waitcnt lgkmcnt(2)
 s_add_u32 s62, s61, 655360
 buffer_store_dwordx4 v[96:99], v4, s[56:59], s62 offen
 s_waitcnt lgkmcnt(1)
 s_add_u32 s62, s61, 786432
 buffer_store_dwordx4 v[100:103], v4, s[56:59], s62 offen
 s_waitcnt lgkmcnt(0)
 s_add_u32 s62, s61, 917504
 buffer_store_dwordx4 v[104:107], v4, s[56:59], s62 offen
 s_waitcnt vmcnt(0)
 ds_read_b128 v[76:79], v3 offset:8320
 ds_read_b128 v[80:83], v3 offset:9360
 ds_read_b128 v[84:87], v3 offset:10400
 ds_read_b128 v[88:91], v3 offset:11440
 ds_read_b128 v[92:95], v3 offset:12480
 ds_read_b128 v[96:99], v3 offset:13520
 ds_read_b128 v[100:103], v3 offset:14560
 ds_read_b128 v[104:107], v3 offset:15600
 s_waitcnt lgkmcnt(7)
 s_add_u32 s62, s61, 1048576
 buffer_store_dwordx4 v[76:79], v4, s[56:59], s62 offen
 s_waitcnt lgkmcnt(6)
 s_add_u32 s62, s61, 1179648
 buffer_store_dwordx4 v[80:83], v4, s[56:59], s62 offen
 s_waitcnt lgkmcnt(5)
 s_add_u32 s62, s61, 1310720
 buffer_store_dwordx4 v[84:87], v4, s[56:59], s62 offen
 s_waitcnt lgkmcnt(4)
 s_add_u32 s62, s61, 1441792
 buffer_store_dwordx4 v[88:91], v4, s[56:59], s62 offen
 s_waitcnt lgkmcnt(3)
 s_add_u32 s62, s61, 1572864
 buffer_store_dwordx4 v[92:95], v4, s[56:59], s62 offen
 s_waitcnt lgkmcnt(2)
 s_add_u32 s62, s61, 1703936
 buffer_store_dwordx4 v[96:99], v4, s[56:59], s62 offen
 s_waitcnt lgkmcnt(1)
 s_add_u32 s62, s61, 1835008
 buffer_store_dwordx4 v[100:103], v4, s[56:59], s62 offen
 s_waitcnt lgkmcnt(0)
 s_add_u32 s62, s61, 1966080
 buffer_store_dwordx4 v[104:107], v4, s[56:59], s62 offen
 s_endpgm
.section .rodata,"a"
.p2align 6
.amdhsa_kernel concat_heads__memory_aug_recurrent_mem_tr__ssm_conv_s4__prompt_kernel
  .amdhsa_next_free_vgpr 512
  .amdhsa_next_free_sgpr 102
  .amdhsa_accum_offset 256
  .amdhsa_group_segment_fixed_size 0
  .amdhsa_kernarg_size 152
  .amdhsa_user_sgpr_count 2
  .amdhsa_user_sgpr_kernarg_segment_ptr 1
  .amdhsa_system_sgpr_workgroup_id_x 1
  .amdhsa_float_denorm_mode_32 3
.end_amdhsa_kernel
```

```asm
; @launch grid=(256,1,1) block=(256,1,1) lds=163840
.amdgcn_target "amdgcn-amd-amdhsa--gfx950"
.text
.globl concat_heads__memory_aug_recurrent_mem_tr__ssm_conv_s4__prompt_kernel
.p2align 8
.type concat_heads__memory_aug_recurrent_mem_tr__ssm_conv_s4__prompt_kernel,@function
concat_heads__memory_aug_recurrent_mem_tr__ssm_conv_s4__prompt_kernel:
 s_cmp_ge_u32 s2, 256
 s_cbranch_scc1 L_exit
 s_load_dwordx4 s[40:43], s[0:1], 128
 s_load_dwordx2 s[44:45], s[0:1], 144
 s_load_dwordx16 s[8:23], s[0:1], 0
 s_load_dwordx16 s[24:39], s[0:1], 64
 s_getreg_b32 s5, hwreg(HW_REG_XCC_ID, 0, 3)
 v_lshrrev_b32 v1, 6, v0
 s_nop 0
 v_readfirstlane_b32 s4, v1
 v_and_b32 v0, 63, v0
 s_mov_b32 s46, 400000
 s_lshl_b32 s7, s5, 5
 v_mov_b32 v1, s7
 v_mov_b32 v2, 1
 v_mov_b32 v3, 0
 v_mov_b32 v4, 0
 s_waitcnt lgkmcnt(0)
 s_cmp_eq_u32 s4, 0
 s_cbranch_scc0 L_no_ticket
 s_mov_b64 exec, 1
 global_atomic_add v3, v1, v2, s[42:43] sc0 sc1
 s_mov_b64 exec, 0xffffffff
 s_getpc_b64 s[60:61]
L_pc:
 s_lshr_b32 s62, s2, 3
 s_lshl_b32 s62, s62, 12
 v_lshl_add_u32 v5, v0, 7, s62
 v_min_u32 v5, L_code_end-L_pc, v5
 global_load_dword v100, v5, s[60:61]
 s_mov_b64 exec, 1
 s_waitcnt vmcnt(1)
 ds_write_b32 v4, v3
 s_waitcnt lgkmcnt(0)
 s_mov_b64 exec, -1
L_no_ticket:
 s_barrier
 ds_read_b32 v3, v4
 s_waitcnt lgkmcnt(0)
 v_readfirstlane_b32 s6, v3
 s_barrier
 s_mov_b32 s48, s44
 s_and_b32 s49, s45, 0xffff
 s_mov_b32 s50, 268435456
 s_mov_b32 s51, 0x20000
 s_cmp_ge_u32 s6, 32
 s_cbranch_scc1 L_exit
 s_and_b32 s47, s5, 3
 s_cmp_lt_u32 s5, 4
 s_cbranch_scc1 L_chain
 s_branch L_worker
L_exit:
 s_endpgm
L_chain:
 v_lshlrev_b32 v233, 3, v0
 v_bfe_u32 v19, v0, 2, 3
 v_and_b32 v20, 32, v0
 v_add_u32 v19, v19, v20
 v_and_b32 v20, 3, v0
 v_lshlrev_b32 v20, 4, v20
 v_lshl_add_u32 v16, v19, 13, v20
 v_lshl_add_u32 v17, v19, 11, v20
 v_lshrrev_b32 v21, 5, v0
 v_lshlrev_b32 v21, 4, v21
 v_bfe_u32 v22, v0, 4, 1
 v_lshl_add_u32 v21, v22, 2, v21
 v_bfe_u32 v22, v0, 2, 1
 v_add_u32 v21, v21, v22
 v_bfe_u32 v22, v0, 3, 1
 v_lshl_add_u32 v21, v22, 3, v21
 v_lshl_add_u32 v18, v21, 6, v20
 s_mul_i32 s65, s4, 40960
 v_add_u32 v18, s65, v18
 s_lshl_b32 s63, s4, 21
 s_lshl_b32 s7, s47, 5
 s_add_u32 s7, s7, s6
 s_lshl_b32 s7, s7, 6
 s_add_u32 s63, s63, s7
 s_lshl_b32 s64, s47, 2
 s_add_u32 s64, s64, s4
 s_lshl_b32 s64, s64, 19
 s_lshl_b32 s7, s6, 6
 s_add_u32 s64, s64, s7
 s_cmp_eq_u32 s4, 0
 s_cselect_b64 s[72:73], s[14:15], s[12:13]
 s_cmp_eq_u32 s4, 2
 s_cselect_b64 s[72:73], s[16:17], s[72:73]
 s_cmp_eq_u32 s4, 3
 s_cselect_b64 s[72:73], s[18:19], s[72:73]
 s_cselect_b32 s74, 11, 13
 s_cselect_b32 s75, 21, 11
 s_lshl_b32 s75, s47, s75
 s_lshl_b32 s7, s6, 5
 s_lshl_b32 s7, s7, s74
 s_add_u32 s75, s75, s7
 v_and_b32 v19, 31, v0
 v_lshlrev_b32 v19, s74, v19
 v_lshrrev_b32 v20, 5, v0
 v_lshl_add_u32 v20, v20, 10, v19
 s_mov_b32 s52, s72
 s_and_b32 s53, s73, 0xffff
 s_mov_b32 s54, 8388608
 s_mov_b32 s55, 0x20000
 s_cmp_lt_u32 s4, 2
 s_cbranch_scc1 Lc_notouch
 buffer_load_dword v21, v20, s[52:55], s75 offen offset:384
 s_cmp_eq_u32 s47, 3
 s_cbranch_scc0 Lc_notouch
 s_mov_b64 exec, 0xffffffff
 buffer_load_dword v21, v19, s[52:55], s75 offen offset:1920
 s_mov_b64 exec, -1
Lc_notouch:
 s_mov_b32 s52, s14
 s_and_b32 s53, s15, 0xffff
 s_mov_b32 s54, 8388608
 s_mov_b32 s55, 0x20000
 s_add_u32 m0, s65, 0
 s_add_u32 s7, s63, 0
 buffer_load_dwordx4 v16, s[52:55], s7 offen nt lds
 s_add_u32 m0, s65, 1024
 s_add_u32 s7, s63, 524288
 buffer_load_dwordx4 v16, s[52:55], s7 offen nt lds
 s_add_u32 m0, s65, 2048
 s_add_u32 s7, s63, 1048576
 buffer_load_dwordx4 v16, s[52:55], s7 offen nt lds
 s_add_u32 m0, s65, 3072
 s_add_u32 s7, s63, 1572864
 buffer_load_dwordx4 v16, s[52:55], s7 offen nt lds
 s_add_u32 m0, s65, 4096
 s_add_u32 s7, s63, 65536
 buffer_load_dwordx4 v16, s[52:55], s7 offen nt lds
 s_add_u32 m0, s65, 5120
 s_add_u32 s7, s63, 589824
 buffer_load_dwordx4 v16, s[52:55], s7 offen nt lds
 s_add_u32 m0, s65, 6144
 s_add_u32 s7, s63, 1114112
 buffer_load_dwordx4 v16, s[52:55], s7 offen nt lds
 s_add_u32 m0, s65, 7168
 s_add_u32 s7, s63, 1638400
 buffer_load_dwordx4 v16, s[52:55], s7 offen nt lds
 v_lshlrev_b32 v2, 4, v0
 v_lshrrev_b32 v30, 4, v0
 v_and_b32 v31, 7, v0
 v_bfe_u32 v29, v0, 3, 1
 v_lshlrev_b32 v3, 4, v31
 v_lshl_add_u32 v3, v30, 10, v3
 v_lshl_add_u32 v4, v29, 3, v3
 s_lshl_b32 s81, s47, 5
 s_add_u32 s81, s81, s6
 s_lshl_b32 s79, s81, 11
 s_add_u32 s67, s79, 2621440
 s_add_u32 s76, s79, 16777216
 s_lshr_b32 s79, s81, 2
 s_lshl_b32 s79, s79, 7
 s_and_b32 s80, s81, 3
 s_lshl_b32 s80, s80, 4
 s_add_u32 s78, s79, s80
 s_add_u32 s78, s78, 3145728
 s_lshr_b32 s79, s6, 1
 s_lshl_b32 s79, s79, 14
 s_and_b32 s80, s6, 1
 s_lshl_b32 s80, s80, 12
 s_add_u32 s71, s79, s80
 s_lshl_b32 s79, s47, 10
 s_add_u32 s71, s71, s79
 s_lshl_b32 s79, s47, 16
 s_lshr_b32 s80, s6, 3
 s_mul_i32 s80, s80, 4096
 s_add_u32 s66, s79, s80
 s_and_b32 s80, s6, 7
 s_lshl_b32 s80, s80, 7
 s_add_u32 s66, s66, s80
 v_mov_b32 v92, -1
 v_mov_b32 v93, -1
 v_mov_b32 v94, -1
 v_mov_b32 v95, -1
 s_lshr_b32 s79, s6, 3
 s_cmp_eq_u32 s79, 0
 s_cselect_b32 s80, 8, 16
 s_cmp_eq_u32 s79, 2
 s_cselect_b32 s80, 64, s80
 s_cmp_eq_u32 s79, 3
 s_cselect_b32 s80, 74, s80
 s_and_b32 s79, s6, 7
 s_add_u32 s79, s79, s80
 s_lshl_b32 s79, s79, 21
 s_add_u32 s79, s79, 2097088
 s_load_dword s86, s[44:45], s79
 v_and_b32 v28, 15, v0
 v_mov_b32 v1, 0x4444
 v_mov_b32 v27, 0xeeee
 v_cmp_eq_u32 vcc, 1, v29
 s_nop 1
 v_cndmask_b32 v1, v1, v27, vcc
 v_mov_b32 v12, 0x3e0293ee
 v_cndmask_b32 v12, v12, 1.0, vcc
 v_mov_b32 v13, v12
 v_lshlrev_b32 v27, 4, v29
 v_add_u32 v27, v27, v31
 v_lshlrev_b32 v5, 9, v30
 v_lshl_add_u32 v5, v27, 4, v5
 v_lshrrev_b32 v26, 1, v30
 v_and_b32 v25, 1, v30
 v_lshlrev_b32 v6, 8, v26
 v_lshl_add_u32 v6, v31, 4, v6
 v_lshl_add_u32 v6, v25, 3, v6
 v_lshl_add_u32 v6, v29, 2, v6
 v_add_u32 v6, 1536, v6
 s_lshl_b32 s79, s4, 10
 v_add_u32 v9, s79, v2
 s_mov_b32 s79, 16256
 s_mov_b32 s80, 1065353216
 v_lshlrev_b32 v24, 2, v25
 v_add_u32 v23, 0, v24
 v_cmp_eq_u32 vcc, v23, v28
 v_mov_b32 v22, s79
 s_nop 0
 v_cndmask_b32 v80, 0, v22, vcc
 v_add_u32 v23, 1, v23
 v_cmp_eq_u32 vcc, v23, v28
 v_mov_b32 v22, s80
 s_nop 0
 v_cndmask_b32 v80, v80, v22, vcc
 v_lshlrev_b32 v23, 1, v24
 v_add_u32 v23, 0, v23
 v_cmp_eq_u32 vcc, v23, v28
 v_mov_b32 v22, s79
 s_nop 0
 v_cndmask_b32 v84, 0, v22, vcc
 v_add_u32 v23, 1, v23
 v_cmp_eq_u32 vcc, v23, v28
 v_mov_b32 v22, s80
 s_nop 0
 v_cndmask_b32 v84, v84, v22, vcc
 v_mov_b32 v88, 0x3f803f80
 v_lshl_add_u32 v23, v30, 2, 0
 v_cmp_eq_u32 vcc, v23, v28
 v_mov_b32 v22, s79
 s_nop 0
 v_cndmask_b32 v184, 0, v22, vcc
 v_add_u32 v23, 1, v23
 v_cmp_eq_u32 vcc, v23, v28
 v_mov_b32 v22, s80
 s_nop 0
 v_cndmask_b32 v184, v184, v22, vcc
 v_add_u32 v23, 2, v24
 v_cmp_eq_u32 vcc, v23, v28
 v_mov_b32 v22, s79
 s_nop 0
 v_cndmask_b32 v81, 0, v22, vcc
 v_add_u32 v23, 1, v23
 v_cmp_eq_u32 vcc, v23, v28
 v_mov_b32 v22, s80
 s_nop 0
 v_cndmask_b32 v81, v81, v22, vcc
 v_lshlrev_b32 v23, 1, v24
 v_add_u32 v23, 4, v23
 v_cmp_eq_u32 vcc, v23, v28
 v_mov_b32 v22, s79
 s_nop 0
 v_cndmask_b32 v85, 0, v22, vcc
 v_add_u32 v23, 1, v23
 v_cmp_eq_u32 vcc, v23, v28
 v_mov_b32 v22, s80
 s_nop 0
 v_cndmask_b32 v85, v85, v22, vcc
 v_mov_b32 v89, 0x3f803f80
 v_lshl_add_u32 v23, v30, 2, 2
 v_cmp_eq_u32 vcc, v23, v28
 v_mov_b32 v22, s79
 s_nop 0
 v_cndmask_b32 v185, 0, v22, vcc
 v_add_u32 v23, 1, v23
 v_cmp_eq_u32 vcc, v23, v28
 v_mov_b32 v22, s80
 s_nop 0
 v_cndmask_b32 v185, v185, v22, vcc
 v_add_u32 v23, 8, v24
 v_cmp_eq_u32 vcc, v23, v28
 v_mov_b32 v22, s79
 s_nop 0
 v_cndmask_b32 v82, 0, v22, vcc
 v_add_u32 v23, 1, v23
 v_cmp_eq_u32 vcc, v23, v28
 v_mov_b32 v22, s80
 s_nop 0
 v_cndmask_b32 v82, v82, v22, vcc
 v_lshlrev_b32 v23, 1, v24
 v_add_u32 v23, 2, v23
 v_cmp_eq_u32 vcc, v23, v28
 v_mov_b32 v22, s79
 s_nop 0
 v_cndmask_b32 v86, 0, v22, vcc
 v_add_u32 v23, 1, v23
 v_cmp_eq_u32 vcc, v23, v28
 v_mov_b32 v22, s80
 s_nop 0
 v_cndmask_b32 v86, v86, v22, vcc
 v_mov_b32 v90, 0x3f803f80
 v_lshl_add_u32 v23, v30, 2, 0
 v_cmp_eq_u32 vcc, v23, v28
 v_mov_b32 v22, s79
 s_nop 0
 v_cndmask_b32 v186, 0, v22, vcc
 v_add_u32 v23, 1, v23
 v_cmp_eq_u32 vcc, v23, v28
 v_mov_b32 v22, s80
 s_nop 0
 v_cndmask_b32 v186, v186, v22, vcc
 v_add_u32 v23, 10, v24
 v_cmp_eq_u32 vcc, v23, v28
 v_mov_b32 v22, s79
 s_nop 0
 v_cndmask_b32 v83, 0, v22, vcc
 v_add_u32 v23, 1, v23
 v_cmp_eq_u32 vcc, v23, v28
 v_mov_b32 v22, s80
 s_nop 0
 v_cndmask_b32 v83, v83, v22, vcc
 v_lshlrev_b32 v23, 1, v24
 v_add_u32 v23, 6, v23
 v_cmp_eq_u32 vcc, v23, v28
 v_mov_b32 v22, s79
 s_nop 0
 v_cndmask_b32 v87, 0, v22, vcc
 v_add_u32 v23, 1, v23
 v_cmp_eq_u32 vcc, v23, v28
 v_mov_b32 v22, s80
 s_nop 0
 v_cndmask_b32 v87, v87, v22, vcc
 v_mov_b32 v91, 0x3f803f80
 v_lshl_add_u32 v23, v30, 2, 2
 v_cmp_eq_u32 vcc, v23, v28
 v_mov_b32 v22, s79
 s_nop 0
 v_cndmask_b32 v187, 0, v22, vcc
 v_add_u32 v23, 1, v23
 v_cmp_eq_u32 vcc, v23, v28
 v_mov_b32 v22, s80
 s_nop 0
 v_cndmask_b32 v187, v187, v22, vcc
 v_mov_b64 v[32:33], 0
 v_mov_b64 v[34:35], 0
 v_mov_b64 v[36:37], 0
 v_mov_b64 v[38:39], 0
 v_mov_b64 v[40:41], 0
 v_mov_b64 v[42:43], 0
 v_mov_b64 v[44:45], 0
 v_mov_b64 v[46:47], 0
 v_mov_b64 v[48:49], 0
 v_mov_b64 v[50:51], 0
 v_mov_b64 v[52:53], 0
 v_mov_b64 v[54:55], 0
 v_mov_b64 v[56:57], 0
 v_mov_b64 v[58:59], 0
 v_mov_b64 v[60:61], 0
 v_mov_b64 v[62:63], 0
 v_mov_b64 v[188:189], 0
 v_mov_b64 v[190:191], 0
 v_mov_b64 v[192:193], 0
 v_mov_b64 v[194:195], 0
 v_mov_b64 v[196:197], 0
 v_mov_b64 v[198:199], 0
 v_mov_b64 v[200:201], 0
 v_mov_b64 v[202:203], 0
 v_mov_b64 v[240:241], 0
 v_mov_b64 v[242:243], 0
 v_mov_b64 v[244:245], 0
 v_mov_b64 v[246:247], 0
 v_mov_b64 v[248:249], 0
 v_mov_b64 v[250:251], 0
 v_mov_b64 v[252:253], 0
 v_mov_b64 v[254:255], 0
 s_mov_b32 s82, 0x00ff00ff
 s_mov_b32 s83, 0x00ff00ff
 s_mov_b32 s84, 0xff00ff00
 s_mov_b32 s85, 0xff00ff00
 s_lshr_b32 s87, s81, 3
 s_lshl_b32 s87, s87, 14
 s_and_b32 s79, s81, 7
 s_lshl_b32 s79, s79, 10
 s_add_u32 s87, s87, s79
 s_xor_b32 s68, s67, 2048
 s_xor_b32 s69, s67, 4096
 s_xor_b32 s70, s67, 6144
 s_waitcnt vmcnt(4) lgkmcnt(0)
 s_add_u32 m0, s65, 8192
 s_add_u32 s7, s63, 131072
 buffer_load_dwordx4 v16, s[52:55], s7 offen nt lds
 s_add_u32 m0, s65, 9216
 s_add_u32 s7, s63, 655360
 buffer_load_dwordx4 v16, s[52:55], s7 offen nt lds
 s_add_u32 m0, s65, 10240
 s_add_u32 s7, s63, 1179648
 buffer_load_dwordx4 v16, s[52:55], s7 offen nt lds
 s_add_u32 m0, s65, 11264
 s_add_u32 s7, s63, 1703936
 buffer_load_dwordx4 v16, s[52:55], s7 offen nt lds
 ds_read_b64_tr_b16 a[64:65], v18 offset:0
 ds_read_b64_tr_b16 a[66:67], v18 offset:128
 ds_read_b64_tr_b16 a[68:69], v18 offset:2048
 ds_read_b64_tr_b16 a[70:71], v18 offset:2176
 ds_read_b64_tr_b16 a[72:73], v18 offset:8
 ds_read_b64_tr_b16 a[74:75], v18 offset:136
 ds_read_b64_tr_b16 a[76:77], v18 offset:2056
 ds_read_b64_tr_b16 a[78:79], v18 offset:2184
 s_waitcnt vmcnt(4) lgkmcnt(0)
 s_add_u32 m0, s65, 12288
 s_add_u32 s7, s63, 196608
 buffer_load_dwordx4 v16, s[52:55], s7 offen nt lds
 s_add_u32 m0, s65, 13312
 s_add_u32 s7, s63, 720896
 buffer_load_dwordx4 v16, s[52:55], s7 offen nt lds
 s_add_u32 m0, s65, 14336
 s_add_u32 s7, s63, 1245184
 buffer_load_dwordx4 v16, s[52:55], s7 offen nt lds
 s_add_u32 m0, s65, 15360
 s_add_u32 s7, s63, 1769472
 buffer_load_dwordx4 v16, s[52:55], s7 offen nt lds
 ds_read_b64_tr_b16 a[80:81], v18 offset:4096
 ds_read_b64_tr_b16 a[82:83], v18 offset:4224
 ds_read_b64_tr_b16 a[84:85], v18 offset:6144
 ds_read_b64_tr_b16 a[86:87], v18 offset:6272
 ds_read_b64_tr_b16 a[88:89], v18 offset:4104
 ds_read_b64_tr_b16 a[90:91], v18 offset:4232
 ds_read_b64_tr_b16 a[92:93], v18 offset:6152
 ds_read_b64_tr_b16 a[94:95], v18 offset:6280
 s_waitcnt vmcnt(4) lgkmcnt(0)
 s_mov_b32 s56, s12
 s_and_b32 s57, s13, 0xffff
 s_mov_b32 s58, 8388608
 s_mov_b32 s59, 0x20000
 s_add_u32 m0, s65, 16384
 s_add_u32 s7, s63, 0
 buffer_load_dwordx4 v16, s[56:59], s7 offen nt lds
 s_add_u32 m0, s65, 17408
 s_add_u32 s7, s63, 524288
 buffer_load_dwordx4 v16, s[56:59], s7 offen nt lds
 s_add_u32 m0, s65, 18432
 s_add_u32 s7, s63, 1048576
 buffer_load_dwordx4 v16, s[56:59], s7 offen nt lds
 s_add_u32 m0, s65, 19456
 s_add_u32 s7, s63, 1572864
 buffer_load_dwordx4 v16, s[56:59], s7 offen nt lds
 ds_read_b64_tr_b16 a[96:97], v18 offset:8192
 ds_read_b64_tr_b16 a[98:99], v18 offset:8320
 ds_read_b64_tr_b16 a[100:101], v18 offset:10240
 ds_read_b64_tr_b16 a[102:103], v18 offset:10368
 ds_read_b64_tr_b16 a[104:105], v18 offset:8200
 ds_read_b64_tr_b16 a[106:107], v18 offset:8328
 ds_read_b64_tr_b16 a[108:109], v18 offset:10248
 ds_read_b64_tr_b16 a[110:111], v18 offset:10376
 s_waitcnt vmcnt(4) lgkmcnt(0)
 s_add_u32 m0, s65, 20480
 s_add_u32 s7, s63, 65536
 buffer_load_dwordx4 v16, s[56:59], s7 offen nt lds
 s_add_u32 m0, s65, 21504
 s_add_u32 s7, s63, 589824
 buffer_load_dwordx4 v16, s[56:59], s7 offen nt lds
 s_add_u32 m0, s65, 22528
 s_add_u32 s7, s63, 1114112
 buffer_load_dwordx4 v16, s[56:59], s7 offen nt lds
 s_add_u32 m0, s65, 23552
 s_add_u32 s7, s63, 1638400
 buffer_load_dwordx4 v16, s[56:59], s7 offen nt lds
 ds_read_b64_tr_b16 a[112:113], v18 offset:12288
 ds_read_b64_tr_b16 a[114:115], v18 offset:12416
 ds_read_b64_tr_b16 a[116:117], v18 offset:14336
 ds_read_b64_tr_b16 a[118:119], v18 offset:14464
 ds_read_b64_tr_b16 a[120:121], v18 offset:12296
 ds_read_b64_tr_b16 a[122:123], v18 offset:12424
 ds_read_b64_tr_b16 a[124:125], v18 offset:14344
 ds_read_b64_tr_b16 a[126:127], v18 offset:14472
 s_waitcnt vmcnt(4) lgkmcnt(0)
 s_add_u32 m0, s65, 24576
 s_add_u32 s7, s63, 131072
 buffer_load_dwordx4 v16, s[56:59], s7 offen nt lds
 s_add_u32 m0, s65, 25600
 s_add_u32 s7, s63, 655360
 buffer_load_dwordx4 v16, s[56:59], s7 offen nt lds
 s_add_u32 m0, s65, 26624
 s_add_u32 s7, s63, 1179648
 buffer_load_dwordx4 v16, s[56:59], s7 offen nt lds
 s_add_u32 m0, s65, 27648
 s_add_u32 s7, s63, 1703936
 buffer_load_dwordx4 v16, s[56:59], s7 offen nt lds
 ds_read_b64_tr_b16 a[0:1], v18 offset:16384
 ds_read_b64_tr_b16 a[2:3], v18 offset:16512
 ds_read_b64_tr_b16 a[4:5], v18 offset:18432
 ds_read_b64_tr_b16 a[6:7], v18 offset:18560
 ds_read_b64_tr_b16 a[8:9], v18 offset:16392
 ds_read_b64_tr_b16 a[10:11], v18 offset:16520
 ds_read_b64_tr_b16 a[12:13], v18 offset:18440
 ds_read_b64_tr_b16 a[14:15], v18 offset:18568
 s_waitcnt vmcnt(4) lgkmcnt(0)
 s_add_u32 m0, s65, 28672
 s_add_u32 s7, s63, 196608
 buffer_load_dwordx4 v16, s[56:59], s7 offen nt lds
 s_add_u32 m0, s65, 29696
 s_add_u32 s7, s63, 720896
 buffer_load_dwordx4 v16, s[56:59], s7 offen nt lds
 s_add_u32 m0, s65, 30720
 s_add_u32 s7, s63, 1245184
 buffer_load_dwordx4 v16, s[56:59], s7 offen nt lds
 s_add_u32 m0, s65, 31744
 s_add_u32 s7, s63, 1769472
 buffer_load_dwordx4 v16, s[56:59], s7 offen nt lds
 ds_read_b64_tr_b16 a[16:17], v18 offset:20480
 ds_read_b64_tr_b16 a[18:19], v18 offset:20608
 ds_read_b64_tr_b16 a[20:21], v18 offset:22528
 ds_read_b64_tr_b16 a[22:23], v18 offset:22656
 ds_read_b64_tr_b16 a[24:25], v18 offset:20488
 ds_read_b64_tr_b16 a[26:27], v18 offset:20616
 ds_read_b64_tr_b16 a[28:29], v18 offset:22536
 ds_read_b64_tr_b16 a[30:31], v18 offset:22664
 s_waitcnt vmcnt(4) lgkmcnt(0)
 s_mov_b32 s52, s16
 s_and_b32 s53, s17, 0xffff
 s_mov_b32 s54, 8388608
 s_mov_b32 s55, 0x20000
 s_add_u32 m0, s65, 32768
 s_add_u32 s7, s63, 0
 buffer_load_dwordx4 v16, s[52:55], s7 offen nt lds
 s_add_u32 m0, s65, 33792
 s_add_u32 s7, s63, 524288
 buffer_load_dwordx4 v16, s[52:55], s7 offen nt lds
 s_add_u32 m0, s65, 34816
 s_add_u32 s7, s63, 1048576
 buffer_load_dwordx4 v16, s[52:55], s7 offen nt lds
 s_add_u32 m0, s65, 35840
 s_add_u32 s7, s63, 1572864
 buffer_load_dwordx4 v16, s[52:55], s7 offen nt lds
 ds_read_b64_tr_b16 a[32:33], v18 offset:24576
 ds_read_b64_tr_b16 a[34:35], v18 offset:24704
 ds_read_b64_tr_b16 a[36:37], v18 offset:26624
 ds_read_b64_tr_b16 a[38:39], v18 offset:26752
 ds_read_b64_tr_b16 a[40:41], v18 offset:24584
 ds_read_b64_tr_b16 a[42:43], v18 offset:24712
 ds_read_b64_tr_b16 a[44:45], v18 offset:26632
 ds_read_b64_tr_b16 a[46:47], v18 offset:26760
 s_waitcnt vmcnt(4) lgkmcnt(0)
 s_add_u32 m0, s65, 36864
 s_add_u32 s7, s63, 65536
 buffer_load_dwordx4 v16, s[52:55], s7 offen nt lds
 s_add_u32 m0, s65, 37888
 s_add_u32 s7, s63, 589824
 buffer_load_dwordx4 v16, s[52:55], s7 offen nt lds
 s_add_u32 m0, s65, 38912
 s_add_u32 s7, s63, 1114112
 buffer_load_dwordx4 v16, s[52:55], s7 offen nt lds
 s_add_u32 m0, s65, 39936
 s_add_u32 s7, s63, 1638400
 buffer_load_dwordx4 v16, s[52:55], s7 offen nt lds
 ds_read_b64_tr_b16 a[48:49], v18 offset:28672
 ds_read_b64_tr_b16 a[50:51], v18 offset:28800
 ds_read_b64_tr_b16 a[52:53], v18 offset:30720
 ds_read_b64_tr_b16 a[54:55], v18 offset:30848
 ds_read_b64_tr_b16 a[56:57], v18 offset:28680
 ds_read_b64_tr_b16 a[58:59], v18 offset:28808
 ds_read_b64_tr_b16 a[60:61], v18 offset:30728
 ds_read_b64_tr_b16 a[62:63], v18 offset:30856
 s_waitcnt vmcnt(4) lgkmcnt(0)
 s_add_u32 m0, s65, 0
 s_add_u32 s7, s63, 131072
 buffer_load_dwordx4 v16, s[52:55], s7 offen nt lds
 s_add_u32 m0, s65, 1024
 s_add_u32 s7, s63, 655360
 buffer_load_dwordx4 v16, s[52:55], s7 offen nt lds
 s_add_u32 m0, s65, 2048
 s_add_u32 s7, s63, 1179648
 buffer_load_dwordx4 v16, s[52:55], s7 offen nt lds
 s_add_u32 m0, s65, 3072
 s_add_u32 s7, s63, 1703936
 buffer_load_dwordx4 v16, s[52:55], s7 offen nt lds
 ds_read_b64_tr_b16 a[128:129], v18 offset:32768
 ds_read_b64_tr_b16 a[130:131], v18 offset:32896
 ds_read_b64_tr_b16 a[132:133], v18 offset:34816
 ds_read_b64_tr_b16 a[134:135], v18 offset:34944
 ds_read_b64_tr_b16 a[136:137], v18 offset:32776
 ds_read_b64_tr_b16 a[138:139], v18 offset:32904
 ds_read_b64_tr_b16 a[140:141], v18 offset:34824
 ds_read_b64_tr_b16 a[142:143], v18 offset:34952
 s_waitcnt vmcnt(4) lgkmcnt(0)
 v_mov_b32 v10, 0
 global_load_dword v11, v10, s[42:43] offset:132 sc1
 s_add_u32 m0, s65, 4096
 s_add_u32 s7, s63, 196608
 buffer_load_dwordx4 v16, s[52:55], s7 offen nt lds
 s_add_u32 m0, s65, 5120
 s_add_u32 s7, s63, 720896
 buffer_load_dwordx4 v16, s[52:55], s7 offen nt lds
 s_add_u32 m0, s65, 6144
 s_add_u32 s7, s63, 1245184
 buffer_load_dwordx4 v16, s[52:55], s7 offen nt lds
 s_add_u32 m0, s65, 7168
 s_add_u32 s7, s63, 1769472
 buffer_load_dwordx4 v16, s[52:55], s7 offen nt lds
 ds_read_b64_tr_b16 a[144:145], v18 offset:36864
 ds_read_b64_tr_b16 a[146:147], v18 offset:36992
 ds_read_b64_tr_b16 a[148:149], v18 offset:38912
 ds_read_b64_tr_b16 a[150:151], v18 offset:39040
 ds_read_b64_tr_b16 a[152:153], v18 offset:36872
 ds_read_b64_tr_b16 a[154:155], v18 offset:37000
 ds_read_b64_tr_b16 a[156:157], v18 offset:38920
 ds_read_b64_tr_b16 a[158:159], v18 offset:39048
 s_waitcnt vmcnt(4) lgkmcnt(0)
 s_mov_b32 s56, s18
 s_and_b32 s57, s19, 0xffff
 s_mov_b32 s58, 8388608
 s_mov_b32 s59, 0x20000
 s_add_u32 m0, s65, 8192
 s_add_u32 s7, s64, 0
 buffer_load_dwordx4 v17, s[56:59], s7 offen nt lds
 s_add_u32 m0, s65, 9216
 s_add_u32 s7, s64, 131072
 buffer_load_dwordx4 v17, s[56:59], s7 offen nt lds
 s_add_u32 m0, s65, 10240
 s_add_u32 s7, s64, 262144
 buffer_load_dwordx4 v17, s[56:59], s7 offen nt lds
 s_add_u32 m0, s65, 11264
 s_add_u32 s7, s64, 393216
 buffer_load_dwordx4 v17, s[56:59], s7 offen nt lds
 ds_read_b64_tr_b16 a[160:161], v18 offset:0
 ds_read_b64_tr_b16 a[162:163], v18 offset:128
 ds_read_b64_tr_b16 a[164:165], v18 offset:2048
 ds_read_b64_tr_b16 a[166:167], v18 offset:2176
 ds_read_b64_tr_b16 a[168:169], v18 offset:8
 ds_read_b64_tr_b16 a[170:171], v18 offset:136
 ds_read_b64_tr_b16 a[172:173], v18 offset:2056
 ds_read_b64_tr_b16 a[174:175], v18 offset:2184
 s_waitcnt vmcnt(4) lgkmcnt(0)
 s_add_u32 m0, s65, 12288
 s_add_u32 s7, s64, 16384
 buffer_load_dwordx4 v17, s[56:59], s7 offen nt lds
 s_add_u32 m0, s65, 13312
 s_add_u32 s7, s64, 147456
 buffer_load_dwordx4 v17, s[56:59], s7 offen nt lds
 s_add_u32 m0, s65, 14336
 s_add_u32 s7, s64, 278528
 buffer_load_dwordx4 v17, s[56:59], s7 offen nt lds
 s_add_u32 m0, s65, 15360
 s_add_u32 s7, s64, 409600
 buffer_load_dwordx4 v17, s[56:59], s7 offen nt lds
 ds_read_b64_tr_b16 a[176:177], v18 offset:4096
 ds_read_b64_tr_b16 a[178:179], v18 offset:4224
 ds_read_b64_tr_b16 a[180:181], v18 offset:6144
 ds_read_b64_tr_b16 a[182:183], v18 offset:6272
 ds_read_b64_tr_b16 a[184:185], v18 offset:4104
 ds_read_b64_tr_b16 a[186:187], v18 offset:4232
 ds_read_b64_tr_b16 a[188:189], v18 offset:6152
 ds_read_b64_tr_b16 a[190:191], v18 offset:6280
 s_waitcnt vmcnt(4) lgkmcnt(0)
 s_add_u32 m0, s65, 16384
 s_add_u32 s7, s64, 32768
 buffer_load_dwordx4 v17, s[56:59], s7 offen nt lds
 s_add_u32 m0, s65, 17408
 s_add_u32 s7, s64, 163840
 buffer_load_dwordx4 v17, s[56:59], s7 offen nt lds
 s_add_u32 m0, s65, 18432
 s_add_u32 s7, s64, 294912
 buffer_load_dwordx4 v17, s[56:59], s7 offen nt lds
 s_add_u32 m0, s65, 19456
 s_add_u32 s7, s64, 425984
 buffer_load_dwordx4 v17, s[56:59], s7 offen nt lds
 ds_read_b64_tr_b16 a[192:193], v18 offset:8192
 ds_read_b64_tr_b16 a[194:195], v18 offset:8320
 ds_read_b64_tr_b16 a[196:197], v18 offset:10240
 ds_read_b64_tr_b16 a[198:199], v18 offset:10368
 ds_read_b64_tr_b16 a[200:201], v18 offset:8200
 ds_read_b64_tr_b16 a[202:203], v18 offset:8328
 ds_read_b64_tr_b16 a[204:205], v18 offset:10248
 ds_read_b64_tr_b16 a[206:207], v18 offset:10376
 s_waitcnt vmcnt(4) lgkmcnt(0)
 s_add_u32 m0, s65, 20480
 s_add_u32 s7, s64, 49152
 buffer_load_dwordx4 v17, s[56:59], s7 offen nt lds
 s_add_u32 m0, s65, 21504
 s_add_u32 s7, s64, 180224
 buffer_load_dwordx4 v17, s[56:59], s7 offen nt lds
 s_add_u32 m0, s65, 22528
 s_add_u32 s7, s64, 311296
 buffer_load_dwordx4 v17, s[56:59], s7 offen nt lds
 s_add_u32 m0, s65, 23552
 s_add_u32 s7, s64, 442368
 buffer_load_dwordx4 v17, s[56:59], s7 offen nt lds
 s_branch newschk_3
news_1:
 v_mov_b32 v10, 0
 global_load_dword v11, v10, s[42:43] offset:132 sc1
 s_waitcnt vmcnt(0)
newschk_3:
 v_readfirstlane_b32 s7, v11
 s_nop 0
 s_bfe_u32 s62, s7, 0x10005
 s_and_b32 s7, s7, 16
 s_cmp_eq_u32 s7, 16
 s_cbranch_scc1 newsok_2
 s_sleep 2
 s_sub_u32 s46, s46, 1
 s_cbranch_scc0 news_1
 s_mov_b32 s46, 0
 s_branch newsok_2
newsok_2:
 s_cmp_eq_u32 s4, 0
 s_cbranch_scc0 Lc_nopre
 s_add_u32 s79, s66, 2097152
 buffer_load_dwordx2 v[96:97], v4, s[48:51], s79 offen sc1
 s_add_u32 s79, s66, 2129920
 buffer_load_dwordx2 v[96:97], v4, s[48:51], s79 offen sc1
 s_add_u32 s79, s66, 2359296
 buffer_load_dwordx2 v[96:97], v4, s[48:51], s79 offen sc1
 s_add_u32 s79, s66, 2392064
 buffer_load_dwordx2 v[96:97], v4, s[48:51], s79 offen sc1
 buffer_load_dwordx4 v[96:99], v2, s[48:51], s67 offen offset:0 sc1
 buffer_load_dwordx4 v[96:99], v2, s[48:51], s67 offen offset:1024 sc1
Lc_nopre:
 ds_read_b64_tr_b16 a[208:209], v18 offset:12288
 ds_read_b64_tr_b16 a[210:211], v18 offset:12416
 ds_read_b64_tr_b16 a[212:213], v18 offset:14336
 ds_read_b64_tr_b16 a[214:215], v18 offset:14464
 ds_read_b64_tr_b16 a[216:217], v18 offset:12296
 ds_read_b64_tr_b16 a[218:219], v18 offset:12424
 ds_read_b64_tr_b16 a[220:221], v18 offset:14344
 ds_read_b64_tr_b16 a[222:223], v18 offset:14472
 s_waitcnt vmcnt(4) lgkmcnt(0)
 ds_read_b64_tr_b16 a[224:225], v18 offset:16384
 ds_read_b64_tr_b16 a[226:227], v18 offset:16512
 ds_read_b64_tr_b16 a[228:229], v18 offset:18432
 ds_read_b64_tr_b16 a[230:231], v18 offset:18560
 ds_read_b64_tr_b16 a[232:233], v18 offset:16392
 ds_read_b64_tr_b16 a[234:235], v18 offset:16520
 ds_read_b64_tr_b16 a[236:237], v18 offset:18440
 ds_read_b64_tr_b16 a[238:239], v18 offset:18568
 s_waitcnt vmcnt(0) lgkmcnt(0)
 ds_read_b64_tr_b16 a[240:241], v18 offset:20480
 ds_read_b64_tr_b16 a[242:243], v18 offset:20608
 ds_read_b64_tr_b16 a[244:245], v18 offset:22528
 ds_read_b64_tr_b16 a[246:247], v18 offset:22656
 ds_read_b64_tr_b16 a[248:249], v18 offset:20488
 ds_read_b64_tr_b16 a[250:251], v18 offset:20616
 ds_read_b64_tr_b16 a[252:253], v18 offset:22536
 ds_read_b64_tr_b16 a[254:255], v18 offset:22664
 s_waitcnt lgkmcnt(0)
 s_lshl_b32 s79, s47, 16
 s_mul_i32 s80, s4, 4096
 s_add_u32 s79, s79, s80
 s_add_u32 s63, s79, 2097152
 s_add_u32 s65, s79, 2359296
 s_add_u32 s64, s66, 2129920
 s_add_u32 s66, s66, 2359296
 s_mov_b32 s60, 0
 s_mov_b32 s61, 0
 s_barrier
 s_and_b32 s79, s62, 1
 s_lshl_b32 s79, s79, 13
 s_add_u32 s71, s71, s79
 s_add_u32 s71, s71, 134217728
 s_add_u32 s87, s87, s79
 s_add_u32 s87, s87, 155189248
 s_lshl_b32 s79, s60, 18
 s_and_b32 s80, s60, 8
 s_lshl_b32 s80, s80, 10
 s_add_u32 s72, s71, s79
 s_xor_b32 s72, s72, s80
 s_add_u32 s77, s87, s79
 s_xor_b32 s77, s77, s80
 s_xor_b32 s73, s72, 1024
 s_xor_b32 s74, s72, 2048
 s_xor_b32 s75, s72, 3072
 s_cmp_eq_u32 s4, 1
 s_cbranch_scc0 Lc_first
 s_mov_b32 s80, 1
kv_4:
 v_mov_b32 v11, 0
 buffer_load_dwordx2 v[14:15], v11, s[48:51], s78 offen sc1
 s_waitcnt vmcnt(0)
 v_min_u32 v10, v14, v15
 s_nop 0
 v_readfirstlane_b32 s61, v10
 s_nop 0
 s_cmp_ge_u32 s61, s80
 s_cbranch_scc1 kvok_5
 s_sub_u32 s46, s46, 1
 s_cbranch_scc0 kv_4
 s_mov_b32 s46, 0
 s_branch kvok_5
kvok_5:
 s_add_u32 s79, s76, 16777216
 s_mov_b32 m0, 16384
 s_nop 0
 buffer_load_dwordx4 v5, s[48:51], s76 offen sc1 lds
 s_mov_b32 m0, 17280
 s_nop 0
 buffer_load_dwordx4 v5, s[48:51], s76 offen offset:128 sc1 lds
 s_mov_b32 m0, 18432
 s_nop 0
 buffer_load_dwordx4 v5, s[48:51], s79 offen sc1 lds
 s_mov_b32 m0, 19328
 s_nop 0
 buffer_load_dwordx4 v5, s[48:51], s79 offen offset:128 sc1 lds
 s_waitcnt vmcnt(0)
Lc_first:
 s_barrier
 ds_read_b128 v[124:127], v2 offset:16384
 ds_read_b128 v[128:131], v2 offset:17408
 ds_read_b128 v[132:135], v2 offset:18432
 ds_read_b128 v[136:139], v2 offset:19456
 v_mov_b64 v[254:255], 0
 s_mov_b32 s52, s10
 s_and_b32 s53, s11, 0xffff
 s_mov_b32 s54, 16384
 s_mov_b32 s55, 0x20000
 v_lshrrev_b32 v10, 3, v0
 v_and_b32 v11, 7, v0
 v_lshlrev_b32 v11, 11, v11
 v_lshl_add_u32 v10, v10, 6, v11
 s_lshl_b32 s79, s4, 9
 buffer_load_dwordx4 v[16:19], v10, s[52:55], s79 offen offset:0
 buffer_load_dwordx4 v[20:23], v10, s[52:55], s79 offen offset:16
 buffer_load_dwordx4 v[24:27], v10, s[52:55], s79 offen offset:32
 buffer_load_dwordx4 v[28:31], v10, s[52:55], s79 offen offset:48
 s_cmp_eq_u32 s4, 0
 s_cbranch_scc1 LlA_first
 s_branch LhA_first
Lh_step:
 s_barrier
 buffer_load_dwordx4 v[16:19], v2, s[48:51], s63 offen offset:0 sc1
 v_mov_b64 v[32:33], 0
 v_mov_b64 v[34:35], 0
 v_mov_b64 v[36:37], 0
 v_mov_b64 v[38:39], 0
 s_nop 12
 buffer_load_dwordx4 v[20:23], v2, s[48:51], s63 offen offset:1024 sc1
 v_mov_b64 v[40:41], 0
 v_mov_b64 v[42:43], 0
 v_mov_b64 v[44:45], 0
 v_mov_b64 v[46:47], 0
 s_nop 12
 buffer_load_dwordx4 v[24:27], v2, s[48:51], s63 offen offset:2048 sc1
 v_mov_b64 v[48:49], 0
 v_mov_b64 v[50:51], 0
 v_mov_b64 v[52:53], 0
 v_mov_b64 v[54:55], 0
 s_nop 12
 buffer_load_dwordx4 v[28:31], v2, s[48:51], s63 offen offset:3072 sc1
LhA_first:
 s_waitcnt vmcnt(3)
 v_max_u32 v8, v16, v18
 v_cmp_eq_u32 vcc, -1, v8
 s_cbranch_vccnz LhA_miss0
LhA_got0:
 v_smfmac_f32_16x16x64_bf16 v[32:35], v[16:19], a[0:7], v1
 v_smfmac_f32_16x16x64_bf16 v[36:39], v[16:19], a[64:71], v1
 v_smfmac_f32_16x16x64_bf16 v[40:43], v[16:19], a[8:15], v1
 v_smfmac_f32_16x16x64_bf16 v[44:47], v[16:19], a[72:79], v1
 s_waitcnt vmcnt(2)
 v_smfmac_f32_16x16x64_bf16 v[32:35], v[20:23], a[16:23], v1
 v_max3_u32 v8, v8, v20, v22
 v_smfmac_f32_16x16x64_bf16 v[36:39], v[20:23], a[80:87], v1
 v_smfmac_f32_16x16x64_bf16 v[40:43], v[20:23], a[24:31], v1
 v_smfmac_f32_16x16x64_bf16 v[44:47], v[20:23], a[88:95], v1
 s_waitcnt vmcnt(1)
 v_smfmac_f32_16x16x64_bf16 v[32:35], v[24:27], a[32:39], v1
 v_max3_u32 v8, v8, v24, v26
 v_smfmac_f32_16x16x64_bf16 v[36:39], v[24:27], a[96:103], v1
 v_smfmac_f32_16x16x64_bf16 v[40:43], v[24:27], a[40:47], v1
 v_smfmac_f32_16x16x64_bf16 v[44:47], v[24:27], a[104:111], v1
 s_waitcnt vmcnt(0)
 v_smfmac_f32_16x16x64_bf16 v[32:35], v[28:31], a[48:55], v1
 v_max3_u32 v8, v8, v28, v30
 v_cmp_eq_u32 vcc, -1, v8
 v_smfmac_f32_16x16x64_bf16 v[36:39], v[28:31], a[112:119], v1
 v_smfmac_f32_16x16x64_bf16 v[40:43], v[28:31], a[56:63], v1
 v_cvt_pk_bf16_f32 v64, v32, v33
 v_cvt_pk_bf16_f32 v65, v34, v35
 v_smfmac_f32_16x16x64_bf16 v[44:47], v[28:31], a[120:127], v1
 v_cvt_pk_bf16_f32 v66, v36, v37
 v_cvt_pk_bf16_f32 v67, v38, v39
 s_cbranch_vccnz LhA_bad0
LhA_ok0:
 s_nop 0
 v_mfma_f32_16x16x32_bf16 v[72:75], v[64:67], v[80:83], 0
 v_cvt_pk_bf16_f32 v68, v40, v41
 v_cvt_pk_bf16_f32 v69, v42, v43
 v_cvt_pk_bf16_f32 v70, v44, v45
 v_cvt_pk_bf16_f32 v71, v46, v47
 s_nop 1
 v_mfma_f32_16x16x32_bf16 v[76:79], v[68:71], v[80:83], 0
 ds_write_b128 v9, v[72:75] offset:0
 v_smfmac_f32_16x16x64_bf16 v[48:51], v[16:19], a[128:135], v1
 v_smfmac_f32_16x16x64_bf16 v[52:55], v[16:19], a[136:143], v1
 ds_write_b128 v9, v[76:79] offset:4096
 v_smfmac_f32_16x16x64_bf16 v[48:51], v[20:23], a[144:151], v1
 s_branch LhA_join
LhA_bad0:
 s_sub_u32 s46, s46, 1
 s_cbranch_scc0 LhA_redo
 s_mov_b32 s46, 0
 s_branch LhA_ok0
LhA_miss0:
 buffer_load_dwordx4 v[16:19], v2, s[48:51], s63 offen offset:0 sc1
 s_waitcnt vmcnt(3)
 v_max_u32 v8, v20, v22
 v_cmp_eq_u32 vcc, -1, v8
 s_cbranch_vccnz LhA_miss1
LhA_got1:
 v_smfmac_f32_16x16x64_bf16 v[32:35], v[20:23], a[16:23], v1
 v_smfmac_f32_16x16x64_bf16 v[36:39], v[20:23], a[80:87], v1
 v_smfmac_f32_16x16x64_bf16 v[40:43], v[20:23], a[24:31], v1
 v_smfmac_f32_16x16x64_bf16 v[44:47], v[20:23], a[88:95], v1
 s_waitcnt vmcnt(2)
 v_smfmac_f32_16x16x64_bf16 v[32:35], v[24:27], a[32:39], v1
 v_max3_u32 v8, v8, v24, v26
 v_smfmac_f32_16x16x64_bf16 v[36:39], v[24:27], a[96:103], v1
 v_smfmac_f32_16x16x64_bf16 v[40:43], v[24:27], a[40:47], v1
 v_smfmac_f32_16x16x64_bf16 v[44:47], v[24:27], a[104:111], v1
 s_waitcnt vmcnt(1)
 v_smfmac_f32_16x16x64_bf16 v[32:35], v[28:31], a[48:55], v1
 v_max3_u32 v8, v8, v28, v30
 v_smfmac_f32_16x16x64_bf16 v[36:39], v[28:31], a[112:119], v1
 v_smfmac_f32_16x16x64_bf16 v[40:43], v[28:31], a[56:63], v1
 v_smfmac_f32_16x16x64_bf16 v[44:47], v[28:31], a[120:127], v1
 s_waitcnt vmcnt(0)
 v_smfmac_f32_16x16x64_bf16 v[32:35], v[16:19], a[0:7], v1
 v_max3_u32 v8, v8, v16, v18
 v_cmp_eq_u32 vcc, -1, v8
 v_smfmac_f32_16x16x64_bf16 v[36:39], v[16:19], a[64:71], v1
 v_smfmac_f32_16x16x64_bf16 v[40:43], v[16:19], a[8:15], v1
 v_cvt_pk_bf16_f32 v64, v32, v33
 v_cvt_pk_bf16_f32 v65, v34, v35
 v_smfmac_f32_16x16x64_bf16 v[44:47], v[16:19], a[72:79], v1
 v_cvt_pk_bf16_f32 v66, v36, v37
 v_cvt_pk_bf16_f32 v67, v38, v39
 s_cbranch_vccnz LhA_bad1
LhA_ok1:
 s_nop 0
 v_mfma_f32_16x16x32_bf16 v[72:75], v[64:67], v[80:83], 0
 v_cvt_pk_bf16_f32 v68, v40, v41
 v_cvt_pk_bf16_f32 v69, v42, v43
 v_cvt_pk_bf16_f32 v70, v44, v45
 v_cvt_pk_bf16_f32 v71, v46, v47
 s_nop 1
 v_mfma_f32_16x16x32_bf16 v[76:79], v[68:71], v[80:83], 0
 ds_write_b128 v9, v[72:75] offset:0
 v_smfmac_f32_16x16x64_bf16 v[48:51], v[16:19], a[128:135], v1
 v_smfmac_f32_16x16x64_bf16 v[52:55], v[16:19], a[136:143], v1
 ds_write_b128 v9, v[76:79] offset:4096
 v_smfmac_f32_16x16x64_bf16 v[48:51], v[20:23], a[144:151], v1
 s_branch LhA_join
LhA_bad1:
 s_sub_u32 s46, s46, 1
 s_cbranch_scc0 LhA_redo
 s_mov_b32 s46, 0
 s_branch LhA_ok1
LhA_miss1:
 buffer_load_dwordx4 v[20:23], v2, s[48:51], s63 offen offset:1024 sc1
 s_waitcnt vmcnt(3)
 v_max_u32 v8, v24, v26
 v_cmp_eq_u32 vcc, -1, v8
 s_cbranch_vccnz LhA_miss2
LhA_got2:
 v_smfmac_f32_16x16x64_bf16 v[32:35], v[24:27], a[32:39], v1
 v_smfmac_f32_16x16x64_bf16 v[36:39], v[24:27], a[96:103], v1
 v_smfmac_f32_16x16x64_bf16 v[40:43], v[24:27], a[40:47], v1
 v_smfmac_f32_16x16x64_bf16 v[44:47], v[24:27], a[104:111], v1
 s_waitcnt vmcnt(2)
 v_smfmac_f32_16x16x64_bf16 v[32:35], v[28:31], a[48:55], v1
 v_max3_u32 v8, v8, v28, v30
 v_smfmac_f32_16x16x64_bf16 v[36:39], v[28:31], a[112:119], v1
 v_smfmac_f32_16x16x64_bf16 v[40:43], v[28:31], a[56:63], v1
 v_smfmac_f32_16x16x64_bf16 v[44:47], v[28:31], a[120:127], v1
 s_waitcnt vmcnt(1)
 v_smfmac_f32_16x16x64_bf16 v[32:35], v[16:19], a[0:7], v1
 v_max3_u32 v8, v8, v16, v18
 v_smfmac_f32_16x16x64_bf16 v[36:39], v[16:19], a[64:71], v1
 v_smfmac_f32_16x16x64_bf16 v[40:43], v[16:19], a[8:15], v1
 v_smfmac_f32_16x16x64_bf16 v[44:47], v[16:19], a[72:79], v1
 s_waitcnt vmcnt(0)
 v_smfmac_f32_16x16x64_bf16 v[32:35], v[20:23], a[16:23], v1
 v_max3_u32 v8, v8, v20, v22
 v_cmp_eq_u32 vcc, -1, v8
 v_smfmac_f32_16x16x64_bf16 v[36:39], v[20:23], a[80:87], v1
 v_smfmac_f32_16x16x64_bf16 v[40:43], v[20:23], a[24:31], v1
 v_cvt_pk_bf16_f32 v64, v32, v33
 v_cvt_pk_bf16_f32 v65, v34, v35
 v_smfmac_f32_16x16x64_bf16 v[44:47], v[20:23], a[88:95], v1
 v_cvt_pk_bf16_f32 v66, v36, v37
 v_cvt_pk_bf16_f32 v67, v38, v39
 s_cbranch_vccnz LhA_bad2
LhA_ok2:
 s_nop 0
 v_mfma_f32_16x16x32_bf16 v[72:75], v[64:67], v[80:83], 0
 v_cvt_pk_bf16_f32 v68, v40, v41
 v_cvt_pk_bf16_f32 v69, v42, v43
 v_cvt_pk_bf16_f32 v70, v44, v45
 v_cvt_pk_bf16_f32 v71, v46, v47
 s_nop 1
 v_mfma_f32_16x16x32_bf16 v[76:79], v[68:71], v[80:83], 0
 ds_write_b128 v9, v[72:75] offset:0
 v_smfmac_f32_16x16x64_bf16 v[48:51], v[16:19], a[128:135], v1
 v_smfmac_f32_16x16x64_bf16 v[52:55], v[16:19], a[136:143], v1
 ds_write_b128 v9, v[76:79] offset:4096
 v_smfmac_f32_16x16x64_bf16 v[48:51], v[20:23], a[144:151], v1
 s_branch LhA_join
LhA_bad2:
 s_sub_u32 s46, s46, 1
 s_cbranch_scc0 LhA_redo
 s_mov_b32 s46, 0
 s_branch LhA_ok2
LhA_miss2:
 buffer_load_dwordx4 v[24:27], v2, s[48:51], s63 offen offset:2048 sc1
 s_waitcnt vmcnt(3)
 v_max_u32 v8, v28, v30
 v_cmp_eq_u32 vcc, -1, v8
 s_cbranch_vccnz LhA_miss3
LhA_got3:
 v_smfmac_f32_16x16x64_bf16 v[32:35], v[28:31], a[48:55], v1
 v_smfmac_f32_16x16x64_bf16 v[36:39], v[28:31], a[112:119], v1
 v_smfmac_f32_16x16x64_bf16 v[40:43], v[28:31], a[56:63], v1
 v_smfmac_f32_16x16x64_bf16 v[44:47], v[28:31], a[120:127], v1
 s_waitcnt vmcnt(2)
 v_smfmac_f32_16x16x64_bf16 v[32:35], v[16:19], a[0:7], v1
 v_max3_u32 v8, v8, v16, v18
 v_smfmac_f32_16x16x64_bf16 v[36:39], v[16:19], a[64:71], v1
 v_smfmac_f32_16x16x64_bf16 v[40:43], v[16:19], a[8:15], v1
 v_smfmac_f32_16x16x64_bf16 v[44:47], v[16:19], a[72:79], v1
 s_waitcnt vmcnt(1)
 v_smfmac_f32_16x16x64_bf16 v[32:35], v[20:23], a[16:23], v1
 v_max3_u32 v8, v8, v20, v22
 v_smfmac_f32_16x16x64_bf16 v[36:39], v[20:23], a[80:87], v1
 v_smfmac_f32_16x16x64_bf16 v[40:43], v[20:23], a[24:31], v1
 v_smfmac_f32_16x16x64_bf16 v[44:47], v[20:23], a[88:95], v1
 s_waitcnt vmcnt(0)
 v_smfmac_f32_16x16x64_bf16 v[32:35], v[24:27], a[32:39], v1
 v_max3_u32 v8, v8, v24, v26
 v_cmp_eq_u32 vcc, -1, v8
 v_smfmac_f32_16x16x64_bf16 v[36:39], v[24:27], a[96:103], v1
 v_smfmac_f32_16x16x64_bf16 v[40:43], v[24:27], a[40:47], v1
 v_cvt_pk_bf16_f32 v64, v32, v33
 v_cvt_pk_bf16_f32 v65, v34, v35
 v_smfmac_f32_16x16x64_bf16 v[44:47], v[24:27], a[104:111], v1
 v_cvt_pk_bf16_f32 v66, v36, v37
 v_cvt_pk_bf16_f32 v67, v38, v39
 s_cbranch_vccnz LhA_bad3
LhA_ok3:
 s_nop 0
 v_mfma_f32_16x16x32_bf16 v[72:75], v[64:67], v[80:83], 0
 v_cvt_pk_bf16_f32 v68, v40, v41
 v_cvt_pk_bf16_f32 v69, v42, v43
 v_cvt_pk_bf16_f32 v70, v44, v45
 v_cvt_pk_bf16_f32 v71, v46, v47
 s_nop 1
 v_mfma_f32_16x16x32_bf16 v[76:79], v[68:71], v[80:83], 0
 ds_write_b128 v9, v[72:75] offset:0
 v_smfmac_f32_16x16x64_bf16 v[48:51], v[16:19], a[128:135], v1
 v_smfmac_f32_16x16x64_bf16 v[52:55], v[16:19], a[136:143], v1
 ds_write_b128 v9, v[76:79] offset:4096
 v_smfmac_f32_16x16x64_bf16 v[48:51], v[20:23], a[144:151], v1
 s_branch LhA_join
LhA_bad3:
 s_sub_u32 s46, s46, 1
 s_cbranch_scc0 LhA_redo
 s_mov_b32 s46, 0
 s_branch LhA_ok3
LhA_miss3:
 buffer_load_dwordx4 v[28:31], v2, s[48:51], s63 offen offset:3072 sc1
 s_sub_u32 s46, s46, 1
 s_cbranch_scc0 LhA_first
 s_mov_b32 s46, 0
 s_branch LhA_late
LhA_late:
 s_waitcnt vmcnt(3)
 s_branch LhA_got0
LhA_redo:
 buffer_load_dwordx4 v[16:19], v2, s[48:51], s63 offen offset:0 sc1
 buffer_load_dwordx4 v[20:23], v2, s[48:51], s63 offen offset:1024 sc1
 buffer_load_dwordx4 v[24:27], v2, s[48:51], s63 offen offset:2048 sc1
 buffer_load_dwordx4 v[28:31], v2, s[48:51], s63 offen offset:3072 sc1
 v_mov_b64 v[32:33], 0
 v_mov_b64 v[34:35], 0
 v_mov_b64 v[36:37], 0
 v_mov_b64 v[38:39], 0
 v_mov_b64 v[40:41], 0
 v_mov_b64 v[42:43], 0
 v_mov_b64 v[44:45], 0
 v_mov_b64 v[46:47], 0
 s_branch LhA_first
LhA_join:
 v_smfmac_f32_16x16x64_bf16 v[52:55], v[20:23], a[152:159], v1
 s_waitcnt lgkmcnt(0)
 s_barrier
 v_smfmac_f32_16x16x64_bf16 v[48:51], v[24:27], a[160:167], v1
 v_smfmac_f32_16x16x64_bf16 v[52:55], v[24:27], a[168:175], v1
 v_smfmac_f32_16x16x64_bf16 v[48:51], v[28:31], a[176:183], v1
 v_smfmac_f32_16x16x64_bf16 v[52:55], v[28:31], a[184:191], v1
 s_nop 3
 v_cvt_pk_bf16_f32 v64, v48, v49
 v_cvt_pk_bf16_f32 v65, v50, v51
 s_nop 1
 v_cvt_pk_bf16_f32 v66, v52, v53
 v_cvt_pk_bf16_f32 v67, v54, v55
 ds_write_b128 v9, v[64:67] offset:8192
 s_xor_b32 s63, s63, 0x8000
 s_waitcnt lgkmcnt(0)
 s_barrier
 s_cmp_eq_u32 s60, 63
 s_cbranch_scc1 L_chain_done
 s_add_u32 s80, s60, 2
 s_add_u32 s76, s76, 0x40000
 s_barrier
 buffer_load_dwordx4 v[16:19], v2, s[48:51], s65 offen offset:0 sc1
 v_mov_b32 v56, 0
 v_mov_b32 v57, 0
 v_mov_b32 v58, 0
 v_mov_b32 v59, 0
 s_nop 12
 buffer_load_dwordx4 v[20:23], v2, s[48:51], s65 offen offset:1024 sc1
 v_mov_b32 v60, 0
 v_mov_b32 v61, 0
 v_mov_b32 v62, 0
 v_mov_b32 v63, 0
 s_nop 12
 buffer_load_dwordx4 v[24:27], v2, s[48:51], s65 offen offset:2048 sc1
 v_mov_b32 v68, 0
 v_mov_b32 v69, 0
 v_mov_b32 v70, 0
 v_mov_b32 v71, 0
 s_nop 12
 buffer_load_dwordx4 v[28:31], v2, s[48:51], s65 offen offset:3072 sc1
LhF_first:
 s_waitcnt vmcnt(3)
 v_cmp_eq_u32 vcc, -1, v16
 s_cbranch_vccnz LhF_miss0
LhF_got0:
 v_smfmac_f32_16x16x64_bf16 v[56:59], v[16:19], a[192:199], v1
 v_smfmac_f32_16x16x64_bf16 v[60:63], v[16:19], a[200:207], v1
 s_waitcnt vmcnt(2)
 v_smfmac_f32_16x16x64_bf16 v[56:59], v[20:23], a[208:215], v1
 v_mov_b32 v8, v20
 v_smfmac_f32_16x16x64_bf16 v[60:63], v[20:23], a[216:223], v1
 s_waitcnt vmcnt(1)
 v_smfmac_f32_16x16x64_bf16 v[56:59], v[24:27], a[224:231], v1
 v_max_u32 v8, v8, v24
 v_smfmac_f32_16x16x64_bf16 v[60:63], v[24:27], a[232:239], v1
 s_waitcnt vmcnt(0)
 v_smfmac_f32_16x16x64_bf16 v[56:59], v[28:31], a[240:247], v1
 v_max_u32 v8, v8, v28
 v_cmp_eq_u32 vcc, -1, v8
 v_smfmac_f32_16x16x64_bf16 v[60:63], v[28:31], a[248:255], v1
 s_cbranch_vccnz LhF_bad0
LhF_ok0:
 s_nop 2
 v_cvt_pk_bf16_f32 v64, v56, v57
 v_cvt_pk_bf16_f32 v65, v58, v59
 s_nop 1
 v_cvt_pk_bf16_f32 v66, v60, v61
 v_cvt_pk_bf16_f32 v67, v62, v63
 ds_write_b128 v9, v[64:67] offset:12288
 s_branch LhF_join
LhF_bad0:
 s_sub_u32 s46, s46, 1
 s_cbranch_scc0 LhF_redo
 s_mov_b32 s46, 0
 s_branch LhF_ok0
LhF_miss0:
 buffer_load_dwordx4 v[16:19], v2, s[48:51], s65 offen offset:0 sc1
 s_waitcnt vmcnt(3)
 v_cmp_eq_u32 vcc, -1, v20
 s_cbranch_vccnz LhF_miss1
LhF_got1:
 v_smfmac_f32_16x16x64_bf16 v[56:59], v[20:23], a[208:215], v1
 v_smfmac_f32_16x16x64_bf16 v[60:63], v[20:23], a[216:223], v1
 s_waitcnt vmcnt(2)
 v_smfmac_f32_16x16x64_bf16 v[56:59], v[24:27], a[224:231], v1
 v_mov_b32 v8, v24
 v_smfmac_f32_16x16x64_bf16 v[60:63], v[24:27], a[232:239], v1
 s_waitcnt vmcnt(1)
 v_smfmac_f32_16x16x64_bf16 v[56:59], v[28:31], a[240:247], v1
 v_max_u32 v8, v8, v28
 v_smfmac_f32_16x16x64_bf16 v[60:63], v[28:31], a[248:255], v1
 s_waitcnt vmcnt(0)
 v_smfmac_f32_16x16x64_bf16 v[56:59], v[16:19], a[192:199], v1
 v_max_u32 v8, v8, v16
 v_cmp_eq_u32 vcc, -1, v8
 v_smfmac_f32_16x16x64_bf16 v[60:63], v[16:19], a[200:207], v1
 s_cbranch_vccnz LhF_bad1
LhF_ok1:
 s_nop 2
 v_cvt_pk_bf16_f32 v64, v56, v57
 v_cvt_pk_bf16_f32 v65, v58, v59
 s_nop 1
 v_cvt_pk_bf16_f32 v66, v60, v61
 v_cvt_pk_bf16_f32 v67, v62, v63
 ds_write_b128 v9, v[64:67] offset:12288
 s_branch LhF_join
LhF_bad1:
 s_sub_u32 s46, s46, 1
 s_cbranch_scc0 LhF_redo
 s_mov_b32 s46, 0
 s_branch LhF_ok1
LhF_miss1:
 buffer_load_dwordx4 v[20:23], v2, s[48:51], s65 offen offset:1024 sc1
 s_waitcnt vmcnt(3)
 v_cmp_eq_u32 vcc, -1, v24
 s_cbranch_vccnz LhF_miss2
LhF_got2:
 v_smfmac_f32_16x16x64_bf16 v[56:59], v[24:27], a[224:231], v1
 v_smfmac_f32_16x16x64_bf16 v[60:63], v[24:27], a[232:239], v1
 s_waitcnt vmcnt(2)
 v_smfmac_f32_16x16x64_bf16 v[56:59], v[28:31], a[240:247], v1
 v_mov_b32 v8, v28
 v_smfmac_f32_16x16x64_bf16 v[60:63], v[28:31], a[248:255], v1
 s_waitcnt vmcnt(1)
 v_smfmac_f32_16x16x64_bf16 v[56:59], v[16:19], a[192:199], v1
 v_max_u32 v8, v8, v16
 v_smfmac_f32_16x16x64_bf16 v[60:63], v[16:19], a[200:207], v1
 s_waitcnt vmcnt(0)
 v_smfmac_f32_16x16x64_bf16 v[56:59], v[20:23], a[208:215], v1
 v_max_u32 v8, v8, v20
 v_cmp_eq_u32 vcc, -1, v8
 v_smfmac_f32_16x16x64_bf16 v[60:63], v[20:23], a[216:223], v1
 s_cbranch_vccnz LhF_bad2
LhF_ok2:
 s_nop 2
 v_cvt_pk_bf16_f32 v64, v56, v57
 v_cvt_pk_bf16_f32 v65, v58, v59
 s_nop 1
 v_cvt_pk_bf16_f32 v66, v60, v61
 v_cvt_pk_bf16_f32 v67, v62, v63
 ds_write_b128 v9, v[64:67] offset:12288
 s_branch LhF_join
LhF_bad2:
 s_sub_u32 s46, s46, 1
 s_cbranch_scc0 LhF_redo
 s_mov_b32 s46, 0
 s_branch LhF_ok2
LhF_miss2:
 buffer_load_dwordx4 v[24:27], v2, s[48:51], s65 offen offset:2048 sc1
 s_waitcnt vmcnt(3)
 v_cmp_eq_u32 vcc, -1, v28
 s_cbranch_vccnz LhF_miss3
LhF_got3:
 v_smfmac_f32_16x16x64_bf16 v[56:59], v[28:31], a[240:247], v1
 v_smfmac_f32_16x16x64_bf16 v[60:63], v[28:31], a[248:255], v1
 s_waitcnt vmcnt(2)
 v_smfmac_f32_16x16x64_bf16 v[56:59], v[16:19], a[192:199], v1
 v_mov_b32 v8, v16
 v_smfmac_f32_16x16x64_bf16 v[60:63], v[16:19], a[200:207], v1
 s_waitcnt vmcnt(1)
 v_smfmac_f32_16x16x64_bf16 v[56:59], v[20:23], a[208:215], v1
 v_max_u32 v8, v8, v20
 v_smfmac_f32_16x16x64_bf16 v[60:63], v[20:23], a[216:223], v1
 s_waitcnt vmcnt(0)
 v_smfmac_f32_16x16x64_bf16 v[56:59], v[24:27], a[224:231], v1
 v_max_u32 v8, v8, v24
 v_cmp_eq_u32 vcc, -1, v8
 v_smfmac_f32_16x16x64_bf16 v[60:63], v[24:27], a[232:239], v1
 s_cbranch_vccnz LhF_bad3
LhF_ok3:
 s_nop 2
 v_cvt_pk_bf16_f32 v64, v56, v57
 v_cvt_pk_bf16_f32 v65, v58, v59
 s_nop 1
 v_cvt_pk_bf16_f32 v66, v60, v61
 v_cvt_pk_bf16_f32 v67, v62, v63
 ds_write_b128 v9, v[64:67] offset:12288
 s_branch LhF_join
LhF_bad3:
 s_sub_u32 s46, s46, 1
 s_cbranch_scc0 LhF_redo
 s_mov_b32 s46, 0
 s_branch LhF_ok3
LhF_miss3:
 buffer_load_dwordx4 v[28:31], v2, s[48:51], s65 offen offset:3072 sc1
 s_sub_u32 s46, s46, 1
 s_cbranch_scc0 LhF_first
 s_mov_b32 s46, 0
 s_branch LhF_late
LhF_late:
 s_waitcnt vmcnt(3)
 s_branch LhF_got0
LhF_redo:
 buffer_load_dwordx4 v[16:19], v2, s[48:51], s65 offen offset:0 sc1
 buffer_load_dwordx4 v[20:23], v2, s[48:51], s65 offen offset:1024 sc1
 buffer_load_dwordx4 v[24:27], v2, s[48:51], s65 offen offset:2048 sc1
 buffer_load_dwordx4 v[28:31], v2, s[48:51], s65 offen offset:3072 sc1
 v_mov_b64 v[56:57], 0
 v_mov_b64 v[58:59], 0
 v_mov_b64 v[60:61], 0
 v_mov_b64 v[62:63], 0
 s_branch LhF_first
LhF_join:
 s_cmp_ge_u32 s4, 2
 s_cbranch_scc1 Lh_w23
 s_cmp_ge_u32 s61, s80
 s_cbranch_scc0 Lh_kvwait
 s_waitcnt lgkmcnt(0)
 s_barrier
Lh_kvok:
 s_add_u32 s79, s76, 16777216
 s_mov_b32 m0, 16384
 s_nop 0
 buffer_load_dwordx4 v5, s[48:51], s76 offen sc1 lds
 s_mov_b32 m0, 17280
 s_nop 0
 buffer_load_dwordx4 v5, s[48:51], s76 offen offset:128 sc1 lds
 s_mov_b32 m0, 18432
 s_nop 0
 buffer_load_dwordx4 v5, s[48:51], s79 offen sc1 lds
 s_mov_b32 m0, 19328
 s_nop 0
 buffer_load_dwordx4 v5, s[48:51], s79 offen offset:128 sc1 lds
 s_add_u32 s80, s80, 2
 s_min_u32 s80, s80, 64
 s_cmp_ge_u32 s61, s80
 s_cbranch_scc1 Lh_next
 s_mov_b32 s80, 0
kv_6:
 v_mov_b32 v11, 0
 buffer_load_dwordx2 v[14:15], v11, s[48:51], s78 offen sc1
 s_waitcnt vmcnt(0)
 v_min_u32 v10, v14, v15
 s_nop 0
 v_readfirstlane_b32 s61, v10
 s_nop 0
 s_cmp_ge_u32 s61, s80
 s_cbranch_scc1 kvok_7
 s_sub_u32 s46, s46, 1
 s_cbranch_scc0 kv_6
 s_mov_b32 s46, 0
 s_branch kvok_7
kvok_7:
 s_branch Lh_next
Lh_kvwait:
 s_waitcnt lgkmcnt(0)
 s_barrier
kv_8:
 v_mov_b32 v11, 0
 buffer_load_dwordx2 v[14:15], v11, s[48:51], s78 offen sc1
 s_waitcnt vmcnt(0)
 v_min_u32 v10, v14, v15
 s_nop 0
 v_readfirstlane_b32 s61, v10
 s_nop 0
 s_cmp_ge_u32 s61, s80
 s_cbranch_scc1 kvok_9
 s_sub_u32 s46, s46, 1
 s_cbranch_scc0 kv_8
 s_mov_b32 s46, 0
 s_branch kvok_9
kvok_9:
 s_branch Lh_kvok
Lh_w23:
 s_xor_b32 s66, s66, 0x8000
 s_cmp_eq_u32 s4, 2
 s_waitcnt lgkmcnt(0)
 s_barrier
Lh_next:
 s_waitcnt vmcnt(0)
 s_xor_b32 s65, s65, 0x8000
 s_add_u32 s60, s60, 1
 s_branch Lh_step
Ll_step:
 s_waitcnt vmcnt(4)
 v_mfma_f32_16x16x32_bf16 v[228:231], v[184:187], v[240:243], v[224:227]
 s_waitcnt vmcnt(3)
 v_mfma_f32_16x16x32_bf16 v[228:231], v[184:187], v[244:247], v[228:231]
 v_max3_u32 v8, v240, v242, v244
 v_cmp_eq_u32 vcc, -1, v8
 s_cbranch_vccnz Ll_redoH
Ll_okH:
 s_nop 6
 v_cvt_pk_bf16_f32 v220, v228, v229
 v_cvt_pk_bf16_f32 v221, v230, v231
 buffer_store_dwordx2 v[220:221], v4, s[48:51], s64 offen
 s_xor_b32 s64, s64, 0x8000
 s_nop 15
 s_nop 3
 s_barrier
 buffer_load_dwordx4 v[16:19], v2, s[48:51], s63 offen offset:0 sc1
 v_mov_b64 v[32:33], 0
 v_mov_b64 v[34:35], 0
 v_mov_b64 v[36:37], 0
 v_mov_b64 v[38:39], 0
 ds_read_b128 v[124:127], v2 offset:16384
 ds_read_b128 v[128:131], v2 offset:17408
 s_nop 10
 buffer_load_dwordx4 v[20:23], v2, s[48:51], s63 offen offset:1024 sc1
 v_mov_b64 v[40:41], 0
 v_mov_b64 v[42:43], 0
 v_mov_b64 v[44:45], 0
 v_mov_b64 v[46:47], 0
 ds_read_b128 v[132:135], v2 offset:18432
 ds_read_b128 v[136:139], v2 offset:19456
 s_nop 10
 buffer_load_dwordx4 v[24:27], v2, s[48:51], s63 offen offset:2048 sc1
 v_mov_b64 v[48:49], 0
 v_mov_b64 v[50:51], 0
 v_mov_b64 v[52:53], 0
 v_mov_b64 v[54:55], 0
 s_nop 12
 buffer_load_dwordx4 v[28:31], v2, s[48:51], s63 offen offset:3072 sc1
LlA_first:
 s_waitcnt vmcnt(3)
 v_max_u32 v8, v16, v18
 v_cmp_eq_u32 vcc, -1, v8
 s_cbranch_vccnz LlA_miss0
LlA_got0:
 v_smfmac_f32_16x16x64_bf16 v[32:35], v[16:19], a[0:7], v1
 v_smfmac_f32_16x16x64_bf16 v[36:39], v[16:19], a[64:71], v1
 v_smfmac_f32_16x16x64_bf16 v[40:43], v[16:19], a[8:15], v1
 v_smfmac_f32_16x16x64_bf16 v[44:47], v[16:19], a[72:79], v1
 s_waitcnt vmcnt(2)
 v_smfmac_f32_16x16x64_bf16 v[32:35], v[20:23], a[16:23], v1
 v_max3_u32 v8, v8, v20, v22
 v_smfmac_f32_16x16x64_bf16 v[36:39], v[20:23], a[80:87], v1
 v_smfmac_f32_16x16x64_bf16 v[40:43], v[20:23], a[24:31], v1
 v_smfmac_f32_16x16x64_bf16 v[44:47], v[20:23], a[88:95], v1
 s_waitcnt vmcnt(1)
 v_smfmac_f32_16x16x64_bf16 v[32:35], v[24:27], a[32:39], v1
 v_max3_u32 v8, v8, v24, v26
 v_smfmac_f32_16x16x64_bf16 v[36:39], v[24:27], a[96:103], v1
 v_smfmac_f32_16x16x64_bf16 v[40:43], v[24:27], a[40:47], v1
 v_smfmac_f32_16x16x64_bf16 v[44:47], v[24:27], a[104:111], v1
 s_waitcnt vmcnt(0)
 v_smfmac_f32_16x16x64_bf16 v[32:35], v[28:31], a[48:55], v1
 v_max3_u32 v8, v8, v28, v30
 v_cmp_eq_u32 vcc, -1, v8
 v_smfmac_f32_16x16x64_bf16 v[36:39], v[28:31], a[112:119], v1
 v_smfmac_f32_16x16x64_bf16 v[40:43], v[28:31], a[56:63], v1
 v_cvt_pk_bf16_f32 v64, v32, v33
 v_cvt_pk_bf16_f32 v65, v34, v35
 v_smfmac_f32_16x16x64_bf16 v[44:47], v[28:31], a[120:127], v1
 v_cvt_pk_bf16_f32 v66, v36, v37
 v_cvt_pk_bf16_f32 v67, v38, v39
 s_cbranch_vccnz LlA_bad0
LlA_ok0:
 s_nop 0
 v_mfma_f32_16x16x32_bf16 v[72:75], v[64:67], v[80:83], 0
 v_cvt_pk_bf16_f32 v68, v40, v41
 v_cvt_pk_bf16_f32 v69, v42, v43
 v_cvt_pk_bf16_f32 v70, v44, v45
 v_cvt_pk_bf16_f32 v71, v46, v47
 s_nop 1
 v_mfma_f32_16x16x32_bf16 v[76:79], v[68:71], v[80:83], 0
 v_smfmac_f32_16x16x64_bf16 v[48:51], v[16:19], a[128:135], v1
 v_mul_f32 v72, v12, v72
 v_mul_f32 v73, v12, v73
 v_smfmac_f32_16x16x64_bf16 v[52:55], v[16:19], a[136:143], v1
 v_mul_f32 v74, v12, v74
 v_mul_f32 v75, v12, v75
 s_branch LlA_join
LlA_bad0:
 s_sub_u32 s46, s46, 1
 s_cbranch_scc0 LlA_redo
 s_mov_b32 s46, 0
 s_branch LlA_ok0
LlA_miss0:
 buffer_load_dwordx4 v[16:19], v2, s[48:51], s63 offen offset:0 sc1
 s_waitcnt vmcnt(3)
 v_max_u32 v8, v20, v22
 v_cmp_eq_u32 vcc, -1, v8
 s_cbranch_vccnz LlA_miss1
LlA_got1:
 v_smfmac_f32_16x16x64_bf16 v[32:35], v[20:23], a[16:23], v1
 v_smfmac_f32_16x16x64_bf16 v[36:39], v[20:23], a[80:87], v1
 v_smfmac_f32_16x16x64_bf16 v[40:43], v[20:23], a[24:31], v1
 v_smfmac_f32_16x16x64_bf16 v[44:47], v[20:23], a[88:95], v1
 s_waitcnt vmcnt(2)
 v_smfmac_f32_16x16x64_bf16 v[32:35], v[24:27], a[32:39], v1
 v_max3_u32 v8, v8, v24, v26
 v_smfmac_f32_16x16x64_bf16 v[36:39], v[24:27], a[96:103], v1
 v_smfmac_f32_16x16x64_bf16 v[40:43], v[24:27], a[40:47], v1
 v_smfmac_f32_16x16x64_bf16 v[44:47], v[24:27], a[104:111], v1
 s_waitcnt vmcnt(1)
 v_smfmac_f32_16x16x64_bf16 v[32:35], v[28:31], a[48:55], v1
 v_max3_u32 v8, v8, v28, v30
 v_smfmac_f32_16x16x64_bf16 v[36:39], v[28:31], a[112:119], v1
 v_smfmac_f32_16x16x64_bf16 v[40:43], v[28:31], a[56:63], v1
 v_smfmac_f32_16x16x64_bf16 v[44:47], v[28:31], a[120:127], v1
 s_waitcnt vmcnt(0)
 v_smfmac_f32_16x16x64_bf16 v[32:35], v[16:19], a[0:7], v1
 v_max3_u32 v8, v8, v16, v18
 v_cmp_eq_u32 vcc, -1, v8
 v_smfmac_f32_16x16x64_bf16 v[36:39], v[16:19], a[64:71], v1
 v_smfmac_f32_16x16x64_bf16 v[40:43], v[16:19], a[8:15], v1
 v_cvt_pk_bf16_f32 v64, v32, v33
 v_cvt_pk_bf16_f32 v65, v34, v35
 v_smfmac_f32_16x16x64_bf16 v[44:47], v[16:19], a[72:79], v1
 v_cvt_pk_bf16_f32 v66, v36, v37
 v_cvt_pk_bf16_f32 v67, v38, v39
 s_cbranch_vccnz LlA_bad1
LlA_ok1:
 s_nop 0
 v_mfma_f32_16x16x32_bf16 v[72:75], v[64:67], v[80:83], 0
 v_cvt_pk_bf16_f32 v68, v40, v41
 v_cvt_pk_bf16_f32 v69, v42, v43
 v_cvt_pk_bf16_f32 v70, v44, v45
 v_cvt_pk_bf16_f32 v71, v46, v47
 s_nop 1
 v_mfma_f32_16x16x32_bf16 v[76:79], v[68:71], v[80:83], 0
 v_smfmac_f32_16x16x64_bf16 v[48:51], v[16:19], a[128:135], v1
 v_mul_f32 v72, v12, v72
 v_mul_f32 v73, v12, v73
 v_smfmac_f32_16x16x64_bf16 v[52:55], v[16:19], a[136:143], v1
 v_mul_f32 v74, v12, v74
 v_mul_f32 v75, v12, v75
 s_branch LlA_join
LlA_bad1:
 s_sub_u32 s46, s46, 1
 s_cbranch_scc0 LlA_redo
 s_mov_b32 s46, 0
 s_branch LlA_ok1
LlA_miss1:
 buffer_load_dwordx4 v[20:23], v2, s[48:51], s63 offen offset:1024 sc1
 s_waitcnt vmcnt(3)
 v_max_u32 v8, v24, v26
 v_cmp_eq_u32 vcc, -1, v8
 s_cbranch_vccnz LlA_miss2
LlA_got2:
 v_smfmac_f32_16x16x64_bf16 v[32:35], v[24:27], a[32:39], v1
 v_smfmac_f32_16x16x64_bf16 v[36:39], v[24:27], a[96:103], v1
 v_smfmac_f32_16x16x64_bf16 v[40:43], v[24:27], a[40:47], v1
 v_smfmac_f32_16x16x64_bf16 v[44:47], v[24:27], a[104:111], v1
 s_waitcnt vmcnt(2)
 v_smfmac_f32_16x16x64_bf16 v[32:35], v[28:31], a[48:55], v1
 v_max3_u32 v8, v8, v28, v30
 v_smfmac_f32_16x16x64_bf16 v[36:39], v[28:31], a[112:119], v1
 v_smfmac_f32_16x16x64_bf16 v[40:43], v[28:31], a[56:63], v1
 v_smfmac_f32_16x16x64_bf16 v[44:47], v[28:31], a[120:127], v1
 s_waitcnt vmcnt(1)
 v_smfmac_f32_16x16x64_bf16 v[32:35], v[16:19], a[0:7], v1
 v_max3_u32 v8, v8, v16, v18
 v_smfmac_f32_16x16x64_bf16 v[36:39], v[16:19], a[64:71], v1
 v_smfmac_f32_16x16x64_bf16 v[40:43], v[16:19], a[8:15], v1
 v_smfmac_f32_16x16x64_bf16 v[44:47], v[16:19], a[72:79], v1
 s_waitcnt vmcnt(0)
 v_smfmac_f32_16x16x64_bf16 v[32:35], v[20:23], a[16:23], v1
 v_max3_u32 v8, v8, v20, v22
 v_cmp_eq_u32 vcc, -1, v8
 v_smfmac_f32_16x16x64_bf16 v[36:39], v[20:23], a[80:87], v1
 v_smfmac_f32_16x16x64_bf16 v[40:43], v[20:23], a[24:31], v1
 v_cvt_pk_bf16_f32 v64, v32, v33
 v_cvt_pk_bf16_f32 v65, v34, v35
 v_smfmac_f32_16x16x64_bf16 v[44:47], v[20:23], a[88:95], v1
 v_cvt_pk_bf16_f32 v66, v36, v37
 v_cvt_pk_bf16_f32 v67, v38, v39
 s_cbranch_vccnz LlA_bad2
LlA_ok2:
 s_nop 0
 v_mfma_f32_16x16x32_bf16 v[72:75], v[64:67], v[80:83], 0
 v_cvt_pk_bf16_f32 v68, v40, v41
 v_cvt_pk_bf16_f32 v69, v42, v43
 v_cvt_pk_bf16_f32 v70, v44, v45
 v_cvt_pk_bf16_f32 v71, v46, v47
 s_nop 1
 v_mfma_f32_16x16x32_bf16 v[76:79], v[68:71], v[80:83], 0
 v_smfmac_f32_16x16x64_bf16 v[48:51], v[16:19], a[128:135], v1
 v_mul_f32 v72, v12, v72
 v_mul_f32 v73, v12, v73
 v_smfmac_f32_16x16x64_bf16 v[52:55], v[16:19], a[136:143], v1
 v_mul_f32 v74, v12, v74
 v_mul_f32 v75, v12, v75
 s_branch LlA_join
LlA_bad2:
 s_sub_u32 s46, s46, 1
 s_cbranch_scc0 LlA_redo
 s_mov_b32 s46, 0
 s_branch LlA_ok2
LlA_miss2:
 buffer_load_dwordx4 v[24:27], v2, s[48:51], s63 offen offset:2048 sc1
 s_waitcnt vmcnt(3)
 v_max_u32 v8, v28, v30
 v_cmp_eq_u32 vcc, -1, v8
 s_cbranch_vccnz LlA_miss3
LlA_got3:
 v_smfmac_f32_16x16x64_bf16 v[32:35], v[28:31], a[48:55], v1
 v_smfmac_f32_16x16x64_bf16 v[36:39], v[28:31], a[112:119], v1
 v_smfmac_f32_16x16x64_bf16 v[40:43], v[28:31], a[56:63], v1
 v_smfmac_f32_16x16x64_bf16 v[44:47], v[28:31], a[120:127], v1
 s_waitcnt vmcnt(2)
 v_smfmac_f32_16x16x64_bf16 v[32:35], v[16:19], a[0:7], v1
 v_max3_u32 v8, v8, v16, v18
 v_smfmac_f32_16x16x64_bf16 v[36:39], v[16:19], a[64:71], v1
 v_smfmac_f32_16x16x64_bf16 v[40:43], v[16:19], a[8:15], v1
 v_smfmac_f32_16x16x64_bf16 v[44:47], v[16:19], a[72:79], v1
 s_waitcnt vmcnt(1)
 v_smfmac_f32_16x16x64_bf16 v[32:35], v[20:23], a[16:23], v1
 v_max3_u32 v8, v8, v20, v22
 v_smfmac_f32_16x16x64_bf16 v[36:39], v[20:23], a[80:87], v1
 v_smfmac_f32_16x16x64_bf16 v[40:43], v[20:23], a[24:31], v1
 v_smfmac_f32_16x16x64_bf16 v[44:47], v[20:23], a[88:95], v1
 s_waitcnt vmcnt(0)
 v_smfmac_f32_16x16x64_bf16 v[32:35], v[24:27], a[32:39], v1
 v_max3_u32 v8, v8, v24, v26
 v_cmp_eq_u32 vcc, -1, v8
 v_smfmac_f32_16x16x64_bf16 v[36:39], v[24:27], a[96:103], v1
 v_smfmac_f32_16x16x64_bf16 v[40:43], v[24:27], a[40:47], v1
 v_cvt_pk_bf16_f32 v64, v32, v33
 v_cvt_pk_bf16_f32 v65, v34, v35
 v_smfmac_f32_16x16x64_bf16 v[44:47], v[24:27], a[104:111], v1
 v_cvt_pk_bf16_f32 v66, v36, v37
 v_cvt_pk_bf16_f32 v67, v38, v39
 s_cbranch_vccnz LlA_bad3
LlA_ok3:
 s_nop 0
 v_mfma_f32_16x16x32_bf16 v[72:75], v[64:67], v[80:83], 0
 v_cvt_pk_bf16_f32 v68, v40, v41
 v_cvt_pk_bf16_f32 v69, v42, v43
 v_cvt_pk_bf16_f32 v70, v44, v45
 v_cvt_pk_bf16_f32 v71, v46, v47
 s_nop 1
 v_mfma_f32_16x16x32_bf16 v[76:79], v[68:71], v[80:83], 0
 v_smfmac_f32_16x16x64_bf16 v[48:51], v[16:19], a[128:135], v1
 v_mul_f32 v72, v12, v72
 v_mul_f32 v73, v12, v73
 v_smfmac_f32_16x16x64_bf16 v[52:55], v[16:19], a[136:143], v1
 v_mul_f32 v74, v12, v74
 v_mul_f32 v75, v12, v75
 s_branch LlA_join
LlA_bad3:
 s_sub_u32 s46, s46, 1
 s_cbranch_scc0 LlA_redo
 s_mov_b32 s46, 0
 s_branch LlA_ok3
LlA_miss3:
 buffer_load_dwordx4 v[28:31], v2, s[48:51], s63 offen offset:3072 sc1
 s_sub_u32 s46, s46, 1
 s_cbranch_scc0 LlA_first
 s_mov_b32 s46, 0
 s_branch LlA_late
LlA_late:
 s_waitcnt vmcnt(3)
 s_branch LlA_got0
LlA_redo:
 buffer_load_dwordx4 v[16:19], v2, s[48:51], s63 offen offset:0 sc1
 buffer_load_dwordx4 v[20:23], v2, s[48:51], s63 offen offset:1024 sc1
 buffer_load_dwordx4 v[24:27], v2, s[48:51], s63 offen offset:2048 sc1
 buffer_load_dwordx4 v[28:31], v2, s[48:51], s63 offen offset:3072 sc1
 v_mov_b64 v[32:33], 0
 v_mov_b64 v[34:35], 0
 v_mov_b64 v[36:37], 0
 v_mov_b64 v[38:39], 0
 v_mov_b64 v[40:41], 0
 v_mov_b64 v[42:43], 0
 v_mov_b64 v[44:45], 0
 v_mov_b64 v[46:47], 0
 s_branch LlA_first
LlA_join:
 v_smfmac_f32_16x16x64_bf16 v[48:51], v[20:23], a[144:151], v1
 v_mul_f32 v76, v12, v76
 v_mul_f32 v77, v12, v77
 v_smfmac_f32_16x16x64_bf16 v[52:55], v[20:23], a[152:159], v1
 v_mul_f32 v78, v12, v78
 v_mul_f32 v79, v12, v79
 s_cmp_eq_u32 s60, 63
 v_smfmac_f32_16x16x64_bf16 v[48:51], v[24:27], a[160:167], v1
 s_cbranch_scc1 Ll_last
 v_smfmac_f32_16x16x64_bf16 v[52:55], v[24:27], a[168:175], v1
 s_barrier
 ds_read_b128 v[96:99], v2 offset:1024
 ds_read_b128 v[100:103], v2 offset:2048
 ds_read_b128 v[104:107], v2 offset:3072
 ds_read_b128 v[108:111], v2 offset:5120
 ds_read_b128 v[112:115], v2 offset:6144
 ds_read_b128 v[116:119], v2 offset:7168
 s_waitcnt lgkmcnt(5)
 v_pk_fma_f32 v[72:73], v[96:97], v[12:13], v[72:73]
 v_pk_fma_f32 v[74:75], v[98:99], v[12:13], v[74:75]
 s_waitcnt lgkmcnt(3)
 v_pk_fma_f32 v[72:73], v[100:101], v[12:13], v[72:73]
 v_pk_fma_f32 v[74:75], v[102:103], v[12:13], v[74:75]
 v_pk_fma_f32 v[72:73], v[104:105], v[12:13], v[72:73]
 v_pk_fma_f32 v[74:75], v[106:107], v[12:13], v[74:75]
 v_cvt_pk_bf16_f32 v120, v72, v73
 v_cvt_pk_bf16_f32 v121, v74, v75
 s_waitcnt lgkmcnt(0)
 v_pk_fma_f32 v[76:77], v[108:109], v[12:13], v[76:77]
 v_pk_fma_f32 v[78:79], v[110:111], v[12:13], v[78:79]
 v_pk_fma_f32 v[76:77], v[112:113], v[12:13], v[76:77]
 v_pk_fma_f32 v[78:79], v[114:115], v[12:13], v[78:79]
 v_pk_fma_f32 v[76:77], v[116:117], v[12:13], v[76:77]
 v_pk_fma_f32 v[78:79], v[118:119], v[12:13], v[78:79]
 v_cvt_pk_bf16_f32 v122, v76, v77
 v_cvt_pk_bf16_f32 v123, v78, v79
 s_nop 1
 v_mfma_f32_16x16x32_bf16 v[140:143], v[124:127], v[120:123], 0
 v_mfma_f32_16x16x32_bf16 v[144:147], v[128:131], v[120:123], 0
 v_mfma_f32_16x16x32_bf16 v[148:151], v[120:123], v[120:123], 0
 s_mov_b64 exec, s[82:83]
 buffer_store_dwordx4 v[140:143], v2, s[48:51], s67 offen
 s_nop 1
 buffer_store_dwordx4 v[144:147], v2, s[48:51], s67 offen offset:128
 s_nop 2
 buffer_store_dwordx4 v[148:151], v2, s[48:51], s67 offen offset:1024
 s_mov_b64 exec, -1
 v_smfmac_f32_16x16x64_bf16 v[48:51], v[28:31], a[176:183], v1
 v_smfmac_f32_16x16x64_bf16 v[52:55], v[28:31], a[184:191], v1
 v_mov_b32_dpp v140, v144 row_ror:8 row_mask:0xf bank_mask:0xc
 v_mov_b32_dpp v141, v145 row_ror:8 row_mask:0xf bank_mask:0xc
 v_mov_b32_dpp v142, v146 row_ror:8 row_mask:0xf bank_mask:0xc
 v_mov_b32_dpp v143, v147 row_ror:8 row_mask:0xf bank_mask:0xc
 s_nop 9
 buffer_load_dwordx4 v[152:155], v2, s[48:51], s68 offen sc1
 buffer_load_dwordx4 v[156:159], v2, s[48:51], s69 offen sc1
 buffer_load_dwordx4 v[160:163], v2, s[48:51], s70 offen sc1
 buffer_load_dword v164, v6, s[48:51], s67 offen sc1
 buffer_load_dword v165, v6, s[48:51], s68 offen sc1
 buffer_load_dword v166, v6, s[48:51], s69 offen sc1
 buffer_load_dword v167, v6, s[48:51], s70 offen sc1
 v_cvt_pk_bf16_f32 v64, v48, v49
 v_cvt_pk_bf16_f32 v65, v50, v51
 v_cvt_pk_bf16_f32 v66, v52, v53
 v_cvt_pk_bf16_f32 v67, v54, v55
 s_barrier
 ds_read_b128 v[96:99], v2 offset:9216
 ds_read_b128 v[100:103], v2 offset:10240
 ds_read_b128 v[104:107], v2 offset:11264
 v_mfma_f32_16x16x32_bf16 v[204:207], v[84:87], v[64:67], 0
 buffer_load_dwordx4 v[168:171], v2, s[48:51], s68 offen sc1
 buffer_load_dwordx4 v[172:175], v2, s[48:51], s69 offen sc1
 buffer_load_dwordx4 v[176:179], v2, s[48:51], s70 offen sc1
 buffer_load_dword v180, v6, s[48:51], s67 offen sc1
 buffer_load_dword v181, v6, s[48:51], s68 offen sc1
 buffer_load_dword v182, v6, s[48:51], s69 offen sc1
 buffer_load_dword v183, v6, s[48:51], s70 offen sc1
 s_waitcnt lgkmcnt(2)
 v_mfma_f32_16x16x32_bf16 v[204:207], v[84:87], v[96:99], v[204:207]
 s_waitcnt lgkmcnt(1)
 v_mfma_f32_16x16x32_bf16 v[204:207], v[84:87], v[100:103], v[204:207]
 s_waitcnt lgkmcnt(0)
 v_mfma_f32_16x16x32_bf16 v[204:207], v[84:87], v[104:107], v[204:207]
 buffer_load_dwordx4 v[16:19], v2, s[48:51], s68 offen sc1
 buffer_load_dwordx4 v[20:23], v2, s[48:51], s69 offen sc1
 buffer_load_dwordx4 v[24:27], v2, s[48:51], s70 offen sc1
 buffer_load_dword v28, v6, s[48:51], s67 offen sc1
 buffer_load_dword v29, v6, s[48:51], s68 offen sc1
 buffer_load_dword v30, v6, s[48:51], s69 offen sc1
 buffer_load_dword v31, v6, s[48:51], s70 offen sc1
 v_cvt_pk_bf16_f32 v188, v204, v205
 v_cvt_pk_bf16_f32 v192, v206, v207
 s_waitcnt vmcnt(20)
 v_pk_add_f32 v[228:229], v[140:141], v[152:153]
 v_pk_add_f32 v[230:231], v[142:143], v[154:155]
 s_waitcnt vmcnt(18)
 v_pk_add_f32 v[216:217], v[156:157], v[160:161]
 v_pk_add_f32 v[218:219], v[158:159], v[162:163]
 v_max3_u32 v8, v152, v156, v160
 v_pk_add_f32 v[228:229], v[228:229], v[216:217]
 v_pk_add_f32 v[230:231], v[230:231], v[218:219]
 s_waitcnt vmcnt(14)
 v_max3_u32 v8, v8, v164, v165
 v_max3_u32 v8, v8, v166, v167
 v_cmp_eq_u32 vcc, -1, v8
 v_add_f32 v216, v164, v165
 v_add_f32 v217, v166, v167
 v_max3_f32 v236, v228, v229, v230
 v_add_f32 v232, v216, v217
 v_max3_f32 v236, v236, v231, v232
 s_cbranch_vccnz Ll_redoD
Ll_okD:
 s_nop 0
 v_max_f32_dpp v236, v236, v236 row_ror:8 row_mask:0xf bank_mask:0xf
 v_mov_b32 v216, v236
 s_nop 1
 v_permlane16_swap_b32 v236, v216
 v_max_f32 v236, v236, v216
 v_mov_b32 v216, v236
 s_nop 1
 v_permlane32_swap_b32 v236, v216
 v_max_f32 v236, v236, v216
 v_sub_f32 v232, v232, v236
 v_pk_add_f32 v[228:229], v[228:229], v[236:237] op_sel_hi:[1,0] neg_lo:[0,1] neg_hi:[0,1]
 v_exp_f32 v232, v232
 v_pk_add_f32 v[230:231], v[230:231], v[236:237] op_sel_hi:[1,0] neg_lo:[0,1] neg_hi:[0,1]
 v_exp_f32 v228, v228
 v_mov_b32_dpp v216, v232 row_ror:8 row_mask:0xf bank_mask:0xf
 v_exp_f32 v229, v229
 v_cvt_pk_bf16_f32 v200, v232, v216
 v_exp_f32 v230, v230
 v_exp_f32 v231, v231
 v_mfma_f32_16x16x32_bf16 v[204:207], v[88:91], v[200:203], 0
 v_cvt_pk_bf16_f32 v196, v228, v229
 v_cvt_pk_bf16_f32 v197, v230, v231
 v_mfma_f32_16x16x32_bf16 v[208:211], v[188:191], v[200:203], 0
 v_mov_b32_dpp v198, v196 row_ror:8 row_mask:0xf bank_mask:0xf
 v_mov_b32_dpp v199, v197 row_ror:8 row_mask:0xf bank_mask:0xf
 v_mfma_f32_16x16x32_bf16 v[212:215], v[192:195], v[200:203], 0
 v_mfma_f32_16x16x32_bf16 v[204:207], v[88:91], v[196:199], v[204:207]
 v_mfma_f32_16x16x32_bf16 v[208:211], v[132:135], v[196:199], v[208:211]
 v_mfma_f32_16x16x32_bf16 v[212:215], v[136:139], v[196:199], v[212:215]
 v_rcp_f32 v236, v204
 s_mov_b64 exec, s[82:83]
 v_mul_f32 v208, v236, v208
 v_mul_f32 v209, v236, v209
 v_mul_f32 v210, v236, v210
 v_mul_f32 v211, v236, v211
 v_cvt_pk_bf16_f32 v216, v208, v209
 v_cvt_pk_bf16_f32 v217, v210, v211
 v_pk_mul_f32 v[212:213], v[212:213], v[236:237] op_sel_hi:[1,0]
 v_pk_mul_f32 v[214:215], v[214:215], v[236:237] op_sel_hi:[1,0]
 v_cvt_pk_bf16_f32 v218, v212, v213
 v_cvt_pk_bf16_f32 v219, v214, v215
 buffer_store_dwordx4 v[216:219], v3, s[48:51], s66 offen
 s_mov_b64 exec, -1
 s_nop 15
 s_nop 3
 s_barrier
 buffer_load_dwordx4 v[16:19], v2, s[48:51], s65 offen offset:0 sc1
 v_mov_b32 v56, 0
 v_mov_b32 v57, 0
 v_mov_b32 v58, 0
 v_mov_b32 v59, 0
 v_mov_b32 v60, 0
 v_mov_b32 v61, 0
 v_mov_b32 v62, 0
 v_mov_b32 v63, 0
 v_mov_b32_dpp v120, v188 quad_perm:[0,1,2,3] row_mask:0xf bank_mask:0x3
 v_mov_b32_dpp v121, v192 quad_perm:[0,1,2,3] row_mask:0xf bank_mask:0x3
 v_mov_b32_dpp v122, v188 row_ror:8 row_mask:0xf bank_mask:0x3
 v_mov_b32_dpp v123, v192 row_ror:8 row_mask:0xf bank_mask:0x3
 s_nop 4
 buffer_load_dwordx4 v[20:23], v2, s[48:51], s65 offen offset:1024 sc1
 s_lshl_b32 s79, s60, 18
 s_and_b32 s80, s60, 8
 s_lshl_b32 s80, s80, 10
 s_add_u32 s72, s71, s79
 s_xor_b32 s72, s72, s80
 s_add_u32 s77, s87, s79
 s_xor_b32 s77, s77, s80
 s_xor_b32 s73, s72, 1024
 s_xor_b32 s74, s72, 2048
 s_xor_b32 s75, s72, 3072
 s_nop 6
 buffer_load_dwordx4 v[24:27], v2, s[48:51], s65 offen offset:2048 sc1
 s_nop 15
 s_nop 0
 buffer_load_dwordx4 v[28:31], v2, s[48:51], s65 offen offset:3072 sc1
LlF_first:
 s_waitcnt vmcnt(3)
 v_cmp_eq_u32 vcc, -1, v16
 s_cbranch_vccnz LlF_miss0
LlF_got0:
 v_smfmac_f32_16x16x64_bf16 v[56:59], v[16:19], a[192:199], v1
 v_smfmac_f32_16x16x64_bf16 v[60:63], v[16:19], a[200:207], v1
 s_waitcnt vmcnt(2)
 v_smfmac_f32_16x16x64_bf16 v[56:59], v[20:23], a[208:215], v1
 v_mov_b32 v8, v20
 v_smfmac_f32_16x16x64_bf16 v[60:63], v[20:23], a[216:223], v1
 s_waitcnt vmcnt(1)
 v_smfmac_f32_16x16x64_bf16 v[56:59], v[24:27], a[224:231], v1
 v_max_u32 v8, v8, v24
 v_smfmac_f32_16x16x64_bf16 v[60:63], v[24:27], a[232:239], v1
 s_waitcnt vmcnt(0)
 v_smfmac_f32_16x16x64_bf16 v[56:59], v[28:31], a[240:247], v1
 v_max_u32 v8, v8, v28
 v_cmp_eq_u32 vcc, -1, v8
 v_smfmac_f32_16x16x64_bf16 v[60:63], v[28:31], a[248:255], v1
 s_cbranch_vccnz LlF_bad0
LlF_ok0:
 s_nop 2
 v_cvt_pk_bf16_f32 v64, v56, v57
 v_cvt_pk_bf16_f32 v65, v58, v59
 s_nop 1
 v_cvt_pk_bf16_f32 v66, v60, v61
 v_cvt_pk_bf16_f32 v67, v62, v63
 s_branch LlF_join
LlF_bad0:
 s_sub_u32 s46, s46, 1
 s_cbranch_scc0 LlF_redo
 s_mov_b32 s46, 0
 s_branch LlF_ok0
LlF_miss0:
 buffer_load_dwordx4 v[16:19], v2, s[48:51], s65 offen offset:0 sc1
 s_waitcnt vmcnt(3)
 v_cmp_eq_u32 vcc, -1, v20
 s_cbranch_vccnz LlF_miss1
LlF_got1:
 v_smfmac_f32_16x16x64_bf16 v[56:59], v[20:23], a[208:215], v1
 v_smfmac_f32_16x16x64_bf16 v[60:63], v[20:23], a[216:223], v1
 s_waitcnt vmcnt(2)
 v_smfmac_f32_16x16x64_bf16 v[56:59], v[24:27], a[224:231], v1
 v_mov_b32 v8, v24
 v_smfmac_f32_16x16x64_bf16 v[60:63], v[24:27], a[232:239], v1
 s_waitcnt vmcnt(1)
 v_smfmac_f32_16x16x64_bf16 v[56:59], v[28:31], a[240:247], v1
 v_max_u32 v8, v8, v28
 v_smfmac_f32_16x16x64_bf16 v[60:63], v[28:31], a[248:255], v1
 s_waitcnt vmcnt(0)
 v_smfmac_f32_16x16x64_bf16 v[56:59], v[16:19], a[192:199], v1
 v_max_u32 v8, v8, v16
 v_cmp_eq_u32 vcc, -1, v8
 v_smfmac_f32_16x16x64_bf16 v[60:63], v[16:19], a[200:207], v1
 s_cbranch_vccnz LlF_bad1
LlF_ok1:
 s_nop 2
 v_cvt_pk_bf16_f32 v64, v56, v57
 v_cvt_pk_bf16_f32 v65, v58, v59
 s_nop 1
 v_cvt_pk_bf16_f32 v66, v60, v61
 v_cvt_pk_bf16_f32 v67, v62, v63
 s_branch LlF_join
LlF_bad1:
 s_sub_u32 s46, s46, 1
 s_cbranch_scc0 LlF_redo
 s_mov_b32 s46, 0
 s_branch LlF_ok1
LlF_miss1:
 buffer_load_dwordx4 v[20:23], v2, s[48:51], s65 offen offset:1024 sc1
 s_waitcnt vmcnt(3)
 v_cmp_eq_u32 vcc, -1, v24
 s_cbranch_vccnz LlF_miss2
LlF_got2:
 v_smfmac_f32_16x16x64_bf16 v[56:59], v[24:27], a[224:231], v1
 v_smfmac_f32_16x16x64_bf16 v[60:63], v[24:27], a[232:239], v1
 s_waitcnt vmcnt(2)
 v_smfmac_f32_16x16x64_bf16 v[56:59], v[28:31], a[240:247], v1
 v_mov_b32 v8, v28
 v_smfmac_f32_16x16x64_bf16 v[60:63], v[28:31], a[248:255], v1
 s_waitcnt vmcnt(1)
 v_smfmac_f32_16x16x64_bf16 v[56:59], v[16:19], a[192:199], v1
 v_max_u32 v8, v8, v16
 v_smfmac_f32_16x16x64_bf16 v[60:63], v[16:19], a[200:207], v1
 s_waitcnt vmcnt(0)
 v_smfmac_f32_16x16x64_bf16 v[56:59], v[20:23], a[208:215], v1
 v_max_u32 v8, v8, v20
 v_cmp_eq_u32 vcc, -1, v8
 v_smfmac_f32_16x16x64_bf16 v[60:63], v[20:23], a[216:223], v1
 s_cbranch_vccnz LlF_bad2
LlF_ok2:
 s_nop 2
 v_cvt_pk_bf16_f32 v64, v56, v57
 v_cvt_pk_bf16_f32 v65, v58, v59
 s_nop 1
 v_cvt_pk_bf16_f32 v66, v60, v61
 v_cvt_pk_bf16_f32 v67, v62, v63
 s_branch LlF_join
LlF_bad2:
 s_sub_u32 s46, s46, 1
 s_cbranch_scc0 LlF_redo
 s_mov_b32 s46, 0
 s_branch LlF_ok2
LlF_miss2:
 buffer_load_dwordx4 v[24:27], v2, s[48:51], s65 offen offset:2048 sc1
 s_waitcnt vmcnt(3)
 v_cmp_eq_u32 vcc, -1, v28
 s_cbranch_vccnz LlF_miss3
LlF_got3:
 v_smfmac_f32_16x16x64_bf16 v[56:59], v[28:31], a[240:247], v1
 v_smfmac_f32_16x16x64_bf16 v[60:63], v[28:31], a[248:255], v1
 s_waitcnt vmcnt(2)
 v_smfmac_f32_16x16x64_bf16 v[56:59], v[16:19], a[192:199], v1
 v_mov_b32 v8, v16
 v_smfmac_f32_16x16x64_bf16 v[60:63], v[16:19], a[200:207], v1
 s_waitcnt vmcnt(1)
 v_smfmac_f32_16x16x64_bf16 v[56:59], v[20:23], a[208:215], v1
 v_max_u32 v8, v8, v20
 v_smfmac_f32_16x16x64_bf16 v[60:63], v[20:23], a[216:223], v1
 s_waitcnt vmcnt(0)
 v_smfmac_f32_16x16x64_bf16 v[56:59], v[24:27], a[224:231], v1
 v_max_u32 v8, v8, v24
 v_cmp_eq_u32 vcc, -1, v8
 v_smfmac_f32_16x16x64_bf16 v[60:63], v[24:27], a[232:239], v1
 s_cbranch_vccnz LlF_bad3
LlF_ok3:
 s_nop 2
 v_cvt_pk_bf16_f32 v64, v56, v57
 v_cvt_pk_bf16_f32 v65, v58, v59
 s_nop 1
 v_cvt_pk_bf16_f32 v66, v60, v61
 v_cvt_pk_bf16_f32 v67, v62, v63
 s_branch LlF_join
LlF_bad3:
 s_sub_u32 s46, s46, 1
 s_cbranch_scc0 LlF_redo
 s_mov_b32 s46, 0
 s_branch LlF_ok3
LlF_miss3:
 buffer_load_dwordx4 v[28:31], v2, s[48:51], s65 offen offset:3072 sc1
 s_sub_u32 s46, s46, 1
 s_cbranch_scc0 LlF_first
 s_mov_b32 s46, 0
 s_branch LlF_late
LlF_late:
 s_waitcnt vmcnt(3)
 s_branch LlF_got0
LlF_redo:
 buffer_load_dwordx4 v[16:19], v2, s[48:51], s65 offen offset:0 sc1
 buffer_load_dwordx4 v[20:23], v2, s[48:51], s65 offen offset:1024 sc1
 buffer_load_dwordx4 v[24:27], v2, s[48:51], s65 offen offset:2048 sc1
 buffer_load_dwordx4 v[28:31], v2, s[48:51], s65 offen offset:3072 sc1
 v_mov_b64 v[56:57], 0
 v_mov_b64 v[58:59], 0
 v_mov_b64 v[60:61], 0
 v_mov_b64 v[62:63], 0
 s_branch LlF_first
LlF_join:
 s_nop 0
 v_mfma_f32_16x16x32_bf16 v[224:227], v[64:67], v[80:83], 0
 s_barrier
 ds_read_b128 v[96:99], v2 offset:13312
 ds_read_b128 v[100:103], v2 offset:14336
 ds_read_b128 v[104:107], v2 offset:15360
 buffer_store_dwordx4 v[120:123], v2, s[48:51], s77 offen sc1
 s_waitcnt lgkmcnt(2)
 v_mfma_f32_16x16x32_bf16 v[224:227], v[96:99], v[80:83], v[224:227]
 s_waitcnt lgkmcnt(1)
 v_mfma_f32_16x16x32_bf16 v[224:227], v[100:103], v[80:83], v[224:227]
 s_waitcnt lgkmcnt(0)
 v_mfma_f32_16x16x32_bf16 v[224:227], v[104:107], v[80:83], v[224:227]
 s_nop 7
 v_cvt_pk_bf16_f32 v216, v224, v225
 v_cvt_pk_bf16_f32 v217, v226, v227
 buffer_store_dwordx2 v[216:217], v233, s[48:51], s72 offen offset:0 sc1
 buffer_store_dwordx2 v[216:217], v233, s[48:51], s72 offen offset:512 sc1
 s_xor_b32 s66, s66, 0x8000
 s_xor_b32 s79, s64, 0x8000
 buffer_store_dwordx2 v[92:93], v4, s[48:51], s66 offen
 buffer_store_dwordx2 v[92:93], v4, s[48:51], s79 offen
 buffer_store_dwordx4 v[92:95], v2, s[48:51], s67 offen
 buffer_store_dwordx2 v[92:93], v233, s[48:51], s67 offen offset:1536
 s_nop 15
 s_nop 15
 s_nop 15
 s_nop 15
 s_nop 10
 buffer_load_dwordx2 v[240:241], v233, s[48:51], s73 offen offset:0 sc1
 buffer_load_dwordx2 v[242:243], v233, s[48:51], s74 offen offset:0 sc1
 buffer_load_dwordx2 v[244:245], v233, s[48:51], s75 offen offset:0 sc1
 s_nop 15
 s_nop 15
 s_nop 15
 s_nop 6
 buffer_load_dwordx2 v[248:249], v233, s[48:51], s73 offen offset:512 sc1
 buffer_load_dwordx2 v[250:251], v233, s[48:51], s74 offen offset:512 sc1
 buffer_load_dwordx2 v[252:253], v233, s[48:51], s75 offen offset:512 sc1
 s_add_u32 s60, s60, 1
 s_xor_b32 s63, s63, 0x8000
 s_xor_b32 s65, s65, 0x8000
 s_branch Ll_step
Ll_redoD:
 s_waitcnt vmcnt(13)
 v_pk_add_f32 v[228:229], v[140:141], v[168:169]
 v_pk_add_f32 v[230:231], v[142:143], v[170:171]
 s_waitcnt vmcnt(11)
 v_pk_add_f32 v[216:217], v[172:173], v[176:177]
 v_pk_add_f32 v[218:219], v[174:175], v[178:179]
 v_max3_u32 v8, v168, v172, v176
 v_pk_add_f32 v[228:229], v[228:229], v[216:217]
 v_pk_add_f32 v[230:231], v[230:231], v[218:219]
 s_waitcnt vmcnt(7)
 v_max3_u32 v8, v8, v180, v181
 v_max3_u32 v8, v8, v182, v183
 v_cmp_eq_u32 vcc, -1, v8
 v_add_f32 v216, v180, v181
 v_add_f32 v217, v182, v183
 v_max3_f32 v236, v228, v229, v230
 v_add_f32 v232, v216, v217
 v_max3_f32 v236, v236, v231, v232
 s_cbranch_vccz Ll_okD
 s_waitcnt vmcnt(6)
 v_pk_add_f32 v[228:229], v[140:141], v[16:17]
 v_pk_add_f32 v[230:231], v[142:143], v[18:19]
 s_waitcnt vmcnt(4)
 v_pk_add_f32 v[216:217], v[20:21], v[24:25]
 v_pk_add_f32 v[218:219], v[22:23], v[26:27]
 v_max3_u32 v8, v16, v20, v24
 v_pk_add_f32 v[228:229], v[228:229], v[216:217]
 v_pk_add_f32 v[230:231], v[230:231], v[218:219]
 s_waitcnt vmcnt(0)
 v_max3_u32 v8, v8, v28, v29
 v_max3_u32 v8, v8, v30, v31
 v_cmp_eq_u32 vcc, -1, v8
 v_add_f32 v216, v28, v29
 v_add_f32 v217, v30, v31
 v_max3_f32 v236, v228, v229, v230
 v_add_f32 v232, v216, v217
 v_max3_f32 v236, v236, v231, v232
 s_cbranch_vccz Ll_okD
 buffer_load_dwordx4 v[152:155], v2, s[48:51], s68 offen sc1
 buffer_load_dwordx4 v[156:159], v2, s[48:51], s69 offen sc1
 buffer_load_dwordx4 v[160:163], v2, s[48:51], s70 offen sc1
 buffer_load_dword v164, v6, s[48:51], s67 offen sc1
 buffer_load_dword v165, v6, s[48:51], s68 offen sc1
 buffer_load_dword v166, v6, s[48:51], s69 offen sc1
 buffer_load_dword v167, v6, s[48:51], s70 offen sc1
top_10:
 buffer_load_dwordx4 v[168:171], v2, s[48:51], s68 offen sc1
 buffer_load_dwordx4 v[172:175], v2, s[48:51], s69 offen sc1
 buffer_load_dwordx4 v[176:179], v2, s[48:51], s70 offen sc1
 buffer_load_dword v180, v6, s[48:51], s67 offen sc1
 buffer_load_dword v181, v6, s[48:51], s68 offen sc1
 buffer_load_dword v182, v6, s[48:51], s69 offen sc1
 buffer_load_dword v183, v6, s[48:51], s70 offen sc1
 s_waitcnt vmcnt(13)
 v_pk_add_f32 v[228:229], v[140:141], v[152:153]
 v_pk_add_f32 v[230:231], v[142:143], v[154:155]
 s_waitcnt vmcnt(11)
 v_pk_add_f32 v[216:217], v[156:157], v[160:161]
 v_pk_add_f32 v[218:219], v[158:159], v[162:163]
 v_max3_u32 v8, v152, v156, v160
 v_pk_add_f32 v[228:229], v[228:229], v[216:217]
 v_pk_add_f32 v[230:231], v[230:231], v[218:219]
 s_waitcnt vmcnt(7)
 v_max3_u32 v8, v8, v164, v165
 v_max3_u32 v8, v8, v166, v167
 v_cmp_eq_u32 vcc, -1, v8
 v_add_f32 v216, v164, v165
 v_add_f32 v217, v166, v167
 v_max3_f32 v236, v228, v229, v230
 v_add_f32 v232, v216, v217
 v_max3_f32 v236, v236, v231, v232
 s_cbranch_vccz Ll_okD
 buffer_load_dwordx4 v[152:155], v2, s[48:51], s68 offen sc1
 buffer_load_dwordx4 v[156:159], v2, s[48:51], s69 offen sc1
 buffer_load_dwordx4 v[160:163], v2, s[48:51], s70 offen sc1
 buffer_load_dword v164, v6, s[48:51], s67 offen sc1
 buffer_load_dword v165, v6, s[48:51], s68 offen sc1
 buffer_load_dword v166, v6, s[48:51], s69 offen sc1
 buffer_load_dword v167, v6, s[48:51], s70 offen sc1
 s_waitcnt vmcnt(13)
 v_pk_add_f32 v[228:229], v[140:141], v[168:169]
 v_pk_add_f32 v[230:231], v[142:143], v[170:171]
 s_waitcnt vmcnt(11)
 v_pk_add_f32 v[216:217], v[172:173], v[176:177]
 v_pk_add_f32 v[218:219], v[174:175], v[178:179]
 v_max3_u32 v8, v168, v172, v176
 v_pk_add_f32 v[228:229], v[228:229], v[216:217]
 v_pk_add_f32 v[230:231], v[230:231], v[218:219]
 s_waitcnt vmcnt(7)
 v_max3_u32 v8, v8, v180, v181
 v_max3_u32 v8, v8, v182, v183
 v_cmp_eq_u32 vcc, -1, v8
 v_add_f32 v216, v180, v181
 v_add_f32 v217, v182, v183
 v_max3_f32 v236, v228, v229, v230
 v_add_f32 v232, v216, v217
 v_max3_f32 v236, v236, v231, v232
 s_cbranch_vccz Ll_okD
 s_sub_u32 s46, s46, 1
 s_cbranch_scc0 top_10
 s_mov_b32 s46, 0
 s_branch Ll_okD
Ll_redoH:
top_11:
 buffer_load_dwordx2 v[240:241], v233, s[48:51], s73 offen offset:0 sc1
 buffer_load_dwordx2 v[242:243], v233, s[48:51], s74 offen offset:0 sc1
 buffer_load_dwordx2 v[244:245], v233, s[48:51], s75 offen offset:0 sc1
 s_waitcnt vmcnt(3)
 v_max3_u32 v8, v248, v250, v252
 v_cmp_eq_u32 vcc, -1, v8
 s_cbranch_vccz Ll_sumH1
 buffer_load_dwordx2 v[248:249], v233, s[48:51], s73 offen offset:512 sc1
 buffer_load_dwordx2 v[250:251], v233, s[48:51], s74 offen offset:512 sc1
 buffer_load_dwordx2 v[252:253], v233, s[48:51], s75 offen offset:512 sc1
 s_waitcnt vmcnt(3)
 v_max3_u32 v8, v240, v242, v244
 v_cmp_eq_u32 vcc, -1, v8
 s_cbranch_vccz Ll_sumH0
 s_sub_u32 s46, s46, 1
 s_cbranch_scc0 top_11
 s_mov_b32 s46, 0
 s_branch Ll_okH
Ll_sumH0:
 v_mfma_f32_16x16x32_bf16 v[228:231], v[184:187], v[240:243], v[224:227]
 v_mfma_f32_16x16x32_bf16 v[228:231], v[184:187], v[244:247], v[228:231]
 s_branch Ll_okH
Ll_sumH1:
 v_mfma_f32_16x16x32_bf16 v[228:231], v[184:187], v[248:251], v[224:227]
 v_mfma_f32_16x16x32_bf16 v[228:231], v[184:187], v[252:255], v[228:231]
 s_branch Ll_okH
Ll_last:
 v_smfmac_f32_16x16x64_bf16 v[52:55], v[24:27], a[168:175], v1
 v_smfmac_f32_16x16x64_bf16 v[48:51], v[28:31], a[176:183], v1
 v_smfmac_f32_16x16x64_bf16 v[52:55], v[28:31], a[184:191], v1
 s_barrier
 ds_read_b128 v[96:99], v2 offset:1024
 ds_read_b128 v[100:103], v2 offset:2048
 ds_read_b128 v[104:107], v2 offset:3072
 ds_read_b128 v[108:111], v2 offset:5120
 ds_read_b128 v[112:115], v2 offset:6144
 ds_read_b128 v[116:119], v2 offset:7168
 s_waitcnt lgkmcnt(5)
 v_pk_fma_f32 v[72:73], v[96:97], v[12:13], v[72:73]
 v_pk_fma_f32 v[74:75], v[98:99], v[12:13], v[74:75]
 s_waitcnt lgkmcnt(3)
 v_pk_fma_f32 v[72:73], v[100:101], v[12:13], v[72:73]
 v_pk_fma_f32 v[74:75], v[102:103], v[12:13], v[74:75]
 v_pk_fma_f32 v[72:73], v[104:105], v[12:13], v[72:73]
 v_pk_fma_f32 v[74:75], v[106:107], v[12:13], v[74:75]
 v_cvt_pk_bf16_f32 v120, v72, v73
 v_cvt_pk_bf16_f32 v121, v74, v75
 s_waitcnt lgkmcnt(0)
 v_pk_fma_f32 v[76:77], v[108:109], v[12:13], v[76:77]
 v_pk_fma_f32 v[78:79], v[110:111], v[12:13], v[78:79]
 v_pk_fma_f32 v[76:77], v[112:113], v[12:13], v[76:77]
 v_pk_fma_f32 v[78:79], v[114:115], v[12:13], v[78:79]
 v_pk_fma_f32 v[76:77], v[116:117], v[12:13], v[76:77]
 v_pk_fma_f32 v[78:79], v[118:119], v[12:13], v[78:79]
 v_cvt_pk_bf16_f32 v122, v76, v77
 v_cvt_pk_bf16_f32 v123, v78, v79
 v_cvt_pk_bf16_f32 v64, v48, v49
 v_cvt_pk_bf16_f32 v65, v50, v51
 v_cvt_pk_bf16_f32 v66, v52, v53
 v_cvt_pk_bf16_f32 v67, v54, v55
 s_barrier
 ds_read_b128 v[96:99], v2 offset:9216
 ds_read_b128 v[100:103], v2 offset:10240
 ds_read_b128 v[104:107], v2 offset:11264
 v_mfma_f32_16x16x32_bf16 v[204:207], v[84:87], v[64:67], 0
 s_waitcnt lgkmcnt(2)
 v_mfma_f32_16x16x32_bf16 v[204:207], v[84:87], v[96:99], v[204:207]
 s_waitcnt lgkmcnt(1)
 v_mfma_f32_16x16x32_bf16 v[204:207], v[84:87], v[100:103], v[204:207]
 s_waitcnt lgkmcnt(0)
 v_mfma_f32_16x16x32_bf16 v[204:207], v[84:87], v[104:107], v[204:207]
 s_lshl_b32 s79, s60, 18
 s_and_b32 s80, s60, 8
 s_lshl_b32 s80, s80, 10
 s_add_u32 s72, s71, s79
 s_xor_b32 s72, s72, s80
 s_add_u32 s77, s87, s79
 s_xor_b32 s77, s77, s80
 s_xor_b32 s73, s72, 1024
 s_xor_b32 s74, s72, 2048
 s_xor_b32 s75, s72, 3072
 v_cvt_pk_bf16_f32 v188, v204, v205
 v_cvt_pk_bf16_f32 v192, v206, v207
 s_nop 0
 v_mov_b32_dpp v120, v188 quad_perm:[0,1,2,3] row_mask:0xf bank_mask:0x3
 v_mov_b32_dpp v121, v192 quad_perm:[0,1,2,3] row_mask:0xf bank_mask:0x3
 v_mov_b32_dpp v122, v188 row_ror:8 row_mask:0xf bank_mask:0x3
 v_mov_b32_dpp v123, v192 row_ror:8 row_mask:0xf bank_mask:0x3
 buffer_store_dwordx4 v[120:123], v2, s[48:51], s77 offen sc1
 s_branch L_chain_done
L_chain_done:
 s_endpgm
L_worker:
 s_lshr_b32 s60, s6, 3
 s_and_b32 s61, s6, 7
 s_lshl_b32 s62, s47, 3
 s_add_u32 s62, s62, s61
 v_lshlrev_b32 v1, 4, v0
 v_min_u32 v251, 1, v0
 v_lshlrev_b32 v251, 28, v251
 s_mov_b32 s63, 0
 s_mov_b32 s64, 0
 s_mov_b32 s65, 8388608
 s_lshl_b32 s68, s62, 7
 s_lshl_b32 s69, s4, 4
 s_add_u32 s68, s68, s69
 s_lshl_b32 s69, s60, 2
 s_add_u32 s68, s68, s69
 s_add_u32 s68, s68, 3145728
 s_lshl_b32 s69, s47, 2
 s_add_u32 s69, s69, s4
 s_lshl_b32 s69, s69, 7
 s_lshl_b32 s70, s61, 2
 s_add_u32 s69, s69, s70
 s_add_u32 s69, s69, 3153920
 s_cmp_eq_u32 s60, 2
 s_cselect_b32 s68, s69, s68
 s_cmp_lt_u32 s60, 2
 s_cbranch_scc1 Lw_nopoi
 s_cmp_eq_u32 s60, 2
 s_cbranch_scc1 Lw_qinit
 s_mov_b32 s56, s8
 s_and_b32 s57, s9, 0xffff
 s_mov_b32 s58, 4194304
 s_mov_b32 s59, 0x20000
 s_add_u32 s70, s61, 0
 s_lshl_b32 s70, s70, 2
 s_add_u32 s70, s70, s47
 s_lshl_b32 s70, s70, 16
 v_lshrrev_b32 v3, 3, v0
 s_lshl_b32 s69, s4, 3
 v_add_u32 v3, s69, v3
 v_bfe_u32 v4, v3, 1, 3
 v_and_b32 v208, 7, v0
 v_xor_b32 v208, v208, v4
 v_lshlrev_b32 v208, 4, v208
 v_lshl_add_u32 v208, v3, 11, v208
 s_lshl_b32 s71, s4, 10
 s_add_u32 m0, s71, 0
 s_nop 0
 buffer_load_dwordx4 v208, s[56:59], s70 offen offset:0 nt lds
 s_add_u32 m0, s71, 3968
 s_nop 0
 buffer_load_dwordx4 v208, s[56:59], s70 offen offset:128 nt lds
 s_add_u32 m0, s71, 7936
 s_nop 0
 buffer_load_dwordx4 v208, s[56:59], s70 offen offset:256 nt lds
 s_add_u32 m0, s71, 11904
 s_nop 0
 buffer_load_dwordx4 v208, s[56:59], s70 offen offset:384 nt lds
 s_add_u32 m0, s71, 15872
 s_nop 0
 buffer_load_dwordx4 v208, s[56:59], s70 offen offset:512 nt lds
 s_add_u32 m0, s71, 19840
 s_nop 0
 buffer_load_dwordx4 v208, s[56:59], s70 offen offset:640 nt lds
 s_add_u32 m0, s71, 23808
 s_nop 0
 buffer_load_dwordx4 v208, s[56:59], s70 offen offset:768 nt lds
 s_add_u32 m0, s71, 27776
 s_nop 0
 buffer_load_dwordx4 v208, s[56:59], s70 offen offset:896 nt lds
 s_add_u32 m0, s71, 31744
 s_nop 0
 buffer_load_dwordx4 v208, s[56:59], s70 offen offset:1024 nt lds
 s_add_u32 m0, s71, 35712
 s_nop 0
 buffer_load_dwordx4 v208, s[56:59], s70 offen offset:1152 nt lds
 s_add_u32 m0, s71, 39680
 s_nop 0
 buffer_load_dwordx4 v208, s[56:59], s70 offen offset:1280 nt lds
 s_add_u32 m0, s71, 43648
 s_nop 0
 buffer_load_dwordx4 v208, s[56:59], s70 offen offset:1408 nt lds
 s_add_u32 m0, s71, 47616
 s_nop 0
 buffer_load_dwordx4 v208, s[56:59], s70 offen offset:1536 nt lds
 s_add_u32 m0, s71, 51584
 s_nop 0
 buffer_load_dwordx4 v208, s[56:59], s70 offen offset:1664 nt lds
 s_add_u32 m0, s71, 55552
 s_nop 0
 buffer_load_dwordx4 v208, s[56:59], s70 offen offset:1792 nt lds
 s_add_u32 m0, s71, 59520
 s_nop 0
 buffer_load_dwordx4 v208, s[56:59], s70 offen offset:1920 nt lds
 v_and_b32 v3, 31, v0
 s_lshl_b32 s69, s4, 14
 v_lshl_add_u32 v224, v3, 7, s69
 v_bfe_u32 v4, v3, 1, 3
 v_lshrrev_b32 v3, 5, v0
 s_add_u32 s70, s70, s69
 v_add_u32 v225, 0, v3
 v_xor_b32 v225, v225, v4
 v_lshl_add_u32 v209, v225, 4, v224
 v_add_u32 v225, 2, v3
 v_xor_b32 v225, v225, v4
 v_lshl_add_u32 v210, v225, 4, v224
 v_add_u32 v225, 4, v3
 v_xor_b32 v225, v225, v4
 v_lshl_add_u32 v211, v225, 4, v224
 v_add_u32 v225, 6, v3
 v_xor_b32 v225, v225, v4
 v_lshl_add_u32 v212, v225, 4, v224
 s_waitcnt vmcnt(0)
 s_barrier
 ds_read_b128 v[16:19], v209 offset:0
 ds_read_b128 v[20:23], v210 offset:0
 ds_read_b128 v[24:27], v211 offset:0
 ds_read_b128 v[28:31], v212 offset:0
 ds_read_b128 v[32:35], v209 offset:4096
 ds_read_b128 v[36:39], v210 offset:4096
 ds_read_b128 v[40:43], v211 offset:4096
 ds_read_b128 v[44:47], v212 offset:4096
 s_add_u32 s71, s70, 8388608
 s_waitcnt lgkmcnt(7)
 buffer_store_dwordx4 v[16:19], v1, s[48:51], s71 offen offset:0 sc1
 s_waitcnt lgkmcnt(6)
 buffer_store_dwordx4 v[20:23], v1, s[48:51], s71 offen offset:1024 sc1
 s_waitcnt lgkmcnt(5)
 buffer_store_dwordx4 v[24:27], v1, s[48:51], s71 offen offset:2048 sc1
 s_waitcnt lgkmcnt(4)
 buffer_store_dwordx4 v[28:31], v1, s[48:51], s71 offen offset:3072 sc1
 s_add_u32 s71, s70, 8392704
 s_waitcnt lgkmcnt(3)
 buffer_store_dwordx4 v[32:35], v1, s[48:51], s71 offen offset:0 sc1
 s_waitcnt lgkmcnt(2)
 buffer_store_dwordx4 v[36:39], v1, s[48:51], s71 offen offset:1024 sc1
 s_waitcnt lgkmcnt(1)
 buffer_store_dwordx4 v[40:43], v1, s[48:51], s71 offen offset:2048 sc1
 s_waitcnt lgkmcnt(0)
 buffer_store_dwordx4 v[44:47], v1, s[48:51], s71 offen offset:3072 sc1
 ds_read_b128 v[48:51], v209 offset:8192
 ds_read_b128 v[52:55], v210 offset:8192
 ds_read_b128 v[56:59], v211 offset:8192
 ds_read_b128 v[60:63], v212 offset:8192
 ds_read_b128 v[64:67], v209 offset:12288
 ds_read_b128 v[68:71], v210 offset:12288
 ds_read_b128 v[72:75], v211 offset:12288
 ds_read_b128 v[76:79], v212 offset:12288
 s_add_u32 s71, s70, 8396800
 s_waitcnt lgkmcnt(7)
 buffer_store_dwordx4 v[48:51], v1, s[48:51], s71 offen offset:0 sc1
 s_waitcnt lgkmcnt(6)
 buffer_store_dwordx4 v[52:55], v1, s[48:51], s71 offen offset:1024 sc1
 s_waitcnt lgkmcnt(5)
 buffer_store_dwordx4 v[56:59], v1, s[48:51], s71 offen offset:2048 sc1
 s_waitcnt lgkmcnt(4)
 buffer_store_dwordx4 v[60:63], v1, s[48:51], s71 offen offset:3072 sc1
 s_add_u32 s71, s70, 8400896
 s_waitcnt lgkmcnt(3)
 buffer_store_dwordx4 v[64:67], v1, s[48:51], s71 offen offset:0 sc1
 s_waitcnt lgkmcnt(2)
 buffer_store_dwordx4 v[68:71], v1, s[48:51], s71 offen offset:1024 sc1
 s_waitcnt lgkmcnt(1)
 buffer_store_dwordx4 v[72:75], v1, s[48:51], s71 offen offset:2048 sc1
 s_waitcnt lgkmcnt(0)
 buffer_store_dwordx4 v[76:79], v1, s[48:51], s71 offen offset:3072 sc1
 s_branch Lw_inited
Lw_qinit:
 v_mov_b32 v3, 0
 buffer_store_dword v3, v251, s[48:51], s68 offen sc1
 s_lshl_b32 s69, s62, 3
 s_add_u32 s69, s69, s4
 s_lshl_b32 s69, s69, 4
 s_add_u32 s69, s69, 3145728
 v_mov_b32 v3, 0
 buffer_store_dword v3, v251, s[48:51], s69 offen offset:0 sc1
 v_mov_b32 v3, 0
 buffer_store_dword v3, v251, s[48:51], s69 offen offset:4 sc1
 v_mov_b32 v12, -1
 v_mov_b32 v13, -1
 v_mov_b32 v14, -1
 v_mov_b32 v15, -1
 s_lshl_b32 s72, s61, 2
 s_add_u32 s72, s72, s4
 s_lshr_b32 s69, s72, 3
 s_mul_i32 s69, s69, 4096
 s_and_b32 s70, s72, 7
 s_lshl_b32 s70, s70, 7
 s_add_u32 s69, s69, s70
 s_lshl_b32 s70, s47, 16
 s_add_u32 s69, s69, s70
 v_bfe_u32 v3, v0, 3, 2
 v_and_b32 v4, 7, v0
 v_lshlrev_b32 v4, 4, v4
 v_lshl_add_u32 v3, v3, 10, v4
 v_lshrrev_b32 v4, 5, v0
 v_lshl_add_u32 v3, v4, 15, v3
 s_add_u32 s70, s69, 2097152
 buffer_store_dwordx4 v[12:15], v3, s[48:51], s70 offen sc1
 s_add_u32 s70, s69, 2359296
 buffer_store_dwordx4 v[12:15], v3, s[48:51], s70 offen sc1
 s_lshl_b32 s69, s47, 5
 s_add_u32 s69, s69, s72
 s_lshl_b32 s69, s69, 11
 s_add_u32 s69, s69, 2621440
 buffer_store_dwordx4 v[12:15], v1, s[48:51], s69 offen sc1
 buffer_store_dwordx4 v[12:15], v1, s[48:51], s69 offen offset:1024 sc1
 s_lshl_b32 s69, s61, 1
 s_lshr_b32 s70, s4, 1
 s_add_u32 s69, s69, s70
 s_lshl_b32 s71, s69, 14
 s_and_b32 s69, s4, 1
 s_lshl_b32 s69, s69, 12
 s_add_u32 s71, s71, s69
 s_lshl_b32 s69, s47, 10
 s_add_u32 s71, s71, s69
 s_add_u32 s71, s71, 134217728
 s_add_u32 s69, s71, 8192
 buffer_store_dwordx4 v[12:15], v1, s[48:51], s71 offen sc1
 buffer_store_dwordx4 v[12:15], v1, s[48:51], s69 offen sc1
Lw_inited:
 s_waitcnt vmcnt(0)
 s_barrier
 s_cmp_eq_u32 s4, 0
 s_cbranch_scc0 Lw_chored
 s_cmp_eq_u32 s60, 2
 s_cbranch_scc1 Lw_probe
 v_mov_b32 v3, 0
 v_mov_b32 v4, 1
 s_mov_b64 exec, 1
 global_atomic_add v4, v3, v4, s[42:43] offset:36 sc0 sc1
 s_waitcnt vmcnt(0)
 s_mov_b64 exec, 1
 v_readfirstlane_b32 s7, v4
 s_nop 0
 s_cmp_eq_u32 s7, 31
 s_cbranch_scc0 arr_12
 v_mov_b32 v4, 4
 global_atomic_or v3, v4, s[42:43] offset:132 sc1
arr_12:
 s_mov_b64 exec, -1
 s_branch Lw_chore2
Lw_probe:
 s_lshl_b32 s69, s47, 4
 s_add_u32 s69, s69, s61
 s_lshl_b32 s69, s69, 7
 v_mov_b32 v3, s69
 s_mov_b32 s74, -1
 s_mov_b32 s75, -1
 s_mov_b32 s76, 0
 s_mov_b64 exec, 1
Lp_loop:
 s_mov_b32 s77, 171966464
 s_memtime s[78:79]
 s_waitcnt lgkmcnt(0)
 buffer_store_dword v3, v3, s[48:51], s77 offen sc1
 s_waitcnt vmcnt(0)
 s_memtime s[80:81]
 s_waitcnt lgkmcnt(0)
 s_sub_u32 s80, s80, s78
 s_min_u32 s74, s74, s80
 s_mov_b32 s77, 171974656
 s_memtime s[78:79]
 s_waitcnt lgkmcnt(0)
 buffer_store_dword v3, v3, s[48:51], s77 offen sc1
 s_waitcnt vmcnt(0)
 s_memtime s[80:81]
 s_waitcnt lgkmcnt(0)
 s_sub_u32 s80, s80, s78
 s_min_u32 s75, s75, s80
 s_add_u32 s76, s76, 1
 s_cmp_lt_u32 s76, 4
 s_cbranch_scc1 Lp_loop
 s_sub_i32 s76, s75, s74
 s_min_i32 s76, s76, 400
 s_max_i32 s76, s76, -400
 s_add_i32 s76, s76, 1024
 s_mov_b64 exec, -1
 v_mov_b32 v3, 0
 s_add_u32 s76, s76, 16777216
 v_mov_b32 v4, s76
 s_mov_b64 exec, 1
 global_atomic_add v4, v3, v4, s[42:43] offset:100 sc0 sc1
 s_waitcnt vmcnt(0)
 s_mov_b64 exec, 1
 v_readfirstlane_b32 s7, v4
 s_nop 0
 s_add_u32 s7, s7, s76
 s_lshr_b32 s76, s7, 24
 s_cmp_eq_u32 s76, 32
 s_cbranch_scc0 arr_13
 s_and_b32 s7, s7, 0xffffff
 s_cmp_gt_u32 s7, 32768
 s_cselect_b32 s7, 48, 16
 v_mov_b32 v4, s7
 global_atomic_or v3, v4, s[42:43] offset:132 sc1
arr_13:
 s_mov_b64 exec, -1
Lw_chore2:
news_14:
 v_mov_b32 v3, 0
 global_load_dword v4, v3, s[42:43] offset:132 sc1
 s_waitcnt vmcnt(0)
newschk_16:
 v_readfirstlane_b32 s7, v4
 s_nop 0
 s_and_b32 s7, s7, 20
 s_cmp_eq_u32 s7, 20
 s_cbranch_scc1 newsok_15
 s_sleep 2
 s_sub_u32 s46, s46, 1
 s_cbranch_scc0 news_14
 s_mov_b32 s46, 0
 s_branch newsok_15
newsok_15:
 s_cmp_eq_u32 s60, 2
 s_cselect_b32 s70, 0, 1
 s_lshl_b32 s71, s62, 7
 s_add_u32 s71, s71, 3145728
 v_mov_b32 v3, 0
w_17:
 buffer_load_dword v4, v3, s[48:51], s71 offen sc1
 s_waitcnt vmcnt(0)
 v_cmp_gt_u32 vcc, s70, v4
 s_cbranch_vccz wok_18
 s_sleep 6
 s_sub_u32 s46, s46, 1
 s_cbranch_scc0 w_17
 s_mov_b32 s46, 0
 s_branch wok_18
wok_18:
Lw_chored:
 s_barrier
Lw_nopoi:
 v_and_b32 v3, 15, v0
 v_lshrrev_b32 v4, 4, v0
 v_lshlrev_b32 v6, 4, v3
 v_lshl_add_u32 v6, v4, 9, v6
 v_and_b32 v2, 8, v0
 s_cmp_eq_u32 s60, 1
 s_cselect_b32 s69, 16, 0
 v_mul_u32_u24 v2, s69, v2
 s_lshl_b32 s69, s4, 14
 v_add3_u32 v2, v2, v6, s69
 s_mul_i32 s69, s4, 12288
 v_add_u32 v10, s69, v1
 s_xor_b32 s69, s4, 1
 s_mul_i32 s69, s69, 12288
 s_add_u32 s69, s69, 0
 v_add_u32 v7, s69, v1
 s_xor_b32 s69, s4, 2
 s_mul_i32 s69, s69, 12288
 s_add_u32 s69, s69, 4096
 v_add_u32 v8, s69, v1
 s_xor_b32 s69, s4, 3
 s_mul_i32 s69, s69, 12288
 s_add_u32 s69, s69, 8192
 v_add_u32 v9, s69, v1
 s_lshl_b32 s69, s6, 2
 s_add_u32 s69, s69, s4
 s_lshl_b32 s69, s69, 10
 s_lshl_b32 s70, s69, 1
 s_and_b32 s70, s70, 0xffff
 s_cmp_lt_u32 s60, 2
 s_cselect_b32 s69, s69, s70
 v_add_u32 v11, s69, v1
 s_cmp_eq_u32 s60, 0
 s_cselect_b64 s[74:75], s[14:15], s[16:17]
 s_cmp_eq_u32 s60, 2
 s_cselect_b64 s[74:75], s[12:13], s[74:75]
 s_lshl_b32 s70, s62, 8
 s_lshl_b32 s69, s47, 21
 s_lshl_b32 s71, s61, 8
 s_add_u32 s69, s69, s71
 s_cmp_eq_u32 s60, 3
 s_cselect_b64 s[74:75], s[18:19], s[74:75]
 s_cselect_b32 s70, s69, s70
 s_cselect_b32 s71, 11, 13
 s_mov_b32 s52, s74
 s_and_b32 s53, s75, 0xffff
 s_mov_b32 s54, 8388608
 s_mov_b32 s55, 0x20000
 s_mov_b32 s56, s8
 s_and_b32 s57, s9, 0xffff
 s_mov_b32 s58, 4194304
 s_mov_b32 s59, 0x20000
 v_bfe_u32 v3, v2, 4, 5
 v_lshlrev_b32 v3, 11, v3
 v_lshrrev_b32 v4, 4, v0
 v_lshl_add_u32 v3, v4, 4, v3
 s_lshl_b32 s69, s4, 9
 v_add_u32 v226, s69, v3
 s_cmp_eq_u32 s60, 1
 s_cselect_b32 s69, 1, 2
 s_lshl_b32 s69, s69, 14
 v_add_u32 v227, s69, v226
 s_cmp_lt_u32 s60, 2
 s_cbranch_scc0 hook_19
 buffer_load_dwordx4 v[12:15], v11, s[56:59], 0 offen
hw_20:
hook_19:
 v_lshrrev_b32 v3, 4, v0
 v_lshlrev_b32 v4, 2, v3
 v_xor_b32 v4, v4, v0
 v_and_b32 v4, 15, v4
 v_lshlrev_b32 v208, s71, v3
 v_lshl_add_u32 v208, v4, 4, v208
 s_mul_i32 s66, s4, 40960
 v_bfe_u32 v4, v0, 2, 2
 v_lshl_add_u32 v3, v3, 3, v4
 v_lshl_add_u32 v3, v3, 8, s66
 s_cmp_eq_u32 s60, 1
 s_cselect_b32 s67, 3, 5
 s_cselect_b32 s69, 32, 8
 s_cmp_eq_u32 s60, 3
 s_cselect_b32 s67, 4, s67
 s_cselect_b32 s69, 32, s69
 s_cselect_b32 s72, 3, 4
 s_cselect_b32 s73, s47, s4
 s_cselect_b32 s82, s4, 0
 s_and_b32 s82, s82, 1
 s_lshl_b32 s82, s82, 5
 v_xor_b32 v4, s73, v4
 v_add_u32 v3, s82, v3
 v_and_b32 v224, 1, v0
 v_lshl_add_u32 v3, v224, s72, v3
 v_bfe_u32 v224, v0, 1, 1
 v_lshl_add_u32 v3, v224, s67, v3
 v_xor_b32 v224, 0, v4
 v_lshl_add_u32 v209, v224, 6, v3
 v_xor_b32 v210, s69, v209
 v_xor_b32 v224, 1, v4
 v_lshl_add_u32 v211, v224, 6, v3
 v_xor_b32 v212, s69, v211
 v_xor_b32 v224, 2, v4
 v_lshl_add_u32 v213, v224, 6, v3
 v_xor_b32 v214, s69, v213
 v_xor_b32 v224, 3, v4
 v_lshl_add_u32 v215, v224, 6, v3
 v_xor_b32 v216, s69, v215
 s_lshl_b32 s67, s4, 8
 s_lshl_b32 s67, s67, s71
 s_add_u32 s70, s70, s67
 s_lshl_b32 s67, 4, s71
 s_add_u32 m0, s66, 0
 s_nop 0
 buffer_load_dwordx4 v208, s[52:55], s70 offen nt lds
 s_add_u32 s70, s70, s67
 s_add_u32 m0, s66, 1024
 s_nop 0
 buffer_load_dwordx4 v208, s[52:55], s70 offen nt lds
 s_add_u32 s70, s70, s67
 s_add_u32 m0, s66, 2048
 s_nop 0
 buffer_load_dwordx4 v208, s[52:55], s70 offen nt lds
 s_add_u32 s70, s70, s67
 s_add_u32 m0, s66, 3072
 s_nop 0
 buffer_load_dwordx4 v208, s[52:55], s70 offen nt lds
 s_add_u32 s70, s70, s67
 s_add_u32 m0, s66, 4096
 s_nop 0
 buffer_load_dwordx4 v208, s[52:55], s70 offen nt lds
 s_add_u32 s70, s70, s67
 s_add_u32 m0, s66, 5120
 s_nop 0
 buffer_load_dwordx4 v208, s[52:55], s70 offen nt lds
 s_add_u32 s70, s70, s67
 s_add_u32 m0, s66, 6144
 s_nop 0
 buffer_load_dwordx4 v208, s[52:55], s70 offen nt lds
 s_add_u32 s70, s70, s67
 s_add_u32 m0, s66, 7168
 s_nop 0
 buffer_load_dwordx4 v208, s[52:55], s70 offen nt lds
 s_add_u32 s70, s70, s67
 s_add_u32 m0, s66, 8192
 s_nop 0
 buffer_load_dwordx4 v208, s[52:55], s70 offen nt lds
 s_add_u32 s70, s70, s67
 s_add_u32 m0, s66, 9216
 s_nop 0
 buffer_load_dwordx4 v208, s[52:55], s70 offen nt lds
 s_add_u32 s70, s70, s67
 s_add_u32 m0, s66, 10240
 s_nop 0
 buffer_load_dwordx4 v208, s[52:55], s70 offen nt lds
 s_add_u32 s70, s70, s67
 s_add_u32 m0, s66, 11264
 s_nop 0
 buffer_load_dwordx4 v208, s[52:55], s70 offen nt lds
 s_add_u32 s70, s70, s67
 s_waitcnt vmcnt(8)
 s_add_u32 m0, s66, 12288
 s_nop 0
 buffer_load_dwordx4 v208, s[52:55], s70 offen nt lds
 s_add_u32 s70, s70, s67
 s_add_u32 m0, s66, 13312
 s_nop 0
 buffer_load_dwordx4 v208, s[52:55], s70 offen nt lds
 s_add_u32 s70, s70, s67
 s_add_u32 m0, s66, 14336
 s_nop 0
 buffer_load_dwordx4 v208, s[52:55], s70 offen nt lds
 s_add_u32 s70, s70, s67
 s_add_u32 m0, s66, 15360
 s_nop 0
 buffer_load_dwordx4 v208, s[52:55], s70 offen nt lds
 s_add_u32 s70, s70, s67
 s_waitcnt vmcnt(8)
 s_add_u32 m0, s66, 16384
 s_nop 0
 buffer_load_dwordx4 v208, s[52:55], s70 offen nt lds
 s_add_u32 s70, s70, s67
 s_add_u32 m0, s66, 17408
 s_nop 0
 buffer_load_dwordx4 v208, s[52:55], s70 offen nt lds
 s_add_u32 s70, s70, s67
 s_add_u32 m0, s66, 18432
 s_nop 0
 buffer_load_dwordx4 v208, s[52:55], s70 offen nt lds
 s_add_u32 s70, s70, s67
 s_add_u32 m0, s66, 19456
 s_nop 0
 buffer_load_dwordx4 v208, s[52:55], s70 offen nt lds
 s_add_u32 s70, s70, s67
 ds_read_b64_tr_b16 a[0:1], v209 offset:0
 ds_read_b64_tr_b16 a[2:3], v209 offset:1024
 ds_read_b64_tr_b16 a[4:5], v210 offset:0
 ds_read_b64_tr_b16 a[6:7], v210 offset:1024
 ds_read_b64_tr_b16 a[8:9], v211 offset:0
 ds_read_b64_tr_b16 a[10:11], v211 offset:1024
 ds_read_b64_tr_b16 a[12:13], v212 offset:0
 ds_read_b64_tr_b16 a[14:15], v212 offset:1024
 s_waitcnt lgkmcnt(0)
 ds_read_b64_tr_b16 a[16:17], v213 offset:0
 ds_read_b64_tr_b16 a[18:19], v213 offset:1024
 ds_read_b64_tr_b16 a[20:21], v214 offset:0
 ds_read_b64_tr_b16 a[22:23], v214 offset:1024
 ds_read_b64_tr_b16 a[24:25], v215 offset:0
 ds_read_b64_tr_b16 a[26:27], v215 offset:1024
 ds_read_b64_tr_b16 a[28:29], v216 offset:0
 ds_read_b64_tr_b16 a[30:31], v216 offset:1024
 s_waitcnt lgkmcnt(0)
 s_waitcnt vmcnt(8)
 s_cmp_lt_u32 s60, 2
 s_cbranch_scc0 hook_21
 buffer_load_dwordx4 v[16:19], v226, s[56:59], 0 offen offset:0
 buffer_load_dwordx4 v[20:23], v227, s[56:59], 0 offen offset:0
 buffer_load_dwordx4 v[24:27], v226, s[56:59], 0 offen offset:64
 buffer_load_dwordx4 v[28:31], v227, s[56:59], 0 offen offset:64
hw_22:
hook_21:
 s_add_u32 m0, s66, 20480
 s_nop 0
 buffer_load_dwordx4 v208, s[52:55], s70 offen nt lds
 s_add_u32 s70, s70, s67
 s_add_u32 m0, s66, 21504
 s_nop 0
 buffer_load_dwordx4 v208, s[52:55], s70 offen nt lds
 s_add_u32 s70, s70, s67
 s_add_u32 m0, s66, 22528
 s_nop 0
 buffer_load_dwordx4 v208, s[52:55], s70 offen nt lds
 s_add_u32 s70, s70, s67
 s_add_u32 m0, s66, 23552
 s_nop 0
 buffer_load_dwordx4 v208, s[52:55], s70 offen nt lds
 s_add_u32 s70, s70, s67
 s_waitcnt vmcnt(8)
 s_cmp_lt_u32 s60, 2
 s_cbranch_scc0 hook_23
 buffer_load_dwordx4 v[32:35], v226, s[56:59], 0 offen offset:128
 buffer_load_dwordx4 v[36:39], v227, s[56:59], 0 offen offset:128
 buffer_load_dwordx4 v[40:43], v226, s[56:59], 0 offen offset:192
 buffer_load_dwordx4 v[44:47], v227, s[56:59], 0 offen offset:192
hw_24:
hook_23:
 s_add_u32 m0, s66, 24576
 s_nop 0
 buffer_load_dwordx4 v208, s[52:55], s70 offen nt lds
 s_add_u32 s70, s70, s67
 s_add_u32 m0, s66, 25600
 s_nop 0
 buffer_load_dwordx4 v208, s[52:55], s70 offen nt lds
 s_add_u32 s70, s70, s67
 s_add_u32 m0, s66, 26624
 s_nop 0
 buffer_load_dwordx4 v208, s[52:55], s70 offen nt lds
 s_add_u32 s70, s70, s67
 s_add_u32 m0, s66, 27648
 s_nop 0
 buffer_load_dwordx4 v208, s[52:55], s70 offen nt lds
 s_add_u32 s70, s70, s67
 ds_read_b64_tr_b16 a[32:33], v209 offset:8192
 ds_read_b64_tr_b16 a[34:35], v209 offset:9216
 ds_read_b64_tr_b16 a[36:37], v210 offset:8192
 ds_read_b64_tr_b16 a[38:39], v210 offset:9216
 ds_read_b64_tr_b16 a[40:41], v211 offset:8192
 ds_read_b64_tr_b16 a[42:43], v211 offset:9216
 ds_read_b64_tr_b16 a[44:45], v212 offset:8192
 ds_read_b64_tr_b16 a[46:47], v212 offset:9216
 s_waitcnt lgkmcnt(0)
 ds_read_b64_tr_b16 a[48:49], v213 offset:8192
 ds_read_b64_tr_b16 a[50:51], v213 offset:9216
 ds_read_b64_tr_b16 a[52:53], v214 offset:8192
 ds_read_b64_tr_b16 a[54:55], v214 offset:9216
 ds_read_b64_tr_b16 a[56:57], v215 offset:8192
 ds_read_b64_tr_b16 a[58:59], v215 offset:9216
 ds_read_b64_tr_b16 a[60:61], v216 offset:8192
 ds_read_b64_tr_b16 a[62:63], v216 offset:9216
 s_waitcnt lgkmcnt(0)
 s_waitcnt vmcnt(8)
 s_cmp_lt_u32 s60, 2
 s_cbranch_scc0 hook_25
 buffer_load_dwordx4 v[48:51], v226, s[56:59], 0 offen offset:256
 buffer_load_dwordx4 v[52:55], v227, s[56:59], 0 offen offset:256
 buffer_load_dwordx4 v[56:59], v226, s[56:59], 0 offen offset:320
 buffer_load_dwordx4 v[60:63], v227, s[56:59], 0 offen offset:320
hw_26:
hook_25:
 s_add_u32 m0, s66, 28672
 s_nop 0
 buffer_load_dwordx4 v208, s[52:55], s70 offen nt lds
 s_add_u32 s70, s70, s67
 s_add_u32 m0, s66, 29696
 s_nop 0
 buffer_load_dwordx4 v208, s[52:55], s70 offen nt lds
 s_add_u32 s70, s70, s67
 s_add_u32 m0, s66, 30720
 s_nop 0
 buffer_load_dwordx4 v208, s[52:55], s70 offen nt lds
 s_add_u32 s70, s70, s67
 s_add_u32 m0, s66, 31744
 s_nop 0
 buffer_load_dwordx4 v208, s[52:55], s70 offen nt lds
 s_add_u32 s70, s70, s67
 s_waitcnt vmcnt(8)
 s_cmp_lt_u32 s60, 2
 s_cbranch_scc0 hook_27
 buffer_load_dwordx4 v[64:67], v226, s[56:59], 0 offen offset:384
 buffer_load_dwordx4 v[68:71], v227, s[56:59], 0 offen offset:384
 buffer_load_dwordx4 v[72:75], v226, s[56:59], 0 offen offset:448
 buffer_load_dwordx4 v[76:79], v227, s[56:59], 0 offen offset:448
hw_28:
hook_27:
 s_add_u32 m0, s66, 0
 s_nop 0
 buffer_load_dwordx4 v208, s[52:55], s70 offen nt lds
 s_add_u32 s70, s70, s67
 s_add_u32 m0, s66, 1024
 s_nop 0
 buffer_load_dwordx4 v208, s[52:55], s70 offen nt lds
 s_add_u32 s70, s70, s67
 s_add_u32 m0, s66, 2048
 s_nop 0
 buffer_load_dwordx4 v208, s[52:55], s70 offen nt lds
 s_add_u32 s70, s70, s67
 s_add_u32 m0, s66, 3072
 s_nop 0
 buffer_load_dwordx4 v208, s[52:55], s70 offen nt lds
 s_add_u32 s70, s70, s67
 ds_read_b64_tr_b16 a[64:65], v209 offset:16384
 ds_read_b64_tr_b16 a[66:67], v209 offset:17408
 ds_read_b64_tr_b16 a[68:69], v210 offset:16384
 ds_read_b64_tr_b16 a[70:71], v210 offset:17408
 ds_read_b64_tr_b16 a[72:73], v211 offset:16384
 ds_read_b64_tr_b16 a[74:75], v211 offset:17408
 ds_read_b64_tr_b16 a[76:77], v212 offset:16384
 ds_read_b64_tr_b16 a[78:79], v212 offset:17408
 s_waitcnt lgkmcnt(0)
 ds_read_b64_tr_b16 a[80:81], v213 offset:16384
 ds_read_b64_tr_b16 a[82:83], v213 offset:17408
 ds_read_b64_tr_b16 a[84:85], v214 offset:16384
 ds_read_b64_tr_b16 a[86:87], v214 offset:17408
 ds_read_b64_tr_b16 a[88:89], v215 offset:16384
 ds_read_b64_tr_b16 a[90:91], v215 offset:17408
 ds_read_b64_tr_b16 a[92:93], v216 offset:16384
 ds_read_b64_tr_b16 a[94:95], v216 offset:17408
 s_waitcnt lgkmcnt(0)
 s_waitcnt vmcnt(8)
 s_add_u32 m0, s66, 4096
 s_nop 0
 buffer_load_dwordx4 v208, s[52:55], s70 offen nt lds
 s_add_u32 s70, s70, s67
 s_add_u32 m0, s66, 5120
 s_nop 0
 buffer_load_dwordx4 v208, s[52:55], s70 offen nt lds
 s_add_u32 s70, s70, s67
 s_add_u32 m0, s66, 6144
 s_nop 0
 buffer_load_dwordx4 v208, s[52:55], s70 offen nt lds
 s_add_u32 s70, s70, s67
 s_add_u32 m0, s66, 7168
 s_nop 0
 buffer_load_dwordx4 v208, s[52:55], s70 offen nt lds
 s_add_u32 s70, s70, s67
 s_waitcnt vmcnt(8)
 s_add_u32 m0, s66, 8192
 s_nop 0
 buffer_load_dwordx4 v208, s[52:55], s70 offen nt lds
 s_add_u32 s70, s70, s67
 s_add_u32 m0, s66, 9216
 s_nop 0
 buffer_load_dwordx4 v208, s[52:55], s70 offen nt lds
 s_add_u32 s70, s70, s67
 s_add_u32 m0, s66, 10240
 s_nop 0
 buffer_load_dwordx4 v208, s[52:55], s70 offen nt lds
 s_add_u32 s70, s70, s67
 s_add_u32 m0, s66, 11264
 s_nop 0
 buffer_load_dwordx4 v208, s[52:55], s70 offen nt lds
 s_add_u32 s70, s70, s67
 ds_read_b64_tr_b16 a[96:97], v209 offset:24576
 ds_read_b64_tr_b16 a[98:99], v209 offset:25600
 ds_read_b64_tr_b16 a[100:101], v210 offset:24576
 ds_read_b64_tr_b16 a[102:103], v210 offset:25600
 ds_read_b64_tr_b16 a[104:105], v211 offset:24576
 ds_read_b64_tr_b16 a[106:107], v211 offset:25600
 ds_read_b64_tr_b16 a[108:109], v212 offset:24576
 ds_read_b64_tr_b16 a[110:111], v212 offset:25600
 s_waitcnt lgkmcnt(0)
 ds_read_b64_tr_b16 a[112:113], v213 offset:24576
 ds_read_b64_tr_b16 a[114:115], v213 offset:25600
 ds_read_b64_tr_b16 a[116:117], v214 offset:24576
 ds_read_b64_tr_b16 a[118:119], v214 offset:25600
 ds_read_b64_tr_b16 a[120:121], v215 offset:24576
 ds_read_b64_tr_b16 a[122:123], v215 offset:25600
 ds_read_b64_tr_b16 a[124:125], v216 offset:24576
 ds_read_b64_tr_b16 a[126:127], v216 offset:25600
 s_waitcnt lgkmcnt(0)
 s_waitcnt vmcnt(8)
 s_add_u32 m0, s66, 12288
 s_nop 0
 buffer_load_dwordx4 v208, s[52:55], s70 offen nt lds
 s_add_u32 s70, s70, s67
 s_add_u32 m0, s66, 13312
 s_nop 0
 buffer_load_dwordx4 v208, s[52:55], s70 offen nt lds
 s_add_u32 s70, s70, s67
 s_add_u32 m0, s66, 14336
 s_nop 0
 buffer_load_dwordx4 v208, s[52:55], s70 offen nt lds
 s_add_u32 s70, s70, s67
 s_add_u32 m0, s66, 15360
 s_nop 0
 buffer_load_dwordx4 v208, s[52:55], s70 offen nt lds
 s_add_u32 s70, s70, s67
 s_waitcnt vmcnt(8)
 s_cmp_lt_u32 s60, 2
 s_cbranch_scc0 hook_29
 v_mov_b32 v224, 0
 global_load_dword v225, v224, s[42:43] offset:132 sc1
hw_30:
hook_29:
 s_add_u32 m0, s66, 16384
 s_nop 0
 buffer_load_dwordx4 v208, s[52:55], s70 offen nt lds
 s_add_u32 s70, s70, s67
 s_add_u32 m0, s66, 17408
 s_nop 0
 buffer_load_dwordx4 v208, s[52:55], s70 offen nt lds
 s_add_u32 s70, s70, s67
 s_add_u32 m0, s66, 18432
 s_nop 0
 buffer_load_dwordx4 v208, s[52:55], s70 offen nt lds
 s_add_u32 s70, s70, s67
 s_add_u32 m0, s66, 19456
 s_nop 0
 buffer_load_dwordx4 v208, s[52:55], s70 offen nt lds
 s_add_u32 s70, s70, s67
 ds_read_b64_tr_b16 a[128:129], v209 offset:0
 ds_read_b64_tr_b16 a[130:131], v209 offset:1024
 ds_read_b64_tr_b16 a[132:133], v210 offset:0
 ds_read_b64_tr_b16 a[134:135], v210 offset:1024
 ds_read_b64_tr_b16 a[136:137], v211 offset:0
 ds_read_b64_tr_b16 a[138:139], v211 offset:1024
 ds_read_b64_tr_b16 a[140:141], v212 offset:0
 ds_read_b64_tr_b16 a[142:143], v212 offset:1024
 s_waitcnt lgkmcnt(0)
 ds_read_b64_tr_b16 a[144:145], v213 offset:0
 ds_read_b64_tr_b16 a[146:147], v213 offset:1024
 ds_read_b64_tr_b16 a[148:149], v214 offset:0
 ds_read_b64_tr_b16 a[150:151], v214 offset:1024
 ds_read_b64_tr_b16 a[152:153], v215 offset:0
 ds_read_b64_tr_b16 a[154:155], v215 offset:1024
 ds_read_b64_tr_b16 a[156:157], v216 offset:0
 ds_read_b64_tr_b16 a[158:159], v216 offset:1024
 s_waitcnt lgkmcnt(0)
 s_waitcnt vmcnt(8)
 s_add_u32 m0, s66, 20480
 s_nop 0
 buffer_load_dwordx4 v208, s[52:55], s70 offen nt lds
 s_add_u32 s70, s70, s67
 s_add_u32 m0, s66, 21504
 s_nop 0
 buffer_load_dwordx4 v208, s[52:55], s70 offen nt lds
 s_add_u32 s70, s70, s67
 s_add_u32 m0, s66, 22528
 s_nop 0
 buffer_load_dwordx4 v208, s[52:55], s70 offen nt lds
 s_add_u32 s70, s70, s67
 s_add_u32 m0, s66, 23552
 s_nop 0
 buffer_load_dwordx4 v208, s[52:55], s70 offen nt lds
 s_add_u32 s70, s70, s67
 s_waitcnt vmcnt(8)
 s_cmp_lt_u32 s60, 2
 s_cbranch_scc0 hook_31
 s_branch newschk_35
news_33:
 v_mov_b32 v224, 0
 global_load_dword v225, v224, s[42:43] offset:132 sc1
 s_waitcnt vmcnt(0)
newschk_35:
 v_readfirstlane_b32 s7, v225
 s_nop 0
 s_bfe_u32 s64, s7, 0x10005
 s_and_b32 s7, s7, 20
 s_cmp_eq_u32 s7, 20
 s_cbranch_scc1 newsok_34
 s_sleep 2
 s_sub_u32 s46, s46, 1
 s_cbranch_scc0 news_33
 s_mov_b32 s46, 0
 s_branch newsok_34
newsok_34:
 s_mov_b32 s72, s70
 s_add_u32 s70, s65, 65536
 buffer_load_dwordx4 v[12:15], v11, s[48:51], s70 offen offset:0 sc1
 s_add_u32 s70, s65, 131072
 buffer_load_dwordx4 v[12:15], v11, s[48:51], s70 offen offset:0 sc1
 s_mov_b32 s70, s72
hw_32:
hook_31:
 s_add_u32 m0, s66, 24576
 s_nop 0
 buffer_load_dwordx4 v208, s[52:55], s70 offen nt lds
 s_add_u32 s70, s70, s67
 s_add_u32 m0, s66, 25600
 s_nop 0
 buffer_load_dwordx4 v208, s[52:55], s70 offen nt lds
 s_add_u32 s70, s70, s67
 s_add_u32 m0, s66, 26624
 s_nop 0
 buffer_load_dwordx4 v208, s[52:55], s70 offen nt lds
 s_add_u32 s70, s70, s67
 s_add_u32 m0, s66, 27648
 s_nop 0
 buffer_load_dwordx4 v208, s[52:55], s70 offen nt lds
 s_add_u32 s70, s70, s67
 ds_read_b64_tr_b16 a[160:161], v209 offset:8192
 ds_read_b64_tr_b16 a[162:163], v209 offset:9216
 ds_read_b64_tr_b16 a[164:165], v210 offset:8192
 ds_read_b64_tr_b16 a[166:167], v210 offset:9216
 ds_read_b64_tr_b16 a[168:169], v211 offset:8192
 ds_read_b64_tr_b16 a[170:171], v211 offset:9216
 ds_read_b64_tr_b16 a[172:173], v212 offset:8192
 ds_read_b64_tr_b16 a[174:175], v212 offset:9216
 s_waitcnt lgkmcnt(0)
 ds_read_b64_tr_b16 a[176:177], v213 offset:8192
 ds_read_b64_tr_b16 a[178:179], v213 offset:9216
 ds_read_b64_tr_b16 a[180:181], v214 offset:8192
 ds_read_b64_tr_b16 a[182:183], v214 offset:9216
 ds_read_b64_tr_b16 a[184:185], v215 offset:8192
 ds_read_b64_tr_b16 a[186:187], v215 offset:9216
 ds_read_b64_tr_b16 a[188:189], v216 offset:8192
 ds_read_b64_tr_b16 a[190:191], v216 offset:9216
 s_waitcnt lgkmcnt(0)
 s_add_u32 m0, s66, 28672
 s_nop 0
 buffer_load_dwordx4 v208, s[52:55], s70 offen nt lds
 s_add_u32 s70, s70, s67
 s_add_u32 m0, s66, 29696
 s_nop 0
 buffer_load_dwordx4 v208, s[52:55], s70 offen nt lds
 s_add_u32 s70, s70, s67
 s_add_u32 m0, s66, 30720
 s_nop 0
 buffer_load_dwordx4 v208, s[52:55], s70 offen nt lds
 s_add_u32 s70, s70, s67
 s_add_u32 m0, s66, 31744
 s_nop 0
 buffer_load_dwordx4 v208, s[52:55], s70 offen nt lds
 s_add_u32 s70, s70, s67
 s_cmp_lt_u32 s60, 2
 s_cbranch_scc1 Lw_go
 s_waitcnt vmcnt(8)
 ds_read_b64_tr_b16 a[192:193], v209 offset:16384
 ds_read_b64_tr_b16 a[194:195], v209 offset:17408
 ds_read_b64_tr_b16 a[196:197], v210 offset:16384
 ds_read_b64_tr_b16 a[198:199], v210 offset:17408
 ds_read_b64_tr_b16 a[200:201], v211 offset:16384
 ds_read_b64_tr_b16 a[202:203], v211 offset:17408
 ds_read_b64_tr_b16 a[204:205], v212 offset:16384
 ds_read_b64_tr_b16 a[206:207], v212 offset:17408
 s_waitcnt lgkmcnt(0)
 ds_read_b64_tr_b16 a[208:209], v213 offset:16384
 ds_read_b64_tr_b16 a[210:211], v213 offset:17408
 ds_read_b64_tr_b16 a[212:213], v214 offset:16384
 ds_read_b64_tr_b16 a[214:215], v214 offset:17408
 ds_read_b64_tr_b16 a[216:217], v215 offset:16384
 ds_read_b64_tr_b16 a[218:219], v215 offset:17408
 ds_read_b64_tr_b16 a[220:221], v216 offset:16384
 ds_read_b64_tr_b16 a[222:223], v216 offset:17408
 s_waitcnt lgkmcnt(0)
news_36:
 v_mov_b32 v3, 0
 global_load_dword v4, v3, s[42:43] offset:132 sc1
 s_waitcnt vmcnt(0)
newschk_38:
 v_readfirstlane_b32 s7, v4
 s_nop 0
 s_bfe_u32 s64, s7, 0x10005
 s_and_b32 s7, s7, 20
 s_cmp_eq_u32 s7, 20
 s_cbranch_scc1 newsok_37
 s_sleep 2
 s_sub_u32 s46, s46, 1
 s_cbranch_scc0 news_36
 s_mov_b32 s46, 0
 s_branch newsok_37
newsok_37:
 ds_read_b64_tr_b16 a[224:225], v209 offset:24576
 ds_read_b64_tr_b16 a[226:227], v209 offset:25600
 ds_read_b64_tr_b16 a[228:229], v210 offset:24576
 ds_read_b64_tr_b16 a[230:231], v210 offset:25600
 ds_read_b64_tr_b16 a[232:233], v211 offset:24576
 ds_read_b64_tr_b16 a[234:235], v211 offset:25600
 ds_read_b64_tr_b16 a[236:237], v212 offset:24576
 ds_read_b64_tr_b16 a[238:239], v212 offset:25600
 s_waitcnt lgkmcnt(0)
 ds_read_b64_tr_b16 a[240:241], v213 offset:24576
 ds_read_b64_tr_b16 a[242:243], v213 offset:25600
 ds_read_b64_tr_b16 a[244:245], v214 offset:24576
 ds_read_b64_tr_b16 a[246:247], v214 offset:25600
 ds_read_b64_tr_b16 a[248:249], v215 offset:24576
 ds_read_b64_tr_b16 a[250:251], v215 offset:25600
 ds_read_b64_tr_b16 a[252:253], v216 offset:24576
 ds_read_b64_tr_b16 a[254:255], v216 offset:25600
 s_waitcnt lgkmcnt(0)
 s_barrier
 s_cmp_eq_u32 s60, 3
 s_cbranch_scc0 Lw_go
 s_xor_b32 s71, s47, 1
 s_and_b32 s69, s71, 2
 s_add_u32 s69, s69, s71
 s_lshl_b32 s69, s69, 2
 s_add_u32 s69, s69, s47
 s_lshl_b32 s69, s69, 10
 v_add_u32 v244, s69, v1
 s_xor_b32 s71, s47, 1
 s_and_b32 s69, s47, 2
 s_add_u32 s69, s69, s47
 s_lshl_b32 s69, s69, 2
 s_add_u32 s69, s69, s71
 s_lshl_b32 s69, s69, 10
 v_add_u32 v247, s69, v1
 s_xor_b32 s71, s47, 2
 s_and_b32 s69, s71, 2
 s_add_u32 s69, s69, s71
 s_lshl_b32 s69, s69, 2
 s_add_u32 s69, s69, s47
 s_lshl_b32 s69, s69, 10
 v_add_u32 v245, s69, v1
 s_xor_b32 s71, s47, 2
 s_and_b32 s69, s47, 2
 s_add_u32 s69, s69, s47
 s_lshl_b32 s69, s69, 2
 s_add_u32 s69, s69, s71
 s_lshl_b32 s69, s69, 10
 v_add_u32 v248, s69, v1
 s_xor_b32 s71, s47, 3
 s_and_b32 s69, s71, 2
 s_add_u32 s69, s69, s71
 s_lshl_b32 s69, s69, 2
 s_add_u32 s69, s69, s47
 s_lshl_b32 s69, s69, 10
 v_add_u32 v246, s69, v1
 s_xor_b32 s71, s47, 3
 s_and_b32 s69, s47, 2
 s_add_u32 s69, s69, s47
 s_lshl_b32 s69, s69, 2
 s_add_u32 s69, s69, s71
 s_lshl_b32 s69, s69, 10
 v_add_u32 v249, s69, v1
 s_lshl_b32 s69, s61, 2
 s_add_u32 s69, s69, s4
 s_lshl_b32 s76, s69, 15
 s_xor_b32 s69, s64, 1
 s_lshl_b32 s69, s69, 13
 s_add_u32 s76, s76, s69
 s_add_u32 s76, s76, 100663296
 v_mov_b32 v12, -1
 v_mov_b32 v13, -1
 v_mov_b32 v14, -1
 v_mov_b32 v15, -1
 s_add_u32 s69, s76, 0
 buffer_store_dwordx4 v[12:15], v244, s[48:51], s69 offen sc1
 buffer_store_dwordx4 v[12:15], v245, s[48:51], s69 offen sc1
 buffer_store_dwordx4 v[12:15], v246, s[48:51], s69 offen sc1
 s_add_u32 s69, s76, 4194304
 buffer_store_dwordx4 v[12:15], v244, s[48:51], s69 offen sc1
 buffer_store_dwordx4 v[12:15], v245, s[48:51], s69 offen sc1
 buffer_store_dwordx4 v[12:15], v246, s[48:51], s69 offen sc1
 s_add_u32 s69, s76, 8388608
 buffer_store_dwordx4 v[12:15], v244, s[48:51], s69 offen sc1
 buffer_store_dwordx4 v[12:15], v245, s[48:51], s69 offen sc1
 buffer_store_dwordx4 v[12:15], v246, s[48:51], s69 offen sc1
 s_add_u32 s69, s76, 12582912
 buffer_store_dwordx4 v[12:15], v244, s[48:51], s69 offen sc1
 buffer_store_dwordx4 v[12:15], v245, s[48:51], s69 offen sc1
 buffer_store_dwordx4 v[12:15], v246, s[48:51], s69 offen sc1
 s_mov_b32 s56, s8
 s_and_b32 s57, s9, 0xffff
 s_mov_b32 s58, 4194304
 s_mov_b32 s59, 0x20000
 s_add_u32 s70, s61, 8
 s_lshl_b32 s70, s70, 2
 s_add_u32 s70, s70, s47
 s_lshl_b32 s70, s70, 16
 v_lshrrev_b32 v3, 3, v0
 s_lshl_b32 s69, s4, 3
 v_add_u32 v3, s69, v3
 v_bfe_u32 v4, v3, 1, 3
 v_and_b32 v208, 7, v0
 v_xor_b32 v208, v208, v4
 v_lshlrev_b32 v208, 4, v208
 v_lshl_add_u32 v208, v3, 11, v208
 s_lshl_b32 s71, s4, 10
 s_add_u32 m0, s71, 0
 s_nop 0
 buffer_load_dwordx4 v208, s[56:59], s70 offen offset:0 nt lds
 s_add_u32 m0, s71, 3968
 s_nop 0
 buffer_load_dwordx4 v208, s[56:59], s70 offen offset:128 nt lds
 s_add_u32 m0, s71, 7936
 s_nop 0
 buffer_load_dwordx4 v208, s[56:59], s70 offen offset:256 nt lds
 s_add_u32 m0, s71, 11904
 s_nop 0
 buffer_load_dwordx4 v208, s[56:59], s70 offen offset:384 nt lds
 s_add_u32 m0, s71, 15872
 s_nop 0
 buffer_load_dwordx4 v208, s[56:59], s70 offen offset:512 nt lds
 s_add_u32 m0, s71, 19840
 s_nop 0
 buffer_load_dwordx4 v208, s[56:59], s70 offen offset:640 nt lds
 s_add_u32 m0, s71, 23808
 s_nop 0
 buffer_load_dwordx4 v208, s[56:59], s70 offen offset:768 nt lds
 s_add_u32 m0, s71, 27776
 s_nop 0
 buffer_load_dwordx4 v208, s[56:59], s70 offen offset:896 nt lds
 s_add_u32 m0, s71, 31744
 s_nop 0
 buffer_load_dwordx4 v208, s[56:59], s70 offen offset:1024 nt lds
 s_add_u32 m0, s71, 35712
 s_nop 0
 buffer_load_dwordx4 v208, s[56:59], s70 offen offset:1152 nt lds
 s_add_u32 m0, s71, 39680
 s_nop 0
 buffer_load_dwordx4 v208, s[56:59], s70 offen offset:1280 nt lds
 s_add_u32 m0, s71, 43648
 s_nop 0
 buffer_load_dwordx4 v208, s[56:59], s70 offen offset:1408 nt lds
 s_add_u32 m0, s71, 47616
 s_nop 0
 buffer_load_dwordx4 v208, s[56:59], s70 offen offset:1536 nt lds
 s_add_u32 m0, s71, 51584
 s_nop 0
 buffer_load_dwordx4 v208, s[56:59], s70 offen offset:1664 nt lds
 s_add_u32 m0, s71, 55552
 s_nop 0
 buffer_load_dwordx4 v208, s[56:59], s70 offen offset:1792 nt lds
 s_add_u32 m0, s71, 59520
 s_nop 0
 buffer_load_dwordx4 v208, s[56:59], s70 offen offset:1920 nt lds
 v_and_b32 v3, 31, v0
 s_lshl_b32 s69, s4, 14
 v_lshl_add_u32 v224, v3, 7, s69
 v_bfe_u32 v4, v3, 1, 3
 v_lshrrev_b32 v3, 5, v0
 s_add_u32 s70, s70, s69
 v_add_u32 v225, 0, v3
 v_xor_b32 v225, v225, v4
 v_lshl_add_u32 v209, v225, 4, v224
 v_add_u32 v225, 2, v3
 v_xor_b32 v225, v225, v4
 v_lshl_add_u32 v210, v225, 4, v224
 v_add_u32 v225, 4, v3
 v_xor_b32 v225, v225, v4
 v_lshl_add_u32 v211, v225, 4, v224
 v_add_u32 v225, 6, v3
 v_xor_b32 v225, v225, v4
 v_lshl_add_u32 v212, v225, 4, v224
 s_waitcnt vmcnt(0)
 s_barrier
 ds_read_b128 v[16:19], v209 offset:0
 ds_read_b128 v[20:23], v210 offset:0
 ds_read_b128 v[24:27], v211 offset:0
 ds_read_b128 v[28:31], v212 offset:0
 ds_read_b128 v[32:35], v209 offset:4096
 ds_read_b128 v[36:39], v210 offset:4096
 ds_read_b128 v[40:43], v211 offset:4096
 ds_read_b128 v[44:47], v212 offset:4096
 s_add_u32 s71, s70, 8388608
 s_waitcnt lgkmcnt(7)
 buffer_store_dwordx4 v[16:19], v1, s[48:51], s71 offen offset:0 sc1
 s_waitcnt lgkmcnt(6)
 buffer_store_dwordx4 v[20:23], v1, s[48:51], s71 offen offset:1024 sc1
 s_waitcnt lgkmcnt(5)
 buffer_store_dwordx4 v[24:27], v1, s[48:51], s71 offen offset:2048 sc1
 s_waitcnt lgkmcnt(4)
 buffer_store_dwordx4 v[28:31], v1, s[48:51], s71 offen offset:3072 sc1
 s_add_u32 s71, s70, 8392704
 s_waitcnt lgkmcnt(3)
 buffer_store_dwordx4 v[32:35], v1, s[48:51], s71 offen offset:0 sc1
 s_waitcnt lgkmcnt(2)
 buffer_store_dwordx4 v[36:39], v1, s[48:51], s71 offen offset:1024 sc1
 s_waitcnt lgkmcnt(1)
 buffer_store_dwordx4 v[40:43], v1, s[48:51], s71 offen offset:2048 sc1
 s_waitcnt lgkmcnt(0)
 buffer_store_dwordx4 v[44:47], v1, s[48:51], s71 offen offset:3072 sc1
 ds_read_b128 v[48:51], v209 offset:8192
 ds_read_b128 v[52:55], v210 offset:8192
 ds_read_b128 v[56:59], v211 offset:8192
 ds_read_b128 v[60:63], v212 offset:8192
 ds_read_b128 v[64:67], v209 offset:12288
 ds_read_b128 v[68:71], v210 offset:12288
 ds_read_b128 v[72:75], v211 offset:12288
 ds_read_b128 v[76:79], v212 offset:12288
 s_add_u32 s71, s70, 8396800
 s_waitcnt lgkmcnt(7)
 buffer_store_dwordx4 v[48:51], v1, s[48:51], s71 offen offset:0 sc1
 s_waitcnt lgkmcnt(6)
 buffer_store_dwordx4 v[52:55], v1, s[48:51], s71 offen offset:1024 sc1
 s_waitcnt lgkmcnt(5)
 buffer_store_dwordx4 v[56:59], v1, s[48:51], s71 offen offset:2048 sc1
 s_waitcnt lgkmcnt(4)
 buffer_store_dwordx4 v[60:63], v1, s[48:51], s71 offen offset:3072 sc1
 s_add_u32 s71, s70, 8400896
 s_waitcnt lgkmcnt(3)
 buffer_store_dwordx4 v[64:67], v1, s[48:51], s71 offen offset:0 sc1
 s_waitcnt lgkmcnt(2)
 buffer_store_dwordx4 v[68:71], v1, s[48:51], s71 offen offset:1024 sc1
 s_waitcnt lgkmcnt(1)
 buffer_store_dwordx4 v[72:75], v1, s[48:51], s71 offen offset:2048 sc1
 s_waitcnt lgkmcnt(0)
 buffer_store_dwordx4 v[76:79], v1, s[48:51], s71 offen offset:3072 sc1
 s_waitcnt vmcnt(0)
 s_barrier
 s_cmp_eq_u32 s4, 0
 s_cbranch_scc0 Lw_noxf2
 v_mov_b32 v3, 0
 v_mov_b32 v4, 1
 s_mov_b64 exec, 1
 global_atomic_add v4, v3, v4, s[42:43] offset:40 sc0 sc1
 s_waitcnt vmcnt(0)
 s_mov_b64 exec, 1
 v_readfirstlane_b32 s7, v4
 s_nop 0
 s_cmp_eq_u32 s7, 31
 s_cbranch_scc0 arr_39
 v_mov_b32 v4, 8
 global_atomic_or v3, v4, s[42:43] offset:132 sc1
arr_39:
 s_mov_b64 exec, -1
news_40:
 v_mov_b32 v3, 0
 global_load_dword v4, v3, s[42:43] offset:132 sc1
 s_waitcnt vmcnt(0)
newschk_42:
 v_readfirstlane_b32 s7, v4
 s_nop 0
 s_and_b32 s7, s7, 8
 s_cmp_eq_u32 s7, 8
 s_cbranch_scc1 newsok_41
 s_sleep 2
 s_sub_u32 s46, s46, 1
 s_cbranch_scc0 news_40
 s_mov_b32 s46, 0
 s_branch newsok_41
newsok_41:
Lw_noxf2:
 s_barrier
Lw_go:
 s_cmp_eq_u32 s60, 0
 s_cbranch_scc1 Lw_K
 s_cmp_eq_u32 s60, 1
 s_cbranch_scc1 Lw_V
 s_cmp_eq_u32 s60, 2
 s_cbranch_scc1 Lw_Q
 s_mov_b32 s56, s40
 s_and_b32 s57, s41, 0xffff
 s_mov_b32 s58, 8388608
 s_mov_b32 s59, 0x20000
 s_xor_b32 s71, s47, 1
 s_and_b32 s69, s71, 2
 s_add_u32 s69, s69, s71
 s_lshl_b32 s69, s69, 2
 s_add_u32 s69, s69, s47
 s_lshl_b32 s69, s69, 10
 v_add_u32 v244, s69, v1
 s_xor_b32 s71, s47, 1
 s_and_b32 s69, s47, 2
 s_add_u32 s69, s69, s47
 s_lshl_b32 s69, s69, 2
 s_add_u32 s69, s69, s71
 s_lshl_b32 s69, s69, 10
 v_add_u32 v247, s69, v1
 s_xor_b32 s71, s47, 2
 s_and_b32 s69, s71, 2
 s_add_u32 s69, s69, s71
 s_lshl_b32 s69, s69, 2
 s_add_u32 s69, s69, s47
 s_lshl_b32 s69, s69, 10
 v_add_u32 v245, s69, v1
 s_xor_b32 s71, s47, 2
 s_and_b32 s69, s47, 2
 s_add_u32 s69, s69, s47
 s_lshl_b32 s69, s69, 2
 s_add_u32 s69, s69, s71
 s_lshl_b32 s69, s69, 10
 v_add_u32 v248, s69, v1
 s_xor_b32 s71, s47, 3
 s_and_b32 s69, s71, 2
 s_add_u32 s69, s69, s71
 s_lshl_b32 s69, s69, 2
 s_add_u32 s69, s69, s47
 s_lshl_b32 s69, s69, 10
 v_add_u32 v246, s69, v1
 s_xor_b32 s71, s47, 3
 s_and_b32 s69, s47, 2
 s_add_u32 s69, s69, s47
 s_lshl_b32 s69, s69, 2
 s_add_u32 s69, s69, s71
 s_lshl_b32 s69, s69, 10
 v_add_u32 v249, s69, v1
 s_lshl_b32 s69, s61, 2
 s_add_u32 s69, s69, s4
 s_lshl_b32 s76, s69, 15
 s_xor_b32 s69, s64, 1
 s_lshl_b32 s69, s69, 13
 s_add_u32 s76, s76, s69
 s_add_u32 s76, s76, 100663296
 v_and_b32 v11, 1, v0
 s_lshl_b32 s69, s4, 3
 v_lshl_add_u32 v11, v11, 2, s69
 s_lshr_b32 s69, s4, 1
 s_lshl_b32 s70, s69, 8
 v_add_u32 v2, s70, v2
 v_xor_b32 v5, 0x100, v2
 v_and_b32 v3, 15, v0
 v_lshrrev_b32 v4, 4, v0
 v_lshlrev_b32 v4, 3, v4
 v_lshl_add_u32 v250, v3, 12, v4
 s_lshl_b32 s67, s69, 16
 s_lshl_b32 s69, s61, 2
 s_add_u32 s70, s69, s47
 s_lshl_b32 s70, s70, 1
 s_and_b32 s71, s4, 1
 s_add_u32 s70, s70, s71
 s_lshl_b32 s70, s70, 5
 s_add_u32 s67, s67, s70
 s_lshl_b32 s74, s47, 9
 s_add_u32 s74, s74, 3153920
 s_lshl_b32 s65, s47, 16
 s_add_u32 s65, s65, 33554432
Lw_Ocold0:
 s_cmp_eq_u32 s63, 64
 s_cbranch_scc1 Lw_Otail
 s_add_u32 s72, s63, 4
 s_and_b32 s71, s72, 3
 s_lshl_b32 s71, s71, 7
 s_add_u32 s71, s71, s74
 s_lshr_b32 s72, s72, 2
w_44:
 buffer_load_dword v4, v11, s[48:51], s71 offen sc1
 s_waitcnt vmcnt(0)
 v_cmp_gt_u32 vcc, s72, v4
 s_cbranch_vccz wok_45
 s_sleep 1
 s_sub_u32 s46, s46, 1
 s_cbranch_scc0 w_44
 s_mov_b32 s46, 0
 s_branch wok_45
wok_45:
 s_add_u32 s72, s63, 5
 s_and_b32 s71, s72, 3
 s_lshl_b32 s71, s71, 7
 s_add_u32 s71, s71, s74
 s_lshr_b32 s72, s72, 2
 buffer_load_dword v12, v11, s[48:51], s71 offen sc1
 s_add_u32 s82, s65, 0
 buffer_load_dwordx4 v[16:19], v2, s[48:51], s82 offen offset:0 sc1
 buffer_load_dwordx4 v[20:23], v5, s[48:51], s82 offen offset:0 sc1
 buffer_load_dwordx4 v[24:27], v2, s[48:51], s82 offen offset:2048 sc1
 buffer_load_dwordx4 v[28:31], v5, s[48:51], s82 offen offset:2048 sc1
 s_add_u32 s65, s65, 0x40000
 s_waitcnt vmcnt(4)
 v_cmp_gt_u32 vcc, s72, v12
 s_cbranch_vccnz dry_43
 s_waitcnt vmcnt(2)
 v_mfma_f32_16x16x32_bf16 v[80:83], a[0:3], v[16:19], 0
 s_sub_u32 s73, s65, 258048
 buffer_load_dwordx4 v[32:35], v2, s[48:51], s73 offen offset:0 sc1
 v_mfma_f32_16x16x32_bf16 v[96:99], a[4:7], v[16:19], 0
 ds_write_b128 v7, v[160:163] offset:49152
 v_mfma_f32_16x16x32_bf16 v[128:131], a[4:7], v[20:23], 0
 buffer_load_dwordx4 v[36:39], v5, s[48:51], s73 offen offset:0 sc1
 v_mfma_f32_16x16x32_bf16 v[112:115], a[0:3], v[20:23], 0
 v_mfma_f32_16x16x32_bf16 v[84:87], a[8:11], v[16:19], 0
 buffer_load_dwordx4 v[40:43], v2, s[48:51], s73 offen offset:2048 sc1
 v_mfma_f32_16x16x32_bf16 v[100:103], a[12:15], v[16:19], 0
 ds_write_b128 v7, v[164:167] offset:50176
 v_mfma_f32_16x16x32_bf16 v[132:135], a[12:15], v[20:23], 0
 buffer_load_dwordx4 v[44:47], v5, s[48:51], s73 offen offset:2048 sc1
 v_mfma_f32_16x16x32_bf16 v[116:119], a[8:11], v[20:23], 0
 v_mfma_f32_16x16x32_bf16 v[88:91], a[16:19], v[16:19], 0
 s_sub_u32 s73, s65, 253952
 buffer_load_dwordx4 v[48:51], v2, s[48:51], s73 offen offset:0 sc1
 v_mfma_f32_16x16x32_bf16 v[104:107], a[20:23], v[16:19], 0
 ds_write_b128 v7, v[168:171] offset:51200
 v_mfma_f32_16x16x32_bf16 v[136:139], a[20:23], v[20:23], 0
 buffer_load_dwordx4 v[52:55], v5, s[48:51], s73 offen offset:0 sc1
 v_mfma_f32_16x16x32_bf16 v[120:123], a[16:19], v[20:23], 0
 v_mfma_f32_16x16x32_bf16 v[92:95], a[24:27], v[16:19], 0
 buffer_load_dwordx4 v[56:59], v2, s[48:51], s73 offen offset:2048 sc1
 v_mfma_f32_16x16x32_bf16 v[108:111], a[28:31], v[16:19], 0
 ds_write_b128 v7, v[172:175] offset:52224
 v_mfma_f32_16x16x32_bf16 v[140:143], a[28:31], v[20:23], 0
 buffer_load_dwordx4 v[60:63], v5, s[48:51], s73 offen offset:2048 sc1
 v_mfma_f32_16x16x32_bf16 v[124:127], a[24:27], v[20:23], 0
 s_waitcnt vmcnt(8)
 v_mfma_f32_16x16x32_bf16 v[80:83], a[32:35], v[24:27], v[80:83]
 s_add_u32 s82, s65, 0
 buffer_load_dwordx4 v[16:19], v2, s[48:51], s82 offen offset:0 sc1
 v_mfma_f32_16x16x32_bf16 v[96:99], a[36:39], v[24:27], v[96:99]
 ds_write_b128 v8, v[176:179] offset:49152
 v_mfma_f32_16x16x32_bf16 v[128:131], a[36:39], v[28:31], v[128:131]
 buffer_load_dwordx4 v[20:23], v5, s[48:51], s82 offen offset:0 sc1
 v_mfma_f32_16x16x32_bf16 v[112:115], a[32:35], v[28:31], v[112:115]
 v_mfma_f32_16x16x32_bf16 v[84:87], a[40:43], v[24:27], v[84:87]
 s_sub_u32 s73, s65, 249856
 buffer_load_dwordx4 v[64:67], v2, s[48:51], s73 offen offset:0 sc1
 v_mfma_f32_16x16x32_bf16 v[100:103], a[44:47], v[24:27], v[100:103]
 ds_write_b128 v8, v[180:183] offset:50176
 v_mfma_f32_16x16x32_bf16 v[132:135], a[44:47], v[28:31], v[132:135]
 buffer_load_dwordx4 v[68:71], v5, s[48:51], s73 offen offset:0 sc1
 v_mfma_f32_16x16x32_bf16 v[116:119], a[40:43], v[28:31], v[116:119]
 v_mfma_f32_16x16x32_bf16 v[88:91], a[48:51], v[24:27], v[88:91]
 buffer_load_dwordx4 v[72:75], v2, s[48:51], s73 offen offset:2048 sc1
 v_mfma_f32_16x16x32_bf16 v[104:107], a[52:55], v[24:27], v[104:107]
 ds_write_b128 v8, v[184:187] offset:51200
 v_mfma_f32_16x16x32_bf16 v[136:139], a[52:55], v[28:31], v[136:139]
 buffer_load_dwordx4 v[76:79], v5, s[48:51], s73 offen offset:2048 sc1
 v_mfma_f32_16x16x32_bf16 v[120:123], a[48:51], v[28:31], v[120:123]
 s_sub_u32 s77, s63, 3
 s_and_b32 s78, s77, 3
 v_mfma_f32_16x16x32_bf16 v[92:95], a[56:59], v[24:27], v[92:95]
 ds_write_b128 v8, v[188:191] offset:52224
 v_mfma_f32_16x16x32_bf16 v[108:111], a[60:63], v[24:27], v[108:111]
 s_lshl_b32 s78, s78, 22
 s_add_u32 s78, s78, s76
 v_mfma_f32_16x16x32_bf16 v[140:143], a[60:63], v[28:31], v[140:143]
 s_bfe_u32 s79, s77, 0x10002
 v_mfma_f32_16x16x32_bf16 v[124:127], a[56:59], v[28:31], v[124:127]
 ds_write_b128 v9, v[192:195] offset:49152
 s_waitcnt vmcnt(12)
 v_mfma_f32_16x16x32_bf16 v[80:83], a[64:67], v[32:35], v[80:83]
 buffer_load_dwordx4 v[24:27], v2, s[48:51], s82 offen offset:2048 sc1
 v_mfma_f32_16x16x32_bf16 v[96:99], a[68:71], v[32:35], v[96:99]
 buffer_load_dwordx4 v[216:219], v247, s[48:51], s78 offen sc1
 v_mfma_f32_16x16x32_bf16 v[128:131], a[68:71], v[36:39], v[128:131]
 buffer_load_dwordx4 v[28:31], v5, s[48:51], s82 offen offset:2048 sc1
 v_mfma_f32_16x16x32_bf16 v[112:115], a[64:67], v[36:39], v[112:115]
 ds_write_b128 v9, v[196:199] offset:50176
 v_mfma_f32_16x16x32_bf16 v[84:87], a[72:75], v[32:35], v[84:87]
 buffer_load_dwordx4 v[220:223], v248, s[48:51], s78 offen sc1
 v_mfma_f32_16x16x32_bf16 v[100:103], a[76:79], v[32:35], v[100:103]
 buffer_load_dwordx4 v[224:227], v249, s[48:51], s78 offen sc1
 v_mfma_f32_16x16x32_bf16 v[132:135], a[76:79], v[36:39], v[132:135]
 ds_write_b128 v9, v[200:203] offset:51200
 v_mfma_f32_16x16x32_bf16 v[116:119], a[72:75], v[36:39], v[116:119]
 v_mfma_f32_16x16x32_bf16 v[88:91], a[80:83], v[32:35], v[88:91]
 v_mfma_f32_16x16x32_bf16 v[104:107], a[84:87], v[32:35], v[104:107]
 ds_write_b128 v9, v[204:207] offset:52224
 v_mfma_f32_16x16x32_bf16 v[136:139], a[84:87], v[36:39], v[136:139]
 v_mfma_f32_16x16x32_bf16 v[120:123], a[80:83], v[36:39], v[120:123]
 v_mfma_f32_16x16x32_bf16 v[92:95], a[88:91], v[32:35], v[92:95]
 s_waitcnt lgkmcnt(0)
 s_barrier
 v_mfma_f32_16x16x32_bf16 v[108:111], a[92:95], v[32:35], v[108:111]
 ds_read_b128 v[160:163], v10 offset:49152
 v_mfma_f32_16x16x32_bf16 v[140:143], a[92:95], v[36:39], v[140:143]
 ds_read_b128 v[164:167], v10 offset:50176
 v_mfma_f32_16x16x32_bf16 v[124:127], a[88:91], v[36:39], v[124:127]
 ds_read_b128 v[168:171], v10 offset:51200
 s_waitcnt vmcnt(15)
 v_mfma_f32_16x16x32_bf16 v[80:83], a[96:99], v[40:43], v[80:83]
 s_add_u32 s82, s65, 4096
 buffer_load_dwordx4 v[32:35], v2, s[48:51], s82 offen offset:0 sc1
 v_mfma_f32_16x16x32_bf16 v[96:99], a[100:103], v[40:43], v[96:99]
 ds_read_b128 v[172:175], v10 offset:52224
 v_mfma_f32_16x16x32_bf16 v[128:131], a[100:103], v[44:47], v[128:131]
 buffer_load_dwordx4 v[36:39], v5, s[48:51], s82 offen offset:0 sc1
 v_mfma_f32_16x16x32_bf16 v[112:115], a[96:99], v[44:47], v[112:115]
 ds_read_b128 v[176:179], v10 offset:53248
 v_mfma_f32_16x16x32_bf16 v[84:87], a[104:107], v[40:43], v[84:87]
 ds_read_b128 v[180:183], v10 offset:54272
 v_mfma_f32_16x16x32_bf16 v[100:103], a[108:111], v[40:43], v[100:103]
 ds_read_b128 v[184:187], v10 offset:55296
 v_mfma_f32_16x16x32_bf16 v[132:135], a[108:111], v[44:47], v[132:135]
 ds_read_b128 v[188:191], v10 offset:56320
 v_mfma_f32_16x16x32_bf16 v[116:119], a[104:107], v[44:47], v[116:119]
 ds_read_b128 v[192:195], v10 offset:57344
 v_mfma_f32_16x16x32_bf16 v[88:91], a[112:115], v[40:43], v[88:91]
 ds_read_b128 v[196:199], v10 offset:58368
 v_mfma_f32_16x16x32_bf16 v[104:107], a[116:119], v[40:43], v[104:107]
 ds_read_b128 v[200:203], v10 offset:59392
 v_mfma_f32_16x16x32_bf16 v[136:139], a[116:119], v[44:47], v[136:139]
 ds_read_b128 v[204:207], v10 offset:60416
 v_mfma_f32_16x16x32_bf16 v[120:123], a[112:115], v[44:47], v[120:123]
 s_waitcnt lgkmcnt(8)
 v_add_f32 v144, v144, v160
 v_mfma_f32_16x16x32_bf16 v[92:95], a[120:123], v[40:43], v[92:95]
 v_add_f32 v145, v145, v161
 v_add_f32 v146, v146, v162
 v_mfma_f32_16x16x32_bf16 v[108:111], a[124:127], v[40:43], v[108:111]
 v_add_f32 v147, v147, v163
 v_add_f32 v148, v148, v164
 v_mfma_f32_16x16x32_bf16 v[140:143], a[124:127], v[44:47], v[140:143]
 v_add_f32 v149, v149, v165
 v_add_f32 v150, v150, v166
 v_mfma_f32_16x16x32_bf16 v[124:127], a[120:123], v[44:47], v[124:127]
 v_add_f32 v151, v151, v167
 s_waitcnt vmcnt(15)
 v_mfma_f32_16x16x32_bf16 v[80:83], a[128:131], v[48:51], v[80:83]
 buffer_load_dwordx4 v[40:43], v2, s[48:51], s82 offen offset:2048 sc1
 v_mfma_f32_16x16x32_bf16 v[96:99], a[132:135], v[48:51], v[96:99]
 v_add_f32 v152, v152, v168
 v_add_f32 v153, v153, v169
 v_mfma_f32_16x16x32_bf16 v[128:131], a[132:135], v[52:55], v[128:131]
 buffer_load_dwordx4 v[44:47], v5, s[48:51], s82 offen offset:2048 sc1
 v_mfma_f32_16x16x32_bf16 v[112:115], a[128:131], v[52:55], v[112:115]
 v_add_f32 v154, v154, v170
 v_add_f32 v155, v155, v171
 v_mfma_f32_16x16x32_bf16 v[84:87], a[136:139], v[48:51], v[84:87]
 v_add_f32 v156, v156, v172
 v_add_f32 v157, v157, v173
 v_mfma_f32_16x16x32_bf16 v[100:103], a[140:143], v[48:51], v[100:103]
 v_add_f32 v158, v158, v174
 v_add_f32 v159, v159, v175
 v_mfma_f32_16x16x32_bf16 v[132:135], a[140:143], v[52:55], v[132:135]
 s_waitcnt lgkmcnt(4)
 v_add_f32 v144, v144, v176
 v_mfma_f32_16x16x32_bf16 v[116:119], a[136:139], v[52:55], v[116:119]
 v_add_f32 v145, v145, v177
 v_add_f32 v146, v146, v178
 v_mfma_f32_16x16x32_bf16 v[88:91], a[144:147], v[48:51], v[88:91]
 v_add_f32 v147, v147, v179
 v_add_f32 v148, v148, v180
 v_mfma_f32_16x16x32_bf16 v[104:107], a[148:151], v[48:51], v[104:107]
 v_add_f32 v149, v149, v181
 v_add_f32 v150, v150, v182
 v_mfma_f32_16x16x32_bf16 v[136:139], a[148:151], v[52:55], v[136:139]
 v_add_f32 v151, v151, v183
 v_add_f32 v152, v152, v184
 v_mfma_f32_16x16x32_bf16 v[120:123], a[144:147], v[52:55], v[120:123]
 v_add_f32 v153, v153, v185
 v_add_f32 v154, v154, v186
 v_mfma_f32_16x16x32_bf16 v[92:95], a[152:155], v[48:51], v[92:95]
 v_add_f32 v155, v155, v187
 v_add_f32 v156, v156, v188
 v_mfma_f32_16x16x32_bf16 v[108:111], a[156:159], v[48:51], v[108:111]
 v_add_f32 v157, v157, v189
 v_add_f32 v158, v158, v190
 v_mfma_f32_16x16x32_bf16 v[140:143], a[156:159], v[52:55], v[140:143]
 v_add_f32 v159, v159, v191
 s_waitcnt lgkmcnt(0)
 v_mfma_f32_16x16x32_bf16 v[124:127], a[152:155], v[52:55], v[124:127]
 v_add_f32 v144, v144, v192
 s_waitcnt vmcnt(15)
 v_mfma_f32_16x16x32_bf16 v[80:83], a[160:163], v[56:59], v[80:83]
 s_add_u32 s82, s65, 8192
 buffer_load_dwordx4 v[48:51], v2, s[48:51], s82 offen offset:0 sc1
 v_mfma_f32_16x16x32_bf16 v[96:99], a[164:167], v[56:59], v[96:99]
 v_add_f32 v145, v145, v193
 v_add_f32 v146, v146, v194
 v_mfma_f32_16x16x32_bf16 v[128:131], a[164:167], v[60:63], v[128:131]
 buffer_load_dwordx4 v[52:55], v5, s[48:51], s82 offen offset:0 sc1
 v_mfma_f32_16x16x32_bf16 v[112:115], a[160:163], v[60:63], v[112:115]
 v_add_f32 v147, v147, v195
 v_add_f32 v148, v148, v196
 v_mfma_f32_16x16x32_bf16 v[84:87], a[168:171], v[56:59], v[84:87]
 v_add_f32 v149, v149, v197
 v_add_f32 v150, v150, v198
 v_mfma_f32_16x16x32_bf16 v[100:103], a[172:175], v[56:59], v[100:103]
 v_add_f32 v151, v151, v199
 v_add_f32 v152, v152, v200
 v_mfma_f32_16x16x32_bf16 v[132:135], a[172:175], v[60:63], v[132:135]
 v_add_f32 v153, v153, v201
 v_add_f32 v154, v154, v202
 v_mfma_f32_16x16x32_bf16 v[116:119], a[168:171], v[60:63], v[116:119]
 v_add_f32 v155, v155, v203
 v_add_f32 v156, v156, v204
 v_mfma_f32_16x16x32_bf16 v[88:91], a[176:179], v[56:59], v[88:91]
 s_add_u32 s72, s63, 6
 s_and_b32 s71, s72, 3
 v_mfma_f32_16x16x32_bf16 v[104:107], a[180:183], v[56:59], v[104:107]
 s_lshl_b32 s71, s71, 7
 s_add_u32 s71, s71, s74
 v_mfma_f32_16x16x32_bf16 v[136:139], a[180:183], v[60:63], v[136:139]
 s_lshr_b32 s72, s72, 2
 v_mfma_f32_16x16x32_bf16 v[120:123], a[176:179], v[60:63], v[120:123]
 buffer_load_dword v12, v11, s[48:51], s71 offen sc1
 v_mfma_f32_16x16x32_bf16 v[92:95], a[184:187], v[56:59], v[92:95]
 v_add_f32 v157, v157, v205
 v_add_f32 v158, v158, v206
 v_mfma_f32_16x16x32_bf16 v[108:111], a[188:191], v[56:59], v[108:111]
 v_add_f32 v159, v159, v207
 s_waitcnt vmcnt(7)
 v_mfma_f32_16x16x32_bf16 v[140:143], a[188:191], v[60:63], v[140:143]
 v_bitop3_b32 v13, v216, v220, s79 bitop3:0x7e
 v_bitop3_b32 v13, v13, v224, s79 bitop3:0xf6
 v_mfma_f32_16x16x32_bf16 v[124:127], a[184:187], v[60:63], v[124:127]
 v_and_b32 v13, 1, v13
 v_mfma_f32_16x16x32_bf16 v[80:83], a[192:195], v[64:67], v[80:83]
 buffer_load_dwordx4 v[56:59], v2, s[48:51], s82 offen offset:2048 sc1
 v_mfma_f32_16x16x32_bf16 v[96:99], a[196:199], v[64:67], v[96:99]
 v_cmp_eq_u32 vcc, 1, v13
 s_nop 0
 v_mfma_f32_16x16x32_bf16 v[128:131], a[196:199], v[68:71], v[128:131]
 buffer_load_dwordx4 v[60:63], v5, s[48:51], s82 offen offset:2048 sc1
 v_mfma_f32_16x16x32_bf16 v[112:115], a[192:195], v[68:71], v[112:115]
 s_cbranch_vccnz stale_46
fresh_47:
 v_mfma_f32_16x16x32_bf16 v[84:87], a[200:203], v[64:67], v[84:87]
 v_add_f32 v208, v208, v216
 v_add_f32 v209, v209, v217
 v_mfma_f32_16x16x32_bf16 v[100:103], a[204:207], v[64:67], v[100:103]
 v_add_f32 v210, v210, v218
 v_add_f32 v211, v211, v219
 v_mfma_f32_16x16x32_bf16 v[132:135], a[204:207], v[68:71], v[132:135]
 v_add_f32 v208, v208, v220
 v_add_f32 v209, v209, v221
 v_mfma_f32_16x16x32_bf16 v[116:119], a[200:203], v[68:71], v[116:119]
 v_add_f32 v210, v210, v222
 v_add_f32 v211, v211, v223
 v_mfma_f32_16x16x32_bf16 v[88:91], a[208:211], v[64:67], v[88:91]
 v_add_f32 v208, v208, v224
 v_add_f32 v209, v209, v225
 v_mfma_f32_16x16x32_bf16 v[104:107], a[212:215], v[64:67], v[104:107]
 v_add_f32 v210, v210, v226
 v_add_f32 v211, v211, v227
 v_mfma_f32_16x16x32_bf16 v[136:139], a[212:215], v[68:71], v[136:139]
 s_min_u32 s77, s77, 64
 s_lshl_b32 s69, s77, 17
 v_mfma_f32_16x16x32_bf16 v[120:123], a[208:211], v[68:71], v[120:123]
 s_add_u32 s69, s69, s67
 v_cvt_pk_bf16_f32 v14, v208, v209
 v_mfma_f32_16x16x32_bf16 v[92:95], a[216:219], v[64:67], v[92:95]
 v_cvt_pk_bf16_f32 v15, v210, v211
 v_mfma_f32_16x16x32_bf16 v[108:111], a[220:223], v[64:67], v[108:111]
 buffer_store_dwordx2 v[14:15], v250, s[56:59], s69 offen
 v_mfma_f32_16x16x32_bf16 v[140:143], a[220:223], v[68:71], v[140:143]
 v_mov_b32 v208, v144
 v_mov_b32 v209, v145
 v_mfma_f32_16x16x32_bf16 v[124:127], a[216:219], v[68:71], v[124:127]
 v_mov_b32 v210, v146
 v_mfma_f32_16x16x32_bf16 v[80:83], a[224:227], v[72:75], v[80:83]
 s_add_u32 s82, s65, 12288
 buffer_load_dwordx4 v[64:67], v2, s[48:51], s82 offen offset:0 sc1
 v_mfma_f32_16x16x32_bf16 v[96:99], a[228:231], v[72:75], v[96:99]
 v_mov_b32 v211, v147
 s_sub_u32 s77, s63, 1
 v_mfma_f32_16x16x32_bf16 v[128:131], a[228:231], v[76:79], v[128:131]
 buffer_load_dwordx4 v[68:71], v5, s[48:51], s82 offen offset:0 sc1
 v_mfma_f32_16x16x32_bf16 v[112:115], a[224:227], v[76:79], v[112:115]
 s_add_u32 s65, s65, 0x40000
 s_waitcnt vmcnt(5)
 v_mfma_f32_16x16x32_bf16 v[84:87], a[232:235], v[72:75], v[84:87]
 v_cmp_gt_u32 vcc, s72, v12
 s_and_b32 s78, s77, 3
 v_mfma_f32_16x16x32_bf16 v[100:103], a[236:239], v[72:75], v[100:103]
 s_lshl_b32 s78, s78, 22
 s_add_u32 s78, s78, s76
 v_mfma_f32_16x16x32_bf16 v[132:135], a[236:239], v[76:79], v[132:135]
 s_bfe_u32 s79, s77, 0x10002
 v_bfi_b32 v148, 1, s79, v148
 v_mfma_f32_16x16x32_bf16 v[116:119], a[232:235], v[76:79], v[116:119]
 v_bfi_b32 v152, 1, s79, v152
 v_bfi_b32 v156, 1, s79, v156
 v_mfma_f32_16x16x32_bf16 v[88:91], a[240:243], v[72:75], v[88:91]
 buffer_store_dwordx4 v[148:151], v244, s[48:51], s78 offen sc1
 v_mfma_f32_16x16x32_bf16 v[104:107], a[244:247], v[72:75], v[104:107]
 buffer_store_dwordx4 v[152:155], v245, s[48:51], s78 offen sc1
 v_mfma_f32_16x16x32_bf16 v[136:139], a[244:247], v[76:79], v[136:139]
 buffer_store_dwordx4 v[156:159], v246, s[48:51], s78 offen sc1
 v_mfma_f32_16x16x32_bf16 v[120:123], a[240:243], v[76:79], v[120:123]
 s_add_u32 s63, s63, 1
 v_mfma_f32_16x16x32_bf16 v[92:95], a[248:251], v[72:75], v[92:95]
 v_mfma_f32_16x16x32_bf16 v[108:111], a[252:255], v[72:75], v[108:111]
 v_mfma_f32_16x16x32_bf16 v[140:143], a[252:255], v[76:79], v[140:143]
 v_mfma_f32_16x16x32_bf16 v[124:127], a[248:251], v[76:79], v[124:127]
 s_branch Lw_Owarm1
dry_43:
 s_waitcnt vmcnt(2)
 v_mfma_f32_16x16x32_bf16 v[80:83], a[0:3], v[16:19], 0
 s_sub_u32 s73, s65, 258048
 buffer_load_dwordx4 v[32:35], v2, s[48:51], s73 offen offset:0 sc1
 v_mfma_f32_16x16x32_bf16 v[96:99], a[4:7], v[16:19], 0
 ds_write_b128 v7, v[160:163] offset:49152
 v_mfma_f32_16x16x32_bf16 v[128:131], a[4:7], v[20:23], 0
 buffer_load_dwordx4 v[36:39], v5, s[48:51], s73 offen offset:0 sc1
 v_mfma_f32_16x16x32_bf16 v[112:115], a[0:3], v[20:23], 0
 v_mfma_f32_16x16x32_bf16 v[84:87], a[8:11], v[16:19], 0
 buffer_load_dwordx4 v[40:43], v2, s[48:51], s73 offen offset:2048 sc1
 v_mfma_f32_16x16x32_bf16 v[100:103], a[12:15], v[16:19], 0
 ds_write_b128 v7, v[164:167] offset:50176
 v_mfma_f32_16x16x32_bf16 v[132:135], a[12:15], v[20:23], 0
 buffer_load_dwordx4 v[44:47], v5, s[48:51], s73 offen offset:2048 sc1
 v_mfma_f32_16x16x32_bf16 v[116:119], a[8:11], v[20:23], 0
 v_mfma_f32_16x16x32_bf16 v[88:91], a[16:19], v[16:19], 0
 s_sub_u32 s73, s65, 253952
 buffer_load_dwordx4 v[48:51], v2, s[48:51], s73 offen offset:0 sc1
 v_mfma_f32_16x16x32_bf16 v[104:107], a[20:23], v[16:19], 0
 ds_write_b128 v7, v[168:171] offset:51200
 v_mfma_f32_16x16x32_bf16 v[136:139], a[20:23], v[20:23], 0
 buffer_load_dwordx4 v[52:55], v5, s[48:51], s73 offen offset:0 sc1
 v_mfma_f32_16x16x32_bf16 v[120:123], a[16:19], v[20:23], 0
 v_mfma_f32_16x16x32_bf16 v[92:95], a[24:27], v[16:19], 0
 buffer_load_dwordx4 v[56:59], v2, s[48:51], s73 offen offset:2048 sc1
 v_mfma_f32_16x16x32_bf16 v[108:111], a[28:31], v[16:19], 0
 ds_write_b128 v7, v[172:175] offset:52224
 v_mfma_f32_16x16x32_bf16 v[140:143], a[28:31], v[20:23], 0
 buffer_load_dwordx4 v[60:63], v5, s[48:51], s73 offen offset:2048 sc1
 v_mfma_f32_16x16x32_bf16 v[124:127], a[24:27], v[20:23], 0
 s_waitcnt vmcnt(8)
 v_mfma_f32_16x16x32_bf16 v[80:83], a[32:35], v[24:27], v[80:83]
 ds_write_b128 v8, v[176:179] offset:49152
 v_mfma_f32_16x16x32_bf16 v[96:99], a[36:39], v[24:27], v[96:99]
 v_mfma_f32_16x16x32_bf16 v[128:131], a[36:39], v[28:31], v[128:131]
 v_mfma_f32_16x16x32_bf16 v[112:115], a[32:35], v[28:31], v[112:115]
 ds_write_b128 v8, v[180:183] offset:50176
 v_mfma_f32_16x16x32_bf16 v[84:87], a[40:43], v[24:27], v[84:87]
 s_sub_u32 s73, s65, 249856
 buffer_load_dwordx4 v[64:67], v2, s[48:51], s73 offen offset:0 sc1
 v_mfma_f32_16x16x32_bf16 v[100:103], a[44:47], v[24:27], v[100:103]
 v_mfma_f32_16x16x32_bf16 v[132:135], a[44:47], v[28:31], v[132:135]
 buffer_load_dwordx4 v[68:71], v5, s[48:51], s73 offen offset:0 sc1
 v_mfma_f32_16x16x32_bf16 v[116:119], a[40:43], v[28:31], v[116:119]
 ds_write_b128 v8, v[184:187] offset:51200
 v_mfma_f32_16x16x32_bf16 v[88:91], a[48:51], v[24:27], v[88:91]
 buffer_load_dwordx4 v[72:75], v2, s[48:51], s73 offen offset:2048 sc1
 v_mfma_f32_16x16x32_bf16 v[104:107], a[52:55], v[24:27], v[104:107]
 v_mfma_f32_16x16x32_bf16 v[136:139], a[52:55], v[28:31], v[136:139]
 buffer_load_dwordx4 v[76:79], v5, s[48:51], s73 offen offset:2048 sc1
 v_mfma_f32_16x16x32_bf16 v[120:123], a[48:51], v[28:31], v[120:123]
 ds_write_b128 v8, v[188:191] offset:52224
 v_mfma_f32_16x16x32_bf16 v[92:95], a[56:59], v[24:27], v[92:95]
 s_sub_u32 s77, s63, 3
 s_and_b32 s78, s77, 3
 v_mfma_f32_16x16x32_bf16 v[108:111], a[60:63], v[24:27], v[108:111]
 s_lshl_b32 s78, s78, 22
 s_add_u32 s78, s78, s76
 v_mfma_f32_16x16x32_bf16 v[140:143], a[60:63], v[28:31], v[140:143]
 ds_write_b128 v9, v[192:195] offset:49152
 v_mfma_f32_16x16x32_bf16 v[124:127], a[56:59], v[28:31], v[124:127]
 s_bfe_u32 s79, s77, 0x10002
 s_waitcnt vmcnt(10)
 v_mfma_f32_16x16x32_bf16 v[80:83], a[64:67], v[32:35], v[80:83]
 buffer_load_dwordx4 v[216:219], v247, s[48:51], s78 offen sc1
 v_mfma_f32_16x16x32_bf16 v[96:99], a[68:71], v[32:35], v[96:99]
 ds_write_b128 v9, v[196:199] offset:50176
 v_mfma_f32_16x16x32_bf16 v[128:131], a[68:71], v[36:39], v[128:131]
 buffer_load_dwordx4 v[220:223], v248, s[48:51], s78 offen sc1
 v_mfma_f32_16x16x32_bf16 v[112:115], a[64:67], v[36:39], v[112:115]
 buffer_load_dwordx4 v[224:227], v249, s[48:51], s78 offen sc1
 v_mfma_f32_16x16x32_bf16 v[84:87], a[72:75], v[32:35], v[84:87]
 ds_write_b128 v9, v[200:203] offset:51200
 v_mfma_f32_16x16x32_bf16 v[100:103], a[76:79], v[32:35], v[100:103]
 v_mfma_f32_16x16x32_bf16 v[132:135], a[76:79], v[36:39], v[132:135]
 v_mfma_f32_16x16x32_bf16 v[116:119], a[72:75], v[36:39], v[116:119]
 ds_write_b128 v9, v[204:207] offset:52224
 v_mfma_f32_16x16x32_bf16 v[88:91], a[80:83], v[32:35], v[88:91]
 v_mfma_f32_16x16x32_bf16 v[104:107], a[84:87], v[32:35], v[104:107]
 v_mfma_f32_16x16x32_bf16 v[136:139], a[84:87], v[36:39], v[136:139]
 s_waitcnt lgkmcnt(0)
 s_barrier
 v_mfma_f32_16x16x32_bf16 v[120:123], a[80:83], v[36:39], v[120:123]
 ds_read_b128 v[160:163], v10 offset:49152
 v_mfma_f32_16x16x32_bf16 v[92:95], a[88:91], v[32:35], v[92:95]
 ds_read_b128 v[164:167], v10 offset:50176
 v_mfma_f32_16x16x32_bf16 v[108:111], a[92:95], v[32:35], v[108:111]
 ds_read_b128 v[168:171], v10 offset:51200
 v_mfma_f32_16x16x32_bf16 v[140:143], a[92:95], v[36:39], v[140:143]
 ds_read_b128 v[172:175], v10 offset:52224
 v_mfma_f32_16x16x32_bf16 v[124:127], a[88:91], v[36:39], v[124:127]
 ds_read_b128 v[176:179], v10 offset:53248
 s_waitcnt vmcnt(11)
 v_mfma_f32_16x16x32_bf16 v[80:83], a[96:99], v[40:43], v[80:83]
 ds_read_b128 v[180:183], v10 offset:54272
 v_mfma_f32_16x16x32_bf16 v[96:99], a[100:103], v[40:43], v[96:99]
 ds_read_b128 v[184:187], v10 offset:55296
 v_mfma_f32_16x16x32_bf16 v[128:131], a[100:103], v[44:47], v[128:131]
 ds_read_b128 v[188:191], v10 offset:56320
 v_mfma_f32_16x16x32_bf16 v[112:115], a[96:99], v[44:47], v[112:115]
 ds_read_b128 v[192:195], v10 offset:57344
 v_mfma_f32_16x16x32_bf16 v[84:87], a[104:107], v[40:43], v[84:87]
 ds_read_b128 v[196:199], v10 offset:58368
 v_mfma_f32_16x16x32_bf16 v[100:103], a[108:111], v[40:43], v[100:103]
 ds_read_b128 v[200:203], v10 offset:59392
 v_mfma_f32_16x16x32_bf16 v[132:135], a[108:111], v[44:47], v[132:135]
 ds_read_b128 v[204:207], v10 offset:60416
 v_mfma_f32_16x16x32_bf16 v[116:119], a[104:107], v[44:47], v[116:119]
 s_waitcnt lgkmcnt(8)
 v_add_f32 v144, v144, v160
 v_mfma_f32_16x16x32_bf16 v[88:91], a[112:115], v[40:43], v[88:91]
 v_add_f32 v145, v145, v161
 v_add_f32 v146, v146, v162
 v_mfma_f32_16x16x32_bf16 v[104:107], a[116:119], v[40:43], v[104:107]
 v_add_f32 v147, v147, v163
 v_add_f32 v148, v148, v164
 v_mfma_f32_16x16x32_bf16 v[136:139], a[116:119], v[44:47], v[136:139]
 v_add_f32 v149, v149, v165
 v_add_f32 v150, v150, v166
 v_mfma_f32_16x16x32_bf16 v[120:123], a[112:115], v[44:47], v[120:123]
 v_add_f32 v151, v151, v167
 v_add_f32 v152, v152, v168
 v_mfma_f32_16x16x32_bf16 v[92:95], a[120:123], v[40:43], v[92:95]
 v_add_f32 v153, v153, v169
 v_add_f32 v154, v154, v170
 v_mfma_f32_16x16x32_bf16 v[108:111], a[124:127], v[40:43], v[108:111]
 v_add_f32 v155, v155, v171
 v_add_f32 v156, v156, v172
 v_mfma_f32_16x16x32_bf16 v[140:143], a[124:127], v[44:47], v[140:143]
 v_add_f32 v157, v157, v173
 v_add_f32 v158, v158, v174
 v_mfma_f32_16x16x32_bf16 v[124:127], a[120:123], v[44:47], v[124:127]
 v_add_f32 v159, v159, v175
 s_waitcnt vmcnt(9)
 v_mfma_f32_16x16x32_bf16 v[80:83], a[128:131], v[48:51], v[80:83]
 s_waitcnt lgkmcnt(4)
 v_add_f32 v144, v144, v176
 v_mfma_f32_16x16x32_bf16 v[96:99], a[132:135], v[48:51], v[96:99]
 v_add_f32 v145, v145, v177
 v_add_f32 v146, v146, v178
 v_mfma_f32_16x16x32_bf16 v[128:131], a[132:135], v[52:55], v[128:131]
 v_add_f32 v147, v147, v179
 v_add_f32 v148, v148, v180
 v_mfma_f32_16x16x32_bf16 v[112:115], a[128:131], v[52:55], v[112:115]
 v_add_f32 v149, v149, v181
 v_add_f32 v150, v150, v182
 v_mfma_f32_16x16x32_bf16 v[84:87], a[136:139], v[48:51], v[84:87]
 v_add_f32 v151, v151, v183
 v_add_f32 v152, v152, v184
 v_mfma_f32_16x16x32_bf16 v[100:103], a[140:143], v[48:51], v[100:103]
 v_add_f32 v153, v153, v185
 v_add_f32 v154, v154, v186
 v_mfma_f32_16x16x32_bf16 v[132:135], a[140:143], v[52:55], v[132:135]
 v_add_f32 v155, v155, v187
 v_add_f32 v156, v156, v188
 v_mfma_f32_16x16x32_bf16 v[116:119], a[136:139], v[52:55], v[116:119]
 v_add_f32 v157, v157, v189
 v_add_f32 v158, v158, v190
 v_mfma_f32_16x16x32_bf16 v[88:91], a[144:147], v[48:51], v[88:91]
 v_add_f32 v159, v159, v191
 s_waitcnt lgkmcnt(0)
 v_mfma_f32_16x16x32_bf16 v[104:107], a[148:151], v[48:51], v[104:107]
 v_add_f32 v144, v144, v192
 v_add_f32 v145, v145, v193
 v_mfma_f32_16x16x32_bf16 v[136:139], a[148:151], v[52:55], v[136:139]
 v_add_f32 v146, v146, v194
 v_add_f32 v147, v147, v195
 v_mfma_f32_16x16x32_bf16 v[120:123], a[144:147], v[52:55], v[120:123]
 v_add_f32 v148, v148, v196
 v_add_f32 v149, v149, v197
 v_mfma_f32_16x16x32_bf16 v[92:95], a[152:155], v[48:51], v[92:95]
 v_add_f32 v150, v150, v198
 v_add_f32 v151, v151, v199
 v_mfma_f32_16x16x32_bf16 v[108:111], a[156:159], v[48:51], v[108:111]
 v_add_f32 v152, v152, v200
 v_add_f32 v153, v153, v201
 v_mfma_f32_16x16x32_bf16 v[140:143], a[156:159], v[52:55], v[140:143]
 v_add_f32 v154, v154, v202
 v_add_f32 v155, v155, v203
 v_mfma_f32_16x16x32_bf16 v[124:127], a[152:155], v[52:55], v[124:127]
 v_add_f32 v156, v156, v204
 s_waitcnt vmcnt(7)
 v_mfma_f32_16x16x32_bf16 v[80:83], a[160:163], v[56:59], v[80:83]
 v_add_f32 v157, v157, v205
 v_add_f32 v158, v158, v206
 v_mfma_f32_16x16x32_bf16 v[96:99], a[164:167], v[56:59], v[96:99]
 v_add_f32 v159, v159, v207
 s_waitcnt vmcnt(0)
 v_mfma_f32_16x16x32_bf16 v[128:131], a[164:167], v[60:63], v[128:131]
 v_bitop3_b32 v13, v216, v220, s79 bitop3:0x7e
 v_bitop3_b32 v13, v13, v224, s79 bitop3:0xf6
 v_mfma_f32_16x16x32_bf16 v[112:115], a[160:163], v[60:63], v[112:115]
 v_and_b32 v13, 1, v13
 v_cmp_eq_u32 vcc, 1, v13
 v_mfma_f32_16x16x32_bf16 v[84:87], a[168:171], v[56:59], v[84:87]
 s_nop 0
 v_mfma_f32_16x16x32_bf16 v[100:103], a[172:175], v[56:59], v[100:103]
 s_cbranch_vccnz stale_48
fresh_49:
 v_mfma_f32_16x16x32_bf16 v[132:135], a[172:175], v[60:63], v[132:135]
 v_add_f32 v208, v208, v216
 v_add_f32 v209, v209, v217
 v_mfma_f32_16x16x32_bf16 v[116:119], a[168:171], v[60:63], v[116:119]
 v_add_f32 v210, v210, v218
 v_add_f32 v211, v211, v219
 v_mfma_f32_16x16x32_bf16 v[88:91], a[176:179], v[56:59], v[88:91]
 v_add_f32 v208, v208, v220
 v_add_f32 v209, v209, v221
 v_mfma_f32_16x16x32_bf16 v[104:107], a[180:183], v[56:59], v[104:107]
 v_add_f32 v210, v210, v222
 v_add_f32 v211, v211, v223
 v_mfma_f32_16x16x32_bf16 v[136:139], a[180:183], v[60:63], v[136:139]
 v_add_f32 v208, v208, v224
 v_add_f32 v209, v209, v225
 v_mfma_f32_16x16x32_bf16 v[120:123], a[176:179], v[60:63], v[120:123]
 v_add_f32 v210, v210, v226
 v_add_f32 v211, v211, v227
 v_mfma_f32_16x16x32_bf16 v[92:95], a[184:187], v[56:59], v[92:95]
 s_min_u32 s77, s77, 64
 s_lshl_b32 s69, s77, 17
 v_mfma_f32_16x16x32_bf16 v[108:111], a[188:191], v[56:59], v[108:111]
 s_add_u32 s69, s69, s67
 v_cvt_pk_bf16_f32 v14, v208, v209
 v_mfma_f32_16x16x32_bf16 v[140:143], a[188:191], v[60:63], v[140:143]
 v_cvt_pk_bf16_f32 v15, v210, v211
 v_mfma_f32_16x16x32_bf16 v[124:127], a[184:187], v[60:63], v[124:127]
 buffer_store_dwordx2 v[14:15], v250, s[56:59], s69 offen
 v_mfma_f32_16x16x32_bf16 v[80:83], a[192:195], v[64:67], v[80:83]
 v_mov_b32 v208, v144
 v_mov_b32 v209, v145
 v_mfma_f32_16x16x32_bf16 v[96:99], a[196:199], v[64:67], v[96:99]
 v_mov_b32 v210, v146
 v_mov_b32 v211, v147
 v_mfma_f32_16x16x32_bf16 v[128:131], a[196:199], v[68:71], v[128:131]
 s_sub_u32 s77, s63, 1
 s_and_b32 s78, s77, 3
 v_mfma_f32_16x16x32_bf16 v[112:115], a[192:195], v[68:71], v[112:115]
 s_lshl_b32 s78, s78, 22
 s_add_u32 s78, s78, s76
 v_mfma_f32_16x16x32_bf16 v[84:87], a[200:203], v[64:67], v[84:87]
 s_bfe_u32 s79, s77, 0x10002
 v_bfi_b32 v148, 1, s79, v148
 v_mfma_f32_16x16x32_bf16 v[100:103], a[204:207], v[64:67], v[100:103]
 v_bfi_b32 v152, 1, s79, v152
 v_bfi_b32 v156, 1, s79, v156
 v_mfma_f32_16x16x32_bf16 v[132:135], a[204:207], v[68:71], v[132:135]
 buffer_store_dwordx4 v[148:151], v244, s[48:51], s78 offen sc1
 v_mfma_f32_16x16x32_bf16 v[116:119], a[200:203], v[68:71], v[116:119]
 buffer_store_dwordx4 v[152:155], v245, s[48:51], s78 offen sc1
 v_mfma_f32_16x16x32_bf16 v[88:91], a[208:211], v[64:67], v[88:91]
 buffer_store_dwordx4 v[156:159], v246, s[48:51], s78 offen sc1
 v_mfma_f32_16x16x32_bf16 v[104:107], a[212:215], v[64:67], v[104:107]
 s_add_u32 s63, s63, 1
 v_mfma_f32_16x16x32_bf16 v[136:139], a[212:215], v[68:71], v[136:139]
 v_mfma_f32_16x16x32_bf16 v[120:123], a[208:211], v[68:71], v[120:123]
 v_mfma_f32_16x16x32_bf16 v[92:95], a[216:219], v[64:67], v[92:95]
 v_mfma_f32_16x16x32_bf16 v[108:111], a[220:223], v[64:67], v[108:111]
 v_mfma_f32_16x16x32_bf16 v[140:143], a[220:223], v[68:71], v[140:143]
 v_mfma_f32_16x16x32_bf16 v[124:127], a[216:219], v[68:71], v[124:127]
 v_mfma_f32_16x16x32_bf16 v[80:83], a[224:227], v[72:75], v[80:83]
 v_mfma_f32_16x16x32_bf16 v[96:99], a[228:231], v[72:75], v[96:99]
 v_mfma_f32_16x16x32_bf16 v[128:131], a[228:231], v[76:79], v[128:131]
 v_mfma_f32_16x16x32_bf16 v[112:115], a[224:227], v[76:79], v[112:115]
 v_mfma_f32_16x16x32_bf16 v[84:87], a[232:235], v[72:75], v[84:87]
 v_mfma_f32_16x16x32_bf16 v[100:103], a[236:239], v[72:75], v[100:103]
 v_mfma_f32_16x16x32_bf16 v[132:135], a[236:239], v[76:79], v[132:135]
 v_mfma_f32_16x16x32_bf16 v[116:119], a[232:235], v[76:79], v[116:119]
 v_mfma_f32_16x16x32_bf16 v[88:91], a[240:243], v[72:75], v[88:91]
 v_mfma_f32_16x16x32_bf16 v[104:107], a[244:247], v[72:75], v[104:107]
 v_mfma_f32_16x16x32_bf16 v[136:139], a[244:247], v[76:79], v[136:139]
 v_mfma_f32_16x16x32_bf16 v[120:123], a[240:243], v[76:79], v[120:123]
 v_mfma_f32_16x16x32_bf16 v[92:95], a[248:251], v[72:75], v[92:95]
 v_mfma_f32_16x16x32_bf16 v[108:111], a[252:255], v[72:75], v[108:111]
 v_mfma_f32_16x16x32_bf16 v[140:143], a[252:255], v[76:79], v[140:143]
 v_mfma_f32_16x16x32_bf16 v[124:127], a[248:251], v[76:79], v[124:127]
 s_branch Lw_Ocold1
Lw_Owarm0:
 s_cbranch_vccnz dry_50
 v_mfma_f32_16x16x32_bf16 v[80:83], a[0:3], v[16:19], 0
 buffer_load_dwordx4 v[72:75], v2, s[48:51], s82 offen offset:2048 sc1
 v_mfma_f32_16x16x32_bf16 v[96:99], a[4:7], v[16:19], 0
 ds_write_b128 v7, v[160:163] offset:49152
 v_mfma_f32_16x16x32_bf16 v[128:131], a[4:7], v[20:23], 0
 buffer_load_dwordx4 v[76:79], v5, s[48:51], s82 offen offset:2048 sc1
 v_mfma_f32_16x16x32_bf16 v[112:115], a[0:3], v[20:23], 0
 s_sub_u32 s77, s63, 3
 s_and_b32 s78, s77, 3
 v_mfma_f32_16x16x32_bf16 v[84:87], a[8:11], v[16:19], 0
 ds_write_b128 v7, v[164:167] offset:50176
 v_mfma_f32_16x16x32_bf16 v[100:103], a[12:15], v[16:19], 0
 s_lshl_b32 s78, s78, 22
 s_add_u32 s78, s78, s76
 v_mfma_f32_16x16x32_bf16 v[132:135], a[12:15], v[20:23], 0
 s_bfe_u32 s79, s77, 0x10002
 v_mfma_f32_16x16x32_bf16 v[116:119], a[8:11], v[20:23], 0
 ds_write_b128 v7, v[168:171] offset:51200
 v_mfma_f32_16x16x32_bf16 v[88:91], a[16:19], v[16:19], 0
 buffer_load_dwordx4 v[216:219], v247, s[48:51], s78 offen sc1
 v_mfma_f32_16x16x32_bf16 v[104:107], a[20:23], v[16:19], 0
 buffer_load_dwordx4 v[220:223], v248, s[48:51], s78 offen sc1
 v_mfma_f32_16x16x32_bf16 v[136:139], a[20:23], v[20:23], 0
 ds_write_b128 v7, v[172:175] offset:52224
 v_mfma_f32_16x16x32_bf16 v[120:123], a[16:19], v[20:23], 0
 buffer_load_dwordx4 v[224:227], v249, s[48:51], s78 offen sc1
 v_mfma_f32_16x16x32_bf16 v[92:95], a[24:27], v[16:19], 0
 v_mfma_f32_16x16x32_bf16 v[108:111], a[28:31], v[16:19], 0
 ds_write_b128 v8, v[176:179] offset:49152
 v_mfma_f32_16x16x32_bf16 v[140:143], a[28:31], v[20:23], 0
 v_mfma_f32_16x16x32_bf16 v[124:127], a[24:27], v[20:23], 0
 v_mfma_f32_16x16x32_bf16 v[80:83], a[32:35], v[24:27], v[80:83]
 s_add_u32 s82, s65, 0
 buffer_load_dwordx4 v[16:19], v2, s[48:51], s82 offen offset:0 sc1
 v_mfma_f32_16x16x32_bf16 v[96:99], a[36:39], v[24:27], v[96:99]
 ds_write_b128 v8, v[180:183] offset:50176
 v_mfma_f32_16x16x32_bf16 v[128:131], a[36:39], v[28:31], v[128:131]
 buffer_load_dwordx4 v[20:23], v5, s[48:51], s82 offen offset:0 sc1
 v_mfma_f32_16x16x32_bf16 v[112:115], a[32:35], v[28:31], v[112:115]
 v_mfma_f32_16x16x32_bf16 v[84:87], a[40:43], v[24:27], v[84:87]
 ds_write_b128 v8, v[184:187] offset:51200
 v_mfma_f32_16x16x32_bf16 v[100:103], a[44:47], v[24:27], v[100:103]
 v_mfma_f32_16x16x32_bf16 v[132:135], a[44:47], v[28:31], v[132:135]
 v_mfma_f32_16x16x32_bf16 v[116:119], a[40:43], v[28:31], v[116:119]
 ds_write_b128 v8, v[188:191] offset:52224
 v_mfma_f32_16x16x32_bf16 v[88:91], a[48:51], v[24:27], v[88:91]
 v_mfma_f32_16x16x32_bf16 v[104:107], a[52:55], v[24:27], v[104:107]
 v_mfma_f32_16x16x32_bf16 v[136:139], a[52:55], v[28:31], v[136:139]
 ds_write_b128 v9, v[192:195] offset:49152
 v_mfma_f32_16x16x32_bf16 v[120:123], a[48:51], v[28:31], v[120:123]
 v_mfma_f32_16x16x32_bf16 v[92:95], a[56:59], v[24:27], v[92:95]
 v_mfma_f32_16x16x32_bf16 v[108:111], a[60:63], v[24:27], v[108:111]
 ds_write_b128 v9, v[196:199] offset:50176
 v_mfma_f32_16x16x32_bf16 v[140:143], a[60:63], v[28:31], v[140:143]
 v_mfma_f32_16x16x32_bf16 v[124:127], a[56:59], v[28:31], v[124:127]
 v_mfma_f32_16x16x32_bf16 v[80:83], a[64:67], v[32:35], v[80:83]
 buffer_load_dwordx4 v[24:27], v2, s[48:51], s82 offen offset:2048 sc1
 v_mfma_f32_16x16x32_bf16 v[96:99], a[68:71], v[32:35], v[96:99]
 ds_write_b128 v9, v[200:203] offset:51200
 v_mfma_f32_16x16x32_bf16 v[128:131], a[68:71], v[36:39], v[128:131]
 buffer_load_dwordx4 v[28:31], v5, s[48:51], s82 offen offset:2048 sc1
 v_mfma_f32_16x16x32_bf16 v[112:115], a[64:67], v[36:39], v[112:115]
 v_mfma_f32_16x16x32_bf16 v[84:87], a[72:75], v[32:35], v[84:87]
 ds_write_b128 v9, v[204:207] offset:52224
 v_mfma_f32_16x16x32_bf16 v[100:103], a[76:79], v[32:35], v[100:103]
 v_mfma_f32_16x16x32_bf16 v[132:135], a[76:79], v[36:39], v[132:135]
 v_mfma_f32_16x16x32_bf16 v[116:119], a[72:75], v[36:39], v[116:119]
 s_waitcnt lgkmcnt(0)
 s_barrier
 v_mfma_f32_16x16x32_bf16 v[88:91], a[80:83], v[32:35], v[88:91]
 ds_read_b128 v[160:163], v10 offset:49152
 v_mfma_f32_16x16x32_bf16 v[104:107], a[84:87], v[32:35], v[104:107]
 ds_read_b128 v[164:167], v10 offset:50176
 v_mfma_f32_16x16x32_bf16 v[136:139], a[84:87], v[36:39], v[136:139]
 ds_read_b128 v[168:171], v10 offset:51200
 v_mfma_f32_16x16x32_bf16 v[120:123], a[80:83], v[36:39], v[120:123]
 ds_read_b128 v[172:175], v10 offset:52224
 v_mfma_f32_16x16x32_bf16 v[92:95], a[88:91], v[32:35], v[92:95]
 ds_read_b128 v[176:179], v10 offset:53248
 v_mfma_f32_16x16x32_bf16 v[108:111], a[92:95], v[32:35], v[108:111]
 ds_read_b128 v[180:183], v10 offset:54272
 v_mfma_f32_16x16x32_bf16 v[140:143], a[92:95], v[36:39], v[140:143]
 ds_read_b128 v[184:187], v10 offset:55296
 v_mfma_f32_16x16x32_bf16 v[124:127], a[88:91], v[36:39], v[124:127]
 ds_read_b128 v[188:191], v10 offset:56320
 v_mfma_f32_16x16x32_bf16 v[80:83], a[96:99], v[40:43], v[80:83]
 s_add_u32 s82, s65, 4096
 buffer_load_dwordx4 v[32:35], v2, s[48:51], s82 offen offset:0 sc1
 v_mfma_f32_16x16x32_bf16 v[96:99], a[100:103], v[40:43], v[96:99]
 ds_read_b128 v[192:195], v10 offset:57344
 v_mfma_f32_16x16x32_bf16 v[128:131], a[100:103], v[44:47], v[128:131]
 buffer_load_dwordx4 v[36:39], v5, s[48:51], s82 offen offset:0 sc1
 v_mfma_f32_16x16x32_bf16 v[112:115], a[96:99], v[44:47], v[112:115]
 ds_read_b128 v[196:199], v10 offset:58368
 v_mfma_f32_16x16x32_bf16 v[84:87], a[104:107], v[40:43], v[84:87]
 ds_read_b128 v[200:203], v10 offset:59392
 v_mfma_f32_16x16x32_bf16 v[100:103], a[108:111], v[40:43], v[100:103]
 ds_read_b128 v[204:207], v10 offset:60416
 v_mfma_f32_16x16x32_bf16 v[132:135], a[108:111], v[44:47], v[132:135]
 s_waitcnt lgkmcnt(8)
 v_add_f32 v144, v144, v160
 v_mfma_f32_16x16x32_bf16 v[116:119], a[104:107], v[44:47], v[116:119]
 v_add_f32 v145, v145, v161
 v_add_f32 v146, v146, v162
 v_mfma_f32_16x16x32_bf16 v[88:91], a[112:115], v[40:43], v[88:91]
 v_add_f32 v147, v147, v163
 v_add_f32 v148, v148, v164
 v_mfma_f32_16x16x32_bf16 v[104:107], a[116:119], v[40:43], v[104:107]
 v_add_f32 v149, v149, v165
 v_add_f32 v150, v150, v166
 v_mfma_f32_16x16x32_bf16 v[136:139], a[116:119], v[44:47], v[136:139]
 v_add_f32 v151, v151, v167
 v_add_f32 v152, v152, v168
 v_mfma_f32_16x16x32_bf16 v[120:123], a[112:115], v[44:47], v[120:123]
 v_add_f32 v153, v153, v169
 v_add_f32 v154, v154, v170
 v_mfma_f32_16x16x32_bf16 v[92:95], a[120:123], v[40:43], v[92:95]
 v_add_f32 v155, v155, v171
 v_add_f32 v156, v156, v172
 v_mfma_f32_16x16x32_bf16 v[108:111], a[124:127], v[40:43], v[108:111]
 v_add_f32 v157, v157, v173
 v_add_f32 v158, v158, v174
 v_mfma_f32_16x16x32_bf16 v[140:143], a[124:127], v[44:47], v[140:143]
 v_add_f32 v159, v159, v175
 s_waitcnt lgkmcnt(4)
 v_mfma_f32_16x16x32_bf16 v[124:127], a[120:123], v[44:47], v[124:127]
 v_add_f32 v144, v144, v176
 v_mfma_f32_16x16x32_bf16 v[80:83], a[128:131], v[48:51], v[80:83]
 buffer_load_dwordx4 v[40:43], v2, s[48:51], s82 offen offset:2048 sc1
 v_mfma_f32_16x16x32_bf16 v[96:99], a[132:135], v[48:51], v[96:99]
 v_add_f32 v145, v145, v177
 v_add_f32 v146, v146, v178
 v_mfma_f32_16x16x32_bf16 v[128:131], a[132:135], v[52:55], v[128:131]
 buffer_load_dwordx4 v[44:47], v5, s[48:51], s82 offen offset:2048 sc1
 v_mfma_f32_16x16x32_bf16 v[112:115], a[128:131], v[52:55], v[112:115]
 v_add_f32 v147, v147, v179
 v_add_f32 v148, v148, v180
 v_mfma_f32_16x16x32_bf16 v[84:87], a[136:139], v[48:51], v[84:87]
 v_add_f32 v149, v149, v181
 v_add_f32 v150, v150, v182
 v_mfma_f32_16x16x32_bf16 v[100:103], a[140:143], v[48:51], v[100:103]
 v_add_f32 v151, v151, v183
 v_add_f32 v152, v152, v184
 v_mfma_f32_16x16x32_bf16 v[132:135], a[140:143], v[52:55], v[132:135]
 v_add_f32 v153, v153, v185
 v_add_f32 v154, v154, v186
 v_mfma_f32_16x16x32_bf16 v[116:119], a[136:139], v[52:55], v[116:119]
 v_add_f32 v155, v155, v187
 v_add_f32 v156, v156, v188
 v_mfma_f32_16x16x32_bf16 v[88:91], a[144:147], v[48:51], v[88:91]
 v_add_f32 v157, v157, v189
 v_add_f32 v158, v158, v190
 v_mfma_f32_16x16x32_bf16 v[104:107], a[148:151], v[48:51], v[104:107]
 v_add_f32 v159, v159, v191
 s_waitcnt lgkmcnt(0)
 v_mfma_f32_16x16x32_bf16 v[136:139], a[148:151], v[52:55], v[136:139]
 v_add_f32 v144, v144, v192
 v_add_f32 v145, v145, v193
 v_mfma_f32_16x16x32_bf16 v[120:123], a[144:147], v[52:55], v[120:123]
 v_add_f32 v146, v146, v194
 v_add_f32 v147, v147, v195
 v_mfma_f32_16x16x32_bf16 v[92:95], a[152:155], v[48:51], v[92:95]
 v_add_f32 v148, v148, v196
 v_add_f32 v149, v149, v197
 v_mfma_f32_16x16x32_bf16 v[108:111], a[156:159], v[48:51], v[108:111]
 v_add_f32 v150, v150, v198
 v_add_f32 v151, v151, v199
 v_mfma_f32_16x16x32_bf16 v[140:143], a[156:159], v[52:55], v[140:143]
 v_add_f32 v152, v152, v200
 v_add_f32 v153, v153, v201
 v_mfma_f32_16x16x32_bf16 v[124:127], a[152:155], v[52:55], v[124:127]
 v_add_f32 v154, v154, v202
 s_waitcnt vmcnt(19)
 v_mfma_f32_16x16x32_bf16 v[80:83], a[160:163], v[56:59], v[80:83]
 s_add_u32 s82, s65, 8192
 buffer_load_dwordx4 v[48:51], v2, s[48:51], s82 offen offset:0 sc1
 v_mfma_f32_16x16x32_bf16 v[96:99], a[164:167], v[56:59], v[96:99]
 v_add_f32 v155, v155, v203
 v_add_f32 v156, v156, v204
 v_mfma_f32_16x16x32_bf16 v[128:131], a[164:167], v[60:63], v[128:131]
 buffer_load_dwordx4 v[52:55], v5, s[48:51], s82 offen offset:0 sc1
 v_mfma_f32_16x16x32_bf16 v[112:115], a[160:163], v[60:63], v[112:115]
 v_add_f32 v157, v157, v205
 v_add_f32 v158, v158, v206
 v_mfma_f32_16x16x32_bf16 v[84:87], a[168:171], v[56:59], v[84:87]
 v_add_f32 v159, v159, v207
 s_waitcnt vmcnt(10)
 v_mfma_f32_16x16x32_bf16 v[100:103], a[172:175], v[56:59], v[100:103]
 v_bitop3_b32 v13, v216, v220, s79 bitop3:0x7e
 v_bitop3_b32 v13, v13, v224, s79 bitop3:0xf6
 v_mfma_f32_16x16x32_bf16 v[132:135], a[172:175], v[60:63], v[132:135]
 v_and_b32 v13, 1, v13
 v_cmp_eq_u32 vcc, 1, v13
 v_mfma_f32_16x16x32_bf16 v[116:119], a[168:171], v[60:63], v[116:119]
 s_nop 0
 v_mfma_f32_16x16x32_bf16 v[88:91], a[176:179], v[56:59], v[88:91]
 s_add_u32 s72, s63, 6
 s_and_b32 s71, s72, 3
 v_mfma_f32_16x16x32_bf16 v[104:107], a[180:183], v[56:59], v[104:107]
 s_lshl_b32 s71, s71, 7
 s_add_u32 s71, s71, s74
 v_mfma_f32_16x16x32_bf16 v[136:139], a[180:183], v[60:63], v[136:139]
 s_lshr_b32 s72, s72, 2
 v_mfma_f32_16x16x32_bf16 v[120:123], a[176:179], v[60:63], v[120:123]
 buffer_load_dword v12, v11, s[48:51], s71 offen sc1
 v_mfma_f32_16x16x32_bf16 v[92:95], a[184:187], v[56:59], v[92:95]
 s_cbranch_vccnz stale_51
fresh_52:
 v_mfma_f32_16x16x32_bf16 v[108:111], a[188:191], v[56:59], v[108:111]
 v_add_f32 v208, v208, v216
 v_add_f32 v209, v209, v217
 v_mfma_f32_16x16x32_bf16 v[140:143], a[188:191], v[60:63], v[140:143]
 v_add_f32 v210, v210, v218
 v_add_f32 v211, v211, v219
 v_mfma_f32_16x16x32_bf16 v[124:127], a[184:187], v[60:63], v[124:127]
 v_add_f32 v208, v208, v220
 v_mfma_f32_16x16x32_bf16 v[80:83], a[192:195], v[64:67], v[80:83]
 buffer_load_dwordx4 v[56:59], v2, s[48:51], s82 offen offset:2048 sc1
 v_mfma_f32_16x16x32_bf16 v[96:99], a[196:199], v[64:67], v[96:99]
 v_add_f32 v209, v209, v221
 v_add_f32 v210, v210, v222
 v_mfma_f32_16x16x32_bf16 v[128:131], a[196:199], v[68:71], v[128:131]
 buffer_load_dwordx4 v[60:63], v5, s[48:51], s82 offen offset:2048 sc1
 v_mfma_f32_16x16x32_bf16 v[112:115], a[192:195], v[68:71], v[112:115]
 v_add_f32 v211, v211, v223
 v_add_f32 v208, v208, v224
 v_mfma_f32_16x16x32_bf16 v[84:87], a[200:203], v[64:67], v[84:87]
 v_add_f32 v209, v209, v225
 v_add_f32 v210, v210, v226
 v_mfma_f32_16x16x32_bf16 v[100:103], a[204:207], v[64:67], v[100:103]
 v_add_f32 v211, v211, v227
 s_min_u32 s77, s77, 64
 v_mfma_f32_16x16x32_bf16 v[132:135], a[204:207], v[68:71], v[132:135]
 s_lshl_b32 s69, s77, 17
 s_add_u32 s69, s69, s67
 v_mfma_f32_16x16x32_bf16 v[116:119], a[200:203], v[68:71], v[116:119]
 v_cvt_pk_bf16_f32 v14, v208, v209
 v_cvt_pk_bf16_f32 v15, v210, v211
 v_mfma_f32_16x16x32_bf16 v[88:91], a[208:211], v[64:67], v[88:91]
 buffer_store_dwordx2 v[14:15], v250, s[56:59], s69 offen
 v_mfma_f32_16x16x32_bf16 v[104:107], a[212:215], v[64:67], v[104:107]
 v_mov_b32 v208, v144
 v_mov_b32 v209, v145
 v_mfma_f32_16x16x32_bf16 v[136:139], a[212:215], v[68:71], v[136:139]
 v_mov_b32 v210, v146
 v_mov_b32 v211, v147
 v_mfma_f32_16x16x32_bf16 v[120:123], a[208:211], v[68:71], v[120:123]
 s_sub_u32 s77, s63, 1
 s_and_b32 s78, s77, 3
 v_mfma_f32_16x16x32_bf16 v[92:95], a[216:219], v[64:67], v[92:95]
 s_lshl_b32 s78, s78, 22
 s_add_u32 s78, s78, s76
 v_mfma_f32_16x16x32_bf16 v[108:111], a[220:223], v[64:67], v[108:111]
 s_bfe_u32 s79, s77, 0x10002
 v_bfi_b32 v148, 1, s79, v148
 v_mfma_f32_16x16x32_bf16 v[140:143], a[220:223], v[68:71], v[140:143]
 v_bfi_b32 v152, 1, s79, v152
 v_bfi_b32 v156, 1, s79, v156
 v_mfma_f32_16x16x32_bf16 v[124:127], a[216:219], v[68:71], v[124:127]
 buffer_store_dwordx4 v[148:151], v244, s[48:51], s78 offen sc1
 v_mfma_f32_16x16x32_bf16 v[80:83], a[224:227], v[72:75], v[80:83]
 s_add_u32 s82, s65, 12288
 buffer_load_dwordx4 v[64:67], v2, s[48:51], s82 offen offset:0 sc1
 v_mfma_f32_16x16x32_bf16 v[96:99], a[228:231], v[72:75], v[96:99]
 buffer_store_dwordx4 v[152:155], v245, s[48:51], s78 offen sc1
 v_mfma_f32_16x16x32_bf16 v[128:131], a[228:231], v[76:79], v[128:131]
 buffer_load_dwordx4 v[68:71], v5, s[48:51], s82 offen offset:0 sc1
 v_mfma_f32_16x16x32_bf16 v[112:115], a[224:227], v[76:79], v[112:115]
 s_add_u32 s65, s65, 0x40000
 s_waitcnt vmcnt(7)
 v_mfma_f32_16x16x32_bf16 v[84:87], a[232:235], v[72:75], v[84:87]
 v_cmp_gt_u32 vcc, s72, v12
 v_mfma_f32_16x16x32_bf16 v[100:103], a[236:239], v[72:75], v[100:103]
 buffer_store_dwordx4 v[156:159], v246, s[48:51], s78 offen sc1
 v_mfma_f32_16x16x32_bf16 v[132:135], a[236:239], v[76:79], v[132:135]
 s_add_u32 s63, s63, 1
 v_mfma_f32_16x16x32_bf16 v[116:119], a[232:235], v[76:79], v[116:119]
 v_mfma_f32_16x16x32_bf16 v[88:91], a[240:243], v[72:75], v[88:91]
 v_mfma_f32_16x16x32_bf16 v[104:107], a[244:247], v[72:75], v[104:107]
 v_mfma_f32_16x16x32_bf16 v[136:139], a[244:247], v[76:79], v[136:139]
 v_mfma_f32_16x16x32_bf16 v[120:123], a[240:243], v[76:79], v[120:123]
 v_mfma_f32_16x16x32_bf16 v[92:95], a[248:251], v[72:75], v[92:95]
 v_mfma_f32_16x16x32_bf16 v[108:111], a[252:255], v[72:75], v[108:111]
 v_mfma_f32_16x16x32_bf16 v[140:143], a[252:255], v[76:79], v[140:143]
 v_mfma_f32_16x16x32_bf16 v[124:127], a[248:251], v[76:79], v[124:127]
 s_branch Lw_Owarm1
dry_50:
 v_mfma_f32_16x16x32_bf16 v[80:83], a[0:3], v[16:19], 0
 buffer_load_dwordx4 v[72:75], v2, s[48:51], s82 offen offset:2048 sc1
 v_mfma_f32_16x16x32_bf16 v[96:99], a[4:7], v[16:19], 0
 ds_write_b128 v7, v[160:163] offset:49152
 v_mfma_f32_16x16x32_bf16 v[128:131], a[4:7], v[20:23], 0
 buffer_load_dwordx4 v[76:79], v5, s[48:51], s82 offen offset:2048 sc1
 v_mfma_f32_16x16x32_bf16 v[112:115], a[0:3], v[20:23], 0
 s_sub_u32 s77, s63, 3
 s_and_b32 s78, s77, 3
 v_mfma_f32_16x16x32_bf16 v[84:87], a[8:11], v[16:19], 0
 ds_write_b128 v7, v[164:167] offset:50176
 v_mfma_f32_16x16x32_bf16 v[100:103], a[12:15], v[16:19], 0
 s_lshl_b32 s78, s78, 22
 s_add_u32 s78, s78, s76
 v_mfma_f32_16x16x32_bf16 v[132:135], a[12:15], v[20:23], 0
 s_bfe_u32 s79, s77, 0x10002
 v_mfma_f32_16x16x32_bf16 v[116:119], a[8:11], v[20:23], 0
 ds_write_b128 v7, v[168:171] offset:51200
 v_mfma_f32_16x16x32_bf16 v[88:91], a[16:19], v[16:19], 0
 buffer_load_dwordx4 v[216:219], v247, s[48:51], s78 offen sc1
 v_mfma_f32_16x16x32_bf16 v[104:107], a[20:23], v[16:19], 0
 buffer_load_dwordx4 v[220:223], v248, s[48:51], s78 offen sc1
 v_mfma_f32_16x16x32_bf16 v[136:139], a[20:23], v[20:23], 0
 ds_write_b128 v7, v[172:175] offset:52224
 v_mfma_f32_16x16x32_bf16 v[120:123], a[16:19], v[20:23], 0
 buffer_load_dwordx4 v[224:227], v249, s[48:51], s78 offen sc1
 v_mfma_f32_16x16x32_bf16 v[92:95], a[24:27], v[16:19], 0
 v_mfma_f32_16x16x32_bf16 v[108:111], a[28:31], v[16:19], 0
 ds_write_b128 v8, v[176:179] offset:49152
 v_mfma_f32_16x16x32_bf16 v[140:143], a[28:31], v[20:23], 0
 v_mfma_f32_16x16x32_bf16 v[124:127], a[24:27], v[20:23], 0
 v_mfma_f32_16x16x32_bf16 v[80:83], a[32:35], v[24:27], v[80:83]
 ds_write_b128 v8, v[180:183] offset:50176
 v_mfma_f32_16x16x32_bf16 v[96:99], a[36:39], v[24:27], v[96:99]
 v_mfma_f32_16x16x32_bf16 v[128:131], a[36:39], v[28:31], v[128:131]
 v_mfma_f32_16x16x32_bf16 v[112:115], a[32:35], v[28:31], v[112:115]
 ds_write_b128 v8, v[184:187] offset:51200
 v_mfma_f32_16x16x32_bf16 v[84:87], a[40:43], v[24:27], v[84:87]
 v_mfma_f32_16x16x32_bf16 v[100:103], a[44:47], v[24:27], v[100:103]
 v_mfma_f32_16x16x32_bf16 v[132:135], a[44:47], v[28:31], v[132:135]
 ds_write_b128 v8, v[188:191] offset:52224
 v_mfma_f32_16x16x32_bf16 v[116:119], a[40:43], v[28:31], v[116:119]
 v_mfma_f32_16x16x32_bf16 v[88:91], a[48:51], v[24:27], v[88:91]
 v_mfma_f32_16x16x32_bf16 v[104:107], a[52:55], v[24:27], v[104:107]
 ds_write_b128 v9, v[192:195] offset:49152
 v_mfma_f32_16x16x32_bf16 v[136:139], a[52:55], v[28:31], v[136:139]
 v_mfma_f32_16x16x32_bf16 v[120:123], a[48:51], v[28:31], v[120:123]
 v_mfma_f32_16x16x32_bf16 v[92:95], a[56:59], v[24:27], v[92:95]
 ds_write_b128 v9, v[196:199] offset:50176
 v_mfma_f32_16x16x32_bf16 v[108:111], a[60:63], v[24:27], v[108:111]
 v_mfma_f32_16x16x32_bf16 v[140:143], a[60:63], v[28:31], v[140:143]
 v_mfma_f32_16x16x32_bf16 v[124:127], a[56:59], v[28:31], v[124:127]
 ds_write_b128 v9, v[200:203] offset:51200
 v_mfma_f32_16x16x32_bf16 v[80:83], a[64:67], v[32:35], v[80:83]
 v_mfma_f32_16x16x32_bf16 v[96:99], a[68:71], v[32:35], v[96:99]
 v_mfma_f32_16x16x32_bf16 v[128:131], a[68:71], v[36:39], v[128:131]
 ds_write_b128 v9, v[204:207] offset:52224
 v_mfma_f32_16x16x32_bf16 v[112:115], a[64:67], v[36:39], v[112:115]
 v_mfma_f32_16x16x32_bf16 v[84:87], a[72:75], v[32:35], v[84:87]
 v_mfma_f32_16x16x32_bf16 v[100:103], a[76:79], v[32:35], v[100:103]
 s_waitcnt lgkmcnt(0)
 s_barrier
 v_mfma_f32_16x16x32_bf16 v[132:135], a[76:79], v[36:39], v[132:135]
 ds_read_b128 v[160:163], v10 offset:49152
 v_mfma_f32_16x16x32_bf16 v[116:119], a[72:75], v[36:39], v[116:119]
 ds_read_b128 v[164:167], v10 offset:50176
 v_mfma_f32_16x16x32_bf16 v[88:91], a[80:83], v[32:35], v[88:91]
 ds_read_b128 v[168:171], v10 offset:51200
 v_mfma_f32_16x16x32_bf16 v[104:107], a[84:87], v[32:35], v[104:107]
 ds_read_b128 v[172:175], v10 offset:52224
 v_mfma_f32_16x16x32_bf16 v[136:139], a[84:87], v[36:39], v[136:139]
 ds_read_b128 v[176:179], v10 offset:53248
 v_mfma_f32_16x16x32_bf16 v[120:123], a[80:83], v[36:39], v[120:123]
 ds_read_b128 v[180:183], v10 offset:54272
 v_mfma_f32_16x16x32_bf16 v[92:95], a[88:91], v[32:35], v[92:95]
 ds_read_b128 v[184:187], v10 offset:55296
 v_mfma_f32_16x16x32_bf16 v[108:111], a[92:95], v[32:35], v[108:111]
 ds_read_b128 v[188:191], v10 offset:56320
 v_mfma_f32_16x16x32_bf16 v[140:143], a[92:95], v[36:39], v[140:143]
 ds_read_b128 v[192:195], v10 offset:57344
 v_mfma_f32_16x16x32_bf16 v[124:127], a[88:91], v[36:39], v[124:127]
 ds_read_b128 v[196:199], v10 offset:58368
 v_mfma_f32_16x16x32_bf16 v[80:83], a[96:99], v[40:43], v[80:83]
 ds_read_b128 v[200:203], v10 offset:59392
 v_mfma_f32_16x16x32_bf16 v[96:99], a[100:103], v[40:43], v[96:99]
 ds_read_b128 v[204:207], v10 offset:60416
 v_mfma_f32_16x16x32_bf16 v[128:131], a[100:103], v[44:47], v[128:131]
 s_waitcnt lgkmcnt(8)
 v_add_f32 v144, v144, v160
 v_mfma_f32_16x16x32_bf16 v[112:115], a[96:99], v[44:47], v[112:115]
 v_add_f32 v145, v145, v161
 v_add_f32 v146, v146, v162
 v_mfma_f32_16x16x32_bf16 v[84:87], a[104:107], v[40:43], v[84:87]
 v_add_f32 v147, v147, v163
 v_add_f32 v148, v148, v164
 v_mfma_f32_16x16x32_bf16 v[100:103], a[108:111], v[40:43], v[100:103]
 v_add_f32 v149, v149, v165
 v_add_f32 v150, v150, v166
 v_mfma_f32_16x16x32_bf16 v[132:135], a[108:111], v[44:47], v[132:135]
 v_add_f32 v151, v151, v167
 v_add_f32 v152, v152, v168
 v_mfma_f32_16x16x32_bf16 v[116:119], a[104:107], v[44:47], v[116:119]
 v_add_f32 v153, v153, v169
 v_add_f32 v154, v154, v170
 v_mfma_f32_16x16x32_bf16 v[88:91], a[112:115], v[40:43], v[88:91]
 v_add_f32 v155, v155, v171
 v_add_f32 v156, v156, v172
 v_mfma_f32_16x16x32_bf16 v[104:107], a[116:119], v[40:43], v[104:107]
 v_add_f32 v157, v157, v173
 v_add_f32 v158, v158, v174
 v_mfma_f32_16x16x32_bf16 v[136:139], a[116:119], v[44:47], v[136:139]
 v_add_f32 v159, v159, v175
 s_waitcnt lgkmcnt(4)
 v_mfma_f32_16x16x32_bf16 v[120:123], a[112:115], v[44:47], v[120:123]
 v_add_f32 v144, v144, v176
 v_add_f32 v145, v145, v177
 v_mfma_f32_16x16x32_bf16 v[92:95], a[120:123], v[40:43], v[92:95]
 v_add_f32 v146, v146, v178
 v_add_f32 v147, v147, v179
 v_mfma_f32_16x16x32_bf16 v[108:111], a[124:127], v[40:43], v[108:111]
 v_add_f32 v148, v148, v180
 v_add_f32 v149, v149, v181
 v_mfma_f32_16x16x32_bf16 v[140:143], a[124:127], v[44:47], v[140:143]
 v_add_f32 v150, v150, v182
 v_add_f32 v151, v151, v183
 v_mfma_f32_16x16x32_bf16 v[124:127], a[120:123], v[44:47], v[124:127]
 v_add_f32 v152, v152, v184
 v_mfma_f32_16x16x32_bf16 v[80:83], a[128:131], v[48:51], v[80:83]
 v_add_f32 v153, v153, v185
 v_add_f32 v154, v154, v186
 v_mfma_f32_16x16x32_bf16 v[96:99], a[132:135], v[48:51], v[96:99]
 v_add_f32 v155, v155, v187
 v_add_f32 v156, v156, v188
 v_mfma_f32_16x16x32_bf16 v[128:131], a[132:135], v[52:55], v[128:131]
 v_add_f32 v157, v157, v189
 v_add_f32 v158, v158, v190
 v_mfma_f32_16x16x32_bf16 v[112:115], a[128:131], v[52:55], v[112:115]
 v_add_f32 v159, v159, v191
 s_waitcnt lgkmcnt(0)
 v_mfma_f32_16x16x32_bf16 v[84:87], a[136:139], v[48:51], v[84:87]
 v_add_f32 v144, v144, v192
 v_add_f32 v145, v145, v193
 v_mfma_f32_16x16x32_bf16 v[100:103], a[140:143], v[48:51], v[100:103]
 v_add_f32 v146, v146, v194
 v_add_f32 v147, v147, v195
 v_mfma_f32_16x16x32_bf16 v[132:135], a[140:143], v[52:55], v[132:135]
 v_add_f32 v148, v148, v196
 v_add_f32 v149, v149, v197
 v_mfma_f32_16x16x32_bf16 v[116:119], a[136:139], v[52:55], v[116:119]
 v_add_f32 v150, v150, v198
 v_add_f32 v151, v151, v199
 v_mfma_f32_16x16x32_bf16 v[88:91], a[144:147], v[48:51], v[88:91]
 v_add_f32 v152, v152, v200
 v_add_f32 v153, v153, v201
 v_mfma_f32_16x16x32_bf16 v[104:107], a[148:151], v[48:51], v[104:107]
 v_add_f32 v154, v154, v202
 v_add_f32 v155, v155, v203
 v_mfma_f32_16x16x32_bf16 v[136:139], a[148:151], v[52:55], v[136:139]
 v_add_f32 v156, v156, v204
 v_add_f32 v157, v157, v205
 v_mfma_f32_16x16x32_bf16 v[120:123], a[144:147], v[52:55], v[120:123]
 v_add_f32 v158, v158, v206
 v_add_f32 v159, v159, v207
 v_mfma_f32_16x16x32_bf16 v[92:95], a[152:155], v[48:51], v[92:95]
 s_waitcnt vmcnt(0)
 v_bitop3_b32 v13, v216, v220, s79 bitop3:0x7e
 v_mfma_f32_16x16x32_bf16 v[108:111], a[156:159], v[48:51], v[108:111]
 v_bitop3_b32 v13, v13, v224, s79 bitop3:0xf6
 v_and_b32 v13, 1, v13
 v_mfma_f32_16x16x32_bf16 v[140:143], a[156:159], v[52:55], v[140:143]
 v_cmp_eq_u32 vcc, 1, v13
 s_nop 0
 v_mfma_f32_16x16x32_bf16 v[124:127], a[152:155], v[52:55], v[124:127]
 s_cbranch_vccnz stale_53
fresh_54:
 v_mfma_f32_16x16x32_bf16 v[80:83], a[160:163], v[56:59], v[80:83]
 v_add_f32 v208, v208, v216
 v_add_f32 v209, v209, v217
 v_mfma_f32_16x16x32_bf16 v[96:99], a[164:167], v[56:59], v[96:99]
 v_add_f32 v210, v210, v218
 v_add_f32 v211, v211, v219
 v_mfma_f32_16x16x32_bf16 v[128:131], a[164:167], v[60:63], v[128:131]
 v_add_f32 v208, v208, v220
 v_add_f32 v209, v209, v221
 v_mfma_f32_16x16x32_bf16 v[112:115], a[160:163], v[60:63], v[112:115]
 v_add_f32 v210, v210, v222
 v_add_f32 v211, v211, v223
 v_mfma_f32_16x16x32_bf16 v[84:87], a[168:171], v[56:59], v[84:87]
 v_add_f32 v208, v208, v224
 v_add_f32 v209, v209, v225
 v_mfma_f32_16x16x32_bf16 v[100:103], a[172:175], v[56:59], v[100:103]
 v_add_f32 v210, v210, v226
 v_add_f32 v211, v211, v227
 v_mfma_f32_16x16x32_bf16 v[132:135], a[172:175], v[60:63], v[132:135]
 s_min_u32 s77, s77, 64
 s_lshl_b32 s69, s77, 17
 v_mfma_f32_16x16x32_bf16 v[116:119], a[168:171], v[60:63], v[116:119]
 s_add_u32 s69, s69, s67
 v_cvt_pk_bf16_f32 v14, v208, v209
 v_mfma_f32_16x16x32_bf16 v[88:91], a[176:179], v[56:59], v[88:91]
 v_cvt_pk_bf16_f32 v15, v210, v211
 v_mfma_f32_16x16x32_bf16 v[104:107], a[180:183], v[56:59], v[104:107]
 buffer_store_dwordx2 v[14:15], v250, s[56:59], s69 offen
 v_mfma_f32_16x16x32_bf16 v[136:139], a[180:183], v[60:63], v[136:139]
 v_mov_b32 v208, v144
 v_mov_b32 v209, v145
 v_mfma_f32_16x16x32_bf16 v[120:123], a[176:179], v[60:63], v[120:123]
 v_mov_b32 v210, v146
 v_mov_b32 v211, v147
 v_mfma_f32_16x16x32_bf16 v[92:95], a[184:187], v[56:59], v[92:95]
 s_sub_u32 s77, s63, 1
 s_and_b32 s78, s77, 3
 v_mfma_f32_16x16x32_bf16 v[108:111], a[188:191], v[56:59], v[108:111]
 s_lshl_b32 s78, s78, 22
 s_add_u32 s78, s78, s76
 v_mfma_f32_16x16x32_bf16 v[140:143], a[188:191], v[60:63], v[140:143]
 s_bfe_u32 s79, s77, 0x10002
 v_bfi_b32 v148, 1, s79, v148
 v_mfma_f32_16x16x32_bf16 v[124:127], a[184:187], v[60:63], v[124:127]
 v_bfi_b32 v152, 1, s79, v152
 v_mfma_f32_16x16x32_bf16 v[80:83], a[192:195], v[64:67], v[80:83]
 v_bfi_b32 v156, 1, s79, v156
 v_mfma_f32_16x16x32_bf16 v[96:99], a[196:199], v[64:67], v[96:99]
 buffer_store_dwordx4 v[148:151], v244, s[48:51], s78 offen sc1
 v_mfma_f32_16x16x32_bf16 v[128:131], a[196:199], v[68:71], v[128:131]
 buffer_store_dwordx4 v[152:155], v245, s[48:51], s78 offen sc1
 v_mfma_f32_16x16x32_bf16 v[112:115], a[192:195], v[68:71], v[112:115]
 buffer_store_dwordx4 v[156:159], v246, s[48:51], s78 offen sc1
 v_mfma_f32_16x16x32_bf16 v[84:87], a[200:203], v[64:67], v[84:87]
 s_add_u32 s63, s63, 1
 v_mfma_f32_16x16x32_bf16 v[100:103], a[204:207], v[64:67], v[100:103]
 v_mfma_f32_16x16x32_bf16 v[132:135], a[204:207], v[68:71], v[132:135]
 v_mfma_f32_16x16x32_bf16 v[116:119], a[200:203], v[68:71], v[116:119]
 v_mfma_f32_16x16x32_bf16 v[88:91], a[208:211], v[64:67], v[88:91]
 v_mfma_f32_16x16x32_bf16 v[104:107], a[212:215], v[64:67], v[104:107]
 v_mfma_f32_16x16x32_bf16 v[136:139], a[212:215], v[68:71], v[136:139]
 v_mfma_f32_16x16x32_bf16 v[120:123], a[208:211], v[68:71], v[120:123]
 v_mfma_f32_16x16x32_bf16 v[92:95], a[216:219], v[64:67], v[92:95]
 v_mfma_f32_16x16x32_bf16 v[108:111], a[220:223], v[64:67], v[108:111]
 v_mfma_f32_16x16x32_bf16 v[140:143], a[220:223], v[68:71], v[140:143]
 v_mfma_f32_16x16x32_bf16 v[124:127], a[216:219], v[68:71], v[124:127]
 v_mfma_f32_16x16x32_bf16 v[80:83], a[224:227], v[72:75], v[80:83]
 v_mfma_f32_16x16x32_bf16 v[96:99], a[228:231], v[72:75], v[96:99]
 v_mfma_f32_16x16x32_bf16 v[128:131], a[228:231], v[76:79], v[128:131]
 v_mfma_f32_16x16x32_bf16 v[112:115], a[224:227], v[76:79], v[112:115]
 v_mfma_f32_16x16x32_bf16 v[84:87], a[232:235], v[72:75], v[84:87]
 v_mfma_f32_16x16x32_bf16 v[100:103], a[236:239], v[72:75], v[100:103]
 v_mfma_f32_16x16x32_bf16 v[132:135], a[236:239], v[76:79], v[132:135]
 v_mfma_f32_16x16x32_bf16 v[116:119], a[232:235], v[76:79], v[116:119]
 v_mfma_f32_16x16x32_bf16 v[88:91], a[240:243], v[72:75], v[88:91]
 v_mfma_f32_16x16x32_bf16 v[104:107], a[244:247], v[72:75], v[104:107]
 v_mfma_f32_16x16x32_bf16 v[136:139], a[244:247], v[76:79], v[136:139]
 v_mfma_f32_16x16x32_bf16 v[120:123], a[240:243], v[76:79], v[120:123]
 v_mfma_f32_16x16x32_bf16 v[92:95], a[248:251], v[72:75], v[92:95]
 v_mfma_f32_16x16x32_bf16 v[108:111], a[252:255], v[72:75], v[108:111]
 v_mfma_f32_16x16x32_bf16 v[140:143], a[252:255], v[76:79], v[140:143]
 v_mfma_f32_16x16x32_bf16 v[124:127], a[248:251], v[76:79], v[124:127]
 s_branch Lw_Ocold1
Lw_Ocold1:
 s_add_u32 s72, s63, 4
 s_and_b32 s71, s72, 3
 s_lshl_b32 s71, s71, 7
 s_add_u32 s71, s71, s74
 s_lshr_b32 s72, s72, 2
w_56:
 buffer_load_dword v4, v11, s[48:51], s71 offen sc1
 s_waitcnt vmcnt(0)
 v_cmp_gt_u32 vcc, s72, v4
 s_cbranch_vccz wok_57
 s_sleep 1
 s_sub_u32 s46, s46, 1
 s_cbranch_scc0 w_56
 s_mov_b32 s46, 0
 s_branch wok_57
wok_57:
 s_add_u32 s72, s63, 5
 s_and_b32 s71, s72, 3
 s_lshl_b32 s71, s71, 7
 s_add_u32 s71, s71, s74
 s_lshr_b32 s72, s72, 2
 buffer_load_dword v12, v11, s[48:51], s71 offen sc1
 s_add_u32 s82, s65, 0
 buffer_load_dwordx4 v[16:19], v2, s[48:51], s82 offen offset:0 sc1
 buffer_load_dwordx4 v[20:23], v5, s[48:51], s82 offen offset:0 sc1
 buffer_load_dwordx4 v[24:27], v2, s[48:51], s82 offen offset:2048 sc1
 buffer_load_dwordx4 v[28:31], v5, s[48:51], s82 offen offset:2048 sc1
 s_add_u32 s65, s65, 0x40000
 s_waitcnt vmcnt(4)
 v_cmp_gt_u32 vcc, s72, v12
 s_cbranch_vccnz dry_55
 s_waitcnt vmcnt(2)
 v_mfma_f32_16x16x32_bf16 v[144:147], a[0:3], v[16:19], 0
 s_sub_u32 s73, s65, 258048
 buffer_load_dwordx4 v[32:35], v2, s[48:51], s73 offen offset:0 sc1
 v_mfma_f32_16x16x32_bf16 v[160:163], a[4:7], v[16:19], 0
 ds_write_b128 v7, v[96:99] offset:0
 v_mfma_f32_16x16x32_bf16 v[192:195], a[4:7], v[20:23], 0
 buffer_load_dwordx4 v[36:39], v5, s[48:51], s73 offen offset:0 sc1
 v_mfma_f32_16x16x32_bf16 v[176:179], a[0:3], v[20:23], 0
 v_mfma_f32_16x16x32_bf16 v[148:151], a[8:11], v[16:19], 0
 buffer_load_dwordx4 v[40:43], v2, s[48:51], s73 offen offset:2048 sc1
 v_mfma_f32_16x16x32_bf16 v[164:167], a[12:15], v[16:19], 0
 ds_write_b128 v7, v[100:103] offset:1024
 v_mfma_f32_16x16x32_bf16 v[196:199], a[12:15], v[20:23], 0
 buffer_load_dwordx4 v[44:47], v5, s[48:51], s73 offen offset:2048 sc1
 v_mfma_f32_16x16x32_bf16 v[180:183], a[8:11], v[20:23], 0
 v_mfma_f32_16x16x32_bf16 v[152:155], a[16:19], v[16:19], 0
 s_sub_u32 s73, s65, 253952
 buffer_load_dwordx4 v[48:51], v2, s[48:51], s73 offen offset:0 sc1
 v_mfma_f32_16x16x32_bf16 v[168:171], a[20:23], v[16:19], 0
 ds_write_b128 v7, v[104:107] offset:2048
 v_mfma_f32_16x16x32_bf16 v[200:203], a[20:23], v[20:23], 0
 buffer_load_dwordx4 v[52:55], v5, s[48:51], s73 offen offset:0 sc1
 v_mfma_f32_16x16x32_bf16 v[184:187], a[16:19], v[20:23], 0
 v_mfma_f32_16x16x32_bf16 v[156:159], a[24:27], v[16:19], 0
 buffer_load_dwordx4 v[56:59], v2, s[48:51], s73 offen offset:2048 sc1
 v_mfma_f32_16x16x32_bf16 v[172:175], a[28:31], v[16:19], 0
 ds_write_b128 v7, v[108:111] offset:3072
 v_mfma_f32_16x16x32_bf16 v[204:207], a[28:31], v[20:23], 0
 buffer_load_dwordx4 v[60:63], v5, s[48:51], s73 offen offset:2048 sc1
 v_mfma_f32_16x16x32_bf16 v[188:191], a[24:27], v[20:23], 0
 s_waitcnt vmcnt(8)
 v_mfma_f32_16x16x32_bf16 v[144:147], a[32:35], v[24:27], v[144:147]
 s_add_u32 s82, s65, 0
 buffer_load_dwordx4 v[16:19], v2, s[48:51], s82 offen offset:0 sc1
 v_mfma_f32_16x16x32_bf16 v[160:163], a[36:39], v[24:27], v[160:163]
 ds_write_b128 v8, v[112:115] offset:0
 v_mfma_f32_16x16x32_bf16 v[192:195], a[36:39], v[28:31], v[192:195]
 buffer_load_dwordx4 v[20:23], v5, s[48:51], s82 offen offset:0 sc1
 v_mfma_f32_16x16x32_bf16 v[176:179], a[32:35], v[28:31], v[176:179]
 v_mfma_f32_16x16x32_bf16 v[148:151], a[40:43], v[24:27], v[148:151]
 s_sub_u32 s73, s65, 249856
 buffer_load_dwordx4 v[64:67], v2, s[48:51], s73 offen offset:0 sc1
 v_mfma_f32_16x16x32_bf16 v[164:167], a[44:47], v[24:27], v[164:167]
 ds_write_b128 v8, v[116:119] offset:1024
 v_mfma_f32_16x16x32_bf16 v[196:199], a[44:47], v[28:31], v[196:199]
 buffer_load_dwordx4 v[68:71], v5, s[48:51], s73 offen offset:0 sc1
 v_mfma_f32_16x16x32_bf16 v[180:183], a[40:43], v[28:31], v[180:183]
 v_mfma_f32_16x16x32_bf16 v[152:155], a[48:51], v[24:27], v[152:155]
 buffer_load_dwordx4 v[72:75], v2, s[48:51], s73 offen offset:2048 sc1
 v_mfma_f32_16x16x32_bf16 v[168:171], a[52:55], v[24:27], v[168:171]
 ds_write_b128 v8, v[120:123] offset:2048
 v_mfma_f32_16x16x32_bf16 v[200:203], a[52:55], v[28:31], v[200:203]
 buffer_load_dwordx4 v[76:79], v5, s[48:51], s73 offen offset:2048 sc1
 v_mfma_f32_16x16x32_bf16 v[184:187], a[48:51], v[28:31], v[184:187]
 s_sub_u32 s77, s63, 3
 s_and_b32 s78, s77, 3
 v_mfma_f32_16x16x32_bf16 v[156:159], a[56:59], v[24:27], v[156:159]
 ds_write_b128 v8, v[124:127] offset:3072
 v_mfma_f32_16x16x32_bf16 v[172:175], a[60:63], v[24:27], v[172:175]
 s_lshl_b32 s78, s78, 22
 s_add_u32 s78, s78, s76
 v_mfma_f32_16x16x32_bf16 v[204:207], a[60:63], v[28:31], v[204:207]
 s_bfe_u32 s79, s77, 0x10002
 v_mfma_f32_16x16x32_bf16 v[188:191], a[56:59], v[28:31], v[188:191]
 ds_write_b128 v9, v[128:131] offset:0
 s_waitcnt vmcnt(12)
 v_mfma_f32_16x16x32_bf16 v[144:147], a[64:67], v[32:35], v[144:147]
 buffer_load_dwordx4 v[24:27], v2, s[48:51], s82 offen offset:2048 sc1
 v_mfma_f32_16x16x32_bf16 v[160:163], a[68:71], v[32:35], v[160:163]
 buffer_load_dwordx4 v[216:219], v247, s[48:51], s78 offen sc1
 v_mfma_f32_16x16x32_bf16 v[192:195], a[68:71], v[36:39], v[192:195]
 buffer_load_dwordx4 v[28:31], v5, s[48:51], s82 offen offset:2048 sc1
 v_mfma_f32_16x16x32_bf16 v[176:179], a[64:67], v[36:39], v[176:179]
 ds_write_b128 v9, v[132:135] offset:1024
 v_mfma_f32_16x16x32_bf16 v[148:151], a[72:75], v[32:35], v[148:151]
 buffer_load_dwordx4 v[220:223], v248, s[48:51], s78 offen sc1
 v_mfma_f32_16x16x32_bf16 v[164:167], a[76:79], v[32:35], v[164:167]
 buffer_load_dwordx4 v[224:227], v249, s[48:51], s78 offen sc1
 v_mfma_f32_16x16x32_bf16 v[196:199], a[76:79], v[36:39], v[196:199]
 ds_write_b128 v9, v[136:139] offset:2048
 v_mfma_f32_16x16x32_bf16 v[180:183], a[72:75], v[36:39], v[180:183]
 v_mfma_f32_16x16x32_bf16 v[152:155], a[80:83], v[32:35], v[152:155]
 v_mfma_f32_16x16x32_bf16 v[168:171], a[84:87], v[32:35], v[168:171]
 ds_write_b128 v9, v[140:143] offset:3072
 v_mfma_f32_16x16x32_bf16 v[200:203], a[84:87], v[36:39], v[200:203]
 v_mfma_f32_16x16x32_bf16 v[184:187], a[80:83], v[36:39], v[184:187]
 v_mfma_f32_16x16x32_bf16 v[156:159], a[88:91], v[32:35], v[156:159]
 s_waitcnt lgkmcnt(0)
 s_barrier
 v_mfma_f32_16x16x32_bf16 v[172:175], a[92:95], v[32:35], v[172:175]
 ds_read_b128 v[96:99], v10 offset:0
 v_mfma_f32_16x16x32_bf16 v[204:207], a[92:95], v[36:39], v[204:207]
 ds_read_b128 v[100:103], v10 offset:1024
 v_mfma_f32_16x16x32_bf16 v[188:191], a[88:91], v[36:39], v[188:191]
 ds_read_b128 v[104:107], v10 offset:2048
 s_waitcnt vmcnt(15)
 v_mfma_f32_16x16x32_bf16 v[144:147], a[96:99], v[40:43], v[144:147]
 s_add_u32 s82, s65, 4096
 buffer_load_dwordx4 v[32:35], v2, s[48:51], s82 offen offset:0 sc1
 v_mfma_f32_16x16x32_bf16 v[160:163], a[100:103], v[40:43], v[160:163]
 ds_read_b128 v[108:111], v10 offset:3072
 v_mfma_f32_16x16x32_bf16 v[192:195], a[100:103], v[44:47], v[192:195]
 buffer_load_dwordx4 v[36:39], v5, s[48:51], s82 offen offset:0 sc1
 v_mfma_f32_16x16x32_bf16 v[176:179], a[96:99], v[44:47], v[176:179]
 ds_read_b128 v[112:115], v10 offset:4096
 v_mfma_f32_16x16x32_bf16 v[148:151], a[104:107], v[40:43], v[148:151]
 ds_read_b128 v[116:119], v10 offset:5120
 v_mfma_f32_16x16x32_bf16 v[164:167], a[108:111], v[40:43], v[164:167]
 ds_read_b128 v[120:123], v10 offset:6144
 v_mfma_f32_16x16x32_bf16 v[196:199], a[108:111], v[44:47], v[196:199]
 ds_read_b128 v[124:127], v10 offset:7168
 v_mfma_f32_16x16x32_bf16 v[180:183], a[104:107], v[44:47], v[180:183]
 ds_read_b128 v[128:131], v10 offset:8192
 v_mfma_f32_16x16x32_bf16 v[152:155], a[112:115], v[40:43], v[152:155]
 ds_read_b128 v[132:135], v10 offset:9216
 v_mfma_f32_16x16x32_bf16 v[168:171], a[116:119], v[40:43], v[168:171]
 ds_read_b128 v[136:139], v10 offset:10240
 v_mfma_f32_16x16x32_bf16 v[200:203], a[116:119], v[44:47], v[200:203]
 ds_read_b128 v[140:143], v10 offset:11264
 v_mfma_f32_16x16x32_bf16 v[184:187], a[112:115], v[44:47], v[184:187]
 s_waitcnt lgkmcnt(8)
 v_add_f32 v80, v80, v96
 v_mfma_f32_16x16x32_bf16 v[156:159], a[120:123], v[40:43], v[156:159]
 v_add_f32 v81, v81, v97
 v_add_f32 v82, v82, v98
 v_mfma_f32_16x16x32_bf16 v[172:175], a[124:127], v[40:43], v[172:175]
 v_add_f32 v83, v83, v99
 v_add_f32 v84, v84, v100
 v_mfma_f32_16x16x32_bf16 v[204:207], a[124:127], v[44:47], v[204:207]
 v_add_f32 v85, v85, v101
 v_add_f32 v86, v86, v102
 v_mfma_f32_16x16x32_bf16 v[188:191], a[120:123], v[44:47], v[188:191]
 v_add_f32 v87, v87, v103
 s_waitcnt vmcnt(15)
 v_mfma_f32_16x16x32_bf16 v[144:147], a[128:131], v[48:51], v[144:147]
 buffer_load_dwordx4 v[40:43], v2, s[48:51], s82 offen offset:2048 sc1
 v_mfma_f32_16x16x32_bf16 v[160:163], a[132:135], v[48:51], v[160:163]
 v_add_f32 v88, v88, v104
 v_add_f32 v89, v89, v105
 v_mfma_f32_16x16x32_bf16 v[192:195], a[132:135], v[52:55], v[192:195]
 buffer_load_dwordx4 v[44:47], v5, s[48:51], s82 offen offset:2048 sc1
 v_mfma_f32_16x16x32_bf16 v[176:179], a[128:131], v[52:55], v[176:179]
 v_add_f32 v90, v90, v106
 v_add_f32 v91, v91, v107
 v_mfma_f32_16x16x32_bf16 v[148:151], a[136:139], v[48:51], v[148:151]
 v_add_f32 v92, v92, v108
 v_add_f32 v93, v93, v109
 v_mfma_f32_16x16x32_bf16 v[164:167], a[140:143], v[48:51], v[164:167]
 v_add_f32 v94, v94, v110
 v_add_f32 v95, v95, v111
 v_mfma_f32_16x16x32_bf16 v[196:199], a[140:143], v[52:55], v[196:199]
 s_waitcnt lgkmcnt(4)
 v_add_f32 v80, v80, v112
 v_mfma_f32_16x16x32_bf16 v[180:183], a[136:139], v[52:55], v[180:183]
 v_add_f32 v81, v81, v113
 v_add_f32 v82, v82, v114
 v_mfma_f32_16x16x32_bf16 v[152:155], a[144:147], v[48:51], v[152:155]
 v_add_f32 v83, v83, v115
 v_add_f32 v84, v84, v116
 v_mfma_f32_16x16x32_bf16 v[168:171], a[148:151], v[48:51], v[168:171]
 v_add_f32 v85, v85, v117
 v_add_f32 v86, v86, v118
 v_mfma_f32_16x16x32_bf16 v[200:203], a[148:151], v[52:55], v[200:203]
 v_add_f32 v87, v87, v119
 v_add_f32 v88, v88, v120
 v_mfma_f32_16x16x32_bf16 v[184:187], a[144:147], v[52:55], v[184:187]
 v_add_f32 v89, v89, v121
 v_add_f32 v90, v90, v122
 v_mfma_f32_16x16x32_bf16 v[156:159], a[152:155], v[48:51], v[156:159]
 v_add_f32 v91, v91, v123
 v_add_f32 v92, v92, v124
 v_mfma_f32_16x16x32_bf16 v[172:175], a[156:159], v[48:51], v[172:175]
 v_add_f32 v93, v93, v125
 v_add_f32 v94, v94, v126
 v_mfma_f32_16x16x32_bf16 v[204:207], a[156:159], v[52:55], v[204:207]
 v_add_f32 v95, v95, v127
 s_waitcnt lgkmcnt(0)
 v_mfma_f32_16x16x32_bf16 v[188:191], a[152:155], v[52:55], v[188:191]
 v_add_f32 v80, v80, v128
 s_waitcnt vmcnt(15)
 v_mfma_f32_16x16x32_bf16 v[144:147], a[160:163], v[56:59], v[144:147]
 s_add_u32 s82, s65, 8192
 buffer_load_dwordx4 v[48:51], v2, s[48:51], s82 offen offset:0 sc1
 v_mfma_f32_16x16x32_bf16 v[160:163], a[164:167], v[56:59], v[160:163]
 v_add_f32 v81, v81, v129
 v_add_f32 v82, v82, v130
 v_mfma_f32_16x16x32_bf16 v[192:195], a[164:167], v[60:63], v[192:195]
 buffer_load_dwordx4 v[52:55], v5, s[48:51], s82 offen offset:0 sc1
 v_mfma_f32_16x16x32_bf16 v[176:179], a[160:163], v[60:63], v[176:179]
 v_add_f32 v83, v83, v131
 v_add_f32 v84, v84, v132
 v_mfma_f32_16x16x32_bf16 v[148:151], a[168:171], v[56:59], v[148:151]
 v_add_f32 v85, v85, v133
 v_add_f32 v86, v86, v134
 v_mfma_f32_16x16x32_bf16 v[164:167], a[172:175], v[56:59], v[164:167]
 v_add_f32 v87, v87, v135
 v_add_f32 v88, v88, v136
 v_mfma_f32_16x16x32_bf16 v[196:199], a[172:175], v[60:63], v[196:199]
 v_add_f32 v89, v89, v137
 v_add_f32 v90, v90, v138
 v_mfma_f32_16x16x32_bf16 v[180:183], a[168:171], v[60:63], v[180:183]
 v_add_f32 v91, v91, v139
 v_add_f32 v92, v92, v140
 v_mfma_f32_16x16x32_bf16 v[152:155], a[176:179], v[56:59], v[152:155]
 s_add_u32 s72, s63, 6
 s_and_b32 s71, s72, 3
 v_mfma_f32_16x16x32_bf16 v[168:171], a[180:183], v[56:59], v[168:171]
 s_lshl_b32 s71, s71, 7
 s_add_u32 s71, s71, s74
 v_mfma_f32_16x16x32_bf16 v[200:203], a[180:183], v[60:63], v[200:203]
 s_lshr_b32 s72, s72, 2
 v_mfma_f32_16x16x32_bf16 v[184:187], a[176:179], v[60:63], v[184:187]
 buffer_load_dword v12, v11, s[48:51], s71 offen sc1
 v_mfma_f32_16x16x32_bf16 v[156:159], a[184:187], v[56:59], v[156:159]
 v_add_f32 v93, v93, v141
 v_add_f32 v94, v94, v142
 v_mfma_f32_16x16x32_bf16 v[172:175], a[188:191], v[56:59], v[172:175]
 v_add_f32 v95, v95, v143
 s_waitcnt vmcnt(7)
 v_mfma_f32_16x16x32_bf16 v[204:207], a[188:191], v[60:63], v[204:207]
 v_bitop3_b32 v13, v216, v220, s79 bitop3:0x7e
 v_bitop3_b32 v13, v13, v224, s79 bitop3:0xf6
 v_mfma_f32_16x16x32_bf16 v[188:191], a[184:187], v[60:63], v[188:191]
 v_and_b32 v13, 1, v13
 v_mfma_f32_16x16x32_bf16 v[144:147], a[192:195], v[64:67], v[144:147]
 buffer_load_dwordx4 v[56:59], v2, s[48:51], s82 offen offset:2048 sc1
 v_mfma_f32_16x16x32_bf16 v[160:163], a[196:199], v[64:67], v[160:163]
 v_cmp_eq_u32 vcc, 1, v13
 s_nop 0
 v_mfma_f32_16x16x32_bf16 v[192:195], a[196:199], v[68:71], v[192:195]
 buffer_load_dwordx4 v[60:63], v5, s[48:51], s82 offen offset:2048 sc1
 v_mfma_f32_16x16x32_bf16 v[176:179], a[192:195], v[68:71], v[176:179]
 s_cbranch_vccnz stale_58
fresh_59:
 v_mfma_f32_16x16x32_bf16 v[148:151], a[200:203], v[64:67], v[148:151]
 v_add_f32 v212, v212, v216
 v_add_f32 v213, v213, v217
 v_mfma_f32_16x16x32_bf16 v[164:167], a[204:207], v[64:67], v[164:167]
 v_add_f32 v214, v214, v218
 v_add_f32 v215, v215, v219
 v_mfma_f32_16x16x32_bf16 v[196:199], a[204:207], v[68:71], v[196:199]
 v_add_f32 v212, v212, v220
 v_add_f32 v213, v213, v221
 v_mfma_f32_16x16x32_bf16 v[180:183], a[200:203], v[68:71], v[180:183]
 v_add_f32 v214, v214, v222
 v_add_f32 v215, v215, v223
 v_mfma_f32_16x16x32_bf16 v[152:155], a[208:211], v[64:67], v[152:155]
 v_add_f32 v212, v212, v224
 v_add_f32 v213, v213, v225
 v_mfma_f32_16x16x32_bf16 v[168:171], a[212:215], v[64:67], v[168:171]
 v_add_f32 v214, v214, v226
 v_add_f32 v215, v215, v227
 v_mfma_f32_16x16x32_bf16 v[200:203], a[212:215], v[68:71], v[200:203]
 s_min_u32 s77, s77, 64
 s_lshl_b32 s69, s77, 17
 v_mfma_f32_16x16x32_bf16 v[184:187], a[208:211], v[68:71], v[184:187]
 s_add_u32 s69, s69, s67
 v_cvt_pk_bf16_f32 v14, v212, v213
 v_mfma_f32_16x16x32_bf16 v[156:159], a[216:219], v[64:67], v[156:159]
 v_cvt_pk_bf16_f32 v15, v214, v215
 v_mfma_f32_16x16x32_bf16 v[172:175], a[220:223], v[64:67], v[172:175]
 buffer_store_dwordx2 v[14:15], v250, s[56:59], s69 offen
 v_mfma_f32_16x16x32_bf16 v[204:207], a[220:223], v[68:71], v[204:207]
 v_mov_b32 v212, v80
 v_mov_b32 v213, v81
 v_mfma_f32_16x16x32_bf16 v[188:191], a[216:219], v[68:71], v[188:191]
 v_mov_b32 v214, v82
 v_mfma_f32_16x16x32_bf16 v[144:147], a[224:227], v[72:75], v[144:147]
 s_add_u32 s82, s65, 12288
 buffer_load_dwordx4 v[64:67], v2, s[48:51], s82 offen offset:0 sc1
 v_mfma_f32_16x16x32_bf16 v[160:163], a[228:231], v[72:75], v[160:163]
 v_mov_b32 v215, v83
 s_sub_u32 s77, s63, 1
 v_mfma_f32_16x16x32_bf16 v[192:195], a[228:231], v[76:79], v[192:195]
 buffer_load_dwordx4 v[68:71], v5, s[48:51], s82 offen offset:0 sc1
 v_mfma_f32_16x16x32_bf16 v[176:179], a[224:227], v[76:79], v[176:179]
 s_add_u32 s65, s65, 0x40000
 s_waitcnt vmcnt(5)
 v_mfma_f32_16x16x32_bf16 v[148:151], a[232:235], v[72:75], v[148:151]
 v_cmp_gt_u32 vcc, s72, v12
 s_and_b32 s78, s77, 3
 v_mfma_f32_16x16x32_bf16 v[164:167], a[236:239], v[72:75], v[164:167]
 s_lshl_b32 s78, s78, 22
 s_add_u32 s78, s78, s76
 v_mfma_f32_16x16x32_bf16 v[196:199], a[236:239], v[76:79], v[196:199]
 s_bfe_u32 s79, s77, 0x10002
 v_bfi_b32 v84, 1, s79, v84
 v_mfma_f32_16x16x32_bf16 v[180:183], a[232:235], v[76:79], v[180:183]
 v_bfi_b32 v88, 1, s79, v88
 v_bfi_b32 v92, 1, s79, v92
 v_mfma_f32_16x16x32_bf16 v[152:155], a[240:243], v[72:75], v[152:155]
 buffer_store_dwordx4 v[84:87], v244, s[48:51], s78 offen sc1
 v_mfma_f32_16x16x32_bf16 v[168:171], a[244:247], v[72:75], v[168:171]
 buffer_store_dwordx4 v[88:91], v245, s[48:51], s78 offen sc1
 v_mfma_f32_16x16x32_bf16 v[200:203], a[244:247], v[76:79], v[200:203]
 buffer_store_dwordx4 v[92:95], v246, s[48:51], s78 offen sc1
 v_mfma_f32_16x16x32_bf16 v[184:187], a[240:243], v[76:79], v[184:187]
 s_add_u32 s63, s63, 1
 v_mfma_f32_16x16x32_bf16 v[156:159], a[248:251], v[72:75], v[156:159]
 v_mfma_f32_16x16x32_bf16 v[172:175], a[252:255], v[72:75], v[172:175]
 v_mfma_f32_16x16x32_bf16 v[204:207], a[252:255], v[76:79], v[204:207]
 v_mfma_f32_16x16x32_bf16 v[188:191], a[248:251], v[76:79], v[188:191]
 s_branch Lw_Owarm0
dry_55:
 s_waitcnt vmcnt(2)
 v_mfma_f32_16x16x32_bf16 v[144:147], a[0:3], v[16:19], 0
 s_sub_u32 s73, s65, 258048
 buffer_load_dwordx4 v[32:35], v2, s[48:51], s73 offen offset:0 sc1
 v_mfma_f32_16x16x32_bf16 v[160:163], a[4:7], v[16:19], 0
 ds_write_b128 v7, v[96:99] offset:0
 v_mfma_f32_16x16x32_bf16 v[192:195], a[4:7], v[20:23], 0
 buffer_load_dwordx4 v[36:39], v5, s[48:51], s73 offen offset:0 sc1
 v_mfma_f32_16x16x32_bf16 v[176:179], a[0:3], v[20:23], 0
 v_mfma_f32_16x16x32_bf16 v[148:151], a[8:11], v[16:19], 0
 buffer_load_dwordx4 v[40:43], v2, s[48:51], s73 offen offset:2048 sc1
 v_mfma_f32_16x16x32_bf16 v[164:167], a[12:15], v[16:19], 0
 ds_write_b128 v7, v[100:103] offset:1024
 v_mfma_f32_16x16x32_bf16 v[196:199], a[12:15], v[20:23], 0
 buffer_load_dwordx4 v[44:47], v5, s[48:51], s73 offen offset:2048 sc1
 v_mfma_f32_16x16x32_bf16 v[180:183], a[8:11], v[20:23], 0
 v_mfma_f32_16x16x32_bf16 v[152:155], a[16:19], v[16:19], 0
 s_sub_u32 s73, s65, 253952
 buffer_load_dwordx4 v[48:51], v2, s[48:51], s73 offen offset:0 sc1
 v_mfma_f32_16x16x32_bf16 v[168:171], a[20:23], v[16:19], 0
 ds_write_b128 v7, v[104:107] offset:2048
 v_mfma_f32_16x16x32_bf16 v[200:203], a[20:23], v[20:23], 0
 buffer_load_dwordx4 v[52:55], v5, s[48:51], s73 offen offset:0 sc1
 v_mfma_f32_16x16x32_bf16 v[184:187], a[16:19], v[20:23], 0
 v_mfma_f32_16x16x32_bf16 v[156:159], a[24:27], v[16:19], 0
 buffer_load_dwordx4 v[56:59], v2, s[48:51], s73 offen offset:2048 sc1
 v_mfma_f32_16x16x32_bf16 v[172:175], a[28:31], v[16:19], 0
 ds_write_b128 v7, v[108:111] offset:3072
 v_mfma_f32_16x16x32_bf16 v[204:207], a[28:31], v[20:23], 0
 buffer_load_dwordx4 v[60:63], v5, s[48:51], s73 offen offset:2048 sc1
 v_mfma_f32_16x16x32_bf16 v[188:191], a[24:27], v[20:23], 0
 s_waitcnt vmcnt(8)
 v_mfma_f32_16x16x32_bf16 v[144:147], a[32:35], v[24:27], v[144:147]
 ds_write_b128 v8, v[112:115] offset:0
 v_mfma_f32_16x16x32_bf16 v[160:163], a[36:39], v[24:27], v[160:163]
 v_mfma_f32_16x16x32_bf16 v[192:195], a[36:39], v[28:31], v[192:195]
 v_mfma_f32_16x16x32_bf16 v[176:179], a[32:35], v[28:31], v[176:179]
 ds_write_b128 v8, v[116:119] offset:1024
 v_mfma_f32_16x16x32_bf16 v[148:151], a[40:43], v[24:27], v[148:151]
 s_sub_u32 s73, s65, 249856
 buffer_load_dwordx4 v[64:67], v2, s[48:51], s73 offen offset:0 sc1
 v_mfma_f32_16x16x32_bf16 v[164:167], a[44:47], v[24:27], v[164:167]
 v_mfma_f32_16x16x32_bf16 v[196:199], a[44:47], v[28:31], v[196:199]
 buffer_load_dwordx4 v[68:71], v5, s[48:51], s73 offen offset:0 sc1
 v_mfma_f32_16x16x32_bf16 v[180:183], a[40:43], v[28:31], v[180:183]
 ds_write_b128 v8, v[120:123] offset:2048
 v_mfma_f32_16x16x32_bf16 v[152:155], a[48:51], v[24:27], v[152:155]
 buffer_load_dwordx4 v[72:75], v2, s[48:51], s73 offen offset:2048 sc1
 v_mfma_f32_16x16x32_bf16 v[168:171], a[52:55], v[24:27], v[168:171]
 v_mfma_f32_16x16x32_bf16 v[200:203], a[52:55], v[28:31], v[200:203]
 buffer_load_dwordx4 v[76:79], v5, s[48:51], s73 offen offset:2048 sc1
 v_mfma_f32_16x16x32_bf16 v[184:187], a[48:51], v[28:31], v[184:187]
 ds_write_b128 v8, v[124:127] offset:3072
 v_mfma_f32_16x16x32_bf16 v[156:159], a[56:59], v[24:27], v[156:159]
 s_sub_u32 s77, s63, 3
 s_and_b32 s78, s77, 3
 v_mfma_f32_16x16x32_bf16 v[172:175], a[60:63], v[24:27], v[172:175]
 s_lshl_b32 s78, s78, 22
 s_add_u32 s78, s78, s76
 v_mfma_f32_16x16x32_bf16 v[204:207], a[60:63], v[28:31], v[204:207]
 ds_write_b128 v9, v[128:131] offset:0
 v_mfma_f32_16x16x32_bf16 v[188:191], a[56:59], v[28:31], v[188:191]
 s_bfe_u32 s79, s77, 0x10002
 s_waitcnt vmcnt(10)
 v_mfma_f32_16x16x32_bf16 v[144:147], a[64:67], v[32:35], v[144:147]
 buffer_load_dwordx4 v[216:219], v247, s[48:51], s78 offen sc1
 v_mfma_f32_16x16x32_bf16 v[160:163], a[68:71], v[32:35], v[160:163]
 ds_write_b128 v9, v[132:135] offset:1024
 v_mfma_f32_16x16x32_bf16 v[192:195], a[68:71], v[36:39], v[192:195]
 buffer_load_dwordx4 v[220:223], v248, s[48:51], s78 offen sc1
 v_mfma_f32_16x16x32_bf16 v[176:179], a[64:67], v[36:39], v[176:179]
 buffer_load_dwordx4 v[224:227], v249, s[48:51], s78 offen sc1
 v_mfma_f32_16x16x32_bf16 v[148:151], a[72:75], v[32:35], v[148:151]
 ds_write_b128 v9, v[136:139] offset:2048
 v_mfma_f32_16x16x32_bf16 v[164:167], a[76:79], v[32:35], v[164:167]
 v_mfma_f32_16x16x32_bf16 v[196:199], a[76:79], v[36:39], v[196:199]
 v_mfma_f32_16x16x32_bf16 v[180:183], a[72:75], v[36:39], v[180:183]
 ds_write_b128 v9, v[140:143] offset:3072
 v_mfma_f32_16x16x32_bf16 v[152:155], a[80:83], v[32:35], v[152:155]
 v_mfma_f32_16x16x32_bf16 v[168:171], a[84:87], v[32:35], v[168:171]
 v_mfma_f32_16x16x32_bf16 v[200:203], a[84:87], v[36:39], v[200:203]
 s_waitcnt lgkmcnt(0)
 s_barrier
 v_mfma_f32_16x16x32_bf16 v[184:187], a[80:83], v[36:39], v[184:187]
 ds_read_b128 v[96:99], v10 offset:0
 v_mfma_f32_16x16x32_bf16 v[156:159], a[88:91], v[32:35], v[156:159]
 ds_read_b128 v[100:103], v10 offset:1024
 v_mfma_f32_16x16x32_bf16 v[172:175], a[92:95], v[32:35], v[172:175]
 ds_read_b128 v[104:107], v10 offset:2048
 v_mfma_f32_16x16x32_bf16 v[204:207], a[92:95], v[36:39], v[204:207]
 ds_read_b128 v[108:111], v10 offset:3072
 v_mfma_f32_16x16x32_bf16 v[188:191], a[88:91], v[36:39], v[188:191]
 ds_read_b128 v[112:115], v10 offset:4096
 s_waitcnt vmcnt(11)
 v_mfma_f32_16x16x32_bf16 v[144:147], a[96:99], v[40:43], v[144:147]
 ds_read_b128 v[116:119], v10 offset:5120
 v_mfma_f32_16x16x32_bf16 v[160:163], a[100:103], v[40:43], v[160:163]
 ds_read_b128 v[120:123], v10 offset:6144
 v_mfma_f32_16x16x32_bf16 v[192:195], a[100:103], v[44:47], v[192:195]
 ds_read_b128 v[124:127], v10 offset:7168
 v_mfma_f32_16x16x32_bf16 v[176:179], a[96:99], v[44:47], v[176:179]
 ds_read_b128 v[128:131], v10 offset:8192
 v_mfma_f32_16x16x32_bf16 v[148:151], a[104:107], v[40:43], v[148:151]
 ds_read_b128 v[132:135], v10 offset:9216
 v_mfma_f32_16x16x32_bf16 v[164:167], a[108:111], v[40:43], v[164:167]
 ds_read_b128 v[136:139], v10 offset:10240
 v_mfma_f32_16x16x32_bf16 v[196:199], a[108:111], v[44:47], v[196:199]
 ds_read_b128 v[140:143], v10 offset:11264
 v_mfma_f32_16x16x32_bf16 v[180:183], a[104:107], v[44:47], v[180:183]
 s_waitcnt lgkmcnt(8)
 v_add_f32 v80, v80, v96
 v_mfma_f32_16x16x32_bf16 v[152:155], a[112:115], v[40:43], v[152:155]
 v_add_f32 v81, v81, v97
 v_add_f32 v82, v82, v98
 v_mfma_f32_16x16x32_bf16 v[168:171], a[116:119], v[40:43], v[168:171]
 v_add_f32 v83, v83, v99
 v_add_f32 v84, v84, v100
 v_mfma_f32_16x16x32_bf16 v[200:203], a[116:119], v[44:47], v[200:203]
 v_add_f32 v85, v85, v101
 v_add_f32 v86, v86, v102
 v_mfma_f32_16x16x32_bf16 v[184:187], a[112:115], v[44:47], v[184:187]
 v_add_f32 v87, v87, v103
 v_add_f32 v88, v88, v104
 v_mfma_f32_16x16x32_bf16 v[156:159], a[120:123], v[40:43], v[156:159]
 v_add_f32 v89, v89, v105
 v_add_f32 v90, v90, v106
 v_mfma_f32_16x16x32_bf16 v[172:175], a[124:127], v[40:43], v[172:175]
 v_add_f32 v91, v91, v107
 v_add_f32 v92, v92, v108
 v_mfma_f32_16x16x32_bf16 v[204:207], a[124:127], v[44:47], v[204:207]
 v_add_f32 v93, v93, v109
 v_add_f32 v94, v94, v110
 v_mfma_f32_16x16x32_bf16 v[188:191], a[120:123], v[44:47], v[188:191]
 v_add_f32 v95, v95, v111
 s_waitcnt vmcnt(9)
 v_mfma_f32_16x16x32_bf16 v[144:147], a[128:131], v[48:51], v[144:147]
 s_waitcnt lgkmcnt(4)
 v_add_f32 v80, v80, v112
 v_mfma_f32_16x16x32_bf16 v[160:163], a[132:135], v[48:51], v[160:163]
 v_add_f32 v81, v81, v113
 v_add_f32 v82, v82, v114
 v_mfma_f32_16x16x32_bf16 v[192:195], a[132:135], v[52:55], v[192:195]
 v_add_f32 v83, v83, v115
 v_add_f32 v84, v84, v116
 v_mfma_f32_16x16x32_bf16 v[176:179], a[128:131], v[52:55], v[176:179]
 v_add_f32 v85, v85, v117
 v_add_f32 v86, v86, v118
 v_mfma_f32_16x16x32_bf16 v[148:151], a[136:139], v[48:51], v[148:151]
 v_add_f32 v87, v87, v119
 v_add_f32 v88, v88, v120
 v_mfma_f32_16x16x32_bf16 v[164:167], a[140:143], v[48:51], v[164:167]
 v_add_f32 v89, v89, v121
 v_add_f32 v90, v90, v122
 v_mfma_f32_16x16x32_bf16 v[196:199], a[140:143], v[52:55], v[196:199]
 v_add_f32 v91, v91, v123
 v_add_f32 v92, v92, v124
 v_mfma_f32_16x16x32_bf16 v[180:183], a[136:139], v[52:55], v[180:183]
 v_add_f32 v93, v93, v125
 v_add_f32 v94, v94, v126
 v_mfma_f32_16x16x32_bf16 v[152:155], a[144:147], v[48:51], v[152:155]
 v_add_f32 v95, v95, v127
 s_waitcnt lgkmcnt(0)
 v_mfma_f32_16x16x32_bf16 v[168:171], a[148:151], v[48:51], v[168:171]
 v_add_f32 v80, v80, v128
 v_add_f32 v81, v81, v129
 v_mfma_f32_16x16x32_bf16 v[200:203], a[148:151], v[52:55], v[200:203]
 v_add_f32 v82, v82, v130
 v_add_f32 v83, v83, v131
 v_mfma_f32_16x16x32_bf16 v[184:187], a[144:147], v[52:55], v[184:187]
 v_add_f32 v84, v84, v132
 v_add_f32 v85, v85, v133
 v_mfma_f32_16x16x32_bf16 v[156:159], a[152:155], v[48:51], v[156:159]
 v_add_f32 v86, v86, v134
 v_add_f32 v87, v87, v135
 v_mfma_f32_16x16x32_bf16 v[172:175], a[156:159], v[48:51], v[172:175]
 v_add_f32 v88, v88, v136
 v_add_f32 v89, v89, v137
 v_mfma_f32_16x16x32_bf16 v[204:207], a[156:159], v[52:55], v[204:207]
 v_add_f32 v90, v90, v138
 v_add_f32 v91, v91, v139
 v_mfma_f32_16x16x32_bf16 v[188:191], a[152:155], v[52:55], v[188:191]
 v_add_f32 v92, v92, v140
 s_waitcnt vmcnt(7)
 v_mfma_f32_16x16x32_bf16 v[144:147], a[160:163], v[56:59], v[144:147]
 v_add_f32 v93, v93, v141
 v_add_f32 v94, v94, v142
 v_mfma_f32_16x16x32_bf16 v[160:163], a[164:167], v[56:59], v[160:163]
 v_add_f32 v95, v95, v143
 s_waitcnt vmcnt(0)
 v_mfma_f32_16x16x32_bf16 v[192:195], a[164:167], v[60:63], v[192:195]
 v_bitop3_b32 v13, v216, v220, s79 bitop3:0x7e
 v_bitop3_b32 v13, v13, v224, s79 bitop3:0xf6
 v_mfma_f32_16x16x32_bf16 v[176:179], a[160:163], v[60:63], v[176:179]
 v_and_b32 v13, 1, v13
 v_cmp_eq_u32 vcc, 1, v13
 v_mfma_f32_16x16x32_bf16 v[148:151], a[168:171], v[56:59], v[148:151]
 s_nop 0
 v_mfma_f32_16x16x32_bf16 v[164:167], a[172:175], v[56:59], v[164:167]
 s_cbranch_vccnz stale_60
fresh_61:
 v_mfma_f32_16x16x32_bf16 v[196:199], a[172:175], v[60:63], v[196:199]
 v_add_f32 v212, v212, v216
 v_add_f32 v213, v213, v217
 v_mfma_f32_16x16x32_bf16 v[180:183], a[168:171], v[60:63], v[180:183]
 v_add_f32 v214, v214, v218
 v_add_f32 v215, v215, v219
 v_mfma_f32_16x16x32_bf16 v[152:155], a[176:179], v[56:59], v[152:155]
 v_add_f32 v212, v212, v220
 v_add_f32 v213, v213, v221
 v_mfma_f32_16x16x32_bf16 v[168:171], a[180:183], v[56:59], v[168:171]
 v_add_f32 v214, v214, v222
 v_add_f32 v215, v215, v223
 v_mfma_f32_16x16x32_bf16 v[200:203], a[180:183], v[60:63], v[200:203]
 v_add_f32 v212, v212, v224
 v_add_f32 v213, v213, v225
 v_mfma_f32_16x16x32_bf16 v[184:187], a[176:179], v[60:63], v[184:187]
 v_add_f32 v214, v214, v226
 v_add_f32 v215, v215, v227
 v_mfma_f32_16x16x32_bf16 v[156:159], a[184:187], v[56:59], v[156:159]
 s_min_u32 s77, s77, 64
 s_lshl_b32 s69, s77, 17
 v_mfma_f32_16x16x32_bf16 v[172:175], a[188:191], v[56:59], v[172:175]
 s_add_u32 s69, s69, s67
 v_cvt_pk_bf16_f32 v14, v212, v213
 v_mfma_f32_16x16x32_bf16 v[204:207], a[188:191], v[60:63], v[204:207]
 v_cvt_pk_bf16_f32 v15, v214, v215
 v_mfma_f32_16x16x32_bf16 v[188:191], a[184:187], v[60:63], v[188:191]
 buffer_store_dwordx2 v[14:15], v250, s[56:59], s69 offen
 v_mfma_f32_16x16x32_bf16 v[144:147], a[192:195], v[64:67], v[144:147]
 v_mov_b32 v212, v80
 v_mov_b32 v213, v81
 v_mfma_f32_16x16x32_bf16 v[160:163], a[196:199], v[64:67], v[160:163]
 v_mov_b32 v214, v82
 v_mov_b32 v215, v83
 v_mfma_f32_16x16x32_bf16 v[192:195], a[196:199], v[68:71], v[192:195]
 s_sub_u32 s77, s63, 1
 s_and_b32 s78, s77, 3
 v_mfma_f32_16x16x32_bf16 v[176:179], a[192:195], v[68:71], v[176:179]
 s_lshl_b32 s78, s78, 22
 s_add_u32 s78, s78, s76
 v_mfma_f32_16x16x32_bf16 v[148:151], a[200:203], v[64:67], v[148:151]
 s_bfe_u32 s79, s77, 0x10002
 v_bfi_b32 v84, 1, s79, v84
 v_mfma_f32_16x16x32_bf16 v[164:167], a[204:207], v[64:67], v[164:167]
 v_bfi_b32 v88, 1, s79, v88
 v_bfi_b32 v92, 1, s79, v92
 v_mfma_f32_16x16x32_bf16 v[196:199], a[204:207], v[68:71], v[196:199]
 buffer_store_dwordx4 v[84:87], v244, s[48:51], s78 offen sc1
 v_mfma_f32_16x16x32_bf16 v[180:183], a[200:203], v[68:71], v[180:183]
 buffer_store_dwordx4 v[88:91], v245, s[48:51], s78 offen sc1
 v_mfma_f32_16x16x32_bf16 v[152:155], a[208:211], v[64:67], v[152:155]
 buffer_store_dwordx4 v[92:95], v246, s[48:51], s78 offen sc1
 v_mfma_f32_16x16x32_bf16 v[168:171], a[212:215], v[64:67], v[168:171]
 s_add_u32 s63, s63, 1
 v_mfma_f32_16x16x32_bf16 v[200:203], a[212:215], v[68:71], v[200:203]
 v_mfma_f32_16x16x32_bf16 v[184:187], a[208:211], v[68:71], v[184:187]
 v_mfma_f32_16x16x32_bf16 v[156:159], a[216:219], v[64:67], v[156:159]
 v_mfma_f32_16x16x32_bf16 v[172:175], a[220:223], v[64:67], v[172:175]
 v_mfma_f32_16x16x32_bf16 v[204:207], a[220:223], v[68:71], v[204:207]
 v_mfma_f32_16x16x32_bf16 v[188:191], a[216:219], v[68:71], v[188:191]
 v_mfma_f32_16x16x32_bf16 v[144:147], a[224:227], v[72:75], v[144:147]
 v_mfma_f32_16x16x32_bf16 v[160:163], a[228:231], v[72:75], v[160:163]
 v_mfma_f32_16x16x32_bf16 v[192:195], a[228:231], v[76:79], v[192:195]
 v_mfma_f32_16x16x32_bf16 v[176:179], a[224:227], v[76:79], v[176:179]
 v_mfma_f32_16x16x32_bf16 v[148:151], a[232:235], v[72:75], v[148:151]
 v_mfma_f32_16x16x32_bf16 v[164:167], a[236:239], v[72:75], v[164:167]
 v_mfma_f32_16x16x32_bf16 v[196:199], a[236:239], v[76:79], v[196:199]
 v_mfma_f32_16x16x32_bf16 v[180:183], a[232:235], v[76:79], v[180:183]
 v_mfma_f32_16x16x32_bf16 v[152:155], a[240:243], v[72:75], v[152:155]
 v_mfma_f32_16x16x32_bf16 v[168:171], a[244:247], v[72:75], v[168:171]
 v_mfma_f32_16x16x32_bf16 v[200:203], a[244:247], v[76:79], v[200:203]
 v_mfma_f32_16x16x32_bf16 v[184:187], a[240:243], v[76:79], v[184:187]
 v_mfma_f32_16x16x32_bf16 v[156:159], a[248:251], v[72:75], v[156:159]
 v_mfma_f32_16x16x32_bf16 v[172:175], a[252:255], v[72:75], v[172:175]
 v_mfma_f32_16x16x32_bf16 v[204:207], a[252:255], v[76:79], v[204:207]
 v_mfma_f32_16x16x32_bf16 v[188:191], a[248:251], v[76:79], v[188:191]
 s_branch Lw_Ocold0
Lw_Owarm1:
 s_cbranch_vccnz dry_62
 v_mfma_f32_16x16x32_bf16 v[144:147], a[0:3], v[16:19], 0
 buffer_load_dwordx4 v[72:75], v2, s[48:51], s82 offen offset:2048 sc1
 v_mfma_f32_16x16x32_bf16 v[160:163], a[4:7], v[16:19], 0
 ds_write_b128 v7, v[96:99] offset:0
 v_mfma_f32_16x16x32_bf16 v[192:195], a[4:7], v[20:23], 0
 buffer_load_dwordx4 v[76:79], v5, s[48:51], s82 offen offset:2048 sc1
 v_mfma_f32_16x16x32_bf16 v[176:179], a[0:3], v[20:23], 0
 s_sub_u32 s77, s63, 3
 s_and_b32 s78, s77, 3
 v_mfma_f32_16x16x32_bf16 v[148:151], a[8:11], v[16:19], 0
 ds_write_b128 v7, v[100:103] offset:1024
 v_mfma_f32_16x16x32_bf16 v[164:167], a[12:15], v[16:19], 0
 s_lshl_b32 s78, s78, 22
 s_add_u32 s78, s78, s76
 v_mfma_f32_16x16x32_bf16 v[196:199], a[12:15], v[20:23], 0
 s_bfe_u32 s79, s77, 0x10002
 v_mfma_f32_16x16x32_bf16 v[180:183], a[8:11], v[20:23], 0
 ds_write_b128 v7, v[104:107] offset:2048
 v_mfma_f32_16x16x32_bf16 v[152:155], a[16:19], v[16:19], 0
 buffer_load_dwordx4 v[216:219], v247, s[48:51], s78 offen sc1
 v_mfma_f32_16x16x32_bf16 v[168:171], a[20:23], v[16:19], 0
 buffer_load_dwordx4 v[220:223], v248, s[48:51], s78 offen sc1
 v_mfma_f32_16x16x32_bf16 v[200:203], a[20:23], v[20:23], 0
 ds_write_b128 v7, v[108:111] offset:3072
 v_mfma_f32_16x16x32_bf16 v[184:187], a[16:19], v[20:23], 0
 buffer_load_dwordx4 v[224:227], v249, s[48:51], s78 offen sc1
 v_mfma_f32_16x16x32_bf16 v[156:159], a[24:27], v[16:19], 0
 v_mfma_f32_16x16x32_bf16 v[172:175], a[28:31], v[16:19], 0
 ds_write_b128 v8, v[112:115] offset:0
 v_mfma_f32_16x16x32_bf16 v[204:207], a[28:31], v[20:23], 0
 v_mfma_f32_16x16x32_bf16 v[188:191], a[24:27], v[20:23], 0
 v_mfma_f32_16x16x32_bf16 v[144:147], a[32:35], v[24:27], v[144:147]
 s_add_u32 s82, s65, 0
 buffer_load_dwordx4 v[16:19], v2, s[48:51], s82 offen offset:0 sc1
 v_mfma_f32_16x16x32_bf16 v[160:163], a[36:39], v[24:27], v[160:163]
 ds_write_b128 v8, v[116:119] offset:1024
 v_mfma_f32_16x16x32_bf16 v[192:195], a[36:39], v[28:31], v[192:195]
 buffer_load_dwordx4 v[20:23], v5, s[48:51], s82 offen offset:0 sc1
 v_mfma_f32_16x16x32_bf16 v[176:179], a[32:35], v[28:31], v[176:179]
 v_mfma_f32_16x16x32_bf16 v[148:151], a[40:43], v[24:27], v[148:151]
 ds_write_b128 v8, v[120:123] offset:2048
 v_mfma_f32_16x16x32_bf16 v[164:167], a[44:47], v[24:27], v[164:167]
 v_mfma_f32_16x16x32_bf16 v[196:199], a[44:47], v[28:31], v[196:199]
 v_mfma_f32_16x16x32_bf16 v[180:183], a[40:43], v[28:31], v[180:183]
 ds_write_b128 v8, v[124:127] offset:3072
 v_mfma_f32_16x16x32_bf16 v[152:155], a[48:51], v[24:27], v[152:155]
 v_mfma_f32_16x16x32_bf16 v[168:171], a[52:55], v[24:27], v[168:171]
 v_mfma_f32_16x16x32_bf16 v[200:203], a[52:55], v[28:31], v[200:203]
 ds_write_b128 v9, v[128:131] offset:0
 v_mfma_f32_16x16x32_bf16 v[184:187], a[48:51], v[28:31], v[184:187]
 v_mfma_f32_16x16x32_bf16 v[156:159], a[56:59], v[24:27], v[156:159]
 v_mfma_f32_16x16x32_bf16 v[172:175], a[60:63], v[24:27], v[172:175]
 ds_write_b128 v9, v[132:135] offset:1024
 v_mfma_f32_16x16x32_bf16 v[204:207], a[60:63], v[28:31], v[204:207]
 v_mfma_f32_16x16x32_bf16 v[188:191], a[56:59], v[28:31], v[188:191]
 v_mfma_f32_16x16x32_bf16 v[144:147], a[64:67], v[32:35], v[144:147]
 buffer_load_dwordx4 v[24:27], v2, s[48:51], s82 offen offset:2048 sc1
 v_mfma_f32_16x16x32_bf16 v[160:163], a[68:71], v[32:35], v[160:163]
 ds_write_b128 v9, v[136:139] offset:2048
 v_mfma_f32_16x16x32_bf16 v[192:195], a[68:71], v[36:39], v[192:195]
 buffer_load_dwordx4 v[28:31], v5, s[48:51], s82 offen offset:2048 sc1
 v_mfma_f32_16x16x32_bf16 v[176:179], a[64:67], v[36:39], v[176:179]
 v_mfma_f32_16x16x32_bf16 v[148:151], a[72:75], v[32:35], v[148:151]
 ds_write_b128 v9, v[140:143] offset:3072
 v_mfma_f32_16x16x32_bf16 v[164:167], a[76:79], v[32:35], v[164:167]
 v_mfma_f32_16x16x32_bf16 v[196:199], a[76:79], v[36:39], v[196:199]
 v_mfma_f32_16x16x32_bf16 v[180:183], a[72:75], v[36:39], v[180:183]
 s_waitcnt lgkmcnt(0)
 s_barrier
 v_mfma_f32_16x16x32_bf16 v[152:155], a[80:83], v[32:35], v[152:155]
 ds_read_b128 v[96:99], v10 offset:0
 v_mfma_f32_16x16x32_bf16 v[168:171], a[84:87], v[32:35], v[168:171]
 ds_read_b128 v[100:103], v10 offset:1024
 v_mfma_f32_16x16x32_bf16 v[200:203], a[84:87], v[36:39], v[200:203]
 ds_read_b128 v[104:107], v10 offset:2048
 v_mfma_f32_16x16x32_bf16 v[184:187], a[80:83], v[36:39], v[184:187]
 ds_read_b128 v[108:111], v10 offset:3072
 v_mfma_f32_16x16x32_bf16 v[156:159], a[88:91], v[32:35], v[156:159]
 ds_read_b128 v[112:115], v10 offset:4096
 v_mfma_f32_16x16x32_bf16 v[172:175], a[92:95], v[32:35], v[172:175]
 ds_read_b128 v[116:119], v10 offset:5120
 v_mfma_f32_16x16x32_bf16 v[204:207], a[92:95], v[36:39], v[204:207]
 ds_read_b128 v[120:123], v10 offset:6144
 v_mfma_f32_16x16x32_bf16 v[188:191], a[88:91], v[36:39], v[188:191]
 ds_read_b128 v[124:127], v10 offset:7168
 v_mfma_f32_16x16x32_bf16 v[144:147], a[96:99], v[40:43], v[144:147]
 s_add_u32 s82, s65, 4096
 buffer_load_dwordx4 v[32:35], v2, s[48:51], s82 offen offset:0 sc1
 v_mfma_f32_16x16x32_bf16 v[160:163], a[100:103], v[40:43], v[160:163]
 ds_read_b128 v[128:131], v10 offset:8192
 v_mfma_f32_16x16x32_bf16 v[192:195], a[100:103], v[44:47], v[192:195]
 buffer_load_dwordx4 v[36:39], v5, s[48:51], s82 offen offset:0 sc1
 v_mfma_f32_16x16x32_bf16 v[176:179], a[96:99], v[44:47], v[176:179]
 ds_read_b128 v[132:135], v10 offset:9216
 v_mfma_f32_16x16x32_bf16 v[148:151], a[104:107], v[40:43], v[148:151]
 ds_read_b128 v[136:139], v10 offset:10240
 v_mfma_f32_16x16x32_bf16 v[164:167], a[108:111], v[40:43], v[164:167]
 ds_read_b128 v[140:143], v10 offset:11264
 v_mfma_f32_16x16x32_bf16 v[196:199], a[108:111], v[44:47], v[196:199]
 s_waitcnt lgkmcnt(8)
 v_add_f32 v80, v80, v96
 v_mfma_f32_16x16x32_bf16 v[180:183], a[104:107], v[44:47], v[180:183]
 v_add_f32 v81, v81, v97
 v_add_f32 v82, v82, v98
 v_mfma_f32_16x16x32_bf16 v[152:155], a[112:115], v[40:43], v[152:155]
 v_add_f32 v83, v83, v99
 v_add_f32 v84, v84, v100
 v_mfma_f32_16x16x32_bf16 v[168:171], a[116:119], v[40:43], v[168:171]
 v_add_f32 v85, v85, v101
 v_add_f32 v86, v86, v102
 v_mfma_f32_16x16x32_bf16 v[200:203], a[116:119], v[44:47], v[200:203]
 v_add_f32 v87, v87, v103
 v_add_f32 v88, v88, v104
 v_mfma_f32_16x16x32_bf16 v[184:187], a[112:115], v[44:47], v[184:187]
 v_add_f32 v89, v89, v105
 v_add_f32 v90, v90, v106
 v_mfma_f32_16x16x32_bf16 v[156:159], a[120:123], v[40:43], v[156:159]
 v_add_f32 v91, v91, v107
 v_add_f32 v92, v92, v108
 v_mfma_f32_16x16x32_bf16 v[172:175], a[124:127], v[40:43], v[172:175]
 v_add_f32 v93, v93, v109
 v_add_f32 v94, v94, v110
 v_mfma_f32_16x16x32_bf16 v[204:207], a[124:127], v[44:47], v[204:207]
 v_add_f32 v95, v95, v111
 s_waitcnt lgkmcnt(4)
 v_mfma_f32_16x16x32_bf16 v[188:191], a[120:123], v[44:47], v[188:191]
 v_add_f32 v80, v80, v112
 v_mfma_f32_16x16x32_bf16 v[144:147], a[128:131], v[48:51], v[144:147]
 buffer_load_dwordx4 v[40:43], v2, s[48:51], s82 offen offset:2048 sc1
 v_mfma_f32_16x16x32_bf16 v[160:163], a[132:135], v[48:51], v[160:163]
 v_add_f32 v81, v81, v113
 v_add_f32 v82, v82, v114
 v_mfma_f32_16x16x32_bf16 v[192:195], a[132:135], v[52:55], v[192:195]
 buffer_load_dwordx4 v[44:47], v5, s[48:51], s82 offen offset:2048 sc1
 v_mfma_f32_16x16x32_bf16 v[176:179], a[128:131], v[52:55], v[176:179]
 v_add_f32 v83, v83, v115
 v_add_f32 v84, v84, v116
 v_mfma_f32_16x16x32_bf16 v[148:151], a[136:139], v[48:51], v[148:151]
 v_add_f32 v85, v85, v117
 v_add_f32 v86, v86, v118
 v_mfma_f32_16x16x32_bf16 v[164:167], a[140:143], v[48:51], v[164:167]
 v_add_f32 v87, v87, v119
 v_add_f32 v88, v88, v120
 v_mfma_f32_16x16x32_bf16 v[196:199], a[140:143], v[52:55], v[196:199]
 v_add_f32 v89, v89, v121
 v_add_f32 v90, v90, v122
 v_mfma_f32_16x16x32_bf16 v[180:183], a[136:139], v[52:55], v[180:183]
 v_add_f32 v91, v91, v123
 v_add_f32 v92, v92, v124
 v_mfma_f32_16x16x32_bf16 v[152:155], a[144:147], v[48:51], v[152:155]
 v_add_f32 v93, v93, v125
 v_add_f32 v94, v94, v126
 v_mfma_f32_16x16x32_bf16 v[168:171], a[148:151], v[48:51], v[168:171]
 v_add_f32 v95, v95, v127
 s_waitcnt lgkmcnt(0)
 v_mfma_f32_16x16x32_bf16 v[200:203], a[148:151], v[52:55], v[200:203]
 v_add_f32 v80, v80, v128
 v_add_f32 v81, v81, v129
 v_mfma_f32_16x16x32_bf16 v[184:187], a[144:147], v[52:55], v[184:187]
 v_add_f32 v82, v82, v130
 v_add_f32 v83, v83, v131
 v_mfma_f32_16x16x32_bf16 v[156:159], a[152:155], v[48:51], v[156:159]
 v_add_f32 v84, v84, v132
 v_add_f32 v85, v85, v133
 v_mfma_f32_16x16x32_bf16 v[172:175], a[156:159], v[48:51], v[172:175]
 v_add_f32 v86, v86, v134
 v_add_f32 v87, v87, v135
 v_mfma_f32_16x16x32_bf16 v[204:207], a[156:159], v[52:55], v[204:207]
 v_add_f32 v88, v88, v136
 v_add_f32 v89, v89, v137
 v_mfma_f32_16x16x32_bf16 v[188:191], a[152:155], v[52:55], v[188:191]
 v_add_f32 v90, v90, v138
 s_waitcnt vmcnt(19)
 v_mfma_f32_16x16x32_bf16 v[144:147], a[160:163], v[56:59], v[144:147]
 s_add_u32 s82, s65, 8192
 buffer_load_dwordx4 v[48:51], v2, s[48:51], s82 offen offset:0 sc1
 v_mfma_f32_16x16x32_bf16 v[160:163], a[164:167], v[56:59], v[160:163]
 v_add_f32 v91, v91, v139
 v_add_f32 v92, v92, v140
 v_mfma_f32_16x16x32_bf16 v[192:195], a[164:167], v[60:63], v[192:195]
 buffer_load_dwordx4 v[52:55], v5, s[48:51], s82 offen offset:0 sc1
 v_mfma_f32_16x16x32_bf16 v[176:179], a[160:163], v[60:63], v[176:179]
 v_add_f32 v93, v93, v141
 v_add_f32 v94, v94, v142
 v_mfma_f32_16x16x32_bf16 v[148:151], a[168:171], v[56:59], v[148:151]
 v_add_f32 v95, v95, v143
 s_waitcnt vmcnt(10)
 v_mfma_f32_16x16x32_bf16 v[164:167], a[172:175], v[56:59], v[164:167]
 v_bitop3_b32 v13, v216, v220, s79 bitop3:0x7e
 v_bitop3_b32 v13, v13, v224, s79 bitop3:0xf6
 v_mfma_f32_16x16x32_bf16 v[196:199], a[172:175], v[60:63], v[196:199]
 v_and_b32 v13, 1, v13
 v_cmp_eq_u32 vcc, 1, v13
 v_mfma_f32_16x16x32_bf16 v[180:183], a[168:171], v[60:63], v[180:183]
 s_nop 0
 v_mfma_f32_16x16x32_bf16 v[152:155], a[176:179], v[56:59], v[152:155]
 s_add_u32 s72, s63, 6
 s_and_b32 s71, s72, 3
 v_mfma_f32_16x16x32_bf16 v[168:171], a[180:183], v[56:59], v[168:171]
 s_lshl_b32 s71, s71, 7
 s_add_u32 s71, s71, s74
 v_mfma_f32_16x16x32_bf16 v[200:203], a[180:183], v[60:63], v[200:203]
 s_lshr_b32 s72, s72, 2
 v_mfma_f32_16x16x32_bf16 v[184:187], a[176:179], v[60:63], v[184:187]
 buffer_load_dword v12, v11, s[48:51], s71 offen sc1
 v_mfma_f32_16x16x32_bf16 v[156:159], a[184:187], v[56:59], v[156:159]
 s_cbranch_vccnz stale_63
fresh_64:
 v_mfma_f32_16x16x32_bf16 v[172:175], a[188:191], v[56:59], v[172:175]
 v_add_f32 v212, v212, v216
 v_add_f32 v213, v213, v217
 v_mfma_f32_16x16x32_bf16 v[204:207], a[188:191], v[60:63], v[204:207]
 v_add_f32 v214, v214, v218
 v_add_f32 v215, v215, v219
 v_mfma_f32_16x16x32_bf16 v[188:191], a[184:187], v[60:63], v[188:191]
 v_add_f32 v212, v212, v220
 v_mfma_f32_16x16x32_bf16 v[144:147], a[192:195], v[64:67], v[144:147]
 buffer_load_dwordx4 v[56:59], v2, s[48:51], s82 offen offset:2048 sc1
 v_mfma_f32_16x16x32_bf16 v[160:163], a[196:199], v[64:67], v[160:163]
 v_add_f32 v213, v213, v221
 v_add_f32 v214, v214, v222
 v_mfma_f32_16x16x32_bf16 v[192:195], a[196:199], v[68:71], v[192:195]
 buffer_load_dwordx4 v[60:63], v5, s[48:51], s82 offen offset:2048 sc1
 v_mfma_f32_16x16x32_bf16 v[176:179], a[192:195], v[68:71], v[176:179]
 v_add_f32 v215, v215, v223
 v_add_f32 v212, v212, v224
 v_mfma_f32_16x16x32_bf16 v[148:151], a[200:203], v[64:67], v[148:151]
 v_add_f32 v213, v213, v225
 v_add_f32 v214, v214, v226
 v_mfma_f32_16x16x32_bf16 v[164:167], a[204:207], v[64:67], v[164:167]
 v_add_f32 v215, v215, v227
 s_min_u32 s77, s77, 64
 v_mfma_f32_16x16x32_bf16 v[196:199], a[204:207], v[68:71], v[196:199]
 s_lshl_b32 s69, s77, 17
 s_add_u32 s69, s69, s67
 v_mfma_f32_16x16x32_bf16 v[180:183], a[200:203], v[68:71], v[180:183]
 v_cvt_pk_bf16_f32 v14, v212, v213
 v_cvt_pk_bf16_f32 v15, v214, v215
 v_mfma_f32_16x16x32_bf16 v[152:155], a[208:211], v[64:67], v[152:155]
 buffer_store_dwordx2 v[14:15], v250, s[56:59], s69 offen
 v_mfma_f32_16x16x32_bf16 v[168:171], a[212:215], v[64:67], v[168:171]
 v_mov_b32 v212, v80
 v_mov_b32 v213, v81
 v_mfma_f32_16x16x32_bf16 v[200:203], a[212:215], v[68:71], v[200:203]
 v_mov_b32 v214, v82
 v_mov_b32 v215, v83
 v_mfma_f32_16x16x32_bf16 v[184:187], a[208:211], v[68:71], v[184:187]
 s_sub_u32 s77, s63, 1
 s_and_b32 s78, s77, 3
 v_mfma_f32_16x16x32_bf16 v[156:159], a[216:219], v[64:67], v[156:159]
 s_lshl_b32 s78, s78, 22
 s_add_u32 s78, s78, s76
 v_mfma_f32_16x16x32_bf16 v[172:175], a[220:223], v[64:67], v[172:175]
 s_bfe_u32 s79, s77, 0x10002
 v_bfi_b32 v84, 1, s79, v84
 v_mfma_f32_16x16x32_bf16 v[204:207], a[220:223], v[68:71], v[204:207]
 v_bfi_b32 v88, 1, s79, v88
 v_bfi_b32 v92, 1, s79, v92
 v_mfma_f32_16x16x32_bf16 v[188:191], a[216:219], v[68:71], v[188:191]
 buffer_store_dwordx4 v[84:87], v244, s[48:51], s78 offen sc1
 v_mfma_f32_16x16x32_bf16 v[144:147], a[224:227], v[72:75], v[144:147]
 s_add_u32 s82, s65, 12288
 buffer_load_dwordx4 v[64:67], v2, s[48:51], s82 offen offset:0 sc1
 v_mfma_f32_16x16x32_bf16 v[160:163], a[228:231], v[72:75], v[160:163]
 buffer_store_dwordx4 v[88:91], v245, s[48:51], s78 offen sc1
 v_mfma_f32_16x16x32_bf16 v[192:195], a[228:231], v[76:79], v[192:195]
 buffer_load_dwordx4 v[68:71], v5, s[48:51], s82 offen offset:0 sc1
 v_mfma_f32_16x16x32_bf16 v[176:179], a[224:227], v[76:79], v[176:179]
 s_add_u32 s65, s65, 0x40000
 s_waitcnt vmcnt(7)
 v_mfma_f32_16x16x32_bf16 v[148:151], a[232:235], v[72:75], v[148:151]
 v_cmp_gt_u32 vcc, s72, v12
 v_mfma_f32_16x16x32_bf16 v[164:167], a[236:239], v[72:75], v[164:167]
 buffer_store_dwordx4 v[92:95], v246, s[48:51], s78 offen sc1
 v_mfma_f32_16x16x32_bf16 v[196:199], a[236:239], v[76:79], v[196:199]
 s_add_u32 s63, s63, 1
 v_mfma_f32_16x16x32_bf16 v[180:183], a[232:235], v[76:79], v[180:183]
 v_mfma_f32_16x16x32_bf16 v[152:155], a[240:243], v[72:75], v[152:155]
 v_mfma_f32_16x16x32_bf16 v[168:171], a[244:247], v[72:75], v[168:171]
 v_mfma_f32_16x16x32_bf16 v[200:203], a[244:247], v[76:79], v[200:203]
 v_mfma_f32_16x16x32_bf16 v[184:187], a[240:243], v[76:79], v[184:187]
 v_mfma_f32_16x16x32_bf16 v[156:159], a[248:251], v[72:75], v[156:159]
 v_mfma_f32_16x16x32_bf16 v[172:175], a[252:255], v[72:75], v[172:175]
 v_mfma_f32_16x16x32_bf16 v[204:207], a[252:255], v[76:79], v[204:207]
 v_mfma_f32_16x16x32_bf16 v[188:191], a[248:251], v[76:79], v[188:191]
 s_branch Lw_Owarm0
dry_62:
 v_mfma_f32_16x16x32_bf16 v[144:147], a[0:3], v[16:19], 0
 buffer_load_dwordx4 v[72:75], v2, s[48:51], s82 offen offset:2048 sc1
 v_mfma_f32_16x16x32_bf16 v[160:163], a[4:7], v[16:19], 0
 ds_write_b128 v7, v[96:99] offset:0
 v_mfma_f32_16x16x32_bf16 v[192:195], a[4:7], v[20:23], 0
 buffer_load_dwordx4 v[76:79], v5, s[48:51], s82 offen offset:2048 sc1
 v_mfma_f32_16x16x32_bf16 v[176:179], a[0:3], v[20:23], 0
 s_sub_u32 s77, s63, 3
 s_and_b32 s78, s77, 3
 v_mfma_f32_16x16x32_bf16 v[148:151], a[8:11], v[16:19], 0
 ds_write_b128 v7, v[100:103] offset:1024
 v_mfma_f32_16x16x32_bf16 v[164:167], a[12:15], v[16:19], 0
 s_lshl_b32 s78, s78, 22
 s_add_u32 s78, s78, s76
 v_mfma_f32_16x16x32_bf16 v[196:199], a[12:15], v[20:23], 0
 s_bfe_u32 s79, s77, 0x10002
 v_mfma_f32_16x16x32_bf16 v[180:183], a[8:11], v[20:23], 0
 ds_write_b128 v7, v[104:107] offset:2048
 v_mfma_f32_16x16x32_bf16 v[152:155], a[16:19], v[16:19], 0
 buffer_load_dwordx4 v[216:219], v247, s[48:51], s78 offen sc1
 v_mfma_f32_16x16x32_bf16 v[168:171], a[20:23], v[16:19], 0
 buffer_load_dwordx4 v[220:223], v248, s[48:51], s78 offen sc1
 v_mfma_f32_16x16x32_bf16 v[200:203], a[20:23], v[20:23], 0
 ds_write_b128 v7, v[108:111] offset:3072
 v_mfma_f32_16x16x32_bf16 v[184:187], a[16:19], v[20:23], 0
 buffer_load_dwordx4 v[224:227], v249, s[48:51], s78 offen sc1
 v_mfma_f32_16x16x32_bf16 v[156:159], a[24:27], v[16:19], 0
 v_mfma_f32_16x16x32_bf16 v[172:175], a[28:31], v[16:19], 0
 ds_write_b128 v8, v[112:115] offset:0
 v_mfma_f32_16x16x32_bf16 v[204:207], a[28:31], v[20:23], 0
 v_mfma_f32_16x16x32_bf16 v[188:191], a[24:27], v[20:23], 0
 v_mfma_f32_16x16x32_bf16 v[144:147], a[32:35], v[24:27], v[144:147]
 ds_write_b128 v8, v[116:119] offset:1024
 v_mfma_f32_16x16x32_bf16 v[160:163], a[36:39], v[24:27], v[160:163]
 v_mfma_f32_16x16x32_bf16 v[192:195], a[36:39], v[28:31], v[192:195]
 v_mfma_f32_16x16x32_bf16 v[176:179], a[32:35], v[28:31], v[176:179]
 ds_write_b128 v8, v[120:123] offset:2048
 v_mfma_f32_16x16x32_bf16 v[148:151], a[40:43], v[24:27], v[148:151]
 v_mfma_f32_16x16x32_bf16 v[164:167], a[44:47], v[24:27], v[164:167]
 v_mfma_f32_16x16x32_bf16 v[196:199], a[44:47], v[28:31], v[196:199]
 ds_write_b128 v8, v[124:127] offset:3072
 v_mfma_f32_16x16x32_bf16 v[180:183], a[40:43], v[28:31], v[180:183]
 v_mfma_f32_16x16x32_bf16 v[152:155], a[48:51], v[24:27], v[152:155]
 v_mfma_f32_16x16x32_bf16 v[168:171], a[52:55], v[24:27], v[168:171]
 ds_write_b128 v9, v[128:131] offset:0
 v_mfma_f32_16x16x32_bf16 v[200:203], a[52:55], v[28:31], v[200:203]
 v_mfma_f32_16x16x32_bf16 v[184:187], a[48:51], v[28:31], v[184:187]
 v_mfma_f32_16x16x32_bf16 v[156:159], a[56:59], v[24:27], v[156:159]
 ds_write_b128 v9, v[132:135] offset:1024
 v_mfma_f32_16x16x32_bf16 v[172:175], a[60:63], v[24:27], v[172:175]
 v_mfma_f32_16x16x32_bf16 v[204:207], a[60:63], v[28:31], v[204:207]
 v_mfma_f32_16x16x32_bf16 v[188:191], a[56:59], v[28:31], v[188:191]
 ds_write_b128 v9, v[136:139] offset:2048
 v_mfma_f32_16x16x32_bf16 v[144:147], a[64:67], v[32:35], v[144:147]
 v_mfma_f32_16x16x32_bf16 v[160:163], a[68:71], v[32:35], v[160:163]
 v_mfma_f32_16x16x32_bf16 v[192:195], a[68:71], v[36:39], v[192:195]
 ds_write_b128 v9, v[140:143] offset:3072
 v_mfma_f32_16x16x32_bf16 v[176:179], a[64:67], v[36:39], v[176:179]
 v_mfma_f32_16x16x32_bf16 v[148:151], a[72:75], v[32:35], v[148:151]
 v_mfma_f32_16x16x32_bf16 v[164:167], a[76:79], v[32:35], v[164:167]
 s_waitcnt lgkmcnt(0)
 s_barrier
 v_mfma_f32_16x16x32_bf16 v[196:199], a[76:79], v[36:39], v[196:199]
 ds_read_b128 v[96:99], v10 offset:0
 v_mfma_f32_16x16x32_bf16 v[180:183], a[72:75], v[36:39], v[180:183]
 ds_read_b128 v[100:103], v10 offset:1024
 v_mfma_f32_16x16x32_bf16 v[152:155], a[80:83], v[32:35], v[152:155]
 ds_read_b128 v[104:107], v10 offset:2048
 v_mfma_f32_16x16x32_bf16 v[168:171], a[84:87], v[32:35], v[168:171]
 ds_read_b128 v[108:111], v10 offset:3072
 v_mfma_f32_16x16x32_bf16 v[200:203], a[84:87], v[36:39], v[200:203]
 ds_read_b128 v[112:115], v10 offset:4096
 v_mfma_f32_16x16x32_bf16 v[184:187], a[80:83], v[36:39], v[184:187]
 ds_read_b128 v[116:119], v10 offset:5120
 v_mfma_f32_16x16x32_bf16 v[156:159], a[88:91], v[32:35], v[156:159]
 ds_read_b128 v[120:123], v10 offset:6144
 v_mfma_f32_16x16x32_bf16 v[172:175], a[92:95], v[32:35], v[172:175]
 ds_read_b128 v[124:127], v10 offset:7168
 v_mfma_f32_16x16x32_bf16 v[204:207], a[92:95], v[36:39], v[204:207]
 ds_read_b128 v[128:131], v10 offset:8192
 v_mfma_f32_16x16x32_bf16 v[188:191], a[88:91], v[36:39], v[188:191]
 ds_read_b128 v[132:135], v10 offset:9216
 v_mfma_f32_16x16x32_bf16 v[144:147], a[96:99], v[40:43], v[144:147]
 ds_read_b128 v[136:139], v10 offset:10240
 v_mfma_f32_16x16x32_bf16 v[160:163], a[100:103], v[40:43], v[160:163]
 ds_read_b128 v[140:143], v10 offset:11264
 v_mfma_f32_16x16x32_bf16 v[192:195], a[100:103], v[44:47], v[192:195]
 s_waitcnt lgkmcnt(8)
 v_add_f32 v80, v80, v96
 v_mfma_f32_16x16x32_bf16 v[176:179], a[96:99], v[44:47], v[176:179]
 v_add_f32 v81, v81, v97
 v_add_f32 v82, v82, v98
 v_mfma_f32_16x16x32_bf16 v[148:151], a[104:107], v[40:43], v[148:151]
 v_add_f32 v83, v83, v99
 v_add_f32 v84, v84, v100
 v_mfma_f32_16x16x32_bf16 v[164:167], a[108:111], v[40:43], v[164:167]
 v_add_f32 v85, v85, v101
 v_add_f32 v86, v86, v102
 v_mfma_f32_16x16x32_bf16 v[196:199], a[108:111], v[44:47], v[196:199]
 v_add_f32 v87, v87, v103
 v_add_f32 v88, v88, v104
 v_mfma_f32_16x16x32_bf16 v[180:183], a[104:107], v[44:47], v[180:183]
 v_add_f32 v89, v89, v105
 v_add_f32 v90, v90, v106
 v_mfma_f32_16x16x32_bf16 v[152:155], a[112:115], v[40:43], v[152:155]
 v_add_f32 v91, v91, v107
 v_add_f32 v92, v92, v108
 v_mfma_f32_16x16x32_bf16 v[168:171], a[116:119], v[40:43], v[168:171]
 v_add_f32 v93, v93, v109
 v_add_f32 v94, v94, v110
 v_mfma_f32_16x16x32_bf16 v[200:203], a[116:119], v[44:47], v[200:203]
 v_add_f32 v95, v95, v111
 s_waitcnt lgkmcnt(4)
 v_mfma_f32_16x16x32_bf16 v[184:187], a[112:115], v[44:47], v[184:187]
 v_add_f32 v80, v80, v112
 v_add_f32 v81, v81, v113
 v_mfma_f32_16x16x32_bf16 v[156:159], a[120:123], v[40:43], v[156:159]
 v_add_f32 v82, v82, v114
 v_add_f32 v83, v83, v115
 v_mfma_f32_16x16x32_bf16 v[172:175], a[124:127], v[40:43], v[172:175]
 v_add_f32 v84, v84, v116
 v_add_f32 v85, v85, v117
 v_mfma_f32_16x16x32_bf16 v[204:207], a[124:127], v[44:47], v[204:207]
 v_add_f32 v86, v86, v118
 v_add_f32 v87, v87, v119
 v_mfma_f32_16x16x32_bf16 v[188:191], a[120:123], v[44:47], v[188:191]
 v_add_f32 v88, v88, v120
 v_mfma_f32_16x16x32_bf16 v[144:147], a[128:131], v[48:51], v[144:147]
 v_add_f32 v89, v89, v121
 v_add_f32 v90, v90, v122
 v_mfma_f32_16x16x32_bf16 v[160:163], a[132:135], v[48:51], v[160:163]
 v_add_f32 v91, v91, v123
 v_add_f32 v92, v92, v124
 v_mfma_f32_16x16x32_bf16 v[192:195], a[132:135], v[52:55], v[192:195]
 v_add_f32 v93, v93, v125
 v_add_f32 v94, v94, v126
 v_mfma_f32_16x16x32_bf16 v[176:179], a[128:131], v[52:55], v[176:179]
 v_add_f32 v95, v95, v127
 s_waitcnt lgkmcnt(0)
 v_mfma_f32_16x16x32_bf16 v[148:151], a[136:139], v[48:51], v[148:151]
 v_add_f32 v80, v80, v128
 v_add_f32 v81, v81, v129
 v_mfma_f32_16x16x32_bf16 v[164:167], a[140:143], v[48:51], v[164:167]
 v_add_f32 v82, v82, v130
 v_add_f32 v83, v83, v131
 v_mfma_f32_16x16x32_bf16 v[196:199], a[140:143], v[52:55], v[196:199]
 v_add_f32 v84, v84, v132
 v_add_f32 v85, v85, v133
 v_mfma_f32_16x16x32_bf16 v[180:183], a[136:139], v[52:55], v[180:183]
 v_add_f32 v86, v86, v134
 v_add_f32 v87, v87, v135
 v_mfma_f32_16x16x32_bf16 v[152:155], a[144:147], v[48:51], v[152:155]
 v_add_f32 v88, v88, v136
 v_add_f32 v89, v89, v137
 v_mfma_f32_16x16x32_bf16 v[168:171], a[148:151], v[48:51], v[168:171]
 v_add_f32 v90, v90, v138
 v_add_f32 v91, v91, v139
 v_mfma_f32_16x16x32_bf16 v[200:203], a[148:151], v[52:55], v[200:203]
 v_add_f32 v92, v92, v140
 v_add_f32 v93, v93, v141
 v_mfma_f32_16x16x32_bf16 v[184:187], a[144:147], v[52:55], v[184:187]
 v_add_f32 v94, v94, v142
 v_add_f32 v95, v95, v143
 v_mfma_f32_16x16x32_bf16 v[156:159], a[152:155], v[48:51], v[156:159]
 s_waitcnt vmcnt(0)
 v_bitop3_b32 v13, v216, v220, s79 bitop3:0x7e
 v_mfma_f32_16x16x32_bf16 v[172:175], a[156:159], v[48:51], v[172:175]
 v_bitop3_b32 v13, v13, v224, s79 bitop3:0xf6
 v_and_b32 v13, 1, v13
 v_mfma_f32_16x16x32_bf16 v[204:207], a[156:159], v[52:55], v[204:207]
 v_cmp_eq_u32 vcc, 1, v13
 s_nop 0
 v_mfma_f32_16x16x32_bf16 v[188:191], a[152:155], v[52:55], v[188:191]
 s_cbranch_vccnz stale_65
fresh_66:
 v_mfma_f32_16x16x32_bf16 v[144:147], a[160:163], v[56:59], v[144:147]
 v_add_f32 v212, v212, v216
 v_add_f32 v213, v213, v217
 v_mfma_f32_16x16x32_bf16 v[160:163], a[164:167], v[56:59], v[160:163]
 v_add_f32 v214, v214, v218
 v_add_f32 v215, v215, v219
 v_mfma_f32_16x16x32_bf16 v[192:195], a[164:167], v[60:63], v[192:195]
 v_add_f32 v212, v212, v220
 v_add_f32 v213, v213, v221
 v_mfma_f32_16x16x32_bf16 v[176:179], a[160:163], v[60:63], v[176:179]
 v_add_f32 v214, v214, v222
 v_add_f32 v215, v215, v223
 v_mfma_f32_16x16x32_bf16 v[148:151], a[168:171], v[56:59], v[148:151]
 v_add_f32 v212, v212, v224
 v_add_f32 v213, v213, v225
 v_mfma_f32_16x16x32_bf16 v[164:167], a[172:175], v[56:59], v[164:167]
 v_add_f32 v214, v214, v226
 v_add_f32 v215, v215, v227
 v_mfma_f32_16x16x32_bf16 v[196:199], a[172:175], v[60:63], v[196:199]
 s_min_u32 s77, s77, 64
 s_lshl_b32 s69, s77, 17
 v_mfma_f32_16x16x32_bf16 v[180:183], a[168:171], v[60:63], v[180:183]
 s_add_u32 s69, s69, s67
 v_cvt_pk_bf16_f32 v14, v212, v213
 v_mfma_f32_16x16x32_bf16 v[152:155], a[176:179], v[56:59], v[152:155]
 v_cvt_pk_bf16_f32 v15, v214, v215
 v_mfma_f32_16x16x32_bf16 v[168:171], a[180:183], v[56:59], v[168:171]
 buffer_store_dwordx2 v[14:15], v250, s[56:59], s69 offen
 v_mfma_f32_16x16x32_bf16 v[200:203], a[180:183], v[60:63], v[200:203]
 v_mov_b32 v212, v80
 v_mov_b32 v213, v81
 v_mfma_f32_16x16x32_bf16 v[184:187], a[176:179], v[60:63], v[184:187]
 v_mov_b32 v214, v82
 v_mov_b32 v215, v83
 v_mfma_f32_16x16x32_bf16 v[156:159], a[184:187], v[56:59], v[156:159]
 s_sub_u32 s77, s63, 1
 s_and_b32 s78, s77, 3
 v_mfma_f32_16x16x32_bf16 v[172:175], a[188:191], v[56:59], v[172:175]
 s_lshl_b32 s78, s78, 22
 s_add_u32 s78, s78, s76
 v_mfma_f32_16x16x32_bf16 v[204:207], a[188:191], v[60:63], v[204:207]
 s_bfe_u32 s79, s77, 0x10002
 v_bfi_b32 v84, 1, s79, v84
 v_mfma_f32_16x16x32_bf16 v[188:191], a[184:187], v[60:63], v[188:191]
 v_bfi_b32 v88, 1, s79, v88
 v_mfma_f32_16x16x32_bf16 v[144:147], a[192:195], v[64:67], v[144:147]
 v_bfi_b32 v92, 1, s79, v92
 v_mfma_f32_16x16x32_bf16 v[160:163], a[196:199], v[64:67], v[160:163]
 buffer_store_dwordx4 v[84:87], v244, s[48:51], s78 offen sc1
 v_mfma_f32_16x16x32_bf16 v[192:195], a[196:199], v[68:71], v[192:195]
 buffer_store_dwordx4 v[88:91], v245, s[48:51], s78 offen sc1
 v_mfma_f32_16x16x32_bf16 v[176:179], a[192:195], v[68:71], v[176:179]
 buffer_store_dwordx4 v[92:95], v246, s[48:51], s78 offen sc1
 v_mfma_f32_16x16x32_bf16 v[148:151], a[200:203], v[64:67], v[148:151]
 s_add_u32 s63, s63, 1
 v_mfma_f32_16x16x32_bf16 v[164:167], a[204:207], v[64:67], v[164:167]
 v_mfma_f32_16x16x32_bf16 v[196:199], a[204:207], v[68:71], v[196:199]
 v_mfma_f32_16x16x32_bf16 v[180:183], a[200:203], v[68:71], v[180:183]
 v_mfma_f32_16x16x32_bf16 v[152:155], a[208:211], v[64:67], v[152:155]
 v_mfma_f32_16x16x32_bf16 v[168:171], a[212:215], v[64:67], v[168:171]
 v_mfma_f32_16x16x32_bf16 v[200:203], a[212:215], v[68:71], v[200:203]
 v_mfma_f32_16x16x32_bf16 v[184:187], a[208:211], v[68:71], v[184:187]
 v_mfma_f32_16x16x32_bf16 v[156:159], a[216:219], v[64:67], v[156:159]
 v_mfma_f32_16x16x32_bf16 v[172:175], a[220:223], v[64:67], v[172:175]
 v_mfma_f32_16x16x32_bf16 v[204:207], a[220:223], v[68:71], v[204:207]
 v_mfma_f32_16x16x32_bf16 v[188:191], a[216:219], v[68:71], v[188:191]
 v_mfma_f32_16x16x32_bf16 v[144:147], a[224:227], v[72:75], v[144:147]
 v_mfma_f32_16x16x32_bf16 v[160:163], a[228:231], v[72:75], v[160:163]
 v_mfma_f32_16x16x32_bf16 v[192:195], a[228:231], v[76:79], v[192:195]
 v_mfma_f32_16x16x32_bf16 v[176:179], a[224:227], v[76:79], v[176:179]
 v_mfma_f32_16x16x32_bf16 v[148:151], a[232:235], v[72:75], v[148:151]
 v_mfma_f32_16x16x32_bf16 v[164:167], a[236:239], v[72:75], v[164:167]
 v_mfma_f32_16x16x32_bf16 v[196:199], a[236:239], v[76:79], v[196:199]
 v_mfma_f32_16x16x32_bf16 v[180:183], a[232:235], v[76:79], v[180:183]
 v_mfma_f32_16x16x32_bf16 v[152:155], a[240:243], v[72:75], v[152:155]
 v_mfma_f32_16x16x32_bf16 v[168:171], a[244:247], v[72:75], v[168:171]
 v_mfma_f32_16x16x32_bf16 v[200:203], a[244:247], v[76:79], v[200:203]
 v_mfma_f32_16x16x32_bf16 v[184:187], a[240:243], v[76:79], v[184:187]
 v_mfma_f32_16x16x32_bf16 v[156:159], a[248:251], v[72:75], v[156:159]
 v_mfma_f32_16x16x32_bf16 v[172:175], a[252:255], v[72:75], v[172:175]
 v_mfma_f32_16x16x32_bf16 v[204:207], a[252:255], v[76:79], v[204:207]
 v_mfma_f32_16x16x32_bf16 v[188:191], a[248:251], v[76:79], v[188:191]
 s_branch Lw_Ocold0
Lw_Otail:
 s_sub_u32 s77, s63, 3
 s_and_b32 s78, s77, 3
 s_lshl_b32 s78, s78, 22
 s_add_u32 s78, s78, s76
 s_bfe_u32 s79, s77, 0x10002
 buffer_load_dwordx4 v[216:219], v247, s[48:51], s78 offen sc1
 buffer_load_dwordx4 v[220:223], v248, s[48:51], s78 offen sc1
 buffer_load_dwordx4 v[224:227], v249, s[48:51], s78 offen sc1
 ds_write_b128 v7, v[160:163] offset:49152
 ds_write_b128 v7, v[164:167] offset:50176
 ds_write_b128 v7, v[168:171] offset:51200
 ds_write_b128 v7, v[172:175] offset:52224
 ds_write_b128 v8, v[176:179] offset:49152
 ds_write_b128 v8, v[180:183] offset:50176
 ds_write_b128 v8, v[184:187] offset:51200
 ds_write_b128 v8, v[188:191] offset:52224
 ds_write_b128 v9, v[192:195] offset:49152
 ds_write_b128 v9, v[196:199] offset:50176
 ds_write_b128 v9, v[200:203] offset:51200
 ds_write_b128 v9, v[204:207] offset:52224
 s_waitcnt lgkmcnt(0)
 s_barrier
 ds_read_b128 v[160:163], v10 offset:49152
 ds_read_b128 v[164:167], v10 offset:50176
 ds_read_b128 v[168:171], v10 offset:51200
 ds_read_b128 v[172:175], v10 offset:52224
 ds_read_b128 v[176:179], v10 offset:53248
 ds_read_b128 v[180:183], v10 offset:54272
 ds_read_b128 v[184:187], v10 offset:55296
 ds_read_b128 v[188:191], v10 offset:56320
 ds_read_b128 v[192:195], v10 offset:57344
 ds_read_b128 v[196:199], v10 offset:58368
 ds_read_b128 v[200:203], v10 offset:59392
 ds_read_b128 v[204:207], v10 offset:60416
 s_waitcnt lgkmcnt(8)
 v_add_f32 v144, v144, v160
 v_add_f32 v145, v145, v161
 v_add_f32 v146, v146, v162
 v_add_f32 v147, v147, v163
 v_add_f32 v148, v148, v164
 v_add_f32 v149, v149, v165
 v_add_f32 v150, v150, v166
 v_add_f32 v151, v151, v167
 v_add_f32 v152, v152, v168
 v_add_f32 v153, v153, v169
 v_add_f32 v154, v154, v170
 v_add_f32 v155, v155, v171
 v_add_f32 v156, v156, v172
 v_add_f32 v157, v157, v173
 v_add_f32 v158, v158, v174
 v_add_f32 v159, v159, v175
 s_waitcnt lgkmcnt(4)
 v_add_f32 v144, v144, v176
 v_add_f32 v145, v145, v177
 v_add_f32 v146, v146, v178
 v_add_f32 v147, v147, v179
 v_add_f32 v148, v148, v180
 v_add_f32 v149, v149, v181
 v_add_f32 v150, v150, v182
 v_add_f32 v151, v151, v183
 v_add_f32 v152, v152, v184
 v_add_f32 v153, v153, v185
 v_add_f32 v154, v154, v186
 v_add_f32 v155, v155, v187
 v_add_f32 v156, v156, v188
 v_add_f32 v157, v157, v189
 v_add_f32 v158, v158, v190
 v_add_f32 v159, v159, v191
 s_waitcnt lgkmcnt(0)
 v_add_f32 v144, v144, v192
 v_add_f32 v145, v145, v193
 v_add_f32 v146, v146, v194
 v_add_f32 v147, v147, v195
 v_add_f32 v148, v148, v196
 v_add_f32 v149, v149, v197
 v_add_f32 v150, v150, v198
 v_add_f32 v151, v151, v199
 v_add_f32 v152, v152, v200
 v_add_f32 v153, v153, v201
 v_add_f32 v154, v154, v202
 v_add_f32 v155, v155, v203
 v_add_f32 v156, v156, v204
 v_add_f32 v157, v157, v205
 v_add_f32 v158, v158, v206
 v_add_f32 v159, v159, v207
 s_waitcnt vmcnt(0)
 v_bitop3_b32 v13, v216, v220, s79 bitop3:0x7e
 v_bitop3_b32 v13, v13, v224, s79 bitop3:0xf6
 v_and_b32 v13, 1, v13
 v_cmp_eq_u32 vcc, 1, v13
 s_cbranch_vccnz stale_67
fresh_68:
 s_sub_u32 s77, s63, 1
 s_and_b32 s78, s77, 3
 s_lshl_b32 s78, s78, 22
 s_add_u32 s78, s78, s76
 s_bfe_u32 s79, s77, 0x10002
 v_bfi_b32 v148, 1, s79, v148
 v_bfi_b32 v152, 1, s79, v152
 v_bfi_b32 v156, 1, s79, v156
 buffer_store_dwordx4 v[148:151], v244, s[48:51], s78 offen sc1
 buffer_store_dwordx4 v[152:155], v245, s[48:51], s78 offen sc1
 buffer_store_dwordx4 v[156:159], v246, s[48:51], s78 offen sc1
 s_sub_u32 s77, s63, 2
 s_and_b32 s78, s77, 3
 s_lshl_b32 s78, s78, 22
 s_add_u32 s78, s78, s76
 s_bfe_u32 s79, s77, 0x10002
 buffer_load_dwordx4 v[16:19], v247, s[48:51], s78 offen sc1
 buffer_load_dwordx4 v[20:23], v248, s[48:51], s78 offen sc1
 buffer_load_dwordx4 v[24:27], v249, s[48:51], s78 offen sc1
 s_sub_u32 s77, s63, 3
 s_and_b32 s78, s77, 3
 s_lshl_b32 s78, s78, 22
 s_add_u32 s78, s78, s76
 s_bfe_u32 s79, s77, 0x10002
 v_add_f32 v208, v208, v216
 v_add_f32 v209, v209, v217
 v_add_f32 v210, v210, v218
 v_add_f32 v211, v211, v219
 v_add_f32 v208, v208, v220
 v_add_f32 v209, v209, v221
 v_add_f32 v210, v210, v222
 v_add_f32 v211, v211, v223
 v_add_f32 v208, v208, v224
 v_add_f32 v209, v209, v225
 v_add_f32 v210, v210, v226
 v_add_f32 v211, v211, v227
 s_min_u32 s77, s77, 64
 s_lshl_b32 s69, s77, 17
 s_add_u32 s69, s69, s67
 v_cvt_pk_bf16_f32 v14, v208, v209
 v_cvt_pk_bf16_f32 v15, v210, v211
 buffer_store_dwordx2 v[14:15], v250, s[56:59], s69 offen
 s_sub_u32 s77, s63, 2
 s_and_b32 s78, s77, 3
 s_lshl_b32 s78, s78, 22
 s_add_u32 s78, s78, s76
 s_bfe_u32 s79, s77, 0x10002
 s_waitcnt vmcnt(1)
 v_bitop3_b32 v13, v16, v20, s79 bitop3:0x7e
 v_bitop3_b32 v13, v13, v24, s79 bitop3:0xf6
 v_and_b32 v13, 1, v13
 v_cmp_eq_u32 vcc, 1, v13
 s_cbranch_vccnz stale_69
fresh_70:
 s_sub_u32 s77, s63, 1
 s_and_b32 s78, s77, 3
 s_lshl_b32 s78, s78, 22
 s_add_u32 s78, s78, s76
 s_bfe_u32 s79, s77, 0x10002
 buffer_load_dwordx4 v[216:219], v247, s[48:51], s78 offen sc1
 buffer_load_dwordx4 v[220:223], v248, s[48:51], s78 offen sc1
 buffer_load_dwordx4 v[224:227], v249, s[48:51], s78 offen sc1
 s_sub_u32 s77, s63, 2
 s_and_b32 s78, s77, 3
 s_lshl_b32 s78, s78, 22
 s_add_u32 s78, s78, s76
 s_bfe_u32 s79, s77, 0x10002
 v_add_f32 v212, v212, v16
 v_add_f32 v213, v213, v17
 v_add_f32 v214, v214, v18
 v_add_f32 v215, v215, v19
 v_add_f32 v212, v212, v20
 v_add_f32 v213, v213, v21
 v_add_f32 v214, v214, v22
 v_add_f32 v215, v215, v23
 v_add_f32 v212, v212, v24
 v_add_f32 v213, v213, v25
 v_add_f32 v214, v214, v26
 v_add_f32 v215, v215, v27
 s_min_u32 s77, s77, 64
 s_lshl_b32 s69, s77, 17
 s_add_u32 s69, s69, s67
 v_cvt_pk_bf16_f32 v14, v212, v213
 v_cvt_pk_bf16_f32 v15, v214, v215
 buffer_store_dwordx2 v[14:15], v250, s[56:59], s69 offen
 s_sub_u32 s77, s63, 1
 s_and_b32 s78, s77, 3
 s_lshl_b32 s78, s78, 22
 s_add_u32 s78, s78, s76
 s_bfe_u32 s79, s77, 0x10002
 s_waitcnt vmcnt(1)
 v_bitop3_b32 v13, v216, v220, s79 bitop3:0x7e
 v_bitop3_b32 v13, v13, v224, s79 bitop3:0xf6
 v_and_b32 v13, 1, v13
 v_cmp_eq_u32 vcc, 1, v13
 s_cbranch_vccnz stale_71
fresh_72:
 v_add_f32 v144, v144, v216
 v_add_f32 v145, v145, v217
 v_add_f32 v146, v146, v218
 v_add_f32 v147, v147, v219
 v_add_f32 v144, v144, v220
 v_add_f32 v145, v145, v221
 v_add_f32 v146, v146, v222
 v_add_f32 v147, v147, v223
 v_add_f32 v144, v144, v224
 v_add_f32 v145, v145, v225
 v_add_f32 v146, v146, v226
 v_add_f32 v147, v147, v227
 s_min_u32 s77, s77, 64
 s_lshl_b32 s69, s77, 17
 s_add_u32 s69, s69, s67
 v_cvt_pk_bf16_f32 v14, v144, v145
 v_cvt_pk_bf16_f32 v15, v146, v147
 buffer_store_dwordx2 v[14:15], v250, s[56:59], s69 offen
 s_branch Lw_end
stale_46:
 s_cmp_lt_i32 s77, 0
 s_cbranch_scc1 fresh_47
 buffer_load_dwordx4 v[216:219], v247, s[48:51], s78 offen sc1
 buffer_load_dwordx4 v[220:223], v248, s[48:51], s78 offen sc1
 buffer_load_dwordx4 v[224:227], v249, s[48:51], s78 offen sc1
 s_waitcnt vmcnt(0)
 v_bitop3_b32 v13, v216, v220, s79 bitop3:0x7e
 v_bitop3_b32 v13, v13, v224, s79 bitop3:0xf6
 v_and_b32 v13, 1, v13
 v_cmp_eq_u32 vcc, 1, v13
 s_cbranch_vccz fresh_47
 s_sub_u32 s46, s46, 1
 s_cbranch_scc0 stale_46
 s_mov_b32 s46, 0
 s_branch fresh_47
stale_48:
 s_cmp_lt_i32 s77, 0
 s_cbranch_scc1 fresh_49
 buffer_load_dwordx4 v[216:219], v247, s[48:51], s78 offen sc1
 buffer_load_dwordx4 v[220:223], v248, s[48:51], s78 offen sc1
 buffer_load_dwordx4 v[224:227], v249, s[48:51], s78 offen sc1
 s_waitcnt vmcnt(0)
 v_bitop3_b32 v13, v216, v220, s79 bitop3:0x7e
 v_bitop3_b32 v13, v13, v224, s79 bitop3:0xf6
 v_and_b32 v13, 1, v13
 v_cmp_eq_u32 vcc, 1, v13
 s_cbranch_vccz fresh_49
 s_sub_u32 s46, s46, 1
 s_cbranch_scc0 stale_48
 s_mov_b32 s46, 0
 s_branch fresh_49
stale_51:
 s_cmp_lt_i32 s77, 0
 s_cbranch_scc1 fresh_52
 buffer_load_dwordx4 v[216:219], v247, s[48:51], s78 offen sc1
 buffer_load_dwordx4 v[220:223], v248, s[48:51], s78 offen sc1
 buffer_load_dwordx4 v[224:227], v249, s[48:51], s78 offen sc1
 s_waitcnt vmcnt(0)
 v_bitop3_b32 v13, v216, v220, s79 bitop3:0x7e
 v_bitop3_b32 v13, v13, v224, s79 bitop3:0xf6
 v_and_b32 v13, 1, v13
 v_cmp_eq_u32 vcc, 1, v13
 s_cbranch_vccz fresh_52
 s_sub_u32 s46, s46, 1
 s_cbranch_scc0 stale_51
 s_mov_b32 s46, 0
 s_branch fresh_52
stale_53:
 s_cmp_lt_i32 s77, 0
 s_cbranch_scc1 fresh_54
 buffer_load_dwordx4 v[216:219], v247, s[48:51], s78 offen sc1
 buffer_load_dwordx4 v[220:223], v248, s[48:51], s78 offen sc1
 buffer_load_dwordx4 v[224:227], v249, s[48:51], s78 offen sc1
 s_waitcnt vmcnt(0)
 v_bitop3_b32 v13, v216, v220, s79 bitop3:0x7e
 v_bitop3_b32 v13, v13, v224, s79 bitop3:0xf6
 v_and_b32 v13, 1, v13
 v_cmp_eq_u32 vcc, 1, v13
 s_cbranch_vccz fresh_54
 s_sub_u32 s46, s46, 1
 s_cbranch_scc0 stale_53
 s_mov_b32 s46, 0
 s_branch fresh_54
stale_58:
 s_cmp_lt_i32 s77, 0
 s_cbranch_scc1 fresh_59
 buffer_load_dwordx4 v[216:219], v247, s[48:51], s78 offen sc1
 buffer_load_dwordx4 v[220:223], v248, s[48:51], s78 offen sc1
 buffer_load_dwordx4 v[224:227], v249, s[48:51], s78 offen sc1
 s_waitcnt vmcnt(0)
 v_bitop3_b32 v13, v216, v220, s79 bitop3:0x7e
 v_bitop3_b32 v13, v13, v224, s79 bitop3:0xf6
 v_and_b32 v13, 1, v13
 v_cmp_eq_u32 vcc, 1, v13
 s_cbranch_vccz fresh_59
 s_sub_u32 s46, s46, 1
 s_cbranch_scc0 stale_58
 s_mov_b32 s46, 0
 s_branch fresh_59
stale_60:
 s_cmp_lt_i32 s77, 0
 s_cbranch_scc1 fresh_61
 buffer_load_dwordx4 v[216:219], v247, s[48:51], s78 offen sc1
 buffer_load_dwordx4 v[220:223], v248, s[48:51], s78 offen sc1
 buffer_load_dwordx4 v[224:227], v249, s[48:51], s78 offen sc1
 s_waitcnt vmcnt(0)
 v_bitop3_b32 v13, v216, v220, s79 bitop3:0x7e
 v_bitop3_b32 v13, v13, v224, s79 bitop3:0xf6
 v_and_b32 v13, 1, v13
 v_cmp_eq_u32 vcc, 1, v13
 s_cbranch_vccz fresh_61
 s_sub_u32 s46, s46, 1
 s_cbranch_scc0 stale_60
 s_mov_b32 s46, 0
 s_branch fresh_61
stale_63:
 s_cmp_lt_i32 s77, 0
 s_cbranch_scc1 fresh_64
 buffer_load_dwordx4 v[216:219], v247, s[48:51], s78 offen sc1
 buffer_load_dwordx4 v[220:223], v248, s[48:51], s78 offen sc1
 buffer_load_dwordx4 v[224:227], v249, s[48:51], s78 offen sc1
 s_waitcnt vmcnt(0)
 v_bitop3_b32 v13, v216, v220, s79 bitop3:0x7e
 v_bitop3_b32 v13, v13, v224, s79 bitop3:0xf6
 v_and_b32 v13, 1, v13
 v_cmp_eq_u32 vcc, 1, v13
 s_cbranch_vccz fresh_64
 s_sub_u32 s46, s46, 1
 s_cbranch_scc0 stale_63
 s_mov_b32 s46, 0
 s_branch fresh_64
stale_65:
 s_cmp_lt_i32 s77, 0
 s_cbranch_scc1 fresh_66
 buffer_load_dwordx4 v[216:219], v247, s[48:51], s78 offen sc1
 buffer_load_dwordx4 v[220:223], v248, s[48:51], s78 offen sc1
 buffer_load_dwordx4 v[224:227], v249, s[48:51], s78 offen sc1
 s_waitcnt vmcnt(0)
 v_bitop3_b32 v13, v216, v220, s79 bitop3:0x7e
 v_bitop3_b32 v13, v13, v224, s79 bitop3:0xf6
 v_and_b32 v13, 1, v13
 v_cmp_eq_u32 vcc, 1, v13
 s_cbranch_vccz fresh_66
 s_sub_u32 s46, s46, 1
 s_cbranch_scc0 stale_65
 s_mov_b32 s46, 0
 s_branch fresh_66
stale_67:
 s_cmp_lt_i32 s77, 0
 s_cbranch_scc1 fresh_68
 buffer_load_dwordx4 v[216:219], v247, s[48:51], s78 offen sc1
 buffer_load_dwordx4 v[220:223], v248, s[48:51], s78 offen sc1
 buffer_load_dwordx4 v[224:227], v249, s[48:51], s78 offen sc1
 s_waitcnt vmcnt(0)
 v_bitop3_b32 v13, v216, v220, s79 bitop3:0x7e
 v_bitop3_b32 v13, v13, v224, s79 bitop3:0xf6
 v_and_b32 v13, 1, v13
 v_cmp_eq_u32 vcc, 1, v13
 s_cbranch_vccz fresh_68
 s_sub_u32 s46, s46, 1
 s_cbranch_scc0 stale_67
 s_mov_b32 s46, 0
 s_branch fresh_68
stale_69:
 s_cmp_lt_i32 s77, 0
 s_cbranch_scc1 fresh_70
 buffer_load_dwordx4 v[16:19], v247, s[48:51], s78 offen sc1
 buffer_load_dwordx4 v[20:23], v248, s[48:51], s78 offen sc1
 buffer_load_dwordx4 v[24:27], v249, s[48:51], s78 offen sc1
 s_waitcnt vmcnt(0)
 v_bitop3_b32 v13, v16, v20, s79 bitop3:0x7e
 v_bitop3_b32 v13, v13, v24, s79 bitop3:0xf6
 v_and_b32 v13, 1, v13
 v_cmp_eq_u32 vcc, 1, v13
 s_cbranch_vccz fresh_70
 s_sub_u32 s46, s46, 1
 s_cbranch_scc0 stale_69
 s_mov_b32 s46, 0
 s_branch fresh_70
stale_71:
 s_cmp_lt_i32 s77, 0
 s_cbranch_scc1 fresh_72
 buffer_load_dwordx4 v[216:219], v247, s[48:51], s78 offen sc1
 buffer_load_dwordx4 v[220:223], v248, s[48:51], s78 offen sc1
 buffer_load_dwordx4 v[224:227], v249, s[48:51], s78 offen sc1
 s_waitcnt vmcnt(0)
 v_bitop3_b32 v13, v216, v220, s79 bitop3:0x7e
 v_bitop3_b32 v13, v13, v224, s79 bitop3:0xf6
 v_and_b32 v13, 1, v13
 v_cmp_eq_u32 vcc, 1, v13
 s_cbranch_vccz fresh_72
 s_sub_u32 s46, s46, 1
 s_cbranch_scc0 stale_71
 s_mov_b32 s46, 0
 s_branch fresh_72
Lw_Q:
 s_lshl_b32 s69, s4, 11
 s_add_u32 s69, s69, 49152
 v_add_u32 v235, s69, v6
 v_add_u32 v236, 32768, v235
 s_lshl_b32 s69, s4, 13
 s_add_u32 s69, s69, 81920
 v_add_u32 v237, s69, v1
 v_add_u32 v238, 32768, v237
 v_lshrrev_b32 v3, 5, v0
 v_and_b32 v4, 7, v0
 v_lshlrev_b32 v4, 4, v4
 v_lshl_add_u32 v232, v3, 8, v4
 s_lshl_b32 s69, s4, 12
 s_add_u32 s69, s69, 147456
 v_add_u32 v5, s69, v1
 v_add_u32 v232, 128, v232
 v_add_u32 v232, s69, v232
 v_lshl_add_u32 v233, v3, 9, v4
 v_add_u32 v233, s69, v233
 v_bfe_u32 v4, v0, 3, 2
 v_lshl_add_u32 v233, v4, 2, v233
 v_bfe_u32 v4, v0, 1, 2
 v_and_b32 v234, 1, v0
 v_lshlrev_b32 v234, 2, v234
 v_lshl_add_u32 v234, v4, 4, v234
 v_and_b32 v4, 31, v0
 v_lshlrev_b32 v3, 2, v3
 v_sub_u32 v4, v4, v3
 s_add_u32 s82, s65, 0
 buffer_load_dwordx4 v[16:19], v2, s[48:51], s82 offen offset:0 sc1
 buffer_load_dwordx4 v[20:23], v2, s[48:51], s82 offen offset:256 sc1
 buffer_load_dwordx4 v[24:27], v2, s[48:51], s82 offen offset:2048 sc1
 buffer_load_dwordx4 v[28:31], v2, s[48:51], s82 offen offset:2304 sc1
 s_add_u32 s82, s65, 4096
 buffer_load_dwordx4 v[32:35], v2, s[48:51], s82 offen offset:0 sc1
 buffer_load_dwordx4 v[36:39], v2, s[48:51], s82 offen offset:256 sc1
 buffer_load_dwordx4 v[40:43], v2, s[48:51], s82 offen offset:2048 sc1
 buffer_load_dwordx4 v[44:47], v2, s[48:51], s82 offen offset:2304 sc1
 s_add_u32 s82, s65, 8192
 buffer_load_dwordx4 v[48:51], v2, s[48:51], s82 offen offset:0 sc1
 buffer_load_dwordx4 v[52:55], v2, s[48:51], s82 offen offset:256 sc1
 buffer_load_dwordx4 v[56:59], v2, s[48:51], s82 offen offset:2048 sc1
 buffer_load_dwordx4 v[60:63], v2, s[48:51], s82 offen offset:2304 sc1
 s_add_u32 s82, s65, 12288
 buffer_load_dwordx4 v[64:67], v2, s[48:51], s82 offen offset:0 sc1
 buffer_load_dwordx4 v[68:71], v2, s[48:51], s82 offen offset:256 sc1
 buffer_load_dwordx4 v[72:75], v2, s[48:51], s82 offen offset:2048 sc1
 buffer_load_dwordx4 v[76:79], v2, s[48:51], s82 offen offset:2304 sc1
 v_cmp_le_i32 s[8:9], 0, v4
 v_cmp_le_i32 s[10:11], 1, v4
 v_cmp_le_i32 s[12:13], 2, v4
 v_cmp_le_i32 s[14:15], 3, v4
 v_cmp_le_i32 s[16:17], 8, v4
 v_cmp_le_i32 s[18:19], 9, v4
 v_cmp_le_i32 s[20:21], 10, v4
 v_cmp_le_i32 s[22:23], 11, v4
 v_cmp_le_i32 s[24:25], 16, v4
 v_cmp_le_i32 s[26:27], 17, v4
 v_cmp_le_i32 s[28:29], 18, v4
 v_cmp_le_i32 s[30:31], 19, v4
 v_cmp_le_i32 s[32:33], 24, v4
 v_cmp_le_i32 s[34:35], 25, v4
 v_cmp_le_i32 s[36:37], 26, v4
 v_cmp_le_i32 s[38:39], 27, v4
 s_add_u32 s65, s65, 0x10000
 s_lshl_b32 s77, s62, 7
 s_add_u32 s77, s77, 3145728
 s_sub_u32 s74, s4, 8
 s_lshl_b32 s80, s4, 13
 s_add_u32 s80, s80, 114688
 s_mov_b32 s72, -1
 s_mov_b32 s73, 32768
 s_mov_b32 s76, 269484032
 s_mov_b32 s66, 269484032
 s_waitcnt vmcnt(0)
Lw_Qloop:
 s_cmp_eq_u32 s72, 15
 s_cbranch_scc0 Lw_Qproj
 s_add_u32 s74, s74, 4
 s_add_u32 s75, s74, 1
 s_lshl_b32 s67, s74, 18
 s_and_b32 s69, s74, 8
 s_lshl_b32 s69, s69, 10
 s_xor_b32 s78, s66, s69
 s_add_u32 s78, s78, s67
 s_add_u32 s67, s67, s76
 s_cmp_eq_u32 s72, 14
 s_cselect_b32 s75, 64, s75
 s_waitcnt vmcnt(0)
 v_mov_b32 v3, s72
 buffer_store_dword v3, v251, s[48:51], s68 offen
 s_add_u32 s82, s67, 16777216
 buffer_load_dwordx4 v[16:19], v1, s[48:51], s82 offen offset:0 sc1
 buffer_load_dwordx4 v[20:23], v1, s[48:51], s82 offen offset:1024 sc1
 buffer_load_dwordx4 v[24:27], v1, s[48:51], s82 offen offset:2048 sc1
 buffer_load_dwordx4 v[28:31], v1, s[48:51], s82 offen offset:3072 sc1
 s_add_u32 s82, s67, 16781312
 buffer_load_dwordx4 v[32:35], v1, s[48:51], s82 offen offset:0 sc1
 buffer_load_dwordx4 v[36:39], v1, s[48:51], s82 offen offset:1024 sc1
 buffer_load_dwordx4 v[40:43], v1, s[48:51], s82 offen offset:2048 sc1
 buffer_load_dwordx4 v[44:47], v1, s[48:51], s82 offen offset:3072 sc1
 s_add_u32 s71, s67, 33554432
 s_add_u32 m0, s80, 0
 s_nop 0
 buffer_load_dwordx4 v1, s[48:51], s71 offen offset:0 sc1 lds
 s_add_u32 s71, s67, 33554432
 s_add_u32 m0, s80, 0
 s_nop 0
 buffer_load_dwordx4 v1, s[48:51], s71 offen offset:1024 sc1 lds
 s_add_u32 s71, s67, 33554432
 s_add_u32 m0, s80, 0
 s_nop 0
 buffer_load_dwordx4 v1, s[48:51], s71 offen offset:2048 sc1 lds
 s_add_u32 s71, s67, 33554432
 s_add_u32 m0, s80, 0
 s_nop 0
 buffer_load_dwordx4 v1, s[48:51], s71 offen offset:3072 sc1 lds
 s_add_u32 s71, s67, 33558528
 s_add_u32 m0, s80, 4096
 s_nop 0
 buffer_load_dwordx4 v1, s[48:51], s71 offen offset:0 sc1 lds
 s_add_u32 s71, s67, 33558528
 s_add_u32 m0, s80, 4096
 s_nop 0
 buffer_load_dwordx4 v1, s[48:51], s71 offen offset:1024 sc1 lds
 s_add_u32 s71, s67, 33558528
 s_add_u32 m0, s80, 4096
 s_nop 0
 buffer_load_dwordx4 v1, s[48:51], s71 offen offset:2048 sc1 lds
 s_add_u32 s71, s67, 33558528
 s_add_u32 m0, s80, 4096
 s_nop 0
 buffer_load_dwordx4 v1, s[48:51], s71 offen offset:3072 sc1 lds
 ds_write_b128 v7, v[160:163] offset:0
 ds_write_b128 v7, v[164:167] offset:1024
 ds_write_b128 v7, v[168:171] offset:2048
 ds_write_b128 v7, v[172:175] offset:3072
 ds_write_b128 v8, v[176:179] offset:0
 ds_write_b128 v8, v[180:183] offset:1024
 ds_write_b128 v8, v[184:187] offset:2048
 ds_write_b128 v8, v[188:191] offset:3072
 ds_write_b128 v9, v[192:195] offset:0
 ds_write_b128 v9, v[196:199] offset:1024
 ds_write_b128 v9, v[200:203] offset:2048
 ds_write_b128 v9, v[204:207] offset:3072
 s_waitcnt lgkmcnt(0)
 s_barrier
 ds_read_b128 v[160:163], v10 offset:0
 ds_read_b128 v[164:167], v10 offset:1024
 ds_read_b128 v[168:171], v10 offset:2048
 ds_read_b128 v[172:175], v10 offset:3072
 ds_read_b128 v[176:179], v10 offset:4096
 ds_read_b128 v[180:183], v10 offset:5120
 ds_read_b128 v[184:187], v10 offset:6144
 ds_read_b128 v[188:191], v10 offset:7168
 ds_read_b128 v[192:195], v10 offset:8192
 ds_read_b128 v[196:199], v10 offset:9216
 ds_read_b128 v[200:203], v10 offset:10240
 ds_read_b128 v[204:207], v10 offset:11264
 s_waitcnt lgkmcnt(8)
 v_add_f32 v144, v144, v160
 v_add_f32 v145, v145, v161
 v_add_f32 v146, v146, v162
 v_add_f32 v147, v147, v163
 v_add_f32 v148, v148, v164
 v_add_f32 v149, v149, v165
 v_add_f32 v150, v150, v166
 v_add_f32 v151, v151, v167
 v_add_f32 v152, v152, v168
 v_add_f32 v153, v153, v169
 v_add_f32 v154, v154, v170
 v_add_f32 v155, v155, v171
 v_add_f32 v156, v156, v172
 v_add_f32 v157, v157, v173
 v_add_f32 v158, v158, v174
 v_add_f32 v159, v159, v175
 s_waitcnt lgkmcnt(4)
 v_add_f32 v144, v144, v176
 v_add_f32 v145, v145, v177
 v_add_f32 v146, v146, v178
 v_add_f32 v147, v147, v179
 v_add_f32 v148, v148, v180
 v_add_f32 v149, v149, v181
 v_add_f32 v150, v150, v182
 v_add_f32 v151, v151, v183
 v_add_f32 v152, v152, v184
 v_add_f32 v153, v153, v185
 v_add_f32 v154, v154, v186
 v_add_f32 v155, v155, v187
 v_add_f32 v156, v156, v188
 v_add_f32 v157, v157, v189
 v_add_f32 v158, v158, v190
 v_add_f32 v159, v159, v191
 s_waitcnt lgkmcnt(0)
 s_barrier
 v_add_f32 v144, v144, v192
 v_add_f32 v145, v145, v193
 v_add_f32 v146, v146, v194
 v_add_f32 v147, v147, v195
 v_add_f32 v148, v148, v196
 v_add_f32 v149, v149, v197
 v_add_f32 v150, v150, v198
 v_add_f32 v151, v151, v199
 v_add_f32 v152, v152, v200
 v_add_f32 v153, v153, v201
 v_add_f32 v154, v154, v202
 v_add_f32 v155, v155, v203
 v_add_f32 v156, v156, v204
 v_add_f32 v157, v157, v205
 v_add_f32 v158, v158, v206
 v_add_f32 v159, v159, v207
 v_mul_f32 v144, 0x3e0293ee, v144
 v_mul_f32 v145, 0x3e0293ee, v145
 v_cvt_pk_bf16_f32 v224, v144, v145
 v_mul_f32 v146, 0x3e0293ee, v146
 v_mul_f32 v147, 0x3e0293ee, v147
 v_cvt_pk_bf16_f32 v225, v146, v147
 v_mul_f32 v148, 0x3e0293ee, v148
 v_mul_f32 v149, 0x3e0293ee, v149
 v_cvt_pk_bf16_f32 v226, v148, v149
 v_mul_f32 v150, 0x3e0293ee, v150
 v_mul_f32 v151, 0x3e0293ee, v151
 v_cvt_pk_bf16_f32 v227, v150, v151
 ds_write_b128 v236, v[224:227] offset:24576
 v_mul_f32 v152, 0x3e0293ee, v152
 v_mul_f32 v153, 0x3e0293ee, v153
 v_cvt_pk_bf16_f32 v228, v152, v153
 v_mul_f32 v154, 0x3e0293ee, v154
 v_mul_f32 v155, 0x3e0293ee, v155
 v_cvt_pk_bf16_f32 v229, v154, v155
 v_mul_f32 v156, 0x3e0293ee, v156
 v_mul_f32 v157, 0x3e0293ee, v157
 v_cvt_pk_bf16_f32 v230, v156, v157
 v_mul_f32 v158, 0x3e0293ee, v158
 v_mul_f32 v159, 0x3e0293ee, v159
 v_cvt_pk_bf16_f32 v231, v158, v159
 ds_write_b128 v236, v[228:231] offset:24832
 s_mov_b32 s79, -1
 s_waitcnt lgkmcnt(0)
 s_barrier
 ds_read_b128 v[48:51], v237 offset:0
 ds_read_b128 v[52:55], v237 offset:1024
 ds_read_b128 v[56:59], v237 offset:2048
 ds_read_b128 v[60:63], v237 offset:3072
 ds_read_b128 v[64:67], v237 offset:4096
 ds_read_b128 v[68:71], v237 offset:5120
 s_branch Lw_Qatt
Lw_Qkvwait:
 s_cmp_eq_u32 s72, -1
 s_cbranch_scc1 Lw_Qkvok
w_73:
 buffer_load_dword v4, v234, s[48:51], s77 offen sc1
 s_waitcnt vmcnt(0)
 v_cmp_gt_u32 vcc, s75, v4
 s_cbranch_vccz wok_74
 s_sleep 1
 s_sub_u32 s46, s46, 1
 s_cbranch_scc0 w_73
 s_mov_b32 s46, 0
 s_branch wok_74
wok_74:
 s_branch Lw_Qkvok
Lw_Qproj:
 s_waitcnt vmcnt(10)
 v_mfma_f32_16x16x32_bf16 v[80:83], a[0:3], v[16:19], 0
 s_sub_u32 s79, s65, 61440
 buffer_load_dwordx4 v[32:35], v2, s[48:51], s79 offen offset:0 sc1
 v_mfma_f32_16x16x32_bf16 v[84:87], a[4:7], v[16:19], 0
 ds_write_b128 v7, v[160:163] offset:0
 v_mfma_f32_16x16x32_bf16 v[92:95], a[4:7], v[20:23], 0
 buffer_load_dwordx4 v[36:39], v2, s[48:51], s79 offen offset:256 sc1
 v_mfma_f32_16x16x32_bf16 v[88:91], a[0:3], v[20:23], 0
 v_mfma_f32_16x16x32_bf16 v[96:99], a[8:11], v[16:19], 0
 buffer_load_dwordx4 v[40:43], v2, s[48:51], s79 offen offset:2048 sc1
 v_mfma_f32_16x16x32_bf16 v[100:103], a[12:15], v[16:19], 0
 ds_write_b128 v7, v[164:167] offset:1024
 v_mfma_f32_16x16x32_bf16 v[108:111], a[12:15], v[20:23], 0
 buffer_load_dwordx4 v[44:47], v2, s[48:51], s79 offen offset:2304 sc1
 v_mfma_f32_16x16x32_bf16 v[104:107], a[8:11], v[20:23], 0
 v_mfma_f32_16x16x32_bf16 v[112:115], a[16:19], v[16:19], 0
 s_sub_u32 s79, s65, 57344
 buffer_load_dwordx4 v[48:51], v2, s[48:51], s79 offen offset:0 sc1
 v_mfma_f32_16x16x32_bf16 v[116:119], a[20:23], v[16:19], 0
 ds_write_b128 v7, v[168:171] offset:2048
 v_mfma_f32_16x16x32_bf16 v[124:127], a[20:23], v[20:23], 0
 buffer_load_dwordx4 v[52:55], v2, s[48:51], s79 offen offset:256 sc1
 v_mfma_f32_16x16x32_bf16 v[120:123], a[16:19], v[20:23], 0
 v_mfma_f32_16x16x32_bf16 v[128:131], a[24:27], v[16:19], 0
 buffer_load_dwordx4 v[56:59], v2, s[48:51], s79 offen offset:2048 sc1
 v_mfma_f32_16x16x32_bf16 v[132:135], a[28:31], v[16:19], 0
 ds_write_b128 v7, v[172:175] offset:3072
 v_mfma_f32_16x16x32_bf16 v[140:143], a[28:31], v[20:23], 0
 buffer_load_dwordx4 v[60:63], v2, s[48:51], s79 offen offset:2304 sc1
 v_mfma_f32_16x16x32_bf16 v[136:139], a[24:27], v[20:23], 0
 s_waitcnt vmcnt(16)
 v_mfma_f32_16x16x32_bf16 v[80:83], a[32:35], v[24:27], v[80:83]
 s_add_u32 s82, s65, 0
 buffer_load_dwordx4 v[16:19], v2, s[48:51], s82 offen offset:0 sc1
 v_mfma_f32_16x16x32_bf16 v[84:87], a[36:39], v[24:27], v[84:87]
 ds_write_b128 v8, v[176:179] offset:0
 v_mfma_f32_16x16x32_bf16 v[92:95], a[36:39], v[28:31], v[92:95]
 buffer_load_dwordx4 v[20:23], v2, s[48:51], s82 offen offset:256 sc1
 v_mfma_f32_16x16x32_bf16 v[88:91], a[32:35], v[28:31], v[88:91]
 v_mfma_f32_16x16x32_bf16 v[96:99], a[40:43], v[24:27], v[96:99]
 s_sub_u32 s79, s65, 53248
 buffer_load_dwordx4 v[64:67], v2, s[48:51], s79 offen offset:0 sc1
 v_mfma_f32_16x16x32_bf16 v[100:103], a[44:47], v[24:27], v[100:103]
 ds_write_b128 v8, v[180:183] offset:1024
 v_mfma_f32_16x16x32_bf16 v[108:111], a[44:47], v[28:31], v[108:111]
 buffer_load_dwordx4 v[68:71], v2, s[48:51], s79 offen offset:256 sc1
 v_mfma_f32_16x16x32_bf16 v[104:107], a[40:43], v[28:31], v[104:107]
 s_waitcnt vmcnt(12)
 s_max_i32 s71, s72, 0
 v_mfma_f32_16x16x32_bf16 v[112:115], a[48:51], v[24:27], v[112:115]
 buffer_load_dwordx4 v[72:75], v2, s[48:51], s79 offen offset:2048 sc1
 v_mfma_f32_16x16x32_bf16 v[116:119], a[52:55], v[24:27], v[116:119]
 ds_write_b128 v8, v[184:187] offset:2048
 v_mfma_f32_16x16x32_bf16 v[124:127], a[52:55], v[28:31], v[124:127]
 buffer_load_dwordx4 v[76:79], v2, s[48:51], s79 offen offset:2304 sc1
 v_mfma_f32_16x16x32_bf16 v[120:123], a[48:51], v[28:31], v[120:123]
 v_mov_b32 v3, s71
 v_mfma_f32_16x16x32_bf16 v[128:131], a[56:59], v[24:27], v[128:131]
 ds_write_b128 v8, v[188:191] offset:3072
 v_mfma_f32_16x16x32_bf16 v[132:135], a[60:63], v[24:27], v[132:135]
 buffer_store_dword v3, v251, s[48:51], s68 offen
 v_mfma_f32_16x16x32_bf16 v[140:143], a[60:63], v[28:31], v[140:143]
 v_mfma_f32_16x16x32_bf16 v[136:139], a[56:59], v[28:31], v[136:139]
 ds_write_b128 v9, v[192:195] offset:0
 s_waitcnt vmcnt(13)
 v_mfma_f32_16x16x32_bf16 v[80:83], a[64:67], v[32:35], v[80:83]
 buffer_load_dwordx4 v[24:27], v2, s[48:51], s82 offen offset:2048 sc1
 v_mfma_f32_16x16x32_bf16 v[84:87], a[68:71], v[32:35], v[84:87]
 v_mfma_f32_16x16x32_bf16 v[92:95], a[68:71], v[36:39], v[92:95]
 buffer_load_dwordx4 v[28:31], v2, s[48:51], s82 offen offset:2304 sc1
 v_mfma_f32_16x16x32_bf16 v[88:91], a[64:67], v[36:39], v[88:91]
 ds_write_b128 v9, v[196:199] offset:1024
 v_mfma_f32_16x16x32_bf16 v[96:99], a[72:75], v[32:35], v[96:99]
 v_mfma_f32_16x16x32_bf16 v[100:103], a[76:79], v[32:35], v[100:103]
 v_mfma_f32_16x16x32_bf16 v[108:111], a[76:79], v[36:39], v[108:111]
 ds_write_b128 v9, v[200:203] offset:2048
 v_mfma_f32_16x16x32_bf16 v[104:107], a[72:75], v[36:39], v[104:107]
 v_mfma_f32_16x16x32_bf16 v[112:115], a[80:83], v[32:35], v[112:115]
 v_mfma_f32_16x16x32_bf16 v[116:119], a[84:87], v[32:35], v[116:119]
 ds_write_b128 v9, v[204:207] offset:3072
 v_mfma_f32_16x16x32_bf16 v[124:127], a[84:87], v[36:39], v[124:127]
 v_mfma_f32_16x16x32_bf16 v[120:123], a[80:83], v[36:39], v[120:123]
 v_mfma_f32_16x16x32_bf16 v[128:131], a[88:91], v[32:35], v[128:131]
 s_waitcnt lgkmcnt(0)
 s_barrier
 v_mfma_f32_16x16x32_bf16 v[132:135], a[92:95], v[32:35], v[132:135]
 ds_read_b128 v[160:163], v10 offset:0
 v_mfma_f32_16x16x32_bf16 v[140:143], a[92:95], v[36:39], v[140:143]
 ds_read_b128 v[164:167], v10 offset:1024
 v_mfma_f32_16x16x32_bf16 v[136:139], a[88:91], v[36:39], v[136:139]
 ds_read_b128 v[168:171], v10 offset:2048
 s_waitcnt vmcnt(13)
 v_mfma_f32_16x16x32_bf16 v[80:83], a[96:99], v[40:43], v[80:83]
 s_add_u32 s82, s65, 4096
 buffer_load_dwordx4 v[32:35], v2, s[48:51], s82 offen offset:0 sc1
 v_mfma_f32_16x16x32_bf16 v[84:87], a[100:103], v[40:43], v[84:87]
 ds_read_b128 v[172:175], v10 offset:3072
 v_mfma_f32_16x16x32_bf16 v[92:95], a[100:103], v[44:47], v[92:95]
 buffer_load_dwordx4 v[36:39], v2, s[48:51], s82 offen offset:256 sc1
 v_mfma_f32_16x16x32_bf16 v[88:91], a[96:99], v[44:47], v[88:91]
 ds_read_b128 v[176:179], v10 offset:4096
 v_mfma_f32_16x16x32_bf16 v[96:99], a[104:107], v[40:43], v[96:99]
 ds_read_b128 v[180:183], v10 offset:5120
 v_mfma_f32_16x16x32_bf16 v[100:103], a[108:111], v[40:43], v[100:103]
 ds_read_b128 v[184:187], v10 offset:6144
 v_mfma_f32_16x16x32_bf16 v[108:111], a[108:111], v[44:47], v[108:111]
 ds_read_b128 v[188:191], v10 offset:7168
 v_mfma_f32_16x16x32_bf16 v[104:107], a[104:107], v[44:47], v[104:107]
 ds_read_b128 v[192:195], v10 offset:8192
 v_mfma_f32_16x16x32_bf16 v[112:115], a[112:115], v[40:43], v[112:115]
 ds_read_b128 v[196:199], v10 offset:9216
 v_mfma_f32_16x16x32_bf16 v[116:119], a[116:119], v[40:43], v[116:119]
 ds_read_b128 v[200:203], v10 offset:10240
 v_mfma_f32_16x16x32_bf16 v[124:127], a[116:119], v[44:47], v[124:127]
 ds_read_b128 v[204:207], v10 offset:11264
 v_mfma_f32_16x16x32_bf16 v[120:123], a[112:115], v[44:47], v[120:123]
 s_waitcnt lgkmcnt(8)
 v_add_f32 v144, v144, v160
 v_mfma_f32_16x16x32_bf16 v[128:131], a[120:123], v[40:43], v[128:131]
 v_add_f32 v145, v145, v161
 v_add_f32 v146, v146, v162
 v_mfma_f32_16x16x32_bf16 v[132:135], a[124:127], v[40:43], v[132:135]
 v_add_f32 v147, v147, v163
 v_add_f32 v148, v148, v164
 v_mfma_f32_16x16x32_bf16 v[140:143], a[124:127], v[44:47], v[140:143]
 v_add_f32 v149, v149, v165
 v_add_f32 v150, v150, v166
 v_mfma_f32_16x16x32_bf16 v[136:139], a[120:123], v[44:47], v[136:139]
 v_add_f32 v151, v151, v167
 s_waitcnt vmcnt(13)
 v_mfma_f32_16x16x32_bf16 v[80:83], a[128:131], v[48:51], v[80:83]
 buffer_load_dwordx4 v[40:43], v2, s[48:51], s82 offen offset:2048 sc1
 v_mfma_f32_16x16x32_bf16 v[84:87], a[132:135], v[48:51], v[84:87]
 v_add_f32 v152, v152, v168
 v_add_f32 v153, v153, v169
 v_mfma_f32_16x16x32_bf16 v[92:95], a[132:135], v[52:55], v[92:95]
 buffer_load_dwordx4 v[44:47], v2, s[48:51], s82 offen offset:2304 sc1
 v_mfma_f32_16x16x32_bf16 v[88:91], a[128:131], v[52:55], v[88:91]
 v_add_f32 v154, v154, v170
 v_add_f32 v155, v155, v171
 v_mfma_f32_16x16x32_bf16 v[96:99], a[136:139], v[48:51], v[96:99]
 v_add_f32 v156, v156, v172
 v_add_f32 v157, v157, v173
 v_mfma_f32_16x16x32_bf16 v[100:103], a[140:143], v[48:51], v[100:103]
 v_add_f32 v158, v158, v174
 v_add_f32 v159, v159, v175
 v_mfma_f32_16x16x32_bf16 v[108:111], a[140:143], v[52:55], v[108:111]
 s_waitcnt lgkmcnt(4)
 v_add_f32 v144, v144, v176
 v_mfma_f32_16x16x32_bf16 v[104:107], a[136:139], v[52:55], v[104:107]
 v_add_f32 v145, v145, v177
 v_add_f32 v146, v146, v178
 v_mfma_f32_16x16x32_bf16 v[112:115], a[144:147], v[48:51], v[112:115]
 v_add_f32 v147, v147, v179
 v_add_f32 v148, v148, v180
 v_mfma_f32_16x16x32_bf16 v[116:119], a[148:151], v[48:51], v[116:119]
 v_add_f32 v149, v149, v181
 v_add_f32 v150, v150, v182
 v_mfma_f32_16x16x32_bf16 v[124:127], a[148:151], v[52:55], v[124:127]
 v_add_f32 v151, v151, v183
 v_add_f32 v152, v152, v184
 v_mfma_f32_16x16x32_bf16 v[120:123], a[144:147], v[52:55], v[120:123]
 v_add_f32 v153, v153, v185
 v_add_f32 v154, v154, v186
 v_mfma_f32_16x16x32_bf16 v[128:131], a[152:155], v[48:51], v[128:131]
 v_add_f32 v155, v155, v187
 v_add_f32 v156, v156, v188
 v_mfma_f32_16x16x32_bf16 v[132:135], a[156:159], v[48:51], v[132:135]
 v_add_f32 v157, v157, v189
 v_add_f32 v158, v158, v190
 v_mfma_f32_16x16x32_bf16 v[140:143], a[156:159], v[52:55], v[140:143]
 v_add_f32 v159, v159, v191
 s_waitcnt lgkmcnt(0)
 v_mfma_f32_16x16x32_bf16 v[136:139], a[152:155], v[52:55], v[136:139]
 s_barrier
 s_waitcnt vmcnt(13)
 v_mfma_f32_16x16x32_bf16 v[80:83], a[160:163], v[56:59], v[80:83]
 s_add_u32 s82, s65, 8192
 buffer_load_dwordx4 v[48:51], v2, s[48:51], s82 offen offset:0 sc1
 v_mfma_f32_16x16x32_bf16 v[84:87], a[164:167], v[56:59], v[84:87]
 v_add_f32 v144, v144, v192
 v_add_f32 v145, v145, v193
 v_mfma_f32_16x16x32_bf16 v[92:95], a[164:167], v[60:63], v[92:95]
 buffer_load_dwordx4 v[52:55], v2, s[48:51], s82 offen offset:256 sc1
 v_mfma_f32_16x16x32_bf16 v[88:91], a[160:163], v[60:63], v[88:91]
 v_add_f32 v146, v146, v194
 v_add_f32 v147, v147, v195
 v_mfma_f32_16x16x32_bf16 v[96:99], a[168:171], v[56:59], v[96:99]
 v_add_f32 v148, v148, v196
 v_add_f32 v149, v149, v197
 v_mfma_f32_16x16x32_bf16 v[100:103], a[172:175], v[56:59], v[100:103]
 v_add_f32 v150, v150, v198
 v_add_f32 v151, v151, v199
 v_mfma_f32_16x16x32_bf16 v[108:111], a[172:175], v[60:63], v[108:111]
 v_add_f32 v152, v152, v200
 v_add_f32 v153, v153, v201
 v_mfma_f32_16x16x32_bf16 v[104:107], a[168:171], v[60:63], v[104:107]
 v_add_f32 v154, v154, v202
 v_add_f32 v155, v155, v203
 v_mfma_f32_16x16x32_bf16 v[112:115], a[176:179], v[56:59], v[112:115]
 v_add_f32 v156, v156, v204
 v_add_f32 v157, v157, v205
 v_mfma_f32_16x16x32_bf16 v[116:119], a[180:183], v[56:59], v[116:119]
 v_add_f32 v158, v158, v206
 v_add_f32 v159, v159, v207
 v_mfma_f32_16x16x32_bf16 v[124:127], a[180:183], v[60:63], v[124:127]
 v_mul_f32 v144, 0x3e0293ee, v144
 v_mul_f32 v145, 0x3e0293ee, v145
 v_mfma_f32_16x16x32_bf16 v[120:123], a[176:179], v[60:63], v[120:123]
 v_cvt_pk_bf16_f32 v224, v144, v145
 v_mul_f32 v146, 0x3e0293ee, v146
 v_mfma_f32_16x16x32_bf16 v[128:131], a[184:187], v[56:59], v[128:131]
 v_mul_f32 v147, 0x3e0293ee, v147
 v_cvt_pk_bf16_f32 v225, v146, v147
 v_mfma_f32_16x16x32_bf16 v[132:135], a[188:191], v[56:59], v[132:135]
 v_mul_f32 v148, 0x3e0293ee, v148
 v_mul_f32 v149, 0x3e0293ee, v149
 v_mfma_f32_16x16x32_bf16 v[140:143], a[188:191], v[60:63], v[140:143]
 v_cvt_pk_bf16_f32 v226, v148, v149
 v_mul_f32 v150, 0x3e0293ee, v150
 v_mfma_f32_16x16x32_bf16 v[136:139], a[184:187], v[60:63], v[136:139]
 v_mul_f32 v151, 0x3e0293ee, v151
 s_waitcnt vmcnt(11)
 v_mfma_f32_16x16x32_bf16 v[80:83], a[192:195], v[64:67], v[80:83]
 buffer_load_dwordx4 v[56:59], v2, s[48:51], s82 offen offset:2048 sc1
 v_mfma_f32_16x16x32_bf16 v[84:87], a[196:199], v[64:67], v[84:87]
 v_cvt_pk_bf16_f32 v227, v150, v151
 v_mfma_f32_16x16x32_bf16 v[92:95], a[196:199], v[68:71], v[92:95]
 buffer_load_dwordx4 v[60:63], v2, s[48:51], s82 offen offset:2304 sc1
 v_mfma_f32_16x16x32_bf16 v[88:91], a[192:195], v[68:71], v[88:91]
 ds_write_b128 v236, v[224:227] offset:24576
 v_mfma_f32_16x16x32_bf16 v[96:99], a[200:203], v[64:67], v[96:99]
 s_add_u32 s74, s74, 4
 s_add_u32 s75, s74, 1
 v_mfma_f32_16x16x32_bf16 v[100:103], a[204:207], v[64:67], v[100:103]
 s_lshl_b32 s67, s74, 18
 s_and_b32 s69, s74, 8
 v_mfma_f32_16x16x32_bf16 v[108:111], a[204:207], v[68:71], v[108:111]
 s_lshl_b32 s69, s69, 10
 s_xor_b32 s78, s66, s69
 v_mfma_f32_16x16x32_bf16 v[104:107], a[200:203], v[68:71], v[104:107]
 s_add_u32 s78, s78, s67
 s_add_u32 s67, s67, s76
 v_mfma_f32_16x16x32_bf16 v[112:115], a[208:211], v[64:67], v[112:115]
 s_cmp_eq_u32 s72, 14
 s_cselect_b32 s75, 64, s75
 v_mfma_f32_16x16x32_bf16 v[116:119], a[212:215], v[64:67], v[116:119]
 buffer_load_dword v239, v234, s[48:51], s77 offen sc1
 v_mfma_f32_16x16x32_bf16 v[124:127], a[212:215], v[68:71], v[124:127]
 v_mul_f32 v152, 0x3e0293ee, v152
 v_mul_f32 v153, 0x3e0293ee, v153
 v_mfma_f32_16x16x32_bf16 v[120:123], a[208:211], v[68:71], v[120:123]
 v_cvt_pk_bf16_f32 v228, v152, v153
 v_mul_f32 v154, 0x3e0293ee, v154
 v_mfma_f32_16x16x32_bf16 v[128:131], a[216:219], v[64:67], v[128:131]
 v_mul_f32 v155, 0x3e0293ee, v155
 v_cvt_pk_bf16_f32 v229, v154, v155
 v_mfma_f32_16x16x32_bf16 v[132:135], a[220:223], v[64:67], v[132:135]
 v_mul_f32 v156, 0x3e0293ee, v156
 v_mul_f32 v157, 0x3e0293ee, v157
 v_mfma_f32_16x16x32_bf16 v[140:143], a[220:223], v[68:71], v[140:143]
 v_cvt_pk_bf16_f32 v230, v156, v157
 v_mul_f32 v158, 0x3e0293ee, v158
 v_mfma_f32_16x16x32_bf16 v[136:139], a[216:219], v[68:71], v[136:139]
 v_mul_f32 v159, 0x3e0293ee, v159
 s_waitcnt vmcnt(12)
 v_mfma_f32_16x16x32_bf16 v[80:83], a[224:227], v[72:75], v[80:83]
 s_add_u32 s82, s65, 12288
 buffer_load_dwordx4 v[64:67], v2, s[48:51], s82 offen offset:0 sc1
 v_mfma_f32_16x16x32_bf16 v[84:87], a[228:231], v[72:75], v[84:87]
 v_cvt_pk_bf16_f32 v231, v158, v159
 v_mfma_f32_16x16x32_bf16 v[92:95], a[228:231], v[76:79], v[92:95]
 buffer_load_dwordx4 v[68:71], v2, s[48:51], s82 offen offset:256 sc1
 v_mfma_f32_16x16x32_bf16 v[88:91], a[224:227], v[76:79], v[88:91]
 ds_write_b128 v236, v[228:231] offset:24832
 v_mfma_f32_16x16x32_bf16 v[96:99], a[232:235], v[72:75], v[96:99]
 s_add_u32 s70, s65, 131072
 v_mfma_f32_16x16x32_bf16 v[100:103], a[236:239], v[72:75], v[100:103]
 buffer_load_dwordx4 v[12:15], v11, s[48:51], s70 offen offset:0 sc1
 v_mfma_f32_16x16x32_bf16 v[108:111], a[236:239], v[76:79], v[108:111]
 buffer_load_dwordx4 v[12:15], v11, s[48:51], s70 offen offset:1024 sc1
 v_mfma_f32_16x16x32_bf16 v[104:107], a[232:235], v[76:79], v[104:107]
 s_add_u32 s65, s65, 0x10000
 v_mfma_f32_16x16x32_bf16 v[112:115], a[240:243], v[72:75], v[112:115]
 v_mfma_f32_16x16x32_bf16 v[116:119], a[244:247], v[72:75], v[116:119]
 v_mfma_f32_16x16x32_bf16 v[124:127], a[244:247], v[76:79], v[124:127]
 v_mfma_f32_16x16x32_bf16 v[120:123], a[240:243], v[76:79], v[120:123]
 v_mfma_f32_16x16x32_bf16 v[128:131], a[248:251], v[72:75], v[128:131]
 v_mfma_f32_16x16x32_bf16 v[132:135], a[252:255], v[72:75], v[132:135]
 v_mfma_f32_16x16x32_bf16 v[140:143], a[252:255], v[76:79], v[140:143]
 v_mfma_f32_16x16x32_bf16 v[136:139], a[248:251], v[76:79], v[136:139]
 v_mfma_f32_16x16x32_bf16 v[144:147], a[0:3], v[16:19], 0
 buffer_load_dwordx4 v[72:75], v2, s[48:51], s82 offen offset:2048 sc1
 v_mfma_f32_16x16x32_bf16 v[148:151], a[4:7], v[16:19], 0
 ds_write_b128 v7, v[96:99] offset:0
 v_mfma_f32_16x16x32_bf16 v[156:159], a[4:7], v[20:23], 0
 buffer_load_dwordx4 v[76:79], v2, s[48:51], s82 offen offset:2304 sc1
 v_mfma_f32_16x16x32_bf16 v[152:155], a[0:3], v[20:23], 0
 v_mfma_f32_16x16x32_bf16 v[160:163], a[8:11], v[16:19], 0
 ds_write_b128 v7, v[100:103] offset:1024
 v_mfma_f32_16x16x32_bf16 v[164:167], a[12:15], v[16:19], 0
 v_mfma_f32_16x16x32_bf16 v[172:175], a[12:15], v[20:23], 0
 v_mfma_f32_16x16x32_bf16 v[168:171], a[8:11], v[20:23], 0
 ds_write_b128 v7, v[104:107] offset:2048
 v_mfma_f32_16x16x32_bf16 v[176:179], a[16:19], v[16:19], 0
 v_mfma_f32_16x16x32_bf16 v[180:183], a[20:23], v[16:19], 0
 v_mfma_f32_16x16x32_bf16 v[188:191], a[20:23], v[20:23], 0
 ds_write_b128 v7, v[108:111] offset:3072
 v_mfma_f32_16x16x32_bf16 v[184:187], a[16:19], v[20:23], 0
 v_mfma_f32_16x16x32_bf16 v[192:195], a[24:27], v[16:19], 0
 v_mfma_f32_16x16x32_bf16 v[196:199], a[28:31], v[16:19], 0
 ds_write_b128 v8, v[112:115] offset:0
 v_mfma_f32_16x16x32_bf16 v[204:207], a[28:31], v[20:23], 0
 v_mfma_f32_16x16x32_bf16 v[200:203], a[24:27], v[20:23], 0
 s_waitcnt vmcnt(15)
 v_mfma_f32_16x16x32_bf16 v[144:147], a[32:35], v[24:27], v[144:147]
 s_add_u32 s82, s65, 0
 buffer_load_dwordx4 v[16:19], v2, s[48:51], s82 offen offset:0 sc1
 v_mfma_f32_16x16x32_bf16 v[148:151], a[36:39], v[24:27], v[148:151]
 ds_write_b128 v8, v[116:119] offset:1024
 v_mfma_f32_16x16x32_bf16 v[156:159], a[36:39], v[28:31], v[156:159]
 buffer_load_dwordx4 v[20:23], v2, s[48:51], s82 offen offset:256 sc1
 v_mfma_f32_16x16x32_bf16 v[152:155], a[32:35], v[28:31], v[152:155]
 v_mfma_f32_16x16x32_bf16 v[160:163], a[40:43], v[24:27], v[160:163]
 ds_write_b128 v8, v[120:123] offset:2048
 v_mfma_f32_16x16x32_bf16 v[164:167], a[44:47], v[24:27], v[164:167]
 v_mfma_f32_16x16x32_bf16 v[172:175], a[44:47], v[28:31], v[172:175]
 v_mfma_f32_16x16x32_bf16 v[168:171], a[40:43], v[28:31], v[168:171]
 ds_write_b128 v8, v[124:127] offset:3072
 v_mfma_f32_16x16x32_bf16 v[176:179], a[48:51], v[24:27], v[176:179]
 v_mfma_f32_16x16x32_bf16 v[180:183], a[52:55], v[24:27], v[180:183]
 v_mfma_f32_16x16x32_bf16 v[188:191], a[52:55], v[28:31], v[188:191]
 ds_write_b128 v9, v[128:131] offset:0
 v_mfma_f32_16x16x32_bf16 v[184:187], a[48:51], v[28:31], v[184:187]
 v_mfma_f32_16x16x32_bf16 v[192:195], a[56:59], v[24:27], v[192:195]
 v_mfma_f32_16x16x32_bf16 v[196:199], a[60:63], v[24:27], v[196:199]
 ds_write_b128 v9, v[132:135] offset:1024
 v_mfma_f32_16x16x32_bf16 v[204:207], a[60:63], v[28:31], v[204:207]
 v_mfma_f32_16x16x32_bf16 v[200:203], a[56:59], v[28:31], v[200:203]
 s_waitcnt vmcnt(15)
 v_mfma_f32_16x16x32_bf16 v[144:147], a[64:67], v[32:35], v[144:147]
 buffer_load_dwordx4 v[24:27], v2, s[48:51], s82 offen offset:2048 sc1
 v_mfma_f32_16x16x32_bf16 v[148:151], a[68:71], v[32:35], v[148:151]
 ds_write_b128 v9, v[136:139] offset:2048
 v_mfma_f32_16x16x32_bf16 v[156:159], a[68:71], v[36:39], v[156:159]
 buffer_load_dwordx4 v[28:31], v2, s[48:51], s82 offen offset:2304 sc1
 v_mfma_f32_16x16x32_bf16 v[152:155], a[64:67], v[36:39], v[152:155]
 v_mfma_f32_16x16x32_bf16 v[160:163], a[72:75], v[32:35], v[160:163]
 ds_write_b128 v9, v[140:143] offset:3072
 v_mfma_f32_16x16x32_bf16 v[164:167], a[76:79], v[32:35], v[164:167]
 v_mfma_f32_16x16x32_bf16 v[172:175], a[76:79], v[36:39], v[172:175]
 v_mfma_f32_16x16x32_bf16 v[168:171], a[72:75], v[36:39], v[168:171]
 s_waitcnt lgkmcnt(0)
 s_barrier
 v_mfma_f32_16x16x32_bf16 v[176:179], a[80:83], v[32:35], v[176:179]
 ds_read_b128 v[96:99], v10 offset:0
 v_mfma_f32_16x16x32_bf16 v[180:183], a[84:87], v[32:35], v[180:183]
 ds_read_b128 v[100:103], v10 offset:1024
 v_mfma_f32_16x16x32_bf16 v[188:191], a[84:87], v[36:39], v[188:191]
 ds_read_b128 v[104:107], v10 offset:2048
 v_mfma_f32_16x16x32_bf16 v[184:187], a[80:83], v[36:39], v[184:187]
 ds_read_b128 v[108:111], v10 offset:3072
 v_mfma_f32_16x16x32_bf16 v[192:195], a[88:91], v[32:35], v[192:195]
 ds_read_b128 v[112:115], v10 offset:4096
 v_mfma_f32_16x16x32_bf16 v[196:199], a[92:95], v[32:35], v[196:199]
 ds_read_b128 v[116:119], v10 offset:5120
 v_mfma_f32_16x16x32_bf16 v[204:207], a[92:95], v[36:39], v[204:207]
 ds_read_b128 v[120:123], v10 offset:6144
 v_mfma_f32_16x16x32_bf16 v[200:203], a[88:91], v[36:39], v[200:203]
 ds_read_b128 v[124:127], v10 offset:7168
 s_waitcnt vmcnt(15)
 v_mfma_f32_16x16x32_bf16 v[144:147], a[96:99], v[40:43], v[144:147]
 s_add_u32 s82, s65, 4096
 buffer_load_dwordx4 v[32:35], v2, s[48:51], s82 offen offset:0 sc1
 v_mfma_f32_16x16x32_bf16 v[148:151], a[100:103], v[40:43], v[148:151]
 ds_read_b128 v[128:131], v10 offset:8192
 v_mfma_f32_16x16x32_bf16 v[156:159], a[100:103], v[44:47], v[156:159]
 buffer_load_dwordx4 v[36:39], v2, s[48:51], s82 offen offset:256 sc1
 v_mfma_f32_16x16x32_bf16 v[152:155], a[96:99], v[44:47], v[152:155]
 ds_read_b128 v[132:135], v10 offset:9216
 v_mfma_f32_16x16x32_bf16 v[160:163], a[104:107], v[40:43], v[160:163]
 ds_read_b128 v[136:139], v10 offset:10240
 v_mfma_f32_16x16x32_bf16 v[164:167], a[108:111], v[40:43], v[164:167]
 ds_read_b128 v[140:143], v10 offset:11264
 v_mfma_f32_16x16x32_bf16 v[172:175], a[108:111], v[44:47], v[172:175]
 s_waitcnt lgkmcnt(8)
 v_add_f32 v80, v80, v96
 v_mfma_f32_16x16x32_bf16 v[168:171], a[104:107], v[44:47], v[168:171]
 v_add_f32 v81, v81, v97
 v_add_f32 v82, v82, v98
 v_mfma_f32_16x16x32_bf16 v[176:179], a[112:115], v[40:43], v[176:179]
 v_add_f32 v83, v83, v99
 v_add_f32 v84, v84, v100
 v_mfma_f32_16x16x32_bf16 v[180:183], a[116:119], v[40:43], v[180:183]
 v_add_f32 v85, v85, v101
 v_add_f32 v86, v86, v102
 v_mfma_f32_16x16x32_bf16 v[188:191], a[116:119], v[44:47], v[188:191]
 v_add_f32 v87, v87, v103
 v_add_f32 v88, v88, v104
 v_mfma_f32_16x16x32_bf16 v[184:187], a[112:115], v[44:47], v[184:187]
 v_add_f32 v89, v89, v105
 v_add_f32 v90, v90, v106
 v_mfma_f32_16x16x32_bf16 v[192:195], a[120:123], v[40:43], v[192:195]
 s_waitcnt vmcnt(12)
 v_cmp_gt_u32 vcc, s75, v239
 v_mfma_f32_16x16x32_bf16 v[196:199], a[124:127], v[40:43], v[196:199]
 s_nop 0
 v_mfma_f32_16x16x32_bf16 v[204:207], a[124:127], v[44:47], v[204:207]
 s_cbranch_vccnz Lw_Qkvwait
Lw_Qkvok:
 v_mfma_f32_16x16x32_bf16 v[200:203], a[120:123], v[44:47], v[200:203]
 v_add_f32 v91, v91, v107
 v_mfma_f32_16x16x32_bf16 v[144:147], a[128:131], v[48:51], v[144:147]
 buffer_load_dwordx4 v[40:43], v2, s[48:51], s82 offen offset:2048 sc1
 v_mfma_f32_16x16x32_bf16 v[148:151], a[132:135], v[48:51], v[148:151]
 v_add_f32 v92, v92, v108
 v_add_f32 v93, v93, v109
 v_mfma_f32_16x16x32_bf16 v[156:159], a[132:135], v[52:55], v[156:159]
 buffer_load_dwordx4 v[44:47], v2, s[48:51], s82 offen offset:2304 sc1
 v_mfma_f32_16x16x32_bf16 v[152:155], a[128:131], v[52:55], v[152:155]
 v_add_f32 v94, v94, v110
 v_add_f32 v95, v95, v111
 v_mfma_f32_16x16x32_bf16 v[160:163], a[136:139], v[48:51], v[160:163]
 s_waitcnt lgkmcnt(4)
 v_add_f32 v80, v80, v112
 v_mfma_f32_16x16x32_bf16 v[164:167], a[140:143], v[48:51], v[164:167]
 v_add_f32 v81, v81, v113
 v_add_f32 v82, v82, v114
 v_mfma_f32_16x16x32_bf16 v[172:175], a[140:143], v[52:55], v[172:175]
 s_add_u32 s71, s67, 33554432
 s_add_u32 m0, s80, 0
 v_mfma_f32_16x16x32_bf16 v[168:171], a[136:139], v[52:55], v[168:171]
 buffer_load_dwordx4 v1, s[48:51], s71 offen offset:0 sc1 lds
 v_mfma_f32_16x16x32_bf16 v[176:179], a[144:147], v[48:51], v[176:179]
 v_add_f32 v83, v83, v115
 v_add_f32 v84, v84, v116
 v_mfma_f32_16x16x32_bf16 v[180:183], a[148:151], v[48:51], v[180:183]
 v_add_f32 v85, v85, v117
 v_add_f32 v86, v86, v118
 v_mfma_f32_16x16x32_bf16 v[188:191], a[148:151], v[52:55], v[188:191]
 v_add_f32 v87, v87, v119
 v_add_f32 v88, v88, v120
 v_mfma_f32_16x16x32_bf16 v[184:187], a[144:147], v[52:55], v[184:187]
 v_add_f32 v89, v89, v121
 v_add_f32 v90, v90, v122
 v_mfma_f32_16x16x32_bf16 v[192:195], a[152:155], v[48:51], v[192:195]
 v_add_f32 v91, v91, v123
 v_add_f32 v92, v92, v124
 v_mfma_f32_16x16x32_bf16 v[196:199], a[156:159], v[48:51], v[196:199]
 v_add_f32 v93, v93, v125
 v_add_f32 v94, v94, v126
 v_mfma_f32_16x16x32_bf16 v[204:207], a[156:159], v[52:55], v[204:207]
 v_add_f32 v95, v95, v127
 s_waitcnt lgkmcnt(0)
 v_mfma_f32_16x16x32_bf16 v[200:203], a[152:155], v[52:55], v[200:203]
 s_barrier
 v_mfma_f32_16x16x32_bf16 v[144:147], a[160:163], v[56:59], v[144:147]
 s_add_u32 s82, s65, 8192
 buffer_load_dwordx4 v[48:51], v2, s[48:51], s82 offen offset:0 sc1
 v_mfma_f32_16x16x32_bf16 v[148:151], a[164:167], v[56:59], v[148:151]
 s_add_u32 s71, s67, 33554432
 s_add_u32 m0, s80, 0
 v_mfma_f32_16x16x32_bf16 v[156:159], a[164:167], v[60:63], v[156:159]
 buffer_load_dwordx4 v[52:55], v2, s[48:51], s82 offen offset:256 sc1
 v_mfma_f32_16x16x32_bf16 v[152:155], a[160:163], v[60:63], v[152:155]
 buffer_load_dwordx4 v1, s[48:51], s71 offen offset:1024 sc1 lds
 v_mfma_f32_16x16x32_bf16 v[160:163], a[168:171], v[56:59], v[160:163]
 v_add_f32 v80, v80, v128
 v_add_f32 v81, v81, v129
 v_mfma_f32_16x16x32_bf16 v[164:167], a[172:175], v[56:59], v[164:167]
 v_add_f32 v82, v82, v130
 v_add_f32 v83, v83, v131
 v_mfma_f32_16x16x32_bf16 v[172:175], a[172:175], v[60:63], v[172:175]
 v_add_f32 v84, v84, v132
 v_add_f32 v85, v85, v133
 v_mfma_f32_16x16x32_bf16 v[168:171], a[168:171], v[60:63], v[168:171]
 v_add_f32 v86, v86, v134
 v_add_f32 v87, v87, v135
 v_mfma_f32_16x16x32_bf16 v[176:179], a[176:179], v[56:59], v[176:179]
 v_add_f32 v88, v88, v136
 v_add_f32 v89, v89, v137
 v_mfma_f32_16x16x32_bf16 v[180:183], a[180:183], v[56:59], v[180:183]
 v_add_f32 v90, v90, v138
 v_add_f32 v91, v91, v139
 v_mfma_f32_16x16x32_bf16 v[188:191], a[180:183], v[60:63], v[188:191]
 s_add_u32 s71, s67, 33554432
 s_add_u32 m0, s80, 0
 v_mfma_f32_16x16x32_bf16 v[184:187], a[176:179], v[60:63], v[184:187]
 buffer_load_dwordx4 v1, s[48:51], s71 offen offset:2048 sc1 lds
 v_mfma_f32_16x16x32_bf16 v[192:195], a[184:187], v[56:59], v[192:195]
 v_add_f32 v92, v92, v140
 v_add_f32 v93, v93, v141
 v_mfma_f32_16x16x32_bf16 v[196:199], a[188:191], v[56:59], v[196:199]
 v_add_f32 v94, v94, v142
 v_add_f32 v95, v95, v143
 v_mfma_f32_16x16x32_bf16 v[204:207], a[188:191], v[60:63], v[204:207]
 v_mul_f32 v80, 0x3e0293ee, v80
 v_mul_f32 v81, 0x3e0293ee, v81
 v_mfma_f32_16x16x32_bf16 v[200:203], a[184:187], v[60:63], v[200:203]
 v_cvt_pk_bf16_f32 v224, v80, v81
 s_waitcnt vmcnt(17)
 v_mfma_f32_16x16x32_bf16 v[144:147], a[192:195], v[64:67], v[144:147]
 buffer_load_dwordx4 v[56:59], v2, s[48:51], s82 offen offset:2048 sc1
 v_mfma_f32_16x16x32_bf16 v[148:151], a[196:199], v[64:67], v[148:151]
 v_mul_f32 v82, 0x3e0293ee, v82
 v_mul_f32 v83, 0x3e0293ee, v83
 v_mfma_f32_16x16x32_bf16 v[156:159], a[196:199], v[68:71], v[156:159]
 buffer_load_dwordx4 v[60:63], v2, s[48:51], s82 offen offset:2304 sc1
 v_mfma_f32_16x16x32_bf16 v[152:155], a[192:195], v[68:71], v[152:155]
 v_cvt_pk_bf16_f32 v225, v82, v83
 v_mul_f32 v84, 0x3e0293ee, v84
 v_mfma_f32_16x16x32_bf16 v[160:163], a[200:203], v[64:67], v[160:163]
 v_mul_f32 v85, 0x3e0293ee, v85
 v_cvt_pk_bf16_f32 v226, v84, v85
 v_mfma_f32_16x16x32_bf16 v[164:167], a[204:207], v[64:67], v[164:167]
 v_mul_f32 v86, 0x3e0293ee, v86
 v_mul_f32 v87, 0x3e0293ee, v87
 v_mfma_f32_16x16x32_bf16 v[172:175], a[204:207], v[68:71], v[172:175]
 v_cvt_pk_bf16_f32 v227, v86, v87
 v_mfma_f32_16x16x32_bf16 v[168:171], a[200:203], v[68:71], v[168:171]
 ds_write_b128 v235, v[224:227] offset:0
 v_mfma_f32_16x16x32_bf16 v[176:179], a[208:211], v[64:67], v[176:179]
 v_mul_f32 v88, 0x3e0293ee, v88
 v_mul_f32 v89, 0x3e0293ee, v89
 v_mfma_f32_16x16x32_bf16 v[180:183], a[212:215], v[64:67], v[180:183]
 v_cvt_pk_bf16_f32 v228, v88, v89
 v_mul_f32 v90, 0x3e0293ee, v90
 v_mfma_f32_16x16x32_bf16 v[188:191], a[212:215], v[68:71], v[188:191]
 v_mul_f32 v91, 0x3e0293ee, v91
 v_cvt_pk_bf16_f32 v229, v90, v91
 v_mfma_f32_16x16x32_bf16 v[184:187], a[208:211], v[68:71], v[184:187]
 v_mul_f32 v92, 0x3e0293ee, v92
 v_mul_f32 v93, 0x3e0293ee, v93
 v_mfma_f32_16x16x32_bf16 v[192:195], a[216:219], v[64:67], v[192:195]
 v_cvt_pk_bf16_f32 v230, v92, v93
 v_mul_f32 v94, 0x3e0293ee, v94
 v_mfma_f32_16x16x32_bf16 v[196:199], a[220:223], v[64:67], v[196:199]
 v_mul_f32 v95, 0x3e0293ee, v95
 v_cvt_pk_bf16_f32 v231, v94, v95
 v_mfma_f32_16x16x32_bf16 v[204:207], a[220:223], v[68:71], v[204:207]
 ds_write_b128 v235, v[228:231] offset:256
 v_mfma_f32_16x16x32_bf16 v[200:203], a[216:219], v[68:71], v[200:203]
 s_waitcnt vmcnt(15)
 v_mfma_f32_16x16x32_bf16 v[144:147], a[224:227], v[72:75], v[144:147]
 s_add_u32 s82, s65, 12288
 buffer_load_dwordx4 v[64:67], v2, s[48:51], s82 offen offset:0 sc1
 v_mfma_f32_16x16x32_bf16 v[148:151], a[228:231], v[72:75], v[148:151]
 v_mfma_f32_16x16x32_bf16 v[156:159], a[228:231], v[76:79], v[156:159]
 buffer_load_dwordx4 v[68:71], v2, s[48:51], s82 offen offset:256 sc1
 v_mfma_f32_16x16x32_bf16 v[152:155], a[224:227], v[76:79], v[152:155]
 s_add_u32 s70, s65, 131072
 v_mfma_f32_16x16x32_bf16 v[160:163], a[232:235], v[72:75], v[160:163]
 buffer_load_dwordx4 v[12:15], v11, s[48:51], s70 offen offset:0 sc1
 v_mfma_f32_16x16x32_bf16 v[164:167], a[236:239], v[72:75], v[164:167]
 buffer_load_dwordx4 v[12:15], v11, s[48:51], s70 offen offset:1024 sc1
 v_mfma_f32_16x16x32_bf16 v[172:175], a[236:239], v[76:79], v[172:175]
 s_add_u32 s65, s65, 0x10000
 v_mfma_f32_16x16x32_bf16 v[168:171], a[232:235], v[76:79], v[168:171]
 v_mfma_f32_16x16x32_bf16 v[176:179], a[240:243], v[72:75], v[176:179]
 v_mfma_f32_16x16x32_bf16 v[180:183], a[244:247], v[72:75], v[180:183]
 v_mfma_f32_16x16x32_bf16 v[188:191], a[244:247], v[76:79], v[188:191]
 v_mfma_f32_16x16x32_bf16 v[184:187], a[240:243], v[76:79], v[184:187]
 v_mfma_f32_16x16x32_bf16 v[192:195], a[248:251], v[72:75], v[192:195]
 v_mfma_f32_16x16x32_bf16 v[196:199], a[252:255], v[72:75], v[196:199]
 v_mfma_f32_16x16x32_bf16 v[204:207], a[252:255], v[76:79], v[204:207]
 v_mfma_f32_16x16x32_bf16 v[200:203], a[248:251], v[76:79], v[200:203]
 s_waitcnt vmcnt(17)
 v_mfma_f32_16x16x32_bf16 v[80:83], a[0:3], v[16:19], 0
 buffer_load_dwordx4 v[72:75], v2, s[48:51], s82 offen offset:2048 sc1
 v_mfma_f32_16x16x32_bf16 v[84:87], a[4:7], v[16:19], 0
 ds_write_b128 v7, v[160:163] offset:0
 v_mfma_f32_16x16x32_bf16 v[92:95], a[4:7], v[20:23], 0
 buffer_load_dwordx4 v[76:79], v2, s[48:51], s82 offen offset:2304 sc1
 v_mfma_f32_16x16x32_bf16 v[88:91], a[0:3], v[20:23], 0
 v_mfma_f32_16x16x32_bf16 v[96:99], a[8:11], v[16:19], 0
 ds_write_b128 v7, v[164:167] offset:1024
 v_mfma_f32_16x16x32_bf16 v[100:103], a[12:15], v[16:19], 0
 s_add_u32 s71, s67, 33554432
 s_add_u32 m0, s80, 0
 v_mfma_f32_16x16x32_bf16 v[108:111], a[12:15], v[20:23], 0
 buffer_load_dwordx4 v1, s[48:51], s71 offen offset:3072 sc1 lds
 v_mfma_f32_16x16x32_bf16 v[104:107], a[8:11], v[20:23], 0
 ds_write_b128 v7, v[168:171] offset:2048
 v_mfma_f32_16x16x32_bf16 v[112:115], a[16:19], v[16:19], 0
 v_mfma_f32_16x16x32_bf16 v[116:119], a[20:23], v[16:19], 0
 v_mfma_f32_16x16x32_bf16 v[124:127], a[20:23], v[20:23], 0
 ds_write_b128 v7, v[172:175] offset:3072
 v_mfma_f32_16x16x32_bf16 v[120:123], a[16:19], v[20:23], 0
 v_mfma_f32_16x16x32_bf16 v[128:131], a[24:27], v[16:19], 0
 v_mfma_f32_16x16x32_bf16 v[132:135], a[28:31], v[16:19], 0
 ds_write_b128 v8, v[176:179] offset:0
 v_mfma_f32_16x16x32_bf16 v[140:143], a[28:31], v[20:23], 0
 s_add_u32 s71, s67, 33558528
 s_add_u32 m0, s80, 4096
 v_mfma_f32_16x16x32_bf16 v[136:139], a[24:27], v[20:23], 0
 buffer_load_dwordx4 v1, s[48:51], s71 offen offset:0 sc1 lds
 s_waitcnt vmcnt(19)
 v_mfma_f32_16x16x32_bf16 v[80:83], a[32:35], v[24:27], v[80:83]
 s_add_u32 s82, s65, 0
 buffer_load_dwordx4 v[16:19], v2, s[48:51], s82 offen offset:0 sc1
 v_mfma_f32_16x16x32_bf16 v[84:87], a[36:39], v[24:27], v[84:87]
 ds_write_b128 v8, v[180:183] offset:1024
 v_mfma_f32_16x16x32_bf16 v[92:95], a[36:39], v[28:31], v[92:95]
 buffer_load_dwordx4 v[20:23], v2, s[48:51], s82 offen offset:256 sc1
 v_mfma_f32_16x16x32_bf16 v[88:91], a[32:35], v[28:31], v[88:91]
 v_mfma_f32_16x16x32_bf16 v[96:99], a[40:43], v[24:27], v[96:99]
 ds_write_b128 v8, v[184:187] offset:2048
 v_mfma_f32_16x16x32_bf16 v[100:103], a[44:47], v[24:27], v[100:103]
 v_mfma_f32_16x16x32_bf16 v[108:111], a[44:47], v[28:31], v[108:111]
 s_add_u32 s71, s67, 33558528
 s_add_u32 m0, s80, 4096
 v_mfma_f32_16x16x32_bf16 v[104:107], a[40:43], v[28:31], v[104:107]
 ds_write_b128 v8, v[188:191] offset:3072
 v_mfma_f32_16x16x32_bf16 v[112:115], a[48:51], v[24:27], v[112:115]
 buffer_load_dwordx4 v1, s[48:51], s71 offen offset:1024 sc1 lds
 v_mfma_f32_16x16x32_bf16 v[116:119], a[52:55], v[24:27], v[116:119]
 v_mfma_f32_16x16x32_bf16 v[124:127], a[52:55], v[28:31], v[124:127]
 ds_write_b128 v9, v[192:195] offset:0
 v_mfma_f32_16x16x32_bf16 v[120:123], a[48:51], v[28:31], v[120:123]
 v_mfma_f32_16x16x32_bf16 v[128:131], a[56:59], v[24:27], v[128:131]
 v_mfma_f32_16x16x32_bf16 v[132:135], a[60:63], v[24:27], v[132:135]
 ds_write_b128 v9, v[196:199] offset:1024
 v_mfma_f32_16x16x32_bf16 v[140:143], a[60:63], v[28:31], v[140:143]
 v_mfma_f32_16x16x32_bf16 v[136:139], a[56:59], v[28:31], v[136:139]
 s_add_u32 s71, s67, 33558528
 s_waitcnt vmcnt(20)
 v_mfma_f32_16x16x32_bf16 v[80:83], a[64:67], v[32:35], v[80:83]
 buffer_load_dwordx4 v[24:27], v2, s[48:51], s82 offen offset:2048 sc1
 v_mfma_f32_16x16x32_bf16 v[84:87], a[68:71], v[32:35], v[84:87]
 ds_write_b128 v9, v[200:203] offset:2048
 v_mfma_f32_16x16x32_bf16 v[92:95], a[68:71], v[36:39], v[92:95]
 buffer_load_dwordx4 v[28:31], v2, s[48:51], s82 offen offset:2304 sc1
 v_mfma_f32_16x16x32_bf16 v[88:91], a[64:67], v[36:39], v[88:91]
 s_add_u32 m0, s80, 4096
 v_mfma_f32_16x16x32_bf16 v[96:99], a[72:75], v[32:35], v[96:99]
 ds_write_b128 v9, v[204:207] offset:3072
 v_mfma_f32_16x16x32_bf16 v[100:103], a[76:79], v[32:35], v[100:103]
 buffer_load_dwordx4 v1, s[48:51], s71 offen offset:2048 sc1 lds
 v_mfma_f32_16x16x32_bf16 v[108:111], a[76:79], v[36:39], v[108:111]
 v_mfma_f32_16x16x32_bf16 v[104:107], a[72:75], v[36:39], v[104:107]
 s_waitcnt lgkmcnt(0)
 s_barrier
 v_mfma_f32_16x16x32_bf16 v[112:115], a[80:83], v[32:35], v[112:115]
 s_add_u32 s71, s67, 33558528
 s_add_u32 m0, s80, 4096
 v_mfma_f32_16x16x32_bf16 v[116:119], a[84:87], v[32:35], v[116:119]
 buffer_load_dwordx4 v1, s[48:51], s71 offen offset:3072 sc1 lds
 v_mfma_f32_16x16x32_bf16 v[124:127], a[84:87], v[36:39], v[124:127]
 ds_read_b128 v[160:163], v10 offset:0
 v_mfma_f32_16x16x32_bf16 v[120:123], a[80:83], v[36:39], v[120:123]
 ds_read_b128 v[164:167], v10 offset:1024
 v_mfma_f32_16x16x32_bf16 v[128:131], a[88:91], v[32:35], v[128:131]
 ds_read_b128 v[168:171], v10 offset:2048
 v_mfma_f32_16x16x32_bf16 v[132:135], a[92:95], v[32:35], v[132:135]
 ds_read_b128 v[172:175], v10 offset:3072
 v_mfma_f32_16x16x32_bf16 v[140:143], a[92:95], v[36:39], v[140:143]
 ds_read_b128 v[176:179], v10 offset:4096
 v_mfma_f32_16x16x32_bf16 v[136:139], a[88:91], v[36:39], v[136:139]
 ds_read_b128 v[180:183], v10 offset:5120
 s_waitcnt vmcnt(22)
 v_mfma_f32_16x16x32_bf16 v[80:83], a[96:99], v[40:43], v[80:83]
 s_add_u32 s82, s65, 4096
 buffer_load_dwordx4 v[32:35], v2, s[48:51], s82 offen offset:0 sc1
 v_mfma_f32_16x16x32_bf16 v[84:87], a[100:103], v[40:43], v[84:87]
 ds_read_b128 v[184:187], v10 offset:6144
 v_mfma_f32_16x16x32_bf16 v[92:95], a[100:103], v[44:47], v[92:95]
 buffer_load_dwordx4 v[36:39], v2, s[48:51], s82 offen offset:256 sc1
 v_mfma_f32_16x16x32_bf16 v[88:91], a[96:99], v[44:47], v[88:91]
 ds_read_b128 v[188:191], v10 offset:7168
 v_mfma_f32_16x16x32_bf16 v[96:99], a[104:107], v[40:43], v[96:99]
 ds_read_b128 v[192:195], v10 offset:8192
 v_mfma_f32_16x16x32_bf16 v[100:103], a[108:111], v[40:43], v[100:103]
 ds_read_b128 v[196:199], v10 offset:9216
 v_mfma_f32_16x16x32_bf16 v[108:111], a[108:111], v[44:47], v[108:111]
 ds_read_b128 v[200:203], v10 offset:10240
 v_mfma_f32_16x16x32_bf16 v[104:107], a[104:107], v[44:47], v[104:107]
 ds_read_b128 v[204:207], v10 offset:11264
 v_mfma_f32_16x16x32_bf16 v[112:115], a[112:115], v[40:43], v[112:115]
 s_waitcnt lgkmcnt(8)
 v_add_f32 v144, v144, v160
 v_mfma_f32_16x16x32_bf16 v[116:119], a[116:119], v[40:43], v[116:119]
 v_add_f32 v145, v145, v161
 v_add_f32 v146, v146, v162
 v_mfma_f32_16x16x32_bf16 v[124:127], a[116:119], v[44:47], v[124:127]
 v_add_f32 v147, v147, v163
 v_add_f32 v148, v148, v164
 v_mfma_f32_16x16x32_bf16 v[120:123], a[112:115], v[44:47], v[120:123]
 v_add_f32 v149, v149, v165
 v_add_f32 v150, v150, v166
 v_mfma_f32_16x16x32_bf16 v[128:131], a[120:123], v[40:43], v[128:131]
 v_add_f32 v151, v151, v167
 v_add_f32 v152, v152, v168
 v_mfma_f32_16x16x32_bf16 v[132:135], a[124:127], v[40:43], v[132:135]
 v_add_f32 v153, v153, v169
 v_add_f32 v154, v154, v170
 v_mfma_f32_16x16x32_bf16 v[140:143], a[124:127], v[44:47], v[140:143]
 v_add_f32 v155, v155, v171
 v_add_f32 v156, v156, v172
 v_mfma_f32_16x16x32_bf16 v[136:139], a[120:123], v[44:47], v[136:139]
 v_add_f32 v157, v157, v173
 s_waitcnt vmcnt(21)
 v_mfma_f32_16x16x32_bf16 v[80:83], a[128:131], v[48:51], v[80:83]
 buffer_load_dwordx4 v[40:43], v2, s[48:51], s82 offen offset:2048 sc1
 v_mfma_f32_16x16x32_bf16 v[84:87], a[132:135], v[48:51], v[84:87]
 v_add_f32 v158, v158, v174
 v_add_f32 v159, v159, v175
 v_mfma_f32_16x16x32_bf16 v[92:95], a[132:135], v[52:55], v[92:95]
 buffer_load_dwordx4 v[44:47], v2, s[48:51], s82 offen offset:2304 sc1
 v_mfma_f32_16x16x32_bf16 v[88:91], a[128:131], v[52:55], v[88:91]
 s_waitcnt lgkmcnt(4)
 v_add_f32 v144, v144, v176
 v_mfma_f32_16x16x32_bf16 v[96:99], a[136:139], v[48:51], v[96:99]
 v_add_f32 v145, v145, v177
 v_add_f32 v146, v146, v178
 v_mfma_f32_16x16x32_bf16 v[100:103], a[140:143], v[48:51], v[100:103]
 v_add_f32 v147, v147, v179
 v_add_f32 v148, v148, v180
 v_mfma_f32_16x16x32_bf16 v[108:111], a[140:143], v[52:55], v[108:111]
 v_add_f32 v149, v149, v181
 v_add_f32 v150, v150, v182
 v_mfma_f32_16x16x32_bf16 v[104:107], a[136:139], v[52:55], v[104:107]
 v_add_f32 v151, v151, v183
 v_add_f32 v152, v152, v184
 v_mfma_f32_16x16x32_bf16 v[112:115], a[144:147], v[48:51], v[112:115]
 v_add_f32 v153, v153, v185
 v_add_f32 v154, v154, v186
 v_mfma_f32_16x16x32_bf16 v[116:119], a[148:151], v[48:51], v[116:119]
 v_add_f32 v155, v155, v187
 v_add_f32 v156, v156, v188
 v_mfma_f32_16x16x32_bf16 v[124:127], a[148:151], v[52:55], v[124:127]
 v_add_f32 v157, v157, v189
 v_add_f32 v158, v158, v190
 v_mfma_f32_16x16x32_bf16 v[120:123], a[144:147], v[52:55], v[120:123]
 v_add_f32 v159, v159, v191
 s_waitcnt lgkmcnt(0)
 v_mfma_f32_16x16x32_bf16 v[128:131], a[152:155], v[48:51], v[128:131]
 s_barrier
 v_mfma_f32_16x16x32_bf16 v[132:135], a[156:159], v[48:51], v[132:135]
 v_add_f32 v144, v144, v192
 v_add_f32 v145, v145, v193
 v_mfma_f32_16x16x32_bf16 v[140:143], a[156:159], v[52:55], v[140:143]
 v_add_f32 v146, v146, v194
 v_add_f32 v147, v147, v195
 v_mfma_f32_16x16x32_bf16 v[136:139], a[152:155], v[52:55], v[136:139]
 v_add_f32 v148, v148, v196
 s_waitcnt vmcnt(19)
 v_mfma_f32_16x16x32_bf16 v[80:83], a[160:163], v[56:59], v[80:83]
 s_add_u32 s82, s65, 8192
 buffer_load_dwordx4 v[48:51], v2, s[48:51], s82 offen offset:0 sc1
 v_mfma_f32_16x16x32_bf16 v[84:87], a[164:167], v[56:59], v[84:87]
 v_add_f32 v149, v149, v197
 v_add_f32 v150, v150, v198
 v_mfma_f32_16x16x32_bf16 v[92:95], a[164:167], v[60:63], v[92:95]
 buffer_load_dwordx4 v[52:55], v2, s[48:51], s82 offen offset:256 sc1
 v_mfma_f32_16x16x32_bf16 v[88:91], a[160:163], v[60:63], v[88:91]
 v_add_f32 v151, v151, v199
 v_add_f32 v152, v152, v200
 v_mfma_f32_16x16x32_bf16 v[96:99], a[168:171], v[56:59], v[96:99]
 v_add_f32 v153, v153, v201
 v_add_f32 v154, v154, v202
 v_mfma_f32_16x16x32_bf16 v[100:103], a[172:175], v[56:59], v[100:103]
 v_add_f32 v155, v155, v203
 v_add_f32 v156, v156, v204
 v_mfma_f32_16x16x32_bf16 v[108:111], a[172:175], v[60:63], v[108:111]
 v_add_f32 v157, v157, v205
 v_add_f32 v158, v158, v206
 v_mfma_f32_16x16x32_bf16 v[104:107], a[168:171], v[60:63], v[104:107]
 v_add_f32 v159, v159, v207
 v_mul_f32 v144, 0x3e0293ee, v144
 v_mfma_f32_16x16x32_bf16 v[112:115], a[176:179], v[56:59], v[112:115]
 v_mul_f32 v145, 0x3e0293ee, v145
 v_cvt_pk_bf16_f32 v224, v144, v145
 v_mfma_f32_16x16x32_bf16 v[116:119], a[180:183], v[56:59], v[116:119]
 v_mul_f32 v146, 0x3e0293ee, v146
 v_mul_f32 v147, 0x3e0293ee, v147
 v_mfma_f32_16x16x32_bf16 v[124:127], a[180:183], v[60:63], v[124:127]
 v_cvt_pk_bf16_f32 v225, v146, v147
 v_mul_f32 v148, 0x3e0293ee, v148
 v_mfma_f32_16x16x32_bf16 v[120:123], a[176:179], v[60:63], v[120:123]
 v_mul_f32 v149, 0x3e0293ee, v149
 v_cvt_pk_bf16_f32 v226, v148, v149
 v_mfma_f32_16x16x32_bf16 v[128:131], a[184:187], v[56:59], v[128:131]
 v_mul_f32 v150, 0x3e0293ee, v150
 v_mul_f32 v151, 0x3e0293ee, v151
 v_mfma_f32_16x16x32_bf16 v[132:135], a[188:191], v[56:59], v[132:135]
 v_cvt_pk_bf16_f32 v227, v150, v151
 v_mfma_f32_16x16x32_bf16 v[140:143], a[188:191], v[60:63], v[140:143]
 ds_write_b128 v235, v[224:227] offset:8192
 v_mfma_f32_16x16x32_bf16 v[136:139], a[184:187], v[60:63], v[136:139]
 v_mul_f32 v152, 0x3e0293ee, v152
 s_waitcnt vmcnt(19)
 v_mfma_f32_16x16x32_bf16 v[80:83], a[192:195], v[64:67], v[80:83]
 buffer_load_dwordx4 v[56:59], v2, s[48:51], s82 offen offset:2048 sc1
 v_mfma_f32_16x16x32_bf16 v[84:87], a[196:199], v[64:67], v[84:87]
 v_mul_f32 v153, 0x3e0293ee, v153
 v_cvt_pk_bf16_f32 v228, v152, v153
 v_mfma_f32_16x16x32_bf16 v[92:95], a[196:199], v[68:71], v[92:95]
 buffer_load_dwordx4 v[60:63], v2, s[48:51], s82 offen offset:2304 sc1
 v_mfma_f32_16x16x32_bf16 v[88:91], a[192:195], v[68:71], v[88:91]
 v_mul_f32 v154, 0x3e0293ee, v154
 v_mul_f32 v155, 0x3e0293ee, v155
 v_mfma_f32_16x16x32_bf16 v[96:99], a[200:203], v[64:67], v[96:99]
 v_cvt_pk_bf16_f32 v229, v154, v155
 v_mul_f32 v156, 0x3e0293ee, v156
 v_mfma_f32_16x16x32_bf16 v[100:103], a[204:207], v[64:67], v[100:103]
 v_mul_f32 v157, 0x3e0293ee, v157
 v_cvt_pk_bf16_f32 v230, v156, v157
 v_mfma_f32_16x16x32_bf16 v[108:111], a[204:207], v[68:71], v[108:111]
 v_mul_f32 v158, 0x3e0293ee, v158
 v_mul_f32 v159, 0x3e0293ee, v159
 v_mfma_f32_16x16x32_bf16 v[104:107], a[200:203], v[68:71], v[104:107]
 v_cvt_pk_bf16_f32 v231, v158, v159
 v_mfma_f32_16x16x32_bf16 v[112:115], a[208:211], v[64:67], v[112:115]
 ds_write_b128 v235, v[228:231] offset:8448
 v_mfma_f32_16x16x32_bf16 v[116:119], a[212:215], v[64:67], v[116:119]
 v_mfma_f32_16x16x32_bf16 v[124:127], a[212:215], v[68:71], v[124:127]
 v_mfma_f32_16x16x32_bf16 v[120:123], a[208:211], v[68:71], v[120:123]
 v_mfma_f32_16x16x32_bf16 v[128:131], a[216:219], v[64:67], v[128:131]
 v_mfma_f32_16x16x32_bf16 v[132:135], a[220:223], v[64:67], v[132:135]
 v_mfma_f32_16x16x32_bf16 v[140:143], a[220:223], v[68:71], v[140:143]
 v_mfma_f32_16x16x32_bf16 v[136:139], a[216:219], v[68:71], v[136:139]
 s_waitcnt vmcnt(17)
 v_mfma_f32_16x16x32_bf16 v[80:83], a[224:227], v[72:75], v[80:83]
 s_add_u32 s82, s65, 12288
 buffer_load_dwordx4 v[64:67], v2, s[48:51], s82 offen offset:0 sc1
 v_mfma_f32_16x16x32_bf16 v[84:87], a[228:231], v[72:75], v[84:87]
 v_mfma_f32_16x16x32_bf16 v[92:95], a[228:231], v[76:79], v[92:95]
 buffer_load_dwordx4 v[68:71], v2, s[48:51], s82 offen offset:256 sc1
 v_mfma_f32_16x16x32_bf16 v[88:91], a[224:227], v[76:79], v[88:91]
 s_add_u32 s70, s65, 131072
 v_mfma_f32_16x16x32_bf16 v[96:99], a[232:235], v[72:75], v[96:99]
 buffer_load_dwordx4 v[12:15], v11, s[48:51], s70 offen offset:0 sc1
 v_mfma_f32_16x16x32_bf16 v[100:103], a[236:239], v[72:75], v[100:103]
 buffer_load_dwordx4 v[12:15], v11, s[48:51], s70 offen offset:1024 sc1
 v_mfma_f32_16x16x32_bf16 v[108:111], a[236:239], v[76:79], v[108:111]
 s_add_u32 s65, s65, 0x10000
 v_mfma_f32_16x16x32_bf16 v[104:107], a[232:235], v[76:79], v[104:107]
 v_mfma_f32_16x16x32_bf16 v[112:115], a[240:243], v[72:75], v[112:115]
 v_mfma_f32_16x16x32_bf16 v[116:119], a[244:247], v[72:75], v[116:119]
 v_mfma_f32_16x16x32_bf16 v[124:127], a[244:247], v[76:79], v[124:127]
 v_mfma_f32_16x16x32_bf16 v[120:123], a[240:243], v[76:79], v[120:123]
 v_mfma_f32_16x16x32_bf16 v[128:131], a[248:251], v[72:75], v[128:131]
 v_mfma_f32_16x16x32_bf16 v[132:135], a[252:255], v[72:75], v[132:135]
 v_mfma_f32_16x16x32_bf16 v[140:143], a[252:255], v[76:79], v[140:143]
 v_mfma_f32_16x16x32_bf16 v[136:139], a[248:251], v[76:79], v[136:139]
 s_waitcnt vmcnt(17)
 v_mfma_f32_16x16x32_bf16 v[144:147], a[0:3], v[16:19], 0
 buffer_load_dwordx4 v[72:75], v2, s[48:51], s82 offen offset:2048 sc1
 v_mfma_f32_16x16x32_bf16 v[148:151], a[4:7], v[16:19], 0
 ds_write_b128 v7, v[96:99] offset:0
 v_mfma_f32_16x16x32_bf16 v[156:159], a[4:7], v[20:23], 0
 buffer_load_dwordx4 v[76:79], v2, s[48:51], s82 offen offset:2304 sc1
 v_mfma_f32_16x16x32_bf16 v[152:155], a[0:3], v[20:23], 0
 v_mfma_f32_16x16x32_bf16 v[160:163], a[8:11], v[16:19], 0
 ds_write_b128 v7, v[100:103] offset:1024
 v_mfma_f32_16x16x32_bf16 v[164:167], a[12:15], v[16:19], 0
 s_add_u32 s70, s65, 131072
 v_mfma_f32_16x16x32_bf16 v[172:175], a[12:15], v[20:23], 0
 buffer_load_dwordx4 v[12:15], v11, s[48:51], s70 offen offset:0 sc1
 v_mfma_f32_16x16x32_bf16 v[168:171], a[8:11], v[20:23], 0
 ds_write_b128 v7, v[104:107] offset:2048
 v_mfma_f32_16x16x32_bf16 v[176:179], a[16:19], v[16:19], 0
 buffer_load_dwordx4 v[12:15], v11, s[48:51], s70 offen offset:1024 sc1
 v_mfma_f32_16x16x32_bf16 v[180:183], a[20:23], v[16:19], 0
 v_mfma_f32_16x16x32_bf16 v[188:191], a[20:23], v[20:23], 0
 ds_write_b128 v7, v[108:111] offset:3072
 v_mfma_f32_16x16x32_bf16 v[184:187], a[16:19], v[20:23], 0
 v_mfma_f32_16x16x32_bf16 v[192:195], a[24:27], v[16:19], 0
 v_mfma_f32_16x16x32_bf16 v[196:199], a[28:31], v[16:19], 0
 ds_write_b128 v8, v[112:115] offset:0
 v_mfma_f32_16x16x32_bf16 v[204:207], a[28:31], v[20:23], 0
 v_mfma_f32_16x16x32_bf16 v[200:203], a[24:27], v[20:23], 0
 s_waitcnt vmcnt(18)
 v_mfma_f32_16x16x32_bf16 v[144:147], a[32:35], v[24:27], v[144:147]
 s_add_u32 s82, s67, 16777216
 buffer_load_dwordx4 v[16:19], v1, s[48:51], s82 offen offset:0 sc1
 v_mfma_f32_16x16x32_bf16 v[148:151], a[36:39], v[24:27], v[148:151]
 ds_write_b128 v8, v[116:119] offset:1024
 v_mfma_f32_16x16x32_bf16 v[156:159], a[36:39], v[28:31], v[156:159]
 buffer_load_dwordx4 v[20:23], v1, s[48:51], s82 offen offset:1024 sc1
 v_mfma_f32_16x16x32_bf16 v[152:155], a[32:35], v[28:31], v[152:155]
 v_mfma_f32_16x16x32_bf16 v[160:163], a[40:43], v[24:27], v[160:163]
 ds_write_b128 v8, v[120:123] offset:2048
 v_mfma_f32_16x16x32_bf16 v[164:167], a[44:47], v[24:27], v[164:167]
 v_mfma_f32_16x16x32_bf16 v[172:175], a[44:47], v[28:31], v[172:175]
 v_mfma_f32_16x16x32_bf16 v[168:171], a[40:43], v[28:31], v[168:171]
 ds_write_b128 v8, v[124:127] offset:3072
 v_mfma_f32_16x16x32_bf16 v[176:179], a[48:51], v[24:27], v[176:179]
 v_mfma_f32_16x16x32_bf16 v[180:183], a[52:55], v[24:27], v[180:183]
 v_mfma_f32_16x16x32_bf16 v[188:191], a[52:55], v[28:31], v[188:191]
 ds_write_b128 v9, v[128:131] offset:0
 v_mfma_f32_16x16x32_bf16 v[184:187], a[48:51], v[28:31], v[184:187]
 v_mfma_f32_16x16x32_bf16 v[192:195], a[56:59], v[24:27], v[192:195]
 v_mfma_f32_16x16x32_bf16 v[196:199], a[60:63], v[24:27], v[196:199]
 ds_write_b128 v9, v[132:135] offset:1024
 v_mfma_f32_16x16x32_bf16 v[204:207], a[60:63], v[28:31], v[204:207]
 v_mfma_f32_16x16x32_bf16 v[200:203], a[56:59], v[28:31], v[200:203]
 s_waitcnt vmcnt(16)
 v_mfma_f32_16x16x32_bf16 v[144:147], a[64:67], v[32:35], v[144:147]
 buffer_load_dwordx4 v[24:27], v1, s[48:51], s82 offen offset:2048 sc1
 v_mfma_f32_16x16x32_bf16 v[148:151], a[68:71], v[32:35], v[148:151]
 ds_write_b128 v9, v[136:139] offset:2048
 v_mfma_f32_16x16x32_bf16 v[156:159], a[68:71], v[36:39], v[156:159]
 buffer_load_dwordx4 v[28:31], v1, s[48:51], s82 offen offset:3072 sc1
 v_mfma_f32_16x16x32_bf16 v[152:155], a[64:67], v[36:39], v[152:155]
 v_mfma_f32_16x16x32_bf16 v[160:163], a[72:75], v[32:35], v[160:163]
 ds_write_b128 v9, v[140:143] offset:3072
 v_mfma_f32_16x16x32_bf16 v[164:167], a[76:79], v[32:35], v[164:167]
 buffer_load_dword v239, v251, s[48:51], s78 offen offset:4080 sc1
 v_mfma_f32_16x16x32_bf16 v[172:175], a[76:79], v[36:39], v[172:175]
 v_mfma_f32_16x16x32_bf16 v[168:171], a[72:75], v[36:39], v[168:171]
 s_waitcnt lgkmcnt(0)
 s_barrier
 v_mfma_f32_16x16x32_bf16 v[176:179], a[80:83], v[32:35], v[176:179]
 ds_read_b128 v[96:99], v10 offset:0
 v_mfma_f32_16x16x32_bf16 v[180:183], a[84:87], v[32:35], v[180:183]
 ds_read_b128 v[100:103], v10 offset:1024
 v_mfma_f32_16x16x32_bf16 v[188:191], a[84:87], v[36:39], v[188:191]
 ds_read_b128 v[104:107], v10 offset:2048
 v_mfma_f32_16x16x32_bf16 v[184:187], a[80:83], v[36:39], v[184:187]
 ds_read_b128 v[108:111], v10 offset:3072
 v_mfma_f32_16x16x32_bf16 v[192:195], a[88:91], v[32:35], v[192:195]
 ds_read_b128 v[112:115], v10 offset:4096
 v_mfma_f32_16x16x32_bf16 v[196:199], a[92:95], v[32:35], v[196:199]
 ds_read_b128 v[116:119], v10 offset:5120
 v_mfma_f32_16x16x32_bf16 v[204:207], a[92:95], v[36:39], v[204:207]
 ds_read_b128 v[120:123], v10 offset:6144
 v_mfma_f32_16x16x32_bf16 v[200:203], a[88:91], v[36:39], v[200:203]
 ds_read_b128 v[124:127], v10 offset:7168
 s_waitcnt vmcnt(17)
 v_mfma_f32_16x16x32_bf16 v[144:147], a[96:99], v[40:43], v[144:147]
 s_add_u32 s82, s67, 16781312
 buffer_load_dwordx4 v[32:35], v1, s[48:51], s82 offen offset:0 sc1
 v_mfma_f32_16x16x32_bf16 v[148:151], a[100:103], v[40:43], v[148:151]
 ds_read_b128 v[128:131], v10 offset:8192
 v_mfma_f32_16x16x32_bf16 v[156:159], a[100:103], v[44:47], v[156:159]
 buffer_load_dwordx4 v[36:39], v1, s[48:51], s82 offen offset:1024 sc1
 v_mfma_f32_16x16x32_bf16 v[152:155], a[96:99], v[44:47], v[152:155]
 ds_read_b128 v[132:135], v10 offset:9216
 v_mfma_f32_16x16x32_bf16 v[160:163], a[104:107], v[40:43], v[160:163]
 ds_read_b128 v[136:139], v10 offset:10240
 v_mfma_f32_16x16x32_bf16 v[164:167], a[108:111], v[40:43], v[164:167]
 ds_read_b128 v[140:143], v10 offset:11264
 v_mfma_f32_16x16x32_bf16 v[172:175], a[108:111], v[44:47], v[172:175]
 s_waitcnt lgkmcnt(8)
 v_add_f32 v80, v80, v96
 v_mfma_f32_16x16x32_bf16 v[168:171], a[104:107], v[44:47], v[168:171]
 v_add_f32 v81, v81, v97
 v_add_f32 v82, v82, v98
 v_mfma_f32_16x16x32_bf16 v[176:179], a[112:115], v[40:43], v[176:179]
 v_add_f32 v83, v83, v99
 v_add_f32 v84, v84, v100
 v_mfma_f32_16x16x32_bf16 v[180:183], a[116:119], v[40:43], v[180:183]
 v_add_f32 v85, v85, v101
 v_add_f32 v86, v86, v102
 v_mfma_f32_16x16x32_bf16 v[188:191], a[116:119], v[44:47], v[188:191]
 v_add_f32 v87, v87, v103
 v_add_f32 v88, v88, v104
 v_mfma_f32_16x16x32_bf16 v[184:187], a[112:115], v[44:47], v[184:187]
 v_add_f32 v89, v89, v105
 v_add_f32 v90, v90, v106
 v_mfma_f32_16x16x32_bf16 v[192:195], a[120:123], v[40:43], v[192:195]
 v_add_f32 v91, v91, v107
 v_add_f32 v92, v92, v108
 v_mfma_f32_16x16x32_bf16 v[196:199], a[124:127], v[40:43], v[196:199]
 v_add_f32 v93, v93, v109
 v_add_f32 v94, v94, v110
 v_mfma_f32_16x16x32_bf16 v[204:207], a[124:127], v[44:47], v[204:207]
 v_add_f32 v95, v95, v111
 s_waitcnt lgkmcnt(4)
 v_mfma_f32_16x16x32_bf16 v[200:203], a[120:123], v[44:47], v[200:203]
 v_add_f32 v80, v80, v112
 s_waitcnt vmcnt(17)
 v_mfma_f32_16x16x32_bf16 v[144:147], a[128:131], v[48:51], v[144:147]
 buffer_load_dwordx4 v[40:43], v1, s[48:51], s82 offen offset:2048 sc1
 v_mfma_f32_16x16x32_bf16 v[148:151], a[132:135], v[48:51], v[148:151]
 v_add_f32 v81, v81, v113
 v_add_f32 v82, v82, v114
 v_mfma_f32_16x16x32_bf16 v[156:159], a[132:135], v[52:55], v[156:159]
 buffer_load_dwordx4 v[44:47], v1, s[48:51], s82 offen offset:3072 sc1
 v_mfma_f32_16x16x32_bf16 v[152:155], a[128:131], v[52:55], v[152:155]
 v_add_f32 v83, v83, v115
 v_add_f32 v84, v84, v116
 v_mfma_f32_16x16x32_bf16 v[160:163], a[136:139], v[48:51], v[160:163]
 v_add_f32 v85, v85, v117
 v_add_f32 v86, v86, v118
 v_mfma_f32_16x16x32_bf16 v[164:167], a[140:143], v[48:51], v[164:167]
 v_add_f32 v87, v87, v119
 v_add_f32 v88, v88, v120
 v_mfma_f32_16x16x32_bf16 v[172:175], a[140:143], v[52:55], v[172:175]
 v_add_f32 v89, v89, v121
 v_add_f32 v90, v90, v122
 v_mfma_f32_16x16x32_bf16 v[168:171], a[136:139], v[52:55], v[168:171]
 v_add_f32 v91, v91, v123
 v_add_f32 v92, v92, v124
 v_mfma_f32_16x16x32_bf16 v[176:179], a[144:147], v[48:51], v[176:179]
 v_add_f32 v93, v93, v125
 v_add_f32 v94, v94, v126
 v_mfma_f32_16x16x32_bf16 v[180:183], a[148:151], v[48:51], v[180:183]
 v_add_f32 v95, v95, v127
 s_waitcnt lgkmcnt(0)
 v_mfma_f32_16x16x32_bf16 v[188:191], a[148:151], v[52:55], v[188:191]
 s_barrier
 v_mfma_f32_16x16x32_bf16 v[184:187], a[144:147], v[52:55], v[184:187]
 v_add_f32 v80, v80, v128
 v_add_f32 v81, v81, v129
 v_mfma_f32_16x16x32_bf16 v[192:195], a[152:155], v[48:51], v[192:195]
 v_add_f32 v82, v82, v130
 v_add_f32 v83, v83, v131
 v_mfma_f32_16x16x32_bf16 v[196:199], a[156:159], v[48:51], v[196:199]
 v_add_f32 v84, v84, v132
 v_add_f32 v85, v85, v133
 v_mfma_f32_16x16x32_bf16 v[204:207], a[156:159], v[52:55], v[204:207]
 v_add_f32 v86, v86, v134
 v_add_f32 v87, v87, v135
 v_mfma_f32_16x16x32_bf16 v[200:203], a[152:155], v[52:55], v[200:203]
 v_add_f32 v88, v88, v136
 s_waitcnt vmcnt(17)
 v_mfma_f32_16x16x32_bf16 v[144:147], a[160:163], v[56:59], v[144:147]
 v_add_f32 v89, v89, v137
 v_add_f32 v90, v90, v138
 v_mfma_f32_16x16x32_bf16 v[148:151], a[164:167], v[56:59], v[148:151]
 v_add_f32 v91, v91, v139
 v_add_f32 v92, v92, v140
 v_mfma_f32_16x16x32_bf16 v[156:159], a[164:167], v[60:63], v[156:159]
 v_add_f32 v93, v93, v141
 v_add_f32 v94, v94, v142
 v_mfma_f32_16x16x32_bf16 v[152:155], a[160:163], v[60:63], v[152:155]
 v_add_f32 v95, v95, v143
 v_mul_f32 v80, 0x3e0293ee, v80
 v_mfma_f32_16x16x32_bf16 v[160:163], a[168:171], v[56:59], v[160:163]
 v_mul_f32 v81, 0x3e0293ee, v81
 v_cvt_pk_bf16_f32 v224, v80, v81
 v_mfma_f32_16x16x32_bf16 v[164:167], a[172:175], v[56:59], v[164:167]
 v_mul_f32 v82, 0x3e0293ee, v82
 v_mul_f32 v83, 0x3e0293ee, v83
 v_mfma_f32_16x16x32_bf16 v[172:175], a[172:175], v[60:63], v[172:175]
 v_cvt_pk_bf16_f32 v225, v82, v83
 v_mul_f32 v84, 0x3e0293ee, v84
 v_mfma_f32_16x16x32_bf16 v[168:171], a[168:171], v[60:63], v[168:171]
 v_mul_f32 v85, 0x3e0293ee, v85
 v_cvt_pk_bf16_f32 v226, v84, v85
 v_mfma_f32_16x16x32_bf16 v[176:179], a[176:179], v[56:59], v[176:179]
 v_mul_f32 v86, 0x3e0293ee, v86
 v_mul_f32 v87, 0x3e0293ee, v87
 v_mfma_f32_16x16x32_bf16 v[180:183], a[180:183], v[56:59], v[180:183]
 v_cvt_pk_bf16_f32 v227, v86, v87
 v_mfma_f32_16x16x32_bf16 v[188:191], a[180:183], v[60:63], v[188:191]
 ds_write_b128 v235, v[224:227] offset:16384
 v_mfma_f32_16x16x32_bf16 v[184:187], a[176:179], v[60:63], v[184:187]
 v_mul_f32 v88, 0x3e0293ee, v88
 v_mul_f32 v89, 0x3e0293ee, v89
 v_mfma_f32_16x16x32_bf16 v[192:195], a[184:187], v[56:59], v[192:195]
 s_waitcnt vmcnt(4)
 v_mfma_f32_16x16x32_bf16 v[196:199], a[188:191], v[56:59], v[196:199]
 v_cmp_eq_u32 vcc, -1, v239
 s_mov_b32 s79, -1
 s_cbranch_vccnz notry_75
 s_mov_b32 s79, 0
 s_lshl_b32 s69, s4, 12
 s_add_u32 m0, s69, 147456
 s_nop 0
 buffer_load_dwordx4 v1, s[48:51], s78 offen offset:0 sc1 lds
 buffer_load_dwordx4 v1, s[48:51], s78 offen offset:1024 sc1 lds
 buffer_load_dwordx4 v1, s[48:51], s78 offen offset:2048 sc1 lds
 buffer_load_dwordx4 v1, s[48:51], s78 offen offset:3072 sc1 lds
notry_75:
 v_mfma_f32_16x16x32_bf16 v[204:207], a[188:191], v[60:63], v[204:207]
 v_cvt_pk_bf16_f32 v228, v88, v89
 v_mul_f32 v90, 0x3e0293ee, v90
 v_mfma_f32_16x16x32_bf16 v[200:203], a[184:187], v[60:63], v[200:203]
 v_mul_f32 v91, 0x3e0293ee, v91
 v_mfma_f32_16x16x32_bf16 v[144:147], a[192:195], v[64:67], v[144:147]
 v_cvt_pk_bf16_f32 v229, v90, v91
 v_mul_f32 v92, 0x3e0293ee, v92
 v_mfma_f32_16x16x32_bf16 v[148:151], a[196:199], v[64:67], v[148:151]
 v_mul_f32 v93, 0x3e0293ee, v93
 v_cvt_pk_bf16_f32 v230, v92, v93
 v_mfma_f32_16x16x32_bf16 v[156:159], a[196:199], v[68:71], v[156:159]
 v_mul_f32 v94, 0x3e0293ee, v94
 v_mul_f32 v95, 0x3e0293ee, v95
 v_mfma_f32_16x16x32_bf16 v[152:155], a[192:195], v[68:71], v[152:155]
 v_cvt_pk_bf16_f32 v231, v94, v95
 v_mfma_f32_16x16x32_bf16 v[160:163], a[200:203], v[64:67], v[160:163]
 ds_write_b128 v235, v[228:231] offset:16640
 v_mfma_f32_16x16x32_bf16 v[164:167], a[204:207], v[64:67], v[164:167]
 v_mfma_f32_16x16x32_bf16 v[172:175], a[204:207], v[68:71], v[172:175]
 v_mfma_f32_16x16x32_bf16 v[168:171], a[200:203], v[68:71], v[168:171]
 v_mfma_f32_16x16x32_bf16 v[176:179], a[208:211], v[64:67], v[176:179]
 v_mfma_f32_16x16x32_bf16 v[180:183], a[212:215], v[64:67], v[180:183]
 v_mfma_f32_16x16x32_bf16 v[188:191], a[212:215], v[68:71], v[188:191]
 v_mfma_f32_16x16x32_bf16 v[184:187], a[208:211], v[68:71], v[184:187]
 v_mfma_f32_16x16x32_bf16 v[192:195], a[216:219], v[64:67], v[192:195]
 v_mfma_f32_16x16x32_bf16 v[196:199], a[220:223], v[64:67], v[196:199]
 v_mfma_f32_16x16x32_bf16 v[204:207], a[220:223], v[68:71], v[204:207]
 v_mfma_f32_16x16x32_bf16 v[200:203], a[216:219], v[68:71], v[200:203]
 v_mfma_f32_16x16x32_bf16 v[144:147], a[224:227], v[72:75], v[144:147]
 v_mfma_f32_16x16x32_bf16 v[148:151], a[228:231], v[72:75], v[148:151]
 v_mfma_f32_16x16x32_bf16 v[156:159], a[228:231], v[76:79], v[156:159]
 v_mfma_f32_16x16x32_bf16 v[152:155], a[224:227], v[76:79], v[152:155]
 v_mfma_f32_16x16x32_bf16 v[160:163], a[232:235], v[72:75], v[160:163]
 ds_read_b128 v[48:51], v237 offset:0
 v_mfma_f32_16x16x32_bf16 v[164:167], a[236:239], v[72:75], v[164:167]
 ds_read_b128 v[52:55], v237 offset:1024
 v_mfma_f32_16x16x32_bf16 v[172:175], a[236:239], v[76:79], v[172:175]
 ds_read_b128 v[56:59], v237 offset:2048
 v_mfma_f32_16x16x32_bf16 v[168:171], a[232:235], v[76:79], v[168:171]
 ds_read_b128 v[60:63], v237 offset:3072
 v_mfma_f32_16x16x32_bf16 v[176:179], a[240:243], v[72:75], v[176:179]
 ds_read_b128 v[64:67], v237 offset:4096
 v_mfma_f32_16x16x32_bf16 v[180:183], a[244:247], v[72:75], v[180:183]
 ds_read_b128 v[68:71], v237 offset:5120
 v_mfma_f32_16x16x32_bf16 v[188:191], a[244:247], v[76:79], v[188:191]
 v_mfma_f32_16x16x32_bf16 v[184:187], a[240:243], v[76:79], v[184:187]
 v_mfma_f32_16x16x32_bf16 v[192:195], a[248:251], v[72:75], v[192:195]
 v_mfma_f32_16x16x32_bf16 v[196:199], a[252:255], v[72:75], v[196:199]
 v_mfma_f32_16x16x32_bf16 v[204:207], a[252:255], v[76:79], v[204:207]
 v_mfma_f32_16x16x32_bf16 v[200:203], a[248:251], v[76:79], v[200:203]
 s_cmp_eq_u32 s72, -1
 s_cbranch_scc0 Lw_Qatt
 s_waitcnt vmcnt(0)
 s_waitcnt lgkmcnt(0)
 s_add_u32 s82, s65, 0
 buffer_load_dwordx4 v[16:19], v2, s[48:51], s82 offen offset:0 sc1
 buffer_load_dwordx4 v[20:23], v2, s[48:51], s82 offen offset:256 sc1
 buffer_load_dwordx4 v[24:27], v2, s[48:51], s82 offen offset:2048 sc1
 buffer_load_dwordx4 v[28:31], v2, s[48:51], s82 offen offset:2304 sc1
 s_add_u32 s82, s65, 4096
 buffer_load_dwordx4 v[32:35], v2, s[48:51], s82 offen offset:0 sc1
 buffer_load_dwordx4 v[36:39], v2, s[48:51], s82 offen offset:256 sc1
 buffer_load_dwordx4 v[40:43], v2, s[48:51], s82 offen offset:2048 sc1
 buffer_load_dwordx4 v[44:47], v2, s[48:51], s82 offen offset:2304 sc1
 s_add_u32 s82, s65, 8192
 buffer_load_dwordx4 v[48:51], v2, s[48:51], s82 offen offset:0 sc1
 buffer_load_dwordx4 v[52:55], v2, s[48:51], s82 offen offset:256 sc1
 buffer_load_dwordx4 v[56:59], v2, s[48:51], s82 offen offset:2048 sc1
 buffer_load_dwordx4 v[60:63], v2, s[48:51], s82 offen offset:2304 sc1
 s_add_u32 s82, s65, 12288
 buffer_load_dwordx4 v[64:67], v2, s[48:51], s82 offen offset:0 sc1
 buffer_load_dwordx4 v[68:71], v2, s[48:51], s82 offen offset:256 sc1
 buffer_load_dwordx4 v[72:75], v2, s[48:51], s82 offen offset:2048 sc1
 buffer_load_dwordx4 v[76:79], v2, s[48:51], s82 offen offset:2304 sc1
 s_lshl_b32 s76, s62, 13
 s_lshr_b32 s66, s62, 1
 s_lshl_b32 s66, s66, 1
 s_add_u32 s66, s66, s64
 s_lshl_b32 s66, s66, 1
 s_and_b32 s69, s62, 1
 s_add_u32 s66, s66, s69
 s_lshl_b32 s66, s66, 12
 s_add_u32 s66, s66, 155189248
 s_waitcnt vmcnt(0)
 s_branch Lw_Qnext
Lw_Qatt:
 ds_read_b128 v[72:75], v237 offset:6144
 ds_read_b128 v[76:79], v237 offset:7168
 s_waitcnt vmcnt(0) lgkmcnt(2)
 v_mfma_f32_32x32x16_bf16 v[208:223], v[16:19], v[48:51], 0
 v_mfma_f32_32x32x16_bf16 v[208:223], v[20:23], v[52:55], v[208:223]
 v_mfma_f32_32x32x16_bf16 v[208:223], v[24:27], v[56:59], v[208:223]
 s_waitcnt lgkmcnt(0)
 v_mfma_f32_32x32x16_bf16 v[208:223], v[28:31], v[60:63], v[208:223]
 ds_read_b32 v80, v5 offset:0
 ds_read_b32 v81, v5 offset:1024
 ds_read_b32 v82, v5 offset:2048
 ds_read_b32 v83, v5 offset:3072
 ds_read_b128 v[96:99], v232 offset:0
 ds_read_b128 v[100:103], v232 offset:512
 ds_read_b128 v[104:107], v232 offset:1024
 ds_read_b128 v[108:111], v232 offset:1536
 ds_read_b128 v[112:115], v232 offset:2048
 ds_read_b128 v[116:119], v232 offset:2560
 ds_read_b128 v[120:123], v232 offset:3072
 ds_read_b128 v[124:127], v232 offset:3584
 v_mfma_f32_32x32x16_bf16 v[208:223], v[32:35], v[64:67], v[208:223]
 v_mfma_f32_32x32x16_bf16 v[208:223], v[36:39], v[68:71], v[208:223]
 v_mfma_f32_32x32x16_bf16 v[208:223], v[40:43], v[72:75], v[208:223]
 s_waitcnt lgkmcnt(8)
 v_max3_u32 v80, v80, v81, v82
 v_max3_u32 v80, v80, v83, s79
 v_cmp_eq_u32 vcc, -1, v80
 v_mfma_f32_32x32x16_bf16 v[208:223], v[44:47], v[76:79], v[208:223]
 s_cbranch_vccz okm_78
 s_cmp_eq_u32 s79, 0
 s_cbranch_scc1 fetchm_77
pollm_76:
 buffer_load_dword v239, v251, s[48:51], s78 offen offset:4080 sc1
 s_waitcnt vmcnt(0)
 v_cmp_eq_u32 vcc, -1, v239
 s_cbranch_vccz fetchm_77
 s_sleep 1
 s_sub_u32 s46, s46, 1
 s_cbranch_scc0 pollm_76
 s_mov_b32 s46, 0
 s_branch fetchm_77
fetchm_77:
 s_mov_b32 s79, 0
 s_waitcnt lgkmcnt(0)
 s_lshl_b32 s69, s4, 12
 s_add_u32 m0, s69, 147456
 s_nop 0
 buffer_load_dwordx4 v1, s[48:51], s78 offen offset:0 sc1 lds
 buffer_load_dwordx4 v1, s[48:51], s78 offen offset:1024 sc1 lds
 buffer_load_dwordx4 v1, s[48:51], s78 offen offset:2048 sc1 lds
 buffer_load_dwordx4 v1, s[48:51], s78 offen offset:3072 sc1 lds
 s_waitcnt vmcnt(0)
 ds_read_b32 v80, v5 offset:0
 ds_read_b32 v81, v5 offset:1024
 ds_read_b32 v82, v5 offset:2048
 ds_read_b32 v83, v5 offset:3072
 ds_read_b128 v[96:99], v232 offset:0
 ds_read_b128 v[100:103], v232 offset:512
 ds_read_b128 v[104:107], v232 offset:1024
 ds_read_b128 v[108:111], v232 offset:1536
 ds_read_b128 v[112:115], v232 offset:2048
 ds_read_b128 v[116:119], v232 offset:2560
 ds_read_b128 v[120:123], v232 offset:3072
 ds_read_b128 v[124:127], v232 offset:3584
 s_waitcnt lgkmcnt(8)
 v_max3_u32 v80, v80, v81, v82
 v_max3_u32 v80, v80, v83, s79
 v_cmp_eq_u32 vcc, -1, v80
 s_cbranch_vccz okm_78
 s_sub_u32 s46, s46, 1
 s_cbranch_scc0 fetchm_77
 s_mov_b32 s46, 0
 s_branch okm_78
okm_78:
 s_waitcnt lgkmcnt(7)
 v_mfma_f32_32x32x16_bf16 v[80:95], v[96:99], v[48:51], 0
 s_add_u32 s82, s65, 0
 buffer_load_dwordx4 v[16:19], v2, s[48:51], s82 offen offset:0 sc1
 v_mov_b32 v240, 0xceabdc6e
 s_nop 0
 v_cndmask_b32 v208, v240, v208, s[8:9]
 v_cndmask_b32 v209, v240, v209, s[10:11]
 v_cndmask_b32 v210, v240, v210, s[12:13]
 s_waitcnt lgkmcnt(6)
 v_mfma_f32_32x32x16_bf16 v[80:95], v[100:103], v[52:55], v[80:95]
 buffer_load_dwordx4 v[20:23], v2, s[48:51], s82 offen offset:256 sc1
 v_cndmask_b32 v211, v240, v211, s[14:15]
 v_cndmask_b32 v212, v240, v212, s[16:17]
 v_cndmask_b32 v213, v240, v213, s[18:19]
 v_cndmask_b32 v214, v240, v214, s[20:21]
 s_waitcnt lgkmcnt(5)
 v_mfma_f32_32x32x16_bf16 v[80:95], v[104:107], v[56:59], v[80:95]
 buffer_load_dwordx4 v[24:27], v2, s[48:51], s82 offen offset:2048 sc1
 v_cndmask_b32 v215, v240, v215, s[22:23]
 v_cndmask_b32 v216, v240, v216, s[24:25]
 v_cndmask_b32 v217, v240, v217, s[26:27]
 v_cndmask_b32 v218, v240, v218, s[28:29]
 s_waitcnt lgkmcnt(4)
 v_mfma_f32_32x32x16_bf16 v[80:95], v[108:111], v[60:63], v[80:95]
 buffer_load_dwordx4 v[28:31], v2, s[48:51], s82 offen offset:2304 sc1
 v_cndmask_b32 v219, v240, v219, s[30:31]
 v_cndmask_b32 v220, v240, v220, s[32:33]
 v_cndmask_b32 v221, v240, v221, s[34:35]
 v_cndmask_b32 v222, v240, v222, s[36:37]
 s_waitcnt lgkmcnt(3)
 v_mfma_f32_32x32x16_bf16 v[80:95], v[112:115], v[64:67], v[80:95]
 v_cndmask_b32 v223, v240, v223, s[38:39]
 v_max3_f32 v240, v208, v209, v210
 v_max3_f32 v240, v240, v211, v212
 v_max3_f32 v240, v240, v213, v214
 s_waitcnt lgkmcnt(2)
 v_mfma_f32_32x32x16_bf16 v[80:95], v[116:119], v[68:71], v[80:95]
 v_max3_f32 v240, v240, v215, v216
 v_max3_f32 v240, v240, v217, v218
 v_max3_f32 v240, v240, v219, v220
 v_max3_f32 v240, v240, v221, v222
 s_waitcnt lgkmcnt(1)
 v_mfma_f32_32x32x16_bf16 v[80:95], v[120:123], v[72:75], v[80:95]
 v_max_f32 v240, v240, v223
 s_waitcnt lgkmcnt(0)
 v_mfma_f32_32x32x16_bf16 v[80:95], v[124:127], v[76:79], v[80:95]
 s_nop 11
 v_max3_f32 v240, v240, v80, v81
 v_max3_f32 v240, v240, v82, v83
 v_mov_b32 v242, v240
 s_nop 1
 v_permlane32_swap_b32 v240, v242
 v_max_f32 v240, v240, v242
 v_pk_add_f32 v[208:209], v[208:209], v[240:241] op_sel_hi:[1,0] neg_lo:[0,1] neg_hi:[0,1]
 v_pk_add_f32 v[210:211], v[210:211], v[240:241] op_sel_hi:[1,0] neg_lo:[0,1] neg_hi:[0,1]
 v_pk_add_f32 v[212:213], v[212:213], v[240:241] op_sel_hi:[1,0] neg_lo:[0,1] neg_hi:[0,1]
 v_pk_add_f32 v[214:215], v[214:215], v[240:241] op_sel_hi:[1,0] neg_lo:[0,1] neg_hi:[0,1]
 v_pk_add_f32 v[216:217], v[216:217], v[240:241] op_sel_hi:[1,0] neg_lo:[0,1] neg_hi:[0,1]
 v_pk_add_f32 v[218:219], v[218:219], v[240:241] op_sel_hi:[1,0] neg_lo:[0,1] neg_hi:[0,1]
 v_pk_add_f32 v[220:221], v[220:221], v[240:241] op_sel_hi:[1,0] neg_lo:[0,1] neg_hi:[0,1]
 v_pk_add_f32 v[222:223], v[222:223], v[240:241] op_sel_hi:[1,0] neg_lo:[0,1] neg_hi:[0,1]
 v_pk_add_f32 v[224:225], v[80:81], v[240:241] op_sel_hi:[1,0] neg_lo:[0,1] neg_hi:[0,1]
 v_pk_add_f32 v[226:227], v[82:83], v[240:241] op_sel_hi:[1,0] neg_lo:[0,1] neg_hi:[0,1]
 ds_read_b128 v[80:83], v238 offset:0
 ds_read_b128 v[84:87], v238 offset:1024
 ds_read_b32 v88, v233 offset:0
 ds_read_b32 v89, v233 offset:256
 ds_read_b128 v[92:95], v238 offset:2048
 ds_read_b128 v[96:99], v238 offset:3072
 ds_read_b32 v100, v233 offset:1024
 ds_read_b32 v101, v233 offset:1280
 v_mov_b64 v[90:91], 0
 v_mov_b64 v[102:103], 0
 v_mov_b64 v[254:255], 0
 v_exp_f32 v208, v208
 v_exp_f32 v209, v209
 v_exp_f32 v210, v210
 v_exp_f32 v211, v211
 v_exp_f32 v212, v212
 v_exp_f32 v213, v213
 v_pk_add_f32 v[242:243], v[208:209], v[210:211]
 v_exp_f32 v214, v214
 v_exp_f32 v215, v215
 v_pk_add_f32 v[242:243], v[242:243], v[212:213]
 v_exp_f32 v216, v216
 v_exp_f32 v217, v217
 v_pk_add_f32 v[242:243], v[242:243], v[214:215]
 v_exp_f32 v218, v218
 v_exp_f32 v219, v219
 v_pk_add_f32 v[242:243], v[242:243], v[216:217]
 v_exp_f32 v220, v220
 v_exp_f32 v221, v221
 v_pk_add_f32 v[242:243], v[242:243], v[218:219]
 v_exp_f32 v222, v222
 v_exp_f32 v223, v223
 v_pk_add_f32 v[242:243], v[242:243], v[220:221]
 v_exp_f32 v224, v224
 v_exp_f32 v225, v225
 v_pk_add_f32 v[242:243], v[242:243], v[222:223]
 v_exp_f32 v226, v226
 v_exp_f32 v227, v227
 v_pk_add_f32 v[242:243], v[242:243], v[224:225]
 v_pk_add_f32 v[242:243], v[242:243], v[226:227]
 v_add_f32 v242, v242, v243
 v_mov_b32 v243, v242
 s_nop 1
 v_permlane32_swap_b32 v242, v243
 v_add_f32 v242, v242, v243
 v_rcp_f32 v242, v242
 s_nop 0
 v_pk_mul_f32 v[208:209], v[208:209], v[242:243] op_sel_hi:[1,0]
 v_cvt_pk_bf16_f32 v136, v208, v209
 v_pk_mul_f32 v[210:211], v[210:211], v[242:243] op_sel_hi:[1,0]
 v_cvt_pk_bf16_f32 v137, v210, v211
 v_pk_mul_f32 v[212:213], v[212:213], v[242:243] op_sel_hi:[1,0]
 v_cvt_pk_bf16_f32 v138, v212, v213
 v_pk_mul_f32 v[214:215], v[214:215], v[242:243] op_sel_hi:[1,0]
 v_cvt_pk_bf16_f32 v139, v214, v215
 v_pk_mul_f32 v[216:217], v[216:217], v[242:243] op_sel_hi:[1,0]
 v_cvt_pk_bf16_f32 v140, v216, v217
 v_pk_mul_f32 v[218:219], v[218:219], v[242:243] op_sel_hi:[1,0]
 v_cvt_pk_bf16_f32 v141, v218, v219
 v_pk_mul_f32 v[220:221], v[220:221], v[242:243] op_sel_hi:[1,0]
 v_cvt_pk_bf16_f32 v142, v220, v221
 v_pk_mul_f32 v[222:223], v[222:223], v[242:243] op_sel_hi:[1,0]
 v_cvt_pk_bf16_f32 v143, v222, v223
 v_pk_mul_f32 v[224:225], v[224:225], v[242:243] op_sel_hi:[1,0]
 v_cvt_pk_bf16_f32 v252, v224, v225
 v_pk_mul_f32 v[226:227], v[226:227], v[242:243] op_sel_hi:[1,0]
 v_cvt_pk_bf16_f32 v253, v226, v227
 s_waitcnt lgkmcnt(4)
 v_mfma_f32_32x32x16_bf16 v[104:119], v[80:83], v[136:139], 0
 v_mfma_f32_32x32x16_bf16 v[104:119], v[84:87], v[140:143], v[104:119]
 v_mfma_f32_32x32x16_bf16 v[104:119], v[88:91], v[252:255], v[104:119]
 ds_read_b128 v[80:83], v238 offset:4096
 ds_read_b128 v[84:87], v238 offset:5120
 ds_read_b32 v88, v233 offset:2048
 ds_read_b32 v89, v233 offset:2304
 s_waitcnt lgkmcnt(4)
 v_mfma_f32_32x32x16_bf16 v[120:135], v[92:95], v[136:139], 0
 v_mfma_f32_32x32x16_bf16 v[120:135], v[96:99], v[140:143], v[120:135]
 s_add_u32 s69, s67, 33554432
 v_cvt_pk_bf16_f32 v208, v104, v105
 v_cvt_pk_bf16_f32 v209, v106, v107
 v_cvt_pk_bf16_f32 v210, v108, v109
 v_cvt_pk_bf16_f32 v211, v110, v111
 buffer_store_dwordx4 v[208:211], v1, s[48:51], s69 offen offset:0
 v_mfma_f32_32x32x16_bf16 v[120:135], v[100:103], v[252:255], v[120:135]
 v_cvt_pk_bf16_f32 v212, v112, v113
 v_cvt_pk_bf16_f32 v213, v114, v115
 v_cvt_pk_bf16_f32 v214, v116, v117
 v_cvt_pk_bf16_f32 v215, v118, v119
 buffer_store_dwordx4 v[212:215], v1, s[48:51], s69 offen offset:1024
 ds_read_b128 v[92:95], v238 offset:6144
 ds_read_b128 v[96:99], v238 offset:7168
 ds_read_b32 v100, v233 offset:3072
 ds_read_b32 v101, v233 offset:3328
 s_waitcnt lgkmcnt(4)
 v_mfma_f32_32x32x16_bf16 v[104:119], v[80:83], v[136:139], 0
 v_mfma_f32_32x32x16_bf16 v[104:119], v[84:87], v[140:143], v[104:119]
 s_add_u32 s69, s67, 33556480
 v_cvt_pk_bf16_f32 v216, v120, v121
 v_cvt_pk_bf16_f32 v217, v122, v123
 v_cvt_pk_bf16_f32 v218, v124, v125
 v_cvt_pk_bf16_f32 v219, v126, v127
 buffer_store_dwordx4 v[216:219], v1, s[48:51], s69 offen offset:0
 v_mfma_f32_32x32x16_bf16 v[104:119], v[88:91], v[252:255], v[104:119]
 v_cvt_pk_bf16_f32 v220, v128, v129
 v_cvt_pk_bf16_f32 v221, v130, v131
 v_cvt_pk_bf16_f32 v222, v132, v133
 v_cvt_pk_bf16_f32 v223, v134, v135
 buffer_store_dwordx4 v[220:223], v1, s[48:51], s69 offen offset:1024
 s_waitcnt lgkmcnt(0)
 v_mfma_f32_32x32x16_bf16 v[120:135], v[92:95], v[136:139], 0
 v_mfma_f32_32x32x16_bf16 v[120:135], v[96:99], v[140:143], v[120:135]
 s_add_u32 s69, s67, 33558528
 v_cvt_pk_bf16_f32 v208, v104, v105
 v_cvt_pk_bf16_f32 v209, v106, v107
 v_cvt_pk_bf16_f32 v210, v108, v109
 v_cvt_pk_bf16_f32 v211, v110, v111
 buffer_store_dwordx4 v[208:211], v1, s[48:51], s69 offen offset:0
 v_mfma_f32_32x32x16_bf16 v[120:135], v[100:103], v[252:255], v[120:135]
 v_cvt_pk_bf16_f32 v212, v112, v113
 v_cvt_pk_bf16_f32 v213, v114, v115
 v_cvt_pk_bf16_f32 v214, v116, v117
 v_cvt_pk_bf16_f32 v215, v118, v119
 buffer_store_dwordx4 v[212:215], v1, s[48:51], s69 offen offset:1024
 s_add_u32 s69, s67, 33560576
 s_nop 4
 v_cvt_pk_bf16_f32 v216, v120, v121
 v_cvt_pk_bf16_f32 v217, v122, v123
 v_cvt_pk_bf16_f32 v218, v124, v125
 v_cvt_pk_bf16_f32 v219, v126, v127
 buffer_store_dwordx4 v[216:219], v1, s[48:51], s69 offen offset:0
 v_cvt_pk_bf16_f32 v220, v128, v129
 v_cvt_pk_bf16_f32 v221, v130, v131
 v_cvt_pk_bf16_f32 v222, v132, v133
 v_cvt_pk_bf16_f32 v223, v134, v135
 buffer_store_dwordx4 v[220:223], v1, s[48:51], s69 offen offset:1024
 s_cmp_eq_u32 s72, 15
 s_cbranch_scc0 Lw_Qnext
 s_waitcnt vmcnt(0)
 v_mov_b32 v3, 16
 buffer_store_dword v3, v251, s[48:51], s68 offen
 s_branch Lw_end
Lw_Qnext:
 v_swap_b32 v235, v236
 v_subrev_u32 v237, s73, v237
 s_sub_u32 s73, 0, s73
 s_add_u32 s72, s72, 1
 s_add_u32 s65, s65, 0x10000
 s_cmp_eq_u32 s72, 5
 s_cbranch_scc0 Lw_Qloop
news_79:
 v_mov_b32 v3, 0
 global_load_dword v4, v3, s[42:43] offset:132 sc1
 s_waitcnt vmcnt(0)
newschk_81:
 v_readfirstlane_b32 s7, v4
 s_nop 0
 s_and_b32 s7, s7, 8
 s_cmp_eq_u32 s7, 8
 s_cbranch_scc1 newsok_80
 s_sleep 2
 s_sub_u32 s46, s46, 1
 s_cbranch_scc0 news_79
 s_mov_b32 s46, 0
 s_branch newsok_80
newsok_80:
 s_branch Lw_Qloop
Lw_end:
 s_endpgm
Lw_K:
 s_lshl_b32 s67, s62, 2
 s_add_u32 s67, s67, s4
 s_lshl_b32 s67, s67, 11
 s_add_u32 s67, s67, 16777216
 s_add_u32 s65, s65, 0x10000
 v_mov_b32 v232, -1
 v_mov_b32 v233, -1
 v_mov_b32 v234, -1
 v_mov_b32 v235, -1
 s_lshl_b32 s69, s61, 1
 s_lshr_b32 s70, s4, 1
 s_add_u32 s69, s69, s70
 s_lshl_b32 s74, s69, 14
 s_and_b32 s69, s4, 1
 s_lshl_b32 s69, s69, 12
 s_add_u32 s74, s74, s69
 s_lshl_b32 s69, s47, 10
 s_add_u32 s74, s74, s69
 s_add_u32 s74, s74, 134217728
 s_lshl_b32 s69, s64, 13
 s_add_u32 s74, s74, s69
 v_mfma_f32_16x16x32_bf16 v[80:83], a[0:3], v[16:19], 0
 v_mfma_f32_16x16x32_bf16 v[84:87], a[4:7], v[16:19], 0
 v_mfma_f32_16x16x32_bf16 v[92:95], a[4:7], v[20:23], 0
 v_mfma_f32_16x16x32_bf16 v[88:91], a[0:3], v[20:23], 0
 v_mfma_f32_16x16x32_bf16 v[96:99], a[8:11], v[16:19], 0
 v_mfma_f32_16x16x32_bf16 v[100:103], a[12:15], v[16:19], 0
 v_mfma_f32_16x16x32_bf16 v[108:111], a[12:15], v[20:23], 0
 v_mfma_f32_16x16x32_bf16 v[104:107], a[8:11], v[20:23], 0
 v_mfma_f32_16x16x32_bf16 v[112:115], a[16:19], v[16:19], 0
 v_mfma_f32_16x16x32_bf16 v[116:119], a[20:23], v[16:19], 0
 v_mfma_f32_16x16x32_bf16 v[124:127], a[20:23], v[20:23], 0
 v_mfma_f32_16x16x32_bf16 v[120:123], a[16:19], v[20:23], 0
 v_mfma_f32_16x16x32_bf16 v[128:131], a[24:27], v[16:19], 0
 v_mfma_f32_16x16x32_bf16 v[132:135], a[28:31], v[16:19], 0
 v_mfma_f32_16x16x32_bf16 v[140:143], a[28:31], v[20:23], 0
 v_mfma_f32_16x16x32_bf16 v[136:139], a[24:27], v[20:23], 0
 v_mfma_f32_16x16x32_bf16 v[80:83], a[32:35], v[24:27], v[80:83]
 s_add_u32 s82, s65, 0
 buffer_load_dwordx4 v[16:19], v2, s[48:51], s82 offen offset:0 sc1
 v_mfma_f32_16x16x32_bf16 v[84:87], a[36:39], v[24:27], v[84:87]
 v_mfma_f32_16x16x32_bf16 v[92:95], a[36:39], v[28:31], v[92:95]
 buffer_load_dwordx4 v[20:23], v2, s[48:51], s82 offen offset:256 sc1
 v_mfma_f32_16x16x32_bf16 v[88:91], a[32:35], v[28:31], v[88:91]
 v_mfma_f32_16x16x32_bf16 v[96:99], a[40:43], v[24:27], v[96:99]
 v_mfma_f32_16x16x32_bf16 v[100:103], a[44:47], v[24:27], v[100:103]
 v_mfma_f32_16x16x32_bf16 v[108:111], a[44:47], v[28:31], v[108:111]
 v_mfma_f32_16x16x32_bf16 v[104:107], a[40:43], v[28:31], v[104:107]
 v_mfma_f32_16x16x32_bf16 v[112:115], a[48:51], v[24:27], v[112:115]
 v_mfma_f32_16x16x32_bf16 v[116:119], a[52:55], v[24:27], v[116:119]
 v_mfma_f32_16x16x32_bf16 v[124:127], a[52:55], v[28:31], v[124:127]
 v_mfma_f32_16x16x32_bf16 v[120:123], a[48:51], v[28:31], v[120:123]
 v_mfma_f32_16x16x32_bf16 v[128:131], a[56:59], v[24:27], v[128:131]
 v_mfma_f32_16x16x32_bf16 v[132:135], a[60:63], v[24:27], v[132:135]
 v_mfma_f32_16x16x32_bf16 v[140:143], a[60:63], v[28:31], v[140:143]
 v_mfma_f32_16x16x32_bf16 v[136:139], a[56:59], v[28:31], v[136:139]
 v_mfma_f32_16x16x32_bf16 v[80:83], a[64:67], v[32:35], v[80:83]
 buffer_load_dwordx4 v[24:27], v2, s[48:51], s82 offen offset:2048 sc1
 v_mfma_f32_16x16x32_bf16 v[84:87], a[68:71], v[32:35], v[84:87]
 v_mfma_f32_16x16x32_bf16 v[92:95], a[68:71], v[36:39], v[92:95]
 buffer_load_dwordx4 v[28:31], v2, s[48:51], s82 offen offset:2304 sc1
 v_mfma_f32_16x16x32_bf16 v[88:91], a[64:67], v[36:39], v[88:91]
 v_mfma_f32_16x16x32_bf16 v[96:99], a[72:75], v[32:35], v[96:99]
 v_mfma_f32_16x16x32_bf16 v[100:103], a[76:79], v[32:35], v[100:103]
 v_mfma_f32_16x16x32_bf16 v[108:111], a[76:79], v[36:39], v[108:111]
 v_mfma_f32_16x16x32_bf16 v[104:107], a[72:75], v[36:39], v[104:107]
 v_mfma_f32_16x16x32_bf16 v[112:115], a[80:83], v[32:35], v[112:115]
 v_mfma_f32_16x16x32_bf16 v[116:119], a[84:87], v[32:35], v[116:119]
 v_mfma_f32_16x16x32_bf16 v[124:127], a[84:87], v[36:39], v[124:127]
 v_mfma_f32_16x16x32_bf16 v[120:123], a[80:83], v[36:39], v[120:123]
 v_mfma_f32_16x16x32_bf16 v[128:131], a[88:91], v[32:35], v[128:131]
 v_mfma_f32_16x16x32_bf16 v[132:135], a[92:95], v[32:35], v[132:135]
 v_mfma_f32_16x16x32_bf16 v[140:143], a[92:95], v[36:39], v[140:143]
 v_mfma_f32_16x16x32_bf16 v[136:139], a[88:91], v[36:39], v[136:139]
 v_mfma_f32_16x16x32_bf16 v[80:83], a[96:99], v[40:43], v[80:83]
 s_add_u32 s82, s65, 4096
 buffer_load_dwordx4 v[32:35], v2, s[48:51], s82 offen offset:0 sc1
 v_mfma_f32_16x16x32_bf16 v[84:87], a[100:103], v[40:43], v[84:87]
 v_mfma_f32_16x16x32_bf16 v[92:95], a[100:103], v[44:47], v[92:95]
 buffer_load_dwordx4 v[36:39], v2, s[48:51], s82 offen offset:256 sc1
 v_mfma_f32_16x16x32_bf16 v[88:91], a[96:99], v[44:47], v[88:91]
 v_mfma_f32_16x16x32_bf16 v[96:99], a[104:107], v[40:43], v[96:99]
 v_mfma_f32_16x16x32_bf16 v[100:103], a[108:111], v[40:43], v[100:103]
 v_mfma_f32_16x16x32_bf16 v[108:111], a[108:111], v[44:47], v[108:111]
 v_mfma_f32_16x16x32_bf16 v[104:107], a[104:107], v[44:47], v[104:107]
 v_mfma_f32_16x16x32_bf16 v[112:115], a[112:115], v[40:43], v[112:115]
 v_mfma_f32_16x16x32_bf16 v[116:119], a[116:119], v[40:43], v[116:119]
 v_mfma_f32_16x16x32_bf16 v[124:127], a[116:119], v[44:47], v[124:127]
 v_mfma_f32_16x16x32_bf16 v[120:123], a[112:115], v[44:47], v[120:123]
 v_mfma_f32_16x16x32_bf16 v[128:131], a[120:123], v[40:43], v[128:131]
 v_mfma_f32_16x16x32_bf16 v[132:135], a[124:127], v[40:43], v[132:135]
 v_mfma_f32_16x16x32_bf16 v[140:143], a[124:127], v[44:47], v[140:143]
 v_mfma_f32_16x16x32_bf16 v[136:139], a[120:123], v[44:47], v[136:139]
 v_mfma_f32_16x16x32_bf16 v[80:83], a[128:131], v[48:51], v[80:83]
 buffer_load_dwordx4 v[40:43], v2, s[48:51], s82 offen offset:2048 sc1
 v_mfma_f32_16x16x32_bf16 v[84:87], a[132:135], v[48:51], v[84:87]
 v_mfma_f32_16x16x32_bf16 v[92:95], a[132:135], v[52:55], v[92:95]
 buffer_load_dwordx4 v[44:47], v2, s[48:51], s82 offen offset:2304 sc1
 v_mfma_f32_16x16x32_bf16 v[88:91], a[128:131], v[52:55], v[88:91]
 v_mfma_f32_16x16x32_bf16 v[96:99], a[136:139], v[48:51], v[96:99]
 s_waitcnt vmcnt(16)
 v_mfma_f32_16x16x32_bf16 v[100:103], a[140:143], v[48:51], v[100:103]
 ds_read_b64_tr_b16 a[192:193], v209 offset:16384
 v_mfma_f32_16x16x32_bf16 v[108:111], a[140:143], v[52:55], v[108:111]
 ds_read_b64_tr_b16 a[194:195], v209 offset:17408
 v_mfma_f32_16x16x32_bf16 v[104:107], a[136:139], v[52:55], v[104:107]
 ds_read_b64_tr_b16 a[196:197], v210 offset:16384
 v_mfma_f32_16x16x32_bf16 v[112:115], a[144:147], v[48:51], v[112:115]
 ds_read_b64_tr_b16 a[198:199], v210 offset:17408
 v_mfma_f32_16x16x32_bf16 v[116:119], a[148:151], v[48:51], v[116:119]
 ds_read_b64_tr_b16 a[200:201], v211 offset:16384
 v_mfma_f32_16x16x32_bf16 v[124:127], a[148:151], v[52:55], v[124:127]
 ds_read_b64_tr_b16 a[202:203], v211 offset:17408
 v_mfma_f32_16x16x32_bf16 v[120:123], a[144:147], v[52:55], v[120:123]
 ds_read_b64_tr_b16 a[204:205], v212 offset:16384
 v_mfma_f32_16x16x32_bf16 v[128:131], a[152:155], v[48:51], v[128:131]
 ds_read_b64_tr_b16 a[206:207], v212 offset:17408
 v_mfma_f32_16x16x32_bf16 v[132:135], a[156:159], v[48:51], v[132:135]
 s_waitcnt lgkmcnt(0)
 v_mfma_f32_16x16x32_bf16 v[140:143], a[156:159], v[52:55], v[140:143]
 ds_read_b64_tr_b16 a[208:209], v213 offset:16384
 v_mfma_f32_16x16x32_bf16 v[136:139], a[152:155], v[52:55], v[136:139]
 ds_read_b64_tr_b16 a[210:211], v213 offset:17408
 v_mfma_f32_16x16x32_bf16 v[80:83], a[160:163], v[56:59], v[80:83]
 s_add_u32 s82, s65, 8192
 buffer_load_dwordx4 v[48:51], v2, s[48:51], s82 offen offset:0 sc1
 v_mfma_f32_16x16x32_bf16 v[84:87], a[164:167], v[56:59], v[84:87]
 ds_read_b64_tr_b16 a[212:213], v214 offset:16384
 v_mfma_f32_16x16x32_bf16 v[92:95], a[164:167], v[60:63], v[92:95]
 buffer_load_dwordx4 v[52:55], v2, s[48:51], s82 offen offset:256 sc1
 v_mfma_f32_16x16x32_bf16 v[88:91], a[160:163], v[60:63], v[88:91]
 ds_read_b64_tr_b16 a[214:215], v214 offset:17408
 v_mfma_f32_16x16x32_bf16 v[96:99], a[168:171], v[56:59], v[96:99]
 ds_read_b64_tr_b16 a[216:217], v215 offset:16384
 v_mfma_f32_16x16x32_bf16 v[100:103], a[172:175], v[56:59], v[100:103]
 ds_read_b64_tr_b16 a[218:219], v215 offset:17408
 v_mfma_f32_16x16x32_bf16 v[108:111], a[172:175], v[60:63], v[108:111]
 ds_read_b64_tr_b16 a[220:221], v216 offset:16384
 v_mfma_f32_16x16x32_bf16 v[104:107], a[168:171], v[60:63], v[104:107]
 ds_read_b64_tr_b16 a[222:223], v216 offset:17408
 v_mfma_f32_16x16x32_bf16 v[112:115], a[176:179], v[56:59], v[112:115]
 s_waitcnt lgkmcnt(0)
 v_mfma_f32_16x16x32_bf16 v[116:119], a[180:183], v[56:59], v[116:119]
 v_mfma_f32_16x16x32_bf16 v[124:127], a[180:183], v[60:63], v[124:127]
 s_waitcnt vmcnt(10)
 v_mfma_f32_16x16x32_bf16 v[120:123], a[176:179], v[60:63], v[120:123]
 ds_read_b64_tr_b16 a[224:225], v209 offset:24576
 v_mfma_f32_16x16x32_bf16 v[128:131], a[184:187], v[56:59], v[128:131]
 ds_read_b64_tr_b16 a[226:227], v209 offset:25600
 v_mfma_f32_16x16x32_bf16 v[132:135], a[188:191], v[56:59], v[132:135]
 ds_read_b64_tr_b16 a[228:229], v210 offset:24576
 v_mfma_f32_16x16x32_bf16 v[140:143], a[188:191], v[60:63], v[140:143]
 ds_read_b64_tr_b16 a[230:231], v210 offset:25600
 v_mfma_f32_16x16x32_bf16 v[136:139], a[184:187], v[60:63], v[136:139]
 ds_read_b64_tr_b16 a[232:233], v211 offset:24576
 v_mfma_f32_16x16x32_bf16 v[80:83], a[192:195], v[64:67], v[80:83]
 buffer_load_dwordx4 v[56:59], v2, s[48:51], s82 offen offset:2048 sc1
 v_mfma_f32_16x16x32_bf16 v[84:87], a[196:199], v[64:67], v[84:87]
 ds_read_b64_tr_b16 a[234:235], v211 offset:25600
 v_mfma_f32_16x16x32_bf16 v[92:95], a[196:199], v[68:71], v[92:95]
 buffer_load_dwordx4 v[60:63], v2, s[48:51], s82 offen offset:2304 sc1
 v_mfma_f32_16x16x32_bf16 v[88:91], a[192:195], v[68:71], v[88:91]
 ds_read_b64_tr_b16 a[236:237], v212 offset:24576
 v_mfma_f32_16x16x32_bf16 v[96:99], a[200:203], v[64:67], v[96:99]
 ds_read_b64_tr_b16 a[238:239], v212 offset:25600
 v_mfma_f32_16x16x32_bf16 v[100:103], a[204:207], v[64:67], v[100:103]
 s_waitcnt lgkmcnt(0)
 v_mfma_f32_16x16x32_bf16 v[108:111], a[204:207], v[68:71], v[108:111]
 ds_read_b64_tr_b16 a[240:241], v213 offset:24576
 v_mfma_f32_16x16x32_bf16 v[104:107], a[200:203], v[68:71], v[104:107]
 ds_read_b64_tr_b16 a[242:243], v213 offset:25600
 v_mfma_f32_16x16x32_bf16 v[112:115], a[208:211], v[64:67], v[112:115]
 ds_read_b64_tr_b16 a[244:245], v214 offset:24576
 v_mfma_f32_16x16x32_bf16 v[116:119], a[212:215], v[64:67], v[116:119]
 ds_read_b64_tr_b16 a[246:247], v214 offset:25600
 v_mfma_f32_16x16x32_bf16 v[124:127], a[212:215], v[68:71], v[124:127]
 ds_read_b64_tr_b16 a[248:249], v215 offset:24576
 v_mfma_f32_16x16x32_bf16 v[120:123], a[208:211], v[68:71], v[120:123]
 ds_read_b64_tr_b16 a[250:251], v215 offset:25600
 v_mfma_f32_16x16x32_bf16 v[128:131], a[216:219], v[64:67], v[128:131]
 ds_read_b64_tr_b16 a[252:253], v216 offset:24576
 v_mfma_f32_16x16x32_bf16 v[132:135], a[220:223], v[64:67], v[132:135]
 ds_read_b64_tr_b16 a[254:255], v216 offset:25600
 v_mfma_f32_16x16x32_bf16 v[140:143], a[220:223], v[68:71], v[140:143]
 s_waitcnt lgkmcnt(0)
 v_mfma_f32_16x16x32_bf16 v[136:139], a[216:219], v[68:71], v[136:139]
 v_mfma_f32_16x16x32_bf16 v[80:83], a[224:227], v[72:75], v[80:83]
 s_add_u32 s82, s65, 12288
 buffer_load_dwordx4 v[64:67], v2, s[48:51], s82 offen offset:0 sc1
 v_mfma_f32_16x16x32_bf16 v[84:87], a[228:231], v[72:75], v[84:87]
 v_mfma_f32_16x16x32_bf16 v[92:95], a[228:231], v[76:79], v[92:95]
 buffer_load_dwordx4 v[68:71], v2, s[48:51], s82 offen offset:256 sc1
 v_mfma_f32_16x16x32_bf16 v[88:91], a[224:227], v[76:79], v[88:91]
 s_add_u32 s70, s65, 131072
 v_mfma_f32_16x16x32_bf16 v[96:99], a[232:235], v[72:75], v[96:99]
 buffer_load_dwordx4 v[12:15], v11, s[48:51], s70 offen offset:0 sc1
 v_mfma_f32_16x16x32_bf16 v[100:103], a[236:239], v[72:75], v[100:103]
 s_add_u32 s65, s65, 0x10000
 s_add_u32 s63, s63, 1
 v_mfma_f32_16x16x32_bf16 v[108:111], a[236:239], v[76:79], v[108:111]
 v_mfma_f32_16x16x32_bf16 v[104:107], a[232:235], v[76:79], v[104:107]
 v_mfma_f32_16x16x32_bf16 v[112:115], a[240:243], v[72:75], v[112:115]
 v_mfma_f32_16x16x32_bf16 v[116:119], a[244:247], v[72:75], v[116:119]
 v_mfma_f32_16x16x32_bf16 v[124:127], a[244:247], v[76:79], v[124:127]
 v_mfma_f32_16x16x32_bf16 v[120:123], a[240:243], v[76:79], v[120:123]
 v_mfma_f32_16x16x32_bf16 v[128:131], a[248:251], v[72:75], v[128:131]
 v_mfma_f32_16x16x32_bf16 v[132:135], a[252:255], v[72:75], v[132:135]
 v_mfma_f32_16x16x32_bf16 v[140:143], a[252:255], v[76:79], v[140:143]
 v_mfma_f32_16x16x32_bf16 v[136:139], a[248:251], v[76:79], v[136:139]
 s_barrier
 ds_write_b128 v7, v[96:99] offset:0
 ds_write_b128 v7, v[100:103] offset:1024
 ds_write_b128 v7, v[104:107] offset:2048
 ds_write_b128 v7, v[108:111] offset:3072
 ds_write_b128 v8, v[112:115] offset:0
 ds_write_b128 v8, v[116:119] offset:1024
 ds_write_b128 v8, v[120:123] offset:2048
 ds_write_b128 v8, v[124:127] offset:3072
 ds_write_b128 v9, v[128:131] offset:0
 ds_write_b128 v9, v[132:135] offset:1024
 ds_write_b128 v9, v[136:139] offset:2048
 ds_write_b128 v9, v[140:143] offset:3072
 s_waitcnt lgkmcnt(0)
 s_barrier
 ds_read_b128 v[96:99], v10 offset:0
 ds_read_b128 v[100:103], v10 offset:1024
 ds_read_b128 v[104:107], v10 offset:2048
 ds_read_b128 v[108:111], v10 offset:3072
 ds_read_b128 v[112:115], v10 offset:4096
 ds_read_b128 v[116:119], v10 offset:5120
 ds_read_b128 v[120:123], v10 offset:6144
 ds_read_b128 v[124:127], v10 offset:7168
 ds_read_b128 v[128:131], v10 offset:8192
 ds_read_b128 v[132:135], v10 offset:9216
 ds_read_b128 v[136:139], v10 offset:10240
 ds_read_b128 v[140:143], v10 offset:11264
 s_waitcnt lgkmcnt(8)
 v_add_f32 v80, v80, v96
 v_add_f32 v81, v81, v97
 v_add_f32 v82, v82, v98
 v_add_f32 v83, v83, v99
 v_add_f32 v84, v84, v100
 v_add_f32 v85, v85, v101
 v_add_f32 v86, v86, v102
 v_add_f32 v87, v87, v103
 v_add_f32 v88, v88, v104
 v_add_f32 v89, v89, v105
 v_add_f32 v90, v90, v106
 v_add_f32 v91, v91, v107
 v_add_f32 v92, v92, v108
 v_add_f32 v93, v93, v109
 v_add_f32 v94, v94, v110
 v_add_f32 v95, v95, v111
 s_waitcnt lgkmcnt(4)
 v_add_f32 v80, v80, v112
 v_add_f32 v81, v81, v113
 v_add_f32 v82, v82, v114
 v_add_f32 v83, v83, v115
 v_add_f32 v84, v84, v116
 v_add_f32 v85, v85, v117
 v_add_f32 v86, v86, v118
 v_add_f32 v87, v87, v119
 v_add_f32 v88, v88, v120
 v_add_f32 v89, v89, v121
 v_add_f32 v90, v90, v122
 v_add_f32 v91, v91, v123
 v_add_f32 v92, v92, v124
 v_add_f32 v93, v93, v125
 v_add_f32 v94, v94, v126
 v_add_f32 v95, v95, v127
 s_waitcnt lgkmcnt(0)
 v_add_f32 v80, v80, v128
 v_add_f32 v81, v81, v129
 v_add_f32 v82, v82, v130
 v_add_f32 v83, v83, v131
 v_add_f32 v84, v84, v132
 v_add_f32 v85, v85, v133
 v_add_f32 v86, v86, v134
 v_add_f32 v87, v87, v135
 v_add_f32 v88, v88, v136
 v_add_f32 v89, v89, v137
 v_add_f32 v90, v90, v138
 v_add_f32 v91, v91, v139
 v_add_f32 v92, v92, v140
 v_add_f32 v93, v93, v141
 v_add_f32 v94, v94, v142
 v_add_f32 v95, v95, v143
 v_cvt_pk_bf16_f32 v224, v80, v81
 v_cvt_pk_bf16_f32 v225, v82, v83
 v_cvt_pk_bf16_f32 v226, v84, v85
 v_cvt_pk_bf16_f32 v227, v86, v87
 buffer_store_dwordx4 v[224:227], v6, s[48:51], s67 offen offset:0 sc1
 v_cvt_pk_bf16_f32 v228, v88, v89
 v_cvt_pk_bf16_f32 v229, v90, v91
 v_cvt_pk_bf16_f32 v230, v92, v93
 v_cvt_pk_bf16_f32 v231, v94, v95
 buffer_store_dwordx4 v[228:231], v6, s[48:51], s67 offen offset:256 sc1
 s_add_u32 s74, s74, 0x40000
 s_and_b32 s69, s74, 0x200000
 s_lshr_b32 s69, s69, 8
 s_xor_b32 s69, s69, s74
 buffer_store_dwordx4 v[232:235], v1, s[48:51], s69 offen sc1
 s_add_u32 s67, s67, 0x40000
 s_waitcnt vmcnt(0)
 v_mov_b32 v3, 1
 buffer_store_dword v3, v251, s[48:51], s68 offen sc1
 v_mfma_f32_16x16x32_bf16 v[144:147], a[0:3], v[16:19], 0
 buffer_load_dwordx4 v[72:75], v2, s[48:51], s82 offen offset:2048 sc1
 v_mfma_f32_16x16x32_bf16 v[148:151], a[4:7], v[16:19], 0
 v_mfma_f32_16x16x32_bf16 v[156:159], a[4:7], v[20:23], 0
 buffer_load_dwordx4 v[76:79], v2, s[48:51], s82 offen offset:2304 sc1
 v_mfma_f32_16x16x32_bf16 v[152:155], a[0:3], v[20:23], 0
 v_mfma_f32_16x16x32_bf16 v[160:163], a[8:11], v[16:19], 0
 v_mfma_f32_16x16x32_bf16 v[164:167], a[12:15], v[16:19], 0
 v_mfma_f32_16x16x32_bf16 v[172:175], a[12:15], v[20:23], 0
 v_mfma_f32_16x16x32_bf16 v[168:171], a[8:11], v[20:23], 0
 v_mfma_f32_16x16x32_bf16 v[176:179], a[16:19], v[16:19], 0
 v_mfma_f32_16x16x32_bf16 v[180:183], a[20:23], v[16:19], 0
 v_mfma_f32_16x16x32_bf16 v[188:191], a[20:23], v[20:23], 0
 v_mfma_f32_16x16x32_bf16 v[184:187], a[16:19], v[20:23], 0
 v_mfma_f32_16x16x32_bf16 v[192:195], a[24:27], v[16:19], 0
 v_mfma_f32_16x16x32_bf16 v[196:199], a[28:31], v[16:19], 0
 v_mfma_f32_16x16x32_bf16 v[204:207], a[28:31], v[20:23], 0
 v_mfma_f32_16x16x32_bf16 v[200:203], a[24:27], v[20:23], 0
 v_mfma_f32_16x16x32_bf16 v[144:147], a[32:35], v[24:27], v[144:147]
 s_add_u32 s82, s65, 0
 buffer_load_dwordx4 v[16:19], v2, s[48:51], s82 offen offset:0 sc1
 v_mfma_f32_16x16x32_bf16 v[148:151], a[36:39], v[24:27], v[148:151]
 v_mfma_f32_16x16x32_bf16 v[156:159], a[36:39], v[28:31], v[156:159]
 buffer_load_dwordx4 v[20:23], v2, s[48:51], s82 offen offset:256 sc1
 v_mfma_f32_16x16x32_bf16 v[152:155], a[32:35], v[28:31], v[152:155]
 v_mfma_f32_16x16x32_bf16 v[160:163], a[40:43], v[24:27], v[160:163]
 v_mfma_f32_16x16x32_bf16 v[164:167], a[44:47], v[24:27], v[164:167]
 v_mfma_f32_16x16x32_bf16 v[172:175], a[44:47], v[28:31], v[172:175]
 v_mfma_f32_16x16x32_bf16 v[168:171], a[40:43], v[28:31], v[168:171]
 v_mfma_f32_16x16x32_bf16 v[176:179], a[48:51], v[24:27], v[176:179]
 v_mfma_f32_16x16x32_bf16 v[180:183], a[52:55], v[24:27], v[180:183]
 v_mfma_f32_16x16x32_bf16 v[188:191], a[52:55], v[28:31], v[188:191]
 v_mfma_f32_16x16x32_bf16 v[184:187], a[48:51], v[28:31], v[184:187]
 v_mfma_f32_16x16x32_bf16 v[192:195], a[56:59], v[24:27], v[192:195]
 v_mfma_f32_16x16x32_bf16 v[196:199], a[60:63], v[24:27], v[196:199]
 v_mfma_f32_16x16x32_bf16 v[204:207], a[60:63], v[28:31], v[204:207]
 v_mfma_f32_16x16x32_bf16 v[200:203], a[56:59], v[28:31], v[200:203]
 v_mfma_f32_16x16x32_bf16 v[144:147], a[64:67], v[32:35], v[144:147]
 buffer_load_dwordx4 v[24:27], v2, s[48:51], s82 offen offset:2048 sc1
 v_mfma_f32_16x16x32_bf16 v[148:151], a[68:71], v[32:35], v[148:151]
 v_mfma_f32_16x16x32_bf16 v[156:159], a[68:71], v[36:39], v[156:159]
 buffer_load_dwordx4 v[28:31], v2, s[48:51], s82 offen offset:2304 sc1
 v_mfma_f32_16x16x32_bf16 v[152:155], a[64:67], v[36:39], v[152:155]
 v_mfma_f32_16x16x32_bf16 v[160:163], a[72:75], v[32:35], v[160:163]
 v_mfma_f32_16x16x32_bf16 v[164:167], a[76:79], v[32:35], v[164:167]
 v_mfma_f32_16x16x32_bf16 v[172:175], a[76:79], v[36:39], v[172:175]
 v_mfma_f32_16x16x32_bf16 v[168:171], a[72:75], v[36:39], v[168:171]
 v_mfma_f32_16x16x32_bf16 v[176:179], a[80:83], v[32:35], v[176:179]
 v_mfma_f32_16x16x32_bf16 v[180:183], a[84:87], v[32:35], v[180:183]
 v_mfma_f32_16x16x32_bf16 v[188:191], a[84:87], v[36:39], v[188:191]
 v_mfma_f32_16x16x32_bf16 v[184:187], a[80:83], v[36:39], v[184:187]
 v_mfma_f32_16x16x32_bf16 v[192:195], a[88:91], v[32:35], v[192:195]
 v_mfma_f32_16x16x32_bf16 v[196:199], a[92:95], v[32:35], v[196:199]
 v_mfma_f32_16x16x32_bf16 v[204:207], a[92:95], v[36:39], v[204:207]
 v_mfma_f32_16x16x32_bf16 v[200:203], a[88:91], v[36:39], v[200:203]
 v_mfma_f32_16x16x32_bf16 v[144:147], a[96:99], v[40:43], v[144:147]
 s_add_u32 s82, s65, 4096
 buffer_load_dwordx4 v[32:35], v2, s[48:51], s82 offen offset:0 sc1
 v_mfma_f32_16x16x32_bf16 v[148:151], a[100:103], v[40:43], v[148:151]
 v_mfma_f32_16x16x32_bf16 v[156:159], a[100:103], v[44:47], v[156:159]
 buffer_load_dwordx4 v[36:39], v2, s[48:51], s82 offen offset:256 sc1
 v_mfma_f32_16x16x32_bf16 v[152:155], a[96:99], v[44:47], v[152:155]
 v_mfma_f32_16x16x32_bf16 v[160:163], a[104:107], v[40:43], v[160:163]
 v_mfma_f32_16x16x32_bf16 v[164:167], a[108:111], v[40:43], v[164:167]
 v_mfma_f32_16x16x32_bf16 v[172:175], a[108:111], v[44:47], v[172:175]
 v_mfma_f32_16x16x32_bf16 v[168:171], a[104:107], v[44:47], v[168:171]
 v_mfma_f32_16x16x32_bf16 v[176:179], a[112:115], v[40:43], v[176:179]
 v_mfma_f32_16x16x32_bf16 v[180:183], a[116:119], v[40:43], v[180:183]
 v_mfma_f32_16x16x32_bf16 v[188:191], a[116:119], v[44:47], v[188:191]
 v_mfma_f32_16x16x32_bf16 v[184:187], a[112:115], v[44:47], v[184:187]
 v_mfma_f32_16x16x32_bf16 v[192:195], a[120:123], v[40:43], v[192:195]
 v_mfma_f32_16x16x32_bf16 v[196:199], a[124:127], v[40:43], v[196:199]
 v_mfma_f32_16x16x32_bf16 v[204:207], a[124:127], v[44:47], v[204:207]
 v_mfma_f32_16x16x32_bf16 v[200:203], a[120:123], v[44:47], v[200:203]
 v_mfma_f32_16x16x32_bf16 v[144:147], a[128:131], v[48:51], v[144:147]
 buffer_load_dwordx4 v[40:43], v2, s[48:51], s82 offen offset:2048 sc1
 v_mfma_f32_16x16x32_bf16 v[148:151], a[132:135], v[48:51], v[148:151]
 v_mfma_f32_16x16x32_bf16 v[156:159], a[132:135], v[52:55], v[156:159]
 buffer_load_dwordx4 v[44:47], v2, s[48:51], s82 offen offset:2304 sc1
 v_mfma_f32_16x16x32_bf16 v[152:155], a[128:131], v[52:55], v[152:155]
 v_mfma_f32_16x16x32_bf16 v[160:163], a[136:139], v[48:51], v[160:163]
 v_mfma_f32_16x16x32_bf16 v[164:167], a[140:143], v[48:51], v[164:167]
 v_mfma_f32_16x16x32_bf16 v[172:175], a[140:143], v[52:55], v[172:175]
 v_mfma_f32_16x16x32_bf16 v[168:171], a[136:139], v[52:55], v[168:171]
 v_mfma_f32_16x16x32_bf16 v[176:179], a[144:147], v[48:51], v[176:179]
 v_mfma_f32_16x16x32_bf16 v[180:183], a[148:151], v[48:51], v[180:183]
 v_mfma_f32_16x16x32_bf16 v[188:191], a[148:151], v[52:55], v[188:191]
 v_mfma_f32_16x16x32_bf16 v[184:187], a[144:147], v[52:55], v[184:187]
 v_mfma_f32_16x16x32_bf16 v[192:195], a[152:155], v[48:51], v[192:195]
 v_mfma_f32_16x16x32_bf16 v[196:199], a[156:159], v[48:51], v[196:199]
 v_mfma_f32_16x16x32_bf16 v[204:207], a[156:159], v[52:55], v[204:207]
 v_mfma_f32_16x16x32_bf16 v[200:203], a[152:155], v[52:55], v[200:203]
 v_mfma_f32_16x16x32_bf16 v[144:147], a[160:163], v[56:59], v[144:147]
 s_add_u32 s82, s65, 8192
 buffer_load_dwordx4 v[48:51], v2, s[48:51], s82 offen offset:0 sc1
 v_mfma_f32_16x16x32_bf16 v[148:151], a[164:167], v[56:59], v[148:151]
 v_mfma_f32_16x16x32_bf16 v[156:159], a[164:167], v[60:63], v[156:159]
 buffer_load_dwordx4 v[52:55], v2, s[48:51], s82 offen offset:256 sc1
 v_mfma_f32_16x16x32_bf16 v[152:155], a[160:163], v[60:63], v[152:155]
 v_mfma_f32_16x16x32_bf16 v[160:163], a[168:171], v[56:59], v[160:163]
 v_mfma_f32_16x16x32_bf16 v[164:167], a[172:175], v[56:59], v[164:167]
 v_mfma_f32_16x16x32_bf16 v[172:175], a[172:175], v[60:63], v[172:175]
 v_mfma_f32_16x16x32_bf16 v[168:171], a[168:171], v[60:63], v[168:171]
 v_mfma_f32_16x16x32_bf16 v[176:179], a[176:179], v[56:59], v[176:179]
 v_mfma_f32_16x16x32_bf16 v[180:183], a[180:183], v[56:59], v[180:183]
 v_mfma_f32_16x16x32_bf16 v[188:191], a[180:183], v[60:63], v[188:191]
 v_mfma_f32_16x16x32_bf16 v[184:187], a[176:179], v[60:63], v[184:187]
 v_mfma_f32_16x16x32_bf16 v[192:195], a[184:187], v[56:59], v[192:195]
 v_mfma_f32_16x16x32_bf16 v[196:199], a[188:191], v[56:59], v[196:199]
 v_mfma_f32_16x16x32_bf16 v[204:207], a[188:191], v[60:63], v[204:207]
 v_mfma_f32_16x16x32_bf16 v[200:203], a[184:187], v[60:63], v[200:203]
 v_mfma_f32_16x16x32_bf16 v[144:147], a[192:195], v[64:67], v[144:147]
 buffer_load_dwordx4 v[56:59], v2, s[48:51], s82 offen offset:2048 sc1
 v_mfma_f32_16x16x32_bf16 v[148:151], a[196:199], v[64:67], v[148:151]
 v_mfma_f32_16x16x32_bf16 v[156:159], a[196:199], v[68:71], v[156:159]
 buffer_load_dwordx4 v[60:63], v2, s[48:51], s82 offen offset:2304 sc1
 v_mfma_f32_16x16x32_bf16 v[152:155], a[192:195], v[68:71], v[152:155]
 v_mfma_f32_16x16x32_bf16 v[160:163], a[200:203], v[64:67], v[160:163]
 v_mfma_f32_16x16x32_bf16 v[164:167], a[204:207], v[64:67], v[164:167]
 v_mfma_f32_16x16x32_bf16 v[172:175], a[204:207], v[68:71], v[172:175]
 v_mfma_f32_16x16x32_bf16 v[168:171], a[200:203], v[68:71], v[168:171]
 v_mfma_f32_16x16x32_bf16 v[176:179], a[208:211], v[64:67], v[176:179]
 v_mfma_f32_16x16x32_bf16 v[180:183], a[212:215], v[64:67], v[180:183]
 v_mfma_f32_16x16x32_bf16 v[188:191], a[212:215], v[68:71], v[188:191]
 v_mfma_f32_16x16x32_bf16 v[184:187], a[208:211], v[68:71], v[184:187]
 v_mfma_f32_16x16x32_bf16 v[192:195], a[216:219], v[64:67], v[192:195]
 v_mfma_f32_16x16x32_bf16 v[196:199], a[220:223], v[64:67], v[196:199]
 v_mfma_f32_16x16x32_bf16 v[204:207], a[220:223], v[68:71], v[204:207]
 v_mfma_f32_16x16x32_bf16 v[200:203], a[216:219], v[68:71], v[200:203]
 s_waitcnt vmcnt(12)
 v_mfma_f32_16x16x32_bf16 v[144:147], a[224:227], v[72:75], v[144:147]
 s_add_u32 s82, s65, 12288
 buffer_load_dwordx4 v[64:67], v2, s[48:51], s82 offen offset:0 sc1
 v_mfma_f32_16x16x32_bf16 v[148:151], a[228:231], v[72:75], v[148:151]
 v_mfma_f32_16x16x32_bf16 v[156:159], a[228:231], v[76:79], v[156:159]
 buffer_load_dwordx4 v[68:71], v2, s[48:51], s82 offen offset:256 sc1
 v_mfma_f32_16x16x32_bf16 v[152:155], a[224:227], v[76:79], v[152:155]
 s_add_u32 s70, s65, 131072
 v_mfma_f32_16x16x32_bf16 v[160:163], a[232:235], v[72:75], v[160:163]
 buffer_load_dwordx4 v[12:15], v11, s[48:51], s70 offen offset:0 sc1
 v_mfma_f32_16x16x32_bf16 v[164:167], a[236:239], v[72:75], v[164:167]
 s_add_u32 s65, s65, 0x10000
 s_add_u32 s63, s63, 1
 v_mfma_f32_16x16x32_bf16 v[172:175], a[236:239], v[76:79], v[172:175]
 v_mfma_f32_16x16x32_bf16 v[168:171], a[232:235], v[76:79], v[168:171]
 v_mfma_f32_16x16x32_bf16 v[176:179], a[240:243], v[72:75], v[176:179]
 v_mfma_f32_16x16x32_bf16 v[180:183], a[244:247], v[72:75], v[180:183]
 v_mfma_f32_16x16x32_bf16 v[188:191], a[244:247], v[76:79], v[188:191]
 v_mfma_f32_16x16x32_bf16 v[184:187], a[240:243], v[76:79], v[184:187]
 v_mfma_f32_16x16x32_bf16 v[192:195], a[248:251], v[72:75], v[192:195]
 v_mfma_f32_16x16x32_bf16 v[196:199], a[252:255], v[72:75], v[196:199]
 v_mfma_f32_16x16x32_bf16 v[204:207], a[252:255], v[76:79], v[204:207]
 v_mfma_f32_16x16x32_bf16 v[200:203], a[248:251], v[76:79], v[200:203]
 ds_write_b128 v7, v[160:163] offset:49152
 ds_write_b128 v7, v[164:167] offset:50176
 ds_write_b128 v7, v[168:171] offset:51200
 ds_write_b128 v7, v[172:175] offset:52224
 ds_write_b128 v8, v[176:179] offset:49152
 ds_write_b128 v8, v[180:183] offset:50176
 ds_write_b128 v8, v[184:187] offset:51200
 ds_write_b128 v8, v[188:191] offset:52224
 ds_write_b128 v9, v[192:195] offset:49152
 ds_write_b128 v9, v[196:199] offset:50176
 ds_write_b128 v9, v[200:203] offset:51200
 ds_write_b128 v9, v[204:207] offset:52224
 s_waitcnt lgkmcnt(0)
 s_barrier
 ds_read_b128 v[160:163], v10 offset:49152
 ds_read_b128 v[164:167], v10 offset:50176
 ds_read_b128 v[168:171], v10 offset:51200
 ds_read_b128 v[172:175], v10 offset:52224
 ds_read_b128 v[176:179], v10 offset:53248
 ds_read_b128 v[180:183], v10 offset:54272
 ds_read_b128 v[184:187], v10 offset:55296
 ds_read_b128 v[188:191], v10 offset:56320
 ds_read_b128 v[192:195], v10 offset:57344
 ds_read_b128 v[196:199], v10 offset:58368
 ds_read_b128 v[200:203], v10 offset:59392
 ds_read_b128 v[204:207], v10 offset:60416
 s_waitcnt lgkmcnt(8)
 v_add_f32 v144, v144, v160
 v_add_f32 v145, v145, v161
 v_add_f32 v146, v146, v162
 v_add_f32 v147, v147, v163
 v_add_f32 v148, v148, v164
 v_add_f32 v149, v149, v165
 v_add_f32 v150, v150, v166
 v_add_f32 v151, v151, v167
 v_add_f32 v152, v152, v168
 v_add_f32 v153, v153, v169
 v_add_f32 v154, v154, v170
 v_add_f32 v155, v155, v171
 v_add_f32 v156, v156, v172
 v_add_f32 v157, v157, v173
 v_add_f32 v158, v158, v174
 v_add_f32 v159, v159, v175
 s_waitcnt lgkmcnt(4)
 v_add_f32 v144, v144, v176
 v_add_f32 v145, v145, v177
 v_add_f32 v146, v146, v178
 v_add_f32 v147, v147, v179
 v_add_f32 v148, v148, v180
 v_add_f32 v149, v149, v181
 v_add_f32 v150, v150, v182
 v_add_f32 v151, v151, v183
 v_add_f32 v152, v152, v184
 v_add_f32 v153, v153, v185
 v_add_f32 v154, v154, v186
 v_add_f32 v155, v155, v187
 v_add_f32 v156, v156, v188
 v_add_f32 v157, v157, v189
 v_add_f32 v158, v158, v190
 v_add_f32 v159, v159, v191
 s_waitcnt lgkmcnt(0)
 v_add_f32 v144, v144, v192
 v_add_f32 v145, v145, v193
 v_add_f32 v146, v146, v194
 v_add_f32 v147, v147, v195
 v_add_f32 v148, v148, v196
 v_add_f32 v149, v149, v197
 v_add_f32 v150, v150, v198
 v_add_f32 v151, v151, v199
 v_add_f32 v152, v152, v200
 v_add_f32 v153, v153, v201
 v_add_f32 v154, v154, v202
 v_add_f32 v155, v155, v203
 v_add_f32 v156, v156, v204
 v_add_f32 v157, v157, v205
 v_add_f32 v158, v158, v206
 v_add_f32 v159, v159, v207
 v_cvt_pk_bf16_f32 v224, v144, v145
 v_cvt_pk_bf16_f32 v225, v146, v147
 v_cvt_pk_bf16_f32 v226, v148, v149
 v_cvt_pk_bf16_f32 v227, v150, v151
 buffer_store_dwordx4 v[224:227], v6, s[48:51], s67 offen offset:0 sc1
 v_cvt_pk_bf16_f32 v228, v152, v153
 v_cvt_pk_bf16_f32 v229, v154, v155
 v_cvt_pk_bf16_f32 v230, v156, v157
 v_cvt_pk_bf16_f32 v231, v158, v159
 buffer_store_dwordx4 v[228:231], v6, s[48:51], s67 offen offset:256 sc1
 s_add_u32 s74, s74, 0x40000
 s_and_b32 s69, s74, 0x200000
 s_lshr_b32 s69, s69, 8
 s_xor_b32 s69, s69, s74
 buffer_store_dwordx4 v[232:235], v1, s[48:51], s69 offen sc1
 s_add_u32 s67, s67, 0x40000
 s_waitcnt vmcnt(0)
 v_mov_b32 v3, 2
 buffer_store_dword v3, v251, s[48:51], s68 offen sc1
 v_mfma_f32_16x16x32_bf16 v[80:83], a[0:3], v[16:19], 0
 buffer_load_dwordx4 v[72:75], v2, s[48:51], s82 offen offset:2048 sc1
 v_mfma_f32_16x16x32_bf16 v[84:87], a[4:7], v[16:19], 0
 v_mfma_f32_16x16x32_bf16 v[92:95], a[4:7], v[20:23], 0
 buffer_load_dwordx4 v[76:79], v2, s[48:51], s82 offen offset:2304 sc1
 v_mfma_f32_16x16x32_bf16 v[88:91], a[0:3], v[20:23], 0
 v_mfma_f32_16x16x32_bf16 v[96:99], a[8:11], v[16:19], 0
 v_mfma_f32_16x16x32_bf16 v[100:103], a[12:15], v[16:19], 0
 v_mfma_f32_16x16x32_bf16 v[108:111], a[12:15], v[20:23], 0
 v_mfma_f32_16x16x32_bf16 v[104:107], a[8:11], v[20:23], 0
 v_mfma_f32_16x16x32_bf16 v[112:115], a[16:19], v[16:19], 0
 v_mfma_f32_16x16x32_bf16 v[116:119], a[20:23], v[16:19], 0
 v_mfma_f32_16x16x32_bf16 v[124:127], a[20:23], v[20:23], 0
 v_mfma_f32_16x16x32_bf16 v[120:123], a[16:19], v[20:23], 0
 v_mfma_f32_16x16x32_bf16 v[128:131], a[24:27], v[16:19], 0
 v_mfma_f32_16x16x32_bf16 v[132:135], a[28:31], v[16:19], 0
 v_mfma_f32_16x16x32_bf16 v[140:143], a[28:31], v[20:23], 0
 v_mfma_f32_16x16x32_bf16 v[136:139], a[24:27], v[20:23], 0
 v_mfma_f32_16x16x32_bf16 v[80:83], a[32:35], v[24:27], v[80:83]
 s_add_u32 s82, s65, 0
 buffer_load_dwordx4 v[16:19], v2, s[48:51], s82 offen offset:0 sc1
 v_mfma_f32_16x16x32_bf16 v[84:87], a[36:39], v[24:27], v[84:87]
 v_mfma_f32_16x16x32_bf16 v[92:95], a[36:39], v[28:31], v[92:95]
 buffer_load_dwordx4 v[20:23], v2, s[48:51], s82 offen offset:256 sc1
 v_mfma_f32_16x16x32_bf16 v[88:91], a[32:35], v[28:31], v[88:91]
 v_mfma_f32_16x16x32_bf16 v[96:99], a[40:43], v[24:27], v[96:99]
 v_mfma_f32_16x16x32_bf16 v[100:103], a[44:47], v[24:27], v[100:103]
 v_mfma_f32_16x16x32_bf16 v[108:111], a[44:47], v[28:31], v[108:111]
 v_mfma_f32_16x16x32_bf16 v[104:107], a[40:43], v[28:31], v[104:107]
 v_mfma_f32_16x16x32_bf16 v[112:115], a[48:51], v[24:27], v[112:115]
 v_mfma_f32_16x16x32_bf16 v[116:119], a[52:55], v[24:27], v[116:119]
 v_mfma_f32_16x16x32_bf16 v[124:127], a[52:55], v[28:31], v[124:127]
 v_mfma_f32_16x16x32_bf16 v[120:123], a[48:51], v[28:31], v[120:123]
 v_mfma_f32_16x16x32_bf16 v[128:131], a[56:59], v[24:27], v[128:131]
 v_mfma_f32_16x16x32_bf16 v[132:135], a[60:63], v[24:27], v[132:135]
 v_mfma_f32_16x16x32_bf16 v[140:143], a[60:63], v[28:31], v[140:143]
 v_mfma_f32_16x16x32_bf16 v[136:139], a[56:59], v[28:31], v[136:139]
 v_mfma_f32_16x16x32_bf16 v[80:83], a[64:67], v[32:35], v[80:83]
 buffer_load_dwordx4 v[24:27], v2, s[48:51], s82 offen offset:2048 sc1
 v_mfma_f32_16x16x32_bf16 v[84:87], a[68:71], v[32:35], v[84:87]
 v_mfma_f32_16x16x32_bf16 v[92:95], a[68:71], v[36:39], v[92:95]
 buffer_load_dwordx4 v[28:31], v2, s[48:51], s82 offen offset:2304 sc1
 v_mfma_f32_16x16x32_bf16 v[88:91], a[64:67], v[36:39], v[88:91]
 v_mfma_f32_16x16x32_bf16 v[96:99], a[72:75], v[32:35], v[96:99]
 v_mfma_f32_16x16x32_bf16 v[100:103], a[76:79], v[32:35], v[100:103]
 v_mfma_f32_16x16x32_bf16 v[108:111], a[76:79], v[36:39], v[108:111]
 v_mfma_f32_16x16x32_bf16 v[104:107], a[72:75], v[36:39], v[104:107]
 v_mfma_f32_16x16x32_bf16 v[112:115], a[80:83], v[32:35], v[112:115]
 v_mfma_f32_16x16x32_bf16 v[116:119], a[84:87], v[32:35], v[116:119]
 v_mfma_f32_16x16x32_bf16 v[124:127], a[84:87], v[36:39], v[124:127]
 v_mfma_f32_16x16x32_bf16 v[120:123], a[80:83], v[36:39], v[120:123]
 v_mfma_f32_16x16x32_bf16 v[128:131], a[88:91], v[32:35], v[128:131]
 v_mfma_f32_16x16x32_bf16 v[132:135], a[92:95], v[32:35], v[132:135]
 v_mfma_f32_16x16x32_bf16 v[140:143], a[92:95], v[36:39], v[140:143]
 v_mfma_f32_16x16x32_bf16 v[136:139], a[88:91], v[36:39], v[136:139]
 v_mfma_f32_16x16x32_bf16 v[80:83], a[96:99], v[40:43], v[80:83]
 s_add_u32 s82, s65, 4096
 buffer_load_dwordx4 v[32:35], v2, s[48:51], s82 offen offset:0 sc1
 v_mfma_f32_16x16x32_bf16 v[84:87], a[100:103], v[40:43], v[84:87]
 v_mfma_f32_16x16x32_bf16 v[92:95], a[100:103], v[44:47], v[92:95]
 buffer_load_dwordx4 v[36:39], v2, s[48:51], s82 offen offset:256 sc1
 v_mfma_f32_16x16x32_bf16 v[88:91], a[96:99], v[44:47], v[88:91]
 v_mfma_f32_16x16x32_bf16 v[96:99], a[104:107], v[40:43], v[96:99]
 v_mfma_f32_16x16x32_bf16 v[100:103], a[108:111], v[40:43], v[100:103]
 v_mfma_f32_16x16x32_bf16 v[108:111], a[108:111], v[44:47], v[108:111]
 v_mfma_f32_16x16x32_bf16 v[104:107], a[104:107], v[44:47], v[104:107]
 v_mfma_f32_16x16x32_bf16 v[112:115], a[112:115], v[40:43], v[112:115]
 v_mfma_f32_16x16x32_bf16 v[116:119], a[116:119], v[40:43], v[116:119]
 v_mfma_f32_16x16x32_bf16 v[124:127], a[116:119], v[44:47], v[124:127]
 v_mfma_f32_16x16x32_bf16 v[120:123], a[112:115], v[44:47], v[120:123]
 v_mfma_f32_16x16x32_bf16 v[128:131], a[120:123], v[40:43], v[128:131]
 v_mfma_f32_16x16x32_bf16 v[132:135], a[124:127], v[40:43], v[132:135]
 v_mfma_f32_16x16x32_bf16 v[140:143], a[124:127], v[44:47], v[140:143]
 v_mfma_f32_16x16x32_bf16 v[136:139], a[120:123], v[44:47], v[136:139]
 v_mfma_f32_16x16x32_bf16 v[80:83], a[128:131], v[48:51], v[80:83]
 buffer_load_dwordx4 v[40:43], v2, s[48:51], s82 offen offset:2048 sc1
 v_mfma_f32_16x16x32_bf16 v[84:87], a[132:135], v[48:51], v[84:87]
 v_mfma_f32_16x16x32_bf16 v[92:95], a[132:135], v[52:55], v[92:95]
 buffer_load_dwordx4 v[44:47], v2, s[48:51], s82 offen offset:2304 sc1
 v_mfma_f32_16x16x32_bf16 v[88:91], a[128:131], v[52:55], v[88:91]
 v_mfma_f32_16x16x32_bf16 v[96:99], a[136:139], v[48:51], v[96:99]
 v_mfma_f32_16x16x32_bf16 v[100:103], a[140:143], v[48:51], v[100:103]
 v_mfma_f32_16x16x32_bf16 v[108:111], a[140:143], v[52:55], v[108:111]
 v_mfma_f32_16x16x32_bf16 v[104:107], a[136:139], v[52:55], v[104:107]
 v_mfma_f32_16x16x32_bf16 v[112:115], a[144:147], v[48:51], v[112:115]
 v_mfma_f32_16x16x32_bf16 v[116:119], a[148:151], v[48:51], v[116:119]
 v_mfma_f32_16x16x32_bf16 v[124:127], a[148:151], v[52:55], v[124:127]
 v_mfma_f32_16x16x32_bf16 v[120:123], a[144:147], v[52:55], v[120:123]
 v_mfma_f32_16x16x32_bf16 v[128:131], a[152:155], v[48:51], v[128:131]
 v_mfma_f32_16x16x32_bf16 v[132:135], a[156:159], v[48:51], v[132:135]
 v_mfma_f32_16x16x32_bf16 v[140:143], a[156:159], v[52:55], v[140:143]
 v_mfma_f32_16x16x32_bf16 v[136:139], a[152:155], v[52:55], v[136:139]
 v_mfma_f32_16x16x32_bf16 v[80:83], a[160:163], v[56:59], v[80:83]
 s_add_u32 s82, s65, 8192
 buffer_load_dwordx4 v[48:51], v2, s[48:51], s82 offen offset:0 sc1
 v_mfma_f32_16x16x32_bf16 v[84:87], a[164:167], v[56:59], v[84:87]
 v_mfma_f32_16x16x32_bf16 v[92:95], a[164:167], v[60:63], v[92:95]
 buffer_load_dwordx4 v[52:55], v2, s[48:51], s82 offen offset:256 sc1
 v_mfma_f32_16x16x32_bf16 v[88:91], a[160:163], v[60:63], v[88:91]
 v_mfma_f32_16x16x32_bf16 v[96:99], a[168:171], v[56:59], v[96:99]
 v_mfma_f32_16x16x32_bf16 v[100:103], a[172:175], v[56:59], v[100:103]
 v_mfma_f32_16x16x32_bf16 v[108:111], a[172:175], v[60:63], v[108:111]
 v_mfma_f32_16x16x32_bf16 v[104:107], a[168:171], v[60:63], v[104:107]
 v_mfma_f32_16x16x32_bf16 v[112:115], a[176:179], v[56:59], v[112:115]
 v_mfma_f32_16x16x32_bf16 v[116:119], a[180:183], v[56:59], v[116:119]
 v_mfma_f32_16x16x32_bf16 v[124:127], a[180:183], v[60:63], v[124:127]
 v_mfma_f32_16x16x32_bf16 v[120:123], a[176:179], v[60:63], v[120:123]
 v_mfma_f32_16x16x32_bf16 v[128:131], a[184:187], v[56:59], v[128:131]
 v_mfma_f32_16x16x32_bf16 v[132:135], a[188:191], v[56:59], v[132:135]
 v_mfma_f32_16x16x32_bf16 v[140:143], a[188:191], v[60:63], v[140:143]
 v_mfma_f32_16x16x32_bf16 v[136:139], a[184:187], v[60:63], v[136:139]
 v_mfma_f32_16x16x32_bf16 v[80:83], a[192:195], v[64:67], v[80:83]
 buffer_load_dwordx4 v[56:59], v2, s[48:51], s82 offen offset:2048 sc1
 v_mfma_f32_16x16x32_bf16 v[84:87], a[196:199], v[64:67], v[84:87]
 v_mfma_f32_16x16x32_bf16 v[92:95], a[196:199], v[68:71], v[92:95]
 buffer_load_dwordx4 v[60:63], v2, s[48:51], s82 offen offset:2304 sc1
 v_mfma_f32_16x16x32_bf16 v[88:91], a[192:195], v[68:71], v[88:91]
 v_mfma_f32_16x16x32_bf16 v[96:99], a[200:203], v[64:67], v[96:99]
 v_mfma_f32_16x16x32_bf16 v[100:103], a[204:207], v[64:67], v[100:103]
 v_mfma_f32_16x16x32_bf16 v[108:111], a[204:207], v[68:71], v[108:111]
 v_mfma_f32_16x16x32_bf16 v[104:107], a[200:203], v[68:71], v[104:107]
 v_mfma_f32_16x16x32_bf16 v[112:115], a[208:211], v[64:67], v[112:115]
 v_mfma_f32_16x16x32_bf16 v[116:119], a[212:215], v[64:67], v[116:119]
 v_mfma_f32_16x16x32_bf16 v[124:127], a[212:215], v[68:71], v[124:127]
 v_mfma_f32_16x16x32_bf16 v[120:123], a[208:211], v[68:71], v[120:123]
 v_mfma_f32_16x16x32_bf16 v[128:131], a[216:219], v[64:67], v[128:131]
 v_mfma_f32_16x16x32_bf16 v[132:135], a[220:223], v[64:67], v[132:135]
 v_mfma_f32_16x16x32_bf16 v[140:143], a[220:223], v[68:71], v[140:143]
 v_mfma_f32_16x16x32_bf16 v[136:139], a[216:219], v[68:71], v[136:139]
 s_waitcnt vmcnt(12)
 v_mfma_f32_16x16x32_bf16 v[80:83], a[224:227], v[72:75], v[80:83]
 s_add_u32 s82, s65, 12288
 buffer_load_dwordx4 v[64:67], v2, s[48:51], s82 offen offset:0 sc1
 v_mfma_f32_16x16x32_bf16 v[84:87], a[228:231], v[72:75], v[84:87]
 v_mfma_f32_16x16x32_bf16 v[92:95], a[228:231], v[76:79], v[92:95]
 buffer_load_dwordx4 v[68:71], v2, s[48:51], s82 offen offset:256 sc1
 v_mfma_f32_16x16x32_bf16 v[88:91], a[224:227], v[76:79], v[88:91]
 s_add_u32 s70, s65, 131072
 v_mfma_f32_16x16x32_bf16 v[96:99], a[232:235], v[72:75], v[96:99]
 buffer_load_dwordx4 v[12:15], v11, s[48:51], s70 offen offset:0 sc1
 v_mfma_f32_16x16x32_bf16 v[100:103], a[236:239], v[72:75], v[100:103]
 s_add_u32 s65, s65, 0x10000
 s_add_u32 s63, s63, 1
 v_mfma_f32_16x16x32_bf16 v[108:111], a[236:239], v[76:79], v[108:111]
 v_mfma_f32_16x16x32_bf16 v[104:107], a[232:235], v[76:79], v[104:107]
 v_mfma_f32_16x16x32_bf16 v[112:115], a[240:243], v[72:75], v[112:115]
 v_mfma_f32_16x16x32_bf16 v[116:119], a[244:247], v[72:75], v[116:119]
 v_mfma_f32_16x16x32_bf16 v[124:127], a[244:247], v[76:79], v[124:127]
 v_mfma_f32_16x16x32_bf16 v[120:123], a[240:243], v[76:79], v[120:123]
 v_mfma_f32_16x16x32_bf16 v[128:131], a[248:251], v[72:75], v[128:131]
 v_mfma_f32_16x16x32_bf16 v[132:135], a[252:255], v[72:75], v[132:135]
 v_mfma_f32_16x16x32_bf16 v[140:143], a[252:255], v[76:79], v[140:143]
 v_mfma_f32_16x16x32_bf16 v[136:139], a[248:251], v[76:79], v[136:139]
 s_waitcnt vmcnt(0)
Lw_Kloop:
 s_cmp_eq_u32 s63, 27
 s_cbranch_scc1 Lw_Kxf
Lw_Kxfok:
 s_waitcnt vmcnt(17)
 v_mfma_f32_16x16x32_bf16 v[144:147], a[0:3], v[16:19], 0
 buffer_load_dwordx4 v[72:75], v2, s[48:51], s82 offen offset:2048 sc1
 v_mfma_f32_16x16x32_bf16 v[148:151], a[4:7], v[16:19], 0
 ds_write_b128 v7, v[96:99] offset:0
 v_mfma_f32_16x16x32_bf16 v[156:159], a[4:7], v[20:23], 0
 buffer_load_dwordx4 v[76:79], v2, s[48:51], s82 offen offset:2304 sc1
 v_mfma_f32_16x16x32_bf16 v[152:155], a[0:3], v[20:23], 0
 v_mfma_f32_16x16x32_bf16 v[160:163], a[8:11], v[16:19], 0
 ds_write_b128 v7, v[100:103] offset:1024
 v_mfma_f32_16x16x32_bf16 v[164:167], a[12:15], v[16:19], 0
 v_mfma_f32_16x16x32_bf16 v[172:175], a[12:15], v[20:23], 0
 v_mfma_f32_16x16x32_bf16 v[168:171], a[8:11], v[20:23], 0
 ds_write_b128 v7, v[104:107] offset:2048
 v_mfma_f32_16x16x32_bf16 v[176:179], a[16:19], v[16:19], 0
 v_mfma_f32_16x16x32_bf16 v[180:183], a[20:23], v[16:19], 0
 v_mfma_f32_16x16x32_bf16 v[188:191], a[20:23], v[20:23], 0
 ds_write_b128 v7, v[108:111] offset:3072
 v_mfma_f32_16x16x32_bf16 v[184:187], a[16:19], v[20:23], 0
 v_mfma_f32_16x16x32_bf16 v[192:195], a[24:27], v[16:19], 0
 v_mfma_f32_16x16x32_bf16 v[196:199], a[28:31], v[16:19], 0
 ds_write_b128 v8, v[112:115] offset:0
 v_mfma_f32_16x16x32_bf16 v[204:207], a[28:31], v[20:23], 0
 v_mfma_f32_16x16x32_bf16 v[200:203], a[24:27], v[20:23], 0
 s_waitcnt vmcnt(17)
 v_mfma_f32_16x16x32_bf16 v[144:147], a[32:35], v[24:27], v[144:147]
 s_add_u32 s82, s65, 0
 buffer_load_dwordx4 v[16:19], v2, s[48:51], s82 offen offset:0 sc1
 v_mfma_f32_16x16x32_bf16 v[148:151], a[36:39], v[24:27], v[148:151]
 ds_write_b128 v8, v[116:119] offset:1024
 v_mfma_f32_16x16x32_bf16 v[156:159], a[36:39], v[28:31], v[156:159]
 buffer_load_dwordx4 v[20:23], v2, s[48:51], s82 offen offset:256 sc1
 v_mfma_f32_16x16x32_bf16 v[152:155], a[32:35], v[28:31], v[152:155]
 v_mfma_f32_16x16x32_bf16 v[160:163], a[40:43], v[24:27], v[160:163]
 ds_write_b128 v8, v[120:123] offset:2048
 v_mfma_f32_16x16x32_bf16 v[164:167], a[44:47], v[24:27], v[164:167]
 v_mfma_f32_16x16x32_bf16 v[172:175], a[44:47], v[28:31], v[172:175]
 v_mfma_f32_16x16x32_bf16 v[168:171], a[40:43], v[28:31], v[168:171]
 ds_write_b128 v8, v[124:127] offset:3072
 v_mfma_f32_16x16x32_bf16 v[176:179], a[48:51], v[24:27], v[176:179]
 v_mfma_f32_16x16x32_bf16 v[180:183], a[52:55], v[24:27], v[180:183]
 v_mfma_f32_16x16x32_bf16 v[188:191], a[52:55], v[28:31], v[188:191]
 ds_write_b128 v9, v[128:131] offset:0
 v_mfma_f32_16x16x32_bf16 v[184:187], a[48:51], v[28:31], v[184:187]
 v_mfma_f32_16x16x32_bf16 v[192:195], a[56:59], v[24:27], v[192:195]
 v_mfma_f32_16x16x32_bf16 v[196:199], a[60:63], v[24:27], v[196:199]
 ds_write_b128 v9, v[132:135] offset:1024
 v_mfma_f32_16x16x32_bf16 v[204:207], a[60:63], v[28:31], v[204:207]
 s_waitcnt vmcnt(9)
 s_sub_u32 s71, s63, 1
 v_mfma_f32_16x16x32_bf16 v[200:203], a[56:59], v[28:31], v[200:203]
 s_max_u32 s71, s71, 2
 v_mfma_f32_16x16x32_bf16 v[144:147], a[64:67], v[32:35], v[144:147]
 buffer_load_dwordx4 v[24:27], v2, s[48:51], s82 offen offset:2048 sc1
 v_mfma_f32_16x16x32_bf16 v[148:151], a[68:71], v[32:35], v[148:151]
 ds_write_b128 v9, v[136:139] offset:2048
 v_mfma_f32_16x16x32_bf16 v[156:159], a[68:71], v[36:39], v[156:159]
 buffer_load_dwordx4 v[28:31], v2, s[48:51], s82 offen offset:2304 sc1
 v_mfma_f32_16x16x32_bf16 v[152:155], a[64:67], v[36:39], v[152:155]
 v_mov_b32 v3, s71
 v_mfma_f32_16x16x32_bf16 v[160:163], a[72:75], v[32:35], v[160:163]
 ds_write_b128 v9, v[140:143] offset:3072
 v_mfma_f32_16x16x32_bf16 v[164:167], a[76:79], v[32:35], v[164:167]
 buffer_store_dword v3, v251, s[48:51], s68 offen sc1
 v_mfma_f32_16x16x32_bf16 v[172:175], a[76:79], v[36:39], v[172:175]
 v_mfma_f32_16x16x32_bf16 v[168:171], a[72:75], v[36:39], v[168:171]
 s_waitcnt lgkmcnt(0)
 s_barrier
 v_mfma_f32_16x16x32_bf16 v[176:179], a[80:83], v[32:35], v[176:179]
 ds_read_b128 v[96:99], v10 offset:0
 v_mfma_f32_16x16x32_bf16 v[180:183], a[84:87], v[32:35], v[180:183]
 ds_read_b128 v[100:103], v10 offset:1024
 v_mfma_f32_16x16x32_bf16 v[188:191], a[84:87], v[36:39], v[188:191]
 ds_read_b128 v[104:107], v10 offset:2048
 v_mfma_f32_16x16x32_bf16 v[184:187], a[80:83], v[36:39], v[184:187]
 ds_read_b128 v[108:111], v10 offset:3072
 v_mfma_f32_16x16x32_bf16 v[192:195], a[88:91], v[32:35], v[192:195]
 ds_read_b128 v[112:115], v10 offset:4096
 v_mfma_f32_16x16x32_bf16 v[196:199], a[92:95], v[32:35], v[196:199]
 ds_read_b128 v[116:119], v10 offset:5120
 v_mfma_f32_16x16x32_bf16 v[204:207], a[92:95], v[36:39], v[204:207]
 ds_read_b128 v[120:123], v10 offset:6144
 v_mfma_f32_16x16x32_bf16 v[200:203], a[88:91], v[36:39], v[200:203]
 ds_read_b128 v[124:127], v10 offset:7168
 v_mfma_f32_16x16x32_bf16 v[144:147], a[96:99], v[40:43], v[144:147]
 s_add_u32 s82, s65, 4096
 buffer_load_dwordx4 v[32:35], v2, s[48:51], s82 offen offset:0 sc1
 v_mfma_f32_16x16x32_bf16 v[148:151], a[100:103], v[40:43], v[148:151]
 ds_read_b128 v[128:131], v10 offset:8192
 v_mfma_f32_16x16x32_bf16 v[156:159], a[100:103], v[44:47], v[156:159]
 buffer_load_dwordx4 v[36:39], v2, s[48:51], s82 offen offset:256 sc1
 v_mfma_f32_16x16x32_bf16 v[152:155], a[96:99], v[44:47], v[152:155]
 ds_read_b128 v[132:135], v10 offset:9216
 v_mfma_f32_16x16x32_bf16 v[160:163], a[104:107], v[40:43], v[160:163]
 ds_read_b128 v[136:139], v10 offset:10240
 v_mfma_f32_16x16x32_bf16 v[164:167], a[108:111], v[40:43], v[164:167]
 ds_read_b128 v[140:143], v10 offset:11264
 v_mfma_f32_16x16x32_bf16 v[172:175], a[108:111], v[44:47], v[172:175]
 s_waitcnt lgkmcnt(8)
 v_add_f32 v80, v80, v96
 v_mfma_f32_16x16x32_bf16 v[168:171], a[104:107], v[44:47], v[168:171]
 v_add_f32 v81, v81, v97
 v_add_f32 v82, v82, v98
 v_mfma_f32_16x16x32_bf16 v[176:179], a[112:115], v[40:43], v[176:179]
 v_add_f32 v83, v83, v99
 v_add_f32 v84, v84, v100
 v_mfma_f32_16x16x32_bf16 v[180:183], a[116:119], v[40:43], v[180:183]
 v_add_f32 v85, v85, v101
 v_add_f32 v86, v86, v102
 v_mfma_f32_16x16x32_bf16 v[188:191], a[116:119], v[44:47], v[188:191]
 v_add_f32 v87, v87, v103
 v_add_f32 v88, v88, v104
 v_mfma_f32_16x16x32_bf16 v[184:187], a[112:115], v[44:47], v[184:187]
 v_add_f32 v89, v89, v105
 v_add_f32 v90, v90, v106
 v_mfma_f32_16x16x32_bf16 v[192:195], a[120:123], v[40:43], v[192:195]
 v_add_f32 v91, v91, v107
 v_add_f32 v92, v92, v108
 v_mfma_f32_16x16x32_bf16 v[196:199], a[124:127], v[40:43], v[196:199]
 v_add_f32 v93, v93, v109
 v_add_f32 v94, v94, v110
 v_mfma_f32_16x16x32_bf16 v[204:207], a[124:127], v[44:47], v[204:207]
 v_add_f32 v95, v95, v111
 s_waitcnt lgkmcnt(4)
 v_mfma_f32_16x16x32_bf16 v[200:203], a[120:123], v[44:47], v[200:203]
 v_add_f32 v80, v80, v112
 v_mfma_f32_16x16x32_bf16 v[144:147], a[128:131], v[48:51], v[144:147]
 buffer_load_dwordx4 v[40:43], v2, s[48:51], s82 offen offset:2048 sc1
 v_mfma_f32_16x16x32_bf16 v[148:151], a[132:135], v[48:51], v[148:151]
 v_add_f32 v81, v81, v113
 v_add_f32 v82, v82, v114
 v_mfma_f32_16x16x32_bf16 v[156:159], a[132:135], v[52:55], v[156:159]
 buffer_load_dwordx4 v[44:47], v2, s[48:51], s82 offen offset:2304 sc1
 v_mfma_f32_16x16x32_bf16 v[152:155], a[128:131], v[52:55], v[152:155]
 v_add_f32 v83, v83, v115
 v_add_f32 v84, v84, v116
 v_mfma_f32_16x16x32_bf16 v[160:163], a[136:139], v[48:51], v[160:163]
 v_add_f32 v85, v85, v117
 v_add_f32 v86, v86, v118
 v_mfma_f32_16x16x32_bf16 v[164:167], a[140:143], v[48:51], v[164:167]
 v_add_f32 v87, v87, v119
 v_add_f32 v88, v88, v120
 v_mfma_f32_16x16x32_bf16 v[172:175], a[140:143], v[52:55], v[172:175]
 v_add_f32 v89, v89, v121
 v_add_f32 v90, v90, v122
 v_mfma_f32_16x16x32_bf16 v[168:171], a[136:139], v[52:55], v[168:171]
 v_add_f32 v91, v91, v123
 v_add_f32 v92, v92, v124
 v_mfma_f32_16x16x32_bf16 v[176:179], a[144:147], v[48:51], v[176:179]
 v_add_f32 v93, v93, v125
 v_add_f32 v94, v94, v126
 v_mfma_f32_16x16x32_bf16 v[180:183], a[148:151], v[48:51], v[180:183]
 v_add_f32 v95, v95, v127
 s_waitcnt lgkmcnt(0)
 v_mfma_f32_16x16x32_bf16 v[188:191], a[148:151], v[52:55], v[188:191]
 v_add_f32 v80, v80, v128
 v_add_f32 v81, v81, v129
 v_mfma_f32_16x16x32_bf16 v[184:187], a[144:147], v[52:55], v[184:187]
 v_add_f32 v82, v82, v130
 v_add_f32 v83, v83, v131
 v_mfma_f32_16x16x32_bf16 v[192:195], a[152:155], v[48:51], v[192:195]
 v_add_f32 v84, v84, v132
 v_add_f32 v85, v85, v133
 v_mfma_f32_16x16x32_bf16 v[196:199], a[156:159], v[48:51], v[196:199]
 v_add_f32 v86, v86, v134
 v_add_f32 v87, v87, v135
 v_mfma_f32_16x16x32_bf16 v[204:207], a[156:159], v[52:55], v[204:207]
 v_add_f32 v88, v88, v136
 v_add_f32 v89, v89, v137
 v_mfma_f32_16x16x32_bf16 v[200:203], a[152:155], v[52:55], v[200:203]
 v_add_f32 v90, v90, v138
 s_waitcnt vmcnt(14)
 v_mfma_f32_16x16x32_bf16 v[144:147], a[160:163], v[56:59], v[144:147]
 s_add_u32 s82, s65, 8192
 buffer_load_dwordx4 v[48:51], v2, s[48:51], s82 offen offset:0 sc1
 v_mfma_f32_16x16x32_bf16 v[148:151], a[164:167], v[56:59], v[148:151]
 v_add_f32 v91, v91, v139
 v_add_f32 v92, v92, v140
 v_mfma_f32_16x16x32_bf16 v[156:159], a[164:167], v[60:63], v[156:159]
 buffer_load_dwordx4 v[52:55], v2, s[48:51], s82 offen offset:256 sc1
 v_mfma_f32_16x16x32_bf16 v[152:155], a[160:163], v[60:63], v[152:155]
 v_add_f32 v93, v93, v141
 v_add_f32 v94, v94, v142
 v_mfma_f32_16x16x32_bf16 v[160:163], a[168:171], v[56:59], v[160:163]
 v_add_f32 v95, v95, v143
 v_cvt_pk_bf16_f32 v224, v80, v81
 v_mfma_f32_16x16x32_bf16 v[164:167], a[172:175], v[56:59], v[164:167]
 v_cvt_pk_bf16_f32 v225, v82, v83
 v_cvt_pk_bf16_f32 v226, v84, v85
 v_mfma_f32_16x16x32_bf16 v[172:175], a[172:175], v[60:63], v[172:175]
 v_cvt_pk_bf16_f32 v227, v86, v87
 v_mfma_f32_16x16x32_bf16 v[168:171], a[168:171], v[60:63], v[168:171]
 buffer_store_dwordx4 v[224:227], v6, s[48:51], s67 offen offset:0 sc1
 v_mfma_f32_16x16x32_bf16 v[176:179], a[176:179], v[56:59], v[176:179]
 v_cvt_pk_bf16_f32 v228, v88, v89
 v_cvt_pk_bf16_f32 v229, v90, v91
 v_mfma_f32_16x16x32_bf16 v[180:183], a[180:183], v[56:59], v[180:183]
 v_cvt_pk_bf16_f32 v230, v92, v93
 v_cvt_pk_bf16_f32 v231, v94, v95
 v_mfma_f32_16x16x32_bf16 v[188:191], a[180:183], v[60:63], v[188:191]
 buffer_store_dwordx4 v[228:231], v6, s[48:51], s67 offen offset:256 sc1
 v_mfma_f32_16x16x32_bf16 v[184:187], a[176:179], v[60:63], v[184:187]
 s_add_u32 s74, s74, 0x40000
 s_and_b32 s69, s74, 0x200000
 v_mfma_f32_16x16x32_bf16 v[192:195], a[184:187], v[56:59], v[192:195]
 s_lshr_b32 s69, s69, 8
 s_xor_b32 s69, s69, s74
 v_mfma_f32_16x16x32_bf16 v[196:199], a[188:191], v[56:59], v[196:199]
 buffer_store_dwordx4 v[232:235], v1, s[48:51], s69 offen sc1
 v_mfma_f32_16x16x32_bf16 v[204:207], a[188:191], v[60:63], v[204:207]
 s_add_u32 s67, s67, 0x40000
 v_mfma_f32_16x16x32_bf16 v[200:203], a[184:187], v[60:63], v[200:203]
 s_waitcnt vmcnt(17)
 v_mfma_f32_16x16x32_bf16 v[144:147], a[192:195], v[64:67], v[144:147]
 buffer_load_dwordx4 v[56:59], v2, s[48:51], s82 offen offset:2048 sc1
 v_mfma_f32_16x16x32_bf16 v[148:151], a[196:199], v[64:67], v[148:151]
 v_mfma_f32_16x16x32_bf16 v[156:159], a[196:199], v[68:71], v[156:159]
 buffer_load_dwordx4 v[60:63], v2, s[48:51], s82 offen offset:2304 sc1
 v_mfma_f32_16x16x32_bf16 v[152:155], a[192:195], v[68:71], v[152:155]
 v_mfma_f32_16x16x32_bf16 v[160:163], a[200:203], v[64:67], v[160:163]
 v_mfma_f32_16x16x32_bf16 v[164:167], a[204:207], v[64:67], v[164:167]
 v_mfma_f32_16x16x32_bf16 v[172:175], a[204:207], v[68:71], v[172:175]
 v_mfma_f32_16x16x32_bf16 v[168:171], a[200:203], v[68:71], v[168:171]
 v_mfma_f32_16x16x32_bf16 v[176:179], a[208:211], v[64:67], v[176:179]
 v_mfma_f32_16x16x32_bf16 v[180:183], a[212:215], v[64:67], v[180:183]
 v_mfma_f32_16x16x32_bf16 v[188:191], a[212:215], v[68:71], v[188:191]
 v_mfma_f32_16x16x32_bf16 v[184:187], a[208:211], v[68:71], v[184:187]
 v_mfma_f32_16x16x32_bf16 v[192:195], a[216:219], v[64:67], v[192:195]
 v_mfma_f32_16x16x32_bf16 v[196:199], a[220:223], v[64:67], v[196:199]
 v_mfma_f32_16x16x32_bf16 v[204:207], a[220:223], v[68:71], v[204:207]
 v_mfma_f32_16x16x32_bf16 v[200:203], a[216:219], v[68:71], v[200:203]
 s_waitcnt vmcnt(16)
 v_mfma_f32_16x16x32_bf16 v[144:147], a[224:227], v[72:75], v[144:147]
 s_add_u32 s82, s65, 12288
 buffer_load_dwordx4 v[64:67], v2, s[48:51], s82 offen offset:0 sc1
 v_mfma_f32_16x16x32_bf16 v[148:151], a[228:231], v[72:75], v[148:151]
 v_mfma_f32_16x16x32_bf16 v[156:159], a[228:231], v[76:79], v[156:159]
 buffer_load_dwordx4 v[68:71], v2, s[48:51], s82 offen offset:256 sc1
 v_mfma_f32_16x16x32_bf16 v[152:155], a[224:227], v[76:79], v[152:155]
 s_add_u32 s70, s65, 131072
 v_mfma_f32_16x16x32_bf16 v[160:163], a[232:235], v[72:75], v[160:163]
 buffer_load_dwordx4 v[12:15], v11, s[48:51], s70 offen offset:0 sc1
 v_mfma_f32_16x16x32_bf16 v[164:167], a[236:239], v[72:75], v[164:167]
 s_add_u32 s65, s65, 0x10000
 s_add_u32 s63, s63, 1
 v_mfma_f32_16x16x32_bf16 v[172:175], a[236:239], v[76:79], v[172:175]
 v_mfma_f32_16x16x32_bf16 v[168:171], a[232:235], v[76:79], v[168:171]
 v_mfma_f32_16x16x32_bf16 v[176:179], a[240:243], v[72:75], v[176:179]
 v_mfma_f32_16x16x32_bf16 v[180:183], a[244:247], v[72:75], v[180:183]
 v_mfma_f32_16x16x32_bf16 v[188:191], a[244:247], v[76:79], v[188:191]
 v_mfma_f32_16x16x32_bf16 v[184:187], a[240:243], v[76:79], v[184:187]
 v_mfma_f32_16x16x32_bf16 v[192:195], a[248:251], v[72:75], v[192:195]
 v_mfma_f32_16x16x32_bf16 v[196:199], a[252:255], v[72:75], v[196:199]
 v_mfma_f32_16x16x32_bf16 v[204:207], a[252:255], v[76:79], v[204:207]
 v_mfma_f32_16x16x32_bf16 v[200:203], a[248:251], v[76:79], v[200:203]
 s_cmp_eq_u32 s63, 64
 s_cbranch_scc1 Lw_Kend
 s_waitcnt vmcnt(17)
 v_mfma_f32_16x16x32_bf16 v[80:83], a[0:3], v[16:19], 0
 buffer_load_dwordx4 v[72:75], v2, s[48:51], s82 offen offset:2048 sc1
 v_mfma_f32_16x16x32_bf16 v[84:87], a[4:7], v[16:19], 0
 ds_write_b128 v7, v[160:163] offset:49152
 v_mfma_f32_16x16x32_bf16 v[92:95], a[4:7], v[20:23], 0
 buffer_load_dwordx4 v[76:79], v2, s[48:51], s82 offen offset:2304 sc1
 v_mfma_f32_16x16x32_bf16 v[88:91], a[0:3], v[20:23], 0
 v_mfma_f32_16x16x32_bf16 v[96:99], a[8:11], v[16:19], 0
 ds_write_b128 v7, v[164:167] offset:50176
 v_mfma_f32_16x16x32_bf16 v[100:103], a[12:15], v[16:19], 0
 v_mfma_f32_16x16x32_bf16 v[108:111], a[12:15], v[20:23], 0
 v_mfma_f32_16x16x32_bf16 v[104:107], a[8:11], v[20:23], 0
 ds_write_b128 v7, v[168:171] offset:51200
 v_mfma_f32_16x16x32_bf16 v[112:115], a[16:19], v[16:19], 0
 v_mfma_f32_16x16x32_bf16 v[116:119], a[20:23], v[16:19], 0
 v_mfma_f32_16x16x32_bf16 v[124:127], a[20:23], v[20:23], 0
 ds_write_b128 v7, v[172:175] offset:52224
 v_mfma_f32_16x16x32_bf16 v[120:123], a[16:19], v[20:23], 0
 v_mfma_f32_16x16x32_bf16 v[128:131], a[24:27], v[16:19], 0
 v_mfma_f32_16x16x32_bf16 v[132:135], a[28:31], v[16:19], 0
 ds_write_b128 v8, v[176:179] offset:49152
 v_mfma_f32_16x16x32_bf16 v[140:143], a[28:31], v[20:23], 0
 v_mfma_f32_16x16x32_bf16 v[136:139], a[24:27], v[20:23], 0
 s_waitcnt vmcnt(17)
 v_mfma_f32_16x16x32_bf16 v[80:83], a[32:35], v[24:27], v[80:83]
 s_add_u32 s82, s65, 0
 buffer_load_dwordx4 v[16:19], v2, s[48:51], s82 offen offset:0 sc1
 v_mfma_f32_16x16x32_bf16 v[84:87], a[36:39], v[24:27], v[84:87]
 ds_write_b128 v8, v[180:183] offset:50176
 v_mfma_f32_16x16x32_bf16 v[92:95], a[36:39], v[28:31], v[92:95]
 buffer_load_dwordx4 v[20:23], v2, s[48:51], s82 offen offset:256 sc1
 v_mfma_f32_16x16x32_bf16 v[88:91], a[32:35], v[28:31], v[88:91]
 v_mfma_f32_16x16x32_bf16 v[96:99], a[40:43], v[24:27], v[96:99]
 ds_write_b128 v8, v[184:187] offset:51200
 v_mfma_f32_16x16x32_bf16 v[100:103], a[44:47], v[24:27], v[100:103]
 v_mfma_f32_16x16x32_bf16 v[108:111], a[44:47], v[28:31], v[108:111]
 v_mfma_f32_16x16x32_bf16 v[104:107], a[40:43], v[28:31], v[104:107]
 ds_write_b128 v8, v[188:191] offset:52224
 v_mfma_f32_16x16x32_bf16 v[112:115], a[48:51], v[24:27], v[112:115]
 v_mfma_f32_16x16x32_bf16 v[116:119], a[52:55], v[24:27], v[116:119]
 v_mfma_f32_16x16x32_bf16 v[124:127], a[52:55], v[28:31], v[124:127]
 ds_write_b128 v9, v[192:195] offset:49152
 v_mfma_f32_16x16x32_bf16 v[120:123], a[48:51], v[28:31], v[120:123]
 v_mfma_f32_16x16x32_bf16 v[128:131], a[56:59], v[24:27], v[128:131]
 v_mfma_f32_16x16x32_bf16 v[132:135], a[60:63], v[24:27], v[132:135]
 ds_write_b128 v9, v[196:199] offset:50176
 v_mfma_f32_16x16x32_bf16 v[140:143], a[60:63], v[28:31], v[140:143]
 s_waitcnt vmcnt(9)
 s_sub_u32 s71, s63, 1
 v_mfma_f32_16x16x32_bf16 v[136:139], a[56:59], v[28:31], v[136:139]
 s_max_u32 s71, s71, 2
 v_mfma_f32_16x16x32_bf16 v[80:83], a[64:67], v[32:35], v[80:83]
 buffer_load_dwordx4 v[24:27], v2, s[48:51], s82 offen offset:2048 sc1
 v_mfma_f32_16x16x32_bf16 v[84:87], a[68:71], v[32:35], v[84:87]
 ds_write_b128 v9, v[200:203] offset:51200
 v_mfma_f32_16x16x32_bf16 v[92:95], a[68:71], v[36:39], v[92:95]
 buffer_load_dwordx4 v[28:31], v2, s[48:51], s82 offen offset:2304 sc1
 v_mfma_f32_16x16x32_bf16 v[88:91], a[64:67], v[36:39], v[88:91]
 v_mov_b32 v3, s71
 v_mfma_f32_16x16x32_bf16 v[96:99], a[72:75], v[32:35], v[96:99]
 ds_write_b128 v9, v[204:207] offset:52224
 v_mfma_f32_16x16x32_bf16 v[100:103], a[76:79], v[32:35], v[100:103]
 buffer_store_dword v3, v251, s[48:51], s68 offen sc1
 v_mfma_f32_16x16x32_bf16 v[108:111], a[76:79], v[36:39], v[108:111]
 v_mfma_f32_16x16x32_bf16 v[104:107], a[72:75], v[36:39], v[104:107]
 s_waitcnt lgkmcnt(0)
 s_barrier
 v_mfma_f32_16x16x32_bf16 v[112:115], a[80:83], v[32:35], v[112:115]
 ds_read_b128 v[160:163], v10 offset:49152
 v_mfma_f32_16x16x32_bf16 v[116:119], a[84:87], v[32:35], v[116:119]
 ds_read_b128 v[164:167], v10 offset:50176
 v_mfma_f32_16x16x32_bf16 v[124:127], a[84:87], v[36:39], v[124:127]
 ds_read_b128 v[168:171], v10 offset:51200
 v_mfma_f32_16x16x32_bf16 v[120:123], a[80:83], v[36:39], v[120:123]
 ds_read_b128 v[172:175], v10 offset:52224
 v_mfma_f32_16x16x32_bf16 v[128:131], a[88:91], v[32:35], v[128:131]
 ds_read_b128 v[176:179], v10 offset:53248
 v_mfma_f32_16x16x32_bf16 v[132:135], a[92:95], v[32:35], v[132:135]
 ds_read_b128 v[180:183], v10 offset:54272
 v_mfma_f32_16x16x32_bf16 v[140:143], a[92:95], v[36:39], v[140:143]
 ds_read_b128 v[184:187], v10 offset:55296
 v_mfma_f32_16x16x32_bf16 v[136:139], a[88:91], v[36:39], v[136:139]
 ds_read_b128 v[188:191], v10 offset:56320
 v_mfma_f32_16x16x32_bf16 v[80:83], a[96:99], v[40:43], v[80:83]
 s_add_u32 s82, s65, 4096
 buffer_load_dwordx4 v[32:35], v2, s[48:51], s82 offen offset:0 sc1
 v_mfma_f32_16x16x32_bf16 v[84:87], a[100:103], v[40:43], v[84:87]
 ds_read_b128 v[192:195], v10 offset:57344
 v_mfma_f32_16x16x32_bf16 v[92:95], a[100:103], v[44:47], v[92:95]
 buffer_load_dwordx4 v[36:39], v2, s[48:51], s82 offen offset:256 sc1
 v_mfma_f32_16x16x32_bf16 v[88:91], a[96:99], v[44:47], v[88:91]
 ds_read_b128 v[196:199], v10 offset:58368
 v_mfma_f32_16x16x32_bf16 v[96:99], a[104:107], v[40:43], v[96:99]
 ds_read_b128 v[200:203], v10 offset:59392
 v_mfma_f32_16x16x32_bf16 v[100:103], a[108:111], v[40:43], v[100:103]
 ds_read_b128 v[204:207], v10 offset:60416
 v_mfma_f32_16x16x32_bf16 v[108:111], a[108:111], v[44:47], v[108:111]
 s_waitcnt lgkmcnt(8)
 v_add_f32 v144, v144, v160
 v_mfma_f32_16x16x32_bf16 v[104:107], a[104:107], v[44:47], v[104:107]
 v_add_f32 v145, v145, v161
 v_add_f32 v146, v146, v162
 v_mfma_f32_16x16x32_bf16 v[112:115], a[112:115], v[40:43], v[112:115]
 v_add_f32 v147, v147, v163
 v_add_f32 v148, v148, v164
 v_mfma_f32_16x16x32_bf16 v[116:119], a[116:119], v[40:43], v[116:119]
 v_add_f32 v149, v149, v165
 v_add_f32 v150, v150, v166
 v_mfma_f32_16x16x32_bf16 v[124:127], a[116:119], v[44:47], v[124:127]
 v_add_f32 v151, v151, v167
 v_add_f32 v152, v152, v168
 v_mfma_f32_16x16x32_bf16 v[120:123], a[112:115], v[44:47], v[120:123]
 v_add_f32 v153, v153, v169
 v_add_f32 v154, v154, v170
 v_mfma_f32_16x16x32_bf16 v[128:131], a[120:123], v[40:43], v[128:131]
 v_add_f32 v155, v155, v171
 v_add_f32 v156, v156, v172
 v_mfma_f32_16x16x32_bf16 v[132:135], a[124:127], v[40:43], v[132:135]
 v_add_f32 v157, v157, v173
 v_add_f32 v158, v158, v174
 v_mfma_f32_16x16x32_bf16 v[140:143], a[124:127], v[44:47], v[140:143]
 v_add_f32 v159, v159, v175
 s_waitcnt lgkmcnt(4)
 v_mfma_f32_16x16x32_bf16 v[136:139], a[120:123], v[44:47], v[136:139]
 v_add_f32 v144, v144, v176
 v_mfma_f32_16x16x32_bf16 v[80:83], a[128:131], v[48:51], v[80:83]
 buffer_load_dwordx4 v[40:43], v2, s[48:51], s82 offen offset:2048 sc1
 v_mfma_f32_16x16x32_bf16 v[84:87], a[132:135], v[48:51], v[84:87]
 v_add_f32 v145, v145, v177
 v_add_f32 v146, v146, v178
 v_mfma_f32_16x16x32_bf16 v[92:95], a[132:135], v[52:55], v[92:95]
 buffer_load_dwordx4 v[44:47], v2, s[48:51], s82 offen offset:2304 sc1
 v_mfma_f32_16x16x32_bf16 v[88:91], a[128:131], v[52:55], v[88:91]
 v_add_f32 v147, v147, v179
 v_add_f32 v148, v148, v180
 v_mfma_f32_16x16x32_bf16 v[96:99], a[136:139], v[48:51], v[96:99]
 v_add_f32 v149, v149, v181
 v_add_f32 v150, v150, v182
 v_mfma_f32_16x16x32_bf16 v[100:103], a[140:143], v[48:51], v[100:103]
 v_add_f32 v151, v151, v183
 v_add_f32 v152, v152, v184
 v_mfma_f32_16x16x32_bf16 v[108:111], a[140:143], v[52:55], v[108:111]
 v_add_f32 v153, v153, v185
 v_add_f32 v154, v154, v186
 v_mfma_f32_16x16x32_bf16 v[104:107], a[136:139], v[52:55], v[104:107]
 v_add_f32 v155, v155, v187
 v_add_f32 v156, v156, v188
 v_mfma_f32_16x16x32_bf16 v[112:115], a[144:147], v[48:51], v[112:115]
 v_add_f32 v157, v157, v189
 v_add_f32 v158, v158, v190
 v_mfma_f32_16x16x32_bf16 v[116:119], a[148:151], v[48:51], v[116:119]
 v_add_f32 v159, v159, v191
 s_waitcnt lgkmcnt(0)
 v_mfma_f32_16x16x32_bf16 v[124:127], a[148:151], v[52:55], v[124:127]
 v_add_f32 v144, v144, v192
 v_add_f32 v145, v145, v193
 v_mfma_f32_16x16x32_bf16 v[120:123], a[144:147], v[52:55], v[120:123]
 v_add_f32 v146, v146, v194
 v_add_f32 v147, v147, v195
 v_mfma_f32_16x16x32_bf16 v[128:131], a[152:155], v[48:51], v[128:131]
 v_add_f32 v148, v148, v196
 v_add_f32 v149, v149, v197
 v_mfma_f32_16x16x32_bf16 v[132:135], a[156:159], v[48:51], v[132:135]
 v_add_f32 v150, v150, v198
 v_add_f32 v151, v151, v199
 v_mfma_f32_16x16x32_bf16 v[140:143], a[156:159], v[52:55], v[140:143]
 v_add_f32 v152, v152, v200
 v_add_f32 v153, v153, v201
 v_mfma_f32_16x16x32_bf16 v[136:139], a[152:155], v[52:55], v[136:139]
 v_add_f32 v154, v154, v202
 s_waitcnt vmcnt(14)
 v_mfma_f32_16x16x32_bf16 v[80:83], a[160:163], v[56:59], v[80:83]
 s_add_u32 s82, s65, 8192
 buffer_load_dwordx4 v[48:51], v2, s[48:51], s82 offen offset:0 sc1
 v_mfma_f32_16x16x32_bf16 v[84:87], a[164:167], v[56:59], v[84:87]
 v_add_f32 v155, v155, v203
 v_add_f32 v156, v156, v204
 v_mfma_f32_16x16x32_bf16 v[92:95], a[164:167], v[60:63], v[92:95]
 buffer_load_dwordx4 v[52:55], v2, s[48:51], s82 offen offset:256 sc1
 v_mfma_f32_16x16x32_bf16 v[88:91], a[160:163], v[60:63], v[88:91]
 v_add_f32 v157, v157, v205
 v_add_f32 v158, v158, v206
 v_mfma_f32_16x16x32_bf16 v[96:99], a[168:171], v[56:59], v[96:99]
 v_add_f32 v159, v159, v207
 v_cvt_pk_bf16_f32 v224, v144, v145
 v_mfma_f32_16x16x32_bf16 v[100:103], a[172:175], v[56:59], v[100:103]
 v_cvt_pk_bf16_f32 v225, v146, v147
 v_cvt_pk_bf16_f32 v226, v148, v149
 v_mfma_f32_16x16x32_bf16 v[108:111], a[172:175], v[60:63], v[108:111]
 v_cvt_pk_bf16_f32 v227, v150, v151
 v_mfma_f32_16x16x32_bf16 v[104:107], a[168:171], v[60:63], v[104:107]
 buffer_store_dwordx4 v[224:227], v6, s[48:51], s67 offen offset:0 sc1
 v_mfma_f32_16x16x32_bf16 v[112:115], a[176:179], v[56:59], v[112:115]
 v_cvt_pk_bf16_f32 v228, v152, v153
 v_cvt_pk_bf16_f32 v229, v154, v155
 v_mfma_f32_16x16x32_bf16 v[116:119], a[180:183], v[56:59], v[116:119]
 v_cvt_pk_bf16_f32 v230, v156, v157
 v_cvt_pk_bf16_f32 v231, v158, v159
 v_mfma_f32_16x16x32_bf16 v[124:127], a[180:183], v[60:63], v[124:127]
 buffer_store_dwordx4 v[228:231], v6, s[48:51], s67 offen offset:256 sc1
 v_mfma_f32_16x16x32_bf16 v[120:123], a[176:179], v[60:63], v[120:123]
 s_add_u32 s74, s74, 0x40000
 s_and_b32 s69, s74, 0x200000
 v_mfma_f32_16x16x32_bf16 v[128:131], a[184:187], v[56:59], v[128:131]
 s_lshr_b32 s69, s69, 8
 s_xor_b32 s69, s69, s74
 v_mfma_f32_16x16x32_bf16 v[132:135], a[188:191], v[56:59], v[132:135]
 buffer_store_dwordx4 v[232:235], v1, s[48:51], s69 offen sc1
 v_mfma_f32_16x16x32_bf16 v[140:143], a[188:191], v[60:63], v[140:143]
 s_add_u32 s67, s67, 0x40000
 v_mfma_f32_16x16x32_bf16 v[136:139], a[184:187], v[60:63], v[136:139]
 s_waitcnt vmcnt(17)
 v_mfma_f32_16x16x32_bf16 v[80:83], a[192:195], v[64:67], v[80:83]
 buffer_load_dwordx4 v[56:59], v2, s[48:51], s82 offen offset:2048 sc1
 v_mfma_f32_16x16x32_bf16 v[84:87], a[196:199], v[64:67], v[84:87]
 v_mfma_f32_16x16x32_bf16 v[92:95], a[196:199], v[68:71], v[92:95]
 buffer_load_dwordx4 v[60:63], v2, s[48:51], s82 offen offset:2304 sc1
 v_mfma_f32_16x16x32_bf16 v[88:91], a[192:195], v[68:71], v[88:91]
 v_mfma_f32_16x16x32_bf16 v[96:99], a[200:203], v[64:67], v[96:99]
 v_mfma_f32_16x16x32_bf16 v[100:103], a[204:207], v[64:67], v[100:103]
 v_mfma_f32_16x16x32_bf16 v[108:111], a[204:207], v[68:71], v[108:111]
 v_mfma_f32_16x16x32_bf16 v[104:107], a[200:203], v[68:71], v[104:107]
 v_mfma_f32_16x16x32_bf16 v[112:115], a[208:211], v[64:67], v[112:115]
 v_mfma_f32_16x16x32_bf16 v[116:119], a[212:215], v[64:67], v[116:119]
 v_mfma_f32_16x16x32_bf16 v[124:127], a[212:215], v[68:71], v[124:127]
 v_mfma_f32_16x16x32_bf16 v[120:123], a[208:211], v[68:71], v[120:123]
 v_mfma_f32_16x16x32_bf16 v[128:131], a[216:219], v[64:67], v[128:131]
 v_mfma_f32_16x16x32_bf16 v[132:135], a[220:223], v[64:67], v[132:135]
 v_mfma_f32_16x16x32_bf16 v[140:143], a[220:223], v[68:71], v[140:143]
 v_mfma_f32_16x16x32_bf16 v[136:139], a[216:219], v[68:71], v[136:139]
 s_waitcnt vmcnt(16)
 v_mfma_f32_16x16x32_bf16 v[80:83], a[224:227], v[72:75], v[80:83]
 s_add_u32 s82, s65, 12288
 buffer_load_dwordx4 v[64:67], v2, s[48:51], s82 offen offset:0 sc1
 v_mfma_f32_16x16x32_bf16 v[84:87], a[228:231], v[72:75], v[84:87]
 v_mfma_f32_16x16x32_bf16 v[92:95], a[228:231], v[76:79], v[92:95]
 buffer_load_dwordx4 v[68:71], v2, s[48:51], s82 offen offset:256 sc1
 v_mfma_f32_16x16x32_bf16 v[88:91], a[224:227], v[76:79], v[88:91]
 s_add_u32 s70, s65, 131072
 v_mfma_f32_16x16x32_bf16 v[96:99], a[232:235], v[72:75], v[96:99]
 buffer_load_dwordx4 v[12:15], v11, s[48:51], s70 offen offset:0 sc1
 v_mfma_f32_16x16x32_bf16 v[100:103], a[236:239], v[72:75], v[100:103]
 s_add_u32 s65, s65, 0x10000
 s_add_u32 s63, s63, 1
 v_mfma_f32_16x16x32_bf16 v[108:111], a[236:239], v[76:79], v[108:111]
 v_mfma_f32_16x16x32_bf16 v[104:107], a[232:235], v[76:79], v[104:107]
 v_mfma_f32_16x16x32_bf16 v[112:115], a[240:243], v[72:75], v[112:115]
 v_mfma_f32_16x16x32_bf16 v[116:119], a[244:247], v[72:75], v[116:119]
 v_mfma_f32_16x16x32_bf16 v[124:127], a[244:247], v[76:79], v[124:127]
 v_mfma_f32_16x16x32_bf16 v[120:123], a[240:243], v[76:79], v[120:123]
 v_mfma_f32_16x16x32_bf16 v[128:131], a[248:251], v[72:75], v[128:131]
 v_mfma_f32_16x16x32_bf16 v[132:135], a[252:255], v[72:75], v[132:135]
 v_mfma_f32_16x16x32_bf16 v[140:143], a[252:255], v[76:79], v[140:143]
 v_mfma_f32_16x16x32_bf16 v[136:139], a[248:251], v[76:79], v[136:139]
 s_branch Lw_Kloop
Lw_Kxf:
news_82:
 v_mov_b32 v3, 0
 global_load_dword v4, v3, s[42:43] offset:132 sc1
 s_waitcnt vmcnt(0)
newschk_84:
 v_readfirstlane_b32 s7, v4
 s_nop 0
 s_and_b32 s7, s7, 8
 s_cmp_eq_u32 s7, 8
 s_cbranch_scc1 newsok_83
 s_sleep 2
 s_sub_u32 s46, s46, 1
 s_cbranch_scc0 news_82
 s_mov_b32 s46, 0
 s_branch newsok_83
newsok_83:
 s_branch Lw_Kxfok
Lw_Kend:
 ds_write_b128 v7, v[160:163] offset:49152
 ds_write_b128 v7, v[164:167] offset:50176
 ds_write_b128 v7, v[168:171] offset:51200
 ds_write_b128 v7, v[172:175] offset:52224
 ds_write_b128 v8, v[176:179] offset:49152
 ds_write_b128 v8, v[180:183] offset:50176
 ds_write_b128 v8, v[184:187] offset:51200
 ds_write_b128 v8, v[188:191] offset:52224
 ds_write_b128 v9, v[192:195] offset:49152
 ds_write_b128 v9, v[196:199] offset:50176
 ds_write_b128 v9, v[200:203] offset:51200
 ds_write_b128 v9, v[204:207] offset:52224
 s_waitcnt lgkmcnt(0)
 s_barrier
 ds_read_b128 v[160:163], v10 offset:49152
 ds_read_b128 v[164:167], v10 offset:50176
 ds_read_b128 v[168:171], v10 offset:51200
 ds_read_b128 v[172:175], v10 offset:52224
 ds_read_b128 v[176:179], v10 offset:53248
 ds_read_b128 v[180:183], v10 offset:54272
 ds_read_b128 v[184:187], v10 offset:55296
 ds_read_b128 v[188:191], v10 offset:56320
 ds_read_b128 v[192:195], v10 offset:57344
 ds_read_b128 v[196:199], v10 offset:58368
 ds_read_b128 v[200:203], v10 offset:59392
 ds_read_b128 v[204:207], v10 offset:60416
 s_waitcnt lgkmcnt(8)
 v_add_f32 v144, v144, v160
 v_add_f32 v145, v145, v161
 v_add_f32 v146, v146, v162
 v_add_f32 v147, v147, v163
 v_add_f32 v148, v148, v164
 v_add_f32 v149, v149, v165
 v_add_f32 v150, v150, v166
 v_add_f32 v151, v151, v167
 v_add_f32 v152, v152, v168
 v_add_f32 v153, v153, v169
 v_add_f32 v154, v154, v170
 v_add_f32 v155, v155, v171
 v_add_f32 v156, v156, v172
 v_add_f32 v157, v157, v173
 v_add_f32 v158, v158, v174
 v_add_f32 v159, v159, v175
 s_waitcnt lgkmcnt(4)
 v_add_f32 v144, v144, v176
 v_add_f32 v145, v145, v177
 v_add_f32 v146, v146, v178
 v_add_f32 v147, v147, v179
 v_add_f32 v148, v148, v180
 v_add_f32 v149, v149, v181
 v_add_f32 v150, v150, v182
 v_add_f32 v151, v151, v183
 v_add_f32 v152, v152, v184
 v_add_f32 v153, v153, v185
 v_add_f32 v154, v154, v186
 v_add_f32 v155, v155, v187
 v_add_f32 v156, v156, v188
 v_add_f32 v157, v157, v189
 v_add_f32 v158, v158, v190
 v_add_f32 v159, v159, v191
 s_waitcnt lgkmcnt(0)
 v_add_f32 v144, v144, v192
 v_add_f32 v145, v145, v193
 v_add_f32 v146, v146, v194
 v_add_f32 v147, v147, v195
 v_add_f32 v148, v148, v196
 v_add_f32 v149, v149, v197
 v_add_f32 v150, v150, v198
 v_add_f32 v151, v151, v199
 v_add_f32 v152, v152, v200
 v_add_f32 v153, v153, v201
 v_add_f32 v154, v154, v202
 v_add_f32 v155, v155, v203
 v_add_f32 v156, v156, v204
 v_add_f32 v157, v157, v205
 v_add_f32 v158, v158, v206
 v_add_f32 v159, v159, v207
 v_cvt_pk_bf16_f32 v224, v144, v145
 v_cvt_pk_bf16_f32 v225, v146, v147
 v_cvt_pk_bf16_f32 v226, v148, v149
 v_cvt_pk_bf16_f32 v227, v150, v151
 buffer_store_dwordx4 v[224:227], v6, s[48:51], s67 offen offset:0 sc1
 v_cvt_pk_bf16_f32 v228, v152, v153
 v_cvt_pk_bf16_f32 v229, v154, v155
 v_cvt_pk_bf16_f32 v230, v156, v157
 v_cvt_pk_bf16_f32 v231, v158, v159
 buffer_store_dwordx4 v[228:231], v6, s[48:51], s67 offen offset:256 sc1
 s_add_u32 s74, s74, 0x40000
 s_and_b32 s69, s74, 0x200000
 s_lshr_b32 s69, s69, 8
 s_xor_b32 s69, s69, s74
 buffer_store_dwordx4 v[232:235], v1, s[48:51], s69 offen sc1
 s_waitcnt vmcnt(0)
 v_mov_b32 v3, 64
 buffer_store_dword v3, v251, s[48:51], s68 offen sc1
 s_waitcnt vmcnt(0) lgkmcnt(0)
 s_branch L_ssm
Lw_V:
 s_lshl_b32 s67, s62, 2
 s_add_u32 s67, s67, s4
 s_lshl_b32 s67, s67, 11
 s_add_u32 s67, s67, 33554432
 s_add_u32 s65, s65, 0x10000
 v_mov_b32 v232, -1
 v_mov_b32 v233, -1
 v_mov_b32 v234, -1
 v_mov_b32 v235, -1
 s_lshr_b32 s74, s62, 1
 s_lshl_b32 s74, s74, 14
 s_and_b32 s69, s62, 1
 s_lshl_b32 s69, s69, 2
 s_add_u32 s69, s69, s4
 s_lshl_b32 s69, s69, 10
 s_add_u32 s74, s74, s69
 s_add_u32 s74, s74, 154927104
 s_lshl_b32 s69, s64, 13
 s_add_u32 s74, s74, s69
 v_mfma_f32_16x16x32_bf16 v[80:83], v[16:19], a[0:3], 0
 v_mfma_f32_16x16x32_bf16 v[84:87], v[16:19], a[4:7], 0
 v_mfma_f32_16x16x32_bf16 v[92:95], v[20:23], a[4:7], 0
 v_mfma_f32_16x16x32_bf16 v[88:91], v[20:23], a[0:3], 0
 v_mfma_f32_16x16x32_bf16 v[96:99], v[16:19], a[8:11], 0
 v_mfma_f32_16x16x32_bf16 v[100:103], v[16:19], a[12:15], 0
 v_mfma_f32_16x16x32_bf16 v[108:111], v[20:23], a[12:15], 0
 v_mfma_f32_16x16x32_bf16 v[104:107], v[20:23], a[8:11], 0
 v_mfma_f32_16x16x32_bf16 v[112:115], v[16:19], a[16:19], 0
 v_mfma_f32_16x16x32_bf16 v[116:119], v[16:19], a[20:23], 0
 v_mfma_f32_16x16x32_bf16 v[124:127], v[20:23], a[20:23], 0
 v_mfma_f32_16x16x32_bf16 v[120:123], v[20:23], a[16:19], 0
 v_mfma_f32_16x16x32_bf16 v[128:131], v[16:19], a[24:27], 0
 v_mfma_f32_16x16x32_bf16 v[132:135], v[16:19], a[28:31], 0
 v_mfma_f32_16x16x32_bf16 v[140:143], v[20:23], a[28:31], 0
 v_mfma_f32_16x16x32_bf16 v[136:139], v[20:23], a[24:27], 0
 v_mfma_f32_16x16x32_bf16 v[80:83], v[24:27], a[32:35], v[80:83]
 s_add_u32 s82, s65, 0
 buffer_load_dwordx4 v[16:19], v2, s[48:51], s82 offen offset:0 sc1
 v_mfma_f32_16x16x32_bf16 v[84:87], v[24:27], a[36:39], v[84:87]
 v_mfma_f32_16x16x32_bf16 v[92:95], v[28:31], a[36:39], v[92:95]
 buffer_load_dwordx4 v[20:23], v2, s[48:51], s82 offen offset:128 sc1
 v_mfma_f32_16x16x32_bf16 v[88:91], v[28:31], a[32:35], v[88:91]
 v_mfma_f32_16x16x32_bf16 v[96:99], v[24:27], a[40:43], v[96:99]
 v_mfma_f32_16x16x32_bf16 v[100:103], v[24:27], a[44:47], v[100:103]
 v_mfma_f32_16x16x32_bf16 v[108:111], v[28:31], a[44:47], v[108:111]
 v_mfma_f32_16x16x32_bf16 v[104:107], v[28:31], a[40:43], v[104:107]
 v_mfma_f32_16x16x32_bf16 v[112:115], v[24:27], a[48:51], v[112:115]
 v_mfma_f32_16x16x32_bf16 v[116:119], v[24:27], a[52:55], v[116:119]
 v_mfma_f32_16x16x32_bf16 v[124:127], v[28:31], a[52:55], v[124:127]
 v_mfma_f32_16x16x32_bf16 v[120:123], v[28:31], a[48:51], v[120:123]
 v_mfma_f32_16x16x32_bf16 v[128:131], v[24:27], a[56:59], v[128:131]
 v_mfma_f32_16x16x32_bf16 v[132:135], v[24:27], a[60:63], v[132:135]
 v_mfma_f32_16x16x32_bf16 v[140:143], v[28:31], a[60:63], v[140:143]
 v_mfma_f32_16x16x32_bf16 v[136:139], v[28:31], a[56:59], v[136:139]
 v_mfma_f32_16x16x32_bf16 v[80:83], v[32:35], a[64:67], v[80:83]
 buffer_load_dwordx4 v[24:27], v2, s[48:51], s82 offen offset:2048 sc1
 v_mfma_f32_16x16x32_bf16 v[84:87], v[32:35], a[68:71], v[84:87]
 v_mfma_f32_16x16x32_bf16 v[92:95], v[36:39], a[68:71], v[92:95]
 buffer_load_dwordx4 v[28:31], v2, s[48:51], s82 offen offset:2176 sc1
 v_mfma_f32_16x16x32_bf16 v[88:91], v[36:39], a[64:67], v[88:91]
 v_mfma_f32_16x16x32_bf16 v[96:99], v[32:35], a[72:75], v[96:99]
 v_mfma_f32_16x16x32_bf16 v[100:103], v[32:35], a[76:79], v[100:103]
 v_mfma_f32_16x16x32_bf16 v[108:111], v[36:39], a[76:79], v[108:111]
 v_mfma_f32_16x16x32_bf16 v[104:107], v[36:39], a[72:75], v[104:107]
 v_mfma_f32_16x16x32_bf16 v[112:115], v[32:35], a[80:83], v[112:115]
 v_mfma_f32_16x16x32_bf16 v[116:119], v[32:35], a[84:87], v[116:119]
 v_mfma_f32_16x16x32_bf16 v[124:127], v[36:39], a[84:87], v[124:127]
 v_mfma_f32_16x16x32_bf16 v[120:123], v[36:39], a[80:83], v[120:123]
 v_mfma_f32_16x16x32_bf16 v[128:131], v[32:35], a[88:91], v[128:131]
 v_mfma_f32_16x16x32_bf16 v[132:135], v[32:35], a[92:95], v[132:135]
 v_mfma_f32_16x16x32_bf16 v[140:143], v[36:39], a[92:95], v[140:143]
 v_mfma_f32_16x16x32_bf16 v[136:139], v[36:39], a[88:91], v[136:139]
 v_mfma_f32_16x16x32_bf16 v[80:83], v[40:43], a[96:99], v[80:83]
 s_add_u32 s82, s65, 4096
 buffer_load_dwordx4 v[32:35], v2, s[48:51], s82 offen offset:0 sc1
 v_mfma_f32_16x16x32_bf16 v[84:87], v[40:43], a[100:103], v[84:87]
 v_mfma_f32_16x16x32_bf16 v[92:95], v[44:47], a[100:103], v[92:95]
 buffer_load_dwordx4 v[36:39], v2, s[48:51], s82 offen offset:128 sc1
 v_mfma_f32_16x16x32_bf16 v[88:91], v[44:47], a[96:99], v[88:91]
 v_mfma_f32_16x16x32_bf16 v[96:99], v[40:43], a[104:107], v[96:99]
 v_mfma_f32_16x16x32_bf16 v[100:103], v[40:43], a[108:111], v[100:103]
 v_mfma_f32_16x16x32_bf16 v[108:111], v[44:47], a[108:111], v[108:111]
 v_mfma_f32_16x16x32_bf16 v[104:107], v[44:47], a[104:107], v[104:107]
 v_mfma_f32_16x16x32_bf16 v[112:115], v[40:43], a[112:115], v[112:115]
 v_mfma_f32_16x16x32_bf16 v[116:119], v[40:43], a[116:119], v[116:119]
 v_mfma_f32_16x16x32_bf16 v[124:127], v[44:47], a[116:119], v[124:127]
 v_mfma_f32_16x16x32_bf16 v[120:123], v[44:47], a[112:115], v[120:123]
 v_mfma_f32_16x16x32_bf16 v[128:131], v[40:43], a[120:123], v[128:131]
 v_mfma_f32_16x16x32_bf16 v[132:135], v[40:43], a[124:127], v[132:135]
 v_mfma_f32_16x16x32_bf16 v[140:143], v[44:47], a[124:127], v[140:143]
 v_mfma_f32_16x16x32_bf16 v[136:139], v[44:47], a[120:123], v[136:139]
 v_mfma_f32_16x16x32_bf16 v[80:83], v[48:51], a[128:131], v[80:83]
 buffer_load_dwordx4 v[40:43], v2, s[48:51], s82 offen offset:2048 sc1
 v_mfma_f32_16x16x32_bf16 v[84:87], v[48:51], a[132:135], v[84:87]
 v_mfma_f32_16x16x32_bf16 v[92:95], v[52:55], a[132:135], v[92:95]
 buffer_load_dwordx4 v[44:47], v2, s[48:51], s82 offen offset:2176 sc1
 v_mfma_f32_16x16x32_bf16 v[88:91], v[52:55], a[128:131], v[88:91]
 v_mfma_f32_16x16x32_bf16 v[96:99], v[48:51], a[136:139], v[96:99]
 s_waitcnt vmcnt(16)
 v_mfma_f32_16x16x32_bf16 v[100:103], v[48:51], a[140:143], v[100:103]
 ds_read_b64_tr_b16 a[192:193], v209 offset:16384
 v_mfma_f32_16x16x32_bf16 v[108:111], v[52:55], a[140:143], v[108:111]
 ds_read_b64_tr_b16 a[194:195], v209 offset:17408
 v_mfma_f32_16x16x32_bf16 v[104:107], v[52:55], a[136:139], v[104:107]
 ds_read_b64_tr_b16 a[196:197], v210 offset:16384
 v_mfma_f32_16x16x32_bf16 v[112:115], v[48:51], a[144:147], v[112:115]
 ds_read_b64_tr_b16 a[198:199], v210 offset:17408
 v_mfma_f32_16x16x32_bf16 v[116:119], v[48:51], a[148:151], v[116:119]
 ds_read_b64_tr_b16 a[200:201], v211 offset:16384
 v_mfma_f32_16x16x32_bf16 v[124:127], v[52:55], a[148:151], v[124:127]
 ds_read_b64_tr_b16 a[202:203], v211 offset:17408
 v_mfma_f32_16x16x32_bf16 v[120:123], v[52:55], a[144:147], v[120:123]
 ds_read_b64_tr_b16 a[204:205], v212 offset:16384
 v_mfma_f32_16x16x32_bf16 v[128:131], v[48:51], a[152:155], v[128:131]
 ds_read_b64_tr_b16 a[206:207], v212 offset:17408
 v_mfma_f32_16x16x32_bf16 v[132:135], v[48:51], a[156:159], v[132:135]
 s_waitcnt lgkmcnt(0)
 v_mfma_f32_16x16x32_bf16 v[140:143], v[52:55], a[156:159], v[140:143]
 ds_read_b64_tr_b16 a[208:209], v213 offset:16384
 v_mfma_f32_16x16x32_bf16 v[136:139], v[52:55], a[152:155], v[136:139]
 ds_read_b64_tr_b16 a[210:211], v213 offset:17408
 v_mfma_f32_16x16x32_bf16 v[80:83], v[56:59], a[160:163], v[80:83]
 s_add_u32 s82, s65, 8192
 buffer_load_dwordx4 v[48:51], v2, s[48:51], s82 offen offset:0 sc1
 v_mfma_f32_16x16x32_bf16 v[84:87], v[56:59], a[164:167], v[84:87]
 ds_read_b64_tr_b16 a[212:213], v214 offset:16384
 v_mfma_f32_16x16x32_bf16 v[92:95], v[60:63], a[164:167], v[92:95]
 buffer_load_dwordx4 v[52:55], v2, s[48:51], s82 offen offset:128 sc1
 v_mfma_f32_16x16x32_bf16 v[88:91], v[60:63], a[160:163], v[88:91]
 ds_read_b64_tr_b16 a[214:215], v214 offset:17408
 v_mfma_f32_16x16x32_bf16 v[96:99], v[56:59], a[168:171], v[96:99]
 ds_read_b64_tr_b16 a[216:217], v215 offset:16384
 v_mfma_f32_16x16x32_bf16 v[100:103], v[56:59], a[172:175], v[100:103]
 ds_read_b64_tr_b16 a[218:219], v215 offset:17408
 v_mfma_f32_16x16x32_bf16 v[108:111], v[60:63], a[172:175], v[108:111]
 ds_read_b64_tr_b16 a[220:221], v216 offset:16384
 v_mfma_f32_16x16x32_bf16 v[104:107], v[60:63], a[168:171], v[104:107]
 ds_read_b64_tr_b16 a[222:223], v216 offset:17408
 v_mfma_f32_16x16x32_bf16 v[112:115], v[56:59], a[176:179], v[112:115]
 s_waitcnt lgkmcnt(0)
 v_mfma_f32_16x16x32_bf16 v[116:119], v[56:59], a[180:183], v[116:119]
 v_mfma_f32_16x16x32_bf16 v[124:127], v[60:63], a[180:183], v[124:127]
 s_waitcnt vmcnt(10)
 v_mfma_f32_16x16x32_bf16 v[120:123], v[60:63], a[176:179], v[120:123]
 ds_read_b64_tr_b16 a[224:225], v209 offset:24576
 v_mfma_f32_16x16x32_bf16 v[128:131], v[56:59], a[184:187], v[128:131]
 ds_read_b64_tr_b16 a[226:227], v209 offset:25600
 v_mfma_f32_16x16x32_bf16 v[132:135], v[56:59], a[188:191], v[132:135]
 ds_read_b64_tr_b16 a[228:229], v210 offset:24576
 v_mfma_f32_16x16x32_bf16 v[140:143], v[60:63], a[188:191], v[140:143]
 ds_read_b64_tr_b16 a[230:231], v210 offset:25600
 v_mfma_f32_16x16x32_bf16 v[136:139], v[60:63], a[184:187], v[136:139]
 ds_read_b64_tr_b16 a[232:233], v211 offset:24576
 v_mfma_f32_16x16x32_bf16 v[80:83], v[64:67], a[192:195], v[80:83]
 buffer_load_dwordx4 v[56:59], v2, s[48:51], s82 offen offset:2048 sc1
 v_mfma_f32_16x16x32_bf16 v[84:87], v[64:67], a[196:199], v[84:87]
 ds_read_b64_tr_b16 a[234:235], v211 offset:25600
 v_mfma_f32_16x16x32_bf16 v[92:95], v[68:71], a[196:199], v[92:95]
 buffer_load_dwordx4 v[60:63], v2, s[48:51], s82 offen offset:2176 sc1
 v_mfma_f32_16x16x32_bf16 v[88:91], v[68:71], a[192:195], v[88:91]
 ds_read_b64_tr_b16 a[236:237], v212 offset:24576
 v_mfma_f32_16x16x32_bf16 v[96:99], v[64:67], a[200:203], v[96:99]
 ds_read_b64_tr_b16 a[238:239], v212 offset:25600
 v_mfma_f32_16x16x32_bf16 v[100:103], v[64:67], a[204:207], v[100:103]
 s_waitcnt lgkmcnt(0)
 v_mfma_f32_16x16x32_bf16 v[108:111], v[68:71], a[204:207], v[108:111]
 ds_read_b64_tr_b16 a[240:241], v213 offset:24576
 v_mfma_f32_16x16x32_bf16 v[104:107], v[68:71], a[200:203], v[104:107]
 ds_read_b64_tr_b16 a[242:243], v213 offset:25600
 v_mfma_f32_16x16x32_bf16 v[112:115], v[64:67], a[208:211], v[112:115]
 ds_read_b64_tr_b16 a[244:245], v214 offset:24576
 v_mfma_f32_16x16x32_bf16 v[116:119], v[64:67], a[212:215], v[116:119]
 ds_read_b64_tr_b16 a[246:247], v214 offset:25600
 v_mfma_f32_16x16x32_bf16 v[124:127], v[68:71], a[212:215], v[124:127]
 ds_read_b64_tr_b16 a[248:249], v215 offset:24576
 v_mfma_f32_16x16x32_bf16 v[120:123], v[68:71], a[208:211], v[120:123]
 ds_read_b64_tr_b16 a[250:251], v215 offset:25600
 v_mfma_f32_16x16x32_bf16 v[128:131], v[64:67], a[216:219], v[128:131]
 ds_read_b64_tr_b16 a[252:253], v216 offset:24576
 v_mfma_f32_16x16x32_bf16 v[132:135], v[64:67], a[220:223], v[132:135]
 ds_read_b64_tr_b16 a[254:255], v216 offset:25600
 v_mfma_f32_16x16x32_bf16 v[140:143], v[68:71], a[220:223], v[140:143]
 s_waitcnt lgkmcnt(0)
 v_mfma_f32_16x16x32_bf16 v[136:139], v[68:71], a[216:219], v[136:139]
 v_mfma_f32_16x16x32_bf16 v[80:83], v[72:75], a[224:227], v[80:83]
 s_add_u32 s82, s65, 12288
 buffer_load_dwordx4 v[64:67], v2, s[48:51], s82 offen offset:0 sc1
 v_mfma_f32_16x16x32_bf16 v[84:87], v[72:75], a[228:231], v[84:87]
 v_mfma_f32_16x16x32_bf16 v[92:95], v[76:79], a[228:231], v[92:95]
 buffer_load_dwordx4 v[68:71], v2, s[48:51], s82 offen offset:128 sc1
 v_mfma_f32_16x16x32_bf16 v[88:91], v[76:79], a[224:227], v[88:91]
 s_add_u32 s70, s65, 131072
 v_mfma_f32_16x16x32_bf16 v[96:99], v[72:75], a[232:235], v[96:99]
 buffer_load_dwordx4 v[12:15], v11, s[48:51], s70 offen offset:0 sc1
 v_mfma_f32_16x16x32_bf16 v[100:103], v[72:75], a[236:239], v[100:103]
 s_add_u32 s65, s65, 0x10000
 s_add_u32 s63, s63, 1
 v_mfma_f32_16x16x32_bf16 v[108:111], v[76:79], a[236:239], v[108:111]
 v_mfma_f32_16x16x32_bf16 v[104:107], v[76:79], a[232:235], v[104:107]
 v_mfma_f32_16x16x32_bf16 v[112:115], v[72:75], a[240:243], v[112:115]
 v_mfma_f32_16x16x32_bf16 v[116:119], v[72:75], a[244:247], v[116:119]
 v_mfma_f32_16x16x32_bf16 v[124:127], v[76:79], a[244:247], v[124:127]
 v_mfma_f32_16x16x32_bf16 v[120:123], v[76:79], a[240:243], v[120:123]
 v_mfma_f32_16x16x32_bf16 v[128:131], v[72:75], a[248:251], v[128:131]
 v_mfma_f32_16x16x32_bf16 v[132:135], v[72:75], a[252:255], v[132:135]
 v_mfma_f32_16x16x32_bf16 v[140:143], v[76:79], a[252:255], v[140:143]
 v_mfma_f32_16x16x32_bf16 v[136:139], v[76:79], a[248:251], v[136:139]
 s_barrier
 ds_write_b128 v7, v[96:99] offset:0
 ds_write_b128 v7, v[100:103] offset:1024
 ds_write_b128 v7, v[104:107] offset:2048
 ds_write_b128 v7, v[108:111] offset:3072
 ds_write_b128 v8, v[112:115] offset:0
 ds_write_b128 v8, v[116:119] offset:1024
 ds_write_b128 v8, v[120:123] offset:2048
 ds_write_b128 v8, v[124:127] offset:3072
 ds_write_b128 v9, v[128:131] offset:0
 ds_write_b128 v9, v[132:135] offset:1024
 ds_write_b128 v9, v[136:139] offset:2048
 ds_write_b128 v9, v[140:143] offset:3072
 s_waitcnt lgkmcnt(0)
 s_barrier
 ds_read_b128 v[96:99], v10 offset:0
 ds_read_b128 v[100:103], v10 offset:1024
 ds_read_b128 v[104:107], v10 offset:2048
 ds_read_b128 v[108:111], v10 offset:3072
 ds_read_b128 v[112:115], v10 offset:4096
 ds_read_b128 v[116:119], v10 offset:5120
 ds_read_b128 v[120:123], v10 offset:6144
 ds_read_b128 v[124:127], v10 offset:7168
 ds_read_b128 v[128:131], v10 offset:8192
 ds_read_b128 v[132:135], v10 offset:9216
 ds_read_b128 v[136:139], v10 offset:10240
 ds_read_b128 v[140:143], v10 offset:11264
 s_waitcnt lgkmcnt(8)
 v_add_f32 v80, v80, v96
 v_add_f32 v81, v81, v97
 v_add_f32 v82, v82, v98
 v_add_f32 v83, v83, v99
 v_add_f32 v84, v84, v100
 v_add_f32 v85, v85, v101
 v_add_f32 v86, v86, v102
 v_add_f32 v87, v87, v103
 v_add_f32 v88, v88, v104
 v_add_f32 v89, v89, v105
 v_add_f32 v90, v90, v106
 v_add_f32 v91, v91, v107
 v_add_f32 v92, v92, v108
 v_add_f32 v93, v93, v109
 v_add_f32 v94, v94, v110
 v_add_f32 v95, v95, v111
 s_waitcnt lgkmcnt(4)
 v_add_f32 v80, v80, v112
 v_add_f32 v81, v81, v113
 v_add_f32 v82, v82, v114
 v_add_f32 v83, v83, v115
 v_add_f32 v84, v84, v116
 v_add_f32 v85, v85, v117
 v_add_f32 v86, v86, v118
 v_add_f32 v87, v87, v119
 v_add_f32 v88, v88, v120
 v_add_f32 v89, v89, v121
 v_add_f32 v90, v90, v122
 v_add_f32 v91, v91, v123
 v_add_f32 v92, v92, v124
 v_add_f32 v93, v93, v125
 v_add_f32 v94, v94, v126
 v_add_f32 v95, v95, v127
 s_waitcnt lgkmcnt(0)
 v_add_f32 v80, v80, v128
 v_add_f32 v81, v81, v129
 v_add_f32 v82, v82, v130
 v_add_f32 v83, v83, v131
 v_add_f32 v84, v84, v132
 v_add_f32 v85, v85, v133
 v_add_f32 v86, v86, v134
 v_add_f32 v87, v87, v135
 v_add_f32 v88, v88, v136
 v_add_f32 v89, v89, v137
 v_add_f32 v90, v90, v138
 v_add_f32 v91, v91, v139
 v_add_f32 v92, v92, v140
 v_add_f32 v93, v93, v141
 v_add_f32 v94, v94, v142
 v_add_f32 v95, v95, v143
 v_cvt_pk_bf16_f32 v224, v80, v81
 v_cvt_pk_bf16_f32 v225, v82, v83
 v_cvt_pk_bf16_f32 v226, v88, v89
 v_cvt_pk_bf16_f32 v227, v90, v91
 buffer_store_dwordx4 v[224:227], v6, s[48:51], s67 offen offset:0 sc1
 v_cvt_pk_bf16_f32 v228, v84, v85
 v_cvt_pk_bf16_f32 v229, v86, v87
 v_cvt_pk_bf16_f32 v230, v92, v93
 v_cvt_pk_bf16_f32 v231, v94, v95
 buffer_store_dwordx4 v[228:231], v6, s[48:51], s67 offen offset:256 sc1
 s_add_u32 s74, s74, 0x40000
 s_and_b32 s69, s74, 0x200000
 s_lshr_b32 s69, s69, 8
 s_xor_b32 s69, s69, s74
 buffer_store_dwordx4 v[232:235], v1, s[48:51], s69 offen sc1
 s_add_u32 s67, s67, 0x40000
 s_waitcnt vmcnt(0)
 v_mov_b32 v3, 1
 buffer_store_dword v3, v251, s[48:51], s68 offen sc1
 v_mfma_f32_16x16x32_bf16 v[144:147], v[16:19], a[0:3], 0
 buffer_load_dwordx4 v[72:75], v2, s[48:51], s82 offen offset:2048 sc1
 v_mfma_f32_16x16x32_bf16 v[148:151], v[16:19], a[4:7], 0
 v_mfma_f32_16x16x32_bf16 v[156:159], v[20:23], a[4:7], 0
 buffer_load_dwordx4 v[76:79], v2, s[48:51], s82 offen offset:2176 sc1
 v_mfma_f32_16x16x32_bf16 v[152:155], v[20:23], a[0:3], 0
 v_mfma_f32_16x16x32_bf16 v[160:163], v[16:19], a[8:11], 0
 v_mfma_f32_16x16x32_bf16 v[164:167], v[16:19], a[12:15], 0
 v_mfma_f32_16x16x32_bf16 v[172:175], v[20:23], a[12:15], 0
 v_mfma_f32_16x16x32_bf16 v[168:171], v[20:23], a[8:11], 0
 v_mfma_f32_16x16x32_bf16 v[176:179], v[16:19], a[16:19], 0
 v_mfma_f32_16x16x32_bf16 v[180:183], v[16:19], a[20:23], 0
 v_mfma_f32_16x16x32_bf16 v[188:191], v[20:23], a[20:23], 0
 v_mfma_f32_16x16x32_bf16 v[184:187], v[20:23], a[16:19], 0
 v_mfma_f32_16x16x32_bf16 v[192:195], v[16:19], a[24:27], 0
 v_mfma_f32_16x16x32_bf16 v[196:199], v[16:19], a[28:31], 0
 v_mfma_f32_16x16x32_bf16 v[204:207], v[20:23], a[28:31], 0
 v_mfma_f32_16x16x32_bf16 v[200:203], v[20:23], a[24:27], 0
 v_mfma_f32_16x16x32_bf16 v[144:147], v[24:27], a[32:35], v[144:147]
 s_add_u32 s82, s65, 0
 buffer_load_dwordx4 v[16:19], v2, s[48:51], s82 offen offset:0 sc1
 v_mfma_f32_16x16x32_bf16 v[148:151], v[24:27], a[36:39], v[148:151]
 v_mfma_f32_16x16x32_bf16 v[156:159], v[28:31], a[36:39], v[156:159]
 buffer_load_dwordx4 v[20:23], v2, s[48:51], s82 offen offset:128 sc1
 v_mfma_f32_16x16x32_bf16 v[152:155], v[28:31], a[32:35], v[152:155]
 v_mfma_f32_16x16x32_bf16 v[160:163], v[24:27], a[40:43], v[160:163]
 v_mfma_f32_16x16x32_bf16 v[164:167], v[24:27], a[44:47], v[164:167]
 v_mfma_f32_16x16x32_bf16 v[172:175], v[28:31], a[44:47], v[172:175]
 v_mfma_f32_16x16x32_bf16 v[168:171], v[28:31], a[40:43], v[168:171]
 v_mfma_f32_16x16x32_bf16 v[176:179], v[24:27], a[48:51], v[176:179]
 v_mfma_f32_16x16x32_bf16 v[180:183], v[24:27], a[52:55], v[180:183]
 v_mfma_f32_16x16x32_bf16 v[188:191], v[28:31], a[52:55], v[188:191]
 v_mfma_f32_16x16x32_bf16 v[184:187], v[28:31], a[48:51], v[184:187]
 v_mfma_f32_16x16x32_bf16 v[192:195], v[24:27], a[56:59], v[192:195]
 v_mfma_f32_16x16x32_bf16 v[196:199], v[24:27], a[60:63], v[196:199]
 v_mfma_f32_16x16x32_bf16 v[204:207], v[28:31], a[60:63], v[204:207]
 v_mfma_f32_16x16x32_bf16 v[200:203], v[28:31], a[56:59], v[200:203]
 v_mfma_f32_16x16x32_bf16 v[144:147], v[32:35], a[64:67], v[144:147]
 buffer_load_dwordx4 v[24:27], v2, s[48:51], s82 offen offset:2048 sc1
 v_mfma_f32_16x16x32_bf16 v[148:151], v[32:35], a[68:71], v[148:151]
 v_mfma_f32_16x16x32_bf16 v[156:159], v[36:39], a[68:71], v[156:159]
 buffer_load_dwordx4 v[28:31], v2, s[48:51], s82 offen offset:2176 sc1
 v_mfma_f32_16x16x32_bf16 v[152:155], v[36:39], a[64:67], v[152:155]
 v_mfma_f32_16x16x32_bf16 v[160:163], v[32:35], a[72:75], v[160:163]
 v_mfma_f32_16x16x32_bf16 v[164:167], v[32:35], a[76:79], v[164:167]
 v_mfma_f32_16x16x32_bf16 v[172:175], v[36:39], a[76:79], v[172:175]
 v_mfma_f32_16x16x32_bf16 v[168:171], v[36:39], a[72:75], v[168:171]
 v_mfma_f32_16x16x32_bf16 v[176:179], v[32:35], a[80:83], v[176:179]
 v_mfma_f32_16x16x32_bf16 v[180:183], v[32:35], a[84:87], v[180:183]
 v_mfma_f32_16x16x32_bf16 v[188:191], v[36:39], a[84:87], v[188:191]
 v_mfma_f32_16x16x32_bf16 v[184:187], v[36:39], a[80:83], v[184:187]
 v_mfma_f32_16x16x32_bf16 v[192:195], v[32:35], a[88:91], v[192:195]
 v_mfma_f32_16x16x32_bf16 v[196:199], v[32:35], a[92:95], v[196:199]
 v_mfma_f32_16x16x32_bf16 v[204:207], v[36:39], a[92:95], v[204:207]
 v_mfma_f32_16x16x32_bf16 v[200:203], v[36:39], a[88:91], v[200:203]
 v_mfma_f32_16x16x32_bf16 v[144:147], v[40:43], a[96:99], v[144:147]
 s_add_u32 s82, s65, 4096
 buffer_load_dwordx4 v[32:35], v2, s[48:51], s82 offen offset:0 sc1
 v_mfma_f32_16x16x32_bf16 v[148:151], v[40:43], a[100:103], v[148:151]
 v_mfma_f32_16x16x32_bf16 v[156:159], v[44:47], a[100:103], v[156:159]
 buffer_load_dwordx4 v[36:39], v2, s[48:51], s82 offen offset:128 sc1
 v_mfma_f32_16x16x32_bf16 v[152:155], v[44:47], a[96:99], v[152:155]
 v_mfma_f32_16x16x32_bf16 v[160:163], v[40:43], a[104:107], v[160:163]
 v_mfma_f32_16x16x32_bf16 v[164:167], v[40:43], a[108:111], v[164:167]
 v_mfma_f32_16x16x32_bf16 v[172:175], v[44:47], a[108:111], v[172:175]
 v_mfma_f32_16x16x32_bf16 v[168:171], v[44:47], a[104:107], v[168:171]
 v_mfma_f32_16x16x32_bf16 v[176:179], v[40:43], a[112:115], v[176:179]
 v_mfma_f32_16x16x32_bf16 v[180:183], v[40:43], a[116:119], v[180:183]
 v_mfma_f32_16x16x32_bf16 v[188:191], v[44:47], a[116:119], v[188:191]
 v_mfma_f32_16x16x32_bf16 v[184:187], v[44:47], a[112:115], v[184:187]
 v_mfma_f32_16x16x32_bf16 v[192:195], v[40:43], a[120:123], v[192:195]
 v_mfma_f32_16x16x32_bf16 v[196:199], v[40:43], a[124:127], v[196:199]
 v_mfma_f32_16x16x32_bf16 v[204:207], v[44:47], a[124:127], v[204:207]
 v_mfma_f32_16x16x32_bf16 v[200:203], v[44:47], a[120:123], v[200:203]
 v_mfma_f32_16x16x32_bf16 v[144:147], v[48:51], a[128:131], v[144:147]
 buffer_load_dwordx4 v[40:43], v2, s[48:51], s82 offen offset:2048 sc1
 v_mfma_f32_16x16x32_bf16 v[148:151], v[48:51], a[132:135], v[148:151]
 v_mfma_f32_16x16x32_bf16 v[156:159], v[52:55], a[132:135], v[156:159]
 buffer_load_dwordx4 v[44:47], v2, s[48:51], s82 offen offset:2176 sc1
 v_mfma_f32_16x16x32_bf16 v[152:155], v[52:55], a[128:131], v[152:155]
 v_mfma_f32_16x16x32_bf16 v[160:163], v[48:51], a[136:139], v[160:163]
 v_mfma_f32_16x16x32_bf16 v[164:167], v[48:51], a[140:143], v[164:167]
 v_mfma_f32_16x16x32_bf16 v[172:175], v[52:55], a[140:143], v[172:175]
 v_mfma_f32_16x16x32_bf16 v[168:171], v[52:55], a[136:139], v[168:171]
 v_mfma_f32_16x16x32_bf16 v[176:179], v[48:51], a[144:147], v[176:179]
 v_mfma_f32_16x16x32_bf16 v[180:183], v[48:51], a[148:151], v[180:183]
 v_mfma_f32_16x16x32_bf16 v[188:191], v[52:55], a[148:151], v[188:191]
 v_mfma_f32_16x16x32_bf16 v[184:187], v[52:55], a[144:147], v[184:187]
 v_mfma_f32_16x16x32_bf16 v[192:195], v[48:51], a[152:155], v[192:195]
 v_mfma_f32_16x16x32_bf16 v[196:199], v[48:51], a[156:159], v[196:199]
 v_mfma_f32_16x16x32_bf16 v[204:207], v[52:55], a[156:159], v[204:207]
 v_mfma_f32_16x16x32_bf16 v[200:203], v[52:55], a[152:155], v[200:203]
 v_mfma_f32_16x16x32_bf16 v[144:147], v[56:59], a[160:163], v[144:147]
 s_add_u32 s82, s65, 8192
 buffer_load_dwordx4 v[48:51], v2, s[48:51], s82 offen offset:0 sc1
 v_mfma_f32_16x16x32_bf16 v[148:151], v[56:59], a[164:167], v[148:151]
 v_mfma_f32_16x16x32_bf16 v[156:159], v[60:63], a[164:167], v[156:159]
 buffer_load_dwordx4 v[52:55], v2, s[48:51], s82 offen offset:128 sc1
 v_mfma_f32_16x16x32_bf16 v[152:155], v[60:63], a[160:163], v[152:155]
 v_mfma_f32_16x16x32_bf16 v[160:163], v[56:59], a[168:171], v[160:163]
 v_mfma_f32_16x16x32_bf16 v[164:167], v[56:59], a[172:175], v[164:167]
 v_mfma_f32_16x16x32_bf16 v[172:175], v[60:63], a[172:175], v[172:175]
 v_mfma_f32_16x16x32_bf16 v[168:171], v[60:63], a[168:171], v[168:171]
 v_mfma_f32_16x16x32_bf16 v[176:179], v[56:59], a[176:179], v[176:179]
 v_mfma_f32_16x16x32_bf16 v[180:183], v[56:59], a[180:183], v[180:183]
 v_mfma_f32_16x16x32_bf16 v[188:191], v[60:63], a[180:183], v[188:191]
 v_mfma_f32_16x16x32_bf16 v[184:187], v[60:63], a[176:179], v[184:187]
 v_mfma_f32_16x16x32_bf16 v[192:195], v[56:59], a[184:187], v[192:195]
 v_mfma_f32_16x16x32_bf16 v[196:199], v[56:59], a[188:191], v[196:199]
 v_mfma_f32_16x16x32_bf16 v[204:207], v[60:63], a[188:191], v[204:207]
 v_mfma_f32_16x16x32_bf16 v[200:203], v[60:63], a[184:187], v[200:203]
 v_mfma_f32_16x16x32_bf16 v[144:147], v[64:67], a[192:195], v[144:147]
 buffer_load_dwordx4 v[56:59], v2, s[48:51], s82 offen offset:2048 sc1
 v_mfma_f32_16x16x32_bf16 v[148:151], v[64:67], a[196:199], v[148:151]
 v_mfma_f32_16x16x32_bf16 v[156:159], v[68:71], a[196:199], v[156:159]
 buffer_load_dwordx4 v[60:63], v2, s[48:51], s82 offen offset:2176 sc1
 v_mfma_f32_16x16x32_bf16 v[152:155], v[68:71], a[192:195], v[152:155]
 v_mfma_f32_16x16x32_bf16 v[160:163], v[64:67], a[200:203], v[160:163]
 v_mfma_f32_16x16x32_bf16 v[164:167], v[64:67], a[204:207], v[164:167]
 v_mfma_f32_16x16x32_bf16 v[172:175], v[68:71], a[204:207], v[172:175]
 v_mfma_f32_16x16x32_bf16 v[168:171], v[68:71], a[200:203], v[168:171]
 v_mfma_f32_16x16x32_bf16 v[176:179], v[64:67], a[208:211], v[176:179]
 v_mfma_f32_16x16x32_bf16 v[180:183], v[64:67], a[212:215], v[180:183]
 v_mfma_f32_16x16x32_bf16 v[188:191], v[68:71], a[212:215], v[188:191]
 v_mfma_f32_16x16x32_bf16 v[184:187], v[68:71], a[208:211], v[184:187]
 v_mfma_f32_16x16x32_bf16 v[192:195], v[64:67], a[216:219], v[192:195]
 v_mfma_f32_16x16x32_bf16 v[196:199], v[64:67], a[220:223], v[196:199]
 v_mfma_f32_16x16x32_bf16 v[204:207], v[68:71], a[220:223], v[204:207]
 v_mfma_f32_16x16x32_bf16 v[200:203], v[68:71], a[216:219], v[200:203]
 s_waitcnt vmcnt(12)
 v_mfma_f32_16x16x32_bf16 v[144:147], v[72:75], a[224:227], v[144:147]
 s_add_u32 s82, s65, 12288
 buffer_load_dwordx4 v[64:67], v2, s[48:51], s82 offen offset:0 sc1
 v_mfma_f32_16x16x32_bf16 v[148:151], v[72:75], a[228:231], v[148:151]
 v_mfma_f32_16x16x32_bf16 v[156:159], v[76:79], a[228:231], v[156:159]
 buffer_load_dwordx4 v[68:71], v2, s[48:51], s82 offen offset:128 sc1
 v_mfma_f32_16x16x32_bf16 v[152:155], v[76:79], a[224:227], v[152:155]
 s_add_u32 s70, s65, 131072
 v_mfma_f32_16x16x32_bf16 v[160:163], v[72:75], a[232:235], v[160:163]
 buffer_load_dwordx4 v[12:15], v11, s[48:51], s70 offen offset:0 sc1
 v_mfma_f32_16x16x32_bf16 v[164:167], v[72:75], a[236:239], v[164:167]
 s_add_u32 s65, s65, 0x10000
 s_add_u32 s63, s63, 1
 v_mfma_f32_16x16x32_bf16 v[172:175], v[76:79], a[236:239], v[172:175]
 v_mfma_f32_16x16x32_bf16 v[168:171], v[76:79], a[232:235], v[168:171]
 v_mfma_f32_16x16x32_bf16 v[176:179], v[72:75], a[240:243], v[176:179]
 v_mfma_f32_16x16x32_bf16 v[180:183], v[72:75], a[244:247], v[180:183]
 v_mfma_f32_16x16x32_bf16 v[188:191], v[76:79], a[244:247], v[188:191]
 v_mfma_f32_16x16x32_bf16 v[184:187], v[76:79], a[240:243], v[184:187]
 v_mfma_f32_16x16x32_bf16 v[192:195], v[72:75], a[248:251], v[192:195]
 v_mfma_f32_16x16x32_bf16 v[196:199], v[72:75], a[252:255], v[196:199]
 v_mfma_f32_16x16x32_bf16 v[204:207], v[76:79], a[252:255], v[204:207]
 v_mfma_f32_16x16x32_bf16 v[200:203], v[76:79], a[248:251], v[200:203]
 ds_write_b128 v7, v[160:163] offset:49152
 ds_write_b128 v7, v[164:167] offset:50176
 ds_write_b128 v7, v[168:171] offset:51200
 ds_write_b128 v7, v[172:175] offset:52224
 ds_write_b128 v8, v[176:179] offset:49152
 ds_write_b128 v8, v[180:183] offset:50176
 ds_write_b128 v8, v[184:187] offset:51200
 ds_write_b128 v8, v[188:191] offset:52224
 ds_write_b128 v9, v[192:195] offset:49152
 ds_write_b128 v9, v[196:199] offset:50176
 ds_write_b128 v9, v[200:203] offset:51200
 ds_write_b128 v9, v[204:207] offset:52224
 s_waitcnt lgkmcnt(0)
 s_barrier
 ds_read_b128 v[160:163], v10 offset:49152
 ds_read_b128 v[164:167], v10 offset:50176
 ds_read_b128 v[168:171], v10 offset:51200
 ds_read_b128 v[172:175], v10 offset:52224
 ds_read_b128 v[176:179], v10 offset:53248
 ds_read_b128 v[180:183], v10 offset:54272
 ds_read_b128 v[184:187], v10 offset:55296
 ds_read_b128 v[188:191], v10 offset:56320
 ds_read_b128 v[192:195], v10 offset:57344
 ds_read_b128 v[196:199], v10 offset:58368
 ds_read_b128 v[200:203], v10 offset:59392
 ds_read_b128 v[204:207], v10 offset:60416
 s_waitcnt lgkmcnt(8)
 v_add_f32 v144, v144, v160
 v_add_f32 v145, v145, v161
 v_add_f32 v146, v146, v162
 v_add_f32 v147, v147, v163
 v_add_f32 v148, v148, v164
 v_add_f32 v149, v149, v165
 v_add_f32 v150, v150, v166
 v_add_f32 v151, v151, v167
 v_add_f32 v152, v152, v168
 v_add_f32 v153, v153, v169
 v_add_f32 v154, v154, v170
 v_add_f32 v155, v155, v171
 v_add_f32 v156, v156, v172
 v_add_f32 v157, v157, v173
 v_add_f32 v158, v158, v174
 v_add_f32 v159, v159, v175
 s_waitcnt lgkmcnt(4)
 v_add_f32 v144, v144, v176
 v_add_f32 v145, v145, v177
 v_add_f32 v146, v146, v178
 v_add_f32 v147, v147, v179
 v_add_f32 v148, v148, v180
 v_add_f32 v149, v149, v181
 v_add_f32 v150, v150, v182
 v_add_f32 v151, v151, v183
 v_add_f32 v152, v152, v184
 v_add_f32 v153, v153, v185
 v_add_f32 v154, v154, v186
 v_add_f32 v155, v155, v187
 v_add_f32 v156, v156, v188
 v_add_f32 v157, v157, v189
 v_add_f32 v158, v158, v190
 v_add_f32 v159, v159, v191
 s_waitcnt lgkmcnt(0)
 v_add_f32 v144, v144, v192
 v_add_f32 v145, v145, v193
 v_add_f32 v146, v146, v194
 v_add_f32 v147, v147, v195
 v_add_f32 v148, v148, v196
 v_add_f32 v149, v149, v197
 v_add_f32 v150, v150, v198
 v_add_f32 v151, v151, v199
 v_add_f32 v152, v152, v200
 v_add_f32 v153, v153, v201
 v_add_f32 v154, v154, v202
 v_add_f32 v155, v155, v203
 v_add_f32 v156, v156, v204
 v_add_f32 v157, v157, v205
 v_add_f32 v158, v158, v206
 v_add_f32 v159, v159, v207
 v_cvt_pk_bf16_f32 v224, v144, v145
 v_cvt_pk_bf16_f32 v225, v146, v147
 v_cvt_pk_bf16_f32 v226, v152, v153
 v_cvt_pk_bf16_f32 v227, v154, v155
 buffer_store_dwordx4 v[224:227], v6, s[48:51], s67 offen offset:0 sc1
 v_cvt_pk_bf16_f32 v228, v148, v149
 v_cvt_pk_bf16_f32 v229, v150, v151
 v_cvt_pk_bf16_f32 v230, v156, v157
 v_cvt_pk_bf16_f32 v231, v158, v159
 buffer_store_dwordx4 v[228:231], v6, s[48:51], s67 offen offset:256 sc1
 s_add_u32 s74, s74, 0x40000
 s_and_b32 s69, s74, 0x200000
 s_lshr_b32 s69, s69, 8
 s_xor_b32 s69, s69, s74
 buffer_store_dwordx4 v[232:235], v1, s[48:51], s69 offen sc1
 s_add_u32 s67, s67, 0x40000
 s_waitcnt vmcnt(0)
 v_mov_b32 v3, 2
 buffer_store_dword v3, v251, s[48:51], s68 offen sc1
 v_mfma_f32_16x16x32_bf16 v[80:83], v[16:19], a[0:3], 0
 buffer_load_dwordx4 v[72:75], v2, s[48:51], s82 offen offset:2048 sc1
 v_mfma_f32_16x16x32_bf16 v[84:87], v[16:19], a[4:7], 0
 v_mfma_f32_16x16x32_bf16 v[92:95], v[20:23], a[4:7], 0
 buffer_load_dwordx4 v[76:79], v2, s[48:51], s82 offen offset:2176 sc1
 v_mfma_f32_16x16x32_bf16 v[88:91], v[20:23], a[0:3], 0
 v_mfma_f32_16x16x32_bf16 v[96:99], v[16:19], a[8:11], 0
 v_mfma_f32_16x16x32_bf16 v[100:103], v[16:19], a[12:15], 0
 v_mfma_f32_16x16x32_bf16 v[108:111], v[20:23], a[12:15], 0
 v_mfma_f32_16x16x32_bf16 v[104:107], v[20:23], a[8:11], 0
 v_mfma_f32_16x16x32_bf16 v[112:115], v[16:19], a[16:19], 0
 v_mfma_f32_16x16x32_bf16 v[116:119], v[16:19], a[20:23], 0
 v_mfma_f32_16x16x32_bf16 v[124:127], v[20:23], a[20:23], 0
 v_mfma_f32_16x16x32_bf16 v[120:123], v[20:23], a[16:19], 0
 v_mfma_f32_16x16x32_bf16 v[128:131], v[16:19], a[24:27], 0
 v_mfma_f32_16x16x32_bf16 v[132:135], v[16:19], a[28:31], 0
 v_mfma_f32_16x16x32_bf16 v[140:143], v[20:23], a[28:31], 0
 v_mfma_f32_16x16x32_bf16 v[136:139], v[20:23], a[24:27], 0
 v_mfma_f32_16x16x32_bf16 v[80:83], v[24:27], a[32:35], v[80:83]
 s_add_u32 s82, s65, 0
 buffer_load_dwordx4 v[16:19], v2, s[48:51], s82 offen offset:0 sc1
 v_mfma_f32_16x16x32_bf16 v[84:87], v[24:27], a[36:39], v[84:87]
 v_mfma_f32_16x16x32_bf16 v[92:95], v[28:31], a[36:39], v[92:95]
 buffer_load_dwordx4 v[20:23], v2, s[48:51], s82 offen offset:128 sc1
 v_mfma_f32_16x16x32_bf16 v[88:91], v[28:31], a[32:35], v[88:91]
 v_mfma_f32_16x16x32_bf16 v[96:99], v[24:27], a[40:43], v[96:99]
 v_mfma_f32_16x16x32_bf16 v[100:103], v[24:27], a[44:47], v[100:103]
 v_mfma_f32_16x16x32_bf16 v[108:111], v[28:31], a[44:47], v[108:111]
 v_mfma_f32_16x16x32_bf16 v[104:107], v[28:31], a[40:43], v[104:107]
 v_mfma_f32_16x16x32_bf16 v[112:115], v[24:27], a[48:51], v[112:115]
 v_mfma_f32_16x16x32_bf16 v[116:119], v[24:27], a[52:55], v[116:119]
 v_mfma_f32_16x16x32_bf16 v[124:127], v[28:31], a[52:55], v[124:127]
 v_mfma_f32_16x16x32_bf16 v[120:123], v[28:31], a[48:51], v[120:123]
 v_mfma_f32_16x16x32_bf16 v[128:131], v[24:27], a[56:59], v[128:131]
 v_mfma_f32_16x16x32_bf16 v[132:135], v[24:27], a[60:63], v[132:135]
 v_mfma_f32_16x16x32_bf16 v[140:143], v[28:31], a[60:63], v[140:143]
 v_mfma_f32_16x16x32_bf16 v[136:139], v[28:31], a[56:59], v[136:139]
 v_mfma_f32_16x16x32_bf16 v[80:83], v[32:35], a[64:67], v[80:83]
 buffer_load_dwordx4 v[24:27], v2, s[48:51], s82 offen offset:2048 sc1
 v_mfma_f32_16x16x32_bf16 v[84:87], v[32:35], a[68:71], v[84:87]
 v_mfma_f32_16x16x32_bf16 v[92:95], v[36:39], a[68:71], v[92:95]
 buffer_load_dwordx4 v[28:31], v2, s[48:51], s82 offen offset:2176 sc1
 v_mfma_f32_16x16x32_bf16 v[88:91], v[36:39], a[64:67], v[88:91]
 v_mfma_f32_16x16x32_bf16 v[96:99], v[32:35], a[72:75], v[96:99]
 v_mfma_f32_16x16x32_bf16 v[100:103], v[32:35], a[76:79], v[100:103]
 v_mfma_f32_16x16x32_bf16 v[108:111], v[36:39], a[76:79], v[108:111]
 v_mfma_f32_16x16x32_bf16 v[104:107], v[36:39], a[72:75], v[104:107]
 v_mfma_f32_16x16x32_bf16 v[112:115], v[32:35], a[80:83], v[112:115]
 v_mfma_f32_16x16x32_bf16 v[116:119], v[32:35], a[84:87], v[116:119]
 v_mfma_f32_16x16x32_bf16 v[124:127], v[36:39], a[84:87], v[124:127]
 v_mfma_f32_16x16x32_bf16 v[120:123], v[36:39], a[80:83], v[120:123]
 v_mfma_f32_16x16x32_bf16 v[128:131], v[32:35], a[88:91], v[128:131]
 v_mfma_f32_16x16x32_bf16 v[132:135], v[32:35], a[92:95], v[132:135]
 v_mfma_f32_16x16x32_bf16 v[140:143], v[36:39], a[92:95], v[140:143]
 v_mfma_f32_16x16x32_bf16 v[136:139], v[36:39], a[88:91], v[136:139]
 v_mfma_f32_16x16x32_bf16 v[80:83], v[40:43], a[96:99], v[80:83]
 s_add_u32 s82, s65, 4096
 buffer_load_dwordx4 v[32:35], v2, s[48:51], s82 offen offset:0 sc1
 v_mfma_f32_16x16x32_bf16 v[84:87], v[40:43], a[100:103], v[84:87]
 v_mfma_f32_16x16x32_bf16 v[92:95], v[44:47], a[100:103], v[92:95]
 buffer_load_dwordx4 v[36:39], v2, s[48:51], s82 offen offset:128 sc1
 v_mfma_f32_16x16x32_bf16 v[88:91], v[44:47], a[96:99], v[88:91]
 v_mfma_f32_16x16x32_bf16 v[96:99], v[40:43], a[104:107], v[96:99]
 v_mfma_f32_16x16x32_bf16 v[100:103], v[40:43], a[108:111], v[100:103]
 v_mfma_f32_16x16x32_bf16 v[108:111], v[44:47], a[108:111], v[108:111]
 v_mfma_f32_16x16x32_bf16 v[104:107], v[44:47], a[104:107], v[104:107]
 v_mfma_f32_16x16x32_bf16 v[112:115], v[40:43], a[112:115], v[112:115]
 v_mfma_f32_16x16x32_bf16 v[116:119], v[40:43], a[116:119], v[116:119]
 v_mfma_f32_16x16x32_bf16 v[124:127], v[44:47], a[116:119], v[124:127]
 v_mfma_f32_16x16x32_bf16 v[120:123], v[44:47], a[112:115], v[120:123]
 v_mfma_f32_16x16x32_bf16 v[128:131], v[40:43], a[120:123], v[128:131]
 v_mfma_f32_16x16x32_bf16 v[132:135], v[40:43], a[124:127], v[132:135]
 v_mfma_f32_16x16x32_bf16 v[140:143], v[44:47], a[124:127], v[140:143]
 v_mfma_f32_16x16x32_bf16 v[136:139], v[44:47], a[120:123], v[136:139]
 v_mfma_f32_16x16x32_bf16 v[80:83], v[48:51], a[128:131], v[80:83]
 buffer_load_dwordx4 v[40:43], v2, s[48:51], s82 offen offset:2048 sc1
 v_mfma_f32_16x16x32_bf16 v[84:87], v[48:51], a[132:135], v[84:87]
 v_mfma_f32_16x16x32_bf16 v[92:95], v[52:55], a[132:135], v[92:95]
 buffer_load_dwordx4 v[44:47], v2, s[48:51], s82 offen offset:2176 sc1
 v_mfma_f32_16x16x32_bf16 v[88:91], v[52:55], a[128:131], v[88:91]
 v_mfma_f32_16x16x32_bf16 v[96:99], v[48:51], a[136:139], v[96:99]
 v_mfma_f32_16x16x32_bf16 v[100:103], v[48:51], a[140:143], v[100:103]
 v_mfma_f32_16x16x32_bf16 v[108:111], v[52:55], a[140:143], v[108:111]
 v_mfma_f32_16x16x32_bf16 v[104:107], v[52:55], a[136:139], v[104:107]
 v_mfma_f32_16x16x32_bf16 v[112:115], v[48:51], a[144:147], v[112:115]
 v_mfma_f32_16x16x32_bf16 v[116:119], v[48:51], a[148:151], v[116:119]
 v_mfma_f32_16x16x32_bf16 v[124:127], v[52:55], a[148:151], v[124:127]
 v_mfma_f32_16x16x32_bf16 v[120:123], v[52:55], a[144:147], v[120:123]
 v_mfma_f32_16x16x32_bf16 v[128:131], v[48:51], a[152:155], v[128:131]
 v_mfma_f32_16x16x32_bf16 v[132:135], v[48:51], a[156:159], v[132:135]
 v_mfma_f32_16x16x32_bf16 v[140:143], v[52:55], a[156:159], v[140:143]
 v_mfma_f32_16x16x32_bf16 v[136:139], v[52:55], a[152:155], v[136:139]
 v_mfma_f32_16x16x32_bf16 v[80:83], v[56:59], a[160:163], v[80:83]
 s_add_u32 s82, s65, 8192
 buffer_load_dwordx4 v[48:51], v2, s[48:51], s82 offen offset:0 sc1
 v_mfma_f32_16x16x32_bf16 v[84:87], v[56:59], a[164:167], v[84:87]
 v_mfma_f32_16x16x32_bf16 v[92:95], v[60:63], a[164:167], v[92:95]
 buffer_load_dwordx4 v[52:55], v2, s[48:51], s82 offen offset:128 sc1
 v_mfma_f32_16x16x32_bf16 v[88:91], v[60:63], a[160:163], v[88:91]
 v_mfma_f32_16x16x32_bf16 v[96:99], v[56:59], a[168:171], v[96:99]
 v_mfma_f32_16x16x32_bf16 v[100:103], v[56:59], a[172:175], v[100:103]
 v_mfma_f32_16x16x32_bf16 v[108:111], v[60:63], a[172:175], v[108:111]
 v_mfma_f32_16x16x32_bf16 v[104:107], v[60:63], a[168:171], v[104:107]
 v_mfma_f32_16x16x32_bf16 v[112:115], v[56:59], a[176:179], v[112:115]
 v_mfma_f32_16x16x32_bf16 v[116:119], v[56:59], a[180:183], v[116:119]
 v_mfma_f32_16x16x32_bf16 v[124:127], v[60:63], a[180:183], v[124:127]
 v_mfma_f32_16x16x32_bf16 v[120:123], v[60:63], a[176:179], v[120:123]
 v_mfma_f32_16x16x32_bf16 v[128:131], v[56:59], a[184:187], v[128:131]
 v_mfma_f32_16x16x32_bf16 v[132:135], v[56:59], a[188:191], v[132:135]
 v_mfma_f32_16x16x32_bf16 v[140:143], v[60:63], a[188:191], v[140:143]
 v_mfma_f32_16x16x32_bf16 v[136:139], v[60:63], a[184:187], v[136:139]
 v_mfma_f32_16x16x32_bf16 v[80:83], v[64:67], a[192:195], v[80:83]
 buffer_load_dwordx4 v[56:59], v2, s[48:51], s82 offen offset:2048 sc1
 v_mfma_f32_16x16x32_bf16 v[84:87], v[64:67], a[196:199], v[84:87]
 v_mfma_f32_16x16x32_bf16 v[92:95], v[68:71], a[196:199], v[92:95]
 buffer_load_dwordx4 v[60:63], v2, s[48:51], s82 offen offset:2176 sc1
 v_mfma_f32_16x16x32_bf16 v[88:91], v[68:71], a[192:195], v[88:91]
 v_mfma_f32_16x16x32_bf16 v[96:99], v[64:67], a[200:203], v[96:99]
 v_mfma_f32_16x16x32_bf16 v[100:103], v[64:67], a[204:207], v[100:103]
 v_mfma_f32_16x16x32_bf16 v[108:111], v[68:71], a[204:207], v[108:111]
 v_mfma_f32_16x16x32_bf16 v[104:107], v[68:71], a[200:203], v[104:107]
 v_mfma_f32_16x16x32_bf16 v[112:115], v[64:67], a[208:211], v[112:115]
 v_mfma_f32_16x16x32_bf16 v[116:119], v[64:67], a[212:215], v[116:119]
 v_mfma_f32_16x16x32_bf16 v[124:127], v[68:71], a[212:215], v[124:127]
 v_mfma_f32_16x16x32_bf16 v[120:123], v[68:71], a[208:211], v[120:123]
 v_mfma_f32_16x16x32_bf16 v[128:131], v[64:67], a[216:219], v[128:131]
 v_mfma_f32_16x16x32_bf16 v[132:135], v[64:67], a[220:223], v[132:135]
 v_mfma_f32_16x16x32_bf16 v[140:143], v[68:71], a[220:223], v[140:143]
 v_mfma_f32_16x16x32_bf16 v[136:139], v[68:71], a[216:219], v[136:139]
 s_waitcnt vmcnt(12)
 v_mfma_f32_16x16x32_bf16 v[80:83], v[72:75], a[224:227], v[80:83]
 s_add_u32 s82, s65, 12288
 buffer_load_dwordx4 v[64:67], v2, s[48:51], s82 offen offset:0 sc1
 v_mfma_f32_16x16x32_bf16 v[84:87], v[72:75], a[228:231], v[84:87]
 v_mfma_f32_16x16x32_bf16 v[92:95], v[76:79], a[228:231], v[92:95]
 buffer_load_dwordx4 v[68:71], v2, s[48:51], s82 offen offset:128 sc1
 v_mfma_f32_16x16x32_bf16 v[88:91], v[76:79], a[224:227], v[88:91]
 s_add_u32 s70, s65, 131072
 v_mfma_f32_16x16x32_bf16 v[96:99], v[72:75], a[232:235], v[96:99]
 buffer_load_dwordx4 v[12:15], v11, s[48:51], s70 offen offset:0 sc1
 v_mfma_f32_16x16x32_bf16 v[100:103], v[72:75], a[236:239], v[100:103]
 s_add_u32 s65, s65, 0x10000
 s_add_u32 s63, s63, 1
 v_mfma_f32_16x16x32_bf16 v[108:111], v[76:79], a[236:239], v[108:111]
 v_mfma_f32_16x16x32_bf16 v[104:107], v[76:79], a[232:235], v[104:107]
 v_mfma_f32_16x16x32_bf16 v[112:115], v[72:75], a[240:243], v[112:115]
 v_mfma_f32_16x16x32_bf16 v[116:119], v[72:75], a[244:247], v[116:119]
 v_mfma_f32_16x16x32_bf16 v[124:127], v[76:79], a[244:247], v[124:127]
 v_mfma_f32_16x16x32_bf16 v[120:123], v[76:79], a[240:243], v[120:123]
 v_mfma_f32_16x16x32_bf16 v[128:131], v[72:75], a[248:251], v[128:131]
 v_mfma_f32_16x16x32_bf16 v[132:135], v[72:75], a[252:255], v[132:135]
 v_mfma_f32_16x16x32_bf16 v[140:143], v[76:79], a[252:255], v[140:143]
 v_mfma_f32_16x16x32_bf16 v[136:139], v[76:79], a[248:251], v[136:139]
 s_waitcnt vmcnt(0)
Lw_Vloop:
 s_cmp_eq_u32 s63, 27
 s_cbranch_scc1 Lw_Vxf
Lw_Vxfok:
 s_waitcnt vmcnt(17)
 v_mfma_f32_16x16x32_bf16 v[144:147], v[16:19], a[0:3], 0
 buffer_load_dwordx4 v[72:75], v2, s[48:51], s82 offen offset:2048 sc1
 v_mfma_f32_16x16x32_bf16 v[148:151], v[16:19], a[4:7], 0
 ds_write_b128 v7, v[96:99] offset:0
 v_mfma_f32_16x16x32_bf16 v[156:159], v[20:23], a[4:7], 0
 buffer_load_dwordx4 v[76:79], v2, s[48:51], s82 offen offset:2176 sc1
 v_mfma_f32_16x16x32_bf16 v[152:155], v[20:23], a[0:3], 0
 v_mfma_f32_16x16x32_bf16 v[160:163], v[16:19], a[8:11], 0
 ds_write_b128 v7, v[100:103] offset:1024
 v_mfma_f32_16x16x32_bf16 v[164:167], v[16:19], a[12:15], 0
 v_mfma_f32_16x16x32_bf16 v[172:175], v[20:23], a[12:15], 0
 v_mfma_f32_16x16x32_bf16 v[168:171], v[20:23], a[8:11], 0
 ds_write_b128 v7, v[104:107] offset:2048
 v_mfma_f32_16x16x32_bf16 v[176:179], v[16:19], a[16:19], 0
 v_mfma_f32_16x16x32_bf16 v[180:183], v[16:19], a[20:23], 0
 v_mfma_f32_16x16x32_bf16 v[188:191], v[20:23], a[20:23], 0
 ds_write_b128 v7, v[108:111] offset:3072
 v_mfma_f32_16x16x32_bf16 v[184:187], v[20:23], a[16:19], 0
 v_mfma_f32_16x16x32_bf16 v[192:195], v[16:19], a[24:27], 0
 v_mfma_f32_16x16x32_bf16 v[196:199], v[16:19], a[28:31], 0
 ds_write_b128 v8, v[112:115] offset:0
 v_mfma_f32_16x16x32_bf16 v[204:207], v[20:23], a[28:31], 0
 v_mfma_f32_16x16x32_bf16 v[200:203], v[20:23], a[24:27], 0
 s_waitcnt vmcnt(17)
 v_mfma_f32_16x16x32_bf16 v[144:147], v[24:27], a[32:35], v[144:147]
 s_add_u32 s82, s65, 0
 buffer_load_dwordx4 v[16:19], v2, s[48:51], s82 offen offset:0 sc1
 v_mfma_f32_16x16x32_bf16 v[148:151], v[24:27], a[36:39], v[148:151]
 ds_write_b128 v8, v[116:119] offset:1024
 v_mfma_f32_16x16x32_bf16 v[156:159], v[28:31], a[36:39], v[156:159]
 buffer_load_dwordx4 v[20:23], v2, s[48:51], s82 offen offset:128 sc1
 v_mfma_f32_16x16x32_bf16 v[152:155], v[28:31], a[32:35], v[152:155]
 v_mfma_f32_16x16x32_bf16 v[160:163], v[24:27], a[40:43], v[160:163]
 ds_write_b128 v8, v[120:123] offset:2048
 v_mfma_f32_16x16x32_bf16 v[164:167], v[24:27], a[44:47], v[164:167]
 v_mfma_f32_16x16x32_bf16 v[172:175], v[28:31], a[44:47], v[172:175]
 v_mfma_f32_16x16x32_bf16 v[168:171], v[28:31], a[40:43], v[168:171]
 ds_write_b128 v8, v[124:127] offset:3072
 v_mfma_f32_16x16x32_bf16 v[176:179], v[24:27], a[48:51], v[176:179]
 v_mfma_f32_16x16x32_bf16 v[180:183], v[24:27], a[52:55], v[180:183]
 v_mfma_f32_16x16x32_bf16 v[188:191], v[28:31], a[52:55], v[188:191]
 ds_write_b128 v9, v[128:131] offset:0
 v_mfma_f32_16x16x32_bf16 v[184:187], v[28:31], a[48:51], v[184:187]
 v_mfma_f32_16x16x32_bf16 v[192:195], v[24:27], a[56:59], v[192:195]
 v_mfma_f32_16x16x32_bf16 v[196:199], v[24:27], a[60:63], v[196:199]
 ds_write_b128 v9, v[132:135] offset:1024
 v_mfma_f32_16x16x32_bf16 v[204:207], v[28:31], a[60:63], v[204:207]
 s_waitcnt vmcnt(9)
 s_sub_u32 s71, s63, 1
 v_mfma_f32_16x16x32_bf16 v[200:203], v[28:31], a[56:59], v[200:203]
 s_max_u32 s71, s71, 2
 v_mfma_f32_16x16x32_bf16 v[144:147], v[32:35], a[64:67], v[144:147]
 buffer_load_dwordx4 v[24:27], v2, s[48:51], s82 offen offset:2048 sc1
 v_mfma_f32_16x16x32_bf16 v[148:151], v[32:35], a[68:71], v[148:151]
 ds_write_b128 v9, v[136:139] offset:2048
 v_mfma_f32_16x16x32_bf16 v[156:159], v[36:39], a[68:71], v[156:159]
 buffer_load_dwordx4 v[28:31], v2, s[48:51], s82 offen offset:2176 sc1
 v_mfma_f32_16x16x32_bf16 v[152:155], v[36:39], a[64:67], v[152:155]
 v_mov_b32 v3, s71
 v_mfma_f32_16x16x32_bf16 v[160:163], v[32:35], a[72:75], v[160:163]
 ds_write_b128 v9, v[140:143] offset:3072
 v_mfma_f32_16x16x32_bf16 v[164:167], v[32:35], a[76:79], v[164:167]
 buffer_store_dword v3, v251, s[48:51], s68 offen sc1
 v_mfma_f32_16x16x32_bf16 v[172:175], v[36:39], a[76:79], v[172:175]
 v_mfma_f32_16x16x32_bf16 v[168:171], v[36:39], a[72:75], v[168:171]
 s_waitcnt lgkmcnt(0)
 s_barrier
 v_mfma_f32_16x16x32_bf16 v[176:179], v[32:35], a[80:83], v[176:179]
 ds_read_b128 v[96:99], v10 offset:0
 v_mfma_f32_16x16x32_bf16 v[180:183], v[32:35], a[84:87], v[180:183]
 ds_read_b128 v[100:103], v10 offset:1024
 v_mfma_f32_16x16x32_bf16 v[188:191], v[36:39], a[84:87], v[188:191]
 ds_read_b128 v[104:107], v10 offset:2048
 v_mfma_f32_16x16x32_bf16 v[184:187], v[36:39], a[80:83], v[184:187]
 ds_read_b128 v[108:111], v10 offset:3072
 v_mfma_f32_16x16x32_bf16 v[192:195], v[32:35], a[88:91], v[192:195]
 ds_read_b128 v[112:115], v10 offset:4096
 v_mfma_f32_16x16x32_bf16 v[196:199], v[32:35], a[92:95], v[196:199]
 ds_read_b128 v[116:119], v10 offset:5120
 v_mfma_f32_16x16x32_bf16 v[204:207], v[36:39], a[92:95], v[204:207]
 ds_read_b128 v[120:123], v10 offset:6144
 v_mfma_f32_16x16x32_bf16 v[200:203], v[36:39], a[88:91], v[200:203]
 ds_read_b128 v[124:127], v10 offset:7168
 v_mfma_f32_16x16x32_bf16 v[144:147], v[40:43], a[96:99], v[144:147]
 s_add_u32 s82, s65, 4096
 buffer_load_dwordx4 v[32:35], v2, s[48:51], s82 offen offset:0 sc1
 v_mfma_f32_16x16x32_bf16 v[148:151], v[40:43], a[100:103], v[148:151]
 ds_read_b128 v[128:131], v10 offset:8192
 v_mfma_f32_16x16x32_bf16 v[156:159], v[44:47], a[100:103], v[156:159]
 buffer_load_dwordx4 v[36:39], v2, s[48:51], s82 offen offset:128 sc1
 v_mfma_f32_16x16x32_bf16 v[152:155], v[44:47], a[96:99], v[152:155]
 ds_read_b128 v[132:135], v10 offset:9216
 v_mfma_f32_16x16x32_bf16 v[160:163], v[40:43], a[104:107], v[160:163]
 ds_read_b128 v[136:139], v10 offset:10240
 v_mfma_f32_16x16x32_bf16 v[164:167], v[40:43], a[108:111], v[164:167]
 ds_read_b128 v[140:143], v10 offset:11264
 v_mfma_f32_16x16x32_bf16 v[172:175], v[44:47], a[108:111], v[172:175]
 s_waitcnt lgkmcnt(8)
 v_add_f32 v80, v80, v96
 v_mfma_f32_16x16x32_bf16 v[168:171], v[44:47], a[104:107], v[168:171]
 v_add_f32 v81, v81, v97
 v_add_f32 v82, v82, v98
 v_mfma_f32_16x16x32_bf16 v[176:179], v[40:43], a[112:115], v[176:179]
 v_add_f32 v83, v83, v99
 v_add_f32 v84, v84, v100
 v_mfma_f32_16x16x32_bf16 v[180:183], v[40:43], a[116:119], v[180:183]
 v_add_f32 v85, v85, v101
 v_add_f32 v86, v86, v102
 v_mfma_f32_16x16x32_bf16 v[188:191], v[44:47], a[116:119], v[188:191]
 v_add_f32 v87, v87, v103
 v_add_f32 v88, v88, v104
 v_mfma_f32_16x16x32_bf16 v[184:187], v[44:47], a[112:115], v[184:187]
 v_add_f32 v89, v89, v105
 v_add_f32 v90, v90, v106
 v_mfma_f32_16x16x32_bf16 v[192:195], v[40:43], a[120:123], v[192:195]
 v_add_f32 v91, v91, v107
 v_add_f32 v92, v92, v108
 v_mfma_f32_16x16x32_bf16 v[196:199], v[40:43], a[124:127], v[196:199]
 v_add_f32 v93, v93, v109
 v_add_f32 v94, v94, v110
 v_mfma_f32_16x16x32_bf16 v[204:207], v[44:47], a[124:127], v[204:207]
 v_add_f32 v95, v95, v111
 s_waitcnt lgkmcnt(4)
 v_mfma_f32_16x16x32_bf16 v[200:203], v[44:47], a[120:123], v[200:203]
 v_add_f32 v80, v80, v112
 v_mfma_f32_16x16x32_bf16 v[144:147], v[48:51], a[128:131], v[144:147]
 buffer_load_dwordx4 v[40:43], v2, s[48:51], s82 offen offset:2048 sc1
 v_mfma_f32_16x16x32_bf16 v[148:151], v[48:51], a[132:135], v[148:151]
 v_add_f32 v81, v81, v113
 v_add_f32 v82, v82, v114
 v_mfma_f32_16x16x32_bf16 v[156:159], v[52:55], a[132:135], v[156:159]
 buffer_load_dwordx4 v[44:47], v2, s[48:51], s82 offen offset:2176 sc1
 v_mfma_f32_16x16x32_bf16 v[152:155], v[52:55], a[128:131], v[152:155]
 v_add_f32 v83, v83, v115
 v_add_f32 v84, v84, v116
 v_mfma_f32_16x16x32_bf16 v[160:163], v[48:51], a[136:139], v[160:163]
 v_add_f32 v85, v85, v117
 v_add_f32 v86, v86, v118
 v_mfma_f32_16x16x32_bf16 v[164:167], v[48:51], a[140:143], v[164:167]
 v_add_f32 v87, v87, v119
 v_add_f32 v88, v88, v120
 v_mfma_f32_16x16x32_bf16 v[172:175], v[52:55], a[140:143], v[172:175]
 v_add_f32 v89, v89, v121
 v_add_f32 v90, v90, v122
 v_mfma_f32_16x16x32_bf16 v[168:171], v[52:55], a[136:139], v[168:171]
 v_add_f32 v91, v91, v123
 v_add_f32 v92, v92, v124
 v_mfma_f32_16x16x32_bf16 v[176:179], v[48:51], a[144:147], v[176:179]
 v_add_f32 v93, v93, v125
 v_add_f32 v94, v94, v126
 v_mfma_f32_16x16x32_bf16 v[180:183], v[48:51], a[148:151], v[180:183]
 v_add_f32 v95, v95, v127
 s_waitcnt lgkmcnt(0)
 v_mfma_f32_16x16x32_bf16 v[188:191], v[52:55], a[148:151], v[188:191]
 v_add_f32 v80, v80, v128
 v_add_f32 v81, v81, v129
 v_mfma_f32_16x16x32_bf16 v[184:187], v[52:55], a[144:147], v[184:187]
 v_add_f32 v82, v82, v130
 v_add_f32 v83, v83, v131
 v_mfma_f32_16x16x32_bf16 v[192:195], v[48:51], a[152:155], v[192:195]
 v_add_f32 v84, v84, v132
 v_add_f32 v85, v85, v133
 v_mfma_f32_16x16x32_bf16 v[196:199], v[48:51], a[156:159], v[196:199]
 v_add_f32 v86, v86, v134
 v_add_f32 v87, v87, v135
 v_mfma_f32_16x16x32_bf16 v[204:207], v[52:55], a[156:159], v[204:207]
 v_add_f32 v88, v88, v136
 v_add_f32 v89, v89, v137
 v_mfma_f32_16x16x32_bf16 v[200:203], v[52:55], a[152:155], v[200:203]
 v_add_f32 v90, v90, v138
 s_waitcnt vmcnt(14)
 v_mfma_f32_16x16x32_bf16 v[144:147], v[56:59], a[160:163], v[144:147]
 s_add_u32 s82, s65, 8192
 buffer_load_dwordx4 v[48:51], v2, s[48:51], s82 offen offset:0 sc1
 v_mfma_f32_16x16x32_bf16 v[148:151], v[56:59], a[164:167], v[148:151]
 v_add_f32 v91, v91, v139
 v_add_f32 v92, v92, v140
 v_mfma_f32_16x16x32_bf16 v[156:159], v[60:63], a[164:167], v[156:159]
 buffer_load_dwordx4 v[52:55], v2, s[48:51], s82 offen offset:128 sc1
 v_mfma_f32_16x16x32_bf16 v[152:155], v[60:63], a[160:163], v[152:155]
 v_add_f32 v93, v93, v141
 v_add_f32 v94, v94, v142
 v_mfma_f32_16x16x32_bf16 v[160:163], v[56:59], a[168:171], v[160:163]
 v_add_f32 v95, v95, v143
 v_cvt_pk_bf16_f32 v224, v80, v81
 v_mfma_f32_16x16x32_bf16 v[164:167], v[56:59], a[172:175], v[164:167]
 v_cvt_pk_bf16_f32 v225, v82, v83
 v_cvt_pk_bf16_f32 v226, v88, v89
 v_mfma_f32_16x16x32_bf16 v[172:175], v[60:63], a[172:175], v[172:175]
 v_cvt_pk_bf16_f32 v227, v90, v91
 v_mfma_f32_16x16x32_bf16 v[168:171], v[60:63], a[168:171], v[168:171]
 buffer_store_dwordx4 v[224:227], v6, s[48:51], s67 offen offset:0 sc1
 v_mfma_f32_16x16x32_bf16 v[176:179], v[56:59], a[176:179], v[176:179]
 v_cvt_pk_bf16_f32 v228, v84, v85
 v_cvt_pk_bf16_f32 v229, v86, v87
 v_mfma_f32_16x16x32_bf16 v[180:183], v[56:59], a[180:183], v[180:183]
 v_cvt_pk_bf16_f32 v230, v92, v93
 v_cvt_pk_bf16_f32 v231, v94, v95
 v_mfma_f32_16x16x32_bf16 v[188:191], v[60:63], a[180:183], v[188:191]
 buffer_store_dwordx4 v[228:231], v6, s[48:51], s67 offen offset:256 sc1
 v_mfma_f32_16x16x32_bf16 v[184:187], v[60:63], a[176:179], v[184:187]
 s_add_u32 s74, s74, 0x40000
 s_and_b32 s69, s74, 0x200000
 v_mfma_f32_16x16x32_bf16 v[192:195], v[56:59], a[184:187], v[192:195]
 s_lshr_b32 s69, s69, 8
 s_xor_b32 s69, s69, s74
 v_mfma_f32_16x16x32_bf16 v[196:199], v[56:59], a[188:191], v[196:199]
 buffer_store_dwordx4 v[232:235], v1, s[48:51], s69 offen sc1
 v_mfma_f32_16x16x32_bf16 v[204:207], v[60:63], a[188:191], v[204:207]
 s_add_u32 s67, s67, 0x40000
 v_mfma_f32_16x16x32_bf16 v[200:203], v[60:63], a[184:187], v[200:203]
 s_waitcnt vmcnt(17)
 v_mfma_f32_16x16x32_bf16 v[144:147], v[64:67], a[192:195], v[144:147]
 buffer_load_dwordx4 v[56:59], v2, s[48:51], s82 offen offset:2048 sc1
 v_mfma_f32_16x16x32_bf16 v[148:151], v[64:67], a[196:199], v[148:151]
 v_mfma_f32_16x16x32_bf16 v[156:159], v[68:71], a[196:199], v[156:159]
 buffer_load_dwordx4 v[60:63], v2, s[48:51], s82 offen offset:2176 sc1
 v_mfma_f32_16x16x32_bf16 v[152:155], v[68:71], a[192:195], v[152:155]
 v_mfma_f32_16x16x32_bf16 v[160:163], v[64:67], a[200:203], v[160:163]
 v_mfma_f32_16x16x32_bf16 v[164:167], v[64:67], a[204:207], v[164:167]
 v_mfma_f32_16x16x32_bf16 v[172:175], v[68:71], a[204:207], v[172:175]
 v_mfma_f32_16x16x32_bf16 v[168:171], v[68:71], a[200:203], v[168:171]
 v_mfma_f32_16x16x32_bf16 v[176:179], v[64:67], a[208:211], v[176:179]
 v_mfma_f32_16x16x32_bf16 v[180:183], v[64:67], a[212:215], v[180:183]
 v_mfma_f32_16x16x32_bf16 v[188:191], v[68:71], a[212:215], v[188:191]
 v_mfma_f32_16x16x32_bf16 v[184:187], v[68:71], a[208:211], v[184:187]
 v_mfma_f32_16x16x32_bf16 v[192:195], v[64:67], a[216:219], v[192:195]
 v_mfma_f32_16x16x32_bf16 v[196:199], v[64:67], a[220:223], v[196:199]
 v_mfma_f32_16x16x32_bf16 v[204:207], v[68:71], a[220:223], v[204:207]
 v_mfma_f32_16x16x32_bf16 v[200:203], v[68:71], a[216:219], v[200:203]
 s_waitcnt vmcnt(16)
 v_mfma_f32_16x16x32_bf16 v[144:147], v[72:75], a[224:227], v[144:147]
 s_add_u32 s82, s65, 12288
 buffer_load_dwordx4 v[64:67], v2, s[48:51], s82 offen offset:0 sc1
 v_mfma_f32_16x16x32_bf16 v[148:151], v[72:75], a[228:231], v[148:151]
 v_mfma_f32_16x16x32_bf16 v[156:159], v[76:79], a[228:231], v[156:159]
 buffer_load_dwordx4 v[68:71], v2, s[48:51], s82 offen offset:128 sc1
 v_mfma_f32_16x16x32_bf16 v[152:155], v[76:79], a[224:227], v[152:155]
 s_add_u32 s70, s65, 131072
 v_mfma_f32_16x16x32_bf16 v[160:163], v[72:75], a[232:235], v[160:163]
 buffer_load_dwordx4 v[12:15], v11, s[48:51], s70 offen offset:0 sc1
 v_mfma_f32_16x16x32_bf16 v[164:167], v[72:75], a[236:239], v[164:167]
 s_add_u32 s65, s65, 0x10000
 s_add_u32 s63, s63, 1
 v_mfma_f32_16x16x32_bf16 v[172:175], v[76:79], a[236:239], v[172:175]
 v_mfma_f32_16x16x32_bf16 v[168:171], v[76:79], a[232:235], v[168:171]
 v_mfma_f32_16x16x32_bf16 v[176:179], v[72:75], a[240:243], v[176:179]
 v_mfma_f32_16x16x32_bf16 v[180:183], v[72:75], a[244:247], v[180:183]
 v_mfma_f32_16x16x32_bf16 v[188:191], v[76:79], a[244:247], v[188:191]
 v_mfma_f32_16x16x32_bf16 v[184:187], v[76:79], a[240:243], v[184:187]
 v_mfma_f32_16x16x32_bf16 v[192:195], v[72:75], a[248:251], v[192:195]
 v_mfma_f32_16x16x32_bf16 v[196:199], v[72:75], a[252:255], v[196:199]
 v_mfma_f32_16x16x32_bf16 v[204:207], v[76:79], a[252:255], v[204:207]
 v_mfma_f32_16x16x32_bf16 v[200:203], v[76:79], a[248:251], v[200:203]
 s_cmp_eq_u32 s63, 64
 s_cbranch_scc1 Lw_Vend
 s_waitcnt vmcnt(17)
 v_mfma_f32_16x16x32_bf16 v[80:83], v[16:19], a[0:3], 0
 buffer_load_dwordx4 v[72:75], v2, s[48:51], s82 offen offset:2048 sc1
 v_mfma_f32_16x16x32_bf16 v[84:87], v[16:19], a[4:7], 0
 ds_write_b128 v7, v[160:163] offset:49152
 v_mfma_f32_16x16x32_bf16 v[92:95], v[20:23], a[4:7], 0
 buffer_load_dwordx4 v[76:79], v2, s[48:51], s82 offen offset:2176 sc1
 v_mfma_f32_16x16x32_bf16 v[88:91], v[20:23], a[0:3], 0
 v_mfma_f32_16x16x32_bf16 v[96:99], v[16:19], a[8:11], 0
 ds_write_b128 v7, v[164:167] offset:50176
 v_mfma_f32_16x16x32_bf16 v[100:103], v[16:19], a[12:15], 0
 v_mfma_f32_16x16x32_bf16 v[108:111], v[20:23], a[12:15], 0
 v_mfma_f32_16x16x32_bf16 v[104:107], v[20:23], a[8:11], 0
 ds_write_b128 v7, v[168:171] offset:51200
 v_mfma_f32_16x16x32_bf16 v[112:115], v[16:19], a[16:19], 0
 v_mfma_f32_16x16x32_bf16 v[116:119], v[16:19], a[20:23], 0
 v_mfma_f32_16x16x32_bf16 v[124:127], v[20:23], a[20:23], 0
 ds_write_b128 v7, v[172:175] offset:52224
 v_mfma_f32_16x16x32_bf16 v[120:123], v[20:23], a[16:19], 0
 v_mfma_f32_16x16x32_bf16 v[128:131], v[16:19], a[24:27], 0
 v_mfma_f32_16x16x32_bf16 v[132:135], v[16:19], a[28:31], 0
 ds_write_b128 v8, v[176:179] offset:49152
 v_mfma_f32_16x16x32_bf16 v[140:143], v[20:23], a[28:31], 0
 v_mfma_f32_16x16x32_bf16 v[136:139], v[20:23], a[24:27], 0
 s_waitcnt vmcnt(17)
 v_mfma_f32_16x16x32_bf16 v[80:83], v[24:27], a[32:35], v[80:83]
 s_add_u32 s82, s65, 0
 buffer_load_dwordx4 v[16:19], v2, s[48:51], s82 offen offset:0 sc1
 v_mfma_f32_16x16x32_bf16 v[84:87], v[24:27], a[36:39], v[84:87]
 ds_write_b128 v8, v[180:183] offset:50176
 v_mfma_f32_16x16x32_bf16 v[92:95], v[28:31], a[36:39], v[92:95]
 buffer_load_dwordx4 v[20:23], v2, s[48:51], s82 offen offset:128 sc1
 v_mfma_f32_16x16x32_bf16 v[88:91], v[28:31], a[32:35], v[88:91]
 v_mfma_f32_16x16x32_bf16 v[96:99], v[24:27], a[40:43], v[96:99]
 ds_write_b128 v8, v[184:187] offset:51200
 v_mfma_f32_16x16x32_bf16 v[100:103], v[24:27], a[44:47], v[100:103]
 v_mfma_f32_16x16x32_bf16 v[108:111], v[28:31], a[44:47], v[108:111]
 v_mfma_f32_16x16x32_bf16 v[104:107], v[28:31], a[40:43], v[104:107]
 ds_write_b128 v8, v[188:191] offset:52224
 v_mfma_f32_16x16x32_bf16 v[112:115], v[24:27], a[48:51], v[112:115]
 v_mfma_f32_16x16x32_bf16 v[116:119], v[24:27], a[52:55], v[116:119]
 v_mfma_f32_16x16x32_bf16 v[124:127], v[28:31], a[52:55], v[124:127]
 ds_write_b128 v9, v[192:195] offset:49152
 v_mfma_f32_16x16x32_bf16 v[120:123], v[28:31], a[48:51], v[120:123]
 v_mfma_f32_16x16x32_bf16 v[128:131], v[24:27], a[56:59], v[128:131]
 v_mfma_f32_16x16x32_bf16 v[132:135], v[24:27], a[60:63], v[132:135]
 ds_write_b128 v9, v[196:199] offset:50176
 v_mfma_f32_16x16x32_bf16 v[140:143], v[28:31], a[60:63], v[140:143]
 s_waitcnt vmcnt(9)
 s_sub_u32 s71, s63, 1
 v_mfma_f32_16x16x32_bf16 v[136:139], v[28:31], a[56:59], v[136:139]
 s_max_u32 s71, s71, 2
 v_mfma_f32_16x16x32_bf16 v[80:83], v[32:35], a[64:67], v[80:83]
 buffer_load_dwordx4 v[24:27], v2, s[48:51], s82 offen offset:2048 sc1
 v_mfma_f32_16x16x32_bf16 v[84:87], v[32:35], a[68:71], v[84:87]
 ds_write_b128 v9, v[200:203] offset:51200
 v_mfma_f32_16x16x32_bf16 v[92:95], v[36:39], a[68:71], v[92:95]
 buffer_load_dwordx4 v[28:31], v2, s[48:51], s82 offen offset:2176 sc1
 v_mfma_f32_16x16x32_bf16 v[88:91], v[36:39], a[64:67], v[88:91]
 v_mov_b32 v3, s71
 v_mfma_f32_16x16x32_bf16 v[96:99], v[32:35], a[72:75], v[96:99]
 ds_write_b128 v9, v[204:207] offset:52224
 v_mfma_f32_16x16x32_bf16 v[100:103], v[32:35], a[76:79], v[100:103]
 buffer_store_dword v3, v251, s[48:51], s68 offen sc1
 v_mfma_f32_16x16x32_bf16 v[108:111], v[36:39], a[76:79], v[108:111]
 v_mfma_f32_16x16x32_bf16 v[104:107], v[36:39], a[72:75], v[104:107]
 s_waitcnt lgkmcnt(0)
 s_barrier
 v_mfma_f32_16x16x32_bf16 v[112:115], v[32:35], a[80:83], v[112:115]
 ds_read_b128 v[160:163], v10 offset:49152
 v_mfma_f32_16x16x32_bf16 v[116:119], v[32:35], a[84:87], v[116:119]
 ds_read_b128 v[164:167], v10 offset:50176
 v_mfma_f32_16x16x32_bf16 v[124:127], v[36:39], a[84:87], v[124:127]
 ds_read_b128 v[168:171], v10 offset:51200
 v_mfma_f32_16x16x32_bf16 v[120:123], v[36:39], a[80:83], v[120:123]
 ds_read_b128 v[172:175], v10 offset:52224
 v_mfma_f32_16x16x32_bf16 v[128:131], v[32:35], a[88:91], v[128:131]
 ds_read_b128 v[176:179], v10 offset:53248
 v_mfma_f32_16x16x32_bf16 v[132:135], v[32:35], a[92:95], v[132:135]
 ds_read_b128 v[180:183], v10 offset:54272
 v_mfma_f32_16x16x32_bf16 v[140:143], v[36:39], a[92:95], v[140:143]
 ds_read_b128 v[184:187], v10 offset:55296
 v_mfma_f32_16x16x32_bf16 v[136:139], v[36:39], a[88:91], v[136:139]
 ds_read_b128 v[188:191], v10 offset:56320
 v_mfma_f32_16x16x32_bf16 v[80:83], v[40:43], a[96:99], v[80:83]
 s_add_u32 s82, s65, 4096
 buffer_load_dwordx4 v[32:35], v2, s[48:51], s82 offen offset:0 sc1
 v_mfma_f32_16x16x32_bf16 v[84:87], v[40:43], a[100:103], v[84:87]
 ds_read_b128 v[192:195], v10 offset:57344
 v_mfma_f32_16x16x32_bf16 v[92:95], v[44:47], a[100:103], v[92:95]
 buffer_load_dwordx4 v[36:39], v2, s[48:51], s82 offen offset:128 sc1
 v_mfma_f32_16x16x32_bf16 v[88:91], v[44:47], a[96:99], v[88:91]
 ds_read_b128 v[196:199], v10 offset:58368
 v_mfma_f32_16x16x32_bf16 v[96:99], v[40:43], a[104:107], v[96:99]
 ds_read_b128 v[200:203], v10 offset:59392
 v_mfma_f32_16x16x32_bf16 v[100:103], v[40:43], a[108:111], v[100:103]
 ds_read_b128 v[204:207], v10 offset:60416
 v_mfma_f32_16x16x32_bf16 v[108:111], v[44:47], a[108:111], v[108:111]
 s_waitcnt lgkmcnt(8)
 v_add_f32 v144, v144, v160
 v_mfma_f32_16x16x32_bf16 v[104:107], v[44:47], a[104:107], v[104:107]
 v_add_f32 v145, v145, v161
 v_add_f32 v146, v146, v162
 v_mfma_f32_16x16x32_bf16 v[112:115], v[40:43], a[112:115], v[112:115]
 v_add_f32 v147, v147, v163
 v_add_f32 v148, v148, v164
 v_mfma_f32_16x16x32_bf16 v[116:119], v[40:43], a[116:119], v[116:119]
 v_add_f32 v149, v149, v165
 v_add_f32 v150, v150, v166
 v_mfma_f32_16x16x32_bf16 v[124:127], v[44:47], a[116:119], v[124:127]
 v_add_f32 v151, v151, v167
 v_add_f32 v152, v152, v168
 v_mfma_f32_16x16x32_bf16 v[120:123], v[44:47], a[112:115], v[120:123]
 v_add_f32 v153, v153, v169
 v_add_f32 v154, v154, v170
 v_mfma_f32_16x16x32_bf16 v[128:131], v[40:43], a[120:123], v[128:131]
 v_add_f32 v155, v155, v171
 v_add_f32 v156, v156, v172
 v_mfma_f32_16x16x32_bf16 v[132:135], v[40:43], a[124:127], v[132:135]
 v_add_f32 v157, v157, v173
 v_add_f32 v158, v158, v174
 v_mfma_f32_16x16x32_bf16 v[140:143], v[44:47], a[124:127], v[140:143]
 v_add_f32 v159, v159, v175
 s_waitcnt lgkmcnt(4)
 v_mfma_f32_16x16x32_bf16 v[136:139], v[44:47], a[120:123], v[136:139]
 v_add_f32 v144, v144, v176
 v_mfma_f32_16x16x32_bf16 v[80:83], v[48:51], a[128:131], v[80:83]
 buffer_load_dwordx4 v[40:43], v2, s[48:51], s82 offen offset:2048 sc1
 v_mfma_f32_16x16x32_bf16 v[84:87], v[48:51], a[132:135], v[84:87]
 v_add_f32 v145, v145, v177
 v_add_f32 v146, v146, v178
 v_mfma_f32_16x16x32_bf16 v[92:95], v[52:55], a[132:135], v[92:95]
 buffer_load_dwordx4 v[44:47], v2, s[48:51], s82 offen offset:2176 sc1
 v_mfma_f32_16x16x32_bf16 v[88:91], v[52:55], a[128:131], v[88:91]
 v_add_f32 v147, v147, v179
 v_add_f32 v148, v148, v180
 v_mfma_f32_16x16x32_bf16 v[96:99], v[48:51], a[136:139], v[96:99]
 v_add_f32 v149, v149, v181
 v_add_f32 v150, v150, v182
 v_mfma_f32_16x16x32_bf16 v[100:103], v[48:51], a[140:143], v[100:103]
 v_add_f32 v151, v151, v183
 v_add_f32 v152, v152, v184
 v_mfma_f32_16x16x32_bf16 v[108:111], v[52:55], a[140:143], v[108:111]
 v_add_f32 v153, v153, v185
 v_add_f32 v154, v154, v186
 v_mfma_f32_16x16x32_bf16 v[104:107], v[52:55], a[136:139], v[104:107]
 v_add_f32 v155, v155, v187
 v_add_f32 v156, v156, v188
 v_mfma_f32_16x16x32_bf16 v[112:115], v[48:51], a[144:147], v[112:115]
 v_add_f32 v157, v157, v189
 v_add_f32 v158, v158, v190
 v_mfma_f32_16x16x32_bf16 v[116:119], v[48:51], a[148:151], v[116:119]
 v_add_f32 v159, v159, v191
 s_waitcnt lgkmcnt(0)
 v_mfma_f32_16x16x32_bf16 v[124:127], v[52:55], a[148:151], v[124:127]
 v_add_f32 v144, v144, v192
 v_add_f32 v145, v145, v193
 v_mfma_f32_16x16x32_bf16 v[120:123], v[52:55], a[144:147], v[120:123]
 v_add_f32 v146, v146, v194
 v_add_f32 v147, v147, v195
 v_mfma_f32_16x16x32_bf16 v[128:131], v[48:51], a[152:155], v[128:131]
 v_add_f32 v148, v148, v196
 v_add_f32 v149, v149, v197
 v_mfma_f32_16x16x32_bf16 v[132:135], v[48:51], a[156:159], v[132:135]
 v_add_f32 v150, v150, v198
 v_add_f32 v151, v151, v199
 v_mfma_f32_16x16x32_bf16 v[140:143], v[52:55], a[156:159], v[140:143]
 v_add_f32 v152, v152, v200
 v_add_f32 v153, v153, v201
 v_mfma_f32_16x16x32_bf16 v[136:139], v[52:55], a[152:155], v[136:139]
 v_add_f32 v154, v154, v202
 s_waitcnt vmcnt(14)
 v_mfma_f32_16x16x32_bf16 v[80:83], v[56:59], a[160:163], v[80:83]
 s_add_u32 s82, s65, 8192
 buffer_load_dwordx4 v[48:51], v2, s[48:51], s82 offen offset:0 sc1
 v_mfma_f32_16x16x32_bf16 v[84:87], v[56:59], a[164:167], v[84:87]
 v_add_f32 v155, v155, v203
 v_add_f32 v156, v156, v204
 v_mfma_f32_16x16x32_bf16 v[92:95], v[60:63], a[164:167], v[92:95]
 buffer_load_dwordx4 v[52:55], v2, s[48:51], s82 offen offset:128 sc1
 v_mfma_f32_16x16x32_bf16 v[88:91], v[60:63], a[160:163], v[88:91]
 v_add_f32 v157, v157, v205
 v_add_f32 v158, v158, v206
 v_mfma_f32_16x16x32_bf16 v[96:99], v[56:59], a[168:171], v[96:99]
 v_add_f32 v159, v159, v207
 v_cvt_pk_bf16_f32 v224, v144, v145
 v_mfma_f32_16x16x32_bf16 v[100:103], v[56:59], a[172:175], v[100:103]
 v_cvt_pk_bf16_f32 v225, v146, v147
 v_cvt_pk_bf16_f32 v226, v152, v153
 v_mfma_f32_16x16x32_bf16 v[108:111], v[60:63], a[172:175], v[108:111]
 v_cvt_pk_bf16_f32 v227, v154, v155
 v_mfma_f32_16x16x32_bf16 v[104:107], v[60:63], a[168:171], v[104:107]
 buffer_store_dwordx4 v[224:227], v6, s[48:51], s67 offen offset:0 sc1
 v_mfma_f32_16x16x32_bf16 v[112:115], v[56:59], a[176:179], v[112:115]
 v_cvt_pk_bf16_f32 v228, v148, v149
 v_cvt_pk_bf16_f32 v229, v150, v151
 v_mfma_f32_16x16x32_bf16 v[116:119], v[56:59], a[180:183], v[116:119]
 v_cvt_pk_bf16_f32 v230, v156, v157
 v_cvt_pk_bf16_f32 v231, v158, v159
 v_mfma_f32_16x16x32_bf16 v[124:127], v[60:63], a[180:183], v[124:127]
 buffer_store_dwordx4 v[228:231], v6, s[48:51], s67 offen offset:256 sc1
 v_mfma_f32_16x16x32_bf16 v[120:123], v[60:63], a[176:179], v[120:123]
 s_add_u32 s74, s74, 0x40000
 s_and_b32 s69, s74, 0x200000
 v_mfma_f32_16x16x32_bf16 v[128:131], v[56:59], a[184:187], v[128:131]
 s_lshr_b32 s69, s69, 8
 s_xor_b32 s69, s69, s74
 v_mfma_f32_16x16x32_bf16 v[132:135], v[56:59], a[188:191], v[132:135]
 buffer_store_dwordx4 v[232:235], v1, s[48:51], s69 offen sc1
 v_mfma_f32_16x16x32_bf16 v[140:143], v[60:63], a[188:191], v[140:143]
 s_add_u32 s67, s67, 0x40000
 v_mfma_f32_16x16x32_bf16 v[136:139], v[60:63], a[184:187], v[136:139]
 s_waitcnt vmcnt(17)
 v_mfma_f32_16x16x32_bf16 v[80:83], v[64:67], a[192:195], v[80:83]
 buffer_load_dwordx4 v[56:59], v2, s[48:51], s82 offen offset:2048 sc1
 v_mfma_f32_16x16x32_bf16 v[84:87], v[64:67], a[196:199], v[84:87]
 v_mfma_f32_16x16x32_bf16 v[92:95], v[68:71], a[196:199], v[92:95]
 buffer_load_dwordx4 v[60:63], v2, s[48:51], s82 offen offset:2176 sc1
 v_mfma_f32_16x16x32_bf16 v[88:91], v[68:71], a[192:195], v[88:91]
 v_mfma_f32_16x16x32_bf16 v[96:99], v[64:67], a[200:203], v[96:99]
 v_mfma_f32_16x16x32_bf16 v[100:103], v[64:67], a[204:207], v[100:103]
 v_mfma_f32_16x16x32_bf16 v[108:111], v[68:71], a[204:207], v[108:111]
 v_mfma_f32_16x16x32_bf16 v[104:107], v[68:71], a[200:203], v[104:107]
 v_mfma_f32_16x16x32_bf16 v[112:115], v[64:67], a[208:211], v[112:115]
 v_mfma_f32_16x16x32_bf16 v[116:119], v[64:67], a[212:215], v[116:119]
 v_mfma_f32_16x16x32_bf16 v[124:127], v[68:71], a[212:215], v[124:127]
 v_mfma_f32_16x16x32_bf16 v[120:123], v[68:71], a[208:211], v[120:123]
 v_mfma_f32_16x16x32_bf16 v[128:131], v[64:67], a[216:219], v[128:131]
 v_mfma_f32_16x16x32_bf16 v[132:135], v[64:67], a[220:223], v[132:135]
 v_mfma_f32_16x16x32_bf16 v[140:143], v[68:71], a[220:223], v[140:143]
 v_mfma_f32_16x16x32_bf16 v[136:139], v[68:71], a[216:219], v[136:139]
 s_waitcnt vmcnt(16)
 v_mfma_f32_16x16x32_bf16 v[80:83], v[72:75], a[224:227], v[80:83]
 s_add_u32 s82, s65, 12288
 buffer_load_dwordx4 v[64:67], v2, s[48:51], s82 offen offset:0 sc1
 v_mfma_f32_16x16x32_bf16 v[84:87], v[72:75], a[228:231], v[84:87]
 v_mfma_f32_16x16x32_bf16 v[92:95], v[76:79], a[228:231], v[92:95]
 buffer_load_dwordx4 v[68:71], v2, s[48:51], s82 offen offset:128 sc1
 v_mfma_f32_16x16x32_bf16 v[88:91], v[76:79], a[224:227], v[88:91]
 s_add_u32 s70, s65, 131072
 v_mfma_f32_16x16x32_bf16 v[96:99], v[72:75], a[232:235], v[96:99]
 buffer_load_dwordx4 v[12:15], v11, s[48:51], s70 offen offset:0 sc1
 v_mfma_f32_16x16x32_bf16 v[100:103], v[72:75], a[236:239], v[100:103]
 s_add_u32 s65, s65, 0x10000
 s_add_u32 s63, s63, 1
 v_mfma_f32_16x16x32_bf16 v[108:111], v[76:79], a[236:239], v[108:111]
 v_mfma_f32_16x16x32_bf16 v[104:107], v[76:79], a[232:235], v[104:107]
 v_mfma_f32_16x16x32_bf16 v[112:115], v[72:75], a[240:243], v[112:115]
 v_mfma_f32_16x16x32_bf16 v[116:119], v[72:75], a[244:247], v[116:119]
 v_mfma_f32_16x16x32_bf16 v[124:127], v[76:79], a[244:247], v[124:127]
 v_mfma_f32_16x16x32_bf16 v[120:123], v[76:79], a[240:243], v[120:123]
 v_mfma_f32_16x16x32_bf16 v[128:131], v[72:75], a[248:251], v[128:131]
 v_mfma_f32_16x16x32_bf16 v[132:135], v[72:75], a[252:255], v[132:135]
 v_mfma_f32_16x16x32_bf16 v[140:143], v[76:79], a[252:255], v[140:143]
 v_mfma_f32_16x16x32_bf16 v[136:139], v[76:79], a[248:251], v[136:139]
 s_branch Lw_Vloop
Lw_Vxf:
news_85:
 v_mov_b32 v3, 0
 global_load_dword v4, v3, s[42:43] offset:132 sc1
 s_waitcnt vmcnt(0)
newschk_87:
 v_readfirstlane_b32 s7, v4
 s_nop 0
 s_and_b32 s7, s7, 8
 s_cmp_eq_u32 s7, 8
 s_cbranch_scc1 newsok_86
 s_sleep 2
 s_sub_u32 s46, s46, 1
 s_cbranch_scc0 news_85
 s_mov_b32 s46, 0
 s_branch newsok_86
newsok_86:
 s_branch Lw_Vxfok
Lw_Vend:
 ds_write_b128 v7, v[160:163] offset:49152
 ds_write_b128 v7, v[164:167] offset:50176
 ds_write_b128 v7, v[168:171] offset:51200
 ds_write_b128 v7, v[172:175] offset:52224
 ds_write_b128 v8, v[176:179] offset:49152
 ds_write_b128 v8, v[180:183] offset:50176
 ds_write_b128 v8, v[184:187] offset:51200
 ds_write_b128 v8, v[188:191] offset:52224
 ds_write_b128 v9, v[192:195] offset:49152
 ds_write_b128 v9, v[196:199] offset:50176
 ds_write_b128 v9, v[200:203] offset:51200
 ds_write_b128 v9, v[204:207] offset:52224
 s_waitcnt lgkmcnt(0)
 s_barrier
 ds_read_b128 v[160:163], v10 offset:49152
 ds_read_b128 v[164:167], v10 offset:50176
 ds_read_b128 v[168:171], v10 offset:51200
 ds_read_b128 v[172:175], v10 offset:52224
 ds_read_b128 v[176:179], v10 offset:53248
 ds_read_b128 v[180:183], v10 offset:54272
 ds_read_b128 v[184:187], v10 offset:55296
 ds_read_b128 v[188:191], v10 offset:56320
 ds_read_b128 v[192:195], v10 offset:57344
 ds_read_b128 v[196:199], v10 offset:58368
 ds_read_b128 v[200:203], v10 offset:59392
 ds_read_b128 v[204:207], v10 offset:60416
 s_waitcnt lgkmcnt(8)
 v_add_f32 v144, v144, v160
 v_add_f32 v145, v145, v161
 v_add_f32 v146, v146, v162
 v_add_f32 v147, v147, v163
 v_add_f32 v148, v148, v164
 v_add_f32 v149, v149, v165
 v_add_f32 v150, v150, v166
 v_add_f32 v151, v151, v167
 v_add_f32 v152, v152, v168
 v_add_f32 v153, v153, v169
 v_add_f32 v154, v154, v170
 v_add_f32 v155, v155, v171
 v_add_f32 v156, v156, v172
 v_add_f32 v157, v157, v173
 v_add_f32 v158, v158, v174
 v_add_f32 v159, v159, v175
 s_waitcnt lgkmcnt(4)
 v_add_f32 v144, v144, v176
 v_add_f32 v145, v145, v177
 v_add_f32 v146, v146, v178
 v_add_f32 v147, v147, v179
 v_add_f32 v148, v148, v180
 v_add_f32 v149, v149, v181
 v_add_f32 v150, v150, v182
 v_add_f32 v151, v151, v183
 v_add_f32 v152, v152, v184
 v_add_f32 v153, v153, v185
 v_add_f32 v154, v154, v186
 v_add_f32 v155, v155, v187
 v_add_f32 v156, v156, v188
 v_add_f32 v157, v157, v189
 v_add_f32 v158, v158, v190
 v_add_f32 v159, v159, v191
 s_waitcnt lgkmcnt(0)
 v_add_f32 v144, v144, v192
 v_add_f32 v145, v145, v193
 v_add_f32 v146, v146, v194
 v_add_f32 v147, v147, v195
 v_add_f32 v148, v148, v196
 v_add_f32 v149, v149, v197
 v_add_f32 v150, v150, v198
 v_add_f32 v151, v151, v199
 v_add_f32 v152, v152, v200
 v_add_f32 v153, v153, v201
 v_add_f32 v154, v154, v202
 v_add_f32 v155, v155, v203
 v_add_f32 v156, v156, v204
 v_add_f32 v157, v157, v205
 v_add_f32 v158, v158, v206
 v_add_f32 v159, v159, v207
 v_cvt_pk_bf16_f32 v224, v144, v145
 v_cvt_pk_bf16_f32 v225, v146, v147
 v_cvt_pk_bf16_f32 v226, v152, v153
 v_cvt_pk_bf16_f32 v227, v154, v155
 buffer_store_dwordx4 v[224:227], v6, s[48:51], s67 offen offset:0 sc1
 v_cvt_pk_bf16_f32 v228, v148, v149
 v_cvt_pk_bf16_f32 v229, v150, v151
 v_cvt_pk_bf16_f32 v230, v156, v157
 v_cvt_pk_bf16_f32 v231, v158, v159
 buffer_store_dwordx4 v[228:231], v6, s[48:51], s67 offen offset:256 sc1
 s_add_u32 s74, s74, 0x40000
 s_and_b32 s69, s74, 0x200000
 s_lshr_b32 s69, s69, 8
 s_xor_b32 s69, s69, s74
 buffer_store_dwordx4 v[232:235], v1, s[48:51], s69 offen sc1
 s_waitcnt vmcnt(0)
 v_mov_b32 v3, 64
 buffer_store_dword v3, v251, s[48:51], s68 offen sc1
 s_waitcnt vmcnt(0) lgkmcnt(0)
 s_branch L_ssm
L_ssm:
 s_waitcnt vmcnt(0)
 s_barrier
 s_lshl_b32 s60, s47, 4
 s_add_u32 s60, s60, s6
 s_lshl_b32 s60, s60, 2
 s_add_u32 s60, s60, s4
 s_lshl_b32 s61, s60, 3
 s_load_dwordx2 s[64:65], s[36:37], s61
 s_load_dwordx2 s[66:67], s[38:39], s61
 s_lshl_b32 s62, s60, 10
 v_lshl_add_u32 v2, v0, 2, s62
 global_load_dword v16, v2, s[24:25] offset:0
 global_load_dword v17, v2, s[26:27] offset:0
 global_load_dword v18, v2, s[28:29] offset:0
 global_load_dword v19, v2, s[30:31] offset:0
 global_load_dword v20, v2, s[32:33] offset:0
 global_load_dword v21, v2, s[34:35] offset:0
 global_load_dword v22, v2, s[24:25] offset:256
 global_load_dword v23, v2, s[26:27] offset:256
 global_load_dword v24, v2, s[28:29] offset:256
 global_load_dword v25, v2, s[30:31] offset:256
 global_load_dword v26, v2, s[32:33] offset:256
 global_load_dword v27, v2, s[34:35] offset:256
 global_load_dword v28, v2, s[24:25] offset:512
 global_load_dword v29, v2, s[26:27] offset:512
 global_load_dword v30, v2, s[28:29] offset:512
 global_load_dword v31, v2, s[30:31] offset:512
 global_load_dword v32, v2, s[32:33] offset:512
 global_load_dword v33, v2, s[34:35] offset:512
 global_load_dword v34, v2, s[24:25] offset:768
 global_load_dword v35, v2, s[26:27] offset:768
 global_load_dword v36, v2, s[28:29] offset:768
 global_load_dword v37, v2, s[30:31] offset:768
 global_load_dword v38, v2, s[32:33] offset:768
 global_load_dword v39, v2, s[34:35] offset:768
 s_mov_b32 s52, s22
 s_and_b32 s53, s23, 0xffff
 s_mov_b32 s54, 4194304
 s_mov_b32 s55, 0x20000
 s_mov_b32 s56, s40
 s_and_b32 s57, s41, 0xffff
 s_mov_b32 s58, 8388608
 s_mov_b32 s59, 0x20000
 v_and_b32 v4, 31, v0
 v_lshrrev_b32 v5, 5, v0
 v_lshrrev_b32 v3, 1, v0
 v_and_b32 v15, 1, v0
 v_lshlrev_b32 v15, 4, v15
 v_lshl_add_u32 v3, v3, 11, v15
 s_lshr_b32 s61, s60, 2
 s_lshl_b32 s61, s61, 5
 s_lshl_b32 s62, s4, 20
 s_add_u32 s61, s61, s62
 s_mul_i32 s63, s4, 16640
 s_and_b32 s68, s6, 3
 s_lshl_b32 s68, s68, 2
 s_add_u32 s69, s68, 0
 s_and_b32 s69, s69, 15
 s_mul_i32 s62, s69, 1040
 s_add_u32 m0, s62, s63
 s_lshl_b32 s62, s69, 16
 s_add_u32 s62, s62, s61
 buffer_load_dwordx4 v3, s[52:55], s62 offen lds
 s_add_u32 s69, s68, 1
 s_and_b32 s69, s69, 15
 s_mul_i32 s62, s69, 1040
 s_add_u32 m0, s62, s63
 s_lshl_b32 s62, s69, 16
 s_add_u32 s62, s62, s61
 buffer_load_dwordx4 v3, s[52:55], s62 offen lds
 s_add_u32 s69, s68, 2
 s_and_b32 s69, s69, 15
 s_mul_i32 s62, s69, 1040
 s_add_u32 m0, s62, s63
 s_lshl_b32 s62, s69, 16
 s_add_u32 s62, s62, s61
 buffer_load_dwordx4 v3, s[52:55], s62 offen lds
 s_add_u32 s69, s68, 3
 s_and_b32 s69, s69, 15
 s_mul_i32 s62, s69, 1040
 s_add_u32 m0, s62, s63
 s_lshl_b32 s62, s69, 16
 s_add_u32 s62, s62, s61
 buffer_load_dwordx4 v3, s[52:55], s62 offen lds
 s_add_u32 s69, s68, 4
 s_and_b32 s69, s69, 15
 s_mul_i32 s62, s69, 1040
 s_add_u32 m0, s62, s63
 s_lshl_b32 s62, s69, 16
 s_add_u32 s62, s62, s61
 buffer_load_dwordx4 v3, s[52:55], s62 offen lds
 s_add_u32 s69, s68, 5
 s_and_b32 s69, s69, 15
 s_mul_i32 s62, s69, 1040
 s_add_u32 m0, s62, s63
 s_lshl_b32 s62, s69, 16
 s_add_u32 s62, s62, s61
 buffer_load_dwordx4 v3, s[52:55], s62 offen lds
 s_add_u32 s69, s68, 6
 s_and_b32 s69, s69, 15
 s_mul_i32 s62, s69, 1040
 s_add_u32 m0, s62, s63
 s_lshl_b32 s62, s69, 16
 s_add_u32 s62, s62, s61
 buffer_load_dwordx4 v3, s[52:55], s62 offen lds
 s_add_u32 s69, s68, 7
 s_and_b32 s69, s69, 15
 s_mul_i32 s62, s69, 1040
 s_add_u32 m0, s62, s63
 s_lshl_b32 s62, s69, 16
 s_add_u32 s62, s62, s61
 buffer_load_dwordx4 v3, s[52:55], s62 offen lds
 s_add_u32 s69, s68, 8
 s_and_b32 s69, s69, 15
 s_mul_i32 s62, s69, 1040
 s_add_u32 m0, s62, s63
 s_lshl_b32 s62, s69, 16
 s_add_u32 s62, s62, s61
 buffer_load_dwordx4 v3, s[52:55], s62 offen lds
 s_add_u32 s69, s68, 9
 s_and_b32 s69, s69, 15
 s_mul_i32 s62, s69, 1040
 s_add_u32 m0, s62, s63
 s_lshl_b32 s62, s69, 16
 s_add_u32 s62, s62, s61
 buffer_load_dwordx4 v3, s[52:55], s62 offen lds
 s_add_u32 s69, s68, 10
 s_and_b32 s69, s69, 15
 s_mul_i32 s62, s69, 1040
 s_add_u32 m0, s62, s63
 s_lshl_b32 s62, s69, 16
 s_add_u32 s62, s62, s61
 buffer_load_dwordx4 v3, s[52:55], s62 offen lds
 s_add_u32 s69, s68, 11
 s_and_b32 s69, s69, 15
 s_mul_i32 s62, s69, 1040
 s_add_u32 m0, s62, s63
 s_lshl_b32 s62, s69, 16
 s_add_u32 s62, s62, s61
 buffer_load_dwordx4 v3, s[52:55], s62 offen lds
 s_add_u32 s69, s68, 12
 s_and_b32 s69, s69, 15
 s_mul_i32 s62, s69, 1040
 s_add_u32 m0, s62, s63
 s_lshl_b32 s62, s69, 16
 s_add_u32 s62, s62, s61
 buffer_load_dwordx4 v3, s[52:55], s62 offen lds
 s_add_u32 s69, s68, 13
 s_and_b32 s69, s69, 15
 s_mul_i32 s62, s69, 1040
 s_add_u32 m0, s62, s63
 s_lshl_b32 s62, s69, 16
 s_add_u32 s62, s62, s61
 buffer_load_dwordx4 v3, s[52:55], s62 offen lds
 s_add_u32 s69, s68, 14
 s_and_b32 s69, s69, 15
 s_mul_i32 s62, s69, 1040
 s_add_u32 m0, s62, s63
 s_lshl_b32 s62, s69, 16
 s_add_u32 s62, s62, s61
 buffer_load_dwordx4 v3, s[52:55], s62 offen lds
 s_add_u32 s69, s68, 15
 s_and_b32 s69, s69, 15
 s_mul_i32 s62, s69, 1040
 s_add_u32 m0, s62, s63
 s_lshl_b32 s62, s69, 16
 s_add_u32 s62, s62, s61
 buffer_load_dwordx4 v3, s[52:55], s62 offen lds
 s_mul_i32 s62, s4, 40960
 v_lshl_add_u32 v6, v0, 2, s62
 v_mul_u32_u24 v7, 528, v4
 v_lshl_add_u32 v7, v5, 4, v7
 v_add_u32 v7, s62, v7
 v_lshlrev_b32 v8, 5, v4
 v_lshl_add_u32 v8, v5, 4, v8
 v_and_b32 v2, 28, v4
 v_add3_u32 v8, v2, v8, s62
 v_sub_u32 v2, 4, v5
 v_lshlrev_b32 v9, v2, v4
 v_lshrrev_b32 v2, 7, v9
 v_lshl_add_u32 v9, v2, 2, v9
 v_add_u32 v9, s62, v9
 v_lshl_add_u32 v10, v4, 2, s62
 v_lshl_add_u32 v11, v0, 4, s62
 v_and_b32 v2, 3, v0
 v_mul_u32_u24 v12, 4160, v2
 v_lshrrev_b32 v2, 2, v4
 v_sub_u32 v2, 7, v2
 v_lshl_add_u32 v12, v2, 3, v12
 v_lshl_add_u32 v12, v5, 4, v12
 v_add_u32 v12, s62, v12
 v_mul_u32_u24 v14, 80, v4
 v_add_u32 v14, s62, v14
 v_lshl_add_u32 v13, v5, 4, v14
 v_add_u32 v13, 80, v13
 v_lshl_add_u32 v14, v5, 3, v14
 v_mul_u32_u24 v1, 1040, v4
 v_lshl_add_u32 v1, v5, 7, v1
 s_lshl_b32 s61, s4, 3
 v_add_u32 v1, s61, v1
 v_lshl_add_u32 v5, v0, 3, s62
 s_add_u32 s62, s62, 35664
 v_lshlrev_b32 v2, 3, v0
 v_sub_u32 v3, 2047, v2
 v_cvt_f32_i32 v84, v3
 v_cvt_pk_bf16_f32 v84, v84, 0
 v_subrev_u32 v84, 17024, v84
 v_lshrrev_b32 v85, 5, v84
 v_add_lshl_u32 v84, v84, v85, 2
 v_add_u32 v40, s62, v84
 v_sub_u32 v3, 2046, v2
 v_cvt_f32_i32 v84, v3
 v_cvt_pk_bf16_f32 v84, v84, 0
 v_subrev_u32 v84, 17024, v84
 v_lshrrev_b32 v85, 5, v84
 v_add_lshl_u32 v84, v84, v85, 2
 v_add_u32 v41, s62, v84
 v_sub_u32 v3, 2045, v2
 v_cvt_f32_i32 v84, v3
 v_cvt_pk_bf16_f32 v84, v84, 0
 v_subrev_u32 v84, 17024, v84
 v_lshrrev_b32 v85, 5, v84
 v_add_lshl_u32 v84, v84, v85, 2
 v_add_u32 v42, s62, v84
 v_sub_u32 v3, 2044, v2
 v_cvt_f32_i32 v84, v3
 v_cvt_pk_bf16_f32 v84, v84, 0
 v_subrev_u32 v84, 17024, v84
 v_lshrrev_b32 v85, 5, v84
 v_add_lshl_u32 v84, v84, v85, 2
 v_add_u32 v43, s62, v84
 v_sub_u32 v3, 2043, v2
 v_cvt_f32_i32 v84, v3
 v_cvt_pk_bf16_f32 v84, v84, 0
 v_subrev_u32 v84, 17024, v84
 v_lshrrev_b32 v85, 5, v84
 v_add_lshl_u32 v84, v84, v85, 2
 v_add_u32 v44, s62, v84
 v_sub_u32 v3, 2042, v2
 v_cvt_f32_i32 v84, v3
 v_cvt_pk_bf16_f32 v84, v84, 0
 v_subrev_u32 v84, 17024, v84
 v_lshrrev_b32 v85, 5, v84
 v_add_lshl_u32 v84, v84, v85, 2
 v_add_u32 v45, s62, v84
 v_sub_u32 v3, 2041, v2
 v_cvt_f32_i32 v84, v3
 v_cvt_pk_bf16_f32 v84, v84, 0
 v_subrev_u32 v84, 17024, v84
 v_lshrrev_b32 v85, 5, v84
 v_add_lshl_u32 v84, v84, v85, 2
 v_add_u32 v46, s62, v84
 v_sub_u32 v3, 2040, v2
 v_cvt_f32_i32 v84, v3
 v_cvt_pk_bf16_f32 v84, v84, 0
 v_subrev_u32 v84, 17024, v84
 v_lshrrev_b32 v85, 5, v84
 v_add_lshl_u32 v84, v84, v85, 2
 v_add_u32 v47, s62, v84
 v_sub_u32 v3, 2039, v2
 v_cvt_f32_i32 v84, v3
 v_cvt_pk_bf16_f32 v84, v84, 0
 v_subrev_u32 v84, 17024, v84
 v_lshrrev_b32 v85, 5, v84
 v_add_lshl_u32 v84, v84, v85, 2
 v_add_u32 v48, s62, v84
 v_sub_u32 v3, 2038, v2
 v_cvt_f32_i32 v84, v3
 v_cvt_pk_bf16_f32 v84, v84, 0
 v_subrev_u32 v84, 17024, v84
 v_lshrrev_b32 v85, 5, v84
 v_add_lshl_u32 v84, v84, v85, 2
 v_add_u32 v49, s62, v84
 v_sub_u32 v3, 2037, v2
 v_cvt_f32_i32 v84, v3
 v_cvt_pk_bf16_f32 v84, v84, 0
 v_subrev_u32 v84, 17024, v84
 v_lshrrev_b32 v85, 5, v84
 v_add_lshl_u32 v84, v84, v85, 2
 v_add_u32 v50, s62, v84
 v_sub_u32 v3, 1535, v2
 v_cvt_f32_i32 v84, v3
 v_cvt_pk_bf16_f32 v84, v84, 0
 v_subrev_u32 v84, 17024, v84
 v_lshrrev_b32 v85, 5, v84
 v_add_lshl_u32 v84, v84, v85, 2
 v_add_u32 v51, s62, v84
 v_sub_u32 v3, 1534, v2
 v_cvt_f32_i32 v84, v3
 v_cvt_pk_bf16_f32 v84, v84, 0
 v_subrev_u32 v84, 17024, v84
 v_lshrrev_b32 v85, 5, v84
 v_add_lshl_u32 v84, v84, v85, 2
 v_add_u32 v52, s62, v84
 v_sub_u32 v3, 1533, v2
 v_cvt_f32_i32 v84, v3
 v_cvt_pk_bf16_f32 v84, v84, 0
 v_subrev_u32 v84, 17024, v84
 v_lshrrev_b32 v85, 5, v84
 v_add_lshl_u32 v84, v84, v85, 2
 v_add_u32 v53, s62, v84
 v_sub_u32 v3, 1532, v2
 v_cvt_f32_i32 v84, v3
 v_cvt_pk_bf16_f32 v84, v84, 0
 v_subrev_u32 v84, 17024, v84
 v_lshrrev_b32 v85, 5, v84
 v_add_lshl_u32 v84, v84, v85, 2
 v_add_u32 v54, s62, v84
 v_sub_u32 v3, 1531, v2
 v_cvt_f32_i32 v84, v3
 v_cvt_pk_bf16_f32 v84, v84, 0
 v_subrev_u32 v84, 17024, v84
 v_lshrrev_b32 v85, 5, v84
 v_add_lshl_u32 v84, v84, v85, 2
 v_add_u32 v55, s62, v84
 v_sub_u32 v3, 1530, v2
 v_cvt_f32_i32 v84, v3
 v_cvt_pk_bf16_f32 v84, v84, 0
 v_subrev_u32 v84, 17024, v84
 v_lshrrev_b32 v85, 5, v84
 v_add_lshl_u32 v84, v84, v85, 2
 v_add_u32 v56, s62, v84
 v_sub_u32 v3, 1529, v2
 v_cvt_f32_i32 v84, v3
 v_cvt_pk_bf16_f32 v84, v84, 0
 v_subrev_u32 v84, 17024, v84
 v_lshrrev_b32 v85, 5, v84
 v_add_lshl_u32 v84, v84, v85, 2
 v_add_u32 v57, s62, v84
 v_sub_u32 v3, 1528, v2
 v_cvt_f32_i32 v84, v3
 v_cvt_pk_bf16_f32 v84, v84, 0
 v_subrev_u32 v84, 17024, v84
 v_lshrrev_b32 v85, 5, v84
 v_add_lshl_u32 v84, v84, v85, 2
 v_add_u32 v58, s62, v84
 v_sub_u32 v3, 1527, v2
 v_cvt_f32_i32 v84, v3
 v_cvt_pk_bf16_f32 v84, v84, 0
 v_subrev_u32 v84, 17024, v84
 v_lshrrev_b32 v85, 5, v84
 v_add_lshl_u32 v84, v84, v85, 2
 v_add_u32 v59, s62, v84
 v_sub_u32 v3, 1526, v2
 v_cvt_f32_i32 v84, v3
 v_cvt_pk_bf16_f32 v84, v84, 0
 v_subrev_u32 v84, 17024, v84
 v_lshrrev_b32 v85, 5, v84
 v_add_lshl_u32 v84, v84, v85, 2
 v_add_u32 v60, s62, v84
 v_sub_u32 v3, 1525, v2
 v_cvt_f32_i32 v84, v3
 v_cvt_pk_bf16_f32 v84, v84, 0
 v_subrev_u32 v84, 17024, v84
 v_lshrrev_b32 v85, 5, v84
 v_add_lshl_u32 v84, v84, v85, 2
 v_add_u32 v61, s62, v84
 v_sub_u32 v3, 1023, v2
 v_cvt_f32_i32 v84, v3
 v_cvt_pk_bf16_f32 v84, v84, 0
 v_subrev_u32 v84, 17024, v84
 v_lshrrev_b32 v85, 5, v84
 v_add_lshl_u32 v84, v84, v85, 2
 v_add_u32 v62, s62, v84
 v_sub_u32 v3, 1022, v2
 v_cvt_f32_i32 v84, v3
 v_cvt_pk_bf16_f32 v84, v84, 0
 v_subrev_u32 v84, 17024, v84
 v_lshrrev_b32 v85, 5, v84
 v_add_lshl_u32 v84, v84, v85, 2
 v_add_u32 v63, s62, v84
 v_sub_u32 v3, 1021, v2
 v_cvt_f32_i32 v84, v3
 v_cvt_pk_bf16_f32 v84, v84, 0
 v_subrev_u32 v84, 17024, v84
 v_lshrrev_b32 v85, 5, v84
 v_add_lshl_u32 v84, v84, v85, 2
 v_add_u32 v64, s62, v84
 v_sub_u32 v3, 1020, v2
 v_cvt_f32_i32 v84, v3
 v_cvt_pk_bf16_f32 v84, v84, 0
 v_subrev_u32 v84, 17024, v84
 v_lshrrev_b32 v85, 5, v84
 v_add_lshl_u32 v84, v84, v85, 2
 v_add_u32 v65, s62, v84
 v_sub_u32 v3, 1019, v2
 v_cvt_f32_i32 v84, v3
 v_cvt_pk_bf16_f32 v84, v84, 0
 v_subrev_u32 v84, 17024, v84
 v_lshrrev_b32 v85, 5, v84
 v_add_lshl_u32 v84, v84, v85, 2
 v_add_u32 v66, s62, v84
 v_sub_u32 v3, 1018, v2
 v_cvt_f32_i32 v84, v3
 v_cvt_pk_bf16_f32 v84, v84, 0
 v_subrev_u32 v84, 17024, v84
 v_lshrrev_b32 v85, 5, v84
 v_add_lshl_u32 v84, v84, v85, 2
 v_add_u32 v67, s62, v84
 v_sub_u32 v3, 1017, v2
 v_cvt_f32_i32 v84, v3
 v_cvt_pk_bf16_f32 v84, v84, 0
 v_subrev_u32 v84, 17024, v84
 v_lshrrev_b32 v85, 5, v84
 v_add_lshl_u32 v84, v84, v85, 2
 v_add_u32 v68, s62, v84
 v_sub_u32 v3, 1016, v2
 v_cvt_f32_i32 v84, v3
 v_cvt_pk_bf16_f32 v84, v84, 0
 v_subrev_u32 v84, 17024, v84
 v_lshrrev_b32 v85, 5, v84
 v_add_lshl_u32 v84, v84, v85, 2
 v_add_u32 v69, s62, v84
 v_sub_u32 v3, 1015, v2
 v_cvt_f32_i32 v84, v3
 v_cvt_pk_bf16_f32 v84, v84, 0
 v_subrev_u32 v84, 17024, v84
 v_lshrrev_b32 v85, 5, v84
 v_add_lshl_u32 v84, v84, v85, 2
 v_add_u32 v70, s62, v84
 v_sub_u32 v3, 1014, v2
 v_cvt_f32_i32 v84, v3
 v_cvt_pk_bf16_f32 v84, v84, 0
 v_subrev_u32 v84, 17024, v84
 v_lshrrev_b32 v85, 5, v84
 v_add_lshl_u32 v84, v84, v85, 2
 v_add_u32 v71, s62, v84
 v_sub_u32 v3, 1013, v2
 v_cvt_f32_i32 v84, v3
 v_cvt_pk_bf16_f32 v84, v84, 0
 v_subrev_u32 v84, 17024, v84
 v_lshrrev_b32 v85, 5, v84
 v_add_lshl_u32 v84, v84, v85, 2
 v_add_u32 v72, s62, v84
 v_sub_u32 v3, 511, v2
 v_cvt_f32_i32 v84, v3
 v_cvt_pk_bf16_f32 v84, v84, 0
 v_subrev_u32 v84, 17024, v84
 v_cmp_gt_i32 vcc, 0x100, v3
 s_nop 1
 v_cndmask_b32 v84, v84, v3, vcc
 v_lshrrev_b32 v85, 5, v84
 v_add_lshl_u32 v84, v84, v85, 2
 v_add_u32 v73, s62, v84
 v_sub_u32 v3, 510, v2
 v_cvt_f32_i32 v84, v3
 v_cvt_pk_bf16_f32 v84, v84, 0
 v_subrev_u32 v84, 17024, v84
 v_cmp_gt_i32 vcc, 0x100, v3
 s_nop 1
 v_cndmask_b32 v84, v84, v3, vcc
 v_lshrrev_b32 v85, 5, v84
 v_add_lshl_u32 v84, v84, v85, 2
 v_add_u32 v74, s62, v84
 v_sub_u32 v3, 509, v2
 v_cvt_f32_i32 v84, v3
 v_cvt_pk_bf16_f32 v84, v84, 0
 v_subrev_u32 v84, 17024, v84
 v_cmp_gt_i32 vcc, 0x100, v3
 s_nop 1
 v_cndmask_b32 v84, v84, v3, vcc
 v_lshrrev_b32 v85, 5, v84
 v_add_lshl_u32 v84, v84, v85, 2
 v_add_u32 v75, s62, v84
 v_sub_u32 v3, 508, v2
 v_cvt_f32_i32 v84, v3
 v_cvt_pk_bf16_f32 v84, v84, 0
 v_subrev_u32 v84, 17024, v84
 v_cmp_gt_i32 vcc, 0x100, v3
 s_nop 1
 v_cndmask_b32 v84, v84, v3, vcc
 v_lshrrev_b32 v85, 5, v84
 v_add_lshl_u32 v84, v84, v85, 2
 v_add_u32 v76, s62, v84
 v_sub_u32 v3, 507, v2
 v_cvt_f32_i32 v84, v3
 v_cvt_pk_bf16_f32 v84, v84, 0
 v_subrev_u32 v84, 17024, v84
 v_cmp_gt_i32 vcc, 0x100, v3
 s_nop 1
 v_cndmask_b32 v84, v84, v3, vcc
 v_lshrrev_b32 v85, 5, v84
 v_add_lshl_u32 v84, v84, v85, 2
 v_add_u32 v77, s62, v84
 v_sub_u32 v3, 506, v2
 v_cvt_f32_i32 v84, v3
 v_cvt_pk_bf16_f32 v84, v84, 0
 v_subrev_u32 v84, 17024, v84
 v_cmp_gt_i32 vcc, 0x100, v3
 s_nop 1
 v_cndmask_b32 v84, v84, v3, vcc
 v_lshrrev_b32 v85, 5, v84
 v_add_lshl_u32 v84, v84, v85, 2
 v_add_u32 v78, s62, v84
 v_sub_u32 v3, 505, v2
 v_cvt_f32_i32 v84, v3
 v_cvt_pk_bf16_f32 v84, v84, 0
 v_subrev_u32 v84, 17024, v84
 v_cmp_gt_i32 vcc, 0x100, v3
 s_nop 1
 v_cndmask_b32 v84, v84, v3, vcc
 v_lshrrev_b32 v85, 5, v84
 v_add_lshl_u32 v84, v84, v85, 2
 v_add_u32 v79, s62, v84
 v_sub_u32 v3, 504, v2
 v_cvt_f32_i32 v84, v3
 v_cvt_pk_bf16_f32 v84, v84, 0
 v_subrev_u32 v84, 17024, v84
 v_cmp_gt_i32 vcc, 0x100, v3
 s_nop 1
 v_cndmask_b32 v84, v84, v3, vcc
 v_lshrrev_b32 v85, 5, v84
 v_add_lshl_u32 v84, v84, v85, 2
 v_add_u32 v80, s62, v84
 v_sub_u32 v3, 503, v2
 v_cvt_f32_i32 v84, v3
 v_cvt_pk_bf16_f32 v84, v84, 0
 v_subrev_u32 v84, 17024, v84
 v_cmp_gt_i32 vcc, 0x100, v3
 s_nop 1
 v_cndmask_b32 v84, v84, v3, vcc
 v_mov_b32 v85, 672
 v_cmp_gt_i32 vcc, 0, v3
 s_nop 1
 v_cndmask_b32 v84, v84, v85, vcc
 v_lshrrev_b32 v85, 5, v84
 v_add_lshl_u32 v84, v84, v85, 2
 v_add_u32 v81, s62, v84
 v_sub_u32 v3, 502, v2
 v_cvt_f32_i32 v84, v3
 v_cvt_pk_bf16_f32 v84, v84, 0
 v_subrev_u32 v84, 17024, v84
 v_cmp_gt_i32 vcc, 0x100, v3
 s_nop 1
 v_cndmask_b32 v84, v84, v3, vcc
 v_mov_b32 v85, 672
 v_cmp_gt_i32 vcc, 0, v3
 s_nop 1
 v_cndmask_b32 v84, v84, v85, vcc
 v_lshrrev_b32 v85, 5, v84
 v_add_lshl_u32 v84, v84, v85, 2
 v_add_u32 v82, s62, v84
 v_sub_u32 v3, 501, v2
 v_cvt_f32_i32 v84, v3
 v_cvt_pk_bf16_f32 v84, v84, 0
 v_subrev_u32 v84, 17024, v84
 v_cmp_gt_i32 vcc, 0x100, v3
 s_nop 1
 v_cndmask_b32 v84, v84, v3, vcc
 v_mov_b32 v85, 672
 v_cmp_gt_i32 vcc, 0, v3
 s_nop 1
 v_cndmask_b32 v84, v84, v85, vcc
 v_lshrrev_b32 v85, 5, v84
 v_add_lshl_u32 v84, v84, v85, 2
 v_add_u32 v83, s62, v84
 s_waitcnt vmcnt(0)
 s_barrier
 ds_read_b64 v[192:193], v1 offset:0
 ds_read_b64 v[194:195], v1 offset:32
 ds_read_b64 v[196:197], v1 offset:64
 ds_read_b64 v[198:199], v1 offset:96
 ds_read_b64 v[200:201], v1 offset:256
 ds_read_b64 v[202:203], v1 offset:288
 ds_read_b64 v[204:205], v1 offset:320
 ds_read_b64 v[206:207], v1 offset:352
 s_waitcnt lgkmcnt(0)
 ds_read_b64 v[208:209], v1 offset:512
 ds_read_b64 v[210:211], v1 offset:544
 ds_read_b64 v[212:213], v1 offset:576
 ds_read_b64 v[214:215], v1 offset:608
 ds_read_b64 v[216:217], v1 offset:768
 ds_read_b64 v[218:219], v1 offset:800
 ds_read_b64 v[220:221], v1 offset:832
 ds_read_b64 v[222:223], v1 offset:864
 s_waitcnt lgkmcnt(0)
 ds_read_b64 v[224:225], v1 offset:33280
 ds_read_b64 v[226:227], v1 offset:33312
 ds_read_b64 v[228:229], v1 offset:33344
 ds_read_b64 v[230:231], v1 offset:33376
 ds_read_b64 v[232:233], v1 offset:33536
 ds_read_b64 v[234:235], v1 offset:33568
 ds_read_b64 v[236:237], v1 offset:33600
 ds_read_b64 v[238:239], v1 offset:33632
 s_waitcnt lgkmcnt(0)
 ds_read_b64 v[240:241], v1 offset:33792
 ds_read_b64 v[242:243], v1 offset:33824
 ds_read_b64 v[244:245], v1 offset:33856
 ds_read_b64 v[246:247], v1 offset:33888
 ds_read_b64 v[248:249], v1 offset:34048
 ds_read_b64 v[250:251], v1 offset:34080
 ds_read_b64 v[252:253], v1 offset:34112
 ds_read_b64 v[254:255], v1 offset:34144
 s_waitcnt lgkmcnt(0)
 s_barrier
 v_mov_b32 v2, 0
 ds_write_b32 v6, v2 offset:38436
 ds_write_b32 v6, v2 offset:27984
 ds_write_b32 v6, v2 offset:28240
 ds_write_b32 v6, v2 offset:28496
 ds_write_b32 v6, v2 offset:28752
 ds_write_b32 v6, v2 offset:29008
 ds_write_b32 v6, v2 offset:29264
 ds_write_b32 v6, v2 offset:29520
 ds_write_b32 v6, v2 offset:29776
 ds_write_b32 v6, v2 offset:30032
 ds_write_b32 v6, v2 offset:30288
 s_mov_b32 s63, 0
 s_waitcnt lgkmcnt(0)
Ls_chan:
 s_lshl_b32 s61, s64, 16
 v_mov_b32 v15, 0x3fb8aa3b
 v_mul_f32 v15, s61, v15
 v_exp_f32 v15, v15
 s_bitcmp1_b32 s63, 0
 s_mov_b32 s68, 0x01000c0c
 s_mov_b32 s69, 0x05040100
 s_mov_b32 s70, 0x03020504
 s_mov_b32 s71, 0x03020706
 s_cmov_b32 s68, 0x03020c0c
 s_cmov_b32 s69, 0x07060302
 s_cmov_b32 s70, 0x05040100
 s_cmov_b32 s71, 0x07060100
 v_cvt_pk_bf16_f32 v15, v15, v15
 v_lshlrev_b32 v15, 16, v15
 v_lshlrev_b32 v84, 16, v16
 v_lshlrev_b32 v85, 16, v17
 v_lshlrev_b32 v96, 16, v18
 v_lshlrev_b32 v97, 16, v19
 v_lshlrev_b32 v98, 16, v20
 v_lshlrev_b32 v99, 16, v21
 v_mul_f32 v84, v15, v84
 v_mul_f32 v85, v15, v85
 v_mul_f32 v96, v15, v96
 v_mul_f32 v97, v15, v97
 v_mul_f32 v84, 0x3fb8aa3b, v84
 v_mul_f32 v85, 0.15915494, v85
 v_mul_f32 v2, 0x3f800000, v84
 v_mul_f32 v3, 0x3f800000, v85
 v_exp_f32 v2, v2
 v_fract_f32 v3, v3
 v_cos_f32 v86, v3
 v_sin_f32 v87, v3
 s_nop 0
 v_pk_mul_f32 v[86:87], v[86:87], v[2:3] op_sel_hi:[1,0]
 v_mul_f32 v2, 0x41000000, v84
 v_mul_f32 v3, 0x41000000, v85
 v_exp_f32 v2, v2
 v_fract_f32 v3, v3
 v_cos_f32 v88, v3
 v_sin_f32 v89, v3
 s_nop 0
 v_pk_mul_f32 v[88:89], v[88:89], v[2:3] op_sel_hi:[1,0]
 v_mul_f32 v2, 0x43800000, v84
 v_mul_f32 v3, 0x43800000, v85
 v_exp_f32 v2, v2
 v_fract_f32 v3, v3
 v_cos_f32 v90, v3
 v_sin_f32 v91, v3
 s_nop 0
 v_pk_mul_f32 v[90:91], v[90:91], v[2:3] op_sel_hi:[1,0]
 v_and_b32 v136, 0xffff0000, v16
 v_and_b32 v137, 0xffff0000, v17
 v_and_b32 v148, 0xffff0000, v18
 v_and_b32 v149, 0xffff0000, v19
 v_and_b32 v150, 0xffff0000, v20
 v_and_b32 v151, 0xffff0000, v21
 v_mul_f32 v136, v15, v136
 v_mul_f32 v137, v15, v137
 v_mul_f32 v148, v15, v148
 v_mul_f32 v149, v15, v149
 v_mul_f32 v136, 0x3fb8aa3b, v136
 v_mul_f32 v137, 0.15915494, v137
 v_mul_f32 v2, 0x3f800000, v136
 v_mul_f32 v3, 0x3f800000, v137
 v_exp_f32 v2, v2
 v_fract_f32 v3, v3
 v_cos_f32 v138, v3
 v_sin_f32 v139, v3
 s_nop 0
 v_pk_mul_f32 v[138:139], v[138:139], v[2:3] op_sel_hi:[1,0]
 v_mul_f32 v2, 0x41000000, v136
 v_mul_f32 v3, 0x41000000, v137
 v_exp_f32 v2, v2
 v_fract_f32 v3, v3
 v_cos_f32 v140, v3
 v_sin_f32 v141, v3
 s_nop 0
 v_pk_mul_f32 v[140:141], v[140:141], v[2:3] op_sel_hi:[1,0]
 v_mul_f32 v2, 0x43800000, v136
 v_mul_f32 v3, 0x43800000, v137
 v_exp_f32 v2, v2
 v_fract_f32 v3, v3
 v_cos_f32 v142, v3
 v_sin_f32 v143, v3
 s_nop 0
 v_pk_mul_f32 v[142:143], v[142:143], v[2:3] op_sel_hi:[1,0]
 v_pk_mul_f32 v[100:101], v[98:99], v[96:97] op_sel_hi:[1,0]
 v_pk_mul_f32 v[152:153], v[150:151], v[148:149] op_sel_hi:[1,0]
 v_pk_fma_f32 v[100:101], v[98:99], v[96:97], v[100:101] op_sel:[1,1,0] op_sel_hi:[0,1,1] neg_lo:[1,0,0]
 v_pk_fma_f32 v[152:153], v[150:151], v[148:149], v[152:153] op_sel:[1,1,0] op_sel_hi:[0,1,1] neg_lo:[1,0,0]
 v_mov_b32 v126, 0x3f80
 v_mov_b32 v127, 0x3f80
 ds_write_b64 v5, v[126:127] offset:11088
 v_cvt_pk_bf16_f32 v120, v88, v89
 v_cvt_pk_bf16_f32 v121, v140, v141
 ds_write_b64 v5, v[120:121] offset:11616
 v_pk_mul_f32 v[116:117], v[88:89], v[88:89] op_sel_hi:[1,0]
 v_pk_mul_f32 v[168:169], v[140:141], v[140:141] op_sel_hi:[1,0]
 v_pk_fma_f32 v[116:117], v[88:89], v[88:89], v[116:117] op_sel:[1,1,0] op_sel_hi:[0,1,1] neg_lo:[1,0,0]
 v_pk_fma_f32 v[168:169], v[140:141], v[140:141], v[168:169] op_sel:[1,1,0] op_sel_hi:[0,1,1] neg_lo:[1,0,0]
 v_cvt_pk_bf16_f32 v122, v116, v117
 v_cvt_pk_bf16_f32 v123, v168, v169
 ds_write_b64 v5, v[122:123] offset:12144
 v_pk_mul_f32 v[118:119], v[116:117], v[88:89] op_sel_hi:[1,0]
 v_pk_mul_f32 v[170:171], v[168:169], v[140:141] op_sel_hi:[1,0]
 v_pk_fma_f32 v[118:119], v[116:117], v[88:89], v[118:119] op_sel:[1,1,0] op_sel_hi:[0,1,1] neg_lo:[1,0,0]
 v_pk_fma_f32 v[170:171], v[168:169], v[140:141], v[170:171] op_sel:[1,1,0] op_sel_hi:[0,1,1] neg_lo:[1,0,0]
 v_cvt_pk_bf16_f32 v124, v118, v119
 v_cvt_pk_bf16_f32 v125, v170, v171
 ds_write_b64 v5, v[124:125] offset:12672
 v_pk_mul_f32 v[116:117], v[118:119], v[88:89] op_sel_hi:[1,0]
 v_pk_mul_f32 v[168:169], v[170:171], v[140:141] op_sel_hi:[1,0]
 v_pk_fma_f32 v[116:117], v[118:119], v[88:89], v[116:117] op_sel:[1,1,0] op_sel_hi:[0,1,1] neg_lo:[1,0,0]
 v_pk_fma_f32 v[168:169], v[170:171], v[140:141], v[168:169] op_sel:[1,1,0] op_sel_hi:[0,1,1] neg_lo:[1,0,0]
 v_cvt_pk_bf16_f32 v126, v116, v117
 v_cvt_pk_bf16_f32 v127, v168, v169
 ds_write_b64 v5, v[126:127] offset:13200
 v_pk_mul_f32 v[118:119], v[116:117], v[88:89] op_sel_hi:[1,0]
 v_pk_mul_f32 v[170:171], v[168:169], v[140:141] op_sel_hi:[1,0]
 v_pk_fma_f32 v[118:119], v[116:117], v[88:89], v[118:119] op_sel:[1,1,0] op_sel_hi:[0,1,1] neg_lo:[1,0,0]
 v_pk_fma_f32 v[170:171], v[168:169], v[140:141], v[170:171] op_sel:[1,1,0] op_sel_hi:[0,1,1] neg_lo:[1,0,0]
 v_cvt_pk_bf16_f32 v120, v118, v119
 v_cvt_pk_bf16_f32 v121, v170, v171
 ds_write_b64 v5, v[120:121] offset:13728
 v_pk_mul_f32 v[116:117], v[118:119], v[88:89] op_sel_hi:[1,0]
 v_pk_mul_f32 v[168:169], v[170:171], v[140:141] op_sel_hi:[1,0]
 v_pk_fma_f32 v[116:117], v[118:119], v[88:89], v[116:117] op_sel:[1,1,0] op_sel_hi:[0,1,1] neg_lo:[1,0,0]
 v_pk_fma_f32 v[168:169], v[170:171], v[140:141], v[168:169] op_sel:[1,1,0] op_sel_hi:[0,1,1] neg_lo:[1,0,0]
 v_cvt_pk_bf16_f32 v122, v116, v117
 v_cvt_pk_bf16_f32 v123, v168, v169
 ds_write_b64 v5, v[122:123] offset:14256
 v_pk_mul_f32 v[118:119], v[116:117], v[88:89] op_sel_hi:[1,0]
 v_pk_mul_f32 v[170:171], v[168:169], v[140:141] op_sel_hi:[1,0]
 v_pk_fma_f32 v[118:119], v[116:117], v[88:89], v[118:119] op_sel:[1,1,0] op_sel_hi:[0,1,1] neg_lo:[1,0,0]
 v_pk_fma_f32 v[170:171], v[168:169], v[140:141], v[170:171] op_sel:[1,1,0] op_sel_hi:[0,1,1] neg_lo:[1,0,0]
 v_cvt_pk_bf16_f32 v124, v118, v119
 v_cvt_pk_bf16_f32 v125, v170, v171
 ds_write_b64 v5, v[124:125] offset:14784
 v_pk_mul_f32 v[116:117], v[118:119], v[88:89] op_sel_hi:[1,0]
 v_pk_mul_f32 v[168:169], v[170:171], v[140:141] op_sel_hi:[1,0]
 v_pk_fma_f32 v[116:117], v[118:119], v[88:89], v[116:117] op_sel:[1,1,0] op_sel_hi:[0,1,1] neg_lo:[1,0,0]
 v_pk_fma_f32 v[168:169], v[170:171], v[140:141], v[168:169] op_sel:[1,1,0] op_sel_hi:[0,1,1] neg_lo:[1,0,0]
 v_cvt_pk_bf16_f32 v126, v116, v117
 v_cvt_pk_bf16_f32 v127, v168, v169
 ds_write_b64 v5, v[126:127] offset:15312
 v_pk_mul_f32 v[118:119], v[116:117], v[88:89] op_sel_hi:[1,0]
 v_pk_mul_f32 v[170:171], v[168:169], v[140:141] op_sel_hi:[1,0]
 v_pk_fma_f32 v[118:119], v[116:117], v[88:89], v[118:119] op_sel:[1,1,0] op_sel_hi:[0,1,1] neg_lo:[1,0,0]
 v_pk_fma_f32 v[170:171], v[168:169], v[140:141], v[170:171] op_sel:[1,1,0] op_sel_hi:[0,1,1] neg_lo:[1,0,0]
 v_cvt_pk_bf16_f32 v120, v118, v119
 v_cvt_pk_bf16_f32 v121, v170, v171
 ds_write_b64 v5, v[120:121] offset:15840
 v_pk_mul_f32 v[116:117], v[118:119], v[88:89] op_sel_hi:[1,0]
 v_pk_mul_f32 v[168:169], v[170:171], v[140:141] op_sel_hi:[1,0]
 v_pk_fma_f32 v[116:117], v[118:119], v[88:89], v[116:117] op_sel:[1,1,0] op_sel_hi:[0,1,1] neg_lo:[1,0,0]
 v_pk_fma_f32 v[168:169], v[170:171], v[140:141], v[168:169] op_sel:[1,1,0] op_sel_hi:[0,1,1] neg_lo:[1,0,0]
 v_cvt_pk_bf16_f32 v122, v116, v117
 v_cvt_pk_bf16_f32 v123, v168, v169
 ds_write_b64 v5, v[122:123] offset:16368
 v_pk_mul_f32 v[118:119], v[116:117], v[88:89] op_sel_hi:[1,0]
 v_pk_mul_f32 v[170:171], v[168:169], v[140:141] op_sel_hi:[1,0]
 v_pk_fma_f32 v[118:119], v[116:117], v[88:89], v[118:119] op_sel:[1,1,0] op_sel_hi:[0,1,1] neg_lo:[1,0,0]
 v_pk_fma_f32 v[170:171], v[168:169], v[140:141], v[170:171] op_sel:[1,1,0] op_sel_hi:[0,1,1] neg_lo:[1,0,0]
 v_cvt_pk_bf16_f32 v124, v118, v119
 v_cvt_pk_bf16_f32 v125, v170, v171
 ds_write_b64 v5, v[124:125] offset:16896
 v_pk_mul_f32 v[116:117], v[118:119], v[88:89] op_sel_hi:[1,0]
 v_pk_mul_f32 v[168:169], v[170:171], v[140:141] op_sel_hi:[1,0]
 v_pk_fma_f32 v[116:117], v[118:119], v[88:89], v[116:117] op_sel:[1,1,0] op_sel_hi:[0,1,1] neg_lo:[1,0,0]
 v_pk_fma_f32 v[168:169], v[170:171], v[140:141], v[168:169] op_sel:[1,1,0] op_sel_hi:[0,1,1] neg_lo:[1,0,0]
 v_cvt_pk_bf16_f32 v126, v116, v117
 v_cvt_pk_bf16_f32 v127, v168, v169
 ds_write_b64 v5, v[126:127] offset:17424
 v_pk_mul_f32 v[118:119], v[116:117], v[88:89] op_sel_hi:[1,0]
 v_pk_mul_f32 v[170:171], v[168:169], v[140:141] op_sel_hi:[1,0]
 v_pk_fma_f32 v[118:119], v[116:117], v[88:89], v[118:119] op_sel:[1,1,0] op_sel_hi:[0,1,1] neg_lo:[1,0,0]
 v_pk_fma_f32 v[170:171], v[168:169], v[140:141], v[170:171] op_sel:[1,1,0] op_sel_hi:[0,1,1] neg_lo:[1,0,0]
 v_cvt_pk_bf16_f32 v120, v118, v119
 v_cvt_pk_bf16_f32 v121, v170, v171
 ds_write_b64 v5, v[120:121] offset:17952
 v_pk_mul_f32 v[116:117], v[118:119], v[88:89] op_sel_hi:[1,0]
 v_pk_mul_f32 v[168:169], v[170:171], v[140:141] op_sel_hi:[1,0]
 v_pk_fma_f32 v[116:117], v[118:119], v[88:89], v[116:117] op_sel:[1,1,0] op_sel_hi:[0,1,1] neg_lo:[1,0,0]
 v_pk_fma_f32 v[168:169], v[170:171], v[140:141], v[168:169] op_sel:[1,1,0] op_sel_hi:[0,1,1] neg_lo:[1,0,0]
 v_cvt_pk_bf16_f32 v122, v116, v117
 v_cvt_pk_bf16_f32 v123, v168, v169
 ds_write_b64 v5, v[122:123] offset:18480
 v_pk_mul_f32 v[118:119], v[116:117], v[88:89] op_sel_hi:[1,0]
 v_pk_mul_f32 v[170:171], v[168:169], v[140:141] op_sel_hi:[1,0]
 v_pk_fma_f32 v[118:119], v[116:117], v[88:89], v[118:119] op_sel:[1,1,0] op_sel_hi:[0,1,1] neg_lo:[1,0,0]
 v_pk_fma_f32 v[170:171], v[168:169], v[140:141], v[170:171] op_sel:[1,1,0] op_sel_hi:[0,1,1] neg_lo:[1,0,0]
 v_cvt_pk_bf16_f32 v124, v118, v119
 v_cvt_pk_bf16_f32 v125, v170, v171
 ds_write_b64 v5, v[124:125] offset:19008
 v_pk_mul_f32 v[116:117], v[118:119], v[88:89] op_sel_hi:[1,0]
 v_pk_mul_f32 v[168:169], v[170:171], v[140:141] op_sel_hi:[1,0]
 v_pk_fma_f32 v[116:117], v[118:119], v[88:89], v[116:117] op_sel:[1,1,0] op_sel_hi:[0,1,1] neg_lo:[1,0,0]
 v_pk_fma_f32 v[168:169], v[170:171], v[140:141], v[168:169] op_sel:[1,1,0] op_sel_hi:[0,1,1] neg_lo:[1,0,0]
 v_cvt_pk_bf16_f32 v126, v116, v117
 v_cvt_pk_bf16_f32 v127, v168, v169
 ds_write_b64 v5, v[126:127] offset:19536
 v_pk_mul_f32 v[118:119], v[116:117], v[88:89] op_sel_hi:[1,0]
 v_pk_mul_f32 v[170:171], v[168:169], v[140:141] op_sel_hi:[1,0]
 v_pk_fma_f32 v[118:119], v[116:117], v[88:89], v[118:119] op_sel:[1,1,0] op_sel_hi:[0,1,1] neg_lo:[1,0,0]
 v_pk_fma_f32 v[170:171], v[168:169], v[140:141], v[170:171] op_sel:[1,1,0] op_sel_hi:[0,1,1] neg_lo:[1,0,0]
 v_cvt_pk_bf16_f32 v120, v118, v119
 v_cvt_pk_bf16_f32 v121, v170, v171
 ds_write_b64 v5, v[120:121] offset:20064
 v_pk_mul_f32 v[116:117], v[118:119], v[88:89] op_sel_hi:[1,0]
 v_pk_mul_f32 v[168:169], v[170:171], v[140:141] op_sel_hi:[1,0]
 v_pk_fma_f32 v[116:117], v[118:119], v[88:89], v[116:117] op_sel:[1,1,0] op_sel_hi:[0,1,1] neg_lo:[1,0,0]
 v_pk_fma_f32 v[168:169], v[170:171], v[140:141], v[168:169] op_sel:[1,1,0] op_sel_hi:[0,1,1] neg_lo:[1,0,0]
 v_cvt_pk_bf16_f32 v122, v116, v117
 v_cvt_pk_bf16_f32 v123, v168, v169
 ds_write_b64 v5, v[122:123] offset:20592
 v_pk_mul_f32 v[118:119], v[116:117], v[88:89] op_sel_hi:[1,0]
 v_pk_mul_f32 v[170:171], v[168:169], v[140:141] op_sel_hi:[1,0]
 v_pk_fma_f32 v[118:119], v[116:117], v[88:89], v[118:119] op_sel:[1,1,0] op_sel_hi:[0,1,1] neg_lo:[1,0,0]
 v_pk_fma_f32 v[170:171], v[168:169], v[140:141], v[170:171] op_sel:[1,1,0] op_sel_hi:[0,1,1] neg_lo:[1,0,0]
 v_cvt_pk_bf16_f32 v124, v118, v119
 v_cvt_pk_bf16_f32 v125, v170, v171
 ds_write_b64 v5, v[124:125] offset:21120
 v_pk_mul_f32 v[116:117], v[118:119], v[88:89] op_sel_hi:[1,0]
 v_pk_mul_f32 v[168:169], v[170:171], v[140:141] op_sel_hi:[1,0]
 v_pk_fma_f32 v[116:117], v[118:119], v[88:89], v[116:117] op_sel:[1,1,0] op_sel_hi:[0,1,1] neg_lo:[1,0,0]
 v_pk_fma_f32 v[168:169], v[170:171], v[140:141], v[168:169] op_sel:[1,1,0] op_sel_hi:[0,1,1] neg_lo:[1,0,0]
 v_cvt_pk_bf16_f32 v126, v116, v117
 v_cvt_pk_bf16_f32 v127, v168, v169
 ds_write_b64 v5, v[126:127] offset:21648
 v_pk_mul_f32 v[118:119], v[116:117], v[88:89] op_sel_hi:[1,0]
 v_pk_mul_f32 v[170:171], v[168:169], v[140:141] op_sel_hi:[1,0]
 v_pk_fma_f32 v[118:119], v[116:117], v[88:89], v[118:119] op_sel:[1,1,0] op_sel_hi:[0,1,1] neg_lo:[1,0,0]
 v_pk_fma_f32 v[170:171], v[168:169], v[140:141], v[170:171] op_sel:[1,1,0] op_sel_hi:[0,1,1] neg_lo:[1,0,0]
 v_cvt_pk_bf16_f32 v120, v118, v119
 v_cvt_pk_bf16_f32 v121, v170, v171
 ds_write_b64 v5, v[120:121] offset:22176
 v_pk_mul_f32 v[116:117], v[118:119], v[88:89] op_sel_hi:[1,0]
 v_pk_mul_f32 v[168:169], v[170:171], v[140:141] op_sel_hi:[1,0]
 v_pk_fma_f32 v[116:117], v[118:119], v[88:89], v[116:117] op_sel:[1,1,0] op_sel_hi:[0,1,1] neg_lo:[1,0,0]
 v_pk_fma_f32 v[168:169], v[170:171], v[140:141], v[168:169] op_sel:[1,1,0] op_sel_hi:[0,1,1] neg_lo:[1,0,0]
 v_cvt_pk_bf16_f32 v122, v116, v117
 v_cvt_pk_bf16_f32 v123, v168, v169
 ds_write_b64 v5, v[122:123] offset:22704
 v_pk_mul_f32 v[118:119], v[116:117], v[88:89] op_sel_hi:[1,0]
 v_pk_mul_f32 v[170:171], v[168:169], v[140:141] op_sel_hi:[1,0]
 v_pk_fma_f32 v[118:119], v[116:117], v[88:89], v[118:119] op_sel:[1,1,0] op_sel_hi:[0,1,1] neg_lo:[1,0,0]
 v_pk_fma_f32 v[170:171], v[168:169], v[140:141], v[170:171] op_sel:[1,1,0] op_sel_hi:[0,1,1] neg_lo:[1,0,0]
 v_cvt_pk_bf16_f32 v124, v118, v119
 v_cvt_pk_bf16_f32 v125, v170, v171
 ds_write_b64 v5, v[124:125] offset:23232
 v_pk_mul_f32 v[116:117], v[118:119], v[88:89] op_sel_hi:[1,0]
 v_pk_mul_f32 v[168:169], v[170:171], v[140:141] op_sel_hi:[1,0]
 v_pk_fma_f32 v[116:117], v[118:119], v[88:89], v[116:117] op_sel:[1,1,0] op_sel_hi:[0,1,1] neg_lo:[1,0,0]
 v_pk_fma_f32 v[168:169], v[170:171], v[140:141], v[168:169] op_sel:[1,1,0] op_sel_hi:[0,1,1] neg_lo:[1,0,0]
 v_cvt_pk_bf16_f32 v126, v116, v117
 v_cvt_pk_bf16_f32 v127, v168, v169
 ds_write_b64 v5, v[126:127] offset:23760
 v_pk_mul_f32 v[118:119], v[116:117], v[88:89] op_sel_hi:[1,0]
 v_pk_mul_f32 v[170:171], v[168:169], v[140:141] op_sel_hi:[1,0]
 v_pk_fma_f32 v[118:119], v[116:117], v[88:89], v[118:119] op_sel:[1,1,0] op_sel_hi:[0,1,1] neg_lo:[1,0,0]
 v_pk_fma_f32 v[170:171], v[168:169], v[140:141], v[170:171] op_sel:[1,1,0] op_sel_hi:[0,1,1] neg_lo:[1,0,0]
 v_cvt_pk_bf16_f32 v120, v118, v119
 v_cvt_pk_bf16_f32 v121, v170, v171
 ds_write_b64 v5, v[120:121] offset:24288
 v_pk_mul_f32 v[116:117], v[118:119], v[88:89] op_sel_hi:[1,0]
 v_pk_mul_f32 v[168:169], v[170:171], v[140:141] op_sel_hi:[1,0]
 v_pk_fma_f32 v[116:117], v[118:119], v[88:89], v[116:117] op_sel:[1,1,0] op_sel_hi:[0,1,1] neg_lo:[1,0,0]
 v_pk_fma_f32 v[168:169], v[170:171], v[140:141], v[168:169] op_sel:[1,1,0] op_sel_hi:[0,1,1] neg_lo:[1,0,0]
 v_cvt_pk_bf16_f32 v122, v116, v117
 v_cvt_pk_bf16_f32 v123, v168, v169
 ds_write_b64 v5, v[122:123] offset:24816
 v_pk_mul_f32 v[118:119], v[116:117], v[88:89] op_sel_hi:[1,0]
 v_pk_mul_f32 v[170:171], v[168:169], v[140:141] op_sel_hi:[1,0]
 v_pk_fma_f32 v[118:119], v[116:117], v[88:89], v[118:119] op_sel:[1,1,0] op_sel_hi:[0,1,1] neg_lo:[1,0,0]
 v_pk_fma_f32 v[170:171], v[168:169], v[140:141], v[170:171] op_sel:[1,1,0] op_sel_hi:[0,1,1] neg_lo:[1,0,0]
 v_cvt_pk_bf16_f32 v124, v118, v119
 v_cvt_pk_bf16_f32 v125, v170, v171
 ds_write_b64 v5, v[124:125] offset:25344
 v_pk_mul_f32 v[116:117], v[118:119], v[88:89] op_sel_hi:[1,0]
 v_pk_mul_f32 v[168:169], v[170:171], v[140:141] op_sel_hi:[1,0]
 v_pk_fma_f32 v[116:117], v[118:119], v[88:89], v[116:117] op_sel:[1,1,0] op_sel_hi:[0,1,1] neg_lo:[1,0,0]
 v_pk_fma_f32 v[168:169], v[170:171], v[140:141], v[168:169] op_sel:[1,1,0] op_sel_hi:[0,1,1] neg_lo:[1,0,0]
 v_cvt_pk_bf16_f32 v126, v116, v117
 v_cvt_pk_bf16_f32 v127, v168, v169
 ds_write_b64 v5, v[126:127] offset:25872
 v_pk_mul_f32 v[118:119], v[116:117], v[88:89] op_sel_hi:[1,0]
 v_pk_mul_f32 v[170:171], v[168:169], v[140:141] op_sel_hi:[1,0]
 v_pk_fma_f32 v[118:119], v[116:117], v[88:89], v[118:119] op_sel:[1,1,0] op_sel_hi:[0,1,1] neg_lo:[1,0,0]
 v_pk_fma_f32 v[170:171], v[168:169], v[140:141], v[170:171] op_sel:[1,1,0] op_sel_hi:[0,1,1] neg_lo:[1,0,0]
 v_cvt_pk_bf16_f32 v120, v118, v119
 v_cvt_pk_bf16_f32 v121, v170, v171
 ds_write_b64 v5, v[120:121] offset:26400
 v_pk_mul_f32 v[116:117], v[118:119], v[88:89] op_sel_hi:[1,0]
 v_pk_mul_f32 v[168:169], v[170:171], v[140:141] op_sel_hi:[1,0]
 v_pk_fma_f32 v[116:117], v[118:119], v[88:89], v[116:117] op_sel:[1,1,0] op_sel_hi:[0,1,1] neg_lo:[1,0,0]
 v_pk_fma_f32 v[168:169], v[170:171], v[140:141], v[168:169] op_sel:[1,1,0] op_sel_hi:[0,1,1] neg_lo:[1,0,0]
 v_cvt_pk_bf16_f32 v122, v116, v117
 v_cvt_pk_bf16_f32 v123, v168, v169
 ds_write_b64 v5, v[122:123] offset:26928
 v_pk_mul_f32 v[118:119], v[116:117], v[88:89] op_sel_hi:[1,0]
 v_pk_mul_f32 v[170:171], v[168:169], v[140:141] op_sel_hi:[1,0]
 v_pk_fma_f32 v[118:119], v[116:117], v[88:89], v[118:119] op_sel:[1,1,0] op_sel_hi:[0,1,1] neg_lo:[1,0,0]
 v_pk_fma_f32 v[170:171], v[168:169], v[140:141], v[170:171] op_sel:[1,1,0] op_sel_hi:[0,1,1] neg_lo:[1,0,0]
 v_cvt_pk_bf16_f32 v124, v118, v119
 v_cvt_pk_bf16_f32 v125, v170, v171
 ds_write_b64 v5, v[124:125] offset:27456
 v_cvt_pk_bf16_f32 v126, v100, -v101
 v_cvt_pk_bf16_f32 v127, v152, -v153
 ds_write_b64 v5, v[126:127] offset:0
 v_pk_mul_f32 v[102:103], v[100:101], v[86:87] op_sel_hi:[1,0]
 v_pk_mul_f32 v[154:155], v[152:153], v[138:139] op_sel_hi:[1,0]
 v_pk_fma_f32 v[102:103], v[100:101], v[86:87], v[102:103] op_sel:[1,1,0] op_sel_hi:[0,1,1] neg_lo:[1,0,0]
 v_pk_fma_f32 v[154:155], v[152:153], v[138:139], v[154:155] op_sel:[1,1,0] op_sel_hi:[0,1,1] neg_lo:[1,0,0]
 v_cvt_pk_bf16_f32 v120, v102, -v103
 v_cvt_pk_bf16_f32 v121, v154, -v155
 ds_write_b64 v5, v[120:121] offset:528
 v_pk_mul_f32 v[104:105], v[102:103], v[86:87] op_sel_hi:[1,0]
 v_pk_mul_f32 v[156:157], v[154:155], v[138:139] op_sel_hi:[1,0]
 v_pk_fma_f32 v[104:105], v[102:103], v[86:87], v[104:105] op_sel:[1,1,0] op_sel_hi:[0,1,1] neg_lo:[1,0,0]
 v_pk_fma_f32 v[156:157], v[154:155], v[138:139], v[156:157] op_sel:[1,1,0] op_sel_hi:[0,1,1] neg_lo:[1,0,0]
 v_cvt_pk_bf16_f32 v122, v104, -v105
 v_cvt_pk_bf16_f32 v123, v156, -v157
 ds_write_b64 v5, v[122:123] offset:1056
 v_pk_mul_f32 v[106:107], v[104:105], v[86:87] op_sel_hi:[1,0]
 v_pk_mul_f32 v[158:159], v[156:157], v[138:139] op_sel_hi:[1,0]
 v_pk_fma_f32 v[106:107], v[104:105], v[86:87], v[106:107] op_sel:[1,1,0] op_sel_hi:[0,1,1] neg_lo:[1,0,0]
 v_pk_fma_f32 v[158:159], v[156:157], v[138:139], v[158:159] op_sel:[1,1,0] op_sel_hi:[0,1,1] neg_lo:[1,0,0]
 v_cvt_pk_bf16_f32 v124, v106, -v107
 v_cvt_pk_bf16_f32 v125, v158, -v159
 ds_write_b64 v5, v[124:125] offset:1584
 v_pk_mul_f32 v[108:109], v[106:107], v[86:87] op_sel_hi:[1,0]
 v_pk_mul_f32 v[160:161], v[158:159], v[138:139] op_sel_hi:[1,0]
 v_pk_fma_f32 v[108:109], v[106:107], v[86:87], v[108:109] op_sel:[1,1,0] op_sel_hi:[0,1,1] neg_lo:[1,0,0]
 v_pk_fma_f32 v[160:161], v[158:159], v[138:139], v[160:161] op_sel:[1,1,0] op_sel_hi:[0,1,1] neg_lo:[1,0,0]
 v_cvt_pk_bf16_f32 v126, v108, -v109
 v_cvt_pk_bf16_f32 v127, v160, -v161
 ds_write_b64 v5, v[126:127] offset:2112
 v_pk_mul_f32 v[110:111], v[108:109], v[86:87] op_sel_hi:[1,0]
 v_pk_mul_f32 v[162:163], v[160:161], v[138:139] op_sel_hi:[1,0]
 v_pk_fma_f32 v[110:111], v[108:109], v[86:87], v[110:111] op_sel:[1,1,0] op_sel_hi:[0,1,1] neg_lo:[1,0,0]
 v_pk_fma_f32 v[162:163], v[160:161], v[138:139], v[162:163] op_sel:[1,1,0] op_sel_hi:[0,1,1] neg_lo:[1,0,0]
 v_cvt_pk_bf16_f32 v120, v110, -v111
 v_cvt_pk_bf16_f32 v121, v162, -v163
 ds_write_b64 v5, v[120:121] offset:2640
 v_pk_mul_f32 v[112:113], v[110:111], v[86:87] op_sel_hi:[1,0]
 v_pk_mul_f32 v[164:165], v[162:163], v[138:139] op_sel_hi:[1,0]
 v_pk_fma_f32 v[112:113], v[110:111], v[86:87], v[112:113] op_sel:[1,1,0] op_sel_hi:[0,1,1] neg_lo:[1,0,0]
 v_pk_fma_f32 v[164:165], v[162:163], v[138:139], v[164:165] op_sel:[1,1,0] op_sel_hi:[0,1,1] neg_lo:[1,0,0]
 v_cvt_pk_bf16_f32 v122, v112, -v113
 v_cvt_pk_bf16_f32 v123, v164, -v165
 ds_write_b64 v5, v[122:123] offset:3168
 v_pk_mul_f32 v[114:115], v[112:113], v[86:87] op_sel_hi:[1,0]
 v_pk_mul_f32 v[166:167], v[164:165], v[138:139] op_sel_hi:[1,0]
 v_pk_fma_f32 v[114:115], v[112:113], v[86:87], v[114:115] op_sel:[1,1,0] op_sel_hi:[0,1,1] neg_lo:[1,0,0]
 v_pk_fma_f32 v[166:167], v[164:165], v[138:139], v[166:167] op_sel:[1,1,0] op_sel_hi:[0,1,1] neg_lo:[1,0,0]
 v_cvt_pk_bf16_f32 v124, v114, -v115
 v_cvt_pk_bf16_f32 v125, v166, -v167
 ds_write_b64 v5, v[124:125] offset:3696
 v_pk_mul_f32 v[116:117], v[100:101], v[90:91] op_sel_hi:[1,0]
 v_pk_mul_f32 v[168:169], v[152:153], v[142:143] op_sel_hi:[1,0]
 v_pk_fma_f32 v[116:117], v[100:101], v[90:91], v[116:117] op_sel:[1,1,0] op_sel_hi:[0,1,1] neg_lo:[1,0,0]
 v_pk_fma_f32 v[168:169], v[152:153], v[142:143], v[168:169] op_sel:[1,1,0] op_sel_hi:[0,1,1] neg_lo:[1,0,0]
 v_cvt_pk_bf16_f32 v126, v116, -v117
 v_cvt_pk_bf16_f32 v127, v168, -v169
 ds_write_b64 v5, v[126:127] offset:4224
 v_pk_mul_f32 v[118:119], v[104:105], v[90:91] op_sel_hi:[1,0]
 v_pk_mul_f32 v[170:171], v[156:157], v[142:143] op_sel_hi:[1,0]
 v_pk_fma_f32 v[118:119], v[104:105], v[90:91], v[118:119] op_sel:[1,1,0] op_sel_hi:[0,1,1] neg_lo:[1,0,0]
 v_pk_fma_f32 v[170:171], v[156:157], v[142:143], v[170:171] op_sel:[1,1,0] op_sel_hi:[0,1,1] neg_lo:[1,0,0]
 v_cvt_pk_bf16_f32 v120, v118, -v119
 v_cvt_pk_bf16_f32 v121, v170, -v171
 ds_write_b64 v5, v[120:121] offset:4752
 v_pk_mul_f32 v[116:117], v[108:109], v[90:91] op_sel_hi:[1,0]
 v_pk_mul_f32 v[168:169], v[160:161], v[142:143] op_sel_hi:[1,0]
 v_pk_fma_f32 v[116:117], v[108:109], v[90:91], v[116:117] op_sel:[1,1,0] op_sel_hi:[0,1,1] neg_lo:[1,0,0]
 v_pk_fma_f32 v[168:169], v[160:161], v[142:143], v[168:169] op_sel:[1,1,0] op_sel_hi:[0,1,1] neg_lo:[1,0,0]
 v_cvt_pk_bf16_f32 v122, v116, -v117
 v_cvt_pk_bf16_f32 v123, v168, -v169
 ds_write_b64 v5, v[122:123] offset:5280
 v_pk_mul_f32 v[118:119], v[112:113], v[90:91] op_sel_hi:[1,0]
 v_pk_mul_f32 v[170:171], v[164:165], v[142:143] op_sel_hi:[1,0]
 v_pk_fma_f32 v[118:119], v[112:113], v[90:91], v[118:119] op_sel:[1,1,0] op_sel_hi:[0,1,1] neg_lo:[1,0,0]
 v_pk_fma_f32 v[170:171], v[164:165], v[142:143], v[170:171] op_sel:[1,1,0] op_sel_hi:[0,1,1] neg_lo:[1,0,0]
 v_cvt_pk_bf16_f32 v124, v118, -v119
 v_cvt_pk_bf16_f32 v125, v170, -v171
 ds_write_b64 v5, v[124:125] offset:5808
 v_pk_mul_f32 v[92:93], v[90:91], v[90:91] op_sel_hi:[1,0]
 v_pk_mul_f32 v[144:145], v[142:143], v[142:143] op_sel_hi:[1,0]
 v_pk_fma_f32 v[92:93], v[90:91], v[90:91], v[92:93] op_sel:[1,1,0] op_sel_hi:[0,1,1] neg_lo:[1,0,0]
 v_pk_fma_f32 v[144:145], v[142:143], v[142:143], v[144:145] op_sel:[1,1,0] op_sel_hi:[0,1,1] neg_lo:[1,0,0]
 v_pk_mul_f32 v[116:117], v[100:101], v[92:93] op_sel_hi:[1,0]
 v_pk_mul_f32 v[168:169], v[152:153], v[144:145] op_sel_hi:[1,0]
 v_pk_fma_f32 v[116:117], v[100:101], v[92:93], v[116:117] op_sel:[1,1,0] op_sel_hi:[0,1,1] neg_lo:[1,0,0]
 v_pk_fma_f32 v[168:169], v[152:153], v[144:145], v[168:169] op_sel:[1,1,0] op_sel_hi:[0,1,1] neg_lo:[1,0,0]
 v_cvt_pk_bf16_f32 v126, v116, -v117
 v_cvt_pk_bf16_f32 v127, v168, -v169
 ds_write_b64 v5, v[126:127] offset:6336
 v_pk_mul_f32 v[118:119], v[108:109], v[92:93] op_sel_hi:[1,0]
 v_pk_mul_f32 v[170:171], v[160:161], v[144:145] op_sel_hi:[1,0]
 v_pk_fma_f32 v[118:119], v[108:109], v[92:93], v[118:119] op_sel:[1,1,0] op_sel_hi:[0,1,1] neg_lo:[1,0,0]
 v_pk_fma_f32 v[170:171], v[160:161], v[144:145], v[170:171] op_sel:[1,1,0] op_sel_hi:[0,1,1] neg_lo:[1,0,0]
 v_cvt_pk_bf16_f32 v120, v118, -v119
 v_cvt_pk_bf16_f32 v121, v170, -v171
 ds_write_b64 v5, v[120:121] offset:6864
 v_pk_mul_f32 v[94:95], v[92:93], v[90:91] op_sel_hi:[1,0]
 v_pk_mul_f32 v[146:147], v[144:145], v[142:143] op_sel_hi:[1,0]
 v_pk_fma_f32 v[94:95], v[92:93], v[90:91], v[94:95] op_sel:[1,1,0] op_sel_hi:[0,1,1] neg_lo:[1,0,0]
 v_pk_fma_f32 v[146:147], v[144:145], v[142:143], v[146:147] op_sel:[1,1,0] op_sel_hi:[0,1,1] neg_lo:[1,0,0]
 v_pk_mul_f32 v[116:117], v[100:101], v[94:95] op_sel_hi:[1,0]
 v_pk_mul_f32 v[168:169], v[152:153], v[146:147] op_sel_hi:[1,0]
 v_pk_fma_f32 v[116:117], v[100:101], v[94:95], v[116:117] op_sel:[1,1,0] op_sel_hi:[0,1,1] neg_lo:[1,0,0]
 v_pk_fma_f32 v[168:169], v[152:153], v[146:147], v[168:169] op_sel:[1,1,0] op_sel_hi:[0,1,1] neg_lo:[1,0,0]
 v_cvt_pk_bf16_f32 v122, v116, -v117
 v_cvt_pk_bf16_f32 v123, v168, -v169
 ds_write_b64 v5, v[122:123] offset:7392
 v_pk_mul_f32 v[118:119], v[108:109], v[94:95] op_sel_hi:[1,0]
 v_pk_mul_f32 v[170:171], v[160:161], v[146:147] op_sel_hi:[1,0]
 v_pk_fma_f32 v[118:119], v[108:109], v[94:95], v[118:119] op_sel:[1,1,0] op_sel_hi:[0,1,1] neg_lo:[1,0,0]
 v_pk_fma_f32 v[170:171], v[160:161], v[146:147], v[170:171] op_sel:[1,1,0] op_sel_hi:[0,1,1] neg_lo:[1,0,0]
 v_cvt_pk_bf16_f32 v124, v118, -v119
 v_cvt_pk_bf16_f32 v125, v170, -v171
 ds_write_b64 v5, v[124:125] offset:7920
 v_pk_mul_f32 v[92:93], v[94:95], v[90:91] op_sel_hi:[1,0]
 v_pk_mul_f32 v[144:145], v[146:147], v[142:143] op_sel_hi:[1,0]
 v_pk_fma_f32 v[92:93], v[94:95], v[90:91], v[92:93] op_sel:[1,1,0] op_sel_hi:[0,1,1] neg_lo:[1,0,0]
 v_pk_fma_f32 v[144:145], v[146:147], v[142:143], v[144:145] op_sel:[1,1,0] op_sel_hi:[0,1,1] neg_lo:[1,0,0]
 v_pk_mul_f32 v[116:117], v[100:101], v[92:93] op_sel_hi:[1,0]
 v_pk_mul_f32 v[168:169], v[152:153], v[144:145] op_sel_hi:[1,0]
 v_pk_fma_f32 v[116:117], v[100:101], v[92:93], v[116:117] op_sel:[1,1,0] op_sel_hi:[0,1,1] neg_lo:[1,0,0]
 v_pk_fma_f32 v[168:169], v[152:153], v[144:145], v[168:169] op_sel:[1,1,0] op_sel_hi:[0,1,1] neg_lo:[1,0,0]
 v_cvt_pk_bf16_f32 v126, v116, -v117
 v_cvt_pk_bf16_f32 v127, v168, -v169
 ds_write_b64 v5, v[126:127] offset:8448
 v_pk_mul_f32 v[94:95], v[92:93], v[90:91] op_sel_hi:[1,0]
 v_pk_mul_f32 v[146:147], v[144:145], v[142:143] op_sel_hi:[1,0]
 v_pk_fma_f32 v[94:95], v[92:93], v[90:91], v[94:95] op_sel:[1,1,0] op_sel_hi:[0,1,1] neg_lo:[1,0,0]
 v_pk_fma_f32 v[146:147], v[144:145], v[142:143], v[146:147] op_sel:[1,1,0] op_sel_hi:[0,1,1] neg_lo:[1,0,0]
 v_pk_mul_f32 v[116:117], v[100:101], v[94:95] op_sel_hi:[1,0]
 v_pk_mul_f32 v[168:169], v[152:153], v[146:147] op_sel_hi:[1,0]
 v_pk_fma_f32 v[116:117], v[100:101], v[94:95], v[116:117] op_sel:[1,1,0] op_sel_hi:[0,1,1] neg_lo:[1,0,0]
 v_pk_fma_f32 v[168:169], v[152:153], v[146:147], v[168:169] op_sel:[1,1,0] op_sel_hi:[0,1,1] neg_lo:[1,0,0]
 v_cvt_pk_bf16_f32 v120, v116, -v117
 v_cvt_pk_bf16_f32 v121, v168, -v169
 ds_write_b64 v5, v[120:121] offset:8976
 v_pk_mul_f32 v[92:93], v[94:95], v[90:91] op_sel_hi:[1,0]
 v_pk_mul_f32 v[144:145], v[146:147], v[142:143] op_sel_hi:[1,0]
 v_pk_fma_f32 v[92:93], v[94:95], v[90:91], v[92:93] op_sel:[1,1,0] op_sel_hi:[0,1,1] neg_lo:[1,0,0]
 v_pk_fma_f32 v[144:145], v[146:147], v[142:143], v[144:145] op_sel:[1,1,0] op_sel_hi:[0,1,1] neg_lo:[1,0,0]
 v_pk_mul_f32 v[116:117], v[100:101], v[92:93] op_sel_hi:[1,0]
 v_pk_mul_f32 v[168:169], v[152:153], v[144:145] op_sel_hi:[1,0]
 v_pk_fma_f32 v[116:117], v[100:101], v[92:93], v[116:117] op_sel:[1,1,0] op_sel_hi:[0,1,1] neg_lo:[1,0,0]
 v_pk_fma_f32 v[168:169], v[152:153], v[144:145], v[168:169] op_sel:[1,1,0] op_sel_hi:[0,1,1] neg_lo:[1,0,0]
 v_cvt_pk_bf16_f32 v122, v116, -v117
 v_cvt_pk_bf16_f32 v123, v168, -v169
 ds_write_b64 v5, v[122:123] offset:9504
 v_pk_mul_f32 v[94:95], v[92:93], v[90:91] op_sel_hi:[1,0]
 v_pk_mul_f32 v[146:147], v[144:145], v[142:143] op_sel_hi:[1,0]
 v_pk_fma_f32 v[94:95], v[92:93], v[90:91], v[94:95] op_sel:[1,1,0] op_sel_hi:[0,1,1] neg_lo:[1,0,0]
 v_pk_fma_f32 v[146:147], v[144:145], v[142:143], v[146:147] op_sel:[1,1,0] op_sel_hi:[0,1,1] neg_lo:[1,0,0]
 v_pk_mul_f32 v[116:117], v[100:101], v[94:95] op_sel_hi:[1,0]
 v_pk_mul_f32 v[168:169], v[152:153], v[146:147] op_sel_hi:[1,0]
 v_pk_fma_f32 v[116:117], v[100:101], v[94:95], v[116:117] op_sel:[1,1,0] op_sel_hi:[0,1,1] neg_lo:[1,0,0]
 v_pk_fma_f32 v[168:169], v[152:153], v[146:147], v[168:169] op_sel:[1,1,0] op_sel_hi:[0,1,1] neg_lo:[1,0,0]
 v_cvt_pk_bf16_f32 v124, v116, -v117
 v_cvt_pk_bf16_f32 v125, v168, -v169
 ds_write_b64 v5, v[124:125] offset:10032
 v_pk_mul_f32 v[92:93], v[94:95], v[90:91] op_sel_hi:[1,0]
 v_pk_mul_f32 v[144:145], v[146:147], v[142:143] op_sel_hi:[1,0]
 v_pk_fma_f32 v[92:93], v[94:95], v[90:91], v[92:93] op_sel:[1,1,0] op_sel_hi:[0,1,1] neg_lo:[1,0,0]
 v_pk_fma_f32 v[144:145], v[146:147], v[142:143], v[144:145] op_sel:[1,1,0] op_sel_hi:[0,1,1] neg_lo:[1,0,0]
 v_pk_mul_f32 v[116:117], v[100:101], v[92:93] op_sel_hi:[1,0]
 v_pk_mul_f32 v[168:169], v[152:153], v[144:145] op_sel_hi:[1,0]
 v_pk_fma_f32 v[116:117], v[100:101], v[92:93], v[116:117] op_sel:[1,1,0] op_sel_hi:[0,1,1] neg_lo:[1,0,0]
 v_pk_fma_f32 v[168:169], v[152:153], v[144:145], v[168:169] op_sel:[1,1,0] op_sel_hi:[0,1,1] neg_lo:[1,0,0]
 v_cvt_pk_bf16_f32 v126, v116, -v117
 v_cvt_pk_bf16_f32 v127, v168, -v169
 ds_write_b64 v5, v[126:127] offset:10560
 s_waitcnt lgkmcnt(0)
 ds_read_b128 v[176:179], v7 offset:0
 ds_read_b128 v[160:163], v7 offset:11088
 ds_read_b128 v[180:183], v7 offset:32
 ds_read_b128 v[164:167], v7 offset:11120
 ds_read_b128 v[184:187], v7 offset:64
 ds_read_b128 v[168:171], v7 offset:11152
 ds_read_b128 v[188:191], v7 offset:96
 ds_read_b128 v[172:175], v7 offset:11184
 s_waitcnt lgkmcnt(6)
 v_mfma_f32_32x32x16_bf16 v[128:143], v[176:179], v[160:163], 0
 v_perm_b32 v84, v194, v192, s69
 ds_read_b128 v[176:179], v7 offset:128
 ds_read_b128 v[160:163], v7 offset:11216
 s_waitcnt lgkmcnt(6)
 v_mfma_f32_32x32x16_bf16 v[128:143], v[180:183], v[164:167], v[128:143]
 v_perm_b32 v85, v198, v196, s69
 ds_read_b128 v[180:183], v7 offset:160
 ds_read_b128 v[164:167], v7 offset:11248
 s_waitcnt lgkmcnt(6)
 v_mfma_f32_32x32x16_bf16 v[128:143], v[184:187], v[168:171], v[128:143]
 v_perm_b32 v86, v202, v200, s69
 ds_read_b128 v[184:187], v7 offset:192
 ds_read_b128 v[168:171], v7 offset:11280
 s_waitcnt lgkmcnt(6)
 v_mfma_f32_32x32x16_bf16 v[128:143], v[188:191], v[172:175], v[128:143]
 v_perm_b32 v87, v206, v204, s69
 ds_read_b128 v[188:191], v7 offset:224
 ds_read_b128 v[172:175], v7 offset:11312
 s_waitcnt lgkmcnt(6)
 v_mfma_f32_32x32x16_bf16 v[128:143], v[176:179], v[160:163], v[128:143]
 v_perm_b32 v88, v210, v208, s69
 ds_read_b128 v[176:179], v7 offset:256
 ds_read_b128 v[160:163], v7 offset:11344
 s_waitcnt lgkmcnt(6)
 v_mfma_f32_32x32x16_bf16 v[128:143], v[180:183], v[164:167], v[128:143]
 v_perm_b32 v89, v214, v212, s69
 ds_read_b128 v[180:183], v7 offset:288
 ds_read_b128 v[164:167], v7 offset:11376
 s_waitcnt lgkmcnt(6)
 v_mfma_f32_32x32x16_bf16 v[128:143], v[184:187], v[168:171], v[128:143]
 v_perm_b32 v90, v218, v216, s69
 ds_read_b128 v[184:187], v7 offset:320
 ds_read_b128 v[168:171], v7 offset:11408
 s_waitcnt lgkmcnt(6)
 v_mfma_f32_32x32x16_bf16 v[128:143], v[188:191], v[172:175], v[128:143]
 v_perm_b32 v91, v222, v220, s69
 ds_read_b128 v[188:191], v7 offset:352
 ds_read_b128 v[172:175], v7 offset:11440
 s_waitcnt lgkmcnt(6)
 v_mfma_f32_32x32x16_bf16 v[128:143], v[176:179], v[160:163], v[128:143]
 v_perm_b32 v92, v226, v224, s69
 ds_read_b128 v[176:179], v7 offset:384
 ds_read_b128 v[160:163], v7 offset:11472
 s_waitcnt lgkmcnt(6)
 v_mfma_f32_32x32x16_bf16 v[128:143], v[180:183], v[164:167], v[128:143]
 v_perm_b32 v93, v230, v228, s69
 ds_read_b128 v[180:183], v7 offset:416
 ds_read_b128 v[164:167], v7 offset:11504
 s_waitcnt lgkmcnt(6)
 v_mfma_f32_32x32x16_bf16 v[128:143], v[184:187], v[168:171], v[128:143]
 v_perm_b32 v94, v234, v232, s69
 ds_read_b128 v[184:187], v7 offset:448
 ds_read_b128 v[168:171], v7 offset:11536
 s_waitcnt lgkmcnt(6)
 v_mfma_f32_32x32x16_bf16 v[128:143], v[188:191], v[172:175], v[128:143]
 v_perm_b32 v95, v238, v236, s69
 ds_read_b128 v[188:191], v7 offset:480
 ds_read_b128 v[172:175], v7 offset:11568
 s_waitcnt lgkmcnt(6)
 v_mfma_f32_32x32x16_bf16 v[128:143], v[176:179], v[160:163], v[128:143]
 v_perm_b32 v96, v242, v240, s69
 s_waitcnt lgkmcnt(4)
 v_mfma_f32_32x32x16_bf16 v[128:143], v[180:183], v[164:167], v[128:143]
 v_perm_b32 v97, v246, v244, s69
 s_waitcnt lgkmcnt(2)
 v_mfma_f32_32x32x16_bf16 v[128:143], v[184:187], v[168:171], v[128:143]
 v_perm_b32 v98, v250, v248, s69
 s_waitcnt lgkmcnt(0)
 v_mfma_f32_32x32x16_bf16 v[128:143], v[188:191], v[172:175], v[128:143]
 v_perm_b32 v99, v254, v252, s69
 ds_write_b64 v14, v[84:85] offset:30544
 ds_write_b64 v14, v[86:87] offset:30560
 ds_write_b64 v14, v[88:89] offset:30576
 ds_write_b64 v14, v[90:91] offset:30592
 ds_write_b64 v14, v[92:93] offset:33104
 ds_write_b64 v14, v[94:95] offset:33120
 ds_write_b64 v14, v[96:97] offset:33136
 ds_write_b64 v14, v[98:99] offset:33152
 s_nop 1
 ds_write_b32 v8, v128 offset:35664
 ds_write_b32 v8, v129 offset:35668
 ds_write_b32 v8, v130 offset:35672
 ds_write_b32 v8, v131 offset:35676
 s_mov_b64 exec, 0xffffffff
 ds_write_b32 v9, v132 offset:36720
 ds_write_b32 v10, v136 offset:37776
 ds_write_b32 v9, v133 offset:36724
 ds_write_b32 v10, v137 offset:37908
 ds_write_b32 v9, v134 offset:36728
 ds_write_b32 v10, v138 offset:38040
 ds_write_b32 v9, v135 offset:36732
 ds_write_b32 v10, v139 offset:38172
 s_not_b64 exec, exec
 ds_write_b32 v9, v132 offset:37248
 ds_write_b32 v9, v133 offset:37252
 ds_write_b32 v9, v134 offset:37512
 ds_write_b32 v9, v135 offset:37516
 ds_write_b32 v10, v136 offset:38304
 s_mov_b64 exec, -1
 v_mov_b32 v2, 0
 v_lshrrev_b32 v3, 4, v0
 v_mul_u32_u24 v3, 4096, v3
 v_add_u32 v3, v3, v6
 ds_write_b32 v3, v2 offset:4096
 s_waitcnt lgkmcnt(0)
 ds_read_b32 v84, v40
 ds_read_b32 v85, v41
 ds_read_b32 v86, v42
 ds_read_b32 v87, v43
 ds_read_b32 v88, v44
 ds_read_b32 v89, v45
 ds_read_b32 v90, v46
 ds_read_b32 v91, v47
 ds_read_b32 v92, v48
 ds_read_b32 v93, v49
 ds_read_b32 v94, v50
 s_lshl_b32 s61, s66, 16
 v_perm_b32 v128, v192, v192, s68
 v_mul_f32 v128, s61, v128
 v_perm_b32 v129, v194, v194, s68
 v_mul_f32 v129, s61, v129
 v_perm_b32 v130, v196, v196, s68
 v_mul_f32 v130, s61, v130
 v_perm_b32 v131, v198, v198, s68
 v_mul_f32 v131, s61, v131
 v_perm_b32 v132, v200, v200, s68
 v_mul_f32 v132, s61, v132
 v_perm_b32 v133, v202, v202, s68
 v_mul_f32 v133, s61, v133
 v_perm_b32 v134, v204, v204, s68
 v_mul_f32 v134, s61, v134
 v_perm_b32 v135, v206, v206, s68
 v_mul_f32 v135, s61, v135
 s_waitcnt lgkmcnt(0)
 ds_read_b32 v95, v51
 ds_read_b32 v96, v52
 ds_read_b32 v97, v53
 ds_read_b32 v98, v54
 ds_read_b32 v99, v55
 ds_read_b32 v100, v56
 ds_read_b32 v101, v57
 ds_read_b32 v102, v58
 ds_read_b32 v103, v59
 ds_read_b32 v104, v60
 ds_read_b32 v105, v61
 v_cvt_pk_bf16_f32 v160, v87, v88
 v_cvt_pk_bf16_f32 v161, v89, v90
 v_cvt_pk_bf16_f32 v162, v91, v92
 v_cvt_pk_bf16_f32 v163, v93, v94
 ds_write_b128 v11, v[160:163] offset:0
 v_cvt_pk_bf16_f32 v164, v86, v87
 v_cvt_pk_bf16_f32 v165, v88, v89
 v_cvt_pk_bf16_f32 v166, v90, v91
 v_cvt_pk_bf16_f32 v167, v92, v93
 ds_write_b128 v11, v[164:167] offset:4160
 v_cvt_pk_bf16_f32 v168, v85, v86
 v_cvt_pk_bf16_f32 v169, v87, v88
 v_cvt_pk_bf16_f32 v170, v89, v90
 v_cvt_pk_bf16_f32 v171, v91, v92
 ds_write_b128 v11, v[168:171] offset:8320
 v_cvt_pk_bf16_f32 v172, v84, v85
 v_cvt_pk_bf16_f32 v173, v86, v87
 v_cvt_pk_bf16_f32 v174, v88, v89
 v_cvt_pk_bf16_f32 v175, v90, v91
 ds_write_b128 v11, v[172:175] offset:12480
 v_perm_b32 v136, v208, v208, s68
 v_mul_f32 v136, s61, v136
 v_perm_b32 v137, v210, v210, s68
 v_mul_f32 v137, s61, v137
 v_perm_b32 v138, v212, v212, s68
 v_mul_f32 v138, s61, v138
 v_perm_b32 v139, v214, v214, s68
 v_mul_f32 v139, s61, v139
 v_perm_b32 v140, v216, v216, s68
 v_mul_f32 v140, s61, v140
 v_perm_b32 v141, v218, v218, s68
 v_mul_f32 v141, s61, v141
 v_perm_b32 v142, v220, v220, s68
 v_mul_f32 v142, s61, v142
 v_perm_b32 v143, v222, v222, s68
 v_mul_f32 v143, s61, v143
 s_waitcnt lgkmcnt(4)
 ds_read_b32 v106, v62
 ds_read_b32 v107, v63
 ds_read_b32 v108, v64
 ds_read_b32 v109, v65
 ds_read_b32 v110, v66
 ds_read_b32 v111, v67
 ds_read_b32 v112, v68
 ds_read_b32 v113, v69
 ds_read_b32 v114, v70
 ds_read_b32 v115, v71
 ds_read_b32 v116, v72
 v_cvt_pk_bf16_f32 v176, v98, v99
 v_cvt_pk_bf16_f32 v177, v100, v101
 v_cvt_pk_bf16_f32 v178, v102, v103
 v_cvt_pk_bf16_f32 v179, v104, v105
 s_waitcnt lgkmcnt(11)
 ds_write_b128 v11, v[176:179] offset:1024
 v_cvt_pk_bf16_f32 v180, v97, v98
 v_cvt_pk_bf16_f32 v181, v99, v100
 v_cvt_pk_bf16_f32 v182, v101, v102
 v_cvt_pk_bf16_f32 v183, v103, v104
 ds_write_b128 v11, v[180:183] offset:5184
 v_cvt_pk_bf16_f32 v184, v96, v97
 v_cvt_pk_bf16_f32 v185, v98, v99
 v_cvt_pk_bf16_f32 v186, v100, v101
 v_cvt_pk_bf16_f32 v187, v102, v103
 ds_write_b128 v11, v[184:187] offset:9344
 v_cvt_pk_bf16_f32 v188, v95, v96
 v_cvt_pk_bf16_f32 v189, v97, v98
 v_cvt_pk_bf16_f32 v190, v99, v100
 v_cvt_pk_bf16_f32 v191, v101, v102
 ds_write_b128 v11, v[188:191] offset:13504
 v_perm_b32 v144, v224, v224, s68
 v_mul_f32 v144, s61, v144
 v_perm_b32 v145, v226, v226, s68
 v_mul_f32 v145, s61, v145
 v_perm_b32 v146, v228, v228, s68
 v_mul_f32 v146, s61, v146
 v_perm_b32 v147, v230, v230, s68
 v_mul_f32 v147, s61, v147
 v_perm_b32 v148, v232, v232, s68
 v_mul_f32 v148, s61, v148
 v_perm_b32 v149, v234, v234, s68
 v_mul_f32 v149, s61, v149
 v_perm_b32 v150, v236, v236, s68
 v_mul_f32 v150, s61, v150
 v_perm_b32 v151, v238, v238, s68
 v_mul_f32 v151, s61, v151
 s_waitcnt lgkmcnt(4)
 ds_read_b32 v117, v73
 ds_read_b32 v118, v74
 ds_read_b32 v119, v75
 ds_read_b32 v120, v76
 ds_read_b32 v121, v77
 ds_read_b32 v122, v78
 ds_read_b32 v123, v79
 ds_read_b32 v124, v80
 ds_read_b32 v125, v81
 ds_read_b32 v126, v82
 ds_read_b32 v127, v83
 v_cvt_pk_bf16_f32 v160, v109, v110
 v_cvt_pk_bf16_f32 v161, v111, v112
 v_cvt_pk_bf16_f32 v162, v113, v114
 v_cvt_pk_bf16_f32 v163, v115, v116
 s_waitcnt lgkmcnt(11)
 ds_write_b128 v11, v[160:163] offset:2048
 v_cvt_pk_bf16_f32 v164, v108, v109
 v_cvt_pk_bf16_f32 v165, v110, v111
 v_cvt_pk_bf16_f32 v166, v112, v113
 v_cvt_pk_bf16_f32 v167, v114, v115
 ds_write_b128 v11, v[164:167] offset:6208
 v_cvt_pk_bf16_f32 v168, v107, v108
 v_cvt_pk_bf16_f32 v169, v109, v110
 v_cvt_pk_bf16_f32 v170, v111, v112
 v_cvt_pk_bf16_f32 v171, v113, v114
 ds_write_b128 v11, v[168:171] offset:10368
 v_cvt_pk_bf16_f32 v172, v106, v107
 v_cvt_pk_bf16_f32 v173, v108, v109
 v_cvt_pk_bf16_f32 v174, v110, v111
 v_cvt_pk_bf16_f32 v175, v112, v113
 ds_write_b128 v11, v[172:175] offset:14528
 v_perm_b32 v152, v240, v240, s68
 v_mul_f32 v152, s61, v152
 v_perm_b32 v153, v242, v242, s68
 v_mul_f32 v153, s61, v153
 v_perm_b32 v154, v244, v244, s68
 v_mul_f32 v154, s61, v154
 v_perm_b32 v155, v246, v246, s68
 v_mul_f32 v155, s61, v155
 v_perm_b32 v156, v248, v248, s68
 v_mul_f32 v156, s61, v156
 v_perm_b32 v157, v250, v250, s68
 v_mul_f32 v157, s61, v157
 v_perm_b32 v158, v252, v252, s68
 v_mul_f32 v158, s61, v158
 v_perm_b32 v159, v254, v254, s68
 v_mul_f32 v159, s61, v159
 s_waitcnt lgkmcnt(4)
 v_cvt_pk_bf16_f32 v176, v120, v121
 v_cvt_pk_bf16_f32 v177, v122, v123
 v_cvt_pk_bf16_f32 v178, v124, v125
 v_cvt_pk_bf16_f32 v179, v126, v127
 s_waitcnt lgkmcnt(11)
 ds_write_b128 v11, v[176:179] offset:3072
 v_cvt_pk_bf16_f32 v180, v119, v120
 v_cvt_pk_bf16_f32 v181, v121, v122
 v_cvt_pk_bf16_f32 v182, v123, v124
 v_cvt_pk_bf16_f32 v183, v125, v126
 ds_write_b128 v11, v[180:183] offset:7232
 v_cvt_pk_bf16_f32 v184, v118, v119
 v_cvt_pk_bf16_f32 v185, v120, v121
 v_cvt_pk_bf16_f32 v186, v122, v123
 v_cvt_pk_bf16_f32 v187, v124, v125
 ds_write_b128 v11, v[184:187] offset:11392
 v_cvt_pk_bf16_f32 v188, v117, v118
 v_cvt_pk_bf16_f32 v189, v119, v120
 v_cvt_pk_bf16_f32 v190, v121, v122
 v_cvt_pk_bf16_f32 v191, v123, v124
 ds_write_b128 v11, v[188:191] offset:15552
 s_waitcnt lgkmcnt(0)
 ds_read_b128 v[160:163], v13 offset:33024
 ds_read_b64 a[0:1], v12 offset:4032
 ds_read_b64 a[2:3], v12 offset:4040
 ds_read_b128 v[164:167], v13 offset:33056
 ds_read_b64 a[4:5], v12 offset:4064
 ds_read_b64 a[6:7], v12 offset:4072
 ds_read_b128 v[168:171], v13 offset:32944
 ds_read_b64 a[8:9], v12 offset:3968
 ds_read_b64 a[10:11], v12 offset:3976
 ds_read_b128 v[172:175], v13 offset:32976
 ds_read_b64 a[12:13], v12 offset:4000
 ds_read_b64 a[14:15], v12 offset:4008
 s_waitcnt lgkmcnt(9)
 v_mfma_f32_32x32x16_bf16 v[144:159], a[0:3], v[160:163], v[144:159]
 ds_read_b128 v[160:163], v13 offset:32864
 ds_read_b64 a[16:17], v12 offset:3904
 ds_read_b64 a[18:19], v12 offset:3912
 s_waitcnt lgkmcnt(9)
 v_mfma_f32_32x32x16_bf16 v[144:159], a[4:7], v[164:167], v[144:159]
 ds_read_b128 v[164:167], v13 offset:32896
 ds_read_b64 a[20:21], v12 offset:3936
 ds_read_b64 a[22:23], v12 offset:3944
 s_waitcnt lgkmcnt(9)
 v_mfma_f32_32x32x16_bf16 v[144:159], a[8:11], v[168:171], v[144:159]
 ds_read_b128 v[168:171], v13 offset:32784
 ds_read_b64 a[24:25], v12 offset:3840
 ds_read_b64 a[26:27], v12 offset:3848
 s_waitcnt lgkmcnt(9)
 v_mfma_f32_32x32x16_bf16 v[144:159], a[12:15], v[172:175], v[144:159]
 ds_read_b128 v[172:175], v13 offset:32816
 ds_read_b64 a[28:29], v12 offset:3872
 ds_read_b64 a[30:31], v12 offset:3880
 s_waitcnt lgkmcnt(9)
 v_mfma_f32_32x32x16_bf16 v[144:159], a[16:19], v[160:163], v[144:159]
 ds_read_b128 v[160:163], v13 offset:32704
 ds_read_b64 a[32:33], v12 offset:3776
 ds_read_b64 a[34:35], v12 offset:3784
 s_waitcnt lgkmcnt(9)
 v_mfma_f32_32x32x16_bf16 v[144:159], a[20:23], v[164:167], v[144:159]
 ds_read_b128 v[164:167], v13 offset:32736
 ds_read_b64 a[36:37], v12 offset:3808
 ds_read_b64 a[38:39], v12 offset:3816
 s_waitcnt lgkmcnt(9)
 v_mfma_f32_32x32x16_bf16 v[144:159], a[24:27], v[168:171], v[144:159]
 ds_read_b128 v[168:171], v13 offset:32624
 ds_read_b64 a[40:41], v12 offset:3712
 ds_read_b64 a[42:43], v12 offset:3720
 s_waitcnt lgkmcnt(9)
 v_mfma_f32_32x32x16_bf16 v[144:159], a[28:31], v[172:175], v[144:159]
 ds_read_b128 v[172:175], v13 offset:32656
 ds_read_b64 a[44:45], v12 offset:3744
 ds_read_b64 a[46:47], v12 offset:3752
 s_waitcnt lgkmcnt(9)
 v_mfma_f32_32x32x16_bf16 v[144:159], a[32:35], v[160:163], v[144:159]
 ds_read_b128 v[160:163], v13 offset:32544
 ds_read_b64 a[48:49], v12 offset:3648
 ds_read_b64 a[50:51], v12 offset:3656
 s_waitcnt lgkmcnt(9)
 v_mfma_f32_32x32x16_bf16 v[144:159], a[36:39], v[164:167], v[144:159]
 ds_read_b128 v[164:167], v13 offset:32576
 ds_read_b64 a[52:53], v12 offset:3680
 ds_read_b64 a[54:55], v12 offset:3688
 s_waitcnt lgkmcnt(9)
 v_mfma_f32_32x32x16_bf16 v[144:159], a[40:43], v[168:171], v[144:159]
 ds_read_b128 v[168:171], v13 offset:32464
 ds_read_b64 a[56:57], v12 offset:3584
 ds_read_b64 a[58:59], v12 offset:3592
 s_waitcnt lgkmcnt(9)
 v_mfma_f32_32x32x16_bf16 v[144:159], a[44:47], v[172:175], v[144:159]
 ds_read_b128 v[172:175], v13 offset:32496
 ds_read_b64 a[60:61], v12 offset:3616
 ds_read_b64 a[62:63], v12 offset:3624
 s_waitcnt lgkmcnt(9)
 v_mfma_f32_32x32x16_bf16 v[144:159], a[48:51], v[160:163], v[144:159]
 ds_read_b128 v[160:163], v13 offset:32384
 ds_read_b64 a[64:65], v12 offset:3520
 ds_read_b64 a[66:67], v12 offset:3528
 s_waitcnt lgkmcnt(9)
 v_mfma_f32_32x32x16_bf16 v[144:159], a[52:55], v[164:167], v[144:159]
 ds_read_b128 v[164:167], v13 offset:32416
 ds_read_b64 a[68:69], v12 offset:3552
 ds_read_b64 a[70:71], v12 offset:3560
 s_waitcnt lgkmcnt(9)
 v_mfma_f32_32x32x16_bf16 v[144:159], a[56:59], v[168:171], v[144:159]
 ds_read_b128 v[168:171], v13 offset:32304
 ds_read_b64 a[72:73], v12 offset:3456
 ds_read_b64 a[74:75], v12 offset:3464
 s_waitcnt lgkmcnt(9)
 v_mfma_f32_32x32x16_bf16 v[144:159], a[60:63], v[172:175], v[144:159]
 ds_read_b128 v[172:175], v13 offset:32336
 ds_read_b64 a[76:77], v12 offset:3488
 ds_read_b64 a[78:79], v12 offset:3496
 s_waitcnt lgkmcnt(9)
 v_mfma_f32_32x32x16_bf16 v[144:159], a[64:67], v[160:163], v[144:159]
 ds_read_b128 v[160:163], v13 offset:32224
 ds_read_b64 a[80:81], v12 offset:3392
 ds_read_b64 a[82:83], v12 offset:3400
 s_waitcnt lgkmcnt(9)
 v_mfma_f32_32x32x16_bf16 v[144:159], a[68:71], v[164:167], v[144:159]
 ds_read_b128 v[164:167], v13 offset:32256
 ds_read_b64 a[84:85], v12 offset:3424
 ds_read_b64 a[86:87], v12 offset:3432
 s_waitcnt lgkmcnt(9)
 v_mfma_f32_32x32x16_bf16 v[144:159], a[72:75], v[168:171], v[144:159]
 ds_read_b128 v[168:171], v13 offset:32144
 ds_read_b64 a[88:89], v12 offset:3328
 ds_read_b64 a[90:91], v12 offset:3336
 s_waitcnt lgkmcnt(9)
 v_mfma_f32_32x32x16_bf16 v[144:159], a[76:79], v[172:175], v[144:159]
 ds_read_b128 v[172:175], v13 offset:32176
 ds_read_b64 a[92:93], v12 offset:3360
 ds_read_b64 a[94:95], v12 offset:3368
 s_waitcnt lgkmcnt(9)
 v_mfma_f32_32x32x16_bf16 v[144:159], a[80:83], v[160:163], v[144:159]
 ds_read_b128 v[160:163], v13 offset:32064
 ds_read_b64 a[96:97], v12 offset:3264
 ds_read_b64 a[98:99], v12 offset:3272
 s_waitcnt lgkmcnt(9)
 v_mfma_f32_32x32x16_bf16 v[144:159], a[84:87], v[164:167], v[144:159]
 ds_read_b128 v[164:167], v13 offset:32096
 ds_read_b64 a[100:101], v12 offset:3296
 ds_read_b64 a[102:103], v12 offset:3304
 s_waitcnt lgkmcnt(9)
 v_mfma_f32_32x32x16_bf16 v[144:159], a[88:91], v[168:171], v[144:159]
 ds_read_b128 v[168:171], v13 offset:31984
 ds_read_b64 a[104:105], v12 offset:3200
 ds_read_b64 a[106:107], v12 offset:3208
 s_waitcnt lgkmcnt(9)
 v_mfma_f32_32x32x16_bf16 v[144:159], a[92:95], v[172:175], v[144:159]
 ds_read_b128 v[172:175], v13 offset:32016
 ds_read_b64 a[108:109], v12 offset:3232
 ds_read_b64 a[110:111], v12 offset:3240
 s_waitcnt lgkmcnt(9)
 v_mfma_f32_32x32x16_bf16 v[144:159], a[96:99], v[160:163], v[144:159]
 ds_read_b128 v[160:163], v13 offset:31904
 ds_read_b64 a[112:113], v12 offset:3136
 ds_read_b64 a[114:115], v12 offset:3144
 s_waitcnt lgkmcnt(9)
 v_mfma_f32_32x32x16_bf16 v[144:159], a[100:103], v[164:167], v[144:159]
 ds_read_b128 v[164:167], v13 offset:31936
 ds_read_b64 a[116:117], v12 offset:3168
 ds_read_b64 a[118:119], v12 offset:3176
 s_waitcnt lgkmcnt(9)
 v_mfma_f32_32x32x16_bf16 v[144:159], a[104:107], v[168:171], v[144:159]
 ds_read_b128 v[168:171], v13 offset:31824
 ds_read_b64 a[120:121], v12 offset:3072
 ds_read_b64 a[122:123], v12 offset:3080
 s_waitcnt lgkmcnt(9)
 v_mfma_f32_32x32x16_bf16 v[144:159], a[108:111], v[172:175], v[144:159]
 ds_read_b128 v[172:175], v13 offset:31856
 ds_read_b64 a[124:125], v12 offset:3104
 ds_read_b64 a[126:127], v12 offset:3112
 s_waitcnt lgkmcnt(9)
 v_mfma_f32_32x32x16_bf16 v[144:159], a[112:115], v[160:163], v[144:159]
 ds_read_b128 v[160:163], v13 offset:31744
 ds_read_b64 a[128:129], v12 offset:3008
 ds_read_b64 a[130:131], v12 offset:3016
 s_waitcnt lgkmcnt(9)
 v_mfma_f32_32x32x16_bf16 v[144:159], a[116:119], v[164:167], v[144:159]
 ds_read_b128 v[164:167], v13 offset:31776
 ds_read_b64 a[132:133], v12 offset:3040
 ds_read_b64 a[134:135], v12 offset:3048
 s_waitcnt lgkmcnt(9)
 v_mfma_f32_32x32x16_bf16 v[144:159], a[120:123], v[168:171], v[144:159]
 ds_read_b128 v[168:171], v13 offset:31664
 ds_read_b64 a[136:137], v12 offset:2944
 ds_read_b64 a[138:139], v12 offset:2952
 s_waitcnt lgkmcnt(9)
 v_mfma_f32_32x32x16_bf16 v[144:159], a[124:127], v[172:175], v[144:159]
 ds_read_b128 v[172:175], v13 offset:31696
 ds_read_b64 a[140:141], v12 offset:2976
 ds_read_b64 a[142:143], v12 offset:2984
 s_waitcnt lgkmcnt(9)
 v_mfma_f32_32x32x16_bf16 v[144:159], a[128:131], v[160:163], v[144:159]
 ds_read_b128 v[160:163], v13 offset:31584
 ds_read_b64 a[144:145], v12 offset:2880
 ds_read_b64 a[146:147], v12 offset:2888
 s_waitcnt lgkmcnt(9)
 v_mfma_f32_32x32x16_bf16 v[144:159], a[132:135], v[164:167], v[144:159]
 ds_read_b128 v[164:167], v13 offset:31616
 ds_read_b64 a[148:149], v12 offset:2912
 ds_read_b64 a[150:151], v12 offset:2920
 s_waitcnt lgkmcnt(9)
 v_mfma_f32_32x32x16_bf16 v[144:159], a[136:139], v[168:171], v[144:159]
 ds_read_b128 v[168:171], v13 offset:31504
 ds_read_b64 a[152:153], v12 offset:2816
 ds_read_b64 a[154:155], v12 offset:2824
 s_waitcnt lgkmcnt(9)
 v_mfma_f32_32x32x16_bf16 v[144:159], a[140:143], v[172:175], v[144:159]
 ds_read_b128 v[172:175], v13 offset:31536
 ds_read_b64 a[156:157], v12 offset:2848
 ds_read_b64 a[158:159], v12 offset:2856
 s_waitcnt lgkmcnt(9)
 v_mfma_f32_32x32x16_bf16 v[144:159], a[144:147], v[160:163], v[144:159]
 ds_read_b128 v[160:163], v13 offset:31424
 ds_read_b64 a[160:161], v12 offset:2752
 ds_read_b64 a[162:163], v12 offset:2760
 s_waitcnt lgkmcnt(9)
 v_mfma_f32_32x32x16_bf16 v[144:159], a[148:151], v[164:167], v[144:159]
 ds_read_b128 v[164:167], v13 offset:31456
 ds_read_b64 a[164:165], v12 offset:2784
 ds_read_b64 a[166:167], v12 offset:2792
 s_waitcnt lgkmcnt(9)
 v_mfma_f32_32x32x16_bf16 v[144:159], a[152:155], v[168:171], v[144:159]
 ds_read_b128 v[168:171], v13 offset:31344
 ds_read_b64 a[168:169], v12 offset:2688
 ds_read_b64 a[170:171], v12 offset:2696
 s_waitcnt lgkmcnt(9)
 v_mfma_f32_32x32x16_bf16 v[144:159], a[156:159], v[172:175], v[144:159]
 ds_read_b128 v[172:175], v13 offset:31376
 ds_read_b64 a[172:173], v12 offset:2720
 ds_read_b64 a[174:175], v12 offset:2728
 s_waitcnt lgkmcnt(9)
 v_mfma_f32_32x32x16_bf16 v[144:159], a[160:163], v[160:163], v[144:159]
 ds_read_b128 v[160:163], v13 offset:31264
 ds_read_b64 a[176:177], v12 offset:2624
 ds_read_b64 a[178:179], v12 offset:2632
 s_waitcnt lgkmcnt(9)
 v_mfma_f32_32x32x16_bf16 v[144:159], a[164:167], v[164:167], v[144:159]
 ds_read_b128 v[164:167], v13 offset:31296
 ds_read_b64 a[180:181], v12 offset:2656
 ds_read_b64 a[182:183], v12 offset:2664
 s_waitcnt lgkmcnt(9)
 v_mfma_f32_32x32x16_bf16 v[144:159], a[168:171], v[168:171], v[144:159]
 ds_read_b128 v[168:171], v13 offset:31184
 ds_read_b64 a[184:185], v12 offset:2560
 ds_read_b64 a[186:187], v12 offset:2568
 s_waitcnt lgkmcnt(9)
 v_mfma_f32_32x32x16_bf16 v[144:159], a[172:175], v[172:175], v[144:159]
 ds_read_b128 v[172:175], v13 offset:31216
 ds_read_b64 a[188:189], v12 offset:2592
 ds_read_b64 a[190:191], v12 offset:2600
 s_waitcnt lgkmcnt(9)
 v_mfma_f32_32x32x16_bf16 v[144:159], a[176:179], v[160:163], v[144:159]
 ds_read_b128 v[160:163], v13 offset:31104
 ds_read_b64 a[192:193], v12 offset:2496
 ds_read_b64 a[194:195], v12 offset:2504
 s_waitcnt lgkmcnt(9)
 v_mfma_f32_32x32x16_bf16 v[144:159], a[180:183], v[164:167], v[144:159]
 ds_read_b128 v[164:167], v13 offset:31136
 ds_read_b64 a[196:197], v12 offset:2528
 ds_read_b64 a[198:199], v12 offset:2536
 s_waitcnt lgkmcnt(9)
 v_mfma_f32_32x32x16_bf16 v[144:159], a[184:187], v[168:171], v[144:159]
 ds_read_b128 v[168:171], v13 offset:31024
 ds_read_b64 a[200:201], v12 offset:2432
 ds_read_b64 a[202:203], v12 offset:2440
 s_waitcnt lgkmcnt(9)
 v_mfma_f32_32x32x16_bf16 v[144:159], a[188:191], v[172:175], v[144:159]
 ds_read_b128 v[172:175], v13 offset:31056
 ds_read_b64 a[204:205], v12 offset:2464
 ds_read_b64 a[206:207], v12 offset:2472
 s_waitcnt lgkmcnt(9)
 v_mfma_f32_32x32x16_bf16 v[144:159], a[192:195], v[160:163], v[144:159]
 ds_read_b128 v[160:163], v13 offset:30944
 ds_read_b64 a[208:209], v12 offset:2368
 ds_read_b64 a[210:211], v12 offset:2376
 s_waitcnt lgkmcnt(9)
 v_mfma_f32_32x32x16_bf16 v[144:159], a[196:199], v[164:167], v[144:159]
 ds_read_b128 v[164:167], v13 offset:30976
 ds_read_b64 a[212:213], v12 offset:2400
 ds_read_b64 a[214:215], v12 offset:2408
 s_waitcnt lgkmcnt(9)
 v_mfma_f32_32x32x16_bf16 v[144:159], a[200:203], v[168:171], v[144:159]
 ds_read_b128 v[168:171], v13 offset:30864
 ds_read_b64 a[216:217], v12 offset:2304
 ds_read_b64 a[218:219], v12 offset:2312
 s_waitcnt lgkmcnt(9)
 v_mfma_f32_32x32x16_bf16 v[144:159], a[204:207], v[172:175], v[144:159]
 ds_read_b128 v[172:175], v13 offset:30896
 ds_read_b64 a[220:221], v12 offset:2336
 ds_read_b64 a[222:223], v12 offset:2344
 s_waitcnt lgkmcnt(9)
 v_mfma_f32_32x32x16_bf16 v[144:159], a[208:211], v[160:163], v[144:159]
 ds_read_b128 v[160:163], v13 offset:30784
 ds_read_b64 a[224:225], v12 offset:2240
 ds_read_b64 a[226:227], v12 offset:2248
 s_waitcnt lgkmcnt(9)
 v_mfma_f32_32x32x16_bf16 v[144:159], a[212:215], v[164:167], v[144:159]
 ds_read_b128 v[164:167], v13 offset:30816
 ds_read_b64 a[228:229], v12 offset:2272
 ds_read_b64 a[230:231], v12 offset:2280
 s_waitcnt lgkmcnt(9)
 v_mfma_f32_32x32x16_bf16 v[144:159], a[216:219], v[168:171], v[144:159]
 ds_read_b128 v[168:171], v13 offset:30704
 ds_read_b64 a[232:233], v12 offset:2176
 ds_read_b64 a[234:235], v12 offset:2184
 s_waitcnt lgkmcnt(9)
 v_mfma_f32_32x32x16_bf16 v[144:159], a[220:223], v[172:175], v[144:159]
 ds_read_b128 v[172:175], v13 offset:30736
 ds_read_b64 a[236:237], v12 offset:2208
 ds_read_b64 a[238:239], v12 offset:2216
 s_waitcnt lgkmcnt(9)
 v_mfma_f32_32x32x16_bf16 v[144:159], a[224:227], v[160:163], v[144:159]
 ds_read_b128 v[160:163], v13 offset:30624
 ds_read_b64 a[240:241], v12 offset:2112
 ds_read_b64 a[242:243], v12 offset:2120
 s_waitcnt lgkmcnt(9)
 v_mfma_f32_32x32x16_bf16 v[144:159], a[228:231], v[164:167], v[144:159]
 ds_read_b128 v[164:167], v13 offset:30656
 ds_read_b64 a[244:245], v12 offset:2144
 ds_read_b64 a[246:247], v12 offset:2152
 s_waitcnt lgkmcnt(9)
 v_mfma_f32_32x32x16_bf16 v[144:159], a[232:235], v[168:171], v[144:159]
 ds_read_b128 v[168:171], v13 offset:30544
 ds_read_b64 a[248:249], v12 offset:2048
 ds_read_b64 a[250:251], v12 offset:2056
 s_waitcnt lgkmcnt(9)
 v_mfma_f32_32x32x16_bf16 v[144:159], a[236:239], v[172:175], v[144:159]
 ds_read_b128 v[172:175], v13 offset:30576
 ds_read_b64 a[252:253], v12 offset:2080
 ds_read_b64 a[254:255], v12 offset:2088
 s_waitcnt lgkmcnt(9)
 v_mfma_f32_32x32x16_bf16 v[144:159], a[240:243], v[160:163], v[144:159]
 ds_read_b128 v[160:163], v13 offset:30464
 ds_read_b64 v[176:177], v12 offset:1984
 ds_read_b64 v[178:179], v12 offset:1992
 s_waitcnt lgkmcnt(9)
 v_mfma_f32_32x32x16_bf16 v[144:159], a[244:247], v[164:167], v[144:159]
 s_waitcnt lgkmcnt(6)
 v_mfma_f32_32x32x16_bf16 v[144:159], a[248:251], v[168:171], v[144:159]
 ds_read_b128 v[164:167], v13 offset:30496
 ds_read_b64 v[180:181], v12 offset:2016
 ds_read_b64 v[182:183], v12 offset:2024
 s_waitcnt lgkmcnt(6)
 v_mfma_f32_32x32x16_bf16 v[144:159], a[252:255], v[172:175], v[144:159]
 s_waitcnt lgkmcnt(3)
 v_mfma_f32_32x32x16_bf16 v[144:159], v[176:179], v[160:163], v[144:159]
 ds_read_b128 v[168:171], v13 offset:30384
 ds_read_b64 v[184:185], v12 offset:1920
 ds_read_b64 v[186:187], v12 offset:1928
 v_mfma_f32_32x32x16_bf16 v[128:143], a[0:3], v[160:163], v[128:143]
 s_waitcnt lgkmcnt(3)
 v_mfma_f32_32x32x16_bf16 v[144:159], v[180:183], v[164:167], v[144:159]
 ds_read_b128 v[172:175], v13 offset:30416
 ds_read_b64 v[188:189], v12 offset:1952
 ds_read_b64 v[190:191], v12 offset:1960
 v_mfma_f32_32x32x16_bf16 v[128:143], a[4:7], v[164:167], v[128:143]
 s_waitcnt lgkmcnt(3)
 v_mfma_f32_32x32x16_bf16 v[144:159], v[184:187], v[168:171], v[144:159]
 ds_read_b128 v[160:163], v13 offset:30304
 ds_read_b64 v[176:177], v12 offset:1856
 ds_read_b64 v[178:179], v12 offset:1864
 v_mfma_f32_32x32x16_bf16 v[128:143], a[8:11], v[168:171], v[128:143]
 s_waitcnt lgkmcnt(3)
 v_mfma_f32_32x32x16_bf16 v[144:159], v[188:191], v[172:175], v[144:159]
 ds_read_b128 v[164:167], v13 offset:30336
 ds_read_b64 v[180:181], v12 offset:1888
 ds_read_b64 v[182:183], v12 offset:1896
 v_mfma_f32_32x32x16_bf16 v[128:143], a[12:15], v[172:175], v[128:143]
 s_waitcnt lgkmcnt(3)
 v_mfma_f32_32x32x16_bf16 v[144:159], v[176:179], v[160:163], v[144:159]
 ds_read_b128 v[168:171], v13 offset:30224
 ds_read_b64 v[184:185], v12 offset:1792
 ds_read_b64 v[186:187], v12 offset:1800
 v_mfma_f32_32x32x16_bf16 v[128:143], a[16:19], v[160:163], v[128:143]
 s_waitcnt lgkmcnt(3)
 v_mfma_f32_32x32x16_bf16 v[144:159], v[180:183], v[164:167], v[144:159]
 ds_read_b128 v[172:175], v13 offset:30256
 ds_read_b64 v[188:189], v12 offset:1824
 ds_read_b64 v[190:191], v12 offset:1832
 v_mfma_f32_32x32x16_bf16 v[128:143], a[20:23], v[164:167], v[128:143]
 s_waitcnt lgkmcnt(3)
 v_mfma_f32_32x32x16_bf16 v[144:159], v[184:187], v[168:171], v[144:159]
 ds_read_b128 v[160:163], v13 offset:30144
 ds_read_b64 v[176:177], v12 offset:1728
 ds_read_b64 v[178:179], v12 offset:1736
 v_mfma_f32_32x32x16_bf16 v[128:143], a[24:27], v[168:171], v[128:143]
 s_waitcnt lgkmcnt(3)
 v_mfma_f32_32x32x16_bf16 v[144:159], v[188:191], v[172:175], v[144:159]
 ds_read_b128 v[164:167], v13 offset:30176
 ds_read_b64 v[180:181], v12 offset:1760
 ds_read_b64 v[182:183], v12 offset:1768
 v_mfma_f32_32x32x16_bf16 v[128:143], a[28:31], v[172:175], v[128:143]
 s_waitcnt lgkmcnt(3)
 v_mfma_f32_32x32x16_bf16 v[144:159], v[176:179], v[160:163], v[144:159]
 ds_read_b128 v[168:171], v13 offset:30064
 ds_read_b64 v[184:185], v12 offset:1664
 ds_read_b64 v[186:187], v12 offset:1672
 v_mfma_f32_32x32x16_bf16 v[128:143], a[32:35], v[160:163], v[128:143]
 s_waitcnt lgkmcnt(3)
 v_mfma_f32_32x32x16_bf16 v[144:159], v[180:183], v[164:167], v[144:159]
 ds_read_b128 v[172:175], v13 offset:30096
 ds_read_b64 v[188:189], v12 offset:1696
 ds_read_b64 v[190:191], v12 offset:1704
 v_mfma_f32_32x32x16_bf16 v[128:143], a[36:39], v[164:167], v[128:143]
 s_waitcnt lgkmcnt(3)
 v_mfma_f32_32x32x16_bf16 v[144:159], v[184:187], v[168:171], v[144:159]
 ds_read_b128 v[160:163], v13 offset:29984
 ds_read_b64 v[176:177], v12 offset:1600
 ds_read_b64 v[178:179], v12 offset:1608
 v_mfma_f32_32x32x16_bf16 v[128:143], a[40:43], v[168:171], v[128:143]
 s_waitcnt lgkmcnt(3)
 v_mfma_f32_32x32x16_bf16 v[144:159], v[188:191], v[172:175], v[144:159]
 ds_read_b128 v[164:167], v13 offset:30016
 ds_read_b64 v[180:181], v12 offset:1632
 ds_read_b64 v[182:183], v12 offset:1640
 v_mfma_f32_32x32x16_bf16 v[128:143], a[44:47], v[172:175], v[128:143]
 s_waitcnt lgkmcnt(3)
 v_mfma_f32_32x32x16_bf16 v[144:159], v[176:179], v[160:163], v[144:159]
 ds_read_b128 v[168:171], v13 offset:29904
 ds_read_b64 v[184:185], v12 offset:1536
 ds_read_b64 v[186:187], v12 offset:1544
 v_mfma_f32_32x32x16_bf16 v[128:143], a[48:51], v[160:163], v[128:143]
 s_waitcnt lgkmcnt(3)
 v_mfma_f32_32x32x16_bf16 v[144:159], v[180:183], v[164:167], v[144:159]
 ds_read_b128 v[172:175], v13 offset:29936
 ds_read_b64 v[188:189], v12 offset:1568
 ds_read_b64 v[190:191], v12 offset:1576
 v_mfma_f32_32x32x16_bf16 v[128:143], a[52:55], v[164:167], v[128:143]
 s_waitcnt lgkmcnt(3)
 v_mfma_f32_32x32x16_bf16 v[144:159], v[184:187], v[168:171], v[144:159]
 ds_read_b128 v[160:163], v13 offset:29824
 ds_read_b64 v[176:177], v12 offset:1472
 ds_read_b64 v[178:179], v12 offset:1480
 v_mfma_f32_32x32x16_bf16 v[128:143], a[56:59], v[168:171], v[128:143]
 s_waitcnt lgkmcnt(3)
 v_mfma_f32_32x32x16_bf16 v[144:159], v[188:191], v[172:175], v[144:159]
 ds_read_b128 v[164:167], v13 offset:29856
 ds_read_b64 v[180:181], v12 offset:1504
 ds_read_b64 v[182:183], v12 offset:1512
 v_mfma_f32_32x32x16_bf16 v[128:143], a[60:63], v[172:175], v[128:143]
 s_waitcnt lgkmcnt(3)
 v_mfma_f32_32x32x16_bf16 v[144:159], v[176:179], v[160:163], v[144:159]
 ds_read_b128 v[168:171], v13 offset:29744
 ds_read_b64 v[184:185], v12 offset:1408
 ds_read_b64 v[186:187], v12 offset:1416
 v_mfma_f32_32x32x16_bf16 v[128:143], a[64:67], v[160:163], v[128:143]
 s_waitcnt lgkmcnt(3)
 v_mfma_f32_32x32x16_bf16 v[144:159], v[180:183], v[164:167], v[144:159]
 ds_read_b128 v[172:175], v13 offset:29776
 ds_read_b64 v[188:189], v12 offset:1440
 ds_read_b64 v[190:191], v12 offset:1448
 v_mfma_f32_32x32x16_bf16 v[128:143], a[68:71], v[164:167], v[128:143]
 s_waitcnt lgkmcnt(3)
 v_mfma_f32_32x32x16_bf16 v[144:159], v[184:187], v[168:171], v[144:159]
 ds_read_b128 v[160:163], v13 offset:29664
 ds_read_b64 v[176:177], v12 offset:1344
 ds_read_b64 v[178:179], v12 offset:1352
 v_mfma_f32_32x32x16_bf16 v[128:143], a[72:75], v[168:171], v[128:143]
 s_waitcnt lgkmcnt(3)
 v_mfma_f32_32x32x16_bf16 v[144:159], v[188:191], v[172:175], v[144:159]
 ds_read_b128 v[164:167], v13 offset:29696
 ds_read_b64 v[180:181], v12 offset:1376
 ds_read_b64 v[182:183], v12 offset:1384
 v_mfma_f32_32x32x16_bf16 v[128:143], a[76:79], v[172:175], v[128:143]
 s_waitcnt lgkmcnt(3)
 v_mfma_f32_32x32x16_bf16 v[144:159], v[176:179], v[160:163], v[144:159]
 ds_read_b128 v[168:171], v13 offset:29584
 ds_read_b64 v[184:185], v12 offset:1280
 ds_read_b64 v[186:187], v12 offset:1288
 v_mfma_f32_32x32x16_bf16 v[128:143], a[80:83], v[160:163], v[128:143]
 s_waitcnt lgkmcnt(3)
 v_mfma_f32_32x32x16_bf16 v[144:159], v[180:183], v[164:167], v[144:159]
 ds_read_b128 v[172:175], v13 offset:29616
 ds_read_b64 v[188:189], v12 offset:1312
 ds_read_b64 v[190:191], v12 offset:1320
 v_mfma_f32_32x32x16_bf16 v[128:143], a[84:87], v[164:167], v[128:143]
 s_waitcnt lgkmcnt(3)
 v_mfma_f32_32x32x16_bf16 v[144:159], v[184:187], v[168:171], v[144:159]
 ds_read_b128 v[160:163], v13 offset:29504
 ds_read_b64 v[176:177], v12 offset:1216
 ds_read_b64 v[178:179], v12 offset:1224
 v_mfma_f32_32x32x16_bf16 v[128:143], a[88:91], v[168:171], v[128:143]
 s_waitcnt lgkmcnt(3)
 v_mfma_f32_32x32x16_bf16 v[144:159], v[188:191], v[172:175], v[144:159]
 ds_read_b128 v[164:167], v13 offset:29536
 ds_read_b64 v[180:181], v12 offset:1248
 ds_read_b64 v[182:183], v12 offset:1256
 v_mfma_f32_32x32x16_bf16 v[128:143], a[92:95], v[172:175], v[128:143]
 s_waitcnt lgkmcnt(3)
 v_mfma_f32_32x32x16_bf16 v[144:159], v[176:179], v[160:163], v[144:159]
 ds_read_b128 v[168:171], v13 offset:29424
 ds_read_b64 v[184:185], v12 offset:1152
 ds_read_b64 v[186:187], v12 offset:1160
 v_mfma_f32_32x32x16_bf16 v[128:143], a[96:99], v[160:163], v[128:143]
 s_waitcnt lgkmcnt(3)
 v_mfma_f32_32x32x16_bf16 v[144:159], v[180:183], v[164:167], v[144:159]
 ds_read_b128 v[172:175], v13 offset:29456
 ds_read_b64 v[188:189], v12 offset:1184
 ds_read_b64 v[190:191], v12 offset:1192
 v_mfma_f32_32x32x16_bf16 v[128:143], a[100:103], v[164:167], v[128:143]
 s_waitcnt lgkmcnt(3)
 v_mfma_f32_32x32x16_bf16 v[144:159], v[184:187], v[168:171], v[144:159]
 ds_read_b128 v[160:163], v13 offset:29344
 ds_read_b64 v[176:177], v12 offset:1088
 ds_read_b64 v[178:179], v12 offset:1096
 v_mfma_f32_32x32x16_bf16 v[128:143], a[104:107], v[168:171], v[128:143]
 s_waitcnt lgkmcnt(3)
 v_mfma_f32_32x32x16_bf16 v[144:159], v[188:191], v[172:175], v[144:159]
 ds_read_b128 v[164:167], v13 offset:29376
 ds_read_b64 v[180:181], v12 offset:1120
 ds_read_b64 v[182:183], v12 offset:1128
 v_mfma_f32_32x32x16_bf16 v[128:143], a[108:111], v[172:175], v[128:143]
 s_waitcnt lgkmcnt(3)
 v_mfma_f32_32x32x16_bf16 v[144:159], v[176:179], v[160:163], v[144:159]
 ds_read_b128 v[168:171], v13 offset:29264
 ds_read_b64 v[184:185], v12 offset:1024
 ds_read_b64 v[186:187], v12 offset:1032
 v_mfma_f32_32x32x16_bf16 v[128:143], a[112:115], v[160:163], v[128:143]
 s_waitcnt lgkmcnt(3)
 v_mfma_f32_32x32x16_bf16 v[144:159], v[180:183], v[164:167], v[144:159]
 ds_read_b128 v[172:175], v13 offset:29296
 ds_read_b64 v[188:189], v12 offset:1056
 ds_read_b64 v[190:191], v12 offset:1064
 v_mfma_f32_32x32x16_bf16 v[128:143], a[116:119], v[164:167], v[128:143]
 s_waitcnt lgkmcnt(3)
 v_mfma_f32_32x32x16_bf16 v[144:159], v[184:187], v[168:171], v[144:159]
 ds_read_b128 v[160:163], v13 offset:29184
 ds_read_b64 v[176:177], v12 offset:960
 ds_read_b64 v[178:179], v12 offset:968
 v_mfma_f32_32x32x16_bf16 v[128:143], a[120:123], v[168:171], v[128:143]
 s_waitcnt lgkmcnt(3)
 v_mfma_f32_32x32x16_bf16 v[144:159], v[188:191], v[172:175], v[144:159]
 ds_read_b128 v[164:167], v13 offset:29216
 ds_read_b64 v[180:181], v12 offset:992
 ds_read_b64 v[182:183], v12 offset:1000
 v_mfma_f32_32x32x16_bf16 v[128:143], a[124:127], v[172:175], v[128:143]
 s_waitcnt lgkmcnt(3)
 v_mfma_f32_32x32x16_bf16 v[144:159], v[176:179], v[160:163], v[144:159]
 ds_read_b128 v[168:171], v13 offset:29104
 ds_read_b64 v[184:185], v12 offset:896
 ds_read_b64 v[186:187], v12 offset:904
 v_mfma_f32_32x32x16_bf16 v[128:143], a[128:131], v[160:163], v[128:143]
 s_waitcnt lgkmcnt(3)
 v_mfma_f32_32x32x16_bf16 v[144:159], v[180:183], v[164:167], v[144:159]
 ds_read_b128 v[172:175], v13 offset:29136
 ds_read_b64 v[188:189], v12 offset:928
 ds_read_b64 v[190:191], v12 offset:936
 v_mfma_f32_32x32x16_bf16 v[128:143], a[132:135], v[164:167], v[128:143]
 s_waitcnt lgkmcnt(3)
 v_mfma_f32_32x32x16_bf16 v[144:159], v[184:187], v[168:171], v[144:159]
 ds_read_b128 v[160:163], v13 offset:29024
 ds_read_b64 v[176:177], v12 offset:832
 ds_read_b64 v[178:179], v12 offset:840
 v_mfma_f32_32x32x16_bf16 v[128:143], a[136:139], v[168:171], v[128:143]
 s_waitcnt lgkmcnt(3)
 v_mfma_f32_32x32x16_bf16 v[144:159], v[188:191], v[172:175], v[144:159]
 ds_read_b128 v[164:167], v13 offset:29056
 ds_read_b64 v[180:181], v12 offset:864
 ds_read_b64 v[182:183], v12 offset:872
 v_mfma_f32_32x32x16_bf16 v[128:143], a[140:143], v[172:175], v[128:143]
 s_waitcnt lgkmcnt(3)
 v_mfma_f32_32x32x16_bf16 v[144:159], v[176:179], v[160:163], v[144:159]
 ds_read_b128 v[168:171], v13 offset:28944
 ds_read_b64 v[184:185], v12 offset:768
 ds_read_b64 v[186:187], v12 offset:776
 v_mfma_f32_32x32x16_bf16 v[128:143], a[144:147], v[160:163], v[128:143]
 s_waitcnt lgkmcnt(3)
 v_mfma_f32_32x32x16_bf16 v[144:159], v[180:183], v[164:167], v[144:159]
 ds_read_b128 v[172:175], v13 offset:28976
 ds_read_b64 v[188:189], v12 offset:800
 ds_read_b64 v[190:191], v12 offset:808
 v_mfma_f32_32x32x16_bf16 v[128:143], a[148:151], v[164:167], v[128:143]
 s_waitcnt lgkmcnt(3)
 v_mfma_f32_32x32x16_bf16 v[144:159], v[184:187], v[168:171], v[144:159]
 ds_read_b128 v[160:163], v13 offset:28864
 ds_read_b64 v[176:177], v12 offset:704
 ds_read_b64 v[178:179], v12 offset:712
 v_mfma_f32_32x32x16_bf16 v[128:143], a[152:155], v[168:171], v[128:143]
 s_waitcnt lgkmcnt(3)
 v_mfma_f32_32x32x16_bf16 v[144:159], v[188:191], v[172:175], v[144:159]
 ds_read_b128 v[164:167], v13 offset:28896
 ds_read_b64 v[180:181], v12 offset:736
 ds_read_b64 v[182:183], v12 offset:744
 v_mfma_f32_32x32x16_bf16 v[128:143], a[156:159], v[172:175], v[128:143]
 s_waitcnt lgkmcnt(3)
 v_mfma_f32_32x32x16_bf16 v[144:159], v[176:179], v[160:163], v[144:159]
 ds_read_b128 v[168:171], v13 offset:28784
 ds_read_b64 v[184:185], v12 offset:640
 ds_read_b64 v[186:187], v12 offset:648
 v_mfma_f32_32x32x16_bf16 v[128:143], a[160:163], v[160:163], v[128:143]
 s_waitcnt lgkmcnt(3)
 v_mfma_f32_32x32x16_bf16 v[144:159], v[180:183], v[164:167], v[144:159]
 ds_read_b128 v[172:175], v13 offset:28816
 ds_read_b64 v[188:189], v12 offset:672
 ds_read_b64 v[190:191], v12 offset:680
 v_mfma_f32_32x32x16_bf16 v[128:143], a[164:167], v[164:167], v[128:143]
 s_waitcnt lgkmcnt(3)
 v_mfma_f32_32x32x16_bf16 v[144:159], v[184:187], v[168:171], v[144:159]
 ds_read_b128 v[160:163], v13 offset:28704
 ds_read_b64 v[176:177], v12 offset:576
 ds_read_b64 v[178:179], v12 offset:584
 v_mfma_f32_32x32x16_bf16 v[128:143], a[168:171], v[168:171], v[128:143]
 s_waitcnt lgkmcnt(3)
 v_mfma_f32_32x32x16_bf16 v[144:159], v[188:191], v[172:175], v[144:159]
 ds_read_b128 v[164:167], v13 offset:28736
 ds_read_b64 v[180:181], v12 offset:608
 ds_read_b64 v[182:183], v12 offset:616
 v_mfma_f32_32x32x16_bf16 v[128:143], a[172:175], v[172:175], v[128:143]
 s_waitcnt lgkmcnt(3)
 v_mfma_f32_32x32x16_bf16 v[144:159], v[176:179], v[160:163], v[144:159]
 ds_read_b128 v[168:171], v13 offset:28624
 ds_read_b64 v[184:185], v12 offset:512
 ds_read_b64 v[186:187], v12 offset:520
 v_mfma_f32_32x32x16_bf16 v[128:143], a[176:179], v[160:163], v[128:143]
 s_waitcnt lgkmcnt(3)
 v_mfma_f32_32x32x16_bf16 v[144:159], v[180:183], v[164:167], v[144:159]
 ds_read_b128 v[172:175], v13 offset:28656
 ds_read_b64 v[188:189], v12 offset:544
 ds_read_b64 v[190:191], v12 offset:552
 v_mfma_f32_32x32x16_bf16 v[128:143], a[180:183], v[164:167], v[128:143]
 s_waitcnt lgkmcnt(3)
 v_mfma_f32_32x32x16_bf16 v[144:159], v[184:187], v[168:171], v[144:159]
 ds_read_b128 v[160:163], v13 offset:28544
 ds_read_b64 v[176:177], v12 offset:448
 ds_read_b64 v[178:179], v12 offset:456
 v_mfma_f32_32x32x16_bf16 v[128:143], a[184:187], v[168:171], v[128:143]
 s_waitcnt lgkmcnt(3)
 v_mfma_f32_32x32x16_bf16 v[144:159], v[188:191], v[172:175], v[144:159]
 ds_read_b128 v[164:167], v13 offset:28576
 ds_read_b64 v[180:181], v12 offset:480
 ds_read_b64 v[182:183], v12 offset:488
 v_mfma_f32_32x32x16_bf16 v[128:143], a[188:191], v[172:175], v[128:143]
 s_waitcnt lgkmcnt(3)
 v_mfma_f32_32x32x16_bf16 v[144:159], v[176:179], v[160:163], v[144:159]
 ds_read_b128 v[168:171], v13 offset:28464
 ds_read_b64 v[184:185], v12 offset:384
 ds_read_b64 v[186:187], v12 offset:392
 v_mfma_f32_32x32x16_bf16 v[128:143], a[192:195], v[160:163], v[128:143]
 s_waitcnt lgkmcnt(3)
 v_mfma_f32_32x32x16_bf16 v[144:159], v[180:183], v[164:167], v[144:159]
 ds_read_b128 v[172:175], v13 offset:28496
 ds_read_b64 v[188:189], v12 offset:416
 ds_read_b64 v[190:191], v12 offset:424
 v_mfma_f32_32x32x16_bf16 v[128:143], a[196:199], v[164:167], v[128:143]
 s_waitcnt lgkmcnt(3)
 v_mfma_f32_32x32x16_bf16 v[144:159], v[184:187], v[168:171], v[144:159]
 ds_read_b128 v[160:163], v13 offset:28384
 ds_read_b64 v[176:177], v12 offset:320
 ds_read_b64 v[178:179], v12 offset:328
 v_mfma_f32_32x32x16_bf16 v[128:143], a[200:203], v[168:171], v[128:143]
 s_waitcnt lgkmcnt(3)
 v_mfma_f32_32x32x16_bf16 v[144:159], v[188:191], v[172:175], v[144:159]
 ds_read_b128 v[164:167], v13 offset:28416
 ds_read_b64 v[180:181], v12 offset:352
 ds_read_b64 v[182:183], v12 offset:360
 v_mfma_f32_32x32x16_bf16 v[128:143], a[204:207], v[172:175], v[128:143]
 s_waitcnt lgkmcnt(3)
 v_mfma_f32_32x32x16_bf16 v[144:159], v[176:179], v[160:163], v[144:159]
 ds_read_b128 v[168:171], v13 offset:28304
 ds_read_b64 v[184:185], v12 offset:256
 ds_read_b64 v[186:187], v12 offset:264
 v_mfma_f32_32x32x16_bf16 v[128:143], a[208:211], v[160:163], v[128:143]
 s_waitcnt lgkmcnt(3)
 v_mfma_f32_32x32x16_bf16 v[144:159], v[180:183], v[164:167], v[144:159]
 ds_read_b128 v[172:175], v13 offset:28336
 ds_read_b64 v[188:189], v12 offset:288
 ds_read_b64 v[190:191], v12 offset:296
 v_mfma_f32_32x32x16_bf16 v[128:143], a[212:215], v[164:167], v[128:143]
 s_waitcnt lgkmcnt(3)
 v_mfma_f32_32x32x16_bf16 v[144:159], v[184:187], v[168:171], v[144:159]
 ds_read_b128 v[160:163], v13 offset:28224
 ds_read_b64 v[176:177], v12 offset:192
 ds_read_b64 v[178:179], v12 offset:200
 v_mfma_f32_32x32x16_bf16 v[128:143], a[216:219], v[168:171], v[128:143]
 s_waitcnt lgkmcnt(3)
 v_mfma_f32_32x32x16_bf16 v[144:159], v[188:191], v[172:175], v[144:159]
 ds_read_b128 v[164:167], v13 offset:28256
 ds_read_b64 v[180:181], v12 offset:224
 ds_read_b64 v[182:183], v12 offset:232
 v_mfma_f32_32x32x16_bf16 v[128:143], a[220:223], v[172:175], v[128:143]
 s_waitcnt lgkmcnt(3)
 v_mfma_f32_32x32x16_bf16 v[144:159], v[176:179], v[160:163], v[144:159]
 ds_read_b128 v[168:171], v13 offset:28144
 ds_read_b64 v[184:185], v12 offset:128
 ds_read_b64 v[186:187], v12 offset:136
 v_mfma_f32_32x32x16_bf16 v[128:143], a[224:227], v[160:163], v[128:143]
 s_waitcnt lgkmcnt(3)
 v_mfma_f32_32x32x16_bf16 v[144:159], v[180:183], v[164:167], v[144:159]
 ds_read_b128 v[172:175], v13 offset:28176
 ds_read_b64 v[188:189], v12 offset:160
 ds_read_b64 v[190:191], v12 offset:168
 v_mfma_f32_32x32x16_bf16 v[128:143], a[228:231], v[164:167], v[128:143]
 s_waitcnt lgkmcnt(3)
 v_mfma_f32_32x32x16_bf16 v[144:159], v[184:187], v[168:171], v[144:159]
 ds_read_b128 v[160:163], v13 offset:28064
 ds_read_b64 v[176:177], v12 offset:64
 ds_read_b64 v[178:179], v12 offset:72
 v_mfma_f32_32x32x16_bf16 v[128:143], a[232:235], v[168:171], v[128:143]
 s_waitcnt lgkmcnt(3)
 v_mfma_f32_32x32x16_bf16 v[144:159], v[188:191], v[172:175], v[144:159]
 ds_read_b128 v[164:167], v13 offset:28096
 ds_read_b64 v[180:181], v12 offset:96
 ds_read_b64 v[182:183], v12 offset:104
 v_mfma_f32_32x32x16_bf16 v[128:143], a[236:239], v[172:175], v[128:143]
 s_waitcnt lgkmcnt(3)
 v_mfma_f32_32x32x16_bf16 v[144:159], v[176:179], v[160:163], v[144:159]
 ds_read_b128 v[168:171], v13 offset:27984
 ds_read_b64 v[184:185], v12 offset:0
 ds_read_b64 v[186:187], v12 offset:8
 v_mfma_f32_32x32x16_bf16 v[128:143], a[240:243], v[160:163], v[128:143]
 s_waitcnt lgkmcnt(3)
 v_mfma_f32_32x32x16_bf16 v[144:159], v[180:183], v[164:167], v[144:159]
 ds_read_b128 v[172:175], v13 offset:28016
 ds_read_b64 v[188:189], v12 offset:32
 ds_read_b64 v[190:191], v12 offset:40
 v_mfma_f32_32x32x16_bf16 v[128:143], a[244:247], v[164:167], v[128:143]
 s_waitcnt lgkmcnt(3)
 v_mfma_f32_32x32x16_bf16 v[144:159], v[184:187], v[168:171], v[144:159]
 v_mfma_f32_32x32x16_bf16 v[128:143], a[248:251], v[168:171], v[128:143]
 s_waitcnt lgkmcnt(0)
 v_mfma_f32_32x32x16_bf16 v[144:159], v[188:191], v[172:175], v[144:159]
 v_mfma_f32_32x32x16_bf16 v[128:143], a[252:255], v[172:175], v[128:143]
 v_mov_b32 v16, v22
 v_mov_b32 v17, v23
 v_mov_b32 v18, v24
 v_mov_b32 v19, v25
 v_mov_b32 v20, v26
 v_mov_b32 v21, v27
 v_mov_b32 v22, v28
 v_mov_b32 v23, v29
 v_mov_b32 v24, v30
 v_mov_b32 v25, v31
 v_mov_b32 v26, v32
 v_mov_b32 v27, v33
 v_mov_b32 v28, v34
 v_mov_b32 v29, v35
 v_mov_b32 v30, v36
 v_mov_b32 v31, v37
 v_mov_b32 v32, v38
 v_mov_b32 v33, v39
 v_cvt_pk_bf16_f32 v2, v128, v129
 v_perm_b32 v192, v2, v192, s70
 v_perm_b32 v194, v2, v194, s71
 v_cvt_pk_bf16_f32 v2, v130, v131
 v_perm_b32 v196, v2, v196, s70
 v_perm_b32 v198, v2, v198, s71
 v_cvt_pk_bf16_f32 v2, v132, v133
 v_perm_b32 v200, v2, v200, s70
 v_perm_b32 v202, v2, v202, s71
 v_cvt_pk_bf16_f32 v2, v134, v135
 v_perm_b32 v204, v2, v204, s70
 v_perm_b32 v206, v2, v206, s71
 v_cvt_pk_bf16_f32 v2, v136, v137
 v_perm_b32 v208, v2, v208, s70
 v_perm_b32 v210, v2, v210, s71
 v_cvt_pk_bf16_f32 v2, v138, v139
 v_perm_b32 v212, v2, v212, s70
 v_perm_b32 v214, v2, v214, s71
 v_cvt_pk_bf16_f32 v2, v140, v141
 v_perm_b32 v216, v2, v216, s70
 v_perm_b32 v218, v2, v218, s71
 v_cvt_pk_bf16_f32 v2, v142, v143
 v_perm_b32 v220, v2, v220, s70
 v_perm_b32 v222, v2, v222, s71
 v_cvt_pk_bf16_f32 v2, v144, v145
 v_perm_b32 v224, v2, v224, s70
 v_perm_b32 v226, v2, v226, s71
 v_cvt_pk_bf16_f32 v2, v146, v147
 v_perm_b32 v228, v2, v228, s70
 v_perm_b32 v230, v2, v230, s71
 v_cvt_pk_bf16_f32 v2, v148, v149
 v_perm_b32 v232, v2, v232, s70
 v_perm_b32 v234, v2, v234, s71
 v_cvt_pk_bf16_f32 v2, v150, v151
 v_perm_b32 v236, v2, v236, s70
 v_perm_b32 v238, v2, v238, s71
 v_cvt_pk_bf16_f32 v2, v152, v153
 v_perm_b32 v240, v2, v240, s70
 v_perm_b32 v242, v2, v242, s71
 v_cvt_pk_bf16_f32 v2, v154, v155
 v_perm_b32 v244, v2, v244, s70
 v_perm_b32 v246, v2, v246, s71
 v_cvt_pk_bf16_f32 v2, v156, v157
 v_perm_b32 v248, v2, v248, s70
 v_perm_b32 v250, v2, v250, s71
 v_cvt_pk_bf16_f32 v2, v158, v159
 v_perm_b32 v252, v2, v252, s70
 v_perm_b32 v254, v2, v254, s71
 s_lshr_b64 s[64:65], s[64:65], 16
 s_lshr_b64 s[66:67], s[66:67], 16
 s_bitcmp1_b32 s63, 0
 s_cbranch_scc0 Ls_noswap
 v_swap_b32 v192, v193
 v_swap_b32 v194, v195
 v_swap_b32 v196, v197
 v_swap_b32 v198, v199
 v_swap_b32 v200, v201
 v_swap_b32 v202, v203
 v_swap_b32 v204, v205
 v_swap_b32 v206, v207
 v_swap_b32 v208, v209
 v_swap_b32 v210, v211
 v_swap_b32 v212, v213
 v_swap_b32 v214, v215
 v_swap_b32 v216, v217
 v_swap_b32 v218, v219
 v_swap_b32 v220, v221
 v_swap_b32 v222, v223
 v_swap_b32 v224, v225
 v_swap_b32 v226, v227
 v_swap_b32 v228, v229
 v_swap_b32 v230, v231
 v_swap_b32 v232, v233
 v_swap_b32 v234, v235
 v_swap_b32 v236, v237
 v_swap_b32 v238, v239
 v_swap_b32 v240, v241
 v_swap_b32 v242, v243
 v_swap_b32 v244, v245
 v_swap_b32 v246, v247
 v_swap_b32 v248, v249
 v_swap_b32 v250, v251
 v_swap_b32 v252, v253
 v_swap_b32 v254, v255
Ls_noswap:
 s_add_u32 s63, s63, 1
 s_cmp_lt_u32 s63, 4
 s_cbranch_scc1 Ls_chan
 s_barrier
 ds_write_b64 v1, v[192:193] offset:0
 ds_write_b64 v1, v[194:195] offset:32
 ds_write_b64 v1, v[196:197] offset:64
 ds_write_b64 v1, v[198:199] offset:96
 ds_write_b64 v1, v[200:201] offset:256
 ds_write_b64 v1, v[202:203] offset:288
 ds_write_b64 v1, v[204:205] offset:320
 ds_write_b64 v1, v[206:207] offset:352
 ds_write_b64 v1, v[208:209] offset:512
 ds_write_b64 v1, v[210:211] offset:544
 ds_write_b64 v1, v[212:213] offset:576
 ds_write_b64 v1, v[214:215] offset:608
 ds_write_b64 v1, v[216:217] offset:768
 ds_write_b64 v1, v[218:219] offset:800
 ds_write_b64 v1, v[220:221] offset:832
 ds_write_b64 v1, v[222:223] offset:864
 ds_write_b64 v1, v[224:225] offset:33280
 ds_write_b64 v1, v[226:227] offset:33312
 ds_write_b64 v1, v[228:229] offset:33344
 ds_write_b64 v1, v[230:231] offset:33376
 ds_write_b64 v1, v[232:233] offset:33536
 ds_write_b64 v1, v[234:235] offset:33568
 ds_write_b64 v1, v[236:237] offset:33600
 ds_write_b64 v1, v[238:239] offset:33632
 ds_write_b64 v1, v[240:241] offset:33792
 ds_write_b64 v1, v[242:243] offset:33824
 ds_write_b64 v1, v[244:245] offset:33856
 ds_write_b64 v1, v[246:247] offset:33888
 ds_write_b64 v1, v[248:249] offset:34048
 ds_write_b64 v1, v[250:251] offset:34080
 ds_write_b64 v1, v[252:253] offset:34112
 ds_write_b64 v1, v[254:255] offset:34144
 s_mul_i32 s61, s4, 16640
 v_lshl_add_u32 v3, v0, 4, s61
 v_lshrrev_b32 v4, 1, v0
 v_and_b32 v5, 1, v0
 v_lshlrev_b32 v5, 4, v5
 v_lshl_add_u32 v4, v4, 12, v5
 s_lshr_b32 s61, s60, 2
 s_lshl_b32 s61, s61, 5
 s_lshl_b32 s62, s4, 21
 s_add_u32 s61, s61, s62
 s_add_u32 s61, s61, 2048
 s_waitcnt lgkmcnt(0)
 s_barrier
 ds_read_b128 v[84:87], v3 offset:0
 ds_read_b128 v[88:91], v3 offset:1040
 ds_read_b128 v[92:95], v3 offset:2080
 ds_read_b128 v[96:99], v3 offset:3120
 ds_read_b128 v[100:103], v3 offset:4160
 ds_read_b128 v[104:107], v3 offset:5200
 ds_read_b128 v[108:111], v3 offset:6240
 ds_read_b128 v[112:115], v3 offset:7280
 s_waitcnt lgkmcnt(7)
 s_add_u32 s62, s61, 0
 buffer_store_dwordx4 v[84:87], v4, s[56:59], s62 offen
 s_waitcnt lgkmcnt(6)
 s_add_u32 s62, s61, 131072
 buffer_store_dwordx4 v[88:91], v4, s[56:59], s62 offen
 s_waitcnt lgkmcnt(5)
 s_add_u32 s62, s61, 262144
 buffer_store_dwordx4 v[92:95], v4, s[56:59], s62 offen
 s_waitcnt lgkmcnt(4)
 s_add_u32 s62, s61, 393216
 buffer_store_dwordx4 v[96:99], v4, s[56:59], s62 offen
 s_waitcnt lgkmcnt(3)
 s_add_u32 s62, s61, 524288
 buffer_store_dwordx4 v[100:103], v4, s[56:59], s62 offen
 s_waitcnt lgkmcnt(2)
 s_add_u32 s62, s61, 655360
 buffer_store_dwordx4 v[104:107], v4, s[56:59], s62 offen
 s_waitcnt lgkmcnt(1)
 s_add_u32 s62, s61, 786432
 buffer_store_dwordx4 v[108:111], v4, s[56:59], s62 offen
 s_waitcnt lgkmcnt(0)
 s_add_u32 s62, s61, 917504
 buffer_store_dwordx4 v[112:115], v4, s[56:59], s62 offen
 s_waitcnt vmcnt(0)
 ds_read_b128 v[84:87], v3 offset:8320
 ds_read_b128 v[88:91], v3 offset:9360
 ds_read_b128 v[92:95], v3 offset:10400
 ds_read_b128 v[96:99], v3 offset:11440
 ds_read_b128 v[100:103], v3 offset:12480
 ds_read_b128 v[104:107], v3 offset:13520
 ds_read_b128 v[108:111], v3 offset:14560
 ds_read_b128 v[112:115], v3 offset:15600
 s_waitcnt lgkmcnt(7)
 s_add_u32 s62, s61, 1048576
 buffer_store_dwordx4 v[84:87], v4, s[56:59], s62 offen
 s_waitcnt lgkmcnt(6)
 s_add_u32 s62, s61, 1179648
 buffer_store_dwordx4 v[88:91], v4, s[56:59], s62 offen
 s_waitcnt lgkmcnt(5)
 s_add_u32 s62, s61, 1310720
 buffer_store_dwordx4 v[92:95], v4, s[56:59], s62 offen
 s_waitcnt lgkmcnt(4)
 s_add_u32 s62, s61, 1441792
 buffer_store_dwordx4 v[96:99], v4, s[56:59], s62 offen
 s_waitcnt lgkmcnt(3)
 s_add_u32 s62, s61, 1572864
 buffer_store_dwordx4 v[100:103], v4, s[56:59], s62 offen
 s_waitcnt lgkmcnt(2)
 s_add_u32 s62, s61, 1703936
 buffer_store_dwordx4 v[104:107], v4, s[56:59], s62 offen
 s_waitcnt lgkmcnt(1)
 s_add_u32 s62, s61, 1835008
 buffer_store_dwordx4 v[108:111], v4, s[56:59], s62 offen
 s_waitcnt lgkmcnt(0)
 s_add_u32 s62, s61, 1966080
 buffer_store_dwordx4 v[112:115], v4, s[56:59], s62 offen
L_code_end:
 s_endpgm
.section .rodata,"a"
.p2align 6
.amdhsa_kernel concat_heads__memory_aug_recurrent_mem_tr__ssm_conv_s4__prompt_kernel
  .amdhsa_next_free_vgpr 512
  .amdhsa_next_free_sgpr 102
  .amdhsa_accum_offset 256
  .amdhsa_group_segment_fixed_size 0
  .amdhsa_kernarg_size 152
  .amdhsa_user_sgpr_count 2
  .amdhsa_user_sgpr_kernarg_segment_ptr 1
  .amdhsa_system_sgpr_workgroup_id_x 1
  .amdhsa_float_denorm_mode_32 3
.end_amdhsa_kernel
```
